```python
import torch

def _softmax(x, axis=-1):
    return torch.softmax(x, dim=axis)

def _gelu(x):
    return torch.nn.functional.gelu(x, approximate='tanh')

def _silu(x):
    return torch.nn.functional.silu(x)

def _sigmoid(x):
    return torch.sigmoid(x)

def _layernorm(x, axis=-1, eps=1e-05):
    m = x.mean(dim=axis, keepdim=True)
    v = x.var(dim=axis, keepdim=True, unbiased=False)
    return (x - m) / torch.sqrt(v + eps)

def _scatter_add(tgt, idx, src, axis=0):
    return tgt.clone().index_add_(axis, idx, src)

def _segment_sum(src, seg, n):
    out = torch.zeros((n,) + src.shape[1:], dtype=src.dtype)
    return out.index_add_(0, seg, src)

def _pad(x, pw):
    flat = tuple((v for pair in reversed(pw) for v in pair))
    return torch.nn.functional.pad(x, flat)
kernel_name = 'adaLN_cond__mha_block__glu_gated_swiglu__prompt'

def setup_inputs():

    _w = lambda a: (lambda t: t.to(torch.bfloat16) if t.is_floating_point() else t)(torch.as_tensor(a))

    def _A_setup():
        B, S, D, H = (1, 2048, 576, 32)
        return {'x': _w((lambda *s: torch.randn(*s, dtype=torch.bfloat16) * 0.05)(B, S, D)), 'wqkv': _w((lambda *s: torch.randn(*s, dtype=torch.bfloat16) * 0.05)(D, 3 * D)), 'wo': _w((lambda *s: torch.randn(*s, dtype=torch.bfloat16) * 0.05)(D, D))}
    _A_in = _A_setup()

    def _B_setup():
        B, S, D, F = (1, 2048, 576, 4608)
        return {'x': _w((lambda *s: torch.randn(*s, dtype=torch.bfloat16) * 0.05)(B, S, D)), 'w1': _w((lambda *s: torch.randn(*s, dtype=torch.bfloat16) * 0.8)(D, F) * (2.0 / D) ** 0.5), 'w3': _w((lambda *s: torch.randn(*s, dtype=torch.bfloat16) * 0.8)(D, F) * (2.0 / D) ** 0.5), 'w2': _w((lambda *s: torch.randn(*s, dtype=torch.bfloat16) * 0.8)(F, D) * (2.0 / F) ** 0.5)}
    _B_in = _B_setup()
    return {'A_x': _A_in['x'], 'A_wqkv': _A_in['wqkv'], 'A_wo': _A_in['wo'], 'B_x': _B_in['x'], 'B_w1': _B_in['w1'], 'B_w3': _B_in['w3'], 'B_w2': _B_in['w2'], 'c': _w((lambda *s: torch.randn(*s, dtype=torch.bfloat16) * 0.2)(1, 576) * 8.0), 'w_mod': _w((lambda *s: torch.randn(*s, dtype=torch.bfloat16) * 0.2)(576, 6 * 576) * 576 ** (-0.5) * 8.0)}

def reference(A_x, A_wqkv, A_wo, B_x, B_w1, B_w3, B_w2, c, w_mod):

    def _A_ref(x, wqkv, wo):
        B, S, D = x.shape
        H = 32
        Dh = D // H
        qkv = (lambda x, *d: x.permute(*d))((x @ wqkv).reshape(B, S, 3, H, Dh), 2, 0, 3, 1, 4)
        q, k, v = (qkv[0], qkv[1], qkv[2])
        scores = torch.einsum('bhqd,bhkd->bhqk', q, k) * Dh ** (-0.5)
        p = _softmax(scores, axis=-1)
        o = torch.einsum('bhqk,bhkd->bhqd', p, v)
        return (lambda x, *d: x.permute(*d))(o, 0, 2, 1, 3).reshape(B, S, D) @ wo

    def _B_ref(x, w1, w3, w2):
        gate = torch.einsum('bsd,df->bsf', x, w1)
        up = torch.einsum('bsd,df->bsf', x, w3)
        h = _silu(gate) * up
        out = torch.einsum('bsf,fd->bsd', h, w2)
        return out
    x = A_x
    mod = (_silu(c) @ w_mod).reshape(c.shape[0], 6, 1, -1)
    sa, ca, ga, sb, cb, gb = (mod[:, 0].clone(), mod[:, 1].clone(), mod[:, 2].clone(), mod[:, 3].clone(), mod[:, 4].clone(), mod[:, 5].clone())
    h = _layernorm(x, axis=-1) * (1 + ca) + sa
    x = x + ga * _A_ref(h, A_wqkv, A_wo)
    h = _layernorm(x, axis=-1) * (1 + cb) + sb
    x = x + gb * _B_ref(h, B_w1, B_w3, B_w2)
    return x
```

```asm
; @launch kernel=k01_kernel grid=(254,1,1) block=(256,1,1) lds=152576
; @launch kernel=att_kernel grid=(256,1,1) block=(576,1,1) lds=163840
; @launch kernel=pg_kernel grid=(256,1,1) block=(256,1,1) lds=155648
.amdgcn_target "amdgcn-amd-amdhsa--gfx950"
.text
.globl k01_kernel
.p2align 8
.type k01_kernel,@function
k01_kernel:
 s_cmp_ge_u32 s2, 254
 s_cbranch_scc1 L_k01_end
 s_cmp_ge_u32 s2, 246
 s_cbranch_scc0 L_k01_main
 v_cmp_gt_u32 vcc, 64, v0
 s_nop 0
 s_and_saveexec_b64 s[40:41], vcc
 s_cbranch_execz L_k01_end
 s_getpc_b64 s[84:85]
L_k01_pc1:
 s_add_u32 s84, s84, L_k01_main-L_k01_pc1
 s_addc_u32 s85, s85, 0
 v_lshlrev_b32 v2, 7, v0
 v_add_u32 v2, 0, v2
 v_min_u32 v2, k01_kernel_codeend-L_k01_main-4, v2
 v_mov_b32 v3, s85
 v_add_co_u32 v2, vcc, s84, v2
 s_nop 1
 v_addc_co_u32 v3, vcc, 0, v3, vcc
 global_load_dword v5, v[2:3], off
 v_lshlrev_b32 v2, 7, v0
 v_add_u32 v2, 8192, v2
 v_min_u32 v2, k01_kernel_codeend-L_k01_main-4, v2
 v_mov_b32 v3, s85
 v_add_co_u32 v2, vcc, s84, v2
 s_nop 1
 v_addc_co_u32 v3, vcc, 0, v3, vcc
 global_load_dword v5, v[2:3], off
 v_lshlrev_b32 v2, 7, v0
 v_add_u32 v2, 16384, v2
 v_min_u32 v2, k01_kernel_codeend-L_k01_main-4, v2
 v_mov_b32 v3, s85
 v_add_co_u32 v2, vcc, s84, v2
 s_nop 1
 v_addc_co_u32 v3, vcc, 0, v3, vcc
 global_load_dword v5, v[2:3], off
 v_lshlrev_b32 v2, 7, v0
 v_add_u32 v2, 24576, v2
 v_min_u32 v2, k01_kernel_codeend-L_k01_main-4, v2
 v_mov_b32 v3, s85
 v_add_co_u32 v2, vcc, s84, v2
 s_nop 1
 v_addc_co_u32 v3, vcc, 0, v3, vcc
 global_load_dword v5, v[2:3], off
 v_lshlrev_b32 v2, 7, v0
 v_add_u32 v2, 32768, v2
 v_min_u32 v2, k01_kernel_codeend-L_k01_main-4, v2
 v_mov_b32 v3, s85
 v_add_co_u32 v2, vcc, s84, v2
 s_nop 1
 v_addc_co_u32 v3, vcc, 0, v3, vcc
 global_load_dword v5, v[2:3], off
 s_getpc_b64 s[84:85]
L_k01_pc2:
 s_add_u32 s84, s84, att_kernel-L_k01_pc2
 s_addc_u32 s85, s85, 0
 v_lshlrev_b32 v6, 7, v0
 v_add_u32 v6, 0, v6
 v_min_u32 v6, att_kernel_codeend-att_kernel-4, v6
 v_mov_b32 v7, s85
 v_add_co_u32 v6, vcc, s84, v6
 s_nop 1
 v_addc_co_u32 v7, vcc, 0, v7, vcc
 global_load_dword v9, v[6:7], off
 v_lshlrev_b32 v6, 7, v0
 v_add_u32 v6, 8192, v6
 v_min_u32 v6, att_kernel_codeend-att_kernel-4, v6
 v_mov_b32 v7, s85
 v_add_co_u32 v6, vcc, s84, v6
 s_nop 1
 v_addc_co_u32 v7, vcc, 0, v7, vcc
 global_load_dword v9, v[6:7], off
 v_lshlrev_b32 v6, 7, v0
 v_add_u32 v6, 16384, v6
 v_min_u32 v6, att_kernel_codeend-att_kernel-4, v6
 v_mov_b32 v7, s85
 v_add_co_u32 v6, vcc, s84, v6
 s_nop 1
 v_addc_co_u32 v7, vcc, 0, v7, vcc
 global_load_dword v9, v[6:7], off
 s_cmp_eq_u32 s2, 246
 s_cbranch_scc0 L_k01_end
 s_load_dwordx2 s[4:5], s[0:1], 88
 s_waitcnt lgkmcnt(0)
 s_add_u32 s12, s4, 59310080
 s_addc_u32 s13, s5, 0
 s_mov_b32 s14, 24576
 s_mov_b32 s15, 0x20000
 v_lshlrev_b32 v20, 7, v0
 v_mov_b32 v21, 0
 buffer_store_dword v21, v20, s[12:15], 0 offen
 s_mov_b32 s16, 8192
 buffer_store_dword v21, v20, s[12:15], s16 offen
 s_mov_b32 s16, 16384
 buffer_store_dword v21, v20, s[12:15], s16 offen
 s_branch L_k01_end
L_k01_main:
 s_load_dwordx2 s[4:5], s[0:1], 88
 s_cmp_ge_u32 s2, 192
 s_cbranch_scc1 L_k01_mod
 s_load_dwordx2 s[6:7], s[0:1], 0
 s_load_dwordx2 s[8:9], s[0:1], 8
 s_load_dwordx2 s[10:11], s[0:1], 80
 v_lshrrev_b32 v14, 6, v0
 v_and_b32 v0, 63, v0
 v_readfirstlane_b32 s32, v14
 v_lshlrev_b32 v1, 4, v0
 s_and_b32 s35, s2, 3
 s_lshl_b32 s33, s35, 2
 s_lshr_b32 s35, s2, 3
 s_and_b32 s36, s35, 3
 s_add_u32 s33, s33, s36
 s_lshr_b32 s34, s35, 2
 s_bfe_u32 s35, s2, 0x10002
 s_mul_i32 s35, s35, 6
 s_add_u32 s34, s34, s35
 s_lshl_b32 s38, s33, 2
 s_add_u32 s38, s38, s32
 s_waitcnt lgkmcnt(0)
 s_mov_b32 s16, s6
 s_mov_b32 s17, s7
 s_mov_b32 s18, 2359296
 s_mov_b32 s19, 0x20000
 s_mov_b32 s12, s8
 s_mov_b32 s13, s9
 s_mov_b32 s14, 1990656
 s_mov_b32 s15, 0x20000
 s_mul_i32 s35, s34, 43691
 s_lshr_b32 s35, s35, 18
 s_mul_i32 s35, s35, 6
 s_sub_u32 s35, s34, s35
 s_lshl_b32 s35, s35, 2
 s_add_u32 s35, s35, s32
 s_mul_i32 s35, s35, 6144
 s_mul_i32 s36, s33, 147456
 s_add_u32 s35, s35, s36
 v_lshlrev_b32 v12, 7, v0
 buffer_load_dword a82, v12, s[16:19], s35 offen
 s_and_b32 s35, s33, 3
 s_lshl_b32 s35, s35, 2
 s_add_u32 s35, s35, s32
 s_mul_i32 s35, s35, 36
 v_mul_u32_u24 v12, 21846, v0
 v_lshrrev_b32 v12, 16, v12
 v_mul_u32_u24 v13, 3, v12
 v_sub_u32 v13, v0, v13
 v_lshlrev_b32 v13, 7, v13
 v_add_u32 v12, s35, v12
 v_mul_u32_u24 v12, 3456, v12
 v_add_u32 v12, v12, v13
 s_mul_i32 s35, s34, 288
 s_and_b32 s35, s35, 0xffffff80
 buffer_load_dword a83, v12, s[12:15], s35 offen
 v_add_u32 v12, 72576, v12
 buffer_load_dword a83, v12, s[12:15], s35 offen
 s_mul_i32 s39, s32, 36864
 s_lshl_b32 s37, s38, 5
 s_mul_i32 s37, s37, 1152
 v_xor_b32 v10, 0, v1
 s_add_u32 m0, s39, 0
 s_add_u32 s35, s37, 0
 buffer_load_dwordx4 v10, s[16:19], s35 offen lds
 v_xor_b32 v11, 128, v1
 s_add_u32 m0, s39, 1024
 s_add_u32 s35, s37, 1152
 buffer_load_dwordx4 v11, s[16:19], s35 offen lds
 v_xor_b32 v10, 16, v1
 s_add_u32 m0, s39, 2048
 s_add_u32 s35, s37, 2304
 buffer_load_dwordx4 v10, s[16:19], s35 offen lds
 v_xor_b32 v11, 144, v1
 s_add_u32 m0, s39, 3072
 s_add_u32 s35, s37, 3456
 buffer_load_dwordx4 v11, s[16:19], s35 offen lds
 v_xor_b32 v10, 32, v1
 s_add_u32 m0, s39, 4096
 s_add_u32 s35, s37, 4608
 buffer_load_dwordx4 v10, s[16:19], s35 offen lds
 v_xor_b32 v11, 160, v1
 s_add_u32 m0, s39, 5120
 s_add_u32 s35, s37, 5760
 buffer_load_dwordx4 v11, s[16:19], s35 offen lds
 v_xor_b32 v10, 48, v1
 s_add_u32 m0, s39, 6144
 s_add_u32 s35, s37, 6912
 buffer_load_dwordx4 v10, s[16:19], s35 offen lds
 v_xor_b32 v11, 176, v1
 s_add_u32 m0, s39, 7168
 s_add_u32 s35, s37, 8064
 buffer_load_dwordx4 v11, s[16:19], s35 offen lds
 v_xor_b32 v10, 64, v1
 s_add_u32 m0, s39, 8192
 s_add_u32 s35, s37, 9216
 buffer_load_dwordx4 v10, s[16:19], s35 offen lds
 v_xor_b32 v11, 192, v1
 s_add_u32 m0, s39, 9216
 s_add_u32 s35, s37, 10368
 buffer_load_dwordx4 v11, s[16:19], s35 offen lds
 v_xor_b32 v10, 80, v1
 s_add_u32 m0, s39, 10240
 s_add_u32 s35, s37, 11520
 buffer_load_dwordx4 v10, s[16:19], s35 offen lds
 v_xor_b32 v11, 208, v1
 s_add_u32 m0, s39, 11264
 s_add_u32 s35, s37, 12672
 buffer_load_dwordx4 v11, s[16:19], s35 offen lds
 v_xor_b32 v10, 96, v1
 s_add_u32 m0, s39, 12288
 s_add_u32 s35, s37, 13824
 buffer_load_dwordx4 v10, s[16:19], s35 offen lds
 v_xor_b32 v11, 224, v1
 s_add_u32 m0, s39, 13312
 s_add_u32 s35, s37, 14976
 buffer_load_dwordx4 v11, s[16:19], s35 offen lds
 v_xor_b32 v10, 112, v1
 s_add_u32 m0, s39, 14336
 s_add_u32 s35, s37, 16128
 buffer_load_dwordx4 v10, s[16:19], s35 offen lds
 v_xor_b32 v11, 240, v1
 s_add_u32 m0, s39, 15360
 s_add_u32 s35, s37, 17280
 buffer_load_dwordx4 v11, s[16:19], s35 offen lds
 v_xor_b32 v10, 0, v1
 s_add_u32 m0, s39, 16384
 s_add_u32 s35, s37, 18432
 buffer_load_dwordx4 v10, s[16:19], s35 offen lds
 v_xor_b32 v11, 128, v1
 s_add_u32 m0, s39, 17408
 s_add_u32 s35, s37, 19584
 buffer_load_dwordx4 v11, s[16:19], s35 offen lds
 v_xor_b32 v10, 16, v1
 s_add_u32 m0, s39, 18432
 s_add_u32 s35, s37, 20736
 buffer_load_dwordx4 v10, s[16:19], s35 offen lds
 v_xor_b32 v11, 144, v1
 s_add_u32 m0, s39, 19456
 s_add_u32 s35, s37, 21888
 buffer_load_dwordx4 v11, s[16:19], s35 offen lds
 v_xor_b32 v10, 32, v1
 s_add_u32 m0, s39, 20480
 s_add_u32 s35, s37, 23040
 buffer_load_dwordx4 v10, s[16:19], s35 offen lds
 v_xor_b32 v11, 160, v1
 s_add_u32 m0, s39, 21504
 s_add_u32 s35, s37, 24192
 buffer_load_dwordx4 v11, s[16:19], s35 offen lds
 v_xor_b32 v10, 48, v1
 s_add_u32 m0, s39, 22528
 s_add_u32 s35, s37, 25344
 buffer_load_dwordx4 v10, s[16:19], s35 offen lds
 v_xor_b32 v11, 176, v1
 s_add_u32 m0, s39, 23552
 s_add_u32 s35, s37, 26496
 buffer_load_dwordx4 v11, s[16:19], s35 offen lds
 v_xor_b32 v10, 64, v1
 s_add_u32 m0, s39, 24576
 s_add_u32 s35, s37, 27648
 buffer_load_dwordx4 v10, s[16:19], s35 offen lds
 v_xor_b32 v11, 192, v1
 s_add_u32 m0, s39, 25600
 s_add_u32 s35, s37, 28800
 buffer_load_dwordx4 v11, s[16:19], s35 offen lds
 v_xor_b32 v10, 80, v1
 s_add_u32 m0, s39, 26624
 s_add_u32 s35, s37, 29952
 buffer_load_dwordx4 v10, s[16:19], s35 offen lds
 v_xor_b32 v11, 208, v1
 s_add_u32 m0, s39, 27648
 s_add_u32 s35, s37, 31104
 buffer_load_dwordx4 v11, s[16:19], s35 offen lds
 v_xor_b32 v10, 96, v1
 s_add_u32 m0, s39, 28672
 s_add_u32 s35, s37, 32256
 buffer_load_dwordx4 v10, s[16:19], s35 offen lds
 v_xor_b32 v11, 224, v1
 s_add_u32 m0, s39, 29696
 s_add_u32 s35, s37, 33408
 buffer_load_dwordx4 v11, s[16:19], s35 offen lds
 v_xor_b32 v10, 112, v1
 s_add_u32 m0, s39, 30720
 s_add_u32 s35, s37, 34560
 buffer_load_dwordx4 v10, s[16:19], s35 offen lds
 v_xor_b32 v11, 240, v1
 s_add_u32 m0, s39, 31744
 s_add_u32 s35, s37, 35712
 buffer_load_dwordx4 v11, s[16:19], s35 offen lds
 v_lshrrev_b32 v13, 3, v0
 v_mul_u32_u24 v13, 1152, v13
 v_add_u32 v13, 1024, v13
 v_and_b32 v14, 7, v0
 v_lshrrev_b32 v15, 4, v0
 v_add_u32 v11, 0, v15
 v_xor_b32 v11, v11, v14
 v_lshlrev_b32 v11, 4, v11
 v_add_u32 v11, v11, v13
 s_add_u32 m0, s39, 32768
 s_add_u32 s35, s37, 0
 buffer_load_dwordx4 v11, s[16:19], s35 offen lds
 v_add_u32 v11, 4, v15
 v_xor_b32 v11, v11, v14
 v_lshlrev_b32 v11, 4, v11
 v_add_u32 v11, v11, v13
 s_add_u32 m0, s39, 33792
 s_add_u32 s35, s37, 9216
 buffer_load_dwordx4 v11, s[16:19], s35 offen lds
 v_add_u32 v11, 0, v15
 v_xor_b32 v11, v11, v14
 v_lshlrev_b32 v11, 4, v11
 v_add_u32 v11, v11, v13
 s_add_u32 m0, s39, 34816
 s_add_u32 s35, s37, 18432
 buffer_load_dwordx4 v11, s[16:19], s35 offen lds
 v_add_u32 v11, 4, v15
 v_xor_b32 v11, v11, v14
 v_lshlrev_b32 v11, 4, v11
 v_add_u32 v11, v11, v13
 s_add_u32 m0, s39, 35840
 s_add_u32 s35, s37, 27648
 buffer_load_dwordx4 v11, s[16:19], s35 offen lds
 s_mov_b32 s20, s4
 s_mov_b32 s21, s5
 s_mov_b32 s22, 13824
 s_mov_b32 s23, 0x20000
 s_mov_b32 s48, s10
 s_mov_b32 s49, s11
 s_mov_b32 s50, 256
 s_mov_b32 s51, 0x20000
 s_add_u32 s24, s4, 65536
 s_addc_u32 s25, s5, 0
 s_mov_b32 s26, 2097152
 s_mov_b32 s27, 0x20000
 s_add_u32 s28, s4, 2162688
 s_addc_u32 s29, s5, 0
 s_mov_b32 s30, 262144
 s_mov_b32 s31, 0x20000
 s_add_u32 s44, s4, 2424832
 s_addc_u32 s45, s5, 0
 s_mov_b32 s46, 4849664
 s_mov_b32 s47, 0x20000
 v_add_u32 v13, 0, v0
 v_mul_u32_u24 v14, 3641, v13
 v_lshrrev_b32 v14, 16, v14
 v_mul_u32_u24 v15, 18, v14
 v_sub_u32 v13, v13, v15
 v_lshrrev_b32 v15, 1, v14
 v_and_b32 v15, 4, v15
 v_xor_b32 v14, v14, v15
 v_mul_u32_u24 v14, 3456, v14
 v_lshlrev_b32 v13, 4, v13
 v_add_u32 v160, v13, v14
 v_add_u32 v13, 64, v0
 v_mul_u32_u24 v14, 3641, v13
 v_lshrrev_b32 v14, 16, v14
 v_mul_u32_u24 v15, 18, v14
 v_sub_u32 v13, v13, v15
 v_lshrrev_b32 v15, 1, v14
 v_and_b32 v15, 4, v15
 v_xor_b32 v14, v14, v15
 v_mul_u32_u24 v14, 3456, v14
 v_lshlrev_b32 v13, 4, v13
 v_add_u32 v161, v13, v14
 v_add_u32 v13, 128, v0
 v_mul_u32_u24 v14, 3641, v13
 v_lshrrev_b32 v14, 16, v14
 v_mul_u32_u24 v15, 18, v14
 v_sub_u32 v13, v13, v15
 v_lshrrev_b32 v15, 1, v14
 v_and_b32 v15, 4, v15
 v_xor_b32 v14, v14, v15
 v_mul_u32_u24 v14, 3456, v14
 v_lshlrev_b32 v13, 4, v13
 v_add_u32 v162, v13, v14
 v_add_u32 v13, 192, v0
 v_mul_u32_u24 v14, 3641, v13
 v_lshrrev_b32 v14, 16, v14
 v_mul_u32_u24 v15, 18, v14
 v_sub_u32 v13, v13, v15
 v_lshrrev_b32 v15, 1, v14
 v_and_b32 v15, 4, v15
 v_xor_b32 v14, v14, v15
 v_mul_u32_u24 v14, 3456, v14
 v_lshlrev_b32 v13, 4, v13
 v_add_u32 v163, v13, v14
 v_add_u32 v13, 256, v0
 v_mul_u32_u24 v14, 3641, v13
 v_lshrrev_b32 v14, 16, v14
 v_mul_u32_u24 v15, 18, v14
 v_sub_u32 v13, v13, v15
 v_lshrrev_b32 v15, 1, v14
 v_and_b32 v15, 4, v15
 v_xor_b32 v14, v14, v15
 v_mul_u32_u24 v14, 3456, v14
 v_lshlrev_b32 v13, 4, v13
 v_add_u32 v164, v13, v14
 v_add_u32 v13, 320, v0
 v_mul_u32_u24 v14, 3641, v13
 v_lshrrev_b32 v14, 16, v14
 v_mul_u32_u24 v15, 18, v14
 v_sub_u32 v13, v13, v15
 v_lshrrev_b32 v15, 1, v14
 v_and_b32 v15, 4, v15
 v_xor_b32 v14, v14, v15
 v_mul_u32_u24 v14, 3456, v14
 v_lshlrev_b32 v13, 4, v13
 v_add_u32 v165, v13, v14
 v_add_u32 v13, 384, v0
 v_mul_u32_u24 v14, 3641, v13
 v_lshrrev_b32 v14, 16, v14
 v_mul_u32_u24 v15, 18, v14
 v_sub_u32 v13, v13, v15
 v_lshrrev_b32 v15, 1, v14
 v_and_b32 v15, 4, v15
 v_xor_b32 v14, v14, v15
 v_mul_u32_u24 v14, 3456, v14
 v_lshlrev_b32 v13, 4, v13
 v_add_u32 v166, v13, v14
 v_add_u32 v13, 448, v0
 v_mul_u32_u24 v14, 3641, v13
 v_lshrrev_b32 v14, 16, v14
 v_mul_u32_u24 v15, 18, v14
 v_sub_u32 v13, v13, v15
 v_lshrrev_b32 v15, 1, v14
 v_and_b32 v15, 4, v15
 v_xor_b32 v14, v14, v15
 v_mul_u32_u24 v14, 3456, v14
 v_lshlrev_b32 v13, 4, v13
 v_add_u32 v167, v13, v14
 v_add_u32 v13, 512, v0
 v_mul_u32_u24 v14, 3641, v13
 v_lshrrev_b32 v14, 16, v14
 v_mul_u32_u24 v15, 18, v14
 v_sub_u32 v13, v13, v15
 v_lshrrev_b32 v15, 1, v14
 v_and_b32 v15, 4, v15
 v_xor_b32 v14, v14, v15
 v_mul_u32_u24 v14, 3456, v14
 v_lshlrev_b32 v13, 4, v13
 v_add_u32 v168, v13, v14
 s_mul_i32 s37, s34, 288
 s_mul_i32 s35, s32, 110592
 s_add_u32 s37, s37, s35
 v_and_b32 v13, 15, v0
 v_lshrrev_b32 v14, 1, v13
 v_and_b32 v15, 1, v13
 v_lshlrev_b32 v15, 3, v15
 v_or_b32 v15, v15, v14
 v_lshrrev_b32 v12, 4, v0
 v_lshlrev_b32 v11, 10, v13
 v_add_u32 v11, s39, v11
 v_add_u32 v9, 0, v12
 v_xor_b32 v9, v9, v15
 v_lshlrev_b32 v9, 4, v9
 v_add_u32 v232, v9, v11
 v_add_u32 v9, 4, v12
 v_xor_b32 v9, v9, v15
 v_lshlrev_b32 v9, 4, v9
 v_add_u32 v233, v9, v11
 v_add_u32 v9, 8, v12
 v_xor_b32 v9, v9, v15
 v_lshlrev_b32 v9, 4, v9
 v_add_u32 v234, v9, v11
 v_add_u32 v9, 12, v12
 v_xor_b32 v9, v9, v15
 v_lshlrev_b32 v9, 4, v9
 v_add_u32 v235, v9, v11
 v_lshlrev_b32 v11, 7, v13
 v_add_u32 v11, s39, v11
 v_add_u32 v11, 32768, v11
 v_add_u32 v9, 0, v12
 v_xor_b32 v9, v9, v14
 v_lshlrev_b32 v9, 4, v9
 v_add_u32 v236, v9, v11
 v_add_u32 v9, 4, v12
 v_xor_b32 v9, v9, v14
 v_lshlrev_b32 v9, 4, v9
 v_add_u32 v237, v9, v11
 s_waitcnt vmcnt(0)
 ds_read_b128 v[16:19], v232 offset:0
 ds_read_b128 v[88:91], v232 offset:16384
 ds_read_b128 v[20:23], v233 offset:0
 ds_read_b128 v[92:95], v233 offset:16384
 ds_read_b128 v[24:27], v234 offset:0
 ds_read_b128 v[96:99], v234 offset:16384
 ds_read_b128 v[28:31], v235 offset:0
 ds_read_b128 v[100:103], v235 offset:16384
 ds_read_b128 v[32:35], v232 offset:256
 ds_read_b128 v[104:107], v232 offset:16640
 ds_read_b128 v[36:39], v233 offset:256
 ds_read_b128 v[108:111], v233 offset:16640
 ds_read_b128 v[40:43], v234 offset:256
 ds_read_b128 v[112:115], v234 offset:16640
 ds_read_b128 v[44:47], v235 offset:256
 ds_read_b128 v[116:119], v235 offset:16640
 ds_read_b128 v[48:51], v232 offset:512
 ds_read_b128 v[120:123], v232 offset:16896
 ds_read_b128 v[52:55], v233 offset:512
 ds_read_b128 v[124:127], v233 offset:16896
 ds_read_b128 v[56:59], v234 offset:512
 ds_read_b128 v[128:131], v234 offset:16896
 ds_read_b128 v[60:63], v235 offset:512
 ds_read_b128 v[132:135], v235 offset:16896
 ds_read_b128 v[64:67], v232 offset:768
 ds_read_b128 v[136:139], v232 offset:17152
 ds_read_b128 v[68:71], v233 offset:768
 ds_read_b128 v[140:143], v233 offset:17152
 ds_read_b128 v[72:75], v234 offset:768
 ds_read_b128 v[144:147], v234 offset:17152
 ds_read_b128 v[76:79], v235 offset:768
 ds_read_b128 v[148:151], v235 offset:17152
 ds_read_b128 v[80:83], v236 offset:0
 ds_read_b128 v[152:155], v236 offset:2048
 ds_read_b128 v[84:87], v237 offset:0
 ds_read_b128 v[156:159], v237 offset:2048
 s_waitcnt lgkmcnt(0)
 s_barrier
 s_mul_i32 s37, s34, 288
 s_mul_i32 s35, s32, 110592
 s_add_u32 s37, s37, s35
 s_mul_i32 s39, s32, 9216
 v_lshrrev_b32 v13, 4, v0
 v_lshlrev_b32 v13, 3, v13
 v_bfe_u32 v14, v0, 2, 2
 v_add_u32 v13, v13, v14
 v_lshrrev_b32 v14, 1, v13
 v_and_b32 v14, 4, v14
 v_xor_b32 v15, v13, v14
 v_mul_u32_u24 v15, 288, v15
 v_and_b32 v14, 3, v0
 v_lshlrev_b32 v14, 3, v14
 v_add_u32 v2, v15, v14
 v_add_u32 v13, 4, v13
 v_lshrrev_b32 v15, 1, v13
 v_and_b32 v15, 4, v15
 v_xor_b32 v15, v13, v15
 v_mul_u32_u24 v15, 288, v15
 v_add_u32 v5, v15, v14
 v_add_u32 v3, 64512, v2
 v_add_u32 v6, 64512, v5
 v_add_u32 v4, 129024, v2
 v_add_u32 v7, 129024, v5
 v_lshrrev_b32 v13, 4, v0
 v_lshlrev_b32 v13, 5, v13
 v_add_u32 v8, 147456, v13
 v_mov_b32 v232, 0
 v_mov_b32 v233, 0
 v_mov_b32 v234, 0
 v_mov_b32 v235, 0
 v_mov_b32 v236, 0x3f803f80
 v_dot2_f32_bf16 v232, v16, v236, v232
 v_dot2_f32_bf16 v233, v16, v16, v233
 v_dot2_f32_bf16 v232, v17, v236, v232
 v_dot2_f32_bf16 v233, v17, v17, v233
 v_dot2_f32_bf16 v232, v18, v236, v232
 v_dot2_f32_bf16 v233, v18, v18, v233
 v_dot2_f32_bf16 v232, v19, v236, v232
 v_dot2_f32_bf16 v233, v19, v19, v233
 s_add_u32 m0, s39, 0
 s_add_u32 s35, s37, 0
 buffer_load_dwordx4 v160, s[12:15], s35 offen lds
 v_dot2_f32_bf16 v234, v88, v236, v234
 v_dot2_f32_bf16 v235, v88, v88, v235
 v_dot2_f32_bf16 v234, v89, v236, v234
 v_dot2_f32_bf16 v235, v89, v89, v235
 v_dot2_f32_bf16 v234, v90, v236, v234
 v_dot2_f32_bf16 v235, v90, v90, v235
 v_dot2_f32_bf16 v234, v91, v236, v234
 v_dot2_f32_bf16 v235, v91, v91, v235
 s_add_u32 m0, s39, 1024
 s_add_u32 s35, s37, 0
 buffer_load_dwordx4 v161, s[12:15], s35 offen lds
 v_dot2_f32_bf16 v232, v20, v236, v232
 v_dot2_f32_bf16 v233, v20, v20, v233
 v_dot2_f32_bf16 v232, v21, v236, v232
 v_dot2_f32_bf16 v233, v21, v21, v233
 v_dot2_f32_bf16 v232, v22, v236, v232
 v_dot2_f32_bf16 v233, v22, v22, v233
 v_dot2_f32_bf16 v232, v23, v236, v232
 v_dot2_f32_bf16 v233, v23, v23, v233
 s_add_u32 m0, s39, 2048
 s_add_u32 s35, s37, 0
 buffer_load_dwordx4 v162, s[12:15], s35 offen lds
 v_dot2_f32_bf16 v234, v92, v236, v234
 v_dot2_f32_bf16 v235, v92, v92, v235
 v_dot2_f32_bf16 v234, v93, v236, v234
 v_dot2_f32_bf16 v235, v93, v93, v235
 v_dot2_f32_bf16 v234, v94, v236, v234
 v_dot2_f32_bf16 v235, v94, v94, v235
 v_dot2_f32_bf16 v234, v95, v236, v234
 v_dot2_f32_bf16 v235, v95, v95, v235
 s_add_u32 m0, s39, 3072
 s_add_u32 s35, s37, 0
 buffer_load_dwordx4 v163, s[12:15], s35 offen lds
 v_dot2_f32_bf16 v232, v24, v236, v232
 v_dot2_f32_bf16 v233, v24, v24, v233
 v_dot2_f32_bf16 v232, v25, v236, v232
 v_dot2_f32_bf16 v233, v25, v25, v233
 v_dot2_f32_bf16 v232, v26, v236, v232
 v_dot2_f32_bf16 v233, v26, v26, v233
 v_dot2_f32_bf16 v232, v27, v236, v232
 v_dot2_f32_bf16 v233, v27, v27, v233
 s_add_u32 m0, s39, 4096
 s_add_u32 s35, s37, 0
 buffer_load_dwordx4 v164, s[12:15], s35 offen lds
 v_dot2_f32_bf16 v234, v96, v236, v234
 v_dot2_f32_bf16 v235, v96, v96, v235
 v_dot2_f32_bf16 v234, v97, v236, v234
 v_dot2_f32_bf16 v235, v97, v97, v235
 v_dot2_f32_bf16 v234, v98, v236, v234
 v_dot2_f32_bf16 v235, v98, v98, v235
 v_dot2_f32_bf16 v234, v99, v236, v234
 v_dot2_f32_bf16 v235, v99, v99, v235
 s_add_u32 m0, s39, 5120
 s_add_u32 s35, s37, 0
 buffer_load_dwordx4 v165, s[12:15], s35 offen lds
 v_dot2_f32_bf16 v232, v28, v236, v232
 v_dot2_f32_bf16 v233, v28, v28, v233
 v_dot2_f32_bf16 v232, v29, v236, v232
 v_dot2_f32_bf16 v233, v29, v29, v233
 v_dot2_f32_bf16 v232, v30, v236, v232
 v_dot2_f32_bf16 v233, v30, v30, v233
 v_dot2_f32_bf16 v232, v31, v236, v232
 v_dot2_f32_bf16 v233, v31, v31, v233
 s_add_u32 m0, s39, 6144
 s_add_u32 s35, s37, 0
 buffer_load_dwordx4 v166, s[12:15], s35 offen lds
 v_dot2_f32_bf16 v234, v100, v236, v234
 v_dot2_f32_bf16 v235, v100, v100, v235
 v_dot2_f32_bf16 v234, v101, v236, v234
 v_dot2_f32_bf16 v235, v101, v101, v235
 v_dot2_f32_bf16 v234, v102, v236, v234
 v_dot2_f32_bf16 v235, v102, v102, v235
 v_dot2_f32_bf16 v234, v103, v236, v234
 v_dot2_f32_bf16 v235, v103, v103, v235
 s_add_u32 m0, s39, 7168
 s_add_u32 s35, s37, 0
 buffer_load_dwordx4 v167, s[12:15], s35 offen lds
 v_dot2_f32_bf16 v232, v32, v236, v232
 v_dot2_f32_bf16 v233, v32, v32, v233
 v_dot2_f32_bf16 v232, v33, v236, v232
 v_dot2_f32_bf16 v233, v33, v33, v233
 v_dot2_f32_bf16 v232, v34, v236, v232
 v_dot2_f32_bf16 v233, v34, v34, v233
 v_dot2_f32_bf16 v232, v35, v236, v232
 v_dot2_f32_bf16 v233, v35, v35, v233
 s_add_u32 m0, s39, 8192
 s_add_u32 s35, s37, 0
 buffer_load_dwordx4 v168, s[12:15], s35 offen lds
 v_dot2_f32_bf16 v234, v104, v236, v234
 v_dot2_f32_bf16 v235, v104, v104, v235
 v_dot2_f32_bf16 v234, v105, v236, v234
 v_dot2_f32_bf16 v235, v105, v105, v235
 v_dot2_f32_bf16 v234, v106, v236, v234
 v_dot2_f32_bf16 v235, v106, v106, v235
 v_dot2_f32_bf16 v234, v107, v236, v234
 v_dot2_f32_bf16 v235, v107, v107, v235
 s_add_u32 m0, s39, 36864
 s_add_u32 s35, s37, 442368
 buffer_load_dwordx4 v160, s[12:15], s35 offen lds
 v_dot2_f32_bf16 v232, v36, v236, v232
 v_dot2_f32_bf16 v233, v36, v36, v233
 v_dot2_f32_bf16 v232, v37, v236, v232
 v_dot2_f32_bf16 v233, v37, v37, v233
 v_dot2_f32_bf16 v232, v38, v236, v232
 v_dot2_f32_bf16 v233, v38, v38, v233
 v_dot2_f32_bf16 v232, v39, v236, v232
 v_dot2_f32_bf16 v233, v39, v39, v233
 s_add_u32 m0, s39, 37888
 s_add_u32 s35, s37, 442368
 buffer_load_dwordx4 v161, s[12:15], s35 offen lds
 v_dot2_f32_bf16 v234, v108, v236, v234
 v_dot2_f32_bf16 v235, v108, v108, v235
 v_dot2_f32_bf16 v234, v109, v236, v234
 v_dot2_f32_bf16 v235, v109, v109, v235
 v_dot2_f32_bf16 v234, v110, v236, v234
 v_dot2_f32_bf16 v235, v110, v110, v235
 v_dot2_f32_bf16 v234, v111, v236, v234
 v_dot2_f32_bf16 v235, v111, v111, v235
 s_add_u32 m0, s39, 38912
 s_add_u32 s35, s37, 442368
 buffer_load_dwordx4 v162, s[12:15], s35 offen lds
 v_dot2_f32_bf16 v232, v40, v236, v232
 v_dot2_f32_bf16 v233, v40, v40, v233
 v_dot2_f32_bf16 v232, v41, v236, v232
 v_dot2_f32_bf16 v233, v41, v41, v233
 v_dot2_f32_bf16 v232, v42, v236, v232
 v_dot2_f32_bf16 v233, v42, v42, v233
 v_dot2_f32_bf16 v232, v43, v236, v232
 v_dot2_f32_bf16 v233, v43, v43, v233
 s_add_u32 m0, s39, 39936
 s_add_u32 s35, s37, 442368
 buffer_load_dwordx4 v163, s[12:15], s35 offen lds
 v_dot2_f32_bf16 v234, v112, v236, v234
 v_dot2_f32_bf16 v235, v112, v112, v235
 v_dot2_f32_bf16 v234, v113, v236, v234
 v_dot2_f32_bf16 v235, v113, v113, v235
 v_dot2_f32_bf16 v234, v114, v236, v234
 v_dot2_f32_bf16 v235, v114, v114, v235
 v_dot2_f32_bf16 v234, v115, v236, v234
 v_dot2_f32_bf16 v235, v115, v115, v235
 s_add_u32 m0, s39, 40960
 s_add_u32 s35, s37, 442368
 buffer_load_dwordx4 v164, s[12:15], s35 offen lds
 v_dot2_f32_bf16 v232, v44, v236, v232
 v_dot2_f32_bf16 v233, v44, v44, v233
 v_dot2_f32_bf16 v232, v45, v236, v232
 v_dot2_f32_bf16 v233, v45, v45, v233
 v_dot2_f32_bf16 v232, v46, v236, v232
 v_dot2_f32_bf16 v233, v46, v46, v233
 v_dot2_f32_bf16 v232, v47, v236, v232
 v_dot2_f32_bf16 v233, v47, v47, v233
 s_add_u32 m0, s39, 41984
 s_add_u32 s35, s37, 442368
 buffer_load_dwordx4 v165, s[12:15], s35 offen lds
 v_dot2_f32_bf16 v234, v116, v236, v234
 v_dot2_f32_bf16 v235, v116, v116, v235
 v_dot2_f32_bf16 v234, v117, v236, v234
 v_dot2_f32_bf16 v235, v117, v117, v235
 v_dot2_f32_bf16 v234, v118, v236, v234
 v_dot2_f32_bf16 v235, v118, v118, v235
 v_dot2_f32_bf16 v234, v119, v236, v234
 v_dot2_f32_bf16 v235, v119, v119, v235
 s_add_u32 m0, s39, 43008
 s_add_u32 s35, s37, 442368
 buffer_load_dwordx4 v166, s[12:15], s35 offen lds
 v_dot2_f32_bf16 v232, v48, v236, v232
 v_dot2_f32_bf16 v233, v48, v48, v233
 v_dot2_f32_bf16 v232, v49, v236, v232
 v_dot2_f32_bf16 v233, v49, v49, v233
 v_dot2_f32_bf16 v232, v50, v236, v232
 v_dot2_f32_bf16 v233, v50, v50, v233
 v_dot2_f32_bf16 v232, v51, v236, v232
 v_dot2_f32_bf16 v233, v51, v51, v233
 s_add_u32 m0, s39, 44032
 s_add_u32 s35, s37, 442368
 buffer_load_dwordx4 v167, s[12:15], s35 offen lds
 v_dot2_f32_bf16 v234, v120, v236, v234
 v_dot2_f32_bf16 v235, v120, v120, v235
 v_dot2_f32_bf16 v234, v121, v236, v234
 v_dot2_f32_bf16 v235, v121, v121, v235
 v_dot2_f32_bf16 v234, v122, v236, v234
 v_dot2_f32_bf16 v235, v122, v122, v235
 v_dot2_f32_bf16 v234, v123, v236, v234
 v_dot2_f32_bf16 v235, v123, v123, v235
 s_add_u32 m0, s39, 45056
 s_add_u32 s35, s37, 442368
 buffer_load_dwordx4 v168, s[12:15], s35 offen lds
 v_dot2_f32_bf16 v232, v52, v236, v232
 v_dot2_f32_bf16 v233, v52, v52, v233
 v_dot2_f32_bf16 v232, v53, v236, v232
 v_dot2_f32_bf16 v233, v53, v53, v233
 v_dot2_f32_bf16 v232, v54, v236, v232
 v_dot2_f32_bf16 v233, v54, v54, v233
 v_dot2_f32_bf16 v232, v55, v236, v232
 v_dot2_f32_bf16 v233, v55, v55, v233
 s_add_u32 m0, s39, 73728
 s_add_u32 s35, s37, 884736
 buffer_load_dwordx4 v160, s[12:15], s35 offen lds
 v_dot2_f32_bf16 v234, v124, v236, v234
 v_dot2_f32_bf16 v235, v124, v124, v235
 v_dot2_f32_bf16 v234, v125, v236, v234
 v_dot2_f32_bf16 v235, v125, v125, v235
 v_dot2_f32_bf16 v234, v126, v236, v234
 v_dot2_f32_bf16 v235, v126, v126, v235
 v_dot2_f32_bf16 v234, v127, v236, v234
 v_dot2_f32_bf16 v235, v127, v127, v235
 s_add_u32 m0, s39, 74752
 s_add_u32 s35, s37, 884736
 buffer_load_dwordx4 v161, s[12:15], s35 offen lds
 v_dot2_f32_bf16 v232, v56, v236, v232
 v_dot2_f32_bf16 v233, v56, v56, v233
 v_dot2_f32_bf16 v232, v57, v236, v232
 v_dot2_f32_bf16 v233, v57, v57, v233
 v_dot2_f32_bf16 v232, v58, v236, v232
 v_dot2_f32_bf16 v233, v58, v58, v233
 v_dot2_f32_bf16 v232, v59, v236, v232
 v_dot2_f32_bf16 v233, v59, v59, v233
 s_add_u32 m0, s39, 75776
 s_add_u32 s35, s37, 884736
 buffer_load_dwordx4 v162, s[12:15], s35 offen lds
 v_dot2_f32_bf16 v234, v128, v236, v234
 v_dot2_f32_bf16 v235, v128, v128, v235
 v_dot2_f32_bf16 v234, v129, v236, v234
 v_dot2_f32_bf16 v235, v129, v129, v235
 v_dot2_f32_bf16 v234, v130, v236, v234
 v_dot2_f32_bf16 v235, v130, v130, v235
 v_dot2_f32_bf16 v234, v131, v236, v234
 v_dot2_f32_bf16 v235, v131, v131, v235
 s_add_u32 m0, s39, 76800
 s_add_u32 s35, s37, 884736
 buffer_load_dwordx4 v163, s[12:15], s35 offen lds
 v_dot2_f32_bf16 v232, v60, v236, v232
 v_dot2_f32_bf16 v233, v60, v60, v233
 v_dot2_f32_bf16 v232, v61, v236, v232
 v_dot2_f32_bf16 v233, v61, v61, v233
 v_dot2_f32_bf16 v232, v62, v236, v232
 v_dot2_f32_bf16 v233, v62, v62, v233
 v_dot2_f32_bf16 v232, v63, v236, v232
 v_dot2_f32_bf16 v233, v63, v63, v233
 s_add_u32 m0, s39, 77824
 s_add_u32 s35, s37, 884736
 buffer_load_dwordx4 v164, s[12:15], s35 offen lds
 v_dot2_f32_bf16 v234, v132, v236, v234
 v_dot2_f32_bf16 v235, v132, v132, v235
 v_dot2_f32_bf16 v234, v133, v236, v234
 v_dot2_f32_bf16 v235, v133, v133, v235
 v_dot2_f32_bf16 v234, v134, v236, v234
 v_dot2_f32_bf16 v235, v134, v134, v235
 v_dot2_f32_bf16 v234, v135, v236, v234
 v_dot2_f32_bf16 v235, v135, v135, v235
 s_add_u32 m0, s39, 78848
 s_add_u32 s35, s37, 884736
 buffer_load_dwordx4 v165, s[12:15], s35 offen lds
 v_dot2_f32_bf16 v232, v64, v236, v232
 v_dot2_f32_bf16 v233, v64, v64, v233
 v_dot2_f32_bf16 v232, v65, v236, v232
 v_dot2_f32_bf16 v233, v65, v65, v233
 v_dot2_f32_bf16 v232, v66, v236, v232
 v_dot2_f32_bf16 v233, v66, v66, v233
 v_dot2_f32_bf16 v232, v67, v236, v232
 v_dot2_f32_bf16 v233, v67, v67, v233
 s_add_u32 m0, s39, 79872
 s_add_u32 s35, s37, 884736
 buffer_load_dwordx4 v166, s[12:15], s35 offen lds
 v_dot2_f32_bf16 v234, v136, v236, v234
 v_dot2_f32_bf16 v235, v136, v136, v235
 v_dot2_f32_bf16 v234, v137, v236, v234
 v_dot2_f32_bf16 v235, v137, v137, v235
 v_dot2_f32_bf16 v234, v138, v236, v234
 v_dot2_f32_bf16 v235, v138, v138, v235
 v_dot2_f32_bf16 v234, v139, v236, v234
 v_dot2_f32_bf16 v235, v139, v139, v235
 s_add_u32 m0, s39, 80896
 s_add_u32 s35, s37, 884736
 buffer_load_dwordx4 v167, s[12:15], s35 offen lds
 v_dot2_f32_bf16 v232, v68, v236, v232
 v_dot2_f32_bf16 v233, v68, v68, v233
 v_dot2_f32_bf16 v232, v69, v236, v232
 v_dot2_f32_bf16 v233, v69, v69, v233
 v_dot2_f32_bf16 v232, v70, v236, v232
 v_dot2_f32_bf16 v233, v70, v70, v233
 v_dot2_f32_bf16 v232, v71, v236, v232
 v_dot2_f32_bf16 v233, v71, v71, v233
 s_add_u32 m0, s39, 81920
 s_add_u32 s35, s37, 884736
 buffer_load_dwordx4 v168, s[12:15], s35 offen lds
 v_dot2_f32_bf16 v234, v140, v236, v234
 v_dot2_f32_bf16 v235, v140, v140, v235
 v_dot2_f32_bf16 v234, v141, v236, v234
 v_dot2_f32_bf16 v235, v141, v141, v235
 v_dot2_f32_bf16 v234, v142, v236, v234
 v_dot2_f32_bf16 v235, v142, v142, v235
 v_dot2_f32_bf16 v234, v143, v236, v234
 v_dot2_f32_bf16 v235, v143, v143, v235
 s_add_u32 m0, s39, 110592
 s_add_u32 s35, s37, 1327104
 buffer_load_dwordx4 v160, s[12:15], s35 offen lds
 v_dot2_f32_bf16 v232, v72, v236, v232
 v_dot2_f32_bf16 v233, v72, v72, v233
 v_dot2_f32_bf16 v232, v73, v236, v232
 v_dot2_f32_bf16 v233, v73, v73, v233
 v_dot2_f32_bf16 v232, v74, v236, v232
 v_dot2_f32_bf16 v233, v74, v74, v233
 v_dot2_f32_bf16 v232, v75, v236, v232
 v_dot2_f32_bf16 v233, v75, v75, v233
 s_add_u32 m0, s39, 111616
 s_add_u32 s35, s37, 1327104
 buffer_load_dwordx4 v161, s[12:15], s35 offen lds
 v_dot2_f32_bf16 v234, v144, v236, v234
 v_dot2_f32_bf16 v235, v144, v144, v235
 v_dot2_f32_bf16 v234, v145, v236, v234
 v_dot2_f32_bf16 v235, v145, v145, v235
 v_dot2_f32_bf16 v234, v146, v236, v234
 v_dot2_f32_bf16 v235, v146, v146, v235
 v_dot2_f32_bf16 v234, v147, v236, v234
 v_dot2_f32_bf16 v235, v147, v147, v235
 s_add_u32 m0, s39, 112640
 s_add_u32 s35, s37, 1327104
 buffer_load_dwordx4 v162, s[12:15], s35 offen lds
 v_dot2_f32_bf16 v232, v76, v236, v232
 v_dot2_f32_bf16 v233, v76, v76, v233
 v_dot2_f32_bf16 v232, v77, v236, v232
 v_dot2_f32_bf16 v233, v77, v77, v233
 v_dot2_f32_bf16 v232, v78, v236, v232
 v_dot2_f32_bf16 v233, v78, v78, v233
 v_dot2_f32_bf16 v232, v79, v236, v232
 v_dot2_f32_bf16 v233, v79, v79, v233
 s_add_u32 m0, s39, 113664
 s_add_u32 s35, s37, 1327104
 buffer_load_dwordx4 v163, s[12:15], s35 offen lds
 v_dot2_f32_bf16 v234, v148, v236, v234
 v_dot2_f32_bf16 v235, v148, v148, v235
 v_dot2_f32_bf16 v234, v149, v236, v234
 v_dot2_f32_bf16 v235, v149, v149, v235
 v_dot2_f32_bf16 v234, v150, v236, v234
 v_dot2_f32_bf16 v235, v150, v150, v235
 v_dot2_f32_bf16 v234, v151, v236, v234
 v_dot2_f32_bf16 v235, v151, v151, v235
 s_add_u32 m0, s39, 114688
 s_add_u32 s35, s37, 1327104
 buffer_load_dwordx4 v164, s[12:15], s35 offen lds
 v_dot2_f32_bf16 v232, v80, v236, v232
 v_dot2_f32_bf16 v233, v80, v80, v233
 v_dot2_f32_bf16 v232, v81, v236, v232
 v_dot2_f32_bf16 v233, v81, v81, v233
 v_dot2_f32_bf16 v232, v82, v236, v232
 v_dot2_f32_bf16 v233, v82, v82, v233
 v_dot2_f32_bf16 v232, v83, v236, v232
 v_dot2_f32_bf16 v233, v83, v83, v233
 s_add_u32 m0, s39, 115712
 s_add_u32 s35, s37, 1327104
 buffer_load_dwordx4 v165, s[12:15], s35 offen lds
 v_dot2_f32_bf16 v234, v152, v236, v234
 v_dot2_f32_bf16 v235, v152, v152, v235
 v_dot2_f32_bf16 v234, v153, v236, v234
 v_dot2_f32_bf16 v235, v153, v153, v235
 v_dot2_f32_bf16 v234, v154, v236, v234
 v_dot2_f32_bf16 v235, v154, v154, v235
 v_dot2_f32_bf16 v234, v155, v236, v234
 v_dot2_f32_bf16 v235, v155, v155, v235
 s_add_u32 m0, s39, 116736
 s_add_u32 s35, s37, 1327104
 buffer_load_dwordx4 v166, s[12:15], s35 offen lds
 v_dot2_f32_bf16 v232, v84, v236, v232
 v_dot2_f32_bf16 v233, v84, v84, v233
 v_dot2_f32_bf16 v232, v85, v236, v232
 v_dot2_f32_bf16 v233, v85, v85, v233
 v_dot2_f32_bf16 v232, v86, v236, v232
 v_dot2_f32_bf16 v233, v86, v86, v233
 v_dot2_f32_bf16 v232, v87, v236, v232
 v_dot2_f32_bf16 v233, v87, v87, v233
 s_add_u32 m0, s39, 117760
 s_add_u32 s35, s37, 1327104
 buffer_load_dwordx4 v167, s[12:15], s35 offen lds
 v_dot2_f32_bf16 v234, v156, v236, v234
 v_dot2_f32_bf16 v235, v156, v156, v235
 v_dot2_f32_bf16 v234, v157, v236, v234
 v_dot2_f32_bf16 v235, v157, v157, v235
 v_dot2_f32_bf16 v234, v158, v236, v234
 v_dot2_f32_bf16 v235, v158, v158, v235
 v_dot2_f32_bf16 v234, v159, v236, v234
 v_dot2_f32_bf16 v235, v159, v159, v235
 s_add_u32 m0, s39, 118784
 s_add_u32 s35, s37, 1327104
 buffer_load_dwordx4 v168, s[12:15], s35 offen lds
 v_accvgpr_write_b32 a72, v160
 v_accvgpr_write_b32 a73, v161
 v_accvgpr_write_b32 a74, v162
 v_accvgpr_write_b32 a75, v163
 v_accvgpr_write_b32 a76, v164
 v_accvgpr_write_b32 a77, v165
 v_accvgpr_write_b32 a78, v166
 v_accvgpr_write_b32 a79, v167
 v_accvgpr_write_b32 a80, v168
 v_mov_b32 v13, v232
 s_nop 1
 v_permlane32_swap_b32 v232, v13
 v_add_f32 v232, v232, v13
 v_mov_b32 v13, v232
 s_nop 1
 v_permlane16_swap_b32 v232, v13
 v_add_f32 v232, v232, v13
 v_mov_b32 v13, v233
 s_nop 1
 v_permlane32_swap_b32 v233, v13
 v_add_f32 v233, v233, v13
 v_mov_b32 v13, v233
 s_nop 1
 v_permlane16_swap_b32 v233, v13
 v_add_f32 v233, v233, v13
 v_mov_b32 v13, v234
 s_nop 1
 v_permlane32_swap_b32 v234, v13
 v_add_f32 v234, v234, v13
 v_mov_b32 v13, v234
 s_nop 1
 v_permlane16_swap_b32 v234, v13
 v_add_f32 v234, v234, v13
 v_mov_b32 v13, v235
 s_nop 1
 v_permlane32_swap_b32 v235, v13
 v_add_f32 v235, v235, v13
 v_mov_b32 v13, v235
 s_nop 1
 v_permlane16_swap_b32 v235, v13
 v_add_f32 v235, v235, v13
 v_mul_f32 v232, 0x3ae38e39, v232
 v_mul_f32 v233, 0x3ae38e39, v233
 v_fma_f32 v233, -v232, v232, v233
 v_max_f32 v233, 0, v233
 v_add_f32 v233, 0x3727c5ac, v233
 v_rsq_f32 v233, v233
 s_nop 0
 v_mul_f32 v232, v232, v233
 v_sub_f32 v232, 0, v232
 v_mul_f32 v234, 0x3ae38e39, v234
 v_mul_f32 v235, 0x3ae38e39, v235
 v_fma_f32 v235, -v234, v234, v235
 v_max_f32 v235, 0, v235
 v_add_f32 v235, 0x3727c5ac, v235
 v_rsq_f32 v235, v235
 s_nop 0
 v_mul_f32 v234, v234, v235
 v_sub_f32 v234, 0, v234
 v_mov_b32 v238, v233
 v_mov_b32 v239, v233
 v_mov_b32 v240, v232
 v_mov_b32 v241, v232
 v_mov_b32 v242, v235
 v_mov_b32 v243, v235
 v_mov_b32 v244, v234
 v_mov_b32 v245, v234
 v_lshlrev_b32 v248, 16, v16
 v_and_b32 v249, 0xffff0000, v16
 v_lshlrev_b32 v250, 16, v17
 v_and_b32 v251, 0xffff0000, v17
 v_lshlrev_b32 v252, 16, v18
 v_and_b32 v253, 0xffff0000, v18
 v_lshlrev_b32 v254, 16, v19
 v_and_b32 v255, 0xffff0000, v19
 v_pk_fma_f32 v[248:249], v[248:249], v[238:239], v[240:241]
 v_pk_fma_f32 v[250:251], v[250:251], v[238:239], v[240:241]
 v_pk_fma_f32 v[252:253], v[252:253], v[238:239], v[240:241]
 v_pk_fma_f32 v[254:255], v[254:255], v[238:239], v[240:241]
 v_cvt_pk_f16_f32 v16, v248, v249
 v_cvt_pk_f16_f32 v17, v250, v251
 v_cvt_pk_f16_f32 v18, v252, v253
 v_cvt_pk_f16_f32 v19, v254, v255
 v_lshlrev_b32 v248, 16, v20
 v_and_b32 v249, 0xffff0000, v20
 v_lshlrev_b32 v250, 16, v21
 v_and_b32 v251, 0xffff0000, v21
 v_lshlrev_b32 v252, 16, v22
 v_and_b32 v253, 0xffff0000, v22
 v_lshlrev_b32 v254, 16, v23
 v_and_b32 v255, 0xffff0000, v23
 v_pk_fma_f32 v[248:249], v[248:249], v[238:239], v[240:241]
 v_pk_fma_f32 v[250:251], v[250:251], v[238:239], v[240:241]
 v_pk_fma_f32 v[252:253], v[252:253], v[238:239], v[240:241]
 v_pk_fma_f32 v[254:255], v[254:255], v[238:239], v[240:241]
 v_cvt_pk_f16_f32 v20, v248, v249
 v_cvt_pk_f16_f32 v21, v250, v251
 v_cvt_pk_f16_f32 v22, v252, v253
 v_cvt_pk_f16_f32 v23, v254, v255
 v_lshlrev_b32 v248, 16, v24
 v_and_b32 v249, 0xffff0000, v24
 v_lshlrev_b32 v250, 16, v25
 v_and_b32 v251, 0xffff0000, v25
 v_lshlrev_b32 v252, 16, v26
 v_and_b32 v253, 0xffff0000, v26
 v_lshlrev_b32 v254, 16, v27
 v_and_b32 v255, 0xffff0000, v27
 v_pk_fma_f32 v[248:249], v[248:249], v[238:239], v[240:241]
 v_pk_fma_f32 v[250:251], v[250:251], v[238:239], v[240:241]
 v_pk_fma_f32 v[252:253], v[252:253], v[238:239], v[240:241]
 v_pk_fma_f32 v[254:255], v[254:255], v[238:239], v[240:241]
 v_cvt_pk_f16_f32 v24, v248, v249
 v_cvt_pk_f16_f32 v25, v250, v251
 v_cvt_pk_f16_f32 v26, v252, v253
 v_cvt_pk_f16_f32 v27, v254, v255
 v_lshlrev_b32 v248, 16, v28
 v_and_b32 v249, 0xffff0000, v28
 v_lshlrev_b32 v250, 16, v29
 v_and_b32 v251, 0xffff0000, v29
 v_lshlrev_b32 v252, 16, v30
 v_and_b32 v253, 0xffff0000, v30
 v_lshlrev_b32 v254, 16, v31
 v_and_b32 v255, 0xffff0000, v31
 v_pk_fma_f32 v[248:249], v[248:249], v[238:239], v[240:241]
 v_pk_fma_f32 v[250:251], v[250:251], v[238:239], v[240:241]
 v_pk_fma_f32 v[252:253], v[252:253], v[238:239], v[240:241]
 v_pk_fma_f32 v[254:255], v[254:255], v[238:239], v[240:241]
 v_cvt_pk_f16_f32 v28, v248, v249
 v_cvt_pk_f16_f32 v29, v250, v251
 v_cvt_pk_f16_f32 v30, v252, v253
 v_cvt_pk_f16_f32 v31, v254, v255
 v_lshlrev_b32 v248, 16, v32
 v_and_b32 v249, 0xffff0000, v32
 v_lshlrev_b32 v250, 16, v33
 v_and_b32 v251, 0xffff0000, v33
 v_lshlrev_b32 v252, 16, v34
 v_and_b32 v253, 0xffff0000, v34
 v_lshlrev_b32 v254, 16, v35
 v_and_b32 v255, 0xffff0000, v35
 v_pk_fma_f32 v[248:249], v[248:249], v[238:239], v[240:241]
 v_pk_fma_f32 v[250:251], v[250:251], v[238:239], v[240:241]
 v_pk_fma_f32 v[252:253], v[252:253], v[238:239], v[240:241]
 v_pk_fma_f32 v[254:255], v[254:255], v[238:239], v[240:241]
 v_cvt_pk_f16_f32 v32, v248, v249
 v_cvt_pk_f16_f32 v33, v250, v251
 v_cvt_pk_f16_f32 v34, v252, v253
 v_cvt_pk_f16_f32 v35, v254, v255
 v_lshlrev_b32 v248, 16, v36
 v_and_b32 v249, 0xffff0000, v36
 v_lshlrev_b32 v250, 16, v37
 v_and_b32 v251, 0xffff0000, v37
 v_lshlrev_b32 v252, 16, v38
 v_and_b32 v253, 0xffff0000, v38
 v_lshlrev_b32 v254, 16, v39
 v_and_b32 v255, 0xffff0000, v39
 v_pk_fma_f32 v[248:249], v[248:249], v[238:239], v[240:241]
 v_pk_fma_f32 v[250:251], v[250:251], v[238:239], v[240:241]
 v_pk_fma_f32 v[252:253], v[252:253], v[238:239], v[240:241]
 v_pk_fma_f32 v[254:255], v[254:255], v[238:239], v[240:241]
 v_cvt_pk_f16_f32 v36, v248, v249
 v_cvt_pk_f16_f32 v37, v250, v251
 v_cvt_pk_f16_f32 v38, v252, v253
 v_cvt_pk_f16_f32 v39, v254, v255
 v_lshlrev_b32 v248, 16, v40
 v_and_b32 v249, 0xffff0000, v40
 v_lshlrev_b32 v250, 16, v41
 v_and_b32 v251, 0xffff0000, v41
 v_lshlrev_b32 v252, 16, v42
 v_and_b32 v253, 0xffff0000, v42
 v_lshlrev_b32 v254, 16, v43
 v_and_b32 v255, 0xffff0000, v43
 v_pk_fma_f32 v[248:249], v[248:249], v[238:239], v[240:241]
 v_pk_fma_f32 v[250:251], v[250:251], v[238:239], v[240:241]
 v_pk_fma_f32 v[252:253], v[252:253], v[238:239], v[240:241]
 v_pk_fma_f32 v[254:255], v[254:255], v[238:239], v[240:241]
 v_cvt_pk_f16_f32 v40, v248, v249
 v_cvt_pk_f16_f32 v41, v250, v251
 v_cvt_pk_f16_f32 v42, v252, v253
 v_cvt_pk_f16_f32 v43, v254, v255
 v_lshlrev_b32 v248, 16, v44
 v_and_b32 v249, 0xffff0000, v44
 v_lshlrev_b32 v250, 16, v45
 v_and_b32 v251, 0xffff0000, v45
 v_lshlrev_b32 v252, 16, v46
 v_and_b32 v253, 0xffff0000, v46
 v_lshlrev_b32 v254, 16, v47
 v_and_b32 v255, 0xffff0000, v47
 v_pk_fma_f32 v[248:249], v[248:249], v[238:239], v[240:241]
 v_pk_fma_f32 v[250:251], v[250:251], v[238:239], v[240:241]
 v_pk_fma_f32 v[252:253], v[252:253], v[238:239], v[240:241]
 v_pk_fma_f32 v[254:255], v[254:255], v[238:239], v[240:241]
 v_cvt_pk_f16_f32 v44, v248, v249
 v_cvt_pk_f16_f32 v45, v250, v251
 v_cvt_pk_f16_f32 v46, v252, v253
 v_cvt_pk_f16_f32 v47, v254, v255
 v_lshlrev_b32 v248, 16, v48
 v_and_b32 v249, 0xffff0000, v48
 v_lshlrev_b32 v250, 16, v49
 v_and_b32 v251, 0xffff0000, v49
 v_lshlrev_b32 v252, 16, v50
 v_and_b32 v253, 0xffff0000, v50
 v_lshlrev_b32 v254, 16, v51
 v_and_b32 v255, 0xffff0000, v51
 v_pk_fma_f32 v[248:249], v[248:249], v[238:239], v[240:241]
 v_pk_fma_f32 v[250:251], v[250:251], v[238:239], v[240:241]
 v_pk_fma_f32 v[252:253], v[252:253], v[238:239], v[240:241]
 v_pk_fma_f32 v[254:255], v[254:255], v[238:239], v[240:241]
 v_cvt_pk_f16_f32 v48, v248, v249
 v_cvt_pk_f16_f32 v49, v250, v251
 v_cvt_pk_f16_f32 v50, v252, v253
 v_cvt_pk_f16_f32 v51, v254, v255
 v_lshlrev_b32 v248, 16, v52
 v_and_b32 v249, 0xffff0000, v52
 v_lshlrev_b32 v250, 16, v53
 v_and_b32 v251, 0xffff0000, v53
 v_lshlrev_b32 v252, 16, v54
 v_and_b32 v253, 0xffff0000, v54
 v_lshlrev_b32 v254, 16, v55
 v_and_b32 v255, 0xffff0000, v55
 v_pk_fma_f32 v[248:249], v[248:249], v[238:239], v[240:241]
 v_pk_fma_f32 v[250:251], v[250:251], v[238:239], v[240:241]
 v_pk_fma_f32 v[252:253], v[252:253], v[238:239], v[240:241]
 v_pk_fma_f32 v[254:255], v[254:255], v[238:239], v[240:241]
 v_cvt_pk_f16_f32 v52, v248, v249
 v_cvt_pk_f16_f32 v53, v250, v251
 v_cvt_pk_f16_f32 v54, v252, v253
 v_cvt_pk_f16_f32 v55, v254, v255
 v_lshlrev_b32 v248, 16, v56
 v_and_b32 v249, 0xffff0000, v56
 v_lshlrev_b32 v250, 16, v57
 v_and_b32 v251, 0xffff0000, v57
 v_lshlrev_b32 v252, 16, v58
 v_and_b32 v253, 0xffff0000, v58
 v_lshlrev_b32 v254, 16, v59
 v_and_b32 v255, 0xffff0000, v59
 v_pk_fma_f32 v[248:249], v[248:249], v[238:239], v[240:241]
 v_pk_fma_f32 v[250:251], v[250:251], v[238:239], v[240:241]
 v_pk_fma_f32 v[252:253], v[252:253], v[238:239], v[240:241]
 v_pk_fma_f32 v[254:255], v[254:255], v[238:239], v[240:241]
 v_cvt_pk_f16_f32 v56, v248, v249
 v_cvt_pk_f16_f32 v57, v250, v251
 v_cvt_pk_f16_f32 v58, v252, v253
 v_cvt_pk_f16_f32 v59, v254, v255
 v_lshlrev_b32 v248, 16, v60
 v_and_b32 v249, 0xffff0000, v60
 v_lshlrev_b32 v250, 16, v61
 v_and_b32 v251, 0xffff0000, v61
 v_lshlrev_b32 v252, 16, v62
 v_and_b32 v253, 0xffff0000, v62
 v_lshlrev_b32 v254, 16, v63
 v_and_b32 v255, 0xffff0000, v63
 v_pk_fma_f32 v[248:249], v[248:249], v[238:239], v[240:241]
 v_pk_fma_f32 v[250:251], v[250:251], v[238:239], v[240:241]
 v_pk_fma_f32 v[252:253], v[252:253], v[238:239], v[240:241]
 v_pk_fma_f32 v[254:255], v[254:255], v[238:239], v[240:241]
 v_cvt_pk_f16_f32 v60, v248, v249
 v_cvt_pk_f16_f32 v61, v250, v251
 v_cvt_pk_f16_f32 v62, v252, v253
 v_cvt_pk_f16_f32 v63, v254, v255
 v_lshlrev_b32 v248, 16, v64
 v_and_b32 v249, 0xffff0000, v64
 v_lshlrev_b32 v250, 16, v65
 v_and_b32 v251, 0xffff0000, v65
 v_lshlrev_b32 v252, 16, v66
 v_and_b32 v253, 0xffff0000, v66
 v_lshlrev_b32 v254, 16, v67
 v_and_b32 v255, 0xffff0000, v67
 v_pk_fma_f32 v[248:249], v[248:249], v[238:239], v[240:241]
 v_pk_fma_f32 v[250:251], v[250:251], v[238:239], v[240:241]
 v_pk_fma_f32 v[252:253], v[252:253], v[238:239], v[240:241]
 v_pk_fma_f32 v[254:255], v[254:255], v[238:239], v[240:241]
 v_cvt_pk_f16_f32 v64, v248, v249
 v_cvt_pk_f16_f32 v65, v250, v251
 v_cvt_pk_f16_f32 v66, v252, v253
 v_cvt_pk_f16_f32 v67, v254, v255
 v_lshlrev_b32 v248, 16, v68
 v_and_b32 v249, 0xffff0000, v68
 v_lshlrev_b32 v250, 16, v69
 v_and_b32 v251, 0xffff0000, v69
 v_lshlrev_b32 v252, 16, v70
 v_and_b32 v253, 0xffff0000, v70
 v_lshlrev_b32 v254, 16, v71
 v_and_b32 v255, 0xffff0000, v71
 v_pk_fma_f32 v[248:249], v[248:249], v[238:239], v[240:241]
 v_pk_fma_f32 v[250:251], v[250:251], v[238:239], v[240:241]
 v_pk_fma_f32 v[252:253], v[252:253], v[238:239], v[240:241]
 v_pk_fma_f32 v[254:255], v[254:255], v[238:239], v[240:241]
 v_cvt_pk_f16_f32 v68, v248, v249
 v_cvt_pk_f16_f32 v69, v250, v251
 v_cvt_pk_f16_f32 v70, v252, v253
 v_cvt_pk_f16_f32 v71, v254, v255
 v_lshlrev_b32 v248, 16, v72
 v_and_b32 v249, 0xffff0000, v72
 v_lshlrev_b32 v250, 16, v73
 v_and_b32 v251, 0xffff0000, v73
 v_lshlrev_b32 v252, 16, v74
 v_and_b32 v253, 0xffff0000, v74
 v_lshlrev_b32 v254, 16, v75
 v_and_b32 v255, 0xffff0000, v75
 v_pk_fma_f32 v[248:249], v[248:249], v[238:239], v[240:241]
 v_pk_fma_f32 v[250:251], v[250:251], v[238:239], v[240:241]
 v_pk_fma_f32 v[252:253], v[252:253], v[238:239], v[240:241]
 v_pk_fma_f32 v[254:255], v[254:255], v[238:239], v[240:241]
 v_cvt_pk_f16_f32 v72, v248, v249
 v_cvt_pk_f16_f32 v73, v250, v251
 v_cvt_pk_f16_f32 v74, v252, v253
 v_cvt_pk_f16_f32 v75, v254, v255
 v_lshlrev_b32 v248, 16, v76
 v_and_b32 v249, 0xffff0000, v76
 v_lshlrev_b32 v250, 16, v77
 v_and_b32 v251, 0xffff0000, v77
 v_lshlrev_b32 v252, 16, v78
 v_and_b32 v253, 0xffff0000, v78
 v_lshlrev_b32 v254, 16, v79
 v_and_b32 v255, 0xffff0000, v79
 v_pk_fma_f32 v[248:249], v[248:249], v[238:239], v[240:241]
 v_pk_fma_f32 v[250:251], v[250:251], v[238:239], v[240:241]
 v_pk_fma_f32 v[252:253], v[252:253], v[238:239], v[240:241]
 v_pk_fma_f32 v[254:255], v[254:255], v[238:239], v[240:241]
 v_cvt_pk_f16_f32 v76, v248, v249
 v_cvt_pk_f16_f32 v77, v250, v251
 v_cvt_pk_f16_f32 v78, v252, v253
 v_cvt_pk_f16_f32 v79, v254, v255
 v_lshlrev_b32 v248, 16, v80
 v_and_b32 v249, 0xffff0000, v80
 v_lshlrev_b32 v250, 16, v81
 v_and_b32 v251, 0xffff0000, v81
 v_lshlrev_b32 v252, 16, v82
 v_and_b32 v253, 0xffff0000, v82
 v_lshlrev_b32 v254, 16, v83
 v_and_b32 v255, 0xffff0000, v83
 v_pk_fma_f32 v[248:249], v[248:249], v[238:239], v[240:241]
 v_pk_fma_f32 v[250:251], v[250:251], v[238:239], v[240:241]
 v_pk_fma_f32 v[252:253], v[252:253], v[238:239], v[240:241]
 v_pk_fma_f32 v[254:255], v[254:255], v[238:239], v[240:241]
 v_cvt_pk_f16_f32 v80, v248, v249
 v_cvt_pk_f16_f32 v81, v250, v251
 v_cvt_pk_f16_f32 v82, v252, v253
 v_cvt_pk_f16_f32 v83, v254, v255
 v_lshlrev_b32 v248, 16, v84
 v_and_b32 v249, 0xffff0000, v84
 v_lshlrev_b32 v250, 16, v85
 v_and_b32 v251, 0xffff0000, v85
 v_lshlrev_b32 v252, 16, v86
 v_and_b32 v253, 0xffff0000, v86
 v_lshlrev_b32 v254, 16, v87
 v_and_b32 v255, 0xffff0000, v87
 v_pk_fma_f32 v[248:249], v[248:249], v[238:239], v[240:241]
 v_pk_fma_f32 v[250:251], v[250:251], v[238:239], v[240:241]
 v_pk_fma_f32 v[252:253], v[252:253], v[238:239], v[240:241]
 v_pk_fma_f32 v[254:255], v[254:255], v[238:239], v[240:241]
 v_cvt_pk_f16_f32 v84, v248, v249
 v_cvt_pk_f16_f32 v85, v250, v251
 v_cvt_pk_f16_f32 v86, v252, v253
 v_cvt_pk_f16_f32 v87, v254, v255
 v_lshlrev_b32 v248, 16, v88
 v_and_b32 v249, 0xffff0000, v88
 v_lshlrev_b32 v250, 16, v89
 v_and_b32 v251, 0xffff0000, v89
 v_lshlrev_b32 v252, 16, v90
 v_and_b32 v253, 0xffff0000, v90
 v_lshlrev_b32 v254, 16, v91
 v_and_b32 v255, 0xffff0000, v91
 v_pk_fma_f32 v[248:249], v[248:249], v[242:243], v[244:245]
 v_pk_fma_f32 v[250:251], v[250:251], v[242:243], v[244:245]
 v_pk_fma_f32 v[252:253], v[252:253], v[242:243], v[244:245]
 v_pk_fma_f32 v[254:255], v[254:255], v[242:243], v[244:245]
 v_cvt_pk_f16_f32 v88, v248, v249
 v_cvt_pk_f16_f32 v89, v250, v251
 v_cvt_pk_f16_f32 v90, v252, v253
 v_cvt_pk_f16_f32 v91, v254, v255
 v_lshlrev_b32 v248, 16, v92
 v_and_b32 v249, 0xffff0000, v92
 v_lshlrev_b32 v250, 16, v93
 v_and_b32 v251, 0xffff0000, v93
 v_lshlrev_b32 v252, 16, v94
 v_and_b32 v253, 0xffff0000, v94
 v_lshlrev_b32 v254, 16, v95
 v_and_b32 v255, 0xffff0000, v95
 v_pk_fma_f32 v[248:249], v[248:249], v[242:243], v[244:245]
 v_pk_fma_f32 v[250:251], v[250:251], v[242:243], v[244:245]
 v_pk_fma_f32 v[252:253], v[252:253], v[242:243], v[244:245]
 v_pk_fma_f32 v[254:255], v[254:255], v[242:243], v[244:245]
 v_cvt_pk_f16_f32 v92, v248, v249
 v_cvt_pk_f16_f32 v93, v250, v251
 v_cvt_pk_f16_f32 v94, v252, v253
 v_cvt_pk_f16_f32 v95, v254, v255
 v_lshlrev_b32 v248, 16, v96
 v_and_b32 v249, 0xffff0000, v96
 v_lshlrev_b32 v250, 16, v97
 v_and_b32 v251, 0xffff0000, v97
 v_lshlrev_b32 v252, 16, v98
 v_and_b32 v253, 0xffff0000, v98
 v_lshlrev_b32 v254, 16, v99
 v_and_b32 v255, 0xffff0000, v99
 v_pk_fma_f32 v[248:249], v[248:249], v[242:243], v[244:245]
 v_pk_fma_f32 v[250:251], v[250:251], v[242:243], v[244:245]
 v_pk_fma_f32 v[252:253], v[252:253], v[242:243], v[244:245]
 v_pk_fma_f32 v[254:255], v[254:255], v[242:243], v[244:245]
 v_cvt_pk_f16_f32 v96, v248, v249
 v_cvt_pk_f16_f32 v97, v250, v251
 v_cvt_pk_f16_f32 v98, v252, v253
 v_cvt_pk_f16_f32 v99, v254, v255
 v_lshlrev_b32 v248, 16, v100
 v_and_b32 v249, 0xffff0000, v100
 v_lshlrev_b32 v250, 16, v101
 v_and_b32 v251, 0xffff0000, v101
 v_lshlrev_b32 v252, 16, v102
 v_and_b32 v253, 0xffff0000, v102
 v_lshlrev_b32 v254, 16, v103
 v_and_b32 v255, 0xffff0000, v103
 v_pk_fma_f32 v[248:249], v[248:249], v[242:243], v[244:245]
 v_pk_fma_f32 v[250:251], v[250:251], v[242:243], v[244:245]
 v_pk_fma_f32 v[252:253], v[252:253], v[242:243], v[244:245]
 v_pk_fma_f32 v[254:255], v[254:255], v[242:243], v[244:245]
 v_cvt_pk_f16_f32 v100, v248, v249
 v_cvt_pk_f16_f32 v101, v250, v251
 v_cvt_pk_f16_f32 v102, v252, v253
 v_cvt_pk_f16_f32 v103, v254, v255
 v_lshlrev_b32 v248, 16, v104
 v_and_b32 v249, 0xffff0000, v104
 v_lshlrev_b32 v250, 16, v105
 v_and_b32 v251, 0xffff0000, v105
 v_lshlrev_b32 v252, 16, v106
 v_and_b32 v253, 0xffff0000, v106
 v_lshlrev_b32 v254, 16, v107
 v_and_b32 v255, 0xffff0000, v107
 v_pk_fma_f32 v[248:249], v[248:249], v[242:243], v[244:245]
 v_pk_fma_f32 v[250:251], v[250:251], v[242:243], v[244:245]
 v_pk_fma_f32 v[252:253], v[252:253], v[242:243], v[244:245]
 v_pk_fma_f32 v[254:255], v[254:255], v[242:243], v[244:245]
 v_cvt_pk_f16_f32 v104, v248, v249
 v_cvt_pk_f16_f32 v105, v250, v251
 v_cvt_pk_f16_f32 v106, v252, v253
 v_cvt_pk_f16_f32 v107, v254, v255
 v_lshlrev_b32 v248, 16, v108
 v_and_b32 v249, 0xffff0000, v108
 v_lshlrev_b32 v250, 16, v109
 v_and_b32 v251, 0xffff0000, v109
 v_lshlrev_b32 v252, 16, v110
 v_and_b32 v253, 0xffff0000, v110
 v_lshlrev_b32 v254, 16, v111
 v_and_b32 v255, 0xffff0000, v111
 v_pk_fma_f32 v[248:249], v[248:249], v[242:243], v[244:245]
 v_pk_fma_f32 v[250:251], v[250:251], v[242:243], v[244:245]
 v_pk_fma_f32 v[252:253], v[252:253], v[242:243], v[244:245]
 v_pk_fma_f32 v[254:255], v[254:255], v[242:243], v[244:245]
 v_cvt_pk_f16_f32 v108, v248, v249
 v_cvt_pk_f16_f32 v109, v250, v251
 v_cvt_pk_f16_f32 v110, v252, v253
 v_cvt_pk_f16_f32 v111, v254, v255
 v_lshlrev_b32 v248, 16, v112
 v_and_b32 v249, 0xffff0000, v112
 v_lshlrev_b32 v250, 16, v113
 v_and_b32 v251, 0xffff0000, v113
 v_lshlrev_b32 v252, 16, v114
 v_and_b32 v253, 0xffff0000, v114
 v_lshlrev_b32 v254, 16, v115
 v_and_b32 v255, 0xffff0000, v115
 v_pk_fma_f32 v[248:249], v[248:249], v[242:243], v[244:245]
 v_pk_fma_f32 v[250:251], v[250:251], v[242:243], v[244:245]
 v_pk_fma_f32 v[252:253], v[252:253], v[242:243], v[244:245]
 v_pk_fma_f32 v[254:255], v[254:255], v[242:243], v[244:245]
 v_cvt_pk_f16_f32 v112, v248, v249
 v_cvt_pk_f16_f32 v113, v250, v251
 v_cvt_pk_f16_f32 v114, v252, v253
 v_cvt_pk_f16_f32 v115, v254, v255
 v_lshlrev_b32 v248, 16, v116
 v_and_b32 v249, 0xffff0000, v116
 v_lshlrev_b32 v250, 16, v117
 v_and_b32 v251, 0xffff0000, v117
 v_lshlrev_b32 v252, 16, v118
 v_and_b32 v253, 0xffff0000, v118
 v_lshlrev_b32 v254, 16, v119
 v_and_b32 v255, 0xffff0000, v119
 v_pk_fma_f32 v[248:249], v[248:249], v[242:243], v[244:245]
 v_pk_fma_f32 v[250:251], v[250:251], v[242:243], v[244:245]
 v_pk_fma_f32 v[252:253], v[252:253], v[242:243], v[244:245]
 v_pk_fma_f32 v[254:255], v[254:255], v[242:243], v[244:245]
 v_cvt_pk_f16_f32 v116, v248, v249
 v_cvt_pk_f16_f32 v117, v250, v251
 v_cvt_pk_f16_f32 v118, v252, v253
 v_cvt_pk_f16_f32 v119, v254, v255
 v_lshlrev_b32 v248, 16, v120
 v_and_b32 v249, 0xffff0000, v120
 v_lshlrev_b32 v250, 16, v121
 v_and_b32 v251, 0xffff0000, v121
 v_lshlrev_b32 v252, 16, v122
 v_and_b32 v253, 0xffff0000, v122
 v_lshlrev_b32 v254, 16, v123
 v_and_b32 v255, 0xffff0000, v123
 v_pk_fma_f32 v[248:249], v[248:249], v[242:243], v[244:245]
 v_pk_fma_f32 v[250:251], v[250:251], v[242:243], v[244:245]
 v_pk_fma_f32 v[252:253], v[252:253], v[242:243], v[244:245]
 v_pk_fma_f32 v[254:255], v[254:255], v[242:243], v[244:245]
 v_cvt_pk_f16_f32 v120, v248, v249
 v_cvt_pk_f16_f32 v121, v250, v251
 v_cvt_pk_f16_f32 v122, v252, v253
 v_cvt_pk_f16_f32 v123, v254, v255
 v_lshlrev_b32 v248, 16, v124
 v_and_b32 v249, 0xffff0000, v124
 v_lshlrev_b32 v250, 16, v125
 v_and_b32 v251, 0xffff0000, v125
 v_lshlrev_b32 v252, 16, v126
 v_and_b32 v253, 0xffff0000, v126
 v_lshlrev_b32 v254, 16, v127
 v_and_b32 v255, 0xffff0000, v127
 v_pk_fma_f32 v[248:249], v[248:249], v[242:243], v[244:245]
 v_pk_fma_f32 v[250:251], v[250:251], v[242:243], v[244:245]
 v_pk_fma_f32 v[252:253], v[252:253], v[242:243], v[244:245]
 v_pk_fma_f32 v[254:255], v[254:255], v[242:243], v[244:245]
 v_cvt_pk_f16_f32 v124, v248, v249
 v_cvt_pk_f16_f32 v125, v250, v251
 v_cvt_pk_f16_f32 v126, v252, v253
 v_cvt_pk_f16_f32 v127, v254, v255
 v_lshlrev_b32 v248, 16, v128
 v_and_b32 v249, 0xffff0000, v128
 v_lshlrev_b32 v250, 16, v129
 v_and_b32 v251, 0xffff0000, v129
 v_lshlrev_b32 v252, 16, v130
 v_and_b32 v253, 0xffff0000, v130
 v_lshlrev_b32 v254, 16, v131
 v_and_b32 v255, 0xffff0000, v131
 v_pk_fma_f32 v[248:249], v[248:249], v[242:243], v[244:245]
 v_pk_fma_f32 v[250:251], v[250:251], v[242:243], v[244:245]
 v_pk_fma_f32 v[252:253], v[252:253], v[242:243], v[244:245]
 v_pk_fma_f32 v[254:255], v[254:255], v[242:243], v[244:245]
 v_cvt_pk_f16_f32 v128, v248, v249
 v_cvt_pk_f16_f32 v129, v250, v251
 v_cvt_pk_f16_f32 v130, v252, v253
 v_cvt_pk_f16_f32 v131, v254, v255
 v_lshlrev_b32 v248, 16, v132
 v_and_b32 v249, 0xffff0000, v132
 v_lshlrev_b32 v250, 16, v133
 v_and_b32 v251, 0xffff0000, v133
 v_lshlrev_b32 v252, 16, v134
 v_and_b32 v253, 0xffff0000, v134
 v_lshlrev_b32 v254, 16, v135
 v_and_b32 v255, 0xffff0000, v135
 v_pk_fma_f32 v[248:249], v[248:249], v[242:243], v[244:245]
 v_pk_fma_f32 v[250:251], v[250:251], v[242:243], v[244:245]
 v_pk_fma_f32 v[252:253], v[252:253], v[242:243], v[244:245]
 v_pk_fma_f32 v[254:255], v[254:255], v[242:243], v[244:245]
 v_cvt_pk_f16_f32 v132, v248, v249
 v_cvt_pk_f16_f32 v133, v250, v251
 v_cvt_pk_f16_f32 v134, v252, v253
 v_cvt_pk_f16_f32 v135, v254, v255
 v_lshlrev_b32 v248, 16, v136
 v_and_b32 v249, 0xffff0000, v136
 v_lshlrev_b32 v250, 16, v137
 v_and_b32 v251, 0xffff0000, v137
 v_lshlrev_b32 v252, 16, v138
 v_and_b32 v253, 0xffff0000, v138
 v_lshlrev_b32 v254, 16, v139
 v_and_b32 v255, 0xffff0000, v139
 v_pk_fma_f32 v[248:249], v[248:249], v[242:243], v[244:245]
 v_pk_fma_f32 v[250:251], v[250:251], v[242:243], v[244:245]
 v_pk_fma_f32 v[252:253], v[252:253], v[242:243], v[244:245]
 v_pk_fma_f32 v[254:255], v[254:255], v[242:243], v[244:245]
 v_cvt_pk_f16_f32 v136, v248, v249
 v_cvt_pk_f16_f32 v137, v250, v251
 v_cvt_pk_f16_f32 v138, v252, v253
 v_cvt_pk_f16_f32 v139, v254, v255
 v_lshlrev_b32 v248, 16, v140
 v_and_b32 v249, 0xffff0000, v140
 v_lshlrev_b32 v250, 16, v141
 v_and_b32 v251, 0xffff0000, v141
 v_lshlrev_b32 v252, 16, v142
 v_and_b32 v253, 0xffff0000, v142
 v_lshlrev_b32 v254, 16, v143
 v_and_b32 v255, 0xffff0000, v143
 v_pk_fma_f32 v[248:249], v[248:249], v[242:243], v[244:245]
 v_pk_fma_f32 v[250:251], v[250:251], v[242:243], v[244:245]
 v_pk_fma_f32 v[252:253], v[252:253], v[242:243], v[244:245]
 v_pk_fma_f32 v[254:255], v[254:255], v[242:243], v[244:245]
 v_cvt_pk_f16_f32 v140, v248, v249
 v_cvt_pk_f16_f32 v141, v250, v251
 v_cvt_pk_f16_f32 v142, v252, v253
 v_cvt_pk_f16_f32 v143, v254, v255
 v_lshlrev_b32 v248, 16, v144
 v_and_b32 v249, 0xffff0000, v144
 v_lshlrev_b32 v250, 16, v145
 v_and_b32 v251, 0xffff0000, v145
 v_lshlrev_b32 v252, 16, v146
 v_and_b32 v253, 0xffff0000, v146
 v_lshlrev_b32 v254, 16, v147
 v_and_b32 v255, 0xffff0000, v147
 v_pk_fma_f32 v[248:249], v[248:249], v[242:243], v[244:245]
 v_pk_fma_f32 v[250:251], v[250:251], v[242:243], v[244:245]
 v_pk_fma_f32 v[252:253], v[252:253], v[242:243], v[244:245]
 v_pk_fma_f32 v[254:255], v[254:255], v[242:243], v[244:245]
 v_cvt_pk_f16_f32 v144, v248, v249
 v_cvt_pk_f16_f32 v145, v250, v251
 v_cvt_pk_f16_f32 v146, v252, v253
 v_cvt_pk_f16_f32 v147, v254, v255
 v_lshlrev_b32 v248, 16, v148
 v_and_b32 v249, 0xffff0000, v148
 v_lshlrev_b32 v250, 16, v149
 v_and_b32 v251, 0xffff0000, v149
 v_lshlrev_b32 v252, 16, v150
 v_and_b32 v253, 0xffff0000, v150
 v_lshlrev_b32 v254, 16, v151
 v_and_b32 v255, 0xffff0000, v151
 v_pk_fma_f32 v[248:249], v[248:249], v[242:243], v[244:245]
 v_pk_fma_f32 v[250:251], v[250:251], v[242:243], v[244:245]
 v_pk_fma_f32 v[252:253], v[252:253], v[242:243], v[244:245]
 v_pk_fma_f32 v[254:255], v[254:255], v[242:243], v[244:245]
 v_cvt_pk_f16_f32 v148, v248, v249
 v_cvt_pk_f16_f32 v149, v250, v251
 v_cvt_pk_f16_f32 v150, v252, v253
 v_cvt_pk_f16_f32 v151, v254, v255
 v_lshlrev_b32 v248, 16, v152
 v_and_b32 v249, 0xffff0000, v152
 v_lshlrev_b32 v250, 16, v153
 v_and_b32 v251, 0xffff0000, v153
 v_lshlrev_b32 v252, 16, v154
 v_and_b32 v253, 0xffff0000, v154
 v_lshlrev_b32 v254, 16, v155
 v_and_b32 v255, 0xffff0000, v155
 v_pk_fma_f32 v[248:249], v[248:249], v[242:243], v[244:245]
 v_pk_fma_f32 v[250:251], v[250:251], v[242:243], v[244:245]
 v_pk_fma_f32 v[252:253], v[252:253], v[242:243], v[244:245]
 v_pk_fma_f32 v[254:255], v[254:255], v[242:243], v[244:245]
 v_cvt_pk_f16_f32 v152, v248, v249
 v_cvt_pk_f16_f32 v153, v250, v251
 v_cvt_pk_f16_f32 v154, v252, v253
 v_cvt_pk_f16_f32 v155, v254, v255
 v_lshlrev_b32 v248, 16, v156
 v_and_b32 v249, 0xffff0000, v156
 v_lshlrev_b32 v250, 16, v157
 v_and_b32 v251, 0xffff0000, v157
 v_lshlrev_b32 v252, 16, v158
 v_and_b32 v253, 0xffff0000, v158
 v_lshlrev_b32 v254, 16, v159
 v_and_b32 v255, 0xffff0000, v159
 v_pk_fma_f32 v[248:249], v[248:249], v[242:243], v[244:245]
 v_pk_fma_f32 v[250:251], v[250:251], v[242:243], v[244:245]
 v_pk_fma_f32 v[252:253], v[252:253], v[242:243], v[244:245]
 v_pk_fma_f32 v[254:255], v[254:255], v[242:243], v[244:245]
 v_cvt_pk_f16_f32 v156, v248, v249
 v_cvt_pk_f16_f32 v157, v250, v251
 v_cvt_pk_f16_f32 v158, v252, v253
 v_cvt_pk_f16_f32 v159, v254, v255
 v_add_u32 v11, s39, v2
 v_add_u32 v12, s39, v5
 v_add_u32 v9, s39, v1
 s_cmp_eq_u32 s32, 0
 s_cbranch_scc0 L_k01_polled
 v_mov_b32 v13, 0
 s_mov_b32 s41, 0
L_k01_poll:
 buffer_load_dword v14, v13, s[48:51], 0 offen sc1
 s_waitcnt vmcnt(0)
 v_readfirstlane_b32 s35, v14
 s_nop 0
 s_cmp_ge_u32 s35, 18
 s_cbranch_scc1 L_k01_polled
 s_add_u32 s41, s41, 1
 s_cmp_lt_u32 s41, 0x100000
 s_cbranch_scc0 L_k01_polled
 s_sleep 1
 s_branch L_k01_poll
L_k01_polled:
 s_barrier
 s_lshl_b32 s35, s32, 10
 v_add_u32 v13, s35, v1
 buffer_load_dwordx4 v[232:235], v13, s[20:23], 0 offen sc1
 s_mov_b32 s35, 4096
 buffer_load_dwordx4 v[236:239], v1, s[20:23], s35 offen sc1
 v_add_u32 v13, 147456, v13
 v_add_u32 v14, 151552, v1
 s_waitcnt vmcnt(0)
 ds_write_b128 v13, v[232:235]
 ds_write_b128 v14, v[236:239]
 s_waitcnt lgkmcnt(0)
 s_barrier
 v_add_u32 v9, 64512, v1
 v_add_u32 v10, 129024, v1
 s_cmp_ge_u32 s34, 8
 s_cbranch_scc1 L_k01_v
 ds_read_b128 v[232:235], v8 offset:0
 ds_read_b128 v[236:239], v8 offset:16
 ds_read_b128 v[240:243], v8 offset:2304
 ds_read_b128 v[244:247], v8 offset:2320
 ds_read_b64_tr_b16 a[0:1], v2 offset:0
 ds_read_b64_tr_b16 a[2:3], v5 offset:0
 ds_read_b64_tr_b16 a[4:5], v2 offset:32
 ds_read_b64_tr_b16 a[6:7], v5 offset:32
 ds_read_b64_tr_b16 a[8:9], v2 offset:64
 ds_read_b64_tr_b16 a[10:11], v5 offset:64
 ds_read_b64_tr_b16 a[12:13], v2 offset:96
 ds_read_b64_tr_b16 a[14:15], v5 offset:96
 ds_read_b64_tr_b16 a[16:17], v2 offset:128
 ds_read_b64_tr_b16 a[18:19], v5 offset:128
 ds_read_b64_tr_b16 a[20:21], v2 offset:160
 ds_read_b64_tr_b16 a[22:23], v5 offset:160
 ds_read_b64_tr_b16 a[24:25], v2 offset:192
 ds_read_b64_tr_b16 a[26:27], v5 offset:192
 ds_read_b64_tr_b16 a[28:29], v2 offset:224
 ds_read_b64_tr_b16 a[30:31], v5 offset:224
 ds_read_b64_tr_b16 a[32:33], v2 offset:256
 ds_read_b64_tr_b16 a[34:35], v5 offset:256
 s_waitcnt lgkmcnt(0)
 v_fma_mix_f32 v248, v16, v240, v232 op_sel_hi:[1,0,0]
 v_fma_mix_f32 v249, v16, v241, v233 op_sel:[1,0,0] op_sel_hi:[1,0,0]
 v_fma_mix_f32 v250, v17, v242, v234 op_sel_hi:[1,0,0]
 v_fma_mix_f32 v251, v17, v243, v235 op_sel:[1,0,0] op_sel_hi:[1,0,0]
 v_fma_mix_f32 v252, v18, v244, v236 op_sel_hi:[1,0,0]
 v_fma_mix_f32 v253, v18, v245, v237 op_sel:[1,0,0] op_sel_hi:[1,0,0]
 v_fma_mix_f32 v254, v19, v246, v238 op_sel_hi:[1,0,0]
 v_fma_mix_f32 v255, v19, v247, v239 op_sel:[1,0,0] op_sel_hi:[1,0,0]
 v_cvt_pk_bf16_f32 v16, v248, v249
 v_cvt_pk_bf16_f32 v17, v250, v251
 v_cvt_pk_bf16_f32 v18, v252, v253
 v_cvt_pk_bf16_f32 v19, v254, v255
 v_fma_mix_f32 v248, v88, v240, v232 op_sel_hi:[1,0,0]
 v_fma_mix_f32 v249, v88, v241, v233 op_sel:[1,0,0] op_sel_hi:[1,0,0]
 v_fma_mix_f32 v250, v89, v242, v234 op_sel_hi:[1,0,0]
 v_fma_mix_f32 v251, v89, v243, v235 op_sel:[1,0,0] op_sel_hi:[1,0,0]
 v_fma_mix_f32 v252, v90, v244, v236 op_sel_hi:[1,0,0]
 v_fma_mix_f32 v253, v90, v245, v237 op_sel:[1,0,0] op_sel_hi:[1,0,0]
 v_fma_mix_f32 v254, v91, v246, v238 op_sel_hi:[1,0,0]
 v_fma_mix_f32 v255, v91, v247, v239 op_sel:[1,0,0] op_sel_hi:[1,0,0]
 v_cvt_pk_bf16_f32 v88, v248, v249
 v_cvt_pk_bf16_f32 v89, v250, v251
 v_cvt_pk_bf16_f32 v90, v252, v253
 v_cvt_pk_bf16_f32 v91, v254, v255
 s_waitcnt lgkmcnt(0)
 v_mfma_f32_16x16x32_bf16 v[160:163], a[0:3], v[16:19], 0
 ds_read_b128 v[232:235], v8 offset:128
 ds_read_b128 v[236:239], v8 offset:144
 ds_read_b128 v[240:243], v8 offset:2432
 ds_read_b128 v[244:247], v8 offset:2448
 v_mfma_f32_16x16x32_bf16 v[164:167], a[0:3], v[88:91], 0
 ds_read_b64_tr_b16 a[36:37], v2 offset:9216
 ds_read_b64_tr_b16 a[38:39], v5 offset:9216
 v_mfma_f32_16x16x32_bf16 v[168:171], a[4:7], v[16:19], 0
 ds_read_b64_tr_b16 a[40:41], v2 offset:9248
 ds_read_b64_tr_b16 a[42:43], v5 offset:9248
 v_mfma_f32_16x16x32_bf16 v[172:175], a[4:7], v[88:91], 0
 ds_read_b64_tr_b16 a[44:45], v2 offset:9280
 ds_read_b64_tr_b16 a[46:47], v5 offset:9280
 v_mfma_f32_16x16x32_bf16 v[176:179], a[8:11], v[16:19], 0
 s_waitcnt lgkmcnt(6)
 v_fma_mix_f32 v248, v20, v240, v232 op_sel_hi:[1,0,0]
 v_fma_mix_f32 v249, v20, v241, v233 op_sel:[1,0,0] op_sel_hi:[1,0,0]
 v_mfma_f32_16x16x32_bf16 v[180:183], a[8:11], v[88:91], 0
 ds_read_b64_tr_b16 a[48:49], v2 offset:9312
 v_fma_mix_f32 v250, v21, v242, v234 op_sel_hi:[1,0,0]
 v_fma_mix_f32 v251, v21, v243, v235 op_sel:[1,0,0] op_sel_hi:[1,0,0]
 v_mfma_f32_16x16x32_bf16 v[184:187], a[12:15], v[16:19], 0
 ds_read_b64_tr_b16 a[50:51], v5 offset:9312
 v_fma_mix_f32 v252, v22, v244, v236 op_sel_hi:[1,0,0]
 v_fma_mix_f32 v253, v22, v245, v237 op_sel:[1,0,0] op_sel_hi:[1,0,0]
 v_mfma_f32_16x16x32_bf16 v[188:191], a[12:15], v[88:91], 0
 ds_read_b64_tr_b16 a[52:53], v2 offset:9344
 v_fma_mix_f32 v254, v23, v246, v238 op_sel_hi:[1,0,0]
 v_fma_mix_f32 v255, v23, v247, v239 op_sel:[1,0,0] op_sel_hi:[1,0,0]
 v_mfma_f32_16x16x32_bf16 v[192:195], a[16:19], v[16:19], 0
 ds_read_b64_tr_b16 a[54:55], v5 offset:9344
 v_cvt_pk_bf16_f32 v20, v248, v249
 v_cvt_pk_bf16_f32 v21, v250, v251
 v_mfma_f32_16x16x32_bf16 v[196:199], a[16:19], v[88:91], 0
 ds_read_b64_tr_b16 a[56:57], v2 offset:9376
 v_cvt_pk_bf16_f32 v22, v252, v253
 v_cvt_pk_bf16_f32 v23, v254, v255
 v_mfma_f32_16x16x32_bf16 v[200:203], a[20:23], v[16:19], 0
 ds_read_b64_tr_b16 a[58:59], v5 offset:9376
 v_fma_mix_f32 v248, v92, v240, v232 op_sel_hi:[1,0,0]
 v_fma_mix_f32 v249, v92, v241, v233 op_sel:[1,0,0] op_sel_hi:[1,0,0]
 v_mfma_f32_16x16x32_bf16 v[204:207], a[20:23], v[88:91], 0
 ds_read_b64_tr_b16 a[60:61], v2 offset:9408
 v_fma_mix_f32 v250, v93, v242, v234 op_sel_hi:[1,0,0]
 v_fma_mix_f32 v251, v93, v243, v235 op_sel:[1,0,0] op_sel_hi:[1,0,0]
 v_mfma_f32_16x16x32_bf16 v[208:211], a[24:27], v[16:19], 0
 ds_read_b64_tr_b16 a[62:63], v5 offset:9408
 v_fma_mix_f32 v252, v94, v244, v236 op_sel_hi:[1,0,0]
 v_fma_mix_f32 v253, v94, v245, v237 op_sel:[1,0,0] op_sel_hi:[1,0,0]
 v_mfma_f32_16x16x32_bf16 v[212:215], a[24:27], v[88:91], 0
 ds_read_b64_tr_b16 a[64:65], v2 offset:9440
 v_fma_mix_f32 v254, v95, v246, v238 op_sel_hi:[1,0,0]
 v_fma_mix_f32 v255, v95, v247, v239 op_sel:[1,0,0] op_sel_hi:[1,0,0]
 v_mfma_f32_16x16x32_bf16 v[216:219], a[28:31], v[16:19], 0
 ds_read_b64_tr_b16 a[66:67], v5 offset:9440
 v_cvt_pk_bf16_f32 v92, v248, v249
 v_cvt_pk_bf16_f32 v93, v250, v251
 v_mfma_f32_16x16x32_bf16 v[220:223], a[28:31], v[88:91], 0
 ds_read_b64_tr_b16 a[68:69], v2 offset:9472
 v_cvt_pk_bf16_f32 v94, v252, v253
 v_cvt_pk_bf16_f32 v95, v254, v255
 v_mfma_f32_16x16x32_bf16 v[224:227], a[32:35], v[16:19], 0
 ds_read_b64_tr_b16 a[70:71], v5 offset:9472
 v_mfma_f32_16x16x32_bf16 v[228:231], a[32:35], v[88:91], 0
 s_waitcnt lgkmcnt(0)
 v_mfma_f32_16x16x32_bf16 v[160:163], a[36:39], v[20:23], v[160:163]
 ds_read_b128 v[232:235], v8 offset:256
 ds_read_b128 v[236:239], v8 offset:272
 ds_read_b128 v[240:243], v8 offset:2560
 ds_read_b128 v[244:247], v8 offset:2576
 v_mfma_f32_16x16x32_bf16 v[164:167], a[36:39], v[92:95], v[164:167]
 ds_read_b64_tr_b16 a[0:1], v2 offset:18432
 ds_read_b64_tr_b16 a[2:3], v5 offset:18432
 v_mfma_f32_16x16x32_bf16 v[168:171], a[40:43], v[20:23], v[168:171]
 ds_read_b64_tr_b16 a[4:5], v2 offset:18464
 ds_read_b64_tr_b16 a[6:7], v5 offset:18464
 v_mfma_f32_16x16x32_bf16 v[172:175], a[40:43], v[92:95], v[172:175]
 ds_read_b64_tr_b16 a[8:9], v2 offset:18496
 ds_read_b64_tr_b16 a[10:11], v5 offset:18496
 v_mfma_f32_16x16x32_bf16 v[176:179], a[44:47], v[20:23], v[176:179]
 s_waitcnt lgkmcnt(6)
 v_fma_mix_f32 v248, v24, v240, v232 op_sel_hi:[1,0,0]
 v_fma_mix_f32 v249, v24, v241, v233 op_sel:[1,0,0] op_sel_hi:[1,0,0]
 v_mfma_f32_16x16x32_bf16 v[180:183], a[44:47], v[92:95], v[180:183]
 ds_read_b64_tr_b16 a[12:13], v2 offset:18528
 v_fma_mix_f32 v250, v25, v242, v234 op_sel_hi:[1,0,0]
 v_fma_mix_f32 v251, v25, v243, v235 op_sel:[1,0,0] op_sel_hi:[1,0,0]
 v_mfma_f32_16x16x32_bf16 v[184:187], a[48:51], v[20:23], v[184:187]
 ds_read_b64_tr_b16 a[14:15], v5 offset:18528
 v_fma_mix_f32 v252, v26, v244, v236 op_sel_hi:[1,0,0]
 v_fma_mix_f32 v253, v26, v245, v237 op_sel:[1,0,0] op_sel_hi:[1,0,0]
 v_mfma_f32_16x16x32_bf16 v[188:191], a[48:51], v[92:95], v[188:191]
 ds_read_b64_tr_b16 a[16:17], v2 offset:18560
 v_fma_mix_f32 v254, v27, v246, v238 op_sel_hi:[1,0,0]
 v_fma_mix_f32 v255, v27, v247, v239 op_sel:[1,0,0] op_sel_hi:[1,0,0]
 v_mfma_f32_16x16x32_bf16 v[192:195], a[52:55], v[20:23], v[192:195]
 ds_read_b64_tr_b16 a[18:19], v5 offset:18560
 v_cvt_pk_bf16_f32 v24, v248, v249
 v_cvt_pk_bf16_f32 v25, v250, v251
 v_mfma_f32_16x16x32_bf16 v[196:199], a[52:55], v[92:95], v[196:199]
 ds_read_b64_tr_b16 a[20:21], v2 offset:18592
 v_cvt_pk_bf16_f32 v26, v252, v253
 v_cvt_pk_bf16_f32 v27, v254, v255
 v_mfma_f32_16x16x32_bf16 v[200:203], a[56:59], v[20:23], v[200:203]
 ds_read_b64_tr_b16 a[22:23], v5 offset:18592
 v_fma_mix_f32 v248, v96, v240, v232 op_sel_hi:[1,0,0]
 v_fma_mix_f32 v249, v96, v241, v233 op_sel:[1,0,0] op_sel_hi:[1,0,0]
 v_mfma_f32_16x16x32_bf16 v[204:207], a[56:59], v[92:95], v[204:207]
 ds_read_b64_tr_b16 a[24:25], v2 offset:18624
 v_fma_mix_f32 v250, v97, v242, v234 op_sel_hi:[1,0,0]
 v_fma_mix_f32 v251, v97, v243, v235 op_sel:[1,0,0] op_sel_hi:[1,0,0]
 v_mfma_f32_16x16x32_bf16 v[208:211], a[60:63], v[20:23], v[208:211]
 ds_read_b64_tr_b16 a[26:27], v5 offset:18624
 v_fma_mix_f32 v252, v98, v244, v236 op_sel_hi:[1,0,0]
 v_fma_mix_f32 v253, v98, v245, v237 op_sel:[1,0,0] op_sel_hi:[1,0,0]
 v_mfma_f32_16x16x32_bf16 v[212:215], a[60:63], v[92:95], v[212:215]
 ds_read_b64_tr_b16 a[28:29], v2 offset:18656
 v_fma_mix_f32 v254, v99, v246, v238 op_sel_hi:[1,0,0]
 v_fma_mix_f32 v255, v99, v247, v239 op_sel:[1,0,0] op_sel_hi:[1,0,0]
 v_mfma_f32_16x16x32_bf16 v[216:219], a[64:67], v[20:23], v[216:219]
 ds_read_b64_tr_b16 a[30:31], v5 offset:18656
 v_cvt_pk_bf16_f32 v96, v248, v249
 v_cvt_pk_bf16_f32 v97, v250, v251
 v_mfma_f32_16x16x32_bf16 v[220:223], a[64:67], v[92:95], v[220:223]
 ds_read_b64_tr_b16 a[32:33], v2 offset:18688
 v_cvt_pk_bf16_f32 v98, v252, v253
 v_cvt_pk_bf16_f32 v99, v254, v255
 v_mfma_f32_16x16x32_bf16 v[224:227], a[68:71], v[20:23], v[224:227]
 ds_read_b64_tr_b16 a[34:35], v5 offset:18688
 v_mfma_f32_16x16x32_bf16 v[228:231], a[68:71], v[92:95], v[228:231]
 s_waitcnt lgkmcnt(0)
 s_barrier
 s_cmp_lt_u32 s32, 2
 s_cbranch_scc0 L_k01_nodma_qk
 v_accvgpr_read_b32 v248, a72
 s_add_u32 m0, s39, 0
 s_add_u32 s35, s37, 1769472
 buffer_load_dwordx4 v248, s[12:15], s35 offen lds
 v_accvgpr_read_b32 v249, a73
 s_add_u32 m0, s39, 1024
 s_add_u32 s35, s37, 1769472
 buffer_load_dwordx4 v249, s[12:15], s35 offen lds
 v_accvgpr_read_b32 v250, a74
 s_add_u32 m0, s39, 2048
 s_add_u32 s35, s37, 1769472
 buffer_load_dwordx4 v250, s[12:15], s35 offen lds
 v_accvgpr_read_b32 v251, a75
 s_add_u32 m0, s39, 3072
 s_add_u32 s35, s37, 1769472
 buffer_load_dwordx4 v251, s[12:15], s35 offen lds
 v_accvgpr_read_b32 v248, a76
 s_add_u32 m0, s39, 4096
 s_add_u32 s35, s37, 1769472
 buffer_load_dwordx4 v248, s[12:15], s35 offen lds
 v_accvgpr_read_b32 v249, a77
 s_add_u32 m0, s39, 5120
 s_add_u32 s35, s37, 1769472
 buffer_load_dwordx4 v249, s[12:15], s35 offen lds
 v_accvgpr_read_b32 v250, a78
 s_add_u32 m0, s39, 6144
 s_add_u32 s35, s37, 1769472
 buffer_load_dwordx4 v250, s[12:15], s35 offen lds
 v_accvgpr_read_b32 v251, a79
 s_add_u32 m0, s39, 7168
 s_add_u32 s35, s37, 1769472
 buffer_load_dwordx4 v251, s[12:15], s35 offen lds
 v_accvgpr_read_b32 v248, a80
 s_add_u32 m0, s39, 8192
 s_add_u32 s35, s37, 1769472
 buffer_load_dwordx4 v248, s[12:15], s35 offen lds
L_k01_nodma_qk:
 v_mfma_f32_16x16x32_bf16 v[160:163], a[0:3], v[24:27], v[160:163]
 ds_read_b128 v[232:235], v8 offset:384
 ds_read_b128 v[236:239], v8 offset:400
 ds_read_b128 v[240:243], v8 offset:2688
 ds_read_b128 v[244:247], v8 offset:2704
 v_mfma_f32_16x16x32_bf16 v[164:167], a[0:3], v[96:99], v[164:167]
 ds_read_b64_tr_b16 a[36:37], v2 offset:27648
 ds_read_b64_tr_b16 a[38:39], v5 offset:27648
 v_mfma_f32_16x16x32_bf16 v[168:171], a[4:7], v[24:27], v[168:171]
 ds_read_b64_tr_b16 a[40:41], v2 offset:27680
 ds_read_b64_tr_b16 a[42:43], v5 offset:27680
 v_mfma_f32_16x16x32_bf16 v[172:175], a[4:7], v[96:99], v[172:175]
 ds_read_b64_tr_b16 a[44:45], v2 offset:27712
 ds_read_b64_tr_b16 a[46:47], v5 offset:27712
 v_mfma_f32_16x16x32_bf16 v[176:179], a[8:11], v[24:27], v[176:179]
 s_waitcnt lgkmcnt(6)
 v_fma_mix_f32 v248, v28, v240, v232 op_sel_hi:[1,0,0]
 v_fma_mix_f32 v249, v28, v241, v233 op_sel:[1,0,0] op_sel_hi:[1,0,0]
 v_mfma_f32_16x16x32_bf16 v[180:183], a[8:11], v[96:99], v[180:183]
 ds_read_b64_tr_b16 a[48:49], v2 offset:27744
 v_fma_mix_f32 v250, v29, v242, v234 op_sel_hi:[1,0,0]
 v_fma_mix_f32 v251, v29, v243, v235 op_sel:[1,0,0] op_sel_hi:[1,0,0]
 v_mfma_f32_16x16x32_bf16 v[184:187], a[12:15], v[24:27], v[184:187]
 ds_read_b64_tr_b16 a[50:51], v5 offset:27744
 v_fma_mix_f32 v252, v30, v244, v236 op_sel_hi:[1,0,0]
 v_fma_mix_f32 v253, v30, v245, v237 op_sel:[1,0,0] op_sel_hi:[1,0,0]
 v_mfma_f32_16x16x32_bf16 v[188:191], a[12:15], v[96:99], v[188:191]
 ds_read_b64_tr_b16 a[52:53], v2 offset:27776
 v_fma_mix_f32 v254, v31, v246, v238 op_sel_hi:[1,0,0]
 v_fma_mix_f32 v255, v31, v247, v239 op_sel:[1,0,0] op_sel_hi:[1,0,0]
 v_mfma_f32_16x16x32_bf16 v[192:195], a[16:19], v[24:27], v[192:195]
 ds_read_b64_tr_b16 a[54:55], v5 offset:27776
 v_cvt_pk_bf16_f32 v28, v248, v249
 v_cvt_pk_bf16_f32 v29, v250, v251
 v_mfma_f32_16x16x32_bf16 v[196:199], a[16:19], v[96:99], v[196:199]
 ds_read_b64_tr_b16 a[56:57], v2 offset:27808
 v_cvt_pk_bf16_f32 v30, v252, v253
 v_cvt_pk_bf16_f32 v31, v254, v255
 v_mfma_f32_16x16x32_bf16 v[200:203], a[20:23], v[24:27], v[200:203]
 ds_read_b64_tr_b16 a[58:59], v5 offset:27808
 v_fma_mix_f32 v248, v100, v240, v232 op_sel_hi:[1,0,0]
 v_fma_mix_f32 v249, v100, v241, v233 op_sel:[1,0,0] op_sel_hi:[1,0,0]
 v_mfma_f32_16x16x32_bf16 v[204:207], a[20:23], v[96:99], v[204:207]
 ds_read_b64_tr_b16 a[60:61], v2 offset:27840
 v_fma_mix_f32 v250, v101, v242, v234 op_sel_hi:[1,0,0]
 v_fma_mix_f32 v251, v101, v243, v235 op_sel:[1,0,0] op_sel_hi:[1,0,0]
 v_mfma_f32_16x16x32_bf16 v[208:211], a[24:27], v[24:27], v[208:211]
 ds_read_b64_tr_b16 a[62:63], v5 offset:27840
 v_fma_mix_f32 v252, v102, v244, v236 op_sel_hi:[1,0,0]
 v_fma_mix_f32 v253, v102, v245, v237 op_sel:[1,0,0] op_sel_hi:[1,0,0]
 v_mfma_f32_16x16x32_bf16 v[212:215], a[24:27], v[96:99], v[212:215]
 ds_read_b64_tr_b16 a[64:65], v2 offset:27872
 v_fma_mix_f32 v254, v103, v246, v238 op_sel_hi:[1,0,0]
 v_fma_mix_f32 v255, v103, v247, v239 op_sel:[1,0,0] op_sel_hi:[1,0,0]
 v_mfma_f32_16x16x32_bf16 v[216:219], a[28:31], v[24:27], v[216:219]
 ds_read_b64_tr_b16 a[66:67], v5 offset:27872
 v_cvt_pk_bf16_f32 v100, v248, v249
 v_cvt_pk_bf16_f32 v101, v250, v251
 v_mfma_f32_16x16x32_bf16 v[220:223], a[28:31], v[96:99], v[220:223]
 ds_read_b64_tr_b16 a[68:69], v2 offset:27904
 v_cvt_pk_bf16_f32 v102, v252, v253
 v_cvt_pk_bf16_f32 v103, v254, v255
 v_mfma_f32_16x16x32_bf16 v[224:227], a[32:35], v[24:27], v[224:227]
 ds_read_b64_tr_b16 a[70:71], v5 offset:27904
 v_mfma_f32_16x16x32_bf16 v[228:231], a[32:35], v[96:99], v[228:231]
 s_waitcnt lgkmcnt(0)
 v_mfma_f32_16x16x32_bf16 v[160:163], a[36:39], v[28:31], v[160:163]
 ds_read_b128 v[232:235], v8 offset:512
 ds_read_b128 v[236:239], v8 offset:528
 ds_read_b128 v[240:243], v8 offset:2816
 ds_read_b128 v[244:247], v8 offset:2832
 v_mfma_f32_16x16x32_bf16 v[164:167], a[36:39], v[100:103], v[164:167]
 ds_read_b64_tr_b16 a[0:1], v2 offset:36864
 ds_read_b64_tr_b16 a[2:3], v5 offset:36864
 v_mfma_f32_16x16x32_bf16 v[168:171], a[40:43], v[28:31], v[168:171]
 ds_read_b64_tr_b16 a[4:5], v2 offset:36896
 ds_read_b64_tr_b16 a[6:7], v5 offset:36896
 v_mfma_f32_16x16x32_bf16 v[172:175], a[40:43], v[100:103], v[172:175]
 ds_read_b64_tr_b16 a[8:9], v2 offset:36928
 ds_read_b64_tr_b16 a[10:11], v5 offset:36928
 v_mfma_f32_16x16x32_bf16 v[176:179], a[44:47], v[28:31], v[176:179]
 s_waitcnt lgkmcnt(6)
 v_fma_mix_f32 v248, v32, v240, v232 op_sel_hi:[1,0,0]
 v_fma_mix_f32 v249, v32, v241, v233 op_sel:[1,0,0] op_sel_hi:[1,0,0]
 v_mfma_f32_16x16x32_bf16 v[180:183], a[44:47], v[100:103], v[180:183]
 ds_read_b64_tr_b16 a[12:13], v2 offset:36960
 v_fma_mix_f32 v250, v33, v242, v234 op_sel_hi:[1,0,0]
 v_fma_mix_f32 v251, v33, v243, v235 op_sel:[1,0,0] op_sel_hi:[1,0,0]
 v_mfma_f32_16x16x32_bf16 v[184:187], a[48:51], v[28:31], v[184:187]
 ds_read_b64_tr_b16 a[14:15], v5 offset:36960
 v_fma_mix_f32 v252, v34, v244, v236 op_sel_hi:[1,0,0]
 v_fma_mix_f32 v253, v34, v245, v237 op_sel:[1,0,0] op_sel_hi:[1,0,0]
 v_mfma_f32_16x16x32_bf16 v[188:191], a[48:51], v[100:103], v[188:191]
 ds_read_b64_tr_b16 a[16:17], v2 offset:36992
 v_fma_mix_f32 v254, v35, v246, v238 op_sel_hi:[1,0,0]
 v_fma_mix_f32 v255, v35, v247, v239 op_sel:[1,0,0] op_sel_hi:[1,0,0]
 v_mfma_f32_16x16x32_bf16 v[192:195], a[52:55], v[28:31], v[192:195]
 ds_read_b64_tr_b16 a[18:19], v5 offset:36992
 v_cvt_pk_bf16_f32 v32, v248, v249
 v_cvt_pk_bf16_f32 v33, v250, v251
 v_mfma_f32_16x16x32_bf16 v[196:199], a[52:55], v[100:103], v[196:199]
 ds_read_b64_tr_b16 a[20:21], v2 offset:37024
 v_cvt_pk_bf16_f32 v34, v252, v253
 v_cvt_pk_bf16_f32 v35, v254, v255
 v_mfma_f32_16x16x32_bf16 v[200:203], a[56:59], v[28:31], v[200:203]
 ds_read_b64_tr_b16 a[22:23], v5 offset:37024
 v_fma_mix_f32 v248, v104, v240, v232 op_sel_hi:[1,0,0]
 v_fma_mix_f32 v249, v104, v241, v233 op_sel:[1,0,0] op_sel_hi:[1,0,0]
 v_mfma_f32_16x16x32_bf16 v[204:207], a[56:59], v[100:103], v[204:207]
 ds_read_b64_tr_b16 a[24:25], v2 offset:37056
 v_fma_mix_f32 v250, v105, v242, v234 op_sel_hi:[1,0,0]
 v_fma_mix_f32 v251, v105, v243, v235 op_sel:[1,0,0] op_sel_hi:[1,0,0]
 v_mfma_f32_16x16x32_bf16 v[208:211], a[60:63], v[28:31], v[208:211]
 ds_read_b64_tr_b16 a[26:27], v5 offset:37056
 v_fma_mix_f32 v252, v106, v244, v236 op_sel_hi:[1,0,0]
 v_fma_mix_f32 v253, v106, v245, v237 op_sel:[1,0,0] op_sel_hi:[1,0,0]
 v_mfma_f32_16x16x32_bf16 v[212:215], a[60:63], v[100:103], v[212:215]
 ds_read_b64_tr_b16 a[28:29], v2 offset:37088
 v_fma_mix_f32 v254, v107, v246, v238 op_sel_hi:[1,0,0]
 v_fma_mix_f32 v255, v107, v247, v239 op_sel:[1,0,0] op_sel_hi:[1,0,0]
 v_mfma_f32_16x16x32_bf16 v[216:219], a[64:67], v[28:31], v[216:219]
 ds_read_b64_tr_b16 a[30:31], v5 offset:37088
 v_cvt_pk_bf16_f32 v104, v248, v249
 v_cvt_pk_bf16_f32 v105, v250, v251
 v_mfma_f32_16x16x32_bf16 v[220:223], a[64:67], v[100:103], v[220:223]
 ds_read_b64_tr_b16 a[32:33], v2 offset:37120
 v_cvt_pk_bf16_f32 v106, v252, v253
 v_cvt_pk_bf16_f32 v107, v254, v255
 v_mfma_f32_16x16x32_bf16 v[224:227], a[68:71], v[28:31], v[224:227]
 ds_read_b64_tr_b16 a[34:35], v5 offset:37120
 v_mfma_f32_16x16x32_bf16 v[228:231], a[68:71], v[100:103], v[228:231]
 s_waitcnt lgkmcnt(0)
 v_mfma_f32_16x16x32_bf16 v[160:163], a[0:3], v[32:35], v[160:163]
 ds_read_b128 v[232:235], v8 offset:640
 ds_read_b128 v[236:239], v8 offset:656
 ds_read_b128 v[240:243], v8 offset:2944
 ds_read_b128 v[244:247], v8 offset:2960
 v_mfma_f32_16x16x32_bf16 v[164:167], a[0:3], v[104:107], v[164:167]
 ds_read_b64_tr_b16 a[36:37], v2 offset:46080
 ds_read_b64_tr_b16 a[38:39], v5 offset:46080
 v_mfma_f32_16x16x32_bf16 v[168:171], a[4:7], v[32:35], v[168:171]
 ds_read_b64_tr_b16 a[40:41], v2 offset:46112
 ds_read_b64_tr_b16 a[42:43], v5 offset:46112
 v_mfma_f32_16x16x32_bf16 v[172:175], a[4:7], v[104:107], v[172:175]
 ds_read_b64_tr_b16 a[44:45], v2 offset:46144
 ds_read_b64_tr_b16 a[46:47], v5 offset:46144
 v_mfma_f32_16x16x32_bf16 v[176:179], a[8:11], v[32:35], v[176:179]
 s_waitcnt lgkmcnt(6)
 v_fma_mix_f32 v248, v36, v240, v232 op_sel_hi:[1,0,0]
 v_fma_mix_f32 v249, v36, v241, v233 op_sel:[1,0,0] op_sel_hi:[1,0,0]
 v_mfma_f32_16x16x32_bf16 v[180:183], a[8:11], v[104:107], v[180:183]
 ds_read_b64_tr_b16 a[48:49], v2 offset:46176
 v_fma_mix_f32 v250, v37, v242, v234 op_sel_hi:[1,0,0]
 v_fma_mix_f32 v251, v37, v243, v235 op_sel:[1,0,0] op_sel_hi:[1,0,0]
 v_mfma_f32_16x16x32_bf16 v[184:187], a[12:15], v[32:35], v[184:187]
 ds_read_b64_tr_b16 a[50:51], v5 offset:46176
 v_fma_mix_f32 v252, v38, v244, v236 op_sel_hi:[1,0,0]
 v_fma_mix_f32 v253, v38, v245, v237 op_sel:[1,0,0] op_sel_hi:[1,0,0]
 v_mfma_f32_16x16x32_bf16 v[188:191], a[12:15], v[104:107], v[188:191]
 ds_read_b64_tr_b16 a[52:53], v2 offset:46208
 v_fma_mix_f32 v254, v39, v246, v238 op_sel_hi:[1,0,0]
 v_fma_mix_f32 v255, v39, v247, v239 op_sel:[1,0,0] op_sel_hi:[1,0,0]
 v_mfma_f32_16x16x32_bf16 v[192:195], a[16:19], v[32:35], v[192:195]
 ds_read_b64_tr_b16 a[54:55], v5 offset:46208
 v_cvt_pk_bf16_f32 v36, v248, v249
 v_cvt_pk_bf16_f32 v37, v250, v251
 v_mfma_f32_16x16x32_bf16 v[196:199], a[16:19], v[104:107], v[196:199]
 ds_read_b64_tr_b16 a[56:57], v2 offset:46240
 v_cvt_pk_bf16_f32 v38, v252, v253
 v_cvt_pk_bf16_f32 v39, v254, v255
 v_mfma_f32_16x16x32_bf16 v[200:203], a[20:23], v[32:35], v[200:203]
 ds_read_b64_tr_b16 a[58:59], v5 offset:46240
 v_fma_mix_f32 v248, v108, v240, v232 op_sel_hi:[1,0,0]
 v_fma_mix_f32 v249, v108, v241, v233 op_sel:[1,0,0] op_sel_hi:[1,0,0]
 v_mfma_f32_16x16x32_bf16 v[204:207], a[20:23], v[104:107], v[204:207]
 ds_read_b64_tr_b16 a[60:61], v2 offset:46272
 v_fma_mix_f32 v250, v109, v242, v234 op_sel_hi:[1,0,0]
 v_fma_mix_f32 v251, v109, v243, v235 op_sel:[1,0,0] op_sel_hi:[1,0,0]
 v_mfma_f32_16x16x32_bf16 v[208:211], a[24:27], v[32:35], v[208:211]
 ds_read_b64_tr_b16 a[62:63], v5 offset:46272
 v_fma_mix_f32 v252, v110, v244, v236 op_sel_hi:[1,0,0]
 v_fma_mix_f32 v253, v110, v245, v237 op_sel:[1,0,0] op_sel_hi:[1,0,0]
 v_mfma_f32_16x16x32_bf16 v[212:215], a[24:27], v[104:107], v[212:215]
 ds_read_b64_tr_b16 a[64:65], v2 offset:46304
 v_fma_mix_f32 v254, v111, v246, v238 op_sel_hi:[1,0,0]
 v_fma_mix_f32 v255, v111, v247, v239 op_sel:[1,0,0] op_sel_hi:[1,0,0]
 v_mfma_f32_16x16x32_bf16 v[216:219], a[28:31], v[32:35], v[216:219]
 ds_read_b64_tr_b16 a[66:67], v5 offset:46304
 v_cvt_pk_bf16_f32 v108, v248, v249
 v_cvt_pk_bf16_f32 v109, v250, v251
 v_mfma_f32_16x16x32_bf16 v[220:223], a[28:31], v[104:107], v[220:223]
 ds_read_b64_tr_b16 a[68:69], v2 offset:46336
 v_cvt_pk_bf16_f32 v110, v252, v253
 v_cvt_pk_bf16_f32 v111, v254, v255
 v_mfma_f32_16x16x32_bf16 v[224:227], a[32:35], v[32:35], v[224:227]
 ds_read_b64_tr_b16 a[70:71], v5 offset:46336
 v_mfma_f32_16x16x32_bf16 v[228:231], a[32:35], v[104:107], v[228:231]
 s_waitcnt lgkmcnt(0)
 v_mfma_f32_16x16x32_bf16 v[160:163], a[36:39], v[36:39], v[160:163]
 ds_read_b128 v[232:235], v8 offset:768
 ds_read_b128 v[236:239], v8 offset:784
 ds_read_b128 v[240:243], v8 offset:3072
 ds_read_b128 v[244:247], v8 offset:3088
 v_mfma_f32_16x16x32_bf16 v[164:167], a[36:39], v[108:111], v[164:167]
 ds_read_b64_tr_b16 a[0:1], v2 offset:55296
 ds_read_b64_tr_b16 a[2:3], v5 offset:55296
 v_mfma_f32_16x16x32_bf16 v[168:171], a[40:43], v[36:39], v[168:171]
 ds_read_b64_tr_b16 a[4:5], v2 offset:55328
 ds_read_b64_tr_b16 a[6:7], v5 offset:55328
 v_mfma_f32_16x16x32_bf16 v[172:175], a[40:43], v[108:111], v[172:175]
 ds_read_b64_tr_b16 a[8:9], v2 offset:55360
 ds_read_b64_tr_b16 a[10:11], v5 offset:55360
 v_mfma_f32_16x16x32_bf16 v[176:179], a[44:47], v[36:39], v[176:179]
 s_waitcnt lgkmcnt(6)
 v_fma_mix_f32 v248, v40, v240, v232 op_sel_hi:[1,0,0]
 v_fma_mix_f32 v249, v40, v241, v233 op_sel:[1,0,0] op_sel_hi:[1,0,0]
 v_mfma_f32_16x16x32_bf16 v[180:183], a[44:47], v[108:111], v[180:183]
 ds_read_b64_tr_b16 a[12:13], v2 offset:55392
 v_fma_mix_f32 v250, v41, v242, v234 op_sel_hi:[1,0,0]
 v_fma_mix_f32 v251, v41, v243, v235 op_sel:[1,0,0] op_sel_hi:[1,0,0]
 v_mfma_f32_16x16x32_bf16 v[184:187], a[48:51], v[36:39], v[184:187]
 ds_read_b64_tr_b16 a[14:15], v5 offset:55392
 v_fma_mix_f32 v252, v42, v244, v236 op_sel_hi:[1,0,0]
 v_fma_mix_f32 v253, v42, v245, v237 op_sel:[1,0,0] op_sel_hi:[1,0,0]
 v_mfma_f32_16x16x32_bf16 v[188:191], a[48:51], v[108:111], v[188:191]
 ds_read_b64_tr_b16 a[16:17], v2 offset:55424
 v_fma_mix_f32 v254, v43, v246, v238 op_sel_hi:[1,0,0]
 v_fma_mix_f32 v255, v43, v247, v239 op_sel:[1,0,0] op_sel_hi:[1,0,0]
 v_mfma_f32_16x16x32_bf16 v[192:195], a[52:55], v[36:39], v[192:195]
 ds_read_b64_tr_b16 a[18:19], v5 offset:55424
 v_cvt_pk_bf16_f32 v40, v248, v249
 v_cvt_pk_bf16_f32 v41, v250, v251
 v_mfma_f32_16x16x32_bf16 v[196:199], a[52:55], v[108:111], v[196:199]
 ds_read_b64_tr_b16 a[20:21], v2 offset:55456
 v_cvt_pk_bf16_f32 v42, v252, v253
 v_cvt_pk_bf16_f32 v43, v254, v255
 v_mfma_f32_16x16x32_bf16 v[200:203], a[56:59], v[36:39], v[200:203]
 ds_read_b64_tr_b16 a[22:23], v5 offset:55456
 v_fma_mix_f32 v248, v112, v240, v232 op_sel_hi:[1,0,0]
 v_fma_mix_f32 v249, v112, v241, v233 op_sel:[1,0,0] op_sel_hi:[1,0,0]
 v_mfma_f32_16x16x32_bf16 v[204:207], a[56:59], v[108:111], v[204:207]
 ds_read_b64_tr_b16 a[24:25], v2 offset:55488
 v_fma_mix_f32 v250, v113, v242, v234 op_sel_hi:[1,0,0]
 v_fma_mix_f32 v251, v113, v243, v235 op_sel:[1,0,0] op_sel_hi:[1,0,0]
 v_mfma_f32_16x16x32_bf16 v[208:211], a[60:63], v[36:39], v[208:211]
 ds_read_b64_tr_b16 a[26:27], v5 offset:55488
 v_fma_mix_f32 v252, v114, v244, v236 op_sel_hi:[1,0,0]
 v_fma_mix_f32 v253, v114, v245, v237 op_sel:[1,0,0] op_sel_hi:[1,0,0]
 v_mfma_f32_16x16x32_bf16 v[212:215], a[60:63], v[108:111], v[212:215]
 ds_read_b64_tr_b16 a[28:29], v2 offset:55520
 v_fma_mix_f32 v254, v115, v246, v238 op_sel_hi:[1,0,0]
 v_fma_mix_f32 v255, v115, v247, v239 op_sel:[1,0,0] op_sel_hi:[1,0,0]
 v_mfma_f32_16x16x32_bf16 v[216:219], a[64:67], v[36:39], v[216:219]
 ds_read_b64_tr_b16 a[30:31], v5 offset:55520
 v_cvt_pk_bf16_f32 v112, v248, v249
 v_cvt_pk_bf16_f32 v113, v250, v251
 v_mfma_f32_16x16x32_bf16 v[220:223], a[64:67], v[108:111], v[220:223]
 ds_read_b64_tr_b16 a[32:33], v2 offset:55552
 v_cvt_pk_bf16_f32 v114, v252, v253
 v_cvt_pk_bf16_f32 v115, v254, v255
 v_mfma_f32_16x16x32_bf16 v[224:227], a[68:71], v[36:39], v[224:227]
 ds_read_b64_tr_b16 a[34:35], v5 offset:55552
 v_mfma_f32_16x16x32_bf16 v[228:231], a[68:71], v[108:111], v[228:231]
 s_waitcnt lgkmcnt(0)
 v_mfma_f32_16x16x32_bf16 v[160:163], a[0:3], v[40:43], v[160:163]
 ds_read_b128 v[232:235], v8 offset:896
 ds_read_b128 v[236:239], v8 offset:912
 ds_read_b128 v[240:243], v8 offset:3200
 ds_read_b128 v[244:247], v8 offset:3216
 v_mfma_f32_16x16x32_bf16 v[164:167], a[0:3], v[112:115], v[164:167]
 ds_read_b64_tr_b16 a[36:37], v3 offset:0
 ds_read_b64_tr_b16 a[38:39], v6 offset:0
 v_mfma_f32_16x16x32_bf16 v[168:171], a[4:7], v[40:43], v[168:171]
 ds_read_b64_tr_b16 a[40:41], v3 offset:32
 ds_read_b64_tr_b16 a[42:43], v6 offset:32
 v_mfma_f32_16x16x32_bf16 v[172:175], a[4:7], v[112:115], v[172:175]
 ds_read_b64_tr_b16 a[44:45], v3 offset:64
 ds_read_b64_tr_b16 a[46:47], v6 offset:64
 v_mfma_f32_16x16x32_bf16 v[176:179], a[8:11], v[40:43], v[176:179]
 s_waitcnt lgkmcnt(6)
 v_fma_mix_f32 v248, v44, v240, v232 op_sel_hi:[1,0,0]
 v_fma_mix_f32 v249, v44, v241, v233 op_sel:[1,0,0] op_sel_hi:[1,0,0]
 v_mfma_f32_16x16x32_bf16 v[180:183], a[8:11], v[112:115], v[180:183]
 ds_read_b64_tr_b16 a[48:49], v3 offset:96
 v_fma_mix_f32 v250, v45, v242, v234 op_sel_hi:[1,0,0]
 v_fma_mix_f32 v251, v45, v243, v235 op_sel:[1,0,0] op_sel_hi:[1,0,0]
 v_mfma_f32_16x16x32_bf16 v[184:187], a[12:15], v[40:43], v[184:187]
 ds_read_b64_tr_b16 a[50:51], v6 offset:96
 v_fma_mix_f32 v252, v46, v244, v236 op_sel_hi:[1,0,0]
 v_fma_mix_f32 v253, v46, v245, v237 op_sel:[1,0,0] op_sel_hi:[1,0,0]
 v_mfma_f32_16x16x32_bf16 v[188:191], a[12:15], v[112:115], v[188:191]
 ds_read_b64_tr_b16 a[52:53], v3 offset:128
 v_fma_mix_f32 v254, v47, v246, v238 op_sel_hi:[1,0,0]
 v_fma_mix_f32 v255, v47, v247, v239 op_sel:[1,0,0] op_sel_hi:[1,0,0]
 v_mfma_f32_16x16x32_bf16 v[192:195], a[16:19], v[40:43], v[192:195]
 ds_read_b64_tr_b16 a[54:55], v6 offset:128
 v_cvt_pk_bf16_f32 v44, v248, v249
 v_cvt_pk_bf16_f32 v45, v250, v251
 v_mfma_f32_16x16x32_bf16 v[196:199], a[16:19], v[112:115], v[196:199]
 ds_read_b64_tr_b16 a[56:57], v3 offset:160
 v_cvt_pk_bf16_f32 v46, v252, v253
 v_cvt_pk_bf16_f32 v47, v254, v255
 v_mfma_f32_16x16x32_bf16 v[200:203], a[20:23], v[40:43], v[200:203]
 ds_read_b64_tr_b16 a[58:59], v6 offset:160
 v_fma_mix_f32 v248, v116, v240, v232 op_sel_hi:[1,0,0]
 v_fma_mix_f32 v249, v116, v241, v233 op_sel:[1,0,0] op_sel_hi:[1,0,0]
 v_mfma_f32_16x16x32_bf16 v[204:207], a[20:23], v[112:115], v[204:207]
 ds_read_b64_tr_b16 a[60:61], v3 offset:192
 v_fma_mix_f32 v250, v117, v242, v234 op_sel_hi:[1,0,0]
 v_fma_mix_f32 v251, v117, v243, v235 op_sel:[1,0,0] op_sel_hi:[1,0,0]
 v_mfma_f32_16x16x32_bf16 v[208:211], a[24:27], v[40:43], v[208:211]
 ds_read_b64_tr_b16 a[62:63], v6 offset:192
 v_fma_mix_f32 v252, v118, v244, v236 op_sel_hi:[1,0,0]
 v_fma_mix_f32 v253, v118, v245, v237 op_sel:[1,0,0] op_sel_hi:[1,0,0]
 v_mfma_f32_16x16x32_bf16 v[212:215], a[24:27], v[112:115], v[212:215]
 ds_read_b64_tr_b16 a[64:65], v3 offset:224
 v_fma_mix_f32 v254, v119, v246, v238 op_sel_hi:[1,0,0]
 v_fma_mix_f32 v255, v119, v247, v239 op_sel:[1,0,0] op_sel_hi:[1,0,0]
 v_mfma_f32_16x16x32_bf16 v[216:219], a[28:31], v[40:43], v[216:219]
 ds_read_b64_tr_b16 a[66:67], v6 offset:224
 v_cvt_pk_bf16_f32 v116, v248, v249
 v_cvt_pk_bf16_f32 v117, v250, v251
 v_mfma_f32_16x16x32_bf16 v[220:223], a[28:31], v[112:115], v[220:223]
 ds_read_b64_tr_b16 a[68:69], v3 offset:256
 v_cvt_pk_bf16_f32 v118, v252, v253
 v_cvt_pk_bf16_f32 v119, v254, v255
 v_mfma_f32_16x16x32_bf16 v[224:227], a[32:35], v[40:43], v[224:227]
 ds_read_b64_tr_b16 a[70:71], v6 offset:256
 v_mfma_f32_16x16x32_bf16 v[228:231], a[32:35], v[112:115], v[228:231]
 s_waitcnt lgkmcnt(0)
 v_mfma_f32_16x16x32_bf16 v[160:163], a[36:39], v[44:47], v[160:163]
 ds_read_b128 v[232:235], v8 offset:1024
 ds_read_b128 v[236:239], v8 offset:1040
 ds_read_b128 v[240:243], v8 offset:3328
 ds_read_b128 v[244:247], v8 offset:3344
 v_mfma_f32_16x16x32_bf16 v[164:167], a[36:39], v[116:119], v[164:167]
 ds_read_b64_tr_b16 a[0:1], v3 offset:9216
 ds_read_b64_tr_b16 a[2:3], v6 offset:9216
 v_mfma_f32_16x16x32_bf16 v[168:171], a[40:43], v[44:47], v[168:171]
 ds_read_b64_tr_b16 a[4:5], v3 offset:9248
 ds_read_b64_tr_b16 a[6:7], v6 offset:9248
 v_mfma_f32_16x16x32_bf16 v[172:175], a[40:43], v[116:119], v[172:175]
 ds_read_b64_tr_b16 a[8:9], v3 offset:9280
 ds_read_b64_tr_b16 a[10:11], v6 offset:9280
 v_mfma_f32_16x16x32_bf16 v[176:179], a[44:47], v[44:47], v[176:179]
 s_waitcnt lgkmcnt(6)
 v_fma_mix_f32 v248, v48, v240, v232 op_sel_hi:[1,0,0]
 v_fma_mix_f32 v249, v48, v241, v233 op_sel:[1,0,0] op_sel_hi:[1,0,0]
 v_mfma_f32_16x16x32_bf16 v[180:183], a[44:47], v[116:119], v[180:183]
 ds_read_b64_tr_b16 a[12:13], v3 offset:9312
 v_fma_mix_f32 v250, v49, v242, v234 op_sel_hi:[1,0,0]
 v_fma_mix_f32 v251, v49, v243, v235 op_sel:[1,0,0] op_sel_hi:[1,0,0]
 v_mfma_f32_16x16x32_bf16 v[184:187], a[48:51], v[44:47], v[184:187]
 ds_read_b64_tr_b16 a[14:15], v6 offset:9312
 v_fma_mix_f32 v252, v50, v244, v236 op_sel_hi:[1,0,0]
 v_fma_mix_f32 v253, v50, v245, v237 op_sel:[1,0,0] op_sel_hi:[1,0,0]
 v_mfma_f32_16x16x32_bf16 v[188:191], a[48:51], v[116:119], v[188:191]
 ds_read_b64_tr_b16 a[16:17], v3 offset:9344
 v_fma_mix_f32 v254, v51, v246, v238 op_sel_hi:[1,0,0]
 v_fma_mix_f32 v255, v51, v247, v239 op_sel:[1,0,0] op_sel_hi:[1,0,0]
 v_mfma_f32_16x16x32_bf16 v[192:195], a[52:55], v[44:47], v[192:195]
 ds_read_b64_tr_b16 a[18:19], v6 offset:9344
 v_cvt_pk_bf16_f32 v48, v248, v249
 v_cvt_pk_bf16_f32 v49, v250, v251
 v_mfma_f32_16x16x32_bf16 v[196:199], a[52:55], v[116:119], v[196:199]
 ds_read_b64_tr_b16 a[20:21], v3 offset:9376
 v_cvt_pk_bf16_f32 v50, v252, v253
 v_cvt_pk_bf16_f32 v51, v254, v255
 v_mfma_f32_16x16x32_bf16 v[200:203], a[56:59], v[44:47], v[200:203]
 ds_read_b64_tr_b16 a[22:23], v6 offset:9376
 v_fma_mix_f32 v248, v120, v240, v232 op_sel_hi:[1,0,0]
 v_fma_mix_f32 v249, v120, v241, v233 op_sel:[1,0,0] op_sel_hi:[1,0,0]
 v_mfma_f32_16x16x32_bf16 v[204:207], a[56:59], v[116:119], v[204:207]
 ds_read_b64_tr_b16 a[24:25], v3 offset:9408
 v_fma_mix_f32 v250, v121, v242, v234 op_sel_hi:[1,0,0]
 v_fma_mix_f32 v251, v121, v243, v235 op_sel:[1,0,0] op_sel_hi:[1,0,0]
 v_mfma_f32_16x16x32_bf16 v[208:211], a[60:63], v[44:47], v[208:211]
 ds_read_b64_tr_b16 a[26:27], v6 offset:9408
 v_fma_mix_f32 v252, v122, v244, v236 op_sel_hi:[1,0,0]
 v_fma_mix_f32 v253, v122, v245, v237 op_sel:[1,0,0] op_sel_hi:[1,0,0]
 v_mfma_f32_16x16x32_bf16 v[212:215], a[60:63], v[116:119], v[212:215]
 ds_read_b64_tr_b16 a[28:29], v3 offset:9440
 v_fma_mix_f32 v254, v123, v246, v238 op_sel_hi:[1,0,0]
 v_fma_mix_f32 v255, v123, v247, v239 op_sel:[1,0,0] op_sel_hi:[1,0,0]
 v_mfma_f32_16x16x32_bf16 v[216:219], a[64:67], v[44:47], v[216:219]
 ds_read_b64_tr_b16 a[30:31], v6 offset:9440
 v_cvt_pk_bf16_f32 v120, v248, v249
 v_cvt_pk_bf16_f32 v121, v250, v251
 v_mfma_f32_16x16x32_bf16 v[220:223], a[64:67], v[116:119], v[220:223]
 ds_read_b64_tr_b16 a[32:33], v3 offset:9472
 v_cvt_pk_bf16_f32 v122, v252, v253
 v_cvt_pk_bf16_f32 v123, v254, v255
 v_mfma_f32_16x16x32_bf16 v[224:227], a[68:71], v[44:47], v[224:227]
 ds_read_b64_tr_b16 a[34:35], v6 offset:9472
 v_mfma_f32_16x16x32_bf16 v[228:231], a[68:71], v[116:119], v[228:231]
 s_waitcnt lgkmcnt(0)
 v_mfma_f32_16x16x32_bf16 v[160:163], a[0:3], v[48:51], v[160:163]
 ds_read_b128 v[232:235], v8 offset:1152
 ds_read_b128 v[236:239], v8 offset:1168
 ds_read_b128 v[240:243], v8 offset:3456
 ds_read_b128 v[244:247], v8 offset:3472
 v_mfma_f32_16x16x32_bf16 v[164:167], a[0:3], v[120:123], v[164:167]
 ds_read_b64_tr_b16 a[36:37], v3 offset:18432
 ds_read_b64_tr_b16 a[38:39], v6 offset:18432
 v_mfma_f32_16x16x32_bf16 v[168:171], a[4:7], v[48:51], v[168:171]
 ds_read_b64_tr_b16 a[40:41], v3 offset:18464
 ds_read_b64_tr_b16 a[42:43], v6 offset:18464
 v_mfma_f32_16x16x32_bf16 v[172:175], a[4:7], v[120:123], v[172:175]
 ds_read_b64_tr_b16 a[44:45], v3 offset:18496
 ds_read_b64_tr_b16 a[46:47], v6 offset:18496
 v_mfma_f32_16x16x32_bf16 v[176:179], a[8:11], v[48:51], v[176:179]
 s_waitcnt lgkmcnt(6)
 v_fma_mix_f32 v248, v52, v240, v232 op_sel_hi:[1,0,0]
 v_fma_mix_f32 v249, v52, v241, v233 op_sel:[1,0,0] op_sel_hi:[1,0,0]
 v_mfma_f32_16x16x32_bf16 v[180:183], a[8:11], v[120:123], v[180:183]
 ds_read_b64_tr_b16 a[48:49], v3 offset:18528
 v_fma_mix_f32 v250, v53, v242, v234 op_sel_hi:[1,0,0]
 v_fma_mix_f32 v251, v53, v243, v235 op_sel:[1,0,0] op_sel_hi:[1,0,0]
 v_mfma_f32_16x16x32_bf16 v[184:187], a[12:15], v[48:51], v[184:187]
 ds_read_b64_tr_b16 a[50:51], v6 offset:18528
 v_fma_mix_f32 v252, v54, v244, v236 op_sel_hi:[1,0,0]
 v_fma_mix_f32 v253, v54, v245, v237 op_sel:[1,0,0] op_sel_hi:[1,0,0]
 v_mfma_f32_16x16x32_bf16 v[188:191], a[12:15], v[120:123], v[188:191]
 ds_read_b64_tr_b16 a[52:53], v3 offset:18560
 v_fma_mix_f32 v254, v55, v246, v238 op_sel_hi:[1,0,0]
 v_fma_mix_f32 v255, v55, v247, v239 op_sel:[1,0,0] op_sel_hi:[1,0,0]
 v_mfma_f32_16x16x32_bf16 v[192:195], a[16:19], v[48:51], v[192:195]
 ds_read_b64_tr_b16 a[54:55], v6 offset:18560
 v_cvt_pk_bf16_f32 v52, v248, v249
 v_cvt_pk_bf16_f32 v53, v250, v251
 v_mfma_f32_16x16x32_bf16 v[196:199], a[16:19], v[120:123], v[196:199]
 ds_read_b64_tr_b16 a[56:57], v3 offset:18592
 v_cvt_pk_bf16_f32 v54, v252, v253
 v_cvt_pk_bf16_f32 v55, v254, v255
 v_mfma_f32_16x16x32_bf16 v[200:203], a[20:23], v[48:51], v[200:203]
 ds_read_b64_tr_b16 a[58:59], v6 offset:18592
 v_fma_mix_f32 v248, v124, v240, v232 op_sel_hi:[1,0,0]
 v_fma_mix_f32 v249, v124, v241, v233 op_sel:[1,0,0] op_sel_hi:[1,0,0]
 v_mfma_f32_16x16x32_bf16 v[204:207], a[20:23], v[120:123], v[204:207]
 ds_read_b64_tr_b16 a[60:61], v3 offset:18624
 v_fma_mix_f32 v250, v125, v242, v234 op_sel_hi:[1,0,0]
 v_fma_mix_f32 v251, v125, v243, v235 op_sel:[1,0,0] op_sel_hi:[1,0,0]
 v_mfma_f32_16x16x32_bf16 v[208:211], a[24:27], v[48:51], v[208:211]
 ds_read_b64_tr_b16 a[62:63], v6 offset:18624
 v_fma_mix_f32 v252, v126, v244, v236 op_sel_hi:[1,0,0]
 v_fma_mix_f32 v253, v126, v245, v237 op_sel:[1,0,0] op_sel_hi:[1,0,0]
 v_mfma_f32_16x16x32_bf16 v[212:215], a[24:27], v[120:123], v[212:215]
 ds_read_b64_tr_b16 a[64:65], v3 offset:18656
 v_fma_mix_f32 v254, v127, v246, v238 op_sel_hi:[1,0,0]
 v_fma_mix_f32 v255, v127, v247, v239 op_sel:[1,0,0] op_sel_hi:[1,0,0]
 v_mfma_f32_16x16x32_bf16 v[216:219], a[28:31], v[48:51], v[216:219]
 ds_read_b64_tr_b16 a[66:67], v6 offset:18656
 v_cvt_pk_bf16_f32 v124, v248, v249
 v_cvt_pk_bf16_f32 v125, v250, v251
 v_mfma_f32_16x16x32_bf16 v[220:223], a[28:31], v[120:123], v[220:223]
 ds_read_b64_tr_b16 a[68:69], v3 offset:18688
 v_cvt_pk_bf16_f32 v126, v252, v253
 v_cvt_pk_bf16_f32 v127, v254, v255
 v_mfma_f32_16x16x32_bf16 v[224:227], a[32:35], v[48:51], v[224:227]
 ds_read_b64_tr_b16 a[70:71], v6 offset:18688
 v_mfma_f32_16x16x32_bf16 v[228:231], a[32:35], v[120:123], v[228:231]
 s_waitcnt lgkmcnt(0)
 v_mfma_f32_16x16x32_bf16 v[160:163], a[36:39], v[52:55], v[160:163]
 ds_read_b128 v[232:235], v8 offset:1280
 ds_read_b128 v[236:239], v8 offset:1296
 ds_read_b128 v[240:243], v8 offset:3584
 ds_read_b128 v[244:247], v8 offset:3600
 v_mfma_f32_16x16x32_bf16 v[164:167], a[36:39], v[124:127], v[164:167]
 ds_read_b64_tr_b16 a[0:1], v3 offset:27648
 ds_read_b64_tr_b16 a[2:3], v6 offset:27648
 v_mfma_f32_16x16x32_bf16 v[168:171], a[40:43], v[52:55], v[168:171]
 ds_read_b64_tr_b16 a[4:5], v3 offset:27680
 ds_read_b64_tr_b16 a[6:7], v6 offset:27680
 v_mfma_f32_16x16x32_bf16 v[172:175], a[40:43], v[124:127], v[172:175]
 ds_read_b64_tr_b16 a[8:9], v3 offset:27712
 ds_read_b64_tr_b16 a[10:11], v6 offset:27712
 v_mfma_f32_16x16x32_bf16 v[176:179], a[44:47], v[52:55], v[176:179]
 s_waitcnt lgkmcnt(6)
 v_fma_mix_f32 v248, v56, v240, v232 op_sel_hi:[1,0,0]
 v_fma_mix_f32 v249, v56, v241, v233 op_sel:[1,0,0] op_sel_hi:[1,0,0]
 v_mfma_f32_16x16x32_bf16 v[180:183], a[44:47], v[124:127], v[180:183]
 ds_read_b64_tr_b16 a[12:13], v3 offset:27744
 v_fma_mix_f32 v250, v57, v242, v234 op_sel_hi:[1,0,0]
 v_fma_mix_f32 v251, v57, v243, v235 op_sel:[1,0,0] op_sel_hi:[1,0,0]
 v_mfma_f32_16x16x32_bf16 v[184:187], a[48:51], v[52:55], v[184:187]
 ds_read_b64_tr_b16 a[14:15], v6 offset:27744
 v_fma_mix_f32 v252, v58, v244, v236 op_sel_hi:[1,0,0]
 v_fma_mix_f32 v253, v58, v245, v237 op_sel:[1,0,0] op_sel_hi:[1,0,0]
 v_mfma_f32_16x16x32_bf16 v[188:191], a[48:51], v[124:127], v[188:191]
 ds_read_b64_tr_b16 a[16:17], v3 offset:27776
 v_fma_mix_f32 v254, v59, v246, v238 op_sel_hi:[1,0,0]
 v_fma_mix_f32 v255, v59, v247, v239 op_sel:[1,0,0] op_sel_hi:[1,0,0]
 v_mfma_f32_16x16x32_bf16 v[192:195], a[52:55], v[52:55], v[192:195]
 ds_read_b64_tr_b16 a[18:19], v6 offset:27776
 v_cvt_pk_bf16_f32 v56, v248, v249
 v_cvt_pk_bf16_f32 v57, v250, v251
 v_mfma_f32_16x16x32_bf16 v[196:199], a[52:55], v[124:127], v[196:199]
 ds_read_b64_tr_b16 a[20:21], v3 offset:27808
 v_cvt_pk_bf16_f32 v58, v252, v253
 v_cvt_pk_bf16_f32 v59, v254, v255
 v_mfma_f32_16x16x32_bf16 v[200:203], a[56:59], v[52:55], v[200:203]
 ds_read_b64_tr_b16 a[22:23], v6 offset:27808
 v_fma_mix_f32 v248, v128, v240, v232 op_sel_hi:[1,0,0]
 v_fma_mix_f32 v249, v128, v241, v233 op_sel:[1,0,0] op_sel_hi:[1,0,0]
 v_mfma_f32_16x16x32_bf16 v[204:207], a[56:59], v[124:127], v[204:207]
 ds_read_b64_tr_b16 a[24:25], v3 offset:27840
 v_fma_mix_f32 v250, v129, v242, v234 op_sel_hi:[1,0,0]
 v_fma_mix_f32 v251, v129, v243, v235 op_sel:[1,0,0] op_sel_hi:[1,0,0]
 v_mfma_f32_16x16x32_bf16 v[208:211], a[60:63], v[52:55], v[208:211]
 ds_read_b64_tr_b16 a[26:27], v6 offset:27840
 v_fma_mix_f32 v252, v130, v244, v236 op_sel_hi:[1,0,0]
 v_fma_mix_f32 v253, v130, v245, v237 op_sel:[1,0,0] op_sel_hi:[1,0,0]
 v_mfma_f32_16x16x32_bf16 v[212:215], a[60:63], v[124:127], v[212:215]
 ds_read_b64_tr_b16 a[28:29], v3 offset:27872
 v_fma_mix_f32 v254, v131, v246, v238 op_sel_hi:[1,0,0]
 v_fma_mix_f32 v255, v131, v247, v239 op_sel:[1,0,0] op_sel_hi:[1,0,0]
 v_mfma_f32_16x16x32_bf16 v[216:219], a[64:67], v[52:55], v[216:219]
 ds_read_b64_tr_b16 a[30:31], v6 offset:27872
 v_cvt_pk_bf16_f32 v128, v248, v249
 v_cvt_pk_bf16_f32 v129, v250, v251
 v_mfma_f32_16x16x32_bf16 v[220:223], a[64:67], v[124:127], v[220:223]
 ds_read_b64_tr_b16 a[32:33], v3 offset:27904
 v_cvt_pk_bf16_f32 v130, v252, v253
 v_cvt_pk_bf16_f32 v131, v254, v255
 v_mfma_f32_16x16x32_bf16 v[224:227], a[68:71], v[52:55], v[224:227]
 ds_read_b64_tr_b16 a[34:35], v6 offset:27904
 v_mfma_f32_16x16x32_bf16 v[228:231], a[68:71], v[124:127], v[228:231]
 s_waitcnt lgkmcnt(0)
 v_mfma_f32_16x16x32_bf16 v[160:163], a[0:3], v[56:59], v[160:163]
 ds_read_b128 v[232:235], v8 offset:1408
 ds_read_b128 v[236:239], v8 offset:1424
 ds_read_b128 v[240:243], v8 offset:3712
 ds_read_b128 v[244:247], v8 offset:3728
 v_mfma_f32_16x16x32_bf16 v[164:167], a[0:3], v[128:131], v[164:167]
 ds_read_b64_tr_b16 a[36:37], v3 offset:36864
 ds_read_b64_tr_b16 a[38:39], v6 offset:36864
 v_mfma_f32_16x16x32_bf16 v[168:171], a[4:7], v[56:59], v[168:171]
 ds_read_b64_tr_b16 a[40:41], v3 offset:36896
 ds_read_b64_tr_b16 a[42:43], v6 offset:36896
 v_mfma_f32_16x16x32_bf16 v[172:175], a[4:7], v[128:131], v[172:175]
 ds_read_b64_tr_b16 a[44:45], v3 offset:36928
 ds_read_b64_tr_b16 a[46:47], v6 offset:36928
 v_mfma_f32_16x16x32_bf16 v[176:179], a[8:11], v[56:59], v[176:179]
 s_waitcnt lgkmcnt(6)
 v_fma_mix_f32 v248, v60, v240, v232 op_sel_hi:[1,0,0]
 v_fma_mix_f32 v249, v60, v241, v233 op_sel:[1,0,0] op_sel_hi:[1,0,0]
 v_mfma_f32_16x16x32_bf16 v[180:183], a[8:11], v[128:131], v[180:183]
 ds_read_b64_tr_b16 a[48:49], v3 offset:36960
 v_fma_mix_f32 v250, v61, v242, v234 op_sel_hi:[1,0,0]
 v_fma_mix_f32 v251, v61, v243, v235 op_sel:[1,0,0] op_sel_hi:[1,0,0]
 v_mfma_f32_16x16x32_bf16 v[184:187], a[12:15], v[56:59], v[184:187]
 ds_read_b64_tr_b16 a[50:51], v6 offset:36960
 v_fma_mix_f32 v252, v62, v244, v236 op_sel_hi:[1,0,0]
 v_fma_mix_f32 v253, v62, v245, v237 op_sel:[1,0,0] op_sel_hi:[1,0,0]
 v_mfma_f32_16x16x32_bf16 v[188:191], a[12:15], v[128:131], v[188:191]
 ds_read_b64_tr_b16 a[52:53], v3 offset:36992
 v_fma_mix_f32 v254, v63, v246, v238 op_sel_hi:[1,0,0]
 v_fma_mix_f32 v255, v63, v247, v239 op_sel:[1,0,0] op_sel_hi:[1,0,0]
 v_mfma_f32_16x16x32_bf16 v[192:195], a[16:19], v[56:59], v[192:195]
 ds_read_b64_tr_b16 a[54:55], v6 offset:36992
 v_cvt_pk_bf16_f32 v60, v248, v249
 v_cvt_pk_bf16_f32 v61, v250, v251
 v_mfma_f32_16x16x32_bf16 v[196:199], a[16:19], v[128:131], v[196:199]
 ds_read_b64_tr_b16 a[56:57], v3 offset:37024
 v_cvt_pk_bf16_f32 v62, v252, v253
 v_cvt_pk_bf16_f32 v63, v254, v255
 v_mfma_f32_16x16x32_bf16 v[200:203], a[20:23], v[56:59], v[200:203]
 ds_read_b64_tr_b16 a[58:59], v6 offset:37024
 v_fma_mix_f32 v248, v132, v240, v232 op_sel_hi:[1,0,0]
 v_fma_mix_f32 v249, v132, v241, v233 op_sel:[1,0,0] op_sel_hi:[1,0,0]
 v_mfma_f32_16x16x32_bf16 v[204:207], a[20:23], v[128:131], v[204:207]
 ds_read_b64_tr_b16 a[60:61], v3 offset:37056
 v_fma_mix_f32 v250, v133, v242, v234 op_sel_hi:[1,0,0]
 v_fma_mix_f32 v251, v133, v243, v235 op_sel:[1,0,0] op_sel_hi:[1,0,0]
 v_mfma_f32_16x16x32_bf16 v[208:211], a[24:27], v[56:59], v[208:211]
 ds_read_b64_tr_b16 a[62:63], v6 offset:37056
 v_fma_mix_f32 v252, v134, v244, v236 op_sel_hi:[1,0,0]
 v_fma_mix_f32 v253, v134, v245, v237 op_sel:[1,0,0] op_sel_hi:[1,0,0]
 v_mfma_f32_16x16x32_bf16 v[212:215], a[24:27], v[128:131], v[212:215]
 ds_read_b64_tr_b16 a[64:65], v3 offset:37088
 v_fma_mix_f32 v254, v135, v246, v238 op_sel_hi:[1,0,0]
 v_fma_mix_f32 v255, v135, v247, v239 op_sel:[1,0,0] op_sel_hi:[1,0,0]
 v_mfma_f32_16x16x32_bf16 v[216:219], a[28:31], v[56:59], v[216:219]
 ds_read_b64_tr_b16 a[66:67], v6 offset:37088
 v_cvt_pk_bf16_f32 v132, v248, v249
 v_cvt_pk_bf16_f32 v133, v250, v251
 v_mfma_f32_16x16x32_bf16 v[220:223], a[28:31], v[128:131], v[220:223]
 ds_read_b64_tr_b16 a[68:69], v3 offset:37120
 v_cvt_pk_bf16_f32 v134, v252, v253
 v_cvt_pk_bf16_f32 v135, v254, v255
 v_mfma_f32_16x16x32_bf16 v[224:227], a[32:35], v[56:59], v[224:227]
 ds_read_b64_tr_b16 a[70:71], v6 offset:37120
 v_mfma_f32_16x16x32_bf16 v[228:231], a[32:35], v[128:131], v[228:231]
 s_waitcnt lgkmcnt(0)
 v_mfma_f32_16x16x32_bf16 v[160:163], a[36:39], v[60:63], v[160:163]
 ds_read_b128 v[232:235], v8 offset:1536
 ds_read_b128 v[236:239], v8 offset:1552
 ds_read_b128 v[240:243], v8 offset:3840
 ds_read_b128 v[244:247], v8 offset:3856
 v_mfma_f32_16x16x32_bf16 v[164:167], a[36:39], v[132:135], v[164:167]
 ds_read_b64_tr_b16 a[0:1], v3 offset:46080
 ds_read_b64_tr_b16 a[2:3], v6 offset:46080
 v_mfma_f32_16x16x32_bf16 v[168:171], a[40:43], v[60:63], v[168:171]
 ds_read_b64_tr_b16 a[4:5], v3 offset:46112
 ds_read_b64_tr_b16 a[6:7], v6 offset:46112
 v_mfma_f32_16x16x32_bf16 v[172:175], a[40:43], v[132:135], v[172:175]
 ds_read_b64_tr_b16 a[8:9], v3 offset:46144
 ds_read_b64_tr_b16 a[10:11], v6 offset:46144
 v_mfma_f32_16x16x32_bf16 v[176:179], a[44:47], v[60:63], v[176:179]
 s_waitcnt lgkmcnt(6)
 v_fma_mix_f32 v248, v64, v240, v232 op_sel_hi:[1,0,0]
 v_fma_mix_f32 v249, v64, v241, v233 op_sel:[1,0,0] op_sel_hi:[1,0,0]
 v_mfma_f32_16x16x32_bf16 v[180:183], a[44:47], v[132:135], v[180:183]
 ds_read_b64_tr_b16 a[12:13], v3 offset:46176
 v_fma_mix_f32 v250, v65, v242, v234 op_sel_hi:[1,0,0]
 v_fma_mix_f32 v251, v65, v243, v235 op_sel:[1,0,0] op_sel_hi:[1,0,0]
 v_mfma_f32_16x16x32_bf16 v[184:187], a[48:51], v[60:63], v[184:187]
 ds_read_b64_tr_b16 a[14:15], v6 offset:46176
 v_fma_mix_f32 v252, v66, v244, v236 op_sel_hi:[1,0,0]
 v_fma_mix_f32 v253, v66, v245, v237 op_sel:[1,0,0] op_sel_hi:[1,0,0]
 v_mfma_f32_16x16x32_bf16 v[188:191], a[48:51], v[132:135], v[188:191]
 ds_read_b64_tr_b16 a[16:17], v3 offset:46208
 v_fma_mix_f32 v254, v67, v246, v238 op_sel_hi:[1,0,0]
 v_fma_mix_f32 v255, v67, v247, v239 op_sel:[1,0,0] op_sel_hi:[1,0,0]
 v_mfma_f32_16x16x32_bf16 v[192:195], a[52:55], v[60:63], v[192:195]
 ds_read_b64_tr_b16 a[18:19], v6 offset:46208
 v_cvt_pk_bf16_f32 v64, v248, v249
 v_cvt_pk_bf16_f32 v65, v250, v251
 v_mfma_f32_16x16x32_bf16 v[196:199], a[52:55], v[132:135], v[196:199]
 ds_read_b64_tr_b16 a[20:21], v3 offset:46240
 v_cvt_pk_bf16_f32 v66, v252, v253
 v_cvt_pk_bf16_f32 v67, v254, v255
 v_mfma_f32_16x16x32_bf16 v[200:203], a[56:59], v[60:63], v[200:203]
 ds_read_b64_tr_b16 a[22:23], v6 offset:46240
 v_fma_mix_f32 v248, v136, v240, v232 op_sel_hi:[1,0,0]
 v_fma_mix_f32 v249, v136, v241, v233 op_sel:[1,0,0] op_sel_hi:[1,0,0]
 v_mfma_f32_16x16x32_bf16 v[204:207], a[56:59], v[132:135], v[204:207]
 ds_read_b64_tr_b16 a[24:25], v3 offset:46272
 v_fma_mix_f32 v250, v137, v242, v234 op_sel_hi:[1,0,0]
 v_fma_mix_f32 v251, v137, v243, v235 op_sel:[1,0,0] op_sel_hi:[1,0,0]
 v_mfma_f32_16x16x32_bf16 v[208:211], a[60:63], v[60:63], v[208:211]
 ds_read_b64_tr_b16 a[26:27], v6 offset:46272
 v_fma_mix_f32 v252, v138, v244, v236 op_sel_hi:[1,0,0]
 v_fma_mix_f32 v253, v138, v245, v237 op_sel:[1,0,0] op_sel_hi:[1,0,0]
 v_mfma_f32_16x16x32_bf16 v[212:215], a[60:63], v[132:135], v[212:215]
 ds_read_b64_tr_b16 a[28:29], v3 offset:46304
 v_fma_mix_f32 v254, v139, v246, v238 op_sel_hi:[1,0,0]
 v_fma_mix_f32 v255, v139, v247, v239 op_sel:[1,0,0] op_sel_hi:[1,0,0]
 v_mfma_f32_16x16x32_bf16 v[216:219], a[64:67], v[60:63], v[216:219]
 ds_read_b64_tr_b16 a[30:31], v6 offset:46304
 v_cvt_pk_bf16_f32 v136, v248, v249
 v_cvt_pk_bf16_f32 v137, v250, v251
 v_mfma_f32_16x16x32_bf16 v[220:223], a[64:67], v[132:135], v[220:223]
 ds_read_b64_tr_b16 a[32:33], v3 offset:46336
 v_cvt_pk_bf16_f32 v138, v252, v253
 v_cvt_pk_bf16_f32 v139, v254, v255
 v_mfma_f32_16x16x32_bf16 v[224:227], a[68:71], v[60:63], v[224:227]
 ds_read_b64_tr_b16 a[34:35], v6 offset:46336
 v_mfma_f32_16x16x32_bf16 v[228:231], a[68:71], v[132:135], v[228:231]
 s_waitcnt lgkmcnt(0)
 v_mfma_f32_16x16x32_bf16 v[160:163], a[0:3], v[64:67], v[160:163]
 ds_read_b128 v[232:235], v8 offset:1664
 ds_read_b128 v[236:239], v8 offset:1680
 ds_read_b128 v[240:243], v8 offset:3968
 ds_read_b128 v[244:247], v8 offset:3984
 v_mfma_f32_16x16x32_bf16 v[164:167], a[0:3], v[136:139], v[164:167]
 ds_read_b64_tr_b16 a[36:37], v3 offset:55296
 ds_read_b64_tr_b16 a[38:39], v6 offset:55296
 v_mfma_f32_16x16x32_bf16 v[168:171], a[4:7], v[64:67], v[168:171]
 ds_read_b64_tr_b16 a[40:41], v3 offset:55328
 ds_read_b64_tr_b16 a[42:43], v6 offset:55328
 v_mfma_f32_16x16x32_bf16 v[172:175], a[4:7], v[136:139], v[172:175]
 ds_read_b64_tr_b16 a[44:45], v3 offset:55360
 ds_read_b64_tr_b16 a[46:47], v6 offset:55360
 v_mfma_f32_16x16x32_bf16 v[176:179], a[8:11], v[64:67], v[176:179]
 s_waitcnt lgkmcnt(6)
 v_fma_mix_f32 v248, v68, v240, v232 op_sel_hi:[1,0,0]
 v_fma_mix_f32 v249, v68, v241, v233 op_sel:[1,0,0] op_sel_hi:[1,0,0]
 v_mfma_f32_16x16x32_bf16 v[180:183], a[8:11], v[136:139], v[180:183]
 ds_read_b64_tr_b16 a[48:49], v3 offset:55392
 v_fma_mix_f32 v250, v69, v242, v234 op_sel_hi:[1,0,0]
 v_fma_mix_f32 v251, v69, v243, v235 op_sel:[1,0,0] op_sel_hi:[1,0,0]
 v_mfma_f32_16x16x32_bf16 v[184:187], a[12:15], v[64:67], v[184:187]
 ds_read_b64_tr_b16 a[50:51], v6 offset:55392
 v_fma_mix_f32 v252, v70, v244, v236 op_sel_hi:[1,0,0]
 v_fma_mix_f32 v253, v70, v245, v237 op_sel:[1,0,0] op_sel_hi:[1,0,0]
 v_mfma_f32_16x16x32_bf16 v[188:191], a[12:15], v[136:139], v[188:191]
 ds_read_b64_tr_b16 a[52:53], v3 offset:55424
 v_fma_mix_f32 v254, v71, v246, v238 op_sel_hi:[1,0,0]
 v_fma_mix_f32 v255, v71, v247, v239 op_sel:[1,0,0] op_sel_hi:[1,0,0]
 v_mfma_f32_16x16x32_bf16 v[192:195], a[16:19], v[64:67], v[192:195]
 ds_read_b64_tr_b16 a[54:55], v6 offset:55424
 v_cvt_pk_bf16_f32 v68, v248, v249
 v_cvt_pk_bf16_f32 v69, v250, v251
 v_mfma_f32_16x16x32_bf16 v[196:199], a[16:19], v[136:139], v[196:199]
 ds_read_b64_tr_b16 a[56:57], v3 offset:55456
 v_cvt_pk_bf16_f32 v70, v252, v253
 v_cvt_pk_bf16_f32 v71, v254, v255
 v_mfma_f32_16x16x32_bf16 v[200:203], a[20:23], v[64:67], v[200:203]
 ds_read_b64_tr_b16 a[58:59], v6 offset:55456
 v_fma_mix_f32 v248, v140, v240, v232 op_sel_hi:[1,0,0]
 v_fma_mix_f32 v249, v140, v241, v233 op_sel:[1,0,0] op_sel_hi:[1,0,0]
 v_mfma_f32_16x16x32_bf16 v[204:207], a[20:23], v[136:139], v[204:207]
 ds_read_b64_tr_b16 a[60:61], v3 offset:55488
 v_fma_mix_f32 v250, v141, v242, v234 op_sel_hi:[1,0,0]
 v_fma_mix_f32 v251, v141, v243, v235 op_sel:[1,0,0] op_sel_hi:[1,0,0]
 v_mfma_f32_16x16x32_bf16 v[208:211], a[24:27], v[64:67], v[208:211]
 ds_read_b64_tr_b16 a[62:63], v6 offset:55488
 v_fma_mix_f32 v252, v142, v244, v236 op_sel_hi:[1,0,0]
 v_fma_mix_f32 v253, v142, v245, v237 op_sel:[1,0,0] op_sel_hi:[1,0,0]
 v_mfma_f32_16x16x32_bf16 v[212:215], a[24:27], v[136:139], v[212:215]
 ds_read_b64_tr_b16 a[64:65], v3 offset:55520
 v_fma_mix_f32 v254, v143, v246, v238 op_sel_hi:[1,0,0]
 v_fma_mix_f32 v255, v143, v247, v239 op_sel:[1,0,0] op_sel_hi:[1,0,0]
 v_mfma_f32_16x16x32_bf16 v[216:219], a[28:31], v[64:67], v[216:219]
 ds_read_b64_tr_b16 a[66:67], v6 offset:55520
 v_cvt_pk_bf16_f32 v140, v248, v249
 v_cvt_pk_bf16_f32 v141, v250, v251
 v_mfma_f32_16x16x32_bf16 v[220:223], a[28:31], v[136:139], v[220:223]
 ds_read_b64_tr_b16 a[68:69], v3 offset:55552
 v_cvt_pk_bf16_f32 v142, v252, v253
 v_cvt_pk_bf16_f32 v143, v254, v255
 v_mfma_f32_16x16x32_bf16 v[224:227], a[32:35], v[64:67], v[224:227]
 ds_read_b64_tr_b16 a[70:71], v6 offset:55552
 v_mfma_f32_16x16x32_bf16 v[228:231], a[32:35], v[136:139], v[228:231]
 s_waitcnt lgkmcnt(0)
 v_mfma_f32_16x16x32_bf16 v[160:163], a[36:39], v[68:71], v[160:163]
 ds_read_b128 v[232:235], v8 offset:1792
 ds_read_b128 v[236:239], v8 offset:1808
 ds_read_b128 v[240:243], v8 offset:4096
 ds_read_b128 v[244:247], v8 offset:4112
 v_mfma_f32_16x16x32_bf16 v[164:167], a[36:39], v[140:143], v[164:167]
 ds_read_b64_tr_b16 a[0:1], v4 offset:0
 ds_read_b64_tr_b16 a[2:3], v7 offset:0
 v_mfma_f32_16x16x32_bf16 v[168:171], a[40:43], v[68:71], v[168:171]
 ds_read_b64_tr_b16 a[4:5], v4 offset:32
 ds_read_b64_tr_b16 a[6:7], v7 offset:32
 v_mfma_f32_16x16x32_bf16 v[172:175], a[40:43], v[140:143], v[172:175]
 ds_read_b64_tr_b16 a[8:9], v4 offset:64
 ds_read_b64_tr_b16 a[10:11], v7 offset:64
 v_mfma_f32_16x16x32_bf16 v[176:179], a[44:47], v[68:71], v[176:179]
 s_waitcnt lgkmcnt(6)
 v_fma_mix_f32 v248, v72, v240, v232 op_sel_hi:[1,0,0]
 v_fma_mix_f32 v249, v72, v241, v233 op_sel:[1,0,0] op_sel_hi:[1,0,0]
 v_mfma_f32_16x16x32_bf16 v[180:183], a[44:47], v[140:143], v[180:183]
 ds_read_b64_tr_b16 a[12:13], v4 offset:96
 v_fma_mix_f32 v250, v73, v242, v234 op_sel_hi:[1,0,0]
 v_fma_mix_f32 v251, v73, v243, v235 op_sel:[1,0,0] op_sel_hi:[1,0,0]
 v_mfma_f32_16x16x32_bf16 v[184:187], a[48:51], v[68:71], v[184:187]
 ds_read_b64_tr_b16 a[14:15], v7 offset:96
 v_fma_mix_f32 v252, v74, v244, v236 op_sel_hi:[1,0,0]
 v_fma_mix_f32 v253, v74, v245, v237 op_sel:[1,0,0] op_sel_hi:[1,0,0]
 v_mfma_f32_16x16x32_bf16 v[188:191], a[48:51], v[140:143], v[188:191]
 ds_read_b64_tr_b16 a[16:17], v4 offset:128
 v_fma_mix_f32 v254, v75, v246, v238 op_sel_hi:[1,0,0]
 v_fma_mix_f32 v255, v75, v247, v239 op_sel:[1,0,0] op_sel_hi:[1,0,0]
 v_mfma_f32_16x16x32_bf16 v[192:195], a[52:55], v[68:71], v[192:195]
 ds_read_b64_tr_b16 a[18:19], v7 offset:128
 v_cvt_pk_bf16_f32 v72, v248, v249
 v_cvt_pk_bf16_f32 v73, v250, v251
 v_mfma_f32_16x16x32_bf16 v[196:199], a[52:55], v[140:143], v[196:199]
 ds_read_b64_tr_b16 a[20:21], v4 offset:160
 v_cvt_pk_bf16_f32 v74, v252, v253
 v_cvt_pk_bf16_f32 v75, v254, v255
 v_mfma_f32_16x16x32_bf16 v[200:203], a[56:59], v[68:71], v[200:203]
 ds_read_b64_tr_b16 a[22:23], v7 offset:160
 v_fma_mix_f32 v248, v144, v240, v232 op_sel_hi:[1,0,0]
 v_fma_mix_f32 v249, v144, v241, v233 op_sel:[1,0,0] op_sel_hi:[1,0,0]
 v_mfma_f32_16x16x32_bf16 v[204:207], a[56:59], v[140:143], v[204:207]
 ds_read_b64_tr_b16 a[24:25], v4 offset:192
 v_fma_mix_f32 v250, v145, v242, v234 op_sel_hi:[1,0,0]
 v_fma_mix_f32 v251, v145, v243, v235 op_sel:[1,0,0] op_sel_hi:[1,0,0]
 v_mfma_f32_16x16x32_bf16 v[208:211], a[60:63], v[68:71], v[208:211]
 ds_read_b64_tr_b16 a[26:27], v7 offset:192
 v_fma_mix_f32 v252, v146, v244, v236 op_sel_hi:[1,0,0]
 v_fma_mix_f32 v253, v146, v245, v237 op_sel:[1,0,0] op_sel_hi:[1,0,0]
 v_mfma_f32_16x16x32_bf16 v[212:215], a[60:63], v[140:143], v[212:215]
 ds_read_b64_tr_b16 a[28:29], v4 offset:224
 v_fma_mix_f32 v254, v147, v246, v238 op_sel_hi:[1,0,0]
 v_fma_mix_f32 v255, v147, v247, v239 op_sel:[1,0,0] op_sel_hi:[1,0,0]
 v_mfma_f32_16x16x32_bf16 v[216:219], a[64:67], v[68:71], v[216:219]
 ds_read_b64_tr_b16 a[30:31], v7 offset:224
 v_cvt_pk_bf16_f32 v144, v248, v249
 v_cvt_pk_bf16_f32 v145, v250, v251
 v_mfma_f32_16x16x32_bf16 v[220:223], a[64:67], v[140:143], v[220:223]
 ds_read_b64_tr_b16 a[32:33], v4 offset:256
 v_cvt_pk_bf16_f32 v146, v252, v253
 v_cvt_pk_bf16_f32 v147, v254, v255
 v_mfma_f32_16x16x32_bf16 v[224:227], a[68:71], v[68:71], v[224:227]
 ds_read_b64_tr_b16 a[34:35], v7 offset:256
 v_mfma_f32_16x16x32_bf16 v[228:231], a[68:71], v[140:143], v[228:231]
 s_waitcnt lgkmcnt(0)
 s_waitcnt vmcnt(0)
 s_barrier
 v_mfma_f32_16x16x32_bf16 v[160:163], a[0:3], v[72:75], v[160:163]
 ds_read_b128 v[232:235], v8 offset:1920
 ds_read_b128 v[236:239], v8 offset:1936
 ds_read_b128 v[240:243], v8 offset:4224
 ds_read_b128 v[244:247], v8 offset:4240
 v_mfma_f32_16x16x32_bf16 v[164:167], a[0:3], v[144:147], v[164:167]
 ds_read_b64_tr_b16 a[36:37], v4 offset:9216
 ds_read_b64_tr_b16 a[38:39], v7 offset:9216
 v_mfma_f32_16x16x32_bf16 v[168:171], a[4:7], v[72:75], v[168:171]
 ds_read_b64_tr_b16 a[40:41], v4 offset:9248
 ds_read_b64_tr_b16 a[42:43], v7 offset:9248
 v_mfma_f32_16x16x32_bf16 v[172:175], a[4:7], v[144:147], v[172:175]
 ds_read_b64_tr_b16 a[44:45], v4 offset:9280
 ds_read_b64_tr_b16 a[46:47], v7 offset:9280
 v_mfma_f32_16x16x32_bf16 v[176:179], a[8:11], v[72:75], v[176:179]
 s_waitcnt lgkmcnt(6)
 v_fma_mix_f32 v248, v76, v240, v232 op_sel_hi:[1,0,0]
 v_fma_mix_f32 v249, v76, v241, v233 op_sel:[1,0,0] op_sel_hi:[1,0,0]
 v_mfma_f32_16x16x32_bf16 v[180:183], a[8:11], v[144:147], v[180:183]
 ds_read_b64_tr_b16 a[48:49], v4 offset:9312
 v_fma_mix_f32 v250, v77, v242, v234 op_sel_hi:[1,0,0]
 v_fma_mix_f32 v251, v77, v243, v235 op_sel:[1,0,0] op_sel_hi:[1,0,0]
 v_mfma_f32_16x16x32_bf16 v[184:187], a[12:15], v[72:75], v[184:187]
 ds_read_b64_tr_b16 a[50:51], v7 offset:9312
 v_fma_mix_f32 v252, v78, v244, v236 op_sel_hi:[1,0,0]
 v_fma_mix_f32 v253, v78, v245, v237 op_sel:[1,0,0] op_sel_hi:[1,0,0]
 v_mfma_f32_16x16x32_bf16 v[188:191], a[12:15], v[144:147], v[188:191]
 ds_read_b64_tr_b16 a[52:53], v4 offset:9344
 v_fma_mix_f32 v254, v79, v246, v238 op_sel_hi:[1,0,0]
 v_fma_mix_f32 v255, v79, v247, v239 op_sel:[1,0,0] op_sel_hi:[1,0,0]
 v_mfma_f32_16x16x32_bf16 v[192:195], a[16:19], v[72:75], v[192:195]
 ds_read_b64_tr_b16 a[54:55], v7 offset:9344
 v_cvt_pk_bf16_f32 v76, v248, v249
 v_cvt_pk_bf16_f32 v77, v250, v251
 v_mfma_f32_16x16x32_bf16 v[196:199], a[16:19], v[144:147], v[196:199]
 ds_read_b64_tr_b16 a[56:57], v4 offset:9376
 v_cvt_pk_bf16_f32 v78, v252, v253
 v_cvt_pk_bf16_f32 v79, v254, v255
 v_mfma_f32_16x16x32_bf16 v[200:203], a[20:23], v[72:75], v[200:203]
 ds_read_b64_tr_b16 a[58:59], v7 offset:9376
 v_fma_mix_f32 v248, v148, v240, v232 op_sel_hi:[1,0,0]
 v_fma_mix_f32 v249, v148, v241, v233 op_sel:[1,0,0] op_sel_hi:[1,0,0]
 v_mfma_f32_16x16x32_bf16 v[204:207], a[20:23], v[144:147], v[204:207]
 ds_read_b64_tr_b16 a[60:61], v4 offset:9408
 v_fma_mix_f32 v250, v149, v242, v234 op_sel_hi:[1,0,0]
 v_fma_mix_f32 v251, v149, v243, v235 op_sel:[1,0,0] op_sel_hi:[1,0,0]
 v_mfma_f32_16x16x32_bf16 v[208:211], a[24:27], v[72:75], v[208:211]
 ds_read_b64_tr_b16 a[62:63], v7 offset:9408
 v_fma_mix_f32 v252, v150, v244, v236 op_sel_hi:[1,0,0]
 v_fma_mix_f32 v253, v150, v245, v237 op_sel:[1,0,0] op_sel_hi:[1,0,0]
 v_mfma_f32_16x16x32_bf16 v[212:215], a[24:27], v[144:147], v[212:215]
 ds_read_b64_tr_b16 a[64:65], v4 offset:9440
 v_fma_mix_f32 v254, v151, v246, v238 op_sel_hi:[1,0,0]
 v_fma_mix_f32 v255, v151, v247, v239 op_sel:[1,0,0] op_sel_hi:[1,0,0]
 v_mfma_f32_16x16x32_bf16 v[216:219], a[28:31], v[72:75], v[216:219]
 ds_read_b64_tr_b16 a[66:67], v7 offset:9440
 v_cvt_pk_bf16_f32 v148, v248, v249
 v_cvt_pk_bf16_f32 v149, v250, v251
 v_mfma_f32_16x16x32_bf16 v[220:223], a[28:31], v[144:147], v[220:223]
 ds_read_b64_tr_b16 a[68:69], v4 offset:9472
 v_cvt_pk_bf16_f32 v150, v252, v253
 v_cvt_pk_bf16_f32 v151, v254, v255
 v_mfma_f32_16x16x32_bf16 v[224:227], a[32:35], v[72:75], v[224:227]
 ds_read_b64_tr_b16 a[70:71], v7 offset:9472
 v_mfma_f32_16x16x32_bf16 v[228:231], a[32:35], v[144:147], v[228:231]
 s_waitcnt lgkmcnt(0)
 v_mfma_f32_16x16x32_bf16 v[160:163], a[36:39], v[76:79], v[160:163]
 ds_read_b128 v[232:235], v8 offset:2048
 ds_read_b128 v[236:239], v8 offset:2064
 ds_read_b128 v[240:243], v8 offset:4352
 ds_read_b128 v[244:247], v8 offset:4368
 v_mfma_f32_16x16x32_bf16 v[164:167], a[36:39], v[148:151], v[164:167]
 ds_read_b64_tr_b16 a[0:1], v2 offset:0
 ds_read_b64_tr_b16 a[2:3], v5 offset:0
 v_mfma_f32_16x16x32_bf16 v[168:171], a[40:43], v[76:79], v[168:171]
 ds_read_b64_tr_b16 a[4:5], v2 offset:32
 ds_read_b64_tr_b16 a[6:7], v5 offset:32
 v_mfma_f32_16x16x32_bf16 v[172:175], a[40:43], v[148:151], v[172:175]
 ds_read_b64_tr_b16 a[8:9], v2 offset:64
 ds_read_b64_tr_b16 a[10:11], v5 offset:64
 v_mfma_f32_16x16x32_bf16 v[176:179], a[44:47], v[76:79], v[176:179]
 s_waitcnt lgkmcnt(6)
 v_fma_mix_f32 v248, v80, v240, v232 op_sel_hi:[1,0,0]
 v_fma_mix_f32 v249, v80, v241, v233 op_sel:[1,0,0] op_sel_hi:[1,0,0]
 v_mfma_f32_16x16x32_bf16 v[180:183], a[44:47], v[148:151], v[180:183]
 ds_read_b64_tr_b16 a[12:13], v2 offset:96
 v_fma_mix_f32 v250, v81, v242, v234 op_sel_hi:[1,0,0]
 v_fma_mix_f32 v251, v81, v243, v235 op_sel:[1,0,0] op_sel_hi:[1,0,0]
 v_mfma_f32_16x16x32_bf16 v[184:187], a[48:51], v[76:79], v[184:187]
 ds_read_b64_tr_b16 a[14:15], v5 offset:96
 v_fma_mix_f32 v252, v82, v244, v236 op_sel_hi:[1,0,0]
 v_fma_mix_f32 v253, v82, v245, v237 op_sel:[1,0,0] op_sel_hi:[1,0,0]
 v_mfma_f32_16x16x32_bf16 v[188:191], a[48:51], v[148:151], v[188:191]
 ds_read_b64_tr_b16 a[16:17], v2 offset:128
 v_fma_mix_f32 v254, v83, v246, v238 op_sel_hi:[1,0,0]
 v_fma_mix_f32 v255, v83, v247, v239 op_sel:[1,0,0] op_sel_hi:[1,0,0]
 v_mfma_f32_16x16x32_bf16 v[192:195], a[52:55], v[76:79], v[192:195]
 ds_read_b64_tr_b16 a[18:19], v5 offset:128
 v_cvt_pk_bf16_f32 v80, v248, v249
 v_cvt_pk_bf16_f32 v81, v250, v251
 v_mfma_f32_16x16x32_bf16 v[196:199], a[52:55], v[148:151], v[196:199]
 ds_read_b64_tr_b16 a[20:21], v2 offset:160
 v_cvt_pk_bf16_f32 v82, v252, v253
 v_cvt_pk_bf16_f32 v83, v254, v255
 v_mfma_f32_16x16x32_bf16 v[200:203], a[56:59], v[76:79], v[200:203]
 ds_read_b64_tr_b16 a[22:23], v5 offset:160
 v_fma_mix_f32 v248, v152, v240, v232 op_sel_hi:[1,0,0]
 v_fma_mix_f32 v249, v152, v241, v233 op_sel:[1,0,0] op_sel_hi:[1,0,0]
 v_mfma_f32_16x16x32_bf16 v[204:207], a[56:59], v[148:151], v[204:207]
 ds_read_b64_tr_b16 a[24:25], v2 offset:192
 v_fma_mix_f32 v250, v153, v242, v234 op_sel_hi:[1,0,0]
 v_fma_mix_f32 v251, v153, v243, v235 op_sel:[1,0,0] op_sel_hi:[1,0,0]
 v_mfma_f32_16x16x32_bf16 v[208:211], a[60:63], v[76:79], v[208:211]
 ds_read_b64_tr_b16 a[26:27], v5 offset:192
 v_fma_mix_f32 v252, v154, v244, v236 op_sel_hi:[1,0,0]
 v_fma_mix_f32 v253, v154, v245, v237 op_sel:[1,0,0] op_sel_hi:[1,0,0]
 v_mfma_f32_16x16x32_bf16 v[212:215], a[60:63], v[148:151], v[212:215]
 ds_read_b64_tr_b16 a[28:29], v2 offset:224
 v_fma_mix_f32 v254, v155, v246, v238 op_sel_hi:[1,0,0]
 v_fma_mix_f32 v255, v155, v247, v239 op_sel:[1,0,0] op_sel_hi:[1,0,0]
 v_mfma_f32_16x16x32_bf16 v[216:219], a[64:67], v[76:79], v[216:219]
 ds_read_b64_tr_b16 a[30:31], v5 offset:224
 v_cvt_pk_bf16_f32 v152, v248, v249
 v_cvt_pk_bf16_f32 v153, v250, v251
 v_mfma_f32_16x16x32_bf16 v[220:223], a[64:67], v[148:151], v[220:223]
 ds_read_b64_tr_b16 a[32:33], v2 offset:256
 v_cvt_pk_bf16_f32 v154, v252, v253
 v_cvt_pk_bf16_f32 v155, v254, v255
 v_mfma_f32_16x16x32_bf16 v[224:227], a[68:71], v[76:79], v[224:227]
 ds_read_b64_tr_b16 a[34:35], v5 offset:256
 v_mfma_f32_16x16x32_bf16 v[228:231], a[68:71], v[148:151], v[228:231]
 s_waitcnt lgkmcnt(0)
 v_mfma_f32_16x16x32_bf16 v[160:163], a[0:3], v[80:83], v[160:163]
 ds_read_b128 v[232:235], v8 offset:2176
 ds_read_b128 v[236:239], v8 offset:2192
 ds_read_b128 v[240:243], v8 offset:4480
 ds_read_b128 v[244:247], v8 offset:4496
 v_mfma_f32_16x16x32_bf16 v[164:167], a[0:3], v[152:155], v[164:167]
 ds_read_b64_tr_b16 a[36:37], v2 offset:9216
 ds_read_b64_tr_b16 a[38:39], v5 offset:9216
 v_mfma_f32_16x16x32_bf16 v[168:171], a[4:7], v[80:83], v[168:171]
 ds_read_b64_tr_b16 a[40:41], v2 offset:9248
 ds_read_b64_tr_b16 a[42:43], v5 offset:9248
 v_mfma_f32_16x16x32_bf16 v[172:175], a[4:7], v[152:155], v[172:175]
 ds_read_b64_tr_b16 a[44:45], v2 offset:9280
 ds_read_b64_tr_b16 a[46:47], v5 offset:9280
 v_mfma_f32_16x16x32_bf16 v[176:179], a[8:11], v[80:83], v[176:179]
 s_waitcnt lgkmcnt(6)
 v_fma_mix_f32 v248, v84, v240, v232 op_sel_hi:[1,0,0]
 v_fma_mix_f32 v249, v84, v241, v233 op_sel:[1,0,0] op_sel_hi:[1,0,0]
 v_mfma_f32_16x16x32_bf16 v[180:183], a[8:11], v[152:155], v[180:183]
 ds_read_b64_tr_b16 a[48:49], v2 offset:9312
 v_fma_mix_f32 v250, v85, v242, v234 op_sel_hi:[1,0,0]
 v_fma_mix_f32 v251, v85, v243, v235 op_sel:[1,0,0] op_sel_hi:[1,0,0]
 v_mfma_f32_16x16x32_bf16 v[184:187], a[12:15], v[80:83], v[184:187]
 ds_read_b64_tr_b16 a[50:51], v5 offset:9312
 v_fma_mix_f32 v252, v86, v244, v236 op_sel_hi:[1,0,0]
 v_fma_mix_f32 v253, v86, v245, v237 op_sel:[1,0,0] op_sel_hi:[1,0,0]
 v_mfma_f32_16x16x32_bf16 v[188:191], a[12:15], v[152:155], v[188:191]
 ds_read_b64_tr_b16 a[52:53], v2 offset:9344
 v_fma_mix_f32 v254, v87, v246, v238 op_sel_hi:[1,0,0]
 v_fma_mix_f32 v255, v87, v247, v239 op_sel:[1,0,0] op_sel_hi:[1,0,0]
 v_mfma_f32_16x16x32_bf16 v[192:195], a[16:19], v[80:83], v[192:195]
 ds_read_b64_tr_b16 a[54:55], v5 offset:9344
 v_cvt_pk_bf16_f32 v84, v248, v249
 v_cvt_pk_bf16_f32 v85, v250, v251
 v_mfma_f32_16x16x32_bf16 v[196:199], a[16:19], v[152:155], v[196:199]
 ds_read_b64_tr_b16 a[56:57], v2 offset:9376
 v_cvt_pk_bf16_f32 v86, v252, v253
 v_cvt_pk_bf16_f32 v87, v254, v255
 v_mfma_f32_16x16x32_bf16 v[200:203], a[20:23], v[80:83], v[200:203]
 ds_read_b64_tr_b16 a[58:59], v5 offset:9376
 v_fma_mix_f32 v248, v156, v240, v232 op_sel_hi:[1,0,0]
 v_fma_mix_f32 v249, v156, v241, v233 op_sel:[1,0,0] op_sel_hi:[1,0,0]
 v_mfma_f32_16x16x32_bf16 v[204:207], a[20:23], v[152:155], v[204:207]
 ds_read_b64_tr_b16 a[60:61], v2 offset:9408
 v_fma_mix_f32 v250, v157, v242, v234 op_sel_hi:[1,0,0]
 v_fma_mix_f32 v251, v157, v243, v235 op_sel:[1,0,0] op_sel_hi:[1,0,0]
 v_mfma_f32_16x16x32_bf16 v[208:211], a[24:27], v[80:83], v[208:211]
 ds_read_b64_tr_b16 a[62:63], v5 offset:9408
 v_fma_mix_f32 v252, v158, v244, v236 op_sel_hi:[1,0,0]
 v_fma_mix_f32 v253, v158, v245, v237 op_sel:[1,0,0] op_sel_hi:[1,0,0]
 v_mfma_f32_16x16x32_bf16 v[212:215], a[24:27], v[152:155], v[212:215]
 ds_read_b64_tr_b16 a[64:65], v2 offset:9440
 v_fma_mix_f32 v254, v159, v246, v238 op_sel_hi:[1,0,0]
 v_fma_mix_f32 v255, v159, v247, v239 op_sel:[1,0,0] op_sel_hi:[1,0,0]
 v_mfma_f32_16x16x32_bf16 v[216:219], a[28:31], v[80:83], v[216:219]
 ds_read_b64_tr_b16 a[66:67], v5 offset:9440
 v_cvt_pk_bf16_f32 v156, v248, v249
 v_cvt_pk_bf16_f32 v157, v250, v251
 v_mfma_f32_16x16x32_bf16 v[220:223], a[28:31], v[152:155], v[220:223]
 ds_read_b64_tr_b16 a[68:69], v2 offset:9472
 v_cvt_pk_bf16_f32 v158, v252, v253
 v_cvt_pk_bf16_f32 v159, v254, v255
 v_mfma_f32_16x16x32_bf16 v[224:227], a[32:35], v[80:83], v[224:227]
 ds_read_b64_tr_b16 a[70:71], v5 offset:9472
 v_mfma_f32_16x16x32_bf16 v[228:231], a[32:35], v[152:155], v[228:231]
 s_waitcnt lgkmcnt(0)
 v_mfma_f32_16x16x32_bf16 v[160:163], a[36:39], v[84:87], v[160:163]
 v_mfma_f32_16x16x32_bf16 v[164:167], a[36:39], v[156:159], v[164:167]
 v_mfma_f32_16x16x32_bf16 v[168:171], a[40:43], v[84:87], v[168:171]
 v_mfma_f32_16x16x32_bf16 v[172:175], a[40:43], v[156:159], v[172:175]
 v_mfma_f32_16x16x32_bf16 v[176:179], a[44:47], v[84:87], v[176:179]
 v_mfma_f32_16x16x32_bf16 v[180:183], a[44:47], v[156:159], v[180:183]
 v_mfma_f32_16x16x32_bf16 v[184:187], a[48:51], v[84:87], v[184:187]
 v_mfma_f32_16x16x32_bf16 v[188:191], a[48:51], v[156:159], v[188:191]
 v_mfma_f32_16x16x32_bf16 v[192:195], a[52:55], v[84:87], v[192:195]
 v_mfma_f32_16x16x32_bf16 v[196:199], a[52:55], v[156:159], v[196:199]
 v_mfma_f32_16x16x32_bf16 v[200:203], a[56:59], v[84:87], v[200:203]
 v_mfma_f32_16x16x32_bf16 v[204:207], a[56:59], v[156:159], v[204:207]
 v_mfma_f32_16x16x32_bf16 v[208:211], a[60:63], v[84:87], v[208:211]
 v_mfma_f32_16x16x32_bf16 v[212:215], a[60:63], v[156:159], v[212:215]
 v_mfma_f32_16x16x32_bf16 v[216:219], a[64:67], v[84:87], v[216:219]
 v_mfma_f32_16x16x32_bf16 v[220:223], a[64:67], v[156:159], v[220:223]
 v_mfma_f32_16x16x32_bf16 v[224:227], a[68:71], v[84:87], v[224:227]
 v_mfma_f32_16x16x32_bf16 v[228:231], a[68:71], v[156:159], v[228:231]
 s_barrier
 s_cmp_lt_u32 s34, 4
 s_cselect_b32 s40, 0x3eae1a93, 1.0
 s_mul_i32 s35, s32, 9472
 v_and_b32 v13, 15, v0
 v_mul_u32_u24 v13, 296, v13
 v_lshrrev_b32 v15, 4, v0
 v_lshlrev_b32 v15, 3, v15
 v_add_u32 v13, v13, v15
 v_add_u32 v13, s35, v13
 v_mul_f32 v160, s40, v160
 v_mul_f32 v161, s40, v161
 v_mul_f32 v162, s40, v162
 v_mul_f32 v163, s40, v163
 v_cvt_pk_bf16_f32 v160, v160, v161
 v_cvt_pk_bf16_f32 v161, v162, v163
 ds_write_b64 v13, v[160:161] offset:0
 v_mul_f32 v164, s40, v164
 v_mul_f32 v165, s40, v165
 v_mul_f32 v166, s40, v166
 v_mul_f32 v167, s40, v167
 v_cvt_pk_bf16_f32 v164, v164, v165
 v_cvt_pk_bf16_f32 v165, v166, v167
 ds_write_b64 v13, v[164:165] offset:4736
 v_mul_f32 v168, s40, v168
 v_mul_f32 v169, s40, v169
 v_mul_f32 v170, s40, v170
 v_mul_f32 v171, s40, v171
 v_cvt_pk_bf16_f32 v168, v168, v169
 v_cvt_pk_bf16_f32 v169, v170, v171
 ds_write_b64 v13, v[168:169] offset:32
 v_mul_f32 v172, s40, v172
 v_mul_f32 v173, s40, v173
 v_mul_f32 v174, s40, v174
 v_mul_f32 v175, s40, v175
 v_cvt_pk_bf16_f32 v172, v172, v173
 v_cvt_pk_bf16_f32 v173, v174, v175
 ds_write_b64 v13, v[172:173] offset:4768
 v_mul_f32 v176, s40, v176
 v_mul_f32 v177, s40, v177
 v_mul_f32 v178, s40, v178
 v_mul_f32 v179, s40, v179
 v_cvt_pk_bf16_f32 v176, v176, v177
 v_cvt_pk_bf16_f32 v177, v178, v179
 ds_write_b64 v13, v[176:177] offset:64
 v_mul_f32 v180, s40, v180
 v_mul_f32 v181, s40, v181
 v_mul_f32 v182, s40, v182
 v_mul_f32 v183, s40, v183
 v_cvt_pk_bf16_f32 v180, v180, v181
 v_cvt_pk_bf16_f32 v181, v182, v183
 ds_write_b64 v13, v[180:181] offset:4800
 v_mul_f32 v184, s40, v184
 v_mul_f32 v185, s40, v185
 v_mul_f32 v186, s40, v186
 v_mul_f32 v187, s40, v187
 v_cvt_pk_bf16_f32 v184, v184, v185
 v_cvt_pk_bf16_f32 v185, v186, v187
 ds_write_b64 v13, v[184:185] offset:96
 v_mul_f32 v188, s40, v188
 v_mul_f32 v189, s40, v189
 v_mul_f32 v190, s40, v190
 v_mul_f32 v191, s40, v191
 v_cvt_pk_bf16_f32 v188, v188, v189
 v_cvt_pk_bf16_f32 v189, v190, v191
 ds_write_b64 v13, v[188:189] offset:4832
 v_mul_f32 v192, s40, v192
 v_mul_f32 v193, s40, v193
 v_mul_f32 v194, s40, v194
 v_mul_f32 v195, s40, v195
 v_cvt_pk_bf16_f32 v192, v192, v193
 v_cvt_pk_bf16_f32 v193, v194, v195
 ds_write_b64 v13, v[192:193] offset:128
 v_mul_f32 v196, s40, v196
 v_mul_f32 v197, s40, v197
 v_mul_f32 v198, s40, v198
 v_mul_f32 v199, s40, v199
 v_cvt_pk_bf16_f32 v196, v196, v197
 v_cvt_pk_bf16_f32 v197, v198, v199
 ds_write_b64 v13, v[196:197] offset:4864
 v_mul_f32 v200, s40, v200
 v_mul_f32 v201, s40, v201
 v_mul_f32 v202, s40, v202
 v_mul_f32 v203, s40, v203
 v_cvt_pk_bf16_f32 v200, v200, v201
 v_cvt_pk_bf16_f32 v201, v202, v203
 ds_write_b64 v13, v[200:201] offset:160
 v_mul_f32 v204, s40, v204
 v_mul_f32 v205, s40, v205
 v_mul_f32 v206, s40, v206
 v_mul_f32 v207, s40, v207
 v_cvt_pk_bf16_f32 v204, v204, v205
 v_cvt_pk_bf16_f32 v205, v206, v207
 ds_write_b64 v13, v[204:205] offset:4896
 v_mul_f32 v208, s40, v208
 v_mul_f32 v209, s40, v209
 v_mul_f32 v210, s40, v210
 v_mul_f32 v211, s40, v211
 v_cvt_pk_bf16_f32 v208, v208, v209
 v_cvt_pk_bf16_f32 v209, v210, v211
 ds_write_b64 v13, v[208:209] offset:192
 v_mul_f32 v212, s40, v212
 v_mul_f32 v213, s40, v213
 v_mul_f32 v214, s40, v214
 v_mul_f32 v215, s40, v215
 v_cvt_pk_bf16_f32 v212, v212, v213
 v_cvt_pk_bf16_f32 v213, v214, v215
 ds_write_b64 v13, v[212:213] offset:4928
 v_mul_f32 v216, s40, v216
 v_mul_f32 v217, s40, v217
 v_mul_f32 v218, s40, v218
 v_mul_f32 v219, s40, v219
 v_cvt_pk_bf16_f32 v216, v216, v217
 v_cvt_pk_bf16_f32 v217, v218, v219
 ds_write_b64 v13, v[216:217] offset:224
 v_mul_f32 v220, s40, v220
 v_mul_f32 v221, s40, v221
 v_mul_f32 v222, s40, v222
 v_mul_f32 v223, s40, v223
 v_cvt_pk_bf16_f32 v220, v220, v221
 v_cvt_pk_bf16_f32 v221, v222, v223
 ds_write_b64 v13, v[220:221] offset:4960
 v_mul_f32 v224, s40, v224
 v_mul_f32 v225, s40, v225
 v_mul_f32 v226, s40, v226
 v_mul_f32 v227, s40, v227
 v_cvt_pk_bf16_f32 v224, v224, v225
 v_cvt_pk_bf16_f32 v225, v226, v227
 ds_write_b64 v13, v[224:225] offset:256
 v_mul_f32 v228, s40, v228
 v_mul_f32 v229, s40, v229
 v_mul_f32 v230, s40, v230
 v_mul_f32 v231, s40, v231
 v_cvt_pk_bf16_f32 v228, v228, v229
 v_cvt_pk_bf16_f32 v229, v230, v231
 ds_write_b64 v13, v[228:229] offset:4992
 s_waitcnt lgkmcnt(0)
 v_and_b32 v13, 31, v0
 v_mul_u32_u24 v15, 296, v13
 v_lshrrev_b32 v14, 5, v0
 v_lshlrev_b32 v14, 4, v14
 v_add_u32 v15, v15, v14
 v_add_u32 v15, s35, v15
 v_mul_u32_u24 v14, 296, v13
 v_add_u32 v14, s35, v14
 ds_read2_b32 v[16:17], v15 offset0:0 offset1:1
 ds_read2_b32 v[18:19], v15 offset0:2 offset1:3
 ds_read_b32 v20, v14 offset:32
 ds_read2_b32 v[24:25], v15 offset0:9 offset1:10
 ds_read2_b32 v[26:27], v15 offset0:11 offset1:12
 ds_read_b32 v28, v14 offset:68
 ds_read2_b32 v[32:33], v15 offset0:18 offset1:19
 ds_read2_b32 v[34:35], v15 offset0:20 offset1:21
 ds_read_b32 v36, v14 offset:104
 ds_read2_b32 v[40:41], v15 offset0:27 offset1:28
 ds_read2_b32 v[42:43], v15 offset0:29 offset1:30
 ds_read_b32 v44, v14 offset:140
 ds_read2_b32 v[48:49], v15 offset0:36 offset1:37
 ds_read2_b32 v[50:51], v15 offset0:38 offset1:39
 ds_read_b32 v52, v14 offset:176
 ds_read2_b32 v[56:57], v15 offset0:45 offset1:46
 ds_read2_b32 v[58:59], v15 offset0:47 offset1:48
 ds_read_b32 v60, v14 offset:212
 ds_read2_b32 v[64:65], v15 offset0:54 offset1:55
 ds_read2_b32 v[66:67], v15 offset0:56 offset1:57
 ds_read_b32 v68, v14 offset:248
 ds_read2_b32 v[72:73], v15 offset0:63 offset1:64
 ds_read2_b32 v[74:75], v15 offset0:65 offset1:66
 ds_read_b32 v76, v14 offset:284
 v_mov_b32 v11, 0x7fffffff
 v_cmp_gt_u32 vcc, 32, v0
 s_and_b32 s39, s34, 3
 s_lshl_b32 s39, s39, 3
 s_cmp_lt_u32 s34, 4
 s_cbranch_scc0 L_k01_kout
 v_lshlrev_b32 v10, 2, v13
 v_cndmask_b32 v10, v11, v10, vcc
 s_lshl_b32 s35, s39, 6
 s_add_u32 s35, s35, s38
 s_waitcnt lgkmcnt(0)
 s_add_u32 s36, s35, 0
 s_lshl_b32 s37, s36, 10
 buffer_store_dwordx4 v[16:19], v1, s[24:27], s37 offen
 s_lshl_b32 s37, s36, 7
 buffer_store_dword v20, v10, s[28:31], s37 offen
 s_add_u32 s36, s35, 64
 s_lshl_b32 s37, s36, 10
 buffer_store_dwordx4 v[24:27], v1, s[24:27], s37 offen
 s_lshl_b32 s37, s36, 7
 buffer_store_dword v28, v10, s[28:31], s37 offen
 s_add_u32 s36, s35, 128
 s_lshl_b32 s37, s36, 10
 buffer_store_dwordx4 v[32:35], v1, s[24:27], s37 offen
 s_lshl_b32 s37, s36, 7
 buffer_store_dword v36, v10, s[28:31], s37 offen
 s_add_u32 s36, s35, 192
 s_lshl_b32 s37, s36, 10
 buffer_store_dwordx4 v[40:43], v1, s[24:27], s37 offen
 s_lshl_b32 s37, s36, 7
 buffer_store_dword v44, v10, s[28:31], s37 offen
 s_add_u32 s36, s35, 256
 s_lshl_b32 s37, s36, 10
 buffer_store_dwordx4 v[48:51], v1, s[24:27], s37 offen
 s_lshl_b32 s37, s36, 7
 buffer_store_dword v52, v10, s[28:31], s37 offen
 s_add_u32 s36, s35, 320
 s_lshl_b32 s37, s36, 10
 buffer_store_dwordx4 v[56:59], v1, s[24:27], s37 offen
 s_lshl_b32 s37, s36, 7
 buffer_store_dword v60, v10, s[28:31], s37 offen
 s_add_u32 s36, s35, 384
 s_lshl_b32 s37, s36, 10
 buffer_store_dwordx4 v[64:67], v1, s[24:27], s37 offen
 s_lshl_b32 s37, s36, 7
 buffer_store_dword v68, v10, s[28:31], s37 offen
 s_add_u32 s36, s35, 448
 s_lshl_b32 s37, s36, 10
 buffer_store_dwordx4 v[72:75], v1, s[24:27], s37 offen
 s_lshl_b32 s37, s36, 7
 buffer_store_dword v76, v10, s[28:31], s37 offen
 s_branch L_k01_fin
L_k01_kout:
 v_lshlrev_b32 v10, 4, v13
 v_cndmask_b32 v10, v11, v10, vcc
 s_mul_i32 s35, s39, 151552
 s_lshl_b32 s36, s38, 10
 s_add_u32 s36, s36, s35
 s_lshl_b32 s37, s33, 9
 s_add_u32 s35, s35, s37
 s_lshl_b32 s37, s32, 2
 s_add_u32 s35, s35, s37
 s_add_u32 s35, s35, 65536
 s_waitcnt lgkmcnt(0)
 buffer_store_dwordx4 v[16:19], v1, s[44:47], s36 offen
 buffer_store_dword v20, v10, s[44:47], s35 offen
 s_add_u32 s36, s36, 151552
 s_add_u32 s35, s35, 151552
 buffer_store_dwordx4 v[24:27], v1, s[44:47], s36 offen
 buffer_store_dword v28, v10, s[44:47], s35 offen
 s_add_u32 s36, s36, 151552
 s_add_u32 s35, s35, 151552
 buffer_store_dwordx4 v[32:35], v1, s[44:47], s36 offen
 buffer_store_dword v36, v10, s[44:47], s35 offen
 s_add_u32 s36, s36, 151552
 s_add_u32 s35, s35, 151552
 buffer_store_dwordx4 v[40:43], v1, s[44:47], s36 offen
 buffer_store_dword v44, v10, s[44:47], s35 offen
 s_add_u32 s36, s36, 151552
 s_add_u32 s35, s35, 151552
 buffer_store_dwordx4 v[48:51], v1, s[44:47], s36 offen
 buffer_store_dword v52, v10, s[44:47], s35 offen
 s_add_u32 s36, s36, 151552
 s_add_u32 s35, s35, 151552
 buffer_store_dwordx4 v[56:59], v1, s[44:47], s36 offen
 buffer_store_dword v60, v10, s[44:47], s35 offen
 s_add_u32 s36, s36, 151552
 s_add_u32 s35, s35, 151552
 buffer_store_dwordx4 v[64:67], v1, s[44:47], s36 offen
 buffer_store_dword v68, v10, s[44:47], s35 offen
 s_add_u32 s36, s36, 151552
 s_add_u32 s35, s35, 151552
 buffer_store_dwordx4 v[72:75], v1, s[44:47], s36 offen
 buffer_store_dword v76, v10, s[44:47], s35 offen
 s_branch L_k01_fin
L_k01_v:
 ds_read_b128 v[232:235], v8 offset:0
 ds_read_b128 v[236:239], v8 offset:16
 ds_read_b128 v[240:243], v8 offset:2304
 ds_read_b128 v[244:247], v8 offset:2320
 ds_read_b64_tr_b16 a[0:1], v2 offset:0
 ds_read_b64_tr_b16 a[2:3], v5 offset:0
 ds_read_b64_tr_b16 a[4:5], v2 offset:32
 ds_read_b64_tr_b16 a[6:7], v5 offset:32
 ds_read_b64_tr_b16 a[8:9], v2 offset:64
 ds_read_b64_tr_b16 a[10:11], v5 offset:64
 ds_read_b64_tr_b16 a[12:13], v2 offset:96
 ds_read_b64_tr_b16 a[14:15], v5 offset:96
 ds_read_b64_tr_b16 a[16:17], v2 offset:128
 ds_read_b64_tr_b16 a[18:19], v5 offset:128
 ds_read_b64_tr_b16 a[20:21], v2 offset:160
 ds_read_b64_tr_b16 a[22:23], v5 offset:160
 ds_read_b64_tr_b16 a[24:25], v2 offset:192
 ds_read_b64_tr_b16 a[26:27], v5 offset:192
 ds_read_b64_tr_b16 a[28:29], v2 offset:224
 ds_read_b64_tr_b16 a[30:31], v5 offset:224
 ds_read_b64_tr_b16 a[32:33], v2 offset:256
 ds_read_b64_tr_b16 a[34:35], v5 offset:256
 s_waitcnt lgkmcnt(0)
 v_fma_mix_f32 v248, v16, v240, v232 op_sel_hi:[1,0,0]
 v_fma_mix_f32 v249, v16, v241, v233 op_sel:[1,0,0] op_sel_hi:[1,0,0]
 v_fma_mix_f32 v250, v17, v242, v234 op_sel_hi:[1,0,0]
 v_fma_mix_f32 v251, v17, v243, v235 op_sel:[1,0,0] op_sel_hi:[1,0,0]
 v_fma_mix_f32 v252, v18, v244, v236 op_sel_hi:[1,0,0]
 v_fma_mix_f32 v253, v18, v245, v237 op_sel:[1,0,0] op_sel_hi:[1,0,0]
 v_fma_mix_f32 v254, v19, v246, v238 op_sel_hi:[1,0,0]
 v_fma_mix_f32 v255, v19, v247, v239 op_sel:[1,0,0] op_sel_hi:[1,0,0]
 v_cvt_pk_bf16_f32 v16, v248, v249
 v_cvt_pk_bf16_f32 v17, v250, v251
 v_cvt_pk_bf16_f32 v18, v252, v253
 v_cvt_pk_bf16_f32 v19, v254, v255
 v_fma_mix_f32 v248, v88, v240, v232 op_sel_hi:[1,0,0]
 v_fma_mix_f32 v249, v88, v241, v233 op_sel:[1,0,0] op_sel_hi:[1,0,0]
 v_fma_mix_f32 v250, v89, v242, v234 op_sel_hi:[1,0,0]
 v_fma_mix_f32 v251, v89, v243, v235 op_sel:[1,0,0] op_sel_hi:[1,0,0]
 v_fma_mix_f32 v252, v90, v244, v236 op_sel_hi:[1,0,0]
 v_fma_mix_f32 v253, v90, v245, v237 op_sel:[1,0,0] op_sel_hi:[1,0,0]
 v_fma_mix_f32 v254, v91, v246, v238 op_sel_hi:[1,0,0]
 v_fma_mix_f32 v255, v91, v247, v239 op_sel:[1,0,0] op_sel_hi:[1,0,0]
 v_cvt_pk_bf16_f32 v88, v248, v249
 v_cvt_pk_bf16_f32 v89, v250, v251
 v_cvt_pk_bf16_f32 v90, v252, v253
 v_cvt_pk_bf16_f32 v91, v254, v255
 s_waitcnt lgkmcnt(0)
 v_mfma_f32_16x16x32_bf16 v[160:163], v[16:19], a[0:3], 0
 ds_read_b128 v[232:235], v8 offset:128
 ds_read_b128 v[236:239], v8 offset:144
 ds_read_b128 v[240:243], v8 offset:2432
 ds_read_b128 v[244:247], v8 offset:2448
 v_mfma_f32_16x16x32_bf16 v[164:167], v[88:91], a[0:3], 0
 ds_read_b64_tr_b16 a[36:37], v2 offset:9216
 ds_read_b64_tr_b16 a[38:39], v5 offset:9216
 v_mfma_f32_16x16x32_bf16 v[168:171], v[16:19], a[4:7], 0
 ds_read_b64_tr_b16 a[40:41], v2 offset:9248
 ds_read_b64_tr_b16 a[42:43], v5 offset:9248
 v_mfma_f32_16x16x32_bf16 v[172:175], v[88:91], a[4:7], 0
 ds_read_b64_tr_b16 a[44:45], v2 offset:9280
 ds_read_b64_tr_b16 a[46:47], v5 offset:9280
 v_mfma_f32_16x16x32_bf16 v[176:179], v[16:19], a[8:11], 0
 s_waitcnt lgkmcnt(6)
 v_fma_mix_f32 v248, v20, v240, v232 op_sel_hi:[1,0,0]
 v_fma_mix_f32 v249, v20, v241, v233 op_sel:[1,0,0] op_sel_hi:[1,0,0]
 v_mfma_f32_16x16x32_bf16 v[180:183], v[88:91], a[8:11], 0
 ds_read_b64_tr_b16 a[48:49], v2 offset:9312
 v_fma_mix_f32 v250, v21, v242, v234 op_sel_hi:[1,0,0]
 v_fma_mix_f32 v251, v21, v243, v235 op_sel:[1,0,0] op_sel_hi:[1,0,0]
 v_mfma_f32_16x16x32_bf16 v[184:187], v[16:19], a[12:15], 0
 ds_read_b64_tr_b16 a[50:51], v5 offset:9312
 v_fma_mix_f32 v252, v22, v244, v236 op_sel_hi:[1,0,0]
 v_fma_mix_f32 v253, v22, v245, v237 op_sel:[1,0,0] op_sel_hi:[1,0,0]
 v_mfma_f32_16x16x32_bf16 v[188:191], v[88:91], a[12:15], 0
 ds_read_b64_tr_b16 a[52:53], v2 offset:9344
 v_fma_mix_f32 v254, v23, v246, v238 op_sel_hi:[1,0,0]
 v_fma_mix_f32 v255, v23, v247, v239 op_sel:[1,0,0] op_sel_hi:[1,0,0]
 v_mfma_f32_16x16x32_bf16 v[192:195], v[16:19], a[16:19], 0
 ds_read_b64_tr_b16 a[54:55], v5 offset:9344
 v_cvt_pk_bf16_f32 v20, v248, v249
 v_cvt_pk_bf16_f32 v21, v250, v251
 v_mfma_f32_16x16x32_bf16 v[196:199], v[88:91], a[16:19], 0
 ds_read_b64_tr_b16 a[56:57], v2 offset:9376
 v_cvt_pk_bf16_f32 v22, v252, v253
 v_cvt_pk_bf16_f32 v23, v254, v255
 v_mfma_f32_16x16x32_bf16 v[200:203], v[16:19], a[20:23], 0
 ds_read_b64_tr_b16 a[58:59], v5 offset:9376
 v_fma_mix_f32 v248, v92, v240, v232 op_sel_hi:[1,0,0]
 v_fma_mix_f32 v249, v92, v241, v233 op_sel:[1,0,0] op_sel_hi:[1,0,0]
 v_mfma_f32_16x16x32_bf16 v[204:207], v[88:91], a[20:23], 0
 ds_read_b64_tr_b16 a[60:61], v2 offset:9408
 v_fma_mix_f32 v250, v93, v242, v234 op_sel_hi:[1,0,0]
 v_fma_mix_f32 v251, v93, v243, v235 op_sel:[1,0,0] op_sel_hi:[1,0,0]
 v_mfma_f32_16x16x32_bf16 v[208:211], v[16:19], a[24:27], 0
 ds_read_b64_tr_b16 a[62:63], v5 offset:9408
 v_fma_mix_f32 v252, v94, v244, v236 op_sel_hi:[1,0,0]
 v_fma_mix_f32 v253, v94, v245, v237 op_sel:[1,0,0] op_sel_hi:[1,0,0]
 v_mfma_f32_16x16x32_bf16 v[212:215], v[88:91], a[24:27], 0
 ds_read_b64_tr_b16 a[64:65], v2 offset:9440
 v_fma_mix_f32 v254, v95, v246, v238 op_sel_hi:[1,0,0]
 v_fma_mix_f32 v255, v95, v247, v239 op_sel:[1,0,0] op_sel_hi:[1,0,0]
 v_mfma_f32_16x16x32_bf16 v[216:219], v[16:19], a[28:31], 0
 ds_read_b64_tr_b16 a[66:67], v5 offset:9440
 v_cvt_pk_bf16_f32 v92, v248, v249
 v_cvt_pk_bf16_f32 v93, v250, v251
 v_mfma_f32_16x16x32_bf16 v[220:223], v[88:91], a[28:31], 0
 ds_read_b64_tr_b16 a[68:69], v2 offset:9472
 v_cvt_pk_bf16_f32 v94, v252, v253
 v_cvt_pk_bf16_f32 v95, v254, v255
 v_mfma_f32_16x16x32_bf16 v[224:227], v[16:19], a[32:35], 0
 ds_read_b64_tr_b16 a[70:71], v5 offset:9472
 v_mfma_f32_16x16x32_bf16 v[228:231], v[88:91], a[32:35], 0
 s_waitcnt lgkmcnt(0)
 v_mfma_f32_16x16x32_bf16 v[160:163], v[20:23], a[36:39], v[160:163]
 ds_read_b128 v[232:235], v8 offset:256
 ds_read_b128 v[236:239], v8 offset:272
 ds_read_b128 v[240:243], v8 offset:2560
 ds_read_b128 v[244:247], v8 offset:2576
 v_mfma_f32_16x16x32_bf16 v[164:167], v[92:95], a[36:39], v[164:167]
 ds_read_b64_tr_b16 a[0:1], v2 offset:18432
 ds_read_b64_tr_b16 a[2:3], v5 offset:18432
 v_mfma_f32_16x16x32_bf16 v[168:171], v[20:23], a[40:43], v[168:171]
 ds_read_b64_tr_b16 a[4:5], v2 offset:18464
 ds_read_b64_tr_b16 a[6:7], v5 offset:18464
 v_mfma_f32_16x16x32_bf16 v[172:175], v[92:95], a[40:43], v[172:175]
 ds_read_b64_tr_b16 a[8:9], v2 offset:18496
 ds_read_b64_tr_b16 a[10:11], v5 offset:18496
 v_mfma_f32_16x16x32_bf16 v[176:179], v[20:23], a[44:47], v[176:179]
 s_waitcnt lgkmcnt(6)
 v_fma_mix_f32 v248, v24, v240, v232 op_sel_hi:[1,0,0]
 v_fma_mix_f32 v249, v24, v241, v233 op_sel:[1,0,0] op_sel_hi:[1,0,0]
 v_mfma_f32_16x16x32_bf16 v[180:183], v[92:95], a[44:47], v[180:183]
 ds_read_b64_tr_b16 a[12:13], v2 offset:18528
 v_fma_mix_f32 v250, v25, v242, v234 op_sel_hi:[1,0,0]
 v_fma_mix_f32 v251, v25, v243, v235 op_sel:[1,0,0] op_sel_hi:[1,0,0]
 v_mfma_f32_16x16x32_bf16 v[184:187], v[20:23], a[48:51], v[184:187]
 ds_read_b64_tr_b16 a[14:15], v5 offset:18528
 v_fma_mix_f32 v252, v26, v244, v236 op_sel_hi:[1,0,0]
 v_fma_mix_f32 v253, v26, v245, v237 op_sel:[1,0,0] op_sel_hi:[1,0,0]
 v_mfma_f32_16x16x32_bf16 v[188:191], v[92:95], a[48:51], v[188:191]
 ds_read_b64_tr_b16 a[16:17], v2 offset:18560
 v_fma_mix_f32 v254, v27, v246, v238 op_sel_hi:[1,0,0]
 v_fma_mix_f32 v255, v27, v247, v239 op_sel:[1,0,0] op_sel_hi:[1,0,0]
 v_mfma_f32_16x16x32_bf16 v[192:195], v[20:23], a[52:55], v[192:195]
 ds_read_b64_tr_b16 a[18:19], v5 offset:18560
 v_cvt_pk_bf16_f32 v24, v248, v249
 v_cvt_pk_bf16_f32 v25, v250, v251
 v_mfma_f32_16x16x32_bf16 v[196:199], v[92:95], a[52:55], v[196:199]
 ds_read_b64_tr_b16 a[20:21], v2 offset:18592
 v_cvt_pk_bf16_f32 v26, v252, v253
 v_cvt_pk_bf16_f32 v27, v254, v255
 v_mfma_f32_16x16x32_bf16 v[200:203], v[20:23], a[56:59], v[200:203]
 ds_read_b64_tr_b16 a[22:23], v5 offset:18592
 v_fma_mix_f32 v248, v96, v240, v232 op_sel_hi:[1,0,0]
 v_fma_mix_f32 v249, v96, v241, v233 op_sel:[1,0,0] op_sel_hi:[1,0,0]
 v_mfma_f32_16x16x32_bf16 v[204:207], v[92:95], a[56:59], v[204:207]
 ds_read_b64_tr_b16 a[24:25], v2 offset:18624
 v_fma_mix_f32 v250, v97, v242, v234 op_sel_hi:[1,0,0]
 v_fma_mix_f32 v251, v97, v243, v235 op_sel:[1,0,0] op_sel_hi:[1,0,0]
 v_mfma_f32_16x16x32_bf16 v[208:211], v[20:23], a[60:63], v[208:211]
 ds_read_b64_tr_b16 a[26:27], v5 offset:18624
 v_fma_mix_f32 v252, v98, v244, v236 op_sel_hi:[1,0,0]
 v_fma_mix_f32 v253, v98, v245, v237 op_sel:[1,0,0] op_sel_hi:[1,0,0]
 v_mfma_f32_16x16x32_bf16 v[212:215], v[92:95], a[60:63], v[212:215]
 ds_read_b64_tr_b16 a[28:29], v2 offset:18656
 v_fma_mix_f32 v254, v99, v246, v238 op_sel_hi:[1,0,0]
 v_fma_mix_f32 v255, v99, v247, v239 op_sel:[1,0,0] op_sel_hi:[1,0,0]
 v_mfma_f32_16x16x32_bf16 v[216:219], v[20:23], a[64:67], v[216:219]
 ds_read_b64_tr_b16 a[30:31], v5 offset:18656
 v_cvt_pk_bf16_f32 v96, v248, v249
 v_cvt_pk_bf16_f32 v97, v250, v251
 v_mfma_f32_16x16x32_bf16 v[220:223], v[92:95], a[64:67], v[220:223]
 ds_read_b64_tr_b16 a[32:33], v2 offset:18688
 v_cvt_pk_bf16_f32 v98, v252, v253
 v_cvt_pk_bf16_f32 v99, v254, v255
 v_mfma_f32_16x16x32_bf16 v[224:227], v[20:23], a[68:71], v[224:227]
 ds_read_b64_tr_b16 a[34:35], v5 offset:18688
 v_mfma_f32_16x16x32_bf16 v[228:231], v[92:95], a[68:71], v[228:231]
 s_waitcnt lgkmcnt(0)
 s_barrier
 s_cmp_lt_u32 s32, 2
 s_cbranch_scc0 L_k01_nodma_v
 v_accvgpr_read_b32 v248, a72
 s_add_u32 m0, s39, 0
 s_add_u32 s35, s37, 1769472
 buffer_load_dwordx4 v248, s[12:15], s35 offen lds
 v_accvgpr_read_b32 v249, a73
 s_add_u32 m0, s39, 1024
 s_add_u32 s35, s37, 1769472
 buffer_load_dwordx4 v249, s[12:15], s35 offen lds
 v_accvgpr_read_b32 v250, a74
 s_add_u32 m0, s39, 2048
 s_add_u32 s35, s37, 1769472
 buffer_load_dwordx4 v250, s[12:15], s35 offen lds
 v_accvgpr_read_b32 v251, a75
 s_add_u32 m0, s39, 3072
 s_add_u32 s35, s37, 1769472
 buffer_load_dwordx4 v251, s[12:15], s35 offen lds
 v_accvgpr_read_b32 v248, a76
 s_add_u32 m0, s39, 4096
 s_add_u32 s35, s37, 1769472
 buffer_load_dwordx4 v248, s[12:15], s35 offen lds
 v_accvgpr_read_b32 v249, a77
 s_add_u32 m0, s39, 5120
 s_add_u32 s35, s37, 1769472
 buffer_load_dwordx4 v249, s[12:15], s35 offen lds
 v_accvgpr_read_b32 v250, a78
 s_add_u32 m0, s39, 6144
 s_add_u32 s35, s37, 1769472
 buffer_load_dwordx4 v250, s[12:15], s35 offen lds
 v_accvgpr_read_b32 v251, a79
 s_add_u32 m0, s39, 7168
 s_add_u32 s35, s37, 1769472
 buffer_load_dwordx4 v251, s[12:15], s35 offen lds
 v_accvgpr_read_b32 v248, a80
 s_add_u32 m0, s39, 8192
 s_add_u32 s35, s37, 1769472
 buffer_load_dwordx4 v248, s[12:15], s35 offen lds
L_k01_nodma_v:
 v_mfma_f32_16x16x32_bf16 v[160:163], v[24:27], a[0:3], v[160:163]
 ds_read_b128 v[232:235], v8 offset:384
 ds_read_b128 v[236:239], v8 offset:400
 ds_read_b128 v[240:243], v8 offset:2688
 ds_read_b128 v[244:247], v8 offset:2704
 v_mfma_f32_16x16x32_bf16 v[164:167], v[96:99], a[0:3], v[164:167]
 ds_read_b64_tr_b16 a[36:37], v2 offset:27648
 ds_read_b64_tr_b16 a[38:39], v5 offset:27648
 v_mfma_f32_16x16x32_bf16 v[168:171], v[24:27], a[4:7], v[168:171]
 ds_read_b64_tr_b16 a[40:41], v2 offset:27680
 ds_read_b64_tr_b16 a[42:43], v5 offset:27680
 v_mfma_f32_16x16x32_bf16 v[172:175], v[96:99], a[4:7], v[172:175]
 ds_read_b64_tr_b16 a[44:45], v2 offset:27712
 ds_read_b64_tr_b16 a[46:47], v5 offset:27712
 v_mfma_f32_16x16x32_bf16 v[176:179], v[24:27], a[8:11], v[176:179]
 s_waitcnt lgkmcnt(6)
 v_fma_mix_f32 v248, v28, v240, v232 op_sel_hi:[1,0,0]
 v_fma_mix_f32 v249, v28, v241, v233 op_sel:[1,0,0] op_sel_hi:[1,0,0]
 v_mfma_f32_16x16x32_bf16 v[180:183], v[96:99], a[8:11], v[180:183]
 ds_read_b64_tr_b16 a[48:49], v2 offset:27744
 v_fma_mix_f32 v250, v29, v242, v234 op_sel_hi:[1,0,0]
 v_fma_mix_f32 v251, v29, v243, v235 op_sel:[1,0,0] op_sel_hi:[1,0,0]
 v_mfma_f32_16x16x32_bf16 v[184:187], v[24:27], a[12:15], v[184:187]
 ds_read_b64_tr_b16 a[50:51], v5 offset:27744
 v_fma_mix_f32 v252, v30, v244, v236 op_sel_hi:[1,0,0]
 v_fma_mix_f32 v253, v30, v245, v237 op_sel:[1,0,0] op_sel_hi:[1,0,0]
 v_mfma_f32_16x16x32_bf16 v[188:191], v[96:99], a[12:15], v[188:191]
 ds_read_b64_tr_b16 a[52:53], v2 offset:27776
 v_fma_mix_f32 v254, v31, v246, v238 op_sel_hi:[1,0,0]
 v_fma_mix_f32 v255, v31, v247, v239 op_sel:[1,0,0] op_sel_hi:[1,0,0]
 v_mfma_f32_16x16x32_bf16 v[192:195], v[24:27], a[16:19], v[192:195]
 ds_read_b64_tr_b16 a[54:55], v5 offset:27776
 v_cvt_pk_bf16_f32 v28, v248, v249
 v_cvt_pk_bf16_f32 v29, v250, v251
 v_mfma_f32_16x16x32_bf16 v[196:199], v[96:99], a[16:19], v[196:199]
 ds_read_b64_tr_b16 a[56:57], v2 offset:27808
 v_cvt_pk_bf16_f32 v30, v252, v253
 v_cvt_pk_bf16_f32 v31, v254, v255
 v_mfma_f32_16x16x32_bf16 v[200:203], v[24:27], a[20:23], v[200:203]
 ds_read_b64_tr_b16 a[58:59], v5 offset:27808
 v_fma_mix_f32 v248, v100, v240, v232 op_sel_hi:[1,0,0]
 v_fma_mix_f32 v249, v100, v241, v233 op_sel:[1,0,0] op_sel_hi:[1,0,0]
 v_mfma_f32_16x16x32_bf16 v[204:207], v[96:99], a[20:23], v[204:207]
 ds_read_b64_tr_b16 a[60:61], v2 offset:27840
 v_fma_mix_f32 v250, v101, v242, v234 op_sel_hi:[1,0,0]
 v_fma_mix_f32 v251, v101, v243, v235 op_sel:[1,0,0] op_sel_hi:[1,0,0]
 v_mfma_f32_16x16x32_bf16 v[208:211], v[24:27], a[24:27], v[208:211]
 ds_read_b64_tr_b16 a[62:63], v5 offset:27840
 v_fma_mix_f32 v252, v102, v244, v236 op_sel_hi:[1,0,0]
 v_fma_mix_f32 v253, v102, v245, v237 op_sel:[1,0,0] op_sel_hi:[1,0,0]
 v_mfma_f32_16x16x32_bf16 v[212:215], v[96:99], a[24:27], v[212:215]
 ds_read_b64_tr_b16 a[64:65], v2 offset:27872
 v_fma_mix_f32 v254, v103, v246, v238 op_sel_hi:[1,0,0]
 v_fma_mix_f32 v255, v103, v247, v239 op_sel:[1,0,0] op_sel_hi:[1,0,0]
 v_mfma_f32_16x16x32_bf16 v[216:219], v[24:27], a[28:31], v[216:219]
 ds_read_b64_tr_b16 a[66:67], v5 offset:27872
 v_cvt_pk_bf16_f32 v100, v248, v249
 v_cvt_pk_bf16_f32 v101, v250, v251
 v_mfma_f32_16x16x32_bf16 v[220:223], v[96:99], a[28:31], v[220:223]
 ds_read_b64_tr_b16 a[68:69], v2 offset:27904
 v_cvt_pk_bf16_f32 v102, v252, v253
 v_cvt_pk_bf16_f32 v103, v254, v255
 v_mfma_f32_16x16x32_bf16 v[224:227], v[24:27], a[32:35], v[224:227]
 ds_read_b64_tr_b16 a[70:71], v5 offset:27904
 v_mfma_f32_16x16x32_bf16 v[228:231], v[96:99], a[32:35], v[228:231]
 s_waitcnt lgkmcnt(0)
 v_mfma_f32_16x16x32_bf16 v[160:163], v[28:31], a[36:39], v[160:163]
 ds_read_b128 v[232:235], v8 offset:512
 ds_read_b128 v[236:239], v8 offset:528
 ds_read_b128 v[240:243], v8 offset:2816
 ds_read_b128 v[244:247], v8 offset:2832
 v_mfma_f32_16x16x32_bf16 v[164:167], v[100:103], a[36:39], v[164:167]
 ds_read_b64_tr_b16 a[0:1], v2 offset:36864
 ds_read_b64_tr_b16 a[2:3], v5 offset:36864
 v_mfma_f32_16x16x32_bf16 v[168:171], v[28:31], a[40:43], v[168:171]
 ds_read_b64_tr_b16 a[4:5], v2 offset:36896
 ds_read_b64_tr_b16 a[6:7], v5 offset:36896
 v_mfma_f32_16x16x32_bf16 v[172:175], v[100:103], a[40:43], v[172:175]
 ds_read_b64_tr_b16 a[8:9], v2 offset:36928
 ds_read_b64_tr_b16 a[10:11], v5 offset:36928
 v_mfma_f32_16x16x32_bf16 v[176:179], v[28:31], a[44:47], v[176:179]
 s_waitcnt lgkmcnt(6)
 v_fma_mix_f32 v248, v32, v240, v232 op_sel_hi:[1,0,0]
 v_fma_mix_f32 v249, v32, v241, v233 op_sel:[1,0,0] op_sel_hi:[1,0,0]
 v_mfma_f32_16x16x32_bf16 v[180:183], v[100:103], a[44:47], v[180:183]
 ds_read_b64_tr_b16 a[12:13], v2 offset:36960
 v_fma_mix_f32 v250, v33, v242, v234 op_sel_hi:[1,0,0]
 v_fma_mix_f32 v251, v33, v243, v235 op_sel:[1,0,0] op_sel_hi:[1,0,0]
 v_mfma_f32_16x16x32_bf16 v[184:187], v[28:31], a[48:51], v[184:187]
 ds_read_b64_tr_b16 a[14:15], v5 offset:36960
 v_fma_mix_f32 v252, v34, v244, v236 op_sel_hi:[1,0,0]
 v_fma_mix_f32 v253, v34, v245, v237 op_sel:[1,0,0] op_sel_hi:[1,0,0]
 v_mfma_f32_16x16x32_bf16 v[188:191], v[100:103], a[48:51], v[188:191]
 ds_read_b64_tr_b16 a[16:17], v2 offset:36992
 v_fma_mix_f32 v254, v35, v246, v238 op_sel_hi:[1,0,0]
 v_fma_mix_f32 v255, v35, v247, v239 op_sel:[1,0,0] op_sel_hi:[1,0,0]
 v_mfma_f32_16x16x32_bf16 v[192:195], v[28:31], a[52:55], v[192:195]
 ds_read_b64_tr_b16 a[18:19], v5 offset:36992
 v_cvt_pk_bf16_f32 v32, v248, v249
 v_cvt_pk_bf16_f32 v33, v250, v251
 v_mfma_f32_16x16x32_bf16 v[196:199], v[100:103], a[52:55], v[196:199]
 ds_read_b64_tr_b16 a[20:21], v2 offset:37024
 v_cvt_pk_bf16_f32 v34, v252, v253
 v_cvt_pk_bf16_f32 v35, v254, v255
 v_mfma_f32_16x16x32_bf16 v[200:203], v[28:31], a[56:59], v[200:203]
 ds_read_b64_tr_b16 a[22:23], v5 offset:37024
 v_fma_mix_f32 v248, v104, v240, v232 op_sel_hi:[1,0,0]
 v_fma_mix_f32 v249, v104, v241, v233 op_sel:[1,0,0] op_sel_hi:[1,0,0]
 v_mfma_f32_16x16x32_bf16 v[204:207], v[100:103], a[56:59], v[204:207]
 ds_read_b64_tr_b16 a[24:25], v2 offset:37056
 v_fma_mix_f32 v250, v105, v242, v234 op_sel_hi:[1,0,0]
 v_fma_mix_f32 v251, v105, v243, v235 op_sel:[1,0,0] op_sel_hi:[1,0,0]
 v_mfma_f32_16x16x32_bf16 v[208:211], v[28:31], a[60:63], v[208:211]
 ds_read_b64_tr_b16 a[26:27], v5 offset:37056
 v_fma_mix_f32 v252, v106, v244, v236 op_sel_hi:[1,0,0]
 v_fma_mix_f32 v253, v106, v245, v237 op_sel:[1,0,0] op_sel_hi:[1,0,0]
 v_mfma_f32_16x16x32_bf16 v[212:215], v[100:103], a[60:63], v[212:215]
 ds_read_b64_tr_b16 a[28:29], v2 offset:37088
 v_fma_mix_f32 v254, v107, v246, v238 op_sel_hi:[1,0,0]
 v_fma_mix_f32 v255, v107, v247, v239 op_sel:[1,0,0] op_sel_hi:[1,0,0]
 v_mfma_f32_16x16x32_bf16 v[216:219], v[28:31], a[64:67], v[216:219]
 ds_read_b64_tr_b16 a[30:31], v5 offset:37088
 v_cvt_pk_bf16_f32 v104, v248, v249
 v_cvt_pk_bf16_f32 v105, v250, v251
 v_mfma_f32_16x16x32_bf16 v[220:223], v[100:103], a[64:67], v[220:223]
 ds_read_b64_tr_b16 a[32:33], v2 offset:37120
 v_cvt_pk_bf16_f32 v106, v252, v253
 v_cvt_pk_bf16_f32 v107, v254, v255
 v_mfma_f32_16x16x32_bf16 v[224:227], v[28:31], a[68:71], v[224:227]
 ds_read_b64_tr_b16 a[34:35], v5 offset:37120
 v_mfma_f32_16x16x32_bf16 v[228:231], v[100:103], a[68:71], v[228:231]
 s_waitcnt lgkmcnt(0)
 v_mfma_f32_16x16x32_bf16 v[160:163], v[32:35], a[0:3], v[160:163]
 ds_read_b128 v[232:235], v8 offset:640
 ds_read_b128 v[236:239], v8 offset:656
 ds_read_b128 v[240:243], v8 offset:2944
 ds_read_b128 v[244:247], v8 offset:2960
 v_mfma_f32_16x16x32_bf16 v[164:167], v[104:107], a[0:3], v[164:167]
 ds_read_b64_tr_b16 a[36:37], v2 offset:46080
 ds_read_b64_tr_b16 a[38:39], v5 offset:46080
 v_mfma_f32_16x16x32_bf16 v[168:171], v[32:35], a[4:7], v[168:171]
 ds_read_b64_tr_b16 a[40:41], v2 offset:46112
 ds_read_b64_tr_b16 a[42:43], v5 offset:46112
 v_mfma_f32_16x16x32_bf16 v[172:175], v[104:107], a[4:7], v[172:175]
 ds_read_b64_tr_b16 a[44:45], v2 offset:46144
 ds_read_b64_tr_b16 a[46:47], v5 offset:46144
 v_mfma_f32_16x16x32_bf16 v[176:179], v[32:35], a[8:11], v[176:179]
 s_waitcnt lgkmcnt(6)
 v_fma_mix_f32 v248, v36, v240, v232 op_sel_hi:[1,0,0]
 v_fma_mix_f32 v249, v36, v241, v233 op_sel:[1,0,0] op_sel_hi:[1,0,0]
 v_mfma_f32_16x16x32_bf16 v[180:183], v[104:107], a[8:11], v[180:183]
 ds_read_b64_tr_b16 a[48:49], v2 offset:46176
 v_fma_mix_f32 v250, v37, v242, v234 op_sel_hi:[1,0,0]
 v_fma_mix_f32 v251, v37, v243, v235 op_sel:[1,0,0] op_sel_hi:[1,0,0]
 v_mfma_f32_16x16x32_bf16 v[184:187], v[32:35], a[12:15], v[184:187]
 ds_read_b64_tr_b16 a[50:51], v5 offset:46176
 v_fma_mix_f32 v252, v38, v244, v236 op_sel_hi:[1,0,0]
 v_fma_mix_f32 v253, v38, v245, v237 op_sel:[1,0,0] op_sel_hi:[1,0,0]
 v_mfma_f32_16x16x32_bf16 v[188:191], v[104:107], a[12:15], v[188:191]
 ds_read_b64_tr_b16 a[52:53], v2 offset:46208
 v_fma_mix_f32 v254, v39, v246, v238 op_sel_hi:[1,0,0]
 v_fma_mix_f32 v255, v39, v247, v239 op_sel:[1,0,0] op_sel_hi:[1,0,0]
 v_mfma_f32_16x16x32_bf16 v[192:195], v[32:35], a[16:19], v[192:195]
 ds_read_b64_tr_b16 a[54:55], v5 offset:46208
 v_cvt_pk_bf16_f32 v36, v248, v249
 v_cvt_pk_bf16_f32 v37, v250, v251
 v_mfma_f32_16x16x32_bf16 v[196:199], v[104:107], a[16:19], v[196:199]
 ds_read_b64_tr_b16 a[56:57], v2 offset:46240
 v_cvt_pk_bf16_f32 v38, v252, v253
 v_cvt_pk_bf16_f32 v39, v254, v255
 v_mfma_f32_16x16x32_bf16 v[200:203], v[32:35], a[20:23], v[200:203]
 ds_read_b64_tr_b16 a[58:59], v5 offset:46240
 v_fma_mix_f32 v248, v108, v240, v232 op_sel_hi:[1,0,0]
 v_fma_mix_f32 v249, v108, v241, v233 op_sel:[1,0,0] op_sel_hi:[1,0,0]
 v_mfma_f32_16x16x32_bf16 v[204:207], v[104:107], a[20:23], v[204:207]
 ds_read_b64_tr_b16 a[60:61], v2 offset:46272
 v_fma_mix_f32 v250, v109, v242, v234 op_sel_hi:[1,0,0]
 v_fma_mix_f32 v251, v109, v243, v235 op_sel:[1,0,0] op_sel_hi:[1,0,0]
 v_mfma_f32_16x16x32_bf16 v[208:211], v[32:35], a[24:27], v[208:211]
 ds_read_b64_tr_b16 a[62:63], v5 offset:46272
 v_fma_mix_f32 v252, v110, v244, v236 op_sel_hi:[1,0,0]
 v_fma_mix_f32 v253, v110, v245, v237 op_sel:[1,0,0] op_sel_hi:[1,0,0]
 v_mfma_f32_16x16x32_bf16 v[212:215], v[104:107], a[24:27], v[212:215]
 ds_read_b64_tr_b16 a[64:65], v2 offset:46304
 v_fma_mix_f32 v254, v111, v246, v238 op_sel_hi:[1,0,0]
 v_fma_mix_f32 v255, v111, v247, v239 op_sel:[1,0,0] op_sel_hi:[1,0,0]
 v_mfma_f32_16x16x32_bf16 v[216:219], v[32:35], a[28:31], v[216:219]
 ds_read_b64_tr_b16 a[66:67], v5 offset:46304
 v_cvt_pk_bf16_f32 v108, v248, v249
 v_cvt_pk_bf16_f32 v109, v250, v251
 v_mfma_f32_16x16x32_bf16 v[220:223], v[104:107], a[28:31], v[220:223]
 ds_read_b64_tr_b16 a[68:69], v2 offset:46336
 v_cvt_pk_bf16_f32 v110, v252, v253
 v_cvt_pk_bf16_f32 v111, v254, v255
 v_mfma_f32_16x16x32_bf16 v[224:227], v[32:35], a[32:35], v[224:227]
 ds_read_b64_tr_b16 a[70:71], v5 offset:46336
 v_mfma_f32_16x16x32_bf16 v[228:231], v[104:107], a[32:35], v[228:231]
 s_waitcnt lgkmcnt(0)
 v_mfma_f32_16x16x32_bf16 v[160:163], v[36:39], a[36:39], v[160:163]
 ds_read_b128 v[232:235], v8 offset:768
 ds_read_b128 v[236:239], v8 offset:784
 ds_read_b128 v[240:243], v8 offset:3072
 ds_read_b128 v[244:247], v8 offset:3088
 v_mfma_f32_16x16x32_bf16 v[164:167], v[108:111], a[36:39], v[164:167]
 ds_read_b64_tr_b16 a[0:1], v2 offset:55296
 ds_read_b64_tr_b16 a[2:3], v5 offset:55296
 v_mfma_f32_16x16x32_bf16 v[168:171], v[36:39], a[40:43], v[168:171]
 ds_read_b64_tr_b16 a[4:5], v2 offset:55328
 ds_read_b64_tr_b16 a[6:7], v5 offset:55328
 v_mfma_f32_16x16x32_bf16 v[172:175], v[108:111], a[40:43], v[172:175]
 ds_read_b64_tr_b16 a[8:9], v2 offset:55360
 ds_read_b64_tr_b16 a[10:11], v5 offset:55360
 v_mfma_f32_16x16x32_bf16 v[176:179], v[36:39], a[44:47], v[176:179]
 s_waitcnt lgkmcnt(6)
 v_fma_mix_f32 v248, v40, v240, v232 op_sel_hi:[1,0,0]
 v_fma_mix_f32 v249, v40, v241, v233 op_sel:[1,0,0] op_sel_hi:[1,0,0]
 v_mfma_f32_16x16x32_bf16 v[180:183], v[108:111], a[44:47], v[180:183]
 ds_read_b64_tr_b16 a[12:13], v2 offset:55392
 v_fma_mix_f32 v250, v41, v242, v234 op_sel_hi:[1,0,0]
 v_fma_mix_f32 v251, v41, v243, v235 op_sel:[1,0,0] op_sel_hi:[1,0,0]
 v_mfma_f32_16x16x32_bf16 v[184:187], v[36:39], a[48:51], v[184:187]
 ds_read_b64_tr_b16 a[14:15], v5 offset:55392
 v_fma_mix_f32 v252, v42, v244, v236 op_sel_hi:[1,0,0]
 v_fma_mix_f32 v253, v42, v245, v237 op_sel:[1,0,0] op_sel_hi:[1,0,0]
 v_mfma_f32_16x16x32_bf16 v[188:191], v[108:111], a[48:51], v[188:191]
 ds_read_b64_tr_b16 a[16:17], v2 offset:55424
 v_fma_mix_f32 v254, v43, v246, v238 op_sel_hi:[1,0,0]
 v_fma_mix_f32 v255, v43, v247, v239 op_sel:[1,0,0] op_sel_hi:[1,0,0]
 v_mfma_f32_16x16x32_bf16 v[192:195], v[36:39], a[52:55], v[192:195]
 ds_read_b64_tr_b16 a[18:19], v5 offset:55424
 v_cvt_pk_bf16_f32 v40, v248, v249
 v_cvt_pk_bf16_f32 v41, v250, v251
 v_mfma_f32_16x16x32_bf16 v[196:199], v[108:111], a[52:55], v[196:199]
 ds_read_b64_tr_b16 a[20:21], v2 offset:55456
 v_cvt_pk_bf16_f32 v42, v252, v253
 v_cvt_pk_bf16_f32 v43, v254, v255
 v_mfma_f32_16x16x32_bf16 v[200:203], v[36:39], a[56:59], v[200:203]
 ds_read_b64_tr_b16 a[22:23], v5 offset:55456
 v_fma_mix_f32 v248, v112, v240, v232 op_sel_hi:[1,0,0]
 v_fma_mix_f32 v249, v112, v241, v233 op_sel:[1,0,0] op_sel_hi:[1,0,0]
 v_mfma_f32_16x16x32_bf16 v[204:207], v[108:111], a[56:59], v[204:207]
 ds_read_b64_tr_b16 a[24:25], v2 offset:55488
 v_fma_mix_f32 v250, v113, v242, v234 op_sel_hi:[1,0,0]
 v_fma_mix_f32 v251, v113, v243, v235 op_sel:[1,0,0] op_sel_hi:[1,0,0]
 v_mfma_f32_16x16x32_bf16 v[208:211], v[36:39], a[60:63], v[208:211]
 ds_read_b64_tr_b16 a[26:27], v5 offset:55488
 v_fma_mix_f32 v252, v114, v244, v236 op_sel_hi:[1,0,0]
 v_fma_mix_f32 v253, v114, v245, v237 op_sel:[1,0,0] op_sel_hi:[1,0,0]
 v_mfma_f32_16x16x32_bf16 v[212:215], v[108:111], a[60:63], v[212:215]
 ds_read_b64_tr_b16 a[28:29], v2 offset:55520
 v_fma_mix_f32 v254, v115, v246, v238 op_sel_hi:[1,0,0]
 v_fma_mix_f32 v255, v115, v247, v239 op_sel:[1,0,0] op_sel_hi:[1,0,0]
 v_mfma_f32_16x16x32_bf16 v[216:219], v[36:39], a[64:67], v[216:219]
 ds_read_b64_tr_b16 a[30:31], v5 offset:55520
 v_cvt_pk_bf16_f32 v112, v248, v249
 v_cvt_pk_bf16_f32 v113, v250, v251
 v_mfma_f32_16x16x32_bf16 v[220:223], v[108:111], a[64:67], v[220:223]
 ds_read_b64_tr_b16 a[32:33], v2 offset:55552
 v_cvt_pk_bf16_f32 v114, v252, v253
 v_cvt_pk_bf16_f32 v115, v254, v255
 v_mfma_f32_16x16x32_bf16 v[224:227], v[36:39], a[68:71], v[224:227]
 ds_read_b64_tr_b16 a[34:35], v5 offset:55552
 v_mfma_f32_16x16x32_bf16 v[228:231], v[108:111], a[68:71], v[228:231]
 s_waitcnt lgkmcnt(0)
 v_mfma_f32_16x16x32_bf16 v[160:163], v[40:43], a[0:3], v[160:163]
 ds_read_b128 v[232:235], v8 offset:896
 ds_read_b128 v[236:239], v8 offset:912
 ds_read_b128 v[240:243], v8 offset:3200
 ds_read_b128 v[244:247], v8 offset:3216
 v_mfma_f32_16x16x32_bf16 v[164:167], v[112:115], a[0:3], v[164:167]
 ds_read_b64_tr_b16 a[36:37], v3 offset:0
 ds_read_b64_tr_b16 a[38:39], v6 offset:0
 v_mfma_f32_16x16x32_bf16 v[168:171], v[40:43], a[4:7], v[168:171]
 ds_read_b64_tr_b16 a[40:41], v3 offset:32
 ds_read_b64_tr_b16 a[42:43], v6 offset:32
 v_mfma_f32_16x16x32_bf16 v[172:175], v[112:115], a[4:7], v[172:175]
 ds_read_b64_tr_b16 a[44:45], v3 offset:64
 ds_read_b64_tr_b16 a[46:47], v6 offset:64
 v_mfma_f32_16x16x32_bf16 v[176:179], v[40:43], a[8:11], v[176:179]
 s_waitcnt lgkmcnt(6)
 v_fma_mix_f32 v248, v44, v240, v232 op_sel_hi:[1,0,0]
 v_fma_mix_f32 v249, v44, v241, v233 op_sel:[1,0,0] op_sel_hi:[1,0,0]
 v_mfma_f32_16x16x32_bf16 v[180:183], v[112:115], a[8:11], v[180:183]
 ds_read_b64_tr_b16 a[48:49], v3 offset:96
 v_fma_mix_f32 v250, v45, v242, v234 op_sel_hi:[1,0,0]
 v_fma_mix_f32 v251, v45, v243, v235 op_sel:[1,0,0] op_sel_hi:[1,0,0]
 v_mfma_f32_16x16x32_bf16 v[184:187], v[40:43], a[12:15], v[184:187]
 ds_read_b64_tr_b16 a[50:51], v6 offset:96
 v_fma_mix_f32 v252, v46, v244, v236 op_sel_hi:[1,0,0]
 v_fma_mix_f32 v253, v46, v245, v237 op_sel:[1,0,0] op_sel_hi:[1,0,0]
 v_mfma_f32_16x16x32_bf16 v[188:191], v[112:115], a[12:15], v[188:191]
 ds_read_b64_tr_b16 a[52:53], v3 offset:128
 v_fma_mix_f32 v254, v47, v246, v238 op_sel_hi:[1,0,0]
 v_fma_mix_f32 v255, v47, v247, v239 op_sel:[1,0,0] op_sel_hi:[1,0,0]
 v_mfma_f32_16x16x32_bf16 v[192:195], v[40:43], a[16:19], v[192:195]
 ds_read_b64_tr_b16 a[54:55], v6 offset:128
 v_cvt_pk_bf16_f32 v44, v248, v249
 v_cvt_pk_bf16_f32 v45, v250, v251
 v_mfma_f32_16x16x32_bf16 v[196:199], v[112:115], a[16:19], v[196:199]
 ds_read_b64_tr_b16 a[56:57], v3 offset:160
 v_cvt_pk_bf16_f32 v46, v252, v253
 v_cvt_pk_bf16_f32 v47, v254, v255
 v_mfma_f32_16x16x32_bf16 v[200:203], v[40:43], a[20:23], v[200:203]
 ds_read_b64_tr_b16 a[58:59], v6 offset:160
 v_fma_mix_f32 v248, v116, v240, v232 op_sel_hi:[1,0,0]
 v_fma_mix_f32 v249, v116, v241, v233 op_sel:[1,0,0] op_sel_hi:[1,0,0]
 v_mfma_f32_16x16x32_bf16 v[204:207], v[112:115], a[20:23], v[204:207]
 ds_read_b64_tr_b16 a[60:61], v3 offset:192
 v_fma_mix_f32 v250, v117, v242, v234 op_sel_hi:[1,0,0]
 v_fma_mix_f32 v251, v117, v243, v235 op_sel:[1,0,0] op_sel_hi:[1,0,0]
 v_mfma_f32_16x16x32_bf16 v[208:211], v[40:43], a[24:27], v[208:211]
 ds_read_b64_tr_b16 a[62:63], v6 offset:192
 v_fma_mix_f32 v252, v118, v244, v236 op_sel_hi:[1,0,0]
 v_fma_mix_f32 v253, v118, v245, v237 op_sel:[1,0,0] op_sel_hi:[1,0,0]
 v_mfma_f32_16x16x32_bf16 v[212:215], v[112:115], a[24:27], v[212:215]
 ds_read_b64_tr_b16 a[64:65], v3 offset:224
 v_fma_mix_f32 v254, v119, v246, v238 op_sel_hi:[1,0,0]
 v_fma_mix_f32 v255, v119, v247, v239 op_sel:[1,0,0] op_sel_hi:[1,0,0]
 v_mfma_f32_16x16x32_bf16 v[216:219], v[40:43], a[28:31], v[216:219]
 ds_read_b64_tr_b16 a[66:67], v6 offset:224
 v_cvt_pk_bf16_f32 v116, v248, v249
 v_cvt_pk_bf16_f32 v117, v250, v251
 v_mfma_f32_16x16x32_bf16 v[220:223], v[112:115], a[28:31], v[220:223]
 ds_read_b64_tr_b16 a[68:69], v3 offset:256
 v_cvt_pk_bf16_f32 v118, v252, v253
 v_cvt_pk_bf16_f32 v119, v254, v255
 v_mfma_f32_16x16x32_bf16 v[224:227], v[40:43], a[32:35], v[224:227]
 ds_read_b64_tr_b16 a[70:71], v6 offset:256
 v_mfma_f32_16x16x32_bf16 v[228:231], v[112:115], a[32:35], v[228:231]
 s_waitcnt lgkmcnt(0)
 v_mfma_f32_16x16x32_bf16 v[160:163], v[44:47], a[36:39], v[160:163]
 ds_read_b128 v[232:235], v8 offset:1024
 ds_read_b128 v[236:239], v8 offset:1040
 ds_read_b128 v[240:243], v8 offset:3328
 ds_read_b128 v[244:247], v8 offset:3344
 v_mfma_f32_16x16x32_bf16 v[164:167], v[116:119], a[36:39], v[164:167]
 ds_read_b64_tr_b16 a[0:1], v3 offset:9216
 ds_read_b64_tr_b16 a[2:3], v6 offset:9216
 v_mfma_f32_16x16x32_bf16 v[168:171], v[44:47], a[40:43], v[168:171]
 ds_read_b64_tr_b16 a[4:5], v3 offset:9248
 ds_read_b64_tr_b16 a[6:7], v6 offset:9248
 v_mfma_f32_16x16x32_bf16 v[172:175], v[116:119], a[40:43], v[172:175]
 ds_read_b64_tr_b16 a[8:9], v3 offset:9280
 ds_read_b64_tr_b16 a[10:11], v6 offset:9280
 v_mfma_f32_16x16x32_bf16 v[176:179], v[44:47], a[44:47], v[176:179]
 s_waitcnt lgkmcnt(6)
 v_fma_mix_f32 v248, v48, v240, v232 op_sel_hi:[1,0,0]
 v_fma_mix_f32 v249, v48, v241, v233 op_sel:[1,0,0] op_sel_hi:[1,0,0]
 v_mfma_f32_16x16x32_bf16 v[180:183], v[116:119], a[44:47], v[180:183]
 ds_read_b64_tr_b16 a[12:13], v3 offset:9312
 v_fma_mix_f32 v250, v49, v242, v234 op_sel_hi:[1,0,0]
 v_fma_mix_f32 v251, v49, v243, v235 op_sel:[1,0,0] op_sel_hi:[1,0,0]
 v_mfma_f32_16x16x32_bf16 v[184:187], v[44:47], a[48:51], v[184:187]
 ds_read_b64_tr_b16 a[14:15], v6 offset:9312
 v_fma_mix_f32 v252, v50, v244, v236 op_sel_hi:[1,0,0]
 v_fma_mix_f32 v253, v50, v245, v237 op_sel:[1,0,0] op_sel_hi:[1,0,0]
 v_mfma_f32_16x16x32_bf16 v[188:191], v[116:119], a[48:51], v[188:191]
 ds_read_b64_tr_b16 a[16:17], v3 offset:9344
 v_fma_mix_f32 v254, v51, v246, v238 op_sel_hi:[1,0,0]
 v_fma_mix_f32 v255, v51, v247, v239 op_sel:[1,0,0] op_sel_hi:[1,0,0]
 v_mfma_f32_16x16x32_bf16 v[192:195], v[44:47], a[52:55], v[192:195]
 ds_read_b64_tr_b16 a[18:19], v6 offset:9344
 v_cvt_pk_bf16_f32 v48, v248, v249
 v_cvt_pk_bf16_f32 v49, v250, v251
 v_mfma_f32_16x16x32_bf16 v[196:199], v[116:119], a[52:55], v[196:199]
 ds_read_b64_tr_b16 a[20:21], v3 offset:9376
 v_cvt_pk_bf16_f32 v50, v252, v253
 v_cvt_pk_bf16_f32 v51, v254, v255
 v_mfma_f32_16x16x32_bf16 v[200:203], v[44:47], a[56:59], v[200:203]
 ds_read_b64_tr_b16 a[22:23], v6 offset:9376
 v_fma_mix_f32 v248, v120, v240, v232 op_sel_hi:[1,0,0]
 v_fma_mix_f32 v249, v120, v241, v233 op_sel:[1,0,0] op_sel_hi:[1,0,0]
 v_mfma_f32_16x16x32_bf16 v[204:207], v[116:119], a[56:59], v[204:207]
 ds_read_b64_tr_b16 a[24:25], v3 offset:9408
 v_fma_mix_f32 v250, v121, v242, v234 op_sel_hi:[1,0,0]
 v_fma_mix_f32 v251, v121, v243, v235 op_sel:[1,0,0] op_sel_hi:[1,0,0]
 v_mfma_f32_16x16x32_bf16 v[208:211], v[44:47], a[60:63], v[208:211]
 ds_read_b64_tr_b16 a[26:27], v6 offset:9408
 v_fma_mix_f32 v252, v122, v244, v236 op_sel_hi:[1,0,0]
 v_fma_mix_f32 v253, v122, v245, v237 op_sel:[1,0,0] op_sel_hi:[1,0,0]
 v_mfma_f32_16x16x32_bf16 v[212:215], v[116:119], a[60:63], v[212:215]
 ds_read_b64_tr_b16 a[28:29], v3 offset:9440
 v_fma_mix_f32 v254, v123, v246, v238 op_sel_hi:[1,0,0]
 v_fma_mix_f32 v255, v123, v247, v239 op_sel:[1,0,0] op_sel_hi:[1,0,0]
 v_mfma_f32_16x16x32_bf16 v[216:219], v[44:47], a[64:67], v[216:219]
 ds_read_b64_tr_b16 a[30:31], v6 offset:9440
 v_cvt_pk_bf16_f32 v120, v248, v249
 v_cvt_pk_bf16_f32 v121, v250, v251
 v_mfma_f32_16x16x32_bf16 v[220:223], v[116:119], a[64:67], v[220:223]
 ds_read_b64_tr_b16 a[32:33], v3 offset:9472
 v_cvt_pk_bf16_f32 v122, v252, v253
 v_cvt_pk_bf16_f32 v123, v254, v255
 v_mfma_f32_16x16x32_bf16 v[224:227], v[44:47], a[68:71], v[224:227]
 ds_read_b64_tr_b16 a[34:35], v6 offset:9472
 v_mfma_f32_16x16x32_bf16 v[228:231], v[116:119], a[68:71], v[228:231]
 s_waitcnt lgkmcnt(0)
 v_mfma_f32_16x16x32_bf16 v[160:163], v[48:51], a[0:3], v[160:163]
 ds_read_b128 v[232:235], v8 offset:1152
 ds_read_b128 v[236:239], v8 offset:1168
 ds_read_b128 v[240:243], v8 offset:3456
 ds_read_b128 v[244:247], v8 offset:3472
 v_mfma_f32_16x16x32_bf16 v[164:167], v[120:123], a[0:3], v[164:167]
 ds_read_b64_tr_b16 a[36:37], v3 offset:18432
 ds_read_b64_tr_b16 a[38:39], v6 offset:18432
 v_mfma_f32_16x16x32_bf16 v[168:171], v[48:51], a[4:7], v[168:171]
 ds_read_b64_tr_b16 a[40:41], v3 offset:18464
 ds_read_b64_tr_b16 a[42:43], v6 offset:18464
 v_mfma_f32_16x16x32_bf16 v[172:175], v[120:123], a[4:7], v[172:175]
 ds_read_b64_tr_b16 a[44:45], v3 offset:18496
 ds_read_b64_tr_b16 a[46:47], v6 offset:18496
 v_mfma_f32_16x16x32_bf16 v[176:179], v[48:51], a[8:11], v[176:179]
 s_waitcnt lgkmcnt(6)
 v_fma_mix_f32 v248, v52, v240, v232 op_sel_hi:[1,0,0]
 v_fma_mix_f32 v249, v52, v241, v233 op_sel:[1,0,0] op_sel_hi:[1,0,0]
 v_mfma_f32_16x16x32_bf16 v[180:183], v[120:123], a[8:11], v[180:183]
 ds_read_b64_tr_b16 a[48:49], v3 offset:18528
 v_fma_mix_f32 v250, v53, v242, v234 op_sel_hi:[1,0,0]
 v_fma_mix_f32 v251, v53, v243, v235 op_sel:[1,0,0] op_sel_hi:[1,0,0]
 v_mfma_f32_16x16x32_bf16 v[184:187], v[48:51], a[12:15], v[184:187]
 ds_read_b64_tr_b16 a[50:51], v6 offset:18528
 v_fma_mix_f32 v252, v54, v244, v236 op_sel_hi:[1,0,0]
 v_fma_mix_f32 v253, v54, v245, v237 op_sel:[1,0,0] op_sel_hi:[1,0,0]
 v_mfma_f32_16x16x32_bf16 v[188:191], v[120:123], a[12:15], v[188:191]
 ds_read_b64_tr_b16 a[52:53], v3 offset:18560
 v_fma_mix_f32 v254, v55, v246, v238 op_sel_hi:[1,0,0]
 v_fma_mix_f32 v255, v55, v247, v239 op_sel:[1,0,0] op_sel_hi:[1,0,0]
 v_mfma_f32_16x16x32_bf16 v[192:195], v[48:51], a[16:19], v[192:195]
 ds_read_b64_tr_b16 a[54:55], v6 offset:18560
 v_cvt_pk_bf16_f32 v52, v248, v249
 v_cvt_pk_bf16_f32 v53, v250, v251
 v_mfma_f32_16x16x32_bf16 v[196:199], v[120:123], a[16:19], v[196:199]
 ds_read_b64_tr_b16 a[56:57], v3 offset:18592
 v_cvt_pk_bf16_f32 v54, v252, v253
 v_cvt_pk_bf16_f32 v55, v254, v255
 v_mfma_f32_16x16x32_bf16 v[200:203], v[48:51], a[20:23], v[200:203]
 ds_read_b64_tr_b16 a[58:59], v6 offset:18592
 v_fma_mix_f32 v248, v124, v240, v232 op_sel_hi:[1,0,0]
 v_fma_mix_f32 v249, v124, v241, v233 op_sel:[1,0,0] op_sel_hi:[1,0,0]
 v_mfma_f32_16x16x32_bf16 v[204:207], v[120:123], a[20:23], v[204:207]
 ds_read_b64_tr_b16 a[60:61], v3 offset:18624
 v_fma_mix_f32 v250, v125, v242, v234 op_sel_hi:[1,0,0]
 v_fma_mix_f32 v251, v125, v243, v235 op_sel:[1,0,0] op_sel_hi:[1,0,0]
 v_mfma_f32_16x16x32_bf16 v[208:211], v[48:51], a[24:27], v[208:211]
 ds_read_b64_tr_b16 a[62:63], v6 offset:18624
 v_fma_mix_f32 v252, v126, v244, v236 op_sel_hi:[1,0,0]
 v_fma_mix_f32 v253, v126, v245, v237 op_sel:[1,0,0] op_sel_hi:[1,0,0]
 v_mfma_f32_16x16x32_bf16 v[212:215], v[120:123], a[24:27], v[212:215]
 ds_read_b64_tr_b16 a[64:65], v3 offset:18656
 v_fma_mix_f32 v254, v127, v246, v238 op_sel_hi:[1,0,0]
 v_fma_mix_f32 v255, v127, v247, v239 op_sel:[1,0,0] op_sel_hi:[1,0,0]
 v_mfma_f32_16x16x32_bf16 v[216:219], v[48:51], a[28:31], v[216:219]
 ds_read_b64_tr_b16 a[66:67], v6 offset:18656
 v_cvt_pk_bf16_f32 v124, v248, v249
 v_cvt_pk_bf16_f32 v125, v250, v251
 v_mfma_f32_16x16x32_bf16 v[220:223], v[120:123], a[28:31], v[220:223]
 ds_read_b64_tr_b16 a[68:69], v3 offset:18688
 v_cvt_pk_bf16_f32 v126, v252, v253
 v_cvt_pk_bf16_f32 v127, v254, v255
 v_mfma_f32_16x16x32_bf16 v[224:227], v[48:51], a[32:35], v[224:227]
 ds_read_b64_tr_b16 a[70:71], v6 offset:18688
 v_mfma_f32_16x16x32_bf16 v[228:231], v[120:123], a[32:35], v[228:231]
 s_waitcnt lgkmcnt(0)
 v_mfma_f32_16x16x32_bf16 v[160:163], v[52:55], a[36:39], v[160:163]
 ds_read_b128 v[232:235], v8 offset:1280
 ds_read_b128 v[236:239], v8 offset:1296
 ds_read_b128 v[240:243], v8 offset:3584
 ds_read_b128 v[244:247], v8 offset:3600
 v_mfma_f32_16x16x32_bf16 v[164:167], v[124:127], a[36:39], v[164:167]
 ds_read_b64_tr_b16 a[0:1], v3 offset:27648
 ds_read_b64_tr_b16 a[2:3], v6 offset:27648
 v_mfma_f32_16x16x32_bf16 v[168:171], v[52:55], a[40:43], v[168:171]
 ds_read_b64_tr_b16 a[4:5], v3 offset:27680
 ds_read_b64_tr_b16 a[6:7], v6 offset:27680
 v_mfma_f32_16x16x32_bf16 v[172:175], v[124:127], a[40:43], v[172:175]
 ds_read_b64_tr_b16 a[8:9], v3 offset:27712
 ds_read_b64_tr_b16 a[10:11], v6 offset:27712
 v_mfma_f32_16x16x32_bf16 v[176:179], v[52:55], a[44:47], v[176:179]
 s_waitcnt lgkmcnt(6)
 v_fma_mix_f32 v248, v56, v240, v232 op_sel_hi:[1,0,0]
 v_fma_mix_f32 v249, v56, v241, v233 op_sel:[1,0,0] op_sel_hi:[1,0,0]
 v_mfma_f32_16x16x32_bf16 v[180:183], v[124:127], a[44:47], v[180:183]
 ds_read_b64_tr_b16 a[12:13], v3 offset:27744
 v_fma_mix_f32 v250, v57, v242, v234 op_sel_hi:[1,0,0]
 v_fma_mix_f32 v251, v57, v243, v235 op_sel:[1,0,0] op_sel_hi:[1,0,0]
 v_mfma_f32_16x16x32_bf16 v[184:187], v[52:55], a[48:51], v[184:187]
 ds_read_b64_tr_b16 a[14:15], v6 offset:27744
 v_fma_mix_f32 v252, v58, v244, v236 op_sel_hi:[1,0,0]
 v_fma_mix_f32 v253, v58, v245, v237 op_sel:[1,0,0] op_sel_hi:[1,0,0]
 v_mfma_f32_16x16x32_bf16 v[188:191], v[124:127], a[48:51], v[188:191]
 ds_read_b64_tr_b16 a[16:17], v3 offset:27776
 v_fma_mix_f32 v254, v59, v246, v238 op_sel_hi:[1,0,0]
 v_fma_mix_f32 v255, v59, v247, v239 op_sel:[1,0,0] op_sel_hi:[1,0,0]
 v_mfma_f32_16x16x32_bf16 v[192:195], v[52:55], a[52:55], v[192:195]
 ds_read_b64_tr_b16 a[18:19], v6 offset:27776
 v_cvt_pk_bf16_f32 v56, v248, v249
 v_cvt_pk_bf16_f32 v57, v250, v251
 v_mfma_f32_16x16x32_bf16 v[196:199], v[124:127], a[52:55], v[196:199]
 ds_read_b64_tr_b16 a[20:21], v3 offset:27808
 v_cvt_pk_bf16_f32 v58, v252, v253
 v_cvt_pk_bf16_f32 v59, v254, v255
 v_mfma_f32_16x16x32_bf16 v[200:203], v[52:55], a[56:59], v[200:203]
 ds_read_b64_tr_b16 a[22:23], v6 offset:27808
 v_fma_mix_f32 v248, v128, v240, v232 op_sel_hi:[1,0,0]
 v_fma_mix_f32 v249, v128, v241, v233 op_sel:[1,0,0] op_sel_hi:[1,0,0]
 v_mfma_f32_16x16x32_bf16 v[204:207], v[124:127], a[56:59], v[204:207]
 ds_read_b64_tr_b16 a[24:25], v3 offset:27840
 v_fma_mix_f32 v250, v129, v242, v234 op_sel_hi:[1,0,0]
 v_fma_mix_f32 v251, v129, v243, v235 op_sel:[1,0,0] op_sel_hi:[1,0,0]
 v_mfma_f32_16x16x32_bf16 v[208:211], v[52:55], a[60:63], v[208:211]
 ds_read_b64_tr_b16 a[26:27], v6 offset:27840
 v_fma_mix_f32 v252, v130, v244, v236 op_sel_hi:[1,0,0]
 v_fma_mix_f32 v253, v130, v245, v237 op_sel:[1,0,0] op_sel_hi:[1,0,0]
 v_mfma_f32_16x16x32_bf16 v[212:215], v[124:127], a[60:63], v[212:215]
 ds_read_b64_tr_b16 a[28:29], v3 offset:27872
 v_fma_mix_f32 v254, v131, v246, v238 op_sel_hi:[1,0,0]
 v_fma_mix_f32 v255, v131, v247, v239 op_sel:[1,0,0] op_sel_hi:[1,0,0]
 v_mfma_f32_16x16x32_bf16 v[216:219], v[52:55], a[64:67], v[216:219]
 ds_read_b64_tr_b16 a[30:31], v6 offset:27872
 v_cvt_pk_bf16_f32 v128, v248, v249
 v_cvt_pk_bf16_f32 v129, v250, v251
 v_mfma_f32_16x16x32_bf16 v[220:223], v[124:127], a[64:67], v[220:223]
 ds_read_b64_tr_b16 a[32:33], v3 offset:27904
 v_cvt_pk_bf16_f32 v130, v252, v253
 v_cvt_pk_bf16_f32 v131, v254, v255
 v_mfma_f32_16x16x32_bf16 v[224:227], v[52:55], a[68:71], v[224:227]
 ds_read_b64_tr_b16 a[34:35], v6 offset:27904
 v_mfma_f32_16x16x32_bf16 v[228:231], v[124:127], a[68:71], v[228:231]
 s_waitcnt lgkmcnt(0)
 v_mfma_f32_16x16x32_bf16 v[160:163], v[56:59], a[0:3], v[160:163]
 ds_read_b128 v[232:235], v8 offset:1408
 ds_read_b128 v[236:239], v8 offset:1424
 ds_read_b128 v[240:243], v8 offset:3712
 ds_read_b128 v[244:247], v8 offset:3728
 v_mfma_f32_16x16x32_bf16 v[164:167], v[128:131], a[0:3], v[164:167]
 ds_read_b64_tr_b16 a[36:37], v3 offset:36864
 ds_read_b64_tr_b16 a[38:39], v6 offset:36864
 v_mfma_f32_16x16x32_bf16 v[168:171], v[56:59], a[4:7], v[168:171]
 ds_read_b64_tr_b16 a[40:41], v3 offset:36896
 ds_read_b64_tr_b16 a[42:43], v6 offset:36896
 v_mfma_f32_16x16x32_bf16 v[172:175], v[128:131], a[4:7], v[172:175]
 ds_read_b64_tr_b16 a[44:45], v3 offset:36928
 ds_read_b64_tr_b16 a[46:47], v6 offset:36928
 v_mfma_f32_16x16x32_bf16 v[176:179], v[56:59], a[8:11], v[176:179]
 s_waitcnt lgkmcnt(6)
 v_fma_mix_f32 v248, v60, v240, v232 op_sel_hi:[1,0,0]
 v_fma_mix_f32 v249, v60, v241, v233 op_sel:[1,0,0] op_sel_hi:[1,0,0]
 v_mfma_f32_16x16x32_bf16 v[180:183], v[128:131], a[8:11], v[180:183]
 ds_read_b64_tr_b16 a[48:49], v3 offset:36960
 v_fma_mix_f32 v250, v61, v242, v234 op_sel_hi:[1,0,0]
 v_fma_mix_f32 v251, v61, v243, v235 op_sel:[1,0,0] op_sel_hi:[1,0,0]
 v_mfma_f32_16x16x32_bf16 v[184:187], v[56:59], a[12:15], v[184:187]
 ds_read_b64_tr_b16 a[50:51], v6 offset:36960
 v_fma_mix_f32 v252, v62, v244, v236 op_sel_hi:[1,0,0]
 v_fma_mix_f32 v253, v62, v245, v237 op_sel:[1,0,0] op_sel_hi:[1,0,0]
 v_mfma_f32_16x16x32_bf16 v[188:191], v[128:131], a[12:15], v[188:191]
 ds_read_b64_tr_b16 a[52:53], v3 offset:36992
 v_fma_mix_f32 v254, v63, v246, v238 op_sel_hi:[1,0,0]
 v_fma_mix_f32 v255, v63, v247, v239 op_sel:[1,0,0] op_sel_hi:[1,0,0]
 v_mfma_f32_16x16x32_bf16 v[192:195], v[56:59], a[16:19], v[192:195]
 ds_read_b64_tr_b16 a[54:55], v6 offset:36992
 v_cvt_pk_bf16_f32 v60, v248, v249
 v_cvt_pk_bf16_f32 v61, v250, v251
 v_mfma_f32_16x16x32_bf16 v[196:199], v[128:131], a[16:19], v[196:199]
 ds_read_b64_tr_b16 a[56:57], v3 offset:37024
 v_cvt_pk_bf16_f32 v62, v252, v253
 v_cvt_pk_bf16_f32 v63, v254, v255
 v_mfma_f32_16x16x32_bf16 v[200:203], v[56:59], a[20:23], v[200:203]
 ds_read_b64_tr_b16 a[58:59], v6 offset:37024
 v_fma_mix_f32 v248, v132, v240, v232 op_sel_hi:[1,0,0]
 v_fma_mix_f32 v249, v132, v241, v233 op_sel:[1,0,0] op_sel_hi:[1,0,0]
 v_mfma_f32_16x16x32_bf16 v[204:207], v[128:131], a[20:23], v[204:207]
 ds_read_b64_tr_b16 a[60:61], v3 offset:37056
 v_fma_mix_f32 v250, v133, v242, v234 op_sel_hi:[1,0,0]
 v_fma_mix_f32 v251, v133, v243, v235 op_sel:[1,0,0] op_sel_hi:[1,0,0]
 v_mfma_f32_16x16x32_bf16 v[208:211], v[56:59], a[24:27], v[208:211]
 ds_read_b64_tr_b16 a[62:63], v6 offset:37056
 v_fma_mix_f32 v252, v134, v244, v236 op_sel_hi:[1,0,0]
 v_fma_mix_f32 v253, v134, v245, v237 op_sel:[1,0,0] op_sel_hi:[1,0,0]
 v_mfma_f32_16x16x32_bf16 v[212:215], v[128:131], a[24:27], v[212:215]
 ds_read_b64_tr_b16 a[64:65], v3 offset:37088
 v_fma_mix_f32 v254, v135, v246, v238 op_sel_hi:[1,0,0]
 v_fma_mix_f32 v255, v135, v247, v239 op_sel:[1,0,0] op_sel_hi:[1,0,0]
 v_mfma_f32_16x16x32_bf16 v[216:219], v[56:59], a[28:31], v[216:219]
 ds_read_b64_tr_b16 a[66:67], v6 offset:37088
 v_cvt_pk_bf16_f32 v132, v248, v249
 v_cvt_pk_bf16_f32 v133, v250, v251
 v_mfma_f32_16x16x32_bf16 v[220:223], v[128:131], a[28:31], v[220:223]
 ds_read_b64_tr_b16 a[68:69], v3 offset:37120
 v_cvt_pk_bf16_f32 v134, v252, v253
 v_cvt_pk_bf16_f32 v135, v254, v255
 v_mfma_f32_16x16x32_bf16 v[224:227], v[56:59], a[32:35], v[224:227]
 ds_read_b64_tr_b16 a[70:71], v6 offset:37120
 v_mfma_f32_16x16x32_bf16 v[228:231], v[128:131], a[32:35], v[228:231]
 s_waitcnt lgkmcnt(0)
 v_mfma_f32_16x16x32_bf16 v[160:163], v[60:63], a[36:39], v[160:163]
 ds_read_b128 v[232:235], v8 offset:1536
 ds_read_b128 v[236:239], v8 offset:1552
 ds_read_b128 v[240:243], v8 offset:3840
 ds_read_b128 v[244:247], v8 offset:3856
 v_mfma_f32_16x16x32_bf16 v[164:167], v[132:135], a[36:39], v[164:167]
 ds_read_b64_tr_b16 a[0:1], v3 offset:46080
 ds_read_b64_tr_b16 a[2:3], v6 offset:46080
 v_mfma_f32_16x16x32_bf16 v[168:171], v[60:63], a[40:43], v[168:171]
 ds_read_b64_tr_b16 a[4:5], v3 offset:46112
 ds_read_b64_tr_b16 a[6:7], v6 offset:46112
 v_mfma_f32_16x16x32_bf16 v[172:175], v[132:135], a[40:43], v[172:175]
 ds_read_b64_tr_b16 a[8:9], v3 offset:46144
 ds_read_b64_tr_b16 a[10:11], v6 offset:46144
 v_mfma_f32_16x16x32_bf16 v[176:179], v[60:63], a[44:47], v[176:179]
 s_waitcnt lgkmcnt(6)
 v_fma_mix_f32 v248, v64, v240, v232 op_sel_hi:[1,0,0]
 v_fma_mix_f32 v249, v64, v241, v233 op_sel:[1,0,0] op_sel_hi:[1,0,0]
 v_mfma_f32_16x16x32_bf16 v[180:183], v[132:135], a[44:47], v[180:183]
 ds_read_b64_tr_b16 a[12:13], v3 offset:46176
 v_fma_mix_f32 v250, v65, v242, v234 op_sel_hi:[1,0,0]
 v_fma_mix_f32 v251, v65, v243, v235 op_sel:[1,0,0] op_sel_hi:[1,0,0]
 v_mfma_f32_16x16x32_bf16 v[184:187], v[60:63], a[48:51], v[184:187]
 ds_read_b64_tr_b16 a[14:15], v6 offset:46176
 v_fma_mix_f32 v252, v66, v244, v236 op_sel_hi:[1,0,0]
 v_fma_mix_f32 v253, v66, v245, v237 op_sel:[1,0,0] op_sel_hi:[1,0,0]
 v_mfma_f32_16x16x32_bf16 v[188:191], v[132:135], a[48:51], v[188:191]
 ds_read_b64_tr_b16 a[16:17], v3 offset:46208
 v_fma_mix_f32 v254, v67, v246, v238 op_sel_hi:[1,0,0]
 v_fma_mix_f32 v255, v67, v247, v239 op_sel:[1,0,0] op_sel_hi:[1,0,0]
 v_mfma_f32_16x16x32_bf16 v[192:195], v[60:63], a[52:55], v[192:195]
 ds_read_b64_tr_b16 a[18:19], v6 offset:46208
 v_cvt_pk_bf16_f32 v64, v248, v249
 v_cvt_pk_bf16_f32 v65, v250, v251
 v_mfma_f32_16x16x32_bf16 v[196:199], v[132:135], a[52:55], v[196:199]
 ds_read_b64_tr_b16 a[20:21], v3 offset:46240
 v_cvt_pk_bf16_f32 v66, v252, v253
 v_cvt_pk_bf16_f32 v67, v254, v255
 v_mfma_f32_16x16x32_bf16 v[200:203], v[60:63], a[56:59], v[200:203]
 ds_read_b64_tr_b16 a[22:23], v6 offset:46240
 v_fma_mix_f32 v248, v136, v240, v232 op_sel_hi:[1,0,0]
 v_fma_mix_f32 v249, v136, v241, v233 op_sel:[1,0,0] op_sel_hi:[1,0,0]
 v_mfma_f32_16x16x32_bf16 v[204:207], v[132:135], a[56:59], v[204:207]
 ds_read_b64_tr_b16 a[24:25], v3 offset:46272
 v_fma_mix_f32 v250, v137, v242, v234 op_sel_hi:[1,0,0]
 v_fma_mix_f32 v251, v137, v243, v235 op_sel:[1,0,0] op_sel_hi:[1,0,0]
 v_mfma_f32_16x16x32_bf16 v[208:211], v[60:63], a[60:63], v[208:211]
 ds_read_b64_tr_b16 a[26:27], v6 offset:46272
 v_fma_mix_f32 v252, v138, v244, v236 op_sel_hi:[1,0,0]
 v_fma_mix_f32 v253, v138, v245, v237 op_sel:[1,0,0] op_sel_hi:[1,0,0]
 v_mfma_f32_16x16x32_bf16 v[212:215], v[132:135], a[60:63], v[212:215]
 ds_read_b64_tr_b16 a[28:29], v3 offset:46304
 v_fma_mix_f32 v254, v139, v246, v238 op_sel_hi:[1,0,0]
 v_fma_mix_f32 v255, v139, v247, v239 op_sel:[1,0,0] op_sel_hi:[1,0,0]
 v_mfma_f32_16x16x32_bf16 v[216:219], v[60:63], a[64:67], v[216:219]
 ds_read_b64_tr_b16 a[30:31], v6 offset:46304
 v_cvt_pk_bf16_f32 v136, v248, v249
 v_cvt_pk_bf16_f32 v137, v250, v251
 v_mfma_f32_16x16x32_bf16 v[220:223], v[132:135], a[64:67], v[220:223]
 ds_read_b64_tr_b16 a[32:33], v3 offset:46336
 v_cvt_pk_bf16_f32 v138, v252, v253
 v_cvt_pk_bf16_f32 v139, v254, v255
 v_mfma_f32_16x16x32_bf16 v[224:227], v[60:63], a[68:71], v[224:227]
 ds_read_b64_tr_b16 a[34:35], v6 offset:46336
 v_mfma_f32_16x16x32_bf16 v[228:231], v[132:135], a[68:71], v[228:231]
 s_waitcnt lgkmcnt(0)
 v_mfma_f32_16x16x32_bf16 v[160:163], v[64:67], a[0:3], v[160:163]
 ds_read_b128 v[232:235], v8 offset:1664
 ds_read_b128 v[236:239], v8 offset:1680
 ds_read_b128 v[240:243], v8 offset:3968
 ds_read_b128 v[244:247], v8 offset:3984
 v_mfma_f32_16x16x32_bf16 v[164:167], v[136:139], a[0:3], v[164:167]
 ds_read_b64_tr_b16 a[36:37], v3 offset:55296
 ds_read_b64_tr_b16 a[38:39], v6 offset:55296
 v_mfma_f32_16x16x32_bf16 v[168:171], v[64:67], a[4:7], v[168:171]
 ds_read_b64_tr_b16 a[40:41], v3 offset:55328
 ds_read_b64_tr_b16 a[42:43], v6 offset:55328
 v_mfma_f32_16x16x32_bf16 v[172:175], v[136:139], a[4:7], v[172:175]
 ds_read_b64_tr_b16 a[44:45], v3 offset:55360
 ds_read_b64_tr_b16 a[46:47], v6 offset:55360
 v_mfma_f32_16x16x32_bf16 v[176:179], v[64:67], a[8:11], v[176:179]
 s_waitcnt lgkmcnt(6)
 v_fma_mix_f32 v248, v68, v240, v232 op_sel_hi:[1,0,0]
 v_fma_mix_f32 v249, v68, v241, v233 op_sel:[1,0,0] op_sel_hi:[1,0,0]
 v_mfma_f32_16x16x32_bf16 v[180:183], v[136:139], a[8:11], v[180:183]
 ds_read_b64_tr_b16 a[48:49], v3 offset:55392
 v_fma_mix_f32 v250, v69, v242, v234 op_sel_hi:[1,0,0]
 v_fma_mix_f32 v251, v69, v243, v235 op_sel:[1,0,0] op_sel_hi:[1,0,0]
 v_mfma_f32_16x16x32_bf16 v[184:187], v[64:67], a[12:15], v[184:187]
 ds_read_b64_tr_b16 a[50:51], v6 offset:55392
 v_fma_mix_f32 v252, v70, v244, v236 op_sel_hi:[1,0,0]
 v_fma_mix_f32 v253, v70, v245, v237 op_sel:[1,0,0] op_sel_hi:[1,0,0]
 v_mfma_f32_16x16x32_bf16 v[188:191], v[136:139], a[12:15], v[188:191]
 ds_read_b64_tr_b16 a[52:53], v3 offset:55424
 v_fma_mix_f32 v254, v71, v246, v238 op_sel_hi:[1,0,0]
 v_fma_mix_f32 v255, v71, v247, v239 op_sel:[1,0,0] op_sel_hi:[1,0,0]
 v_mfma_f32_16x16x32_bf16 v[192:195], v[64:67], a[16:19], v[192:195]
 ds_read_b64_tr_b16 a[54:55], v6 offset:55424
 v_cvt_pk_bf16_f32 v68, v248, v249
 v_cvt_pk_bf16_f32 v69, v250, v251
 v_mfma_f32_16x16x32_bf16 v[196:199], v[136:139], a[16:19], v[196:199]
 ds_read_b64_tr_b16 a[56:57], v3 offset:55456
 v_cvt_pk_bf16_f32 v70, v252, v253
 v_cvt_pk_bf16_f32 v71, v254, v255
 v_mfma_f32_16x16x32_bf16 v[200:203], v[64:67], a[20:23], v[200:203]
 ds_read_b64_tr_b16 a[58:59], v6 offset:55456
 v_fma_mix_f32 v248, v140, v240, v232 op_sel_hi:[1,0,0]
 v_fma_mix_f32 v249, v140, v241, v233 op_sel:[1,0,0] op_sel_hi:[1,0,0]
 v_mfma_f32_16x16x32_bf16 v[204:207], v[136:139], a[20:23], v[204:207]
 ds_read_b64_tr_b16 a[60:61], v3 offset:55488
 v_fma_mix_f32 v250, v141, v242, v234 op_sel_hi:[1,0,0]
 v_fma_mix_f32 v251, v141, v243, v235 op_sel:[1,0,0] op_sel_hi:[1,0,0]
 v_mfma_f32_16x16x32_bf16 v[208:211], v[64:67], a[24:27], v[208:211]
 ds_read_b64_tr_b16 a[62:63], v6 offset:55488
 v_fma_mix_f32 v252, v142, v244, v236 op_sel_hi:[1,0,0]
 v_fma_mix_f32 v253, v142, v245, v237 op_sel:[1,0,0] op_sel_hi:[1,0,0]
 v_mfma_f32_16x16x32_bf16 v[212:215], v[136:139], a[24:27], v[212:215]
 ds_read_b64_tr_b16 a[64:65], v3 offset:55520
 v_fma_mix_f32 v254, v143, v246, v238 op_sel_hi:[1,0,0]
 v_fma_mix_f32 v255, v143, v247, v239 op_sel:[1,0,0] op_sel_hi:[1,0,0]
 v_mfma_f32_16x16x32_bf16 v[216:219], v[64:67], a[28:31], v[216:219]
 ds_read_b64_tr_b16 a[66:67], v6 offset:55520
 v_cvt_pk_bf16_f32 v140, v248, v249
 v_cvt_pk_bf16_f32 v141, v250, v251
 v_mfma_f32_16x16x32_bf16 v[220:223], v[136:139], a[28:31], v[220:223]
 ds_read_b64_tr_b16 a[68:69], v3 offset:55552
 v_cvt_pk_bf16_f32 v142, v252, v253
 v_cvt_pk_bf16_f32 v143, v254, v255
 v_mfma_f32_16x16x32_bf16 v[224:227], v[64:67], a[32:35], v[224:227]
 ds_read_b64_tr_b16 a[70:71], v6 offset:55552
 v_mfma_f32_16x16x32_bf16 v[228:231], v[136:139], a[32:35], v[228:231]
 s_waitcnt lgkmcnt(0)
 v_mfma_f32_16x16x32_bf16 v[160:163], v[68:71], a[36:39], v[160:163]
 ds_read_b128 v[232:235], v8 offset:1792
 ds_read_b128 v[236:239], v8 offset:1808
 ds_read_b128 v[240:243], v8 offset:4096
 ds_read_b128 v[244:247], v8 offset:4112
 v_mfma_f32_16x16x32_bf16 v[164:167], v[140:143], a[36:39], v[164:167]
 ds_read_b64_tr_b16 a[0:1], v4 offset:0
 ds_read_b64_tr_b16 a[2:3], v7 offset:0
 v_mfma_f32_16x16x32_bf16 v[168:171], v[68:71], a[40:43], v[168:171]
 ds_read_b64_tr_b16 a[4:5], v4 offset:32
 ds_read_b64_tr_b16 a[6:7], v7 offset:32
 v_mfma_f32_16x16x32_bf16 v[172:175], v[140:143], a[40:43], v[172:175]
 ds_read_b64_tr_b16 a[8:9], v4 offset:64
 ds_read_b64_tr_b16 a[10:11], v7 offset:64
 v_mfma_f32_16x16x32_bf16 v[176:179], v[68:71], a[44:47], v[176:179]
 s_waitcnt lgkmcnt(6)
 v_fma_mix_f32 v248, v72, v240, v232 op_sel_hi:[1,0,0]
 v_fma_mix_f32 v249, v72, v241, v233 op_sel:[1,0,0] op_sel_hi:[1,0,0]
 v_mfma_f32_16x16x32_bf16 v[180:183], v[140:143], a[44:47], v[180:183]
 ds_read_b64_tr_b16 a[12:13], v4 offset:96
 v_fma_mix_f32 v250, v73, v242, v234 op_sel_hi:[1,0,0]
 v_fma_mix_f32 v251, v73, v243, v235 op_sel:[1,0,0] op_sel_hi:[1,0,0]
 v_mfma_f32_16x16x32_bf16 v[184:187], v[68:71], a[48:51], v[184:187]
 ds_read_b64_tr_b16 a[14:15], v7 offset:96
 v_fma_mix_f32 v252, v74, v244, v236 op_sel_hi:[1,0,0]
 v_fma_mix_f32 v253, v74, v245, v237 op_sel:[1,0,0] op_sel_hi:[1,0,0]
 v_mfma_f32_16x16x32_bf16 v[188:191], v[140:143], a[48:51], v[188:191]
 ds_read_b64_tr_b16 a[16:17], v4 offset:128
 v_fma_mix_f32 v254, v75, v246, v238 op_sel_hi:[1,0,0]
 v_fma_mix_f32 v255, v75, v247, v239 op_sel:[1,0,0] op_sel_hi:[1,0,0]
 v_mfma_f32_16x16x32_bf16 v[192:195], v[68:71], a[52:55], v[192:195]
 ds_read_b64_tr_b16 a[18:19], v7 offset:128
 v_cvt_pk_bf16_f32 v72, v248, v249
 v_cvt_pk_bf16_f32 v73, v250, v251
 v_mfma_f32_16x16x32_bf16 v[196:199], v[140:143], a[52:55], v[196:199]
 ds_read_b64_tr_b16 a[20:21], v4 offset:160
 v_cvt_pk_bf16_f32 v74, v252, v253
 v_cvt_pk_bf16_f32 v75, v254, v255
 v_mfma_f32_16x16x32_bf16 v[200:203], v[68:71], a[56:59], v[200:203]
 ds_read_b64_tr_b16 a[22:23], v7 offset:160
 v_fma_mix_f32 v248, v144, v240, v232 op_sel_hi:[1,0,0]
 v_fma_mix_f32 v249, v144, v241, v233 op_sel:[1,0,0] op_sel_hi:[1,0,0]
 v_mfma_f32_16x16x32_bf16 v[204:207], v[140:143], a[56:59], v[204:207]
 ds_read_b64_tr_b16 a[24:25], v4 offset:192
 v_fma_mix_f32 v250, v145, v242, v234 op_sel_hi:[1,0,0]
 v_fma_mix_f32 v251, v145, v243, v235 op_sel:[1,0,0] op_sel_hi:[1,0,0]
 v_mfma_f32_16x16x32_bf16 v[208:211], v[68:71], a[60:63], v[208:211]
 ds_read_b64_tr_b16 a[26:27], v7 offset:192
 v_fma_mix_f32 v252, v146, v244, v236 op_sel_hi:[1,0,0]
 v_fma_mix_f32 v253, v146, v245, v237 op_sel:[1,0,0] op_sel_hi:[1,0,0]
 v_mfma_f32_16x16x32_bf16 v[212:215], v[140:143], a[60:63], v[212:215]
 ds_read_b64_tr_b16 a[28:29], v4 offset:224
 v_fma_mix_f32 v254, v147, v246, v238 op_sel_hi:[1,0,0]
 v_fma_mix_f32 v255, v147, v247, v239 op_sel:[1,0,0] op_sel_hi:[1,0,0]
 v_mfma_f32_16x16x32_bf16 v[216:219], v[68:71], a[64:67], v[216:219]
 ds_read_b64_tr_b16 a[30:31], v7 offset:224
 v_cvt_pk_bf16_f32 v144, v248, v249
 v_cvt_pk_bf16_f32 v145, v250, v251
 v_mfma_f32_16x16x32_bf16 v[220:223], v[140:143], a[64:67], v[220:223]
 ds_read_b64_tr_b16 a[32:33], v4 offset:256
 v_cvt_pk_bf16_f32 v146, v252, v253
 v_cvt_pk_bf16_f32 v147, v254, v255
 v_mfma_f32_16x16x32_bf16 v[224:227], v[68:71], a[68:71], v[224:227]
 ds_read_b64_tr_b16 a[34:35], v7 offset:256
 v_mfma_f32_16x16x32_bf16 v[228:231], v[140:143], a[68:71], v[228:231]
 s_waitcnt lgkmcnt(0)
 s_waitcnt vmcnt(0)
 s_barrier
 v_mfma_f32_16x16x32_bf16 v[160:163], v[72:75], a[0:3], v[160:163]
 ds_read_b128 v[232:235], v8 offset:1920
 ds_read_b128 v[236:239], v8 offset:1936
 ds_read_b128 v[240:243], v8 offset:4224
 ds_read_b128 v[244:247], v8 offset:4240
 v_mfma_f32_16x16x32_bf16 v[164:167], v[144:147], a[0:3], v[164:167]
 ds_read_b64_tr_b16 a[36:37], v4 offset:9216
 ds_read_b64_tr_b16 a[38:39], v7 offset:9216
 v_mfma_f32_16x16x32_bf16 v[168:171], v[72:75], a[4:7], v[168:171]
 ds_read_b64_tr_b16 a[40:41], v4 offset:9248
 ds_read_b64_tr_b16 a[42:43], v7 offset:9248
 v_mfma_f32_16x16x32_bf16 v[172:175], v[144:147], a[4:7], v[172:175]
 ds_read_b64_tr_b16 a[44:45], v4 offset:9280
 ds_read_b64_tr_b16 a[46:47], v7 offset:9280
 v_mfma_f32_16x16x32_bf16 v[176:179], v[72:75], a[8:11], v[176:179]
 s_waitcnt lgkmcnt(6)
 v_fma_mix_f32 v248, v76, v240, v232 op_sel_hi:[1,0,0]
 v_fma_mix_f32 v249, v76, v241, v233 op_sel:[1,0,0] op_sel_hi:[1,0,0]
 v_mfma_f32_16x16x32_bf16 v[180:183], v[144:147], a[8:11], v[180:183]
 ds_read_b64_tr_b16 a[48:49], v4 offset:9312
 v_fma_mix_f32 v250, v77, v242, v234 op_sel_hi:[1,0,0]
 v_fma_mix_f32 v251, v77, v243, v235 op_sel:[1,0,0] op_sel_hi:[1,0,0]
 v_mfma_f32_16x16x32_bf16 v[184:187], v[72:75], a[12:15], v[184:187]
 ds_read_b64_tr_b16 a[50:51], v7 offset:9312
 v_fma_mix_f32 v252, v78, v244, v236 op_sel_hi:[1,0,0]
 v_fma_mix_f32 v253, v78, v245, v237 op_sel:[1,0,0] op_sel_hi:[1,0,0]
 v_mfma_f32_16x16x32_bf16 v[188:191], v[144:147], a[12:15], v[188:191]
 ds_read_b64_tr_b16 a[52:53], v4 offset:9344
 v_fma_mix_f32 v254, v79, v246, v238 op_sel_hi:[1,0,0]
 v_fma_mix_f32 v255, v79, v247, v239 op_sel:[1,0,0] op_sel_hi:[1,0,0]
 v_mfma_f32_16x16x32_bf16 v[192:195], v[72:75], a[16:19], v[192:195]
 ds_read_b64_tr_b16 a[54:55], v7 offset:9344
 v_cvt_pk_bf16_f32 v76, v248, v249
 v_cvt_pk_bf16_f32 v77, v250, v251
 v_mfma_f32_16x16x32_bf16 v[196:199], v[144:147], a[16:19], v[196:199]
 ds_read_b64_tr_b16 a[56:57], v4 offset:9376
 v_cvt_pk_bf16_f32 v78, v252, v253
 v_cvt_pk_bf16_f32 v79, v254, v255
 v_mfma_f32_16x16x32_bf16 v[200:203], v[72:75], a[20:23], v[200:203]
 ds_read_b64_tr_b16 a[58:59], v7 offset:9376
 v_fma_mix_f32 v248, v148, v240, v232 op_sel_hi:[1,0,0]
 v_fma_mix_f32 v249, v148, v241, v233 op_sel:[1,0,0] op_sel_hi:[1,0,0]
 v_mfma_f32_16x16x32_bf16 v[204:207], v[144:147], a[20:23], v[204:207]
 ds_read_b64_tr_b16 a[60:61], v4 offset:9408
 v_fma_mix_f32 v250, v149, v242, v234 op_sel_hi:[1,0,0]
 v_fma_mix_f32 v251, v149, v243, v235 op_sel:[1,0,0] op_sel_hi:[1,0,0]
 v_mfma_f32_16x16x32_bf16 v[208:211], v[72:75], a[24:27], v[208:211]
 ds_read_b64_tr_b16 a[62:63], v7 offset:9408
 v_fma_mix_f32 v252, v150, v244, v236 op_sel_hi:[1,0,0]
 v_fma_mix_f32 v253, v150, v245, v237 op_sel:[1,0,0] op_sel_hi:[1,0,0]
 v_mfma_f32_16x16x32_bf16 v[212:215], v[144:147], a[24:27], v[212:215]
 ds_read_b64_tr_b16 a[64:65], v4 offset:9440
 v_fma_mix_f32 v254, v151, v246, v238 op_sel_hi:[1,0,0]
 v_fma_mix_f32 v255, v151, v247, v239 op_sel:[1,0,0] op_sel_hi:[1,0,0]
 v_mfma_f32_16x16x32_bf16 v[216:219], v[72:75], a[28:31], v[216:219]
 ds_read_b64_tr_b16 a[66:67], v7 offset:9440
 v_cvt_pk_bf16_f32 v148, v248, v249
 v_cvt_pk_bf16_f32 v149, v250, v251
 v_mfma_f32_16x16x32_bf16 v[220:223], v[144:147], a[28:31], v[220:223]
 ds_read_b64_tr_b16 a[68:69], v4 offset:9472
 v_cvt_pk_bf16_f32 v150, v252, v253
 v_cvt_pk_bf16_f32 v151, v254, v255
 v_mfma_f32_16x16x32_bf16 v[224:227], v[72:75], a[32:35], v[224:227]
 ds_read_b64_tr_b16 a[70:71], v7 offset:9472
 v_mfma_f32_16x16x32_bf16 v[228:231], v[144:147], a[32:35], v[228:231]
 s_waitcnt lgkmcnt(0)
 v_mfma_f32_16x16x32_bf16 v[160:163], v[76:79], a[36:39], v[160:163]
 ds_read_b128 v[232:235], v8 offset:2048
 ds_read_b128 v[236:239], v8 offset:2064
 ds_read_b128 v[240:243], v8 offset:4352
 ds_read_b128 v[244:247], v8 offset:4368
 v_mfma_f32_16x16x32_bf16 v[164:167], v[148:151], a[36:39], v[164:167]
 ds_read_b64_tr_b16 a[0:1], v2 offset:0
 ds_read_b64_tr_b16 a[2:3], v5 offset:0
 v_mfma_f32_16x16x32_bf16 v[168:171], v[76:79], a[40:43], v[168:171]
 ds_read_b64_tr_b16 a[4:5], v2 offset:32
 ds_read_b64_tr_b16 a[6:7], v5 offset:32
 v_mfma_f32_16x16x32_bf16 v[172:175], v[148:151], a[40:43], v[172:175]
 ds_read_b64_tr_b16 a[8:9], v2 offset:64
 ds_read_b64_tr_b16 a[10:11], v5 offset:64
 v_mfma_f32_16x16x32_bf16 v[176:179], v[76:79], a[44:47], v[176:179]
 s_waitcnt lgkmcnt(6)
 v_fma_mix_f32 v248, v80, v240, v232 op_sel_hi:[1,0,0]
 v_fma_mix_f32 v249, v80, v241, v233 op_sel:[1,0,0] op_sel_hi:[1,0,0]
 v_mfma_f32_16x16x32_bf16 v[180:183], v[148:151], a[44:47], v[180:183]
 ds_read_b64_tr_b16 a[12:13], v2 offset:96
 v_fma_mix_f32 v250, v81, v242, v234 op_sel_hi:[1,0,0]
 v_fma_mix_f32 v251, v81, v243, v235 op_sel:[1,0,0] op_sel_hi:[1,0,0]
 v_mfma_f32_16x16x32_bf16 v[184:187], v[76:79], a[48:51], v[184:187]
 ds_read_b64_tr_b16 a[14:15], v5 offset:96
 v_fma_mix_f32 v252, v82, v244, v236 op_sel_hi:[1,0,0]
 v_fma_mix_f32 v253, v82, v245, v237 op_sel:[1,0,0] op_sel_hi:[1,0,0]
 v_mfma_f32_16x16x32_bf16 v[188:191], v[148:151], a[48:51], v[188:191]
 ds_read_b64_tr_b16 a[16:17], v2 offset:128
 v_fma_mix_f32 v254, v83, v246, v238 op_sel_hi:[1,0,0]
 v_fma_mix_f32 v255, v83, v247, v239 op_sel:[1,0,0] op_sel_hi:[1,0,0]
 v_mfma_f32_16x16x32_bf16 v[192:195], v[76:79], a[52:55], v[192:195]
 ds_read_b64_tr_b16 a[18:19], v5 offset:128
 v_cvt_pk_bf16_f32 v80, v248, v249
 v_cvt_pk_bf16_f32 v81, v250, v251
 v_mfma_f32_16x16x32_bf16 v[196:199], v[148:151], a[52:55], v[196:199]
 ds_read_b64_tr_b16 a[20:21], v2 offset:160
 v_cvt_pk_bf16_f32 v82, v252, v253
 v_cvt_pk_bf16_f32 v83, v254, v255
 v_mfma_f32_16x16x32_bf16 v[200:203], v[76:79], a[56:59], v[200:203]
 ds_read_b64_tr_b16 a[22:23], v5 offset:160
 v_fma_mix_f32 v248, v152, v240, v232 op_sel_hi:[1,0,0]
 v_fma_mix_f32 v249, v152, v241, v233 op_sel:[1,0,0] op_sel_hi:[1,0,0]
 v_mfma_f32_16x16x32_bf16 v[204:207], v[148:151], a[56:59], v[204:207]
 ds_read_b64_tr_b16 a[24:25], v2 offset:192
 v_fma_mix_f32 v250, v153, v242, v234 op_sel_hi:[1,0,0]
 v_fma_mix_f32 v251, v153, v243, v235 op_sel:[1,0,0] op_sel_hi:[1,0,0]
 v_mfma_f32_16x16x32_bf16 v[208:211], v[76:79], a[60:63], v[208:211]
 ds_read_b64_tr_b16 a[26:27], v5 offset:192
 v_fma_mix_f32 v252, v154, v244, v236 op_sel_hi:[1,0,0]
 v_fma_mix_f32 v253, v154, v245, v237 op_sel:[1,0,0] op_sel_hi:[1,0,0]
 v_mfma_f32_16x16x32_bf16 v[212:215], v[148:151], a[60:63], v[212:215]
 ds_read_b64_tr_b16 a[28:29], v2 offset:224
 v_fma_mix_f32 v254, v155, v246, v238 op_sel_hi:[1,0,0]
 v_fma_mix_f32 v255, v155, v247, v239 op_sel:[1,0,0] op_sel_hi:[1,0,0]
 v_mfma_f32_16x16x32_bf16 v[216:219], v[76:79], a[64:67], v[216:219]
 ds_read_b64_tr_b16 a[30:31], v5 offset:224
 v_cvt_pk_bf16_f32 v152, v248, v249
 v_cvt_pk_bf16_f32 v153, v250, v251
 v_mfma_f32_16x16x32_bf16 v[220:223], v[148:151], a[64:67], v[220:223]
 ds_read_b64_tr_b16 a[32:33], v2 offset:256
 v_cvt_pk_bf16_f32 v154, v252, v253
 v_cvt_pk_bf16_f32 v155, v254, v255
 v_mfma_f32_16x16x32_bf16 v[224:227], v[76:79], a[68:71], v[224:227]
 ds_read_b64_tr_b16 a[34:35], v5 offset:256
 v_mfma_f32_16x16x32_bf16 v[228:231], v[148:151], a[68:71], v[228:231]
 s_waitcnt lgkmcnt(0)
 v_mfma_f32_16x16x32_bf16 v[160:163], v[80:83], a[0:3], v[160:163]
 ds_read_b128 v[232:235], v8 offset:2176
 ds_read_b128 v[236:239], v8 offset:2192
 ds_read_b128 v[240:243], v8 offset:4480
 ds_read_b128 v[244:247], v8 offset:4496
 v_mfma_f32_16x16x32_bf16 v[164:167], v[152:155], a[0:3], v[164:167]
 ds_read_b64_tr_b16 a[36:37], v2 offset:9216
 ds_read_b64_tr_b16 a[38:39], v5 offset:9216
 v_mfma_f32_16x16x32_bf16 v[168:171], v[80:83], a[4:7], v[168:171]
 ds_read_b64_tr_b16 a[40:41], v2 offset:9248
 ds_read_b64_tr_b16 a[42:43], v5 offset:9248
 v_mfma_f32_16x16x32_bf16 v[172:175], v[152:155], a[4:7], v[172:175]
 ds_read_b64_tr_b16 a[44:45], v2 offset:9280
 ds_read_b64_tr_b16 a[46:47], v5 offset:9280
 v_mfma_f32_16x16x32_bf16 v[176:179], v[80:83], a[8:11], v[176:179]
 s_waitcnt lgkmcnt(6)
 v_fma_mix_f32 v248, v84, v240, v232 op_sel_hi:[1,0,0]
 v_fma_mix_f32 v249, v84, v241, v233 op_sel:[1,0,0] op_sel_hi:[1,0,0]
 v_mfma_f32_16x16x32_bf16 v[180:183], v[152:155], a[8:11], v[180:183]
 ds_read_b64_tr_b16 a[48:49], v2 offset:9312
 v_fma_mix_f32 v250, v85, v242, v234 op_sel_hi:[1,0,0]
 v_fma_mix_f32 v251, v85, v243, v235 op_sel:[1,0,0] op_sel_hi:[1,0,0]
 v_mfma_f32_16x16x32_bf16 v[184:187], v[80:83], a[12:15], v[184:187]
 ds_read_b64_tr_b16 a[50:51], v5 offset:9312
 v_fma_mix_f32 v252, v86, v244, v236 op_sel_hi:[1,0,0]
 v_fma_mix_f32 v253, v86, v245, v237 op_sel:[1,0,0] op_sel_hi:[1,0,0]
 v_mfma_f32_16x16x32_bf16 v[188:191], v[152:155], a[12:15], v[188:191]
 ds_read_b64_tr_b16 a[52:53], v2 offset:9344
 v_fma_mix_f32 v254, v87, v246, v238 op_sel_hi:[1,0,0]
 v_fma_mix_f32 v255, v87, v247, v239 op_sel:[1,0,0] op_sel_hi:[1,0,0]
 v_mfma_f32_16x16x32_bf16 v[192:195], v[80:83], a[16:19], v[192:195]
 ds_read_b64_tr_b16 a[54:55], v5 offset:9344
 v_cvt_pk_bf16_f32 v84, v248, v249
 v_cvt_pk_bf16_f32 v85, v250, v251
 v_mfma_f32_16x16x32_bf16 v[196:199], v[152:155], a[16:19], v[196:199]
 ds_read_b64_tr_b16 a[56:57], v2 offset:9376
 v_cvt_pk_bf16_f32 v86, v252, v253
 v_cvt_pk_bf16_f32 v87, v254, v255
 v_mfma_f32_16x16x32_bf16 v[200:203], v[80:83], a[20:23], v[200:203]
 ds_read_b64_tr_b16 a[58:59], v5 offset:9376
 v_fma_mix_f32 v248, v156, v240, v232 op_sel_hi:[1,0,0]
 v_fma_mix_f32 v249, v156, v241, v233 op_sel:[1,0,0] op_sel_hi:[1,0,0]
 v_mfma_f32_16x16x32_bf16 v[204:207], v[152:155], a[20:23], v[204:207]
 ds_read_b64_tr_b16 a[60:61], v2 offset:9408
 v_fma_mix_f32 v250, v157, v242, v234 op_sel_hi:[1,0,0]
 v_fma_mix_f32 v251, v157, v243, v235 op_sel:[1,0,0] op_sel_hi:[1,0,0]
 v_mfma_f32_16x16x32_bf16 v[208:211], v[80:83], a[24:27], v[208:211]
 ds_read_b64_tr_b16 a[62:63], v5 offset:9408
 v_fma_mix_f32 v252, v158, v244, v236 op_sel_hi:[1,0,0]
 v_fma_mix_f32 v253, v158, v245, v237 op_sel:[1,0,0] op_sel_hi:[1,0,0]
 v_mfma_f32_16x16x32_bf16 v[212:215], v[152:155], a[24:27], v[212:215]
 ds_read_b64_tr_b16 a[64:65], v2 offset:9440
 v_fma_mix_f32 v254, v159, v246, v238 op_sel_hi:[1,0,0]
 v_fma_mix_f32 v255, v159, v247, v239 op_sel:[1,0,0] op_sel_hi:[1,0,0]
 v_mfma_f32_16x16x32_bf16 v[216:219], v[80:83], a[28:31], v[216:219]
 ds_read_b64_tr_b16 a[66:67], v5 offset:9440
 v_cvt_pk_bf16_f32 v156, v248, v249
 v_cvt_pk_bf16_f32 v157, v250, v251
 v_mfma_f32_16x16x32_bf16 v[220:223], v[152:155], a[28:31], v[220:223]
 ds_read_b64_tr_b16 a[68:69], v2 offset:9472
 v_cvt_pk_bf16_f32 v158, v252, v253
 v_cvt_pk_bf16_f32 v159, v254, v255
 v_mfma_f32_16x16x32_bf16 v[224:227], v[80:83], a[32:35], v[224:227]
 ds_read_b64_tr_b16 a[70:71], v5 offset:9472
 v_mfma_f32_16x16x32_bf16 v[228:231], v[152:155], a[32:35], v[228:231]
 s_waitcnt lgkmcnt(0)
 v_mfma_f32_16x16x32_bf16 v[160:163], v[84:87], a[36:39], v[160:163]
 v_mfma_f32_16x16x32_bf16 v[164:167], v[156:159], a[36:39], v[164:167]
 v_mfma_f32_16x16x32_bf16 v[168:171], v[84:87], a[40:43], v[168:171]
 v_mfma_f32_16x16x32_bf16 v[172:175], v[156:159], a[40:43], v[172:175]
 v_mfma_f32_16x16x32_bf16 v[176:179], v[84:87], a[44:47], v[176:179]
 v_mfma_f32_16x16x32_bf16 v[180:183], v[156:159], a[44:47], v[180:183]
 v_mfma_f32_16x16x32_bf16 v[184:187], v[84:87], a[48:51], v[184:187]
 v_mfma_f32_16x16x32_bf16 v[188:191], v[156:159], a[48:51], v[188:191]
 v_mfma_f32_16x16x32_bf16 v[192:195], v[84:87], a[52:55], v[192:195]
 v_mfma_f32_16x16x32_bf16 v[196:199], v[156:159], a[52:55], v[196:199]
 v_mfma_f32_16x16x32_bf16 v[200:203], v[84:87], a[56:59], v[200:203]
 v_mfma_f32_16x16x32_bf16 v[204:207], v[156:159], a[56:59], v[204:207]
 v_mfma_f32_16x16x32_bf16 v[208:211], v[84:87], a[60:63], v[208:211]
 v_mfma_f32_16x16x32_bf16 v[212:215], v[156:159], a[60:63], v[212:215]
 v_mfma_f32_16x16x32_bf16 v[216:219], v[84:87], a[64:67], v[216:219]
 v_mfma_f32_16x16x32_bf16 v[220:223], v[156:159], a[64:67], v[220:223]
 v_mfma_f32_16x16x32_bf16 v[224:227], v[84:87], a[68:71], v[224:227]
 v_mfma_f32_16x16x32_bf16 v[228:231], v[156:159], a[68:71], v[228:231]
 s_sub_u32 s39, s34, 8
 s_lshl_b32 s39, s39, 3
 s_mul_i32 s35, s39, 151552
 s_mul_i32 s36, s38, 1216
 s_add_u32 s35, s35, s36
 s_add_u32 s35, s35, 73728
 v_lshrrev_b32 v13, 4, v0
 v_and_b32 v14, 1, v13
 v_mul_u32_u24 v14, 304, v14
 v_lshrrev_b32 v13, 1, v13
 v_lshlrev_b32 v13, 3, v13
 v_add_u32 v14, v14, v13
 v_and_b32 v15, 15, v0
 s_mov_b32 s36, 151552
 v_add_u32 v10, 0, v15
 v_mul_u32_u24 v11, 3641, v10
 v_lshrrev_b32 v11, 16, v11
 v_mul_u32_u24 v13, 18, v11
 v_sub_u32 v10, v10, v13
 v_mul_lo_u32 v11, v11, s36
 v_lshlrev_b32 v10, 4, v10
 v_add_u32 v10, v10, v11
 v_add_u32 v10, v10, v14
 v_cvt_pk_bf16_f32 v160, v160, v161
 v_cvt_pk_bf16_f32 v161, v162, v163
 buffer_store_dwordx2 v[160:161], v10, s[44:47], s35 offen offset:0
 v_cvt_pk_bf16_f32 v164, v164, v165
 v_cvt_pk_bf16_f32 v165, v166, v167
 buffer_store_dwordx2 v[164:165], v10, s[44:47], s35 offen offset:608
 v_add_u32 v10, 16, v15
 v_mul_u32_u24 v11, 3641, v10
 v_lshrrev_b32 v11, 16, v11
 v_mul_u32_u24 v13, 18, v11
 v_sub_u32 v10, v10, v13
 v_mul_lo_u32 v11, v11, s36
 v_lshlrev_b32 v10, 4, v10
 v_add_u32 v10, v10, v11
 v_add_u32 v10, v10, v14
 v_cvt_pk_bf16_f32 v168, v168, v169
 v_cvt_pk_bf16_f32 v169, v170, v171
 buffer_store_dwordx2 v[168:169], v10, s[44:47], s35 offen offset:0
 v_cvt_pk_bf16_f32 v172, v172, v173
 v_cvt_pk_bf16_f32 v173, v174, v175
 buffer_store_dwordx2 v[172:173], v10, s[44:47], s35 offen offset:608
 v_add_u32 v10, 32, v15
 v_mul_u32_u24 v11, 3641, v10
 v_lshrrev_b32 v11, 16, v11
 v_mul_u32_u24 v13, 18, v11
 v_sub_u32 v10, v10, v13
 v_mul_lo_u32 v11, v11, s36
 v_lshlrev_b32 v10, 4, v10
 v_add_u32 v10, v10, v11
 v_add_u32 v10, v10, v14
 v_cvt_pk_bf16_f32 v176, v176, v177
 v_cvt_pk_bf16_f32 v177, v178, v179
 buffer_store_dwordx2 v[176:177], v10, s[44:47], s35 offen offset:0
 v_cvt_pk_bf16_f32 v180, v180, v181
 v_cvt_pk_bf16_f32 v181, v182, v183
 buffer_store_dwordx2 v[180:181], v10, s[44:47], s35 offen offset:608
 v_add_u32 v10, 48, v15
 v_mul_u32_u24 v11, 3641, v10
 v_lshrrev_b32 v11, 16, v11
 v_mul_u32_u24 v13, 18, v11
 v_sub_u32 v10, v10, v13
 v_mul_lo_u32 v11, v11, s36
 v_lshlrev_b32 v10, 4, v10
 v_add_u32 v10, v10, v11
 v_add_u32 v10, v10, v14
 v_cvt_pk_bf16_f32 v184, v184, v185
 v_cvt_pk_bf16_f32 v185, v186, v187
 buffer_store_dwordx2 v[184:185], v10, s[44:47], s35 offen offset:0
 v_cvt_pk_bf16_f32 v188, v188, v189
 v_cvt_pk_bf16_f32 v189, v190, v191
 buffer_store_dwordx2 v[188:189], v10, s[44:47], s35 offen offset:608
 v_add_u32 v10, 64, v15
 v_mul_u32_u24 v11, 3641, v10
 v_lshrrev_b32 v11, 16, v11
 v_mul_u32_u24 v13, 18, v11
 v_sub_u32 v10, v10, v13
 v_mul_lo_u32 v11, v11, s36
 v_lshlrev_b32 v10, 4, v10
 v_add_u32 v10, v10, v11
 v_add_u32 v10, v10, v14
 v_cvt_pk_bf16_f32 v192, v192, v193
 v_cvt_pk_bf16_f32 v193, v194, v195
 buffer_store_dwordx2 v[192:193], v10, s[44:47], s35 offen offset:0
 v_cvt_pk_bf16_f32 v196, v196, v197
 v_cvt_pk_bf16_f32 v197, v198, v199
 buffer_store_dwordx2 v[196:197], v10, s[44:47], s35 offen offset:608
 v_add_u32 v10, 80, v15
 v_mul_u32_u24 v11, 3641, v10
 v_lshrrev_b32 v11, 16, v11
 v_mul_u32_u24 v13, 18, v11
 v_sub_u32 v10, v10, v13
 v_mul_lo_u32 v11, v11, s36
 v_lshlrev_b32 v10, 4, v10
 v_add_u32 v10, v10, v11
 v_add_u32 v10, v10, v14
 v_cvt_pk_bf16_f32 v200, v200, v201
 v_cvt_pk_bf16_f32 v201, v202, v203
 buffer_store_dwordx2 v[200:201], v10, s[44:47], s35 offen offset:0
 v_cvt_pk_bf16_f32 v204, v204, v205
 v_cvt_pk_bf16_f32 v205, v206, v207
 buffer_store_dwordx2 v[204:205], v10, s[44:47], s35 offen offset:608
 v_add_u32 v10, 96, v15
 v_mul_u32_u24 v11, 3641, v10
 v_lshrrev_b32 v11, 16, v11
 v_mul_u32_u24 v13, 18, v11
 v_sub_u32 v10, v10, v13
 v_mul_lo_u32 v11, v11, s36
 v_lshlrev_b32 v10, 4, v10
 v_add_u32 v10, v10, v11
 v_add_u32 v10, v10, v14
 v_cvt_pk_bf16_f32 v208, v208, v209
 v_cvt_pk_bf16_f32 v209, v210, v211
 buffer_store_dwordx2 v[208:209], v10, s[44:47], s35 offen offset:0
 v_cvt_pk_bf16_f32 v212, v212, v213
 v_cvt_pk_bf16_f32 v213, v214, v215
 buffer_store_dwordx2 v[212:213], v10, s[44:47], s35 offen offset:608
 v_add_u32 v10, 112, v15
 v_mul_u32_u24 v11, 3641, v10
 v_lshrrev_b32 v11, 16, v11
 v_mul_u32_u24 v13, 18, v11
 v_sub_u32 v10, v10, v13
 v_mul_lo_u32 v11, v11, s36
 v_lshlrev_b32 v10, 4, v10
 v_add_u32 v10, v10, v11
 v_add_u32 v10, v10, v14
 v_cvt_pk_bf16_f32 v216, v216, v217
 v_cvt_pk_bf16_f32 v217, v218, v219
 buffer_store_dwordx2 v[216:217], v10, s[44:47], s35 offen offset:0
 v_cvt_pk_bf16_f32 v220, v220, v221
 v_cvt_pk_bf16_f32 v221, v222, v223
 buffer_store_dwordx2 v[220:221], v10, s[44:47], s35 offen offset:608
 v_add_u32 v10, 128, v15
 v_mul_u32_u24 v11, 3641, v10
 v_lshrrev_b32 v11, 16, v11
 v_mul_u32_u24 v13, 18, v11
 v_sub_u32 v10, v10, v13
 v_mul_lo_u32 v11, v11, s36
 v_lshlrev_b32 v10, 4, v10
 v_add_u32 v10, v10, v11
 v_add_u32 v10, v10, v14
 v_cvt_pk_bf16_f32 v224, v224, v225
 v_cvt_pk_bf16_f32 v225, v226, v227
 buffer_store_dwordx2 v[224:225], v10, s[44:47], s35 offen offset:0
 v_cvt_pk_bf16_f32 v228, v228, v229
 v_cvt_pk_bf16_f32 v229, v230, v231
 buffer_store_dwordx2 v[228:229], v10, s[44:47], s35 offen offset:608
 v_lshrrev_b32 v10, 2, v0
 v_mul_lo_u32 v10, v10, s36
 v_bfe_u32 v11, v0, 1, 1
 v_mul_u32_u24 v11, 608, v11
 v_add_u32 v10, v10, v11
 v_and_b32 v11, 1, v0
 v_mul_u32_u24 v11, 304, v11
 v_add_u32 v10, v10, v11
 v_add_u32 v10, 288, v10
 v_mov_b32 v11, 0x7fffffff
 v_cmp_gt_u32 vcc, 32, v0
 s_nop 1
 v_cndmask_b32 v10, v11, v10, vcc
 v_mov_b32 v16, 0x3f803f80
 v_mov_b32 v17, 0x3f803f80
 v_mov_b32 v18, 0x3f803f80
 v_mov_b32 v19, 0x3f803f80
 buffer_store_dwordx4 v[16:19], v10, s[44:47], s35 offen
L_k01_fin:
 s_branch L_k01_end
L_k01_mod:
 s_sub_u32 s34, s2, 192
 s_load_dwordx2 s[6:7], s[0:1], 56
 s_load_dwordx2 s[8:9], s[0:1], 64
 s_load_dwordx2 s[10:11], s[0:1], 80
 v_and_b32 v1, 7, v0
 v_lshrrev_b32 v2, 3, v0
 v_mul_u32_u24 v3, 6912, v2
 v_lshlrev_b32 v4, 4, v1
 v_add_u32 v3, v3, v4
 s_lshl_b32 s32, s34, 7
 v_add_u32 v3, s32, v3
 v_lshlrev_b32 v4, 1, v2
 s_waitcnt lgkmcnt(0)
 s_mov_b32 s12, s8
 s_mov_b32 s13, s9
 s_mov_b32 s14, 3981312
 s_mov_b32 s15, 0x20000
 s_mov_b32 s16, s6
 s_mov_b32 s17, s7
 s_mov_b32 s18, 1152
 s_mov_b32 s19, 0x20000
 s_mov_b32 s20, s4
 s_mov_b32 s21, s5
 s_mov_b32 s22, 13824
 s_mov_b32 s23, 0x20000
 s_mov_b32 s24, s10
 s_mov_b32 s25, s11
 s_mov_b32 s26, 256
 s_mov_b32 s27, 0x20000
 buffer_load_ushort v8, v4, s[16:19], 0 offen offset:0
 buffer_load_ushort v9, v4, s[16:19], 0 offen offset:64
 buffer_load_ushort v10, v4, s[16:19], 0 offen offset:128
 buffer_load_ushort v11, v4, s[16:19], 0 offen offset:192
 buffer_load_ushort v12, v4, s[16:19], 0 offen offset:256
 buffer_load_ushort v13, v4, s[16:19], 0 offen offset:320
 buffer_load_ushort v14, v4, s[16:19], 0 offen offset:384
 buffer_load_ushort v15, v4, s[16:19], 0 offen offset:448
 buffer_load_ushort v16, v4, s[16:19], 0 offen offset:512
 buffer_load_ushort v17, v4, s[16:19], 0 offen offset:576
 buffer_load_ushort v18, v4, s[16:19], 0 offen offset:640
 buffer_load_ushort v19, v4, s[16:19], 0 offen offset:704
 buffer_load_ushort v20, v4, s[16:19], 0 offen offset:768
 buffer_load_ushort v21, v4, s[16:19], 0 offen offset:832
 buffer_load_ushort v22, v4, s[16:19], 0 offen offset:896
 buffer_load_ushort v23, v4, s[16:19], 0 offen offset:960
 buffer_load_ushort v24, v4, s[16:19], 0 offen offset:1024
 buffer_load_ushort v25, v4, s[16:19], 0 offen offset:1088
 s_mov_b32 s32, 0
 buffer_load_dwordx4 v[28:31], v3, s[12:15], s32 offen
 s_mov_b32 s32, 221184
 buffer_load_dwordx4 v[32:35], v3, s[12:15], s32 offen
 s_mov_b32 s32, 442368
 buffer_load_dwordx4 v[36:39], v3, s[12:15], s32 offen
 s_mov_b32 s32, 663552
 buffer_load_dwordx4 v[40:43], v3, s[12:15], s32 offen
 s_mov_b32 s32, 884736
 buffer_load_dwordx4 v[44:47], v3, s[12:15], s32 offen
 s_mov_b32 s32, 1105920
 buffer_load_dwordx4 v[48:51], v3, s[12:15], s32 offen
 s_mov_b32 s32, 1327104
 buffer_load_dwordx4 v[52:55], v3, s[12:15], s32 offen
 s_mov_b32 s32, 1548288
 buffer_load_dwordx4 v[56:59], v3, s[12:15], s32 offen
 s_mov_b32 s32, 1769472
 buffer_load_dwordx4 v[60:63], v3, s[12:15], s32 offen
 s_mov_b32 s32, 1990656
 buffer_load_dwordx4 v[64:67], v3, s[12:15], s32 offen
 s_mov_b32 s32, 2211840
 buffer_load_dwordx4 v[68:71], v3, s[12:15], s32 offen
 s_mov_b32 s32, 2433024
 buffer_load_dwordx4 v[72:75], v3, s[12:15], s32 offen
 s_mov_b32 s32, 2654208
 buffer_load_dwordx4 v[76:79], v3, s[12:15], s32 offen
 s_mov_b32 s32, 2875392
 buffer_load_dwordx4 v[80:83], v3, s[12:15], s32 offen
 s_mov_b32 s32, 3096576
 buffer_load_dwordx4 v[84:87], v3, s[12:15], s32 offen
 s_mov_b32 s32, 3317760
 buffer_load_dwordx4 v[88:91], v3, s[12:15], s32 offen
 s_mov_b32 s32, 3538944
 buffer_load_dwordx4 v[92:95], v3, s[12:15], s32 offen
 s_mov_b32 s32, 3760128
 buffer_load_dwordx4 v[96:99], v3, s[12:15], s32 offen
 s_waitcnt vmcnt(18)
 v_lshlrev_b32 v8, 16, v8
 v_lshlrev_b32 v9, 16, v9
 v_lshlrev_b32 v10, 16, v10
 v_lshlrev_b32 v11, 16, v11
 v_lshlrev_b32 v12, 16, v12
 v_lshlrev_b32 v13, 16, v13
 v_lshlrev_b32 v14, 16, v14
 v_lshlrev_b32 v15, 16, v15
 v_lshlrev_b32 v16, 16, v16
 v_lshlrev_b32 v17, 16, v17
 v_lshlrev_b32 v18, 16, v18
 v_lshlrev_b32 v19, 16, v19
 v_lshlrev_b32 v20, 16, v20
 v_lshlrev_b32 v21, 16, v21
 v_lshlrev_b32 v22, 16, v22
 v_lshlrev_b32 v23, 16, v23
 v_lshlrev_b32 v24, 16, v24
 v_lshlrev_b32 v25, 16, v25
 v_mul_f32 v100, 0xbfb8aa3b, v8
 v_mul_f32 v101, 0xbfb8aa3b, v9
 v_mul_f32 v102, 0xbfb8aa3b, v10
 v_mul_f32 v103, 0xbfb8aa3b, v11
 v_mul_f32 v104, 0xbfb8aa3b, v12
 v_mul_f32 v105, 0xbfb8aa3b, v13
 v_exp_f32 v100, v100
 v_exp_f32 v101, v101
 v_exp_f32 v102, v102
 v_exp_f32 v103, v103
 v_exp_f32 v104, v104
 v_exp_f32 v105, v105
 v_add_f32 v100, 1.0, v100
 v_add_f32 v101, 1.0, v101
 v_add_f32 v102, 1.0, v102
 v_add_f32 v103, 1.0, v103
 v_add_f32 v104, 1.0, v104
 v_add_f32 v105, 1.0, v105
 v_rcp_f32 v100, v100
 v_rcp_f32 v101, v101
 v_rcp_f32 v102, v102
 v_rcp_f32 v103, v103
 v_rcp_f32 v104, v104
 v_rcp_f32 v105, v105
 v_mul_f32 v8, v8, v100
 v_mul_f32 v9, v9, v101
 v_mul_f32 v10, v10, v102
 v_mul_f32 v11, v11, v103
 v_mul_f32 v12, v12, v104
 v_mul_f32 v13, v13, v105
 v_cvt_pk_bf16_f32 v8, v8, v8
 v_cvt_pk_bf16_f32 v9, v9, v9
 v_cvt_pk_bf16_f32 v10, v10, v10
 v_cvt_pk_bf16_f32 v11, v11, v11
 v_cvt_pk_bf16_f32 v12, v12, v12
 v_cvt_pk_bf16_f32 v13, v13, v13
 v_lshlrev_b32 v8, 16, v8
 v_lshlrev_b32 v9, 16, v9
 v_lshlrev_b32 v10, 16, v10
 v_lshlrev_b32 v11, 16, v11
 v_lshlrev_b32 v12, 16, v12
 v_lshlrev_b32 v13, 16, v13
 v_mul_f32 v100, 0xbfb8aa3b, v14
 v_mul_f32 v101, 0xbfb8aa3b, v15
 v_mul_f32 v102, 0xbfb8aa3b, v16
 v_mul_f32 v103, 0xbfb8aa3b, v17
 v_mul_f32 v104, 0xbfb8aa3b, v18
 v_mul_f32 v105, 0xbfb8aa3b, v19
 v_exp_f32 v100, v100
 v_exp_f32 v101, v101
 v_exp_f32 v102, v102
 v_exp_f32 v103, v103
 v_exp_f32 v104, v104
 v_exp_f32 v105, v105
 v_add_f32 v100, 1.0, v100
 v_add_f32 v101, 1.0, v101
 v_add_f32 v102, 1.0, v102
 v_add_f32 v103, 1.0, v103
 v_add_f32 v104, 1.0, v104
 v_add_f32 v105, 1.0, v105
 v_rcp_f32 v100, v100
 v_rcp_f32 v101, v101
 v_rcp_f32 v102, v102
 v_rcp_f32 v103, v103
 v_rcp_f32 v104, v104
 v_rcp_f32 v105, v105
 v_mul_f32 v14, v14, v100
 v_mul_f32 v15, v15, v101
 v_mul_f32 v16, v16, v102
 v_mul_f32 v17, v17, v103
 v_mul_f32 v18, v18, v104
 v_mul_f32 v19, v19, v105
 v_cvt_pk_bf16_f32 v14, v14, v14
 v_cvt_pk_bf16_f32 v15, v15, v15
 v_cvt_pk_bf16_f32 v16, v16, v16
 v_cvt_pk_bf16_f32 v17, v17, v17
 v_cvt_pk_bf16_f32 v18, v18, v18
 v_cvt_pk_bf16_f32 v19, v19, v19
 v_lshlrev_b32 v14, 16, v14
 v_lshlrev_b32 v15, 16, v15
 v_lshlrev_b32 v16, 16, v16
 v_lshlrev_b32 v17, 16, v17
 v_lshlrev_b32 v18, 16, v18
 v_lshlrev_b32 v19, 16, v19
 v_mul_f32 v100, 0xbfb8aa3b, v20
 v_mul_f32 v101, 0xbfb8aa3b, v21
 v_mul_f32 v102, 0xbfb8aa3b, v22
 v_mul_f32 v103, 0xbfb8aa3b, v23
 v_mul_f32 v104, 0xbfb8aa3b, v24
 v_mul_f32 v105, 0xbfb8aa3b, v25
 v_exp_f32 v100, v100
 v_exp_f32 v101, v101
 v_exp_f32 v102, v102
 v_exp_f32 v103, v103
 v_exp_f32 v104, v104
 v_exp_f32 v105, v105
 v_add_f32 v100, 1.0, v100
 v_add_f32 v101, 1.0, v101
 v_add_f32 v102, 1.0, v102
 v_add_f32 v103, 1.0, v103
 v_add_f32 v104, 1.0, v104
 v_add_f32 v105, 1.0, v105
 v_rcp_f32 v100, v100
 v_rcp_f32 v101, v101
 v_rcp_f32 v102, v102
 v_rcp_f32 v103, v103
 v_rcp_f32 v104, v104
 v_rcp_f32 v105, v105
 v_mul_f32 v20, v20, v100
 v_mul_f32 v21, v21, v101
 v_mul_f32 v22, v22, v102
 v_mul_f32 v23, v23, v103
 v_mul_f32 v24, v24, v104
 v_mul_f32 v25, v25, v105
 v_cvt_pk_bf16_f32 v20, v20, v20
 v_cvt_pk_bf16_f32 v21, v21, v21
 v_cvt_pk_bf16_f32 v22, v22, v22
 v_cvt_pk_bf16_f32 v23, v23, v23
 v_cvt_pk_bf16_f32 v24, v24, v24
 v_cvt_pk_bf16_f32 v25, v25, v25
 v_lshlrev_b32 v20, 16, v20
 v_lshlrev_b32 v21, 16, v21
 v_lshlrev_b32 v22, 16, v22
 v_lshlrev_b32 v23, 16, v23
 v_lshlrev_b32 v24, 16, v24
 v_lshlrev_b32 v25, 16, v25
 v_mov_b32 v108, 0
 v_mov_b32 v109, 0
 v_mov_b32 v110, 0
 v_mov_b32 v111, 0
 v_mov_b32 v112, 0
 v_mov_b32 v113, 0
 v_mov_b32 v114, 0
 v_mov_b32 v115, 0
 s_waitcnt vmcnt(17)
 v_lshlrev_b32 v100, 16, v28
 v_and_b32 v101, 0xffff0000, v28
 v_fmac_f32 v108, v100, v8
 v_fmac_f32 v109, v101, v8
 v_lshlrev_b32 v102, 16, v29
 v_and_b32 v103, 0xffff0000, v29
 v_fmac_f32 v110, v102, v8
 v_fmac_f32 v111, v103, v8
 v_lshlrev_b32 v100, 16, v30
 v_and_b32 v101, 0xffff0000, v30
 v_fmac_f32 v112, v100, v8
 v_fmac_f32 v113, v101, v8
 v_lshlrev_b32 v102, 16, v31
 v_and_b32 v103, 0xffff0000, v31
 v_fmac_f32 v114, v102, v8
 v_fmac_f32 v115, v103, v8
 s_waitcnt vmcnt(16)
 v_lshlrev_b32 v100, 16, v32
 v_and_b32 v101, 0xffff0000, v32
 v_fmac_f32 v108, v100, v9
 v_fmac_f32 v109, v101, v9
 v_lshlrev_b32 v102, 16, v33
 v_and_b32 v103, 0xffff0000, v33
 v_fmac_f32 v110, v102, v9
 v_fmac_f32 v111, v103, v9
 v_lshlrev_b32 v100, 16, v34
 v_and_b32 v101, 0xffff0000, v34
 v_fmac_f32 v112, v100, v9
 v_fmac_f32 v113, v101, v9
 v_lshlrev_b32 v102, 16, v35
 v_and_b32 v103, 0xffff0000, v35
 v_fmac_f32 v114, v102, v9
 v_fmac_f32 v115, v103, v9
 s_waitcnt vmcnt(15)
 v_lshlrev_b32 v100, 16, v36
 v_and_b32 v101, 0xffff0000, v36
 v_fmac_f32 v108, v100, v10
 v_fmac_f32 v109, v101, v10
 v_lshlrev_b32 v102, 16, v37
 v_and_b32 v103, 0xffff0000, v37
 v_fmac_f32 v110, v102, v10
 v_fmac_f32 v111, v103, v10
 v_lshlrev_b32 v100, 16, v38
 v_and_b32 v101, 0xffff0000, v38
 v_fmac_f32 v112, v100, v10
 v_fmac_f32 v113, v101, v10
 v_lshlrev_b32 v102, 16, v39
 v_and_b32 v103, 0xffff0000, v39
 v_fmac_f32 v114, v102, v10
 v_fmac_f32 v115, v103, v10
 s_waitcnt vmcnt(14)
 v_lshlrev_b32 v100, 16, v40
 v_and_b32 v101, 0xffff0000, v40
 v_fmac_f32 v108, v100, v11
 v_fmac_f32 v109, v101, v11
 v_lshlrev_b32 v102, 16, v41
 v_and_b32 v103, 0xffff0000, v41
 v_fmac_f32 v110, v102, v11
 v_fmac_f32 v111, v103, v11
 v_lshlrev_b32 v100, 16, v42
 v_and_b32 v101, 0xffff0000, v42
 v_fmac_f32 v112, v100, v11
 v_fmac_f32 v113, v101, v11
 v_lshlrev_b32 v102, 16, v43
 v_and_b32 v103, 0xffff0000, v43
 v_fmac_f32 v114, v102, v11
 v_fmac_f32 v115, v103, v11
 s_waitcnt vmcnt(13)
 v_lshlrev_b32 v100, 16, v44
 v_and_b32 v101, 0xffff0000, v44
 v_fmac_f32 v108, v100, v12
 v_fmac_f32 v109, v101, v12
 v_lshlrev_b32 v102, 16, v45
 v_and_b32 v103, 0xffff0000, v45
 v_fmac_f32 v110, v102, v12
 v_fmac_f32 v111, v103, v12
 v_lshlrev_b32 v100, 16, v46
 v_and_b32 v101, 0xffff0000, v46
 v_fmac_f32 v112, v100, v12
 v_fmac_f32 v113, v101, v12
 v_lshlrev_b32 v102, 16, v47
 v_and_b32 v103, 0xffff0000, v47
 v_fmac_f32 v114, v102, v12
 v_fmac_f32 v115, v103, v12
 s_waitcnt vmcnt(12)
 v_lshlrev_b32 v100, 16, v48
 v_and_b32 v101, 0xffff0000, v48
 v_fmac_f32 v108, v100, v13
 v_fmac_f32 v109, v101, v13
 v_lshlrev_b32 v102, 16, v49
 v_and_b32 v103, 0xffff0000, v49
 v_fmac_f32 v110, v102, v13
 v_fmac_f32 v111, v103, v13
 v_lshlrev_b32 v100, 16, v50
 v_and_b32 v101, 0xffff0000, v50
 v_fmac_f32 v112, v100, v13
 v_fmac_f32 v113, v101, v13
 v_lshlrev_b32 v102, 16, v51
 v_and_b32 v103, 0xffff0000, v51
 v_fmac_f32 v114, v102, v13
 v_fmac_f32 v115, v103, v13
 s_waitcnt vmcnt(11)
 v_lshlrev_b32 v100, 16, v52
 v_and_b32 v101, 0xffff0000, v52
 v_fmac_f32 v108, v100, v14
 v_fmac_f32 v109, v101, v14
 v_lshlrev_b32 v102, 16, v53
 v_and_b32 v103, 0xffff0000, v53
 v_fmac_f32 v110, v102, v14
 v_fmac_f32 v111, v103, v14
 v_lshlrev_b32 v100, 16, v54
 v_and_b32 v101, 0xffff0000, v54
 v_fmac_f32 v112, v100, v14
 v_fmac_f32 v113, v101, v14
 v_lshlrev_b32 v102, 16, v55
 v_and_b32 v103, 0xffff0000, v55
 v_fmac_f32 v114, v102, v14
 v_fmac_f32 v115, v103, v14
 s_waitcnt vmcnt(10)
 v_lshlrev_b32 v100, 16, v56
 v_and_b32 v101, 0xffff0000, v56
 v_fmac_f32 v108, v100, v15
 v_fmac_f32 v109, v101, v15
 v_lshlrev_b32 v102, 16, v57
 v_and_b32 v103, 0xffff0000, v57
 v_fmac_f32 v110, v102, v15
 v_fmac_f32 v111, v103, v15
 v_lshlrev_b32 v100, 16, v58
 v_and_b32 v101, 0xffff0000, v58
 v_fmac_f32 v112, v100, v15
 v_fmac_f32 v113, v101, v15
 v_lshlrev_b32 v102, 16, v59
 v_and_b32 v103, 0xffff0000, v59
 v_fmac_f32 v114, v102, v15
 v_fmac_f32 v115, v103, v15
 s_waitcnt vmcnt(9)
 v_lshlrev_b32 v100, 16, v60
 v_and_b32 v101, 0xffff0000, v60
 v_fmac_f32 v108, v100, v16
 v_fmac_f32 v109, v101, v16
 v_lshlrev_b32 v102, 16, v61
 v_and_b32 v103, 0xffff0000, v61
 v_fmac_f32 v110, v102, v16
 v_fmac_f32 v111, v103, v16
 v_lshlrev_b32 v100, 16, v62
 v_and_b32 v101, 0xffff0000, v62
 v_fmac_f32 v112, v100, v16
 v_fmac_f32 v113, v101, v16
 v_lshlrev_b32 v102, 16, v63
 v_and_b32 v103, 0xffff0000, v63
 v_fmac_f32 v114, v102, v16
 v_fmac_f32 v115, v103, v16
 s_waitcnt vmcnt(8)
 v_lshlrev_b32 v100, 16, v64
 v_and_b32 v101, 0xffff0000, v64
 v_fmac_f32 v108, v100, v17
 v_fmac_f32 v109, v101, v17
 v_lshlrev_b32 v102, 16, v65
 v_and_b32 v103, 0xffff0000, v65
 v_fmac_f32 v110, v102, v17
 v_fmac_f32 v111, v103, v17
 v_lshlrev_b32 v100, 16, v66
 v_and_b32 v101, 0xffff0000, v66
 v_fmac_f32 v112, v100, v17
 v_fmac_f32 v113, v101, v17
 v_lshlrev_b32 v102, 16, v67
 v_and_b32 v103, 0xffff0000, v67
 v_fmac_f32 v114, v102, v17
 v_fmac_f32 v115, v103, v17
 s_waitcnt vmcnt(7)
 v_lshlrev_b32 v100, 16, v68
 v_and_b32 v101, 0xffff0000, v68
 v_fmac_f32 v108, v100, v18
 v_fmac_f32 v109, v101, v18
 v_lshlrev_b32 v102, 16, v69
 v_and_b32 v103, 0xffff0000, v69
 v_fmac_f32 v110, v102, v18
 v_fmac_f32 v111, v103, v18
 v_lshlrev_b32 v100, 16, v70
 v_and_b32 v101, 0xffff0000, v70
 v_fmac_f32 v112, v100, v18
 v_fmac_f32 v113, v101, v18
 v_lshlrev_b32 v102, 16, v71
 v_and_b32 v103, 0xffff0000, v71
 v_fmac_f32 v114, v102, v18
 v_fmac_f32 v115, v103, v18
 s_waitcnt vmcnt(6)
 v_lshlrev_b32 v100, 16, v72
 v_and_b32 v101, 0xffff0000, v72
 v_fmac_f32 v108, v100, v19
 v_fmac_f32 v109, v101, v19
 v_lshlrev_b32 v102, 16, v73
 v_and_b32 v103, 0xffff0000, v73
 v_fmac_f32 v110, v102, v19
 v_fmac_f32 v111, v103, v19
 v_lshlrev_b32 v100, 16, v74
 v_and_b32 v101, 0xffff0000, v74
 v_fmac_f32 v112, v100, v19
 v_fmac_f32 v113, v101, v19
 v_lshlrev_b32 v102, 16, v75
 v_and_b32 v103, 0xffff0000, v75
 v_fmac_f32 v114, v102, v19
 v_fmac_f32 v115, v103, v19
 s_waitcnt vmcnt(5)
 v_lshlrev_b32 v100, 16, v76
 v_and_b32 v101, 0xffff0000, v76
 v_fmac_f32 v108, v100, v20
 v_fmac_f32 v109, v101, v20
 v_lshlrev_b32 v102, 16, v77
 v_and_b32 v103, 0xffff0000, v77
 v_fmac_f32 v110, v102, v20
 v_fmac_f32 v111, v103, v20
 v_lshlrev_b32 v100, 16, v78
 v_and_b32 v101, 0xffff0000, v78
 v_fmac_f32 v112, v100, v20
 v_fmac_f32 v113, v101, v20
 v_lshlrev_b32 v102, 16, v79
 v_and_b32 v103, 0xffff0000, v79
 v_fmac_f32 v114, v102, v20
 v_fmac_f32 v115, v103, v20
 s_waitcnt vmcnt(4)
 v_lshlrev_b32 v100, 16, v80
 v_and_b32 v101, 0xffff0000, v80
 v_fmac_f32 v108, v100, v21
 v_fmac_f32 v109, v101, v21
 v_lshlrev_b32 v102, 16, v81
 v_and_b32 v103, 0xffff0000, v81
 v_fmac_f32 v110, v102, v21
 v_fmac_f32 v111, v103, v21
 v_lshlrev_b32 v100, 16, v82
 v_and_b32 v101, 0xffff0000, v82
 v_fmac_f32 v112, v100, v21
 v_fmac_f32 v113, v101, v21
 v_lshlrev_b32 v102, 16, v83
 v_and_b32 v103, 0xffff0000, v83
 v_fmac_f32 v114, v102, v21
 v_fmac_f32 v115, v103, v21
 s_waitcnt vmcnt(3)
 v_lshlrev_b32 v100, 16, v84
 v_and_b32 v101, 0xffff0000, v84
 v_fmac_f32 v108, v100, v22
 v_fmac_f32 v109, v101, v22
 v_lshlrev_b32 v102, 16, v85
 v_and_b32 v103, 0xffff0000, v85
 v_fmac_f32 v110, v102, v22
 v_fmac_f32 v111, v103, v22
 v_lshlrev_b32 v100, 16, v86
 v_and_b32 v101, 0xffff0000, v86
 v_fmac_f32 v112, v100, v22
 v_fmac_f32 v113, v101, v22
 v_lshlrev_b32 v102, 16, v87
 v_and_b32 v103, 0xffff0000, v87
 v_fmac_f32 v114, v102, v22
 v_fmac_f32 v115, v103, v22
 s_waitcnt vmcnt(2)
 v_lshlrev_b32 v100, 16, v88
 v_and_b32 v101, 0xffff0000, v88
 v_fmac_f32 v108, v100, v23
 v_fmac_f32 v109, v101, v23
 v_lshlrev_b32 v102, 16, v89
 v_and_b32 v103, 0xffff0000, v89
 v_fmac_f32 v110, v102, v23
 v_fmac_f32 v111, v103, v23
 v_lshlrev_b32 v100, 16, v90
 v_and_b32 v101, 0xffff0000, v90
 v_fmac_f32 v112, v100, v23
 v_fmac_f32 v113, v101, v23
 v_lshlrev_b32 v102, 16, v91
 v_and_b32 v103, 0xffff0000, v91
 v_fmac_f32 v114, v102, v23
 v_fmac_f32 v115, v103, v23
 s_waitcnt vmcnt(1)
 v_lshlrev_b32 v100, 16, v92
 v_and_b32 v101, 0xffff0000, v92
 v_fmac_f32 v108, v100, v24
 v_fmac_f32 v109, v101, v24
 v_lshlrev_b32 v102, 16, v93
 v_and_b32 v103, 0xffff0000, v93
 v_fmac_f32 v110, v102, v24
 v_fmac_f32 v111, v103, v24
 v_lshlrev_b32 v100, 16, v94
 v_and_b32 v101, 0xffff0000, v94
 v_fmac_f32 v112, v100, v24
 v_fmac_f32 v113, v101, v24
 v_lshlrev_b32 v102, 16, v95
 v_and_b32 v103, 0xffff0000, v95
 v_fmac_f32 v114, v102, v24
 v_fmac_f32 v115, v103, v24
 s_waitcnt vmcnt(0)
 v_lshlrev_b32 v100, 16, v96
 v_and_b32 v101, 0xffff0000, v96
 v_fmac_f32 v108, v100, v25
 v_fmac_f32 v109, v101, v25
 v_lshlrev_b32 v102, 16, v97
 v_and_b32 v103, 0xffff0000, v97
 v_fmac_f32 v110, v102, v25
 v_fmac_f32 v111, v103, v25
 v_lshlrev_b32 v100, 16, v98
 v_and_b32 v101, 0xffff0000, v98
 v_fmac_f32 v112, v100, v25
 v_fmac_f32 v113, v101, v25
 v_lshlrev_b32 v102, 16, v99
 v_and_b32 v103, 0xffff0000, v99
 v_fmac_f32 v114, v102, v25
 v_fmac_f32 v115, v103, v25
 v_lshlrev_b32 v5, 8, v2
 v_lshlrev_b32 v6, 5, v1
 v_add_u32 v5, v5, v6
 ds_write_b128 v5, v[108:111]
 ds_write_b128 v5, v[112:115] offset:16
 s_waitcnt lgkmcnt(0)
 s_barrier
 v_cmp_gt_u32 vcc, 64, v0
 s_nop 0
 s_and_saveexec_b64 s[40:41], vcc
 s_cbranch_execz L_k01_end
 v_lshlrev_b32 v5, 2, v0
 ds_read_b32 v28, v5 offset:0
 ds_read_b32 v29, v5 offset:256
 ds_read_b32 v30, v5 offset:512
 ds_read_b32 v31, v5 offset:768
 ds_read_b32 v32, v5 offset:1024
 ds_read_b32 v33, v5 offset:1280
 ds_read_b32 v34, v5 offset:1536
 ds_read_b32 v35, v5 offset:1792
 ds_read_b32 v36, v5 offset:2048
 ds_read_b32 v37, v5 offset:2304
 ds_read_b32 v38, v5 offset:2560
 ds_read_b32 v39, v5 offset:2816
 ds_read_b32 v40, v5 offset:3072
 ds_read_b32 v41, v5 offset:3328
 ds_read_b32 v42, v5 offset:3584
 ds_read_b32 v43, v5 offset:3840
 ds_read_b32 v44, v5 offset:4096
 ds_read_b32 v45, v5 offset:4352
 ds_read_b32 v46, v5 offset:4608
 ds_read_b32 v47, v5 offset:4864
 ds_read_b32 v48, v5 offset:5120
 ds_read_b32 v49, v5 offset:5376
 ds_read_b32 v50, v5 offset:5632
 ds_read_b32 v51, v5 offset:5888
 ds_read_b32 v52, v5 offset:6144
 ds_read_b32 v53, v5 offset:6400
 ds_read_b32 v54, v5 offset:6656
 ds_read_b32 v55, v5 offset:6912
 ds_read_b32 v56, v5 offset:7168
 ds_read_b32 v57, v5 offset:7424
 ds_read_b32 v58, v5 offset:7680
 ds_read_b32 v59, v5 offset:7936
 s_waitcnt lgkmcnt(0)
 v_add_f32 v28, v28, v44
 v_add_f32 v29, v29, v45
 v_add_f32 v30, v30, v46
 v_add_f32 v31, v31, v47
 v_add_f32 v32, v32, v48
 v_add_f32 v33, v33, v49
 v_add_f32 v34, v34, v50
 v_add_f32 v35, v35, v51
 v_add_f32 v36, v36, v52
 v_add_f32 v37, v37, v53
 v_add_f32 v38, v38, v54
 v_add_f32 v39, v39, v55
 v_add_f32 v40, v40, v56
 v_add_f32 v41, v41, v57
 v_add_f32 v42, v42, v58
 v_add_f32 v43, v43, v59
 v_add_f32 v28, v28, v36
 v_add_f32 v29, v29, v37
 v_add_f32 v30, v30, v38
 v_add_f32 v31, v31, v39
 v_add_f32 v32, v32, v40
 v_add_f32 v33, v33, v41
 v_add_f32 v34, v34, v42
 v_add_f32 v35, v35, v43
 v_add_f32 v28, v28, v32
 v_add_f32 v29, v29, v33
 v_add_f32 v30, v30, v34
 v_add_f32 v31, v31, v35
 v_add_f32 v28, v28, v30
 v_add_f32 v29, v29, v31
 v_add_f32 v28, v28, v29
 v_cvt_pk_bf16_f32 v28, v28, v28
 v_lshlrev_b32 v28, 16, v28
 s_mul_i32 s33, s34, 7282
 s_lshr_b32 s33, s33, 16
 s_cmp_eq_u32 s33, 1
 s_cbranch_scc1 L_k01_madd
 s_cmp_eq_u32 s33, 4
 s_cbranch_scc0 L_k01_mst
L_k01_madd:
 v_add_f32 v28, 1.0, v28
 v_cvt_pk_bf16_f32 v28, v28, v28
 v_lshlrev_b32 v28, 16, v28
L_k01_mst:
 s_lshl_b32 s32, s34, 8
 buffer_store_dword v28, v5, s[20:23], s32 offen sc1
 s_cmp_lt_u32 s34, 18
 s_cbranch_scc0 L_k01_end
 s_waitcnt vmcnt(0)
 v_mov_b32 v6, 0
 v_mov_b32 v7, 1
 s_mov_b64 exec, 1
 buffer_atomic_add v7, v6, s[24:27], 0 offen sc1
 s_branch L_k01_end
L_k01_end:
 s_endpgm
k01_kernel_codeend:
.globl att_kernel
.p2align 8
.type att_kernel,@function
att_kernel:
 s_cmp_ge_u32 s2, 256
 s_cbranch_scc1 L_att_end
 s_load_dwordx2 s[4:5], s[0:1], 88
 v_lshrrev_b32 v9, 6, v0
 v_and_b32 v0, 63, v0
 v_readfirstlane_b32 s32, v9
 v_lshlrev_b32 v1, 4, v0
 s_cmp_eq_u32 s32, 8
 s_cbranch_scc1 L_att_helper
 s_and_b32 s35, s2, 7
 s_lshl_b32 s33, s35, 2
 s_lshr_b32 s35, s2, 3
 s_and_b32 s35, s35, 3
 s_add_u32 s33, s33, s35
 s_lshr_b32 s34, s2, 5
 s_lshl_b32 s34, s34, 3
 s_add_u32 s34, s34, s32
 s_mul_i32 s40, s33, 151552
 s_lshl_b32 s35, s32, 10
 s_mov_b32 s44, s35
 s_add_u32 s45, s35, 8192
 s_add_u32 s46, s35, 73728
 s_add_u32 s47, s35, 81920
 s_min_u32 s36, s32, 2
 s_cmp_lt_u32 s32, 3
 s_cselect_b32 s36, s36, 2
 s_lshl_b32 s36, s36, 10
 s_add_u32 s48, s36, 90112
 s_mov_b32 s53, 19456
 s_sub_u32 s36, s32, 3
 s_lshl_b32 s54, s36, 10
 s_add_u32 s54, s54, 65536
 s_cmp_lt_u32 s36, 2
 s_cselect_b32 s48, s54, s48
 s_cselect_b32 s53, 2048, s53
 s_waitcnt lgkmcnt(0)
 s_add_u32 s8, s4, 2424832
 s_addc_u32 s9, s5, 0
 s_mov_b32 s10, 4849664
 s_mov_b32 s11, 0x20000
 s_mov_b32 m0, s44
 s_add_u32 s36, s40, s44
 buffer_load_dwordx4 v1, s[8:11], s36 offen lds
 s_add_u32 s44, s44, 16384
 s_mov_b32 m0, s45
 s_add_u32 s36, s40, s45
 buffer_load_dwordx4 v1, s[8:11], s36 offen lds
 s_add_u32 s45, s45, 16384
 s_mov_b32 m0, s46
 s_add_u32 s36, s40, s46
 buffer_load_dwordx4 v1, s[8:11], s36 offen lds
 s_add_u32 s46, s46, 19456
 s_mov_b32 m0, s47
 s_add_u32 s36, s40, s47
 buffer_load_dwordx4 v1, s[8:11], s36 offen lds
 s_add_u32 s47, s47, 19456
 s_mov_b32 m0, s48
 s_add_u32 s36, s40, s48
 buffer_load_dwordx4 v1, s[8:11], s36 offen lds
 s_add_u32 s48, s48, s53
 s_add_u32 s12, s4, 65536
 s_addc_u32 s13, s5, 0
 s_mov_b32 s14, 2097152
 s_mov_b32 s15, 0x20000
 s_add_u32 s16, s4, 2162688
 s_addc_u32 s17, s5, 0
 s_mov_b32 s18, 262144
 s_mov_b32 s19, 0x20000
 v_and_b32 v9, 31, v0
 v_lshlrev_b32 v5, 2, v9
 v_mov_b32 v10, 0x7fffffff
 v_cmp_gt_u32 vcc, 32, v0
 s_nop 1
 v_cndmask_b32 v6, v10, v5, vcc
 s_lshl_b32 s35, s33, 6
 s_add_u32 s35, s35, s34
 s_lshl_b32 s36, s35, 10
 buffer_load_dwordx4 v[12:15], v1, s[12:15], s36 offen
 s_lshl_b32 s36, s35, 7
 buffer_load_dword v16, v6, s[16:19], s36 offen
 s_mov_b32 m0, s44
 s_add_u32 s36, s40, s44
 buffer_load_dwordx4 v1, s[8:11], s36 offen lds
 s_add_u32 s44, s44, 16384
 s_mov_b32 m0, s45
 s_add_u32 s36, s40, s45
 buffer_load_dwordx4 v1, s[8:11], s36 offen lds
 s_add_u32 s45, s45, 16384
 s_mov_b32 m0, s46
 s_add_u32 s36, s40, s46
 buffer_load_dwordx4 v1, s[8:11], s36 offen lds
 s_add_u32 s46, s46, 19456
 s_mov_b32 m0, s47
 s_add_u32 s36, s40, s47
 buffer_load_dwordx4 v1, s[8:11], s36 offen lds
 s_add_u32 s47, s47, 19456
 s_mov_b32 m0, s48
 s_add_u32 s36, s40, s48
 buffer_load_dwordx4 v1, s[8:11], s36 offen lds
 s_add_u32 s48, s48, s53
 s_mov_b32 m0, s44
 s_add_u32 s36, s40, s44
 buffer_load_dwordx4 v1, s[8:11], s36 offen lds
 s_add_u32 s44, s44, 16384
 s_mov_b32 m0, s45
 s_add_u32 s36, s40, s45
 buffer_load_dwordx4 v1, s[8:11], s36 offen lds
 s_add_u32 s45, s45, 16384
 s_mov_b32 m0, s46
 s_add_u32 s36, s40, s46
 buffer_load_dwordx4 v1, s[8:11], s36 offen lds
 s_add_u32 s46, s46, 19456
 s_mov_b32 m0, s47
 s_add_u32 s36, s40, s47
 buffer_load_dwordx4 v1, s[8:11], s36 offen lds
 s_add_u32 s47, s47, 19456
 s_mov_b32 m0, s48
 s_add_u32 s36, s40, s48
 buffer_load_dwordx4 v1, s[8:11], s36 offen lds
 s_add_u32 s48, s48, s53
 s_mov_b32 m0, s44
 s_add_u32 s36, s40, s44
 buffer_load_dwordx4 v1, s[8:11], s36 offen lds
 s_mov_b32 m0, s45
 s_add_u32 s36, s40, s45
 buffer_load_dwordx4 v1, s[8:11], s36 offen lds
 s_mov_b32 m0, s46
 s_add_u32 s36, s40, s46
 buffer_load_dwordx4 v1, s[8:11], s36 offen lds
 s_mov_b32 m0, s47
 s_add_u32 s36, s40, s47
 buffer_load_dwordx4 v1, s[8:11], s36 offen lds
 s_mov_b32 m0, s48
 s_add_u32 s36, s40, s48
 buffer_load_dwordx4 v1, s[8:11], s36 offen lds
 v_mov_b32 v2, v1
 v_lshlrev_b32 v3, 4, v9
 v_add_u32 v3, 65536, v3
 v_lshrrev_b32 v10, 5, v0
 v_mul_u32_u24 v10, 19, v10
 v_add_u32 v11, v9, v10
 v_lshlrev_b32 v4, 4, v11
 v_add_u32 v4, 73728, v4
 v_cmp_gt_u32 vcc, 19, v9
 v_mov_b32 v10, 0x30000
 s_nop 0
 v_cndmask_b32 v4, v10, v4, vcc
 v_mov_b32 v8, v6
 v_lshlrev_b32 v7, 4, v9
 v_lshrrev_b32 v10, 5, v0
 v_lshlrev_b32 v10, 15, v10
 v_add_u32 v7, v7, v10
 s_add_u32 s20, s4, 7274496
 s_addc_u32 s21, s5, 0
 s_mov_b32 s22, 2097152
 s_mov_b32 s23, 0x20000
 s_add_u32 s24, s4, 9371648
 s_addc_u32 s25, s5, 0
 s_mov_b32 s26, 262144
 s_mov_b32 s27, 0x20000
 v_mov_b32 v125, 0
 v_mov_b32 v126, 0
 v_mov_b32 v127, 0
 v_mov_b32 v128, 0
 v_mov_b32 v130, 0
 v_mov_b32 v131, 0
 v_mov_b32 v132, 0
 v_mov_b32 v133, 0
 v_mov_b32 v135, 0
 v_mov_b32 v136, 0
 v_mov_b32 v137, 0
 v_mov_b32 v138, 0
 s_mov_b32 s37, 0
 s_mov_b32 s39, 1
 s_waitcnt vmcnt(15)
 v_mov_b32 v124, v16
 v_mov_b32 v129, v16
 v_mov_b32 v134, v16
 v_mov_b32 v139, v16
 s_barrier
L_att_max:
 v_mov_b32 v5, 0xff800000
 s_mov_b32 s38, 0
L_att_maxloop:
 ds_read_b128 v[100:103], v3
 ds_read_b128 v[92:95], v2 offset:0
 s_waitcnt lgkmcnt(0)
 v_mfma_f32_32x32x16_bf16 v[36:51], v[92:95], v[12:15], 0
 v_mfma_f32_32x32x16_bf16 v[36:51], v[100:103], v[124:127], v[36:51]
 s_nop 11
 v_max3_f32 v5, v5, v36, v37
 v_max3_f32 v5, v5, v38, v39
 v_max3_f32 v5, v5, v40, v41
 v_max3_f32 v5, v5, v42, v43
 v_max3_f32 v5, v5, v44, v45
 v_max3_f32 v5, v5, v46, v47
 v_max3_f32 v5, v5, v48, v49
 v_max3_f32 v5, v5, v50, v51
 s_cmp_eq_u32 s37, 0
 s_cbranch_scc1 L_att_maxdone
 ds_read_b128 v[92:95], v2 offset:1024
 s_waitcnt lgkmcnt(0)
 v_mfma_f32_32x32x16_bf16 v[36:51], v[92:95], v[12:15], 0
 v_mfma_f32_32x32x16_bf16 v[36:51], v[100:103], v[128:131], v[36:51]
 s_nop 11
 v_max3_f32 v5, v5, v36, v37
 v_max3_f32 v5, v5, v38, v39
 v_max3_f32 v5, v5, v40, v41
 v_max3_f32 v5, v5, v42, v43
 v_max3_f32 v5, v5, v44, v45
 v_max3_f32 v5, v5, v46, v47
 v_max3_f32 v5, v5, v48, v49
 v_max3_f32 v5, v5, v50, v51
 ds_read_b128 v[92:95], v2 offset:2048
 s_waitcnt lgkmcnt(0)
 v_mfma_f32_32x32x16_bf16 v[36:51], v[92:95], v[12:15], 0
 v_mfma_f32_32x32x16_bf16 v[36:51], v[100:103], v[132:135], v[36:51]
 s_nop 11
 v_max3_f32 v5, v5, v36, v37
 v_max3_f32 v5, v5, v38, v39
 v_max3_f32 v5, v5, v40, v41
 v_max3_f32 v5, v5, v42, v43
 v_max3_f32 v5, v5, v44, v45
 v_max3_f32 v5, v5, v46, v47
 v_max3_f32 v5, v5, v48, v49
 v_max3_f32 v5, v5, v50, v51
 ds_read_b128 v[92:95], v2 offset:3072
 s_waitcnt lgkmcnt(0)
 v_mfma_f32_32x32x16_bf16 v[36:51], v[92:95], v[12:15], 0
 v_mfma_f32_32x32x16_bf16 v[36:51], v[100:103], v[136:139], v[36:51]
 s_nop 11
 v_max3_f32 v5, v5, v36, v37
 v_max3_f32 v5, v5, v38, v39
 v_max3_f32 v5, v5, v40, v41
 v_max3_f32 v5, v5, v42, v43
 v_max3_f32 v5, v5, v44, v45
 v_max3_f32 v5, v5, v46, v47
 v_max3_f32 v5, v5, v48, v49
 v_max3_f32 v5, v5, v50, v51
 v_add_u32 v2, 4096, v2
 v_add_u32 v3, 512, v3
 s_add_u32 s38, s38, 1
 s_cmp_lt_u32 s38, s39
 s_cbranch_scc1 L_att_maxloop
L_att_maxdone:
 v_mov_b32 v6, v5
 s_nop 1
 v_permlane32_swap_b32 v5, v6
 v_max_f32 v5, v5, v6
 v_sub_f32 v20, 0, v5
 v_sub_f32 v21, 0, v5
 v_sub_f32 v22, 0, v5
 v_sub_f32 v23, 0, v5
 v_sub_f32 v24, 0, v5
 v_sub_f32 v25, 0, v5
 v_sub_f32 v26, 0, v5
 v_sub_f32 v27, 0, v5
 v_sub_f32 v28, 0, v5
 v_sub_f32 v29, 0, v5
 v_sub_f32 v30, 0, v5
 v_sub_f32 v31, 0, v5
 v_sub_f32 v32, 0, v5
 v_sub_f32 v33, 0, v5
 v_sub_f32 v34, 0, v5
 v_sub_f32 v35, 0, v5
 v_mov_b32 v2, v1
 v_and_b32 v9, 31, v0
 v_lshlrev_b32 v3, 4, v9
 v_add_u32 v3, 65536, v3
 v_mov_b32 v76, 0
 v_mov_b32 v77, 0
 v_mov_b32 v78, 0
 v_mov_b32 v79, 0
 v_mov_b32 v80, 0
 v_mov_b32 v81, 0
 v_mov_b32 v82, 0
 v_mov_b32 v83, 0
 v_mov_b32 v84, 0
 v_mov_b32 v85, 0
 v_mov_b32 v86, 0
 v_mov_b32 v87, 0
 v_mov_b32 v88, 0
 v_mov_b32 v89, 0
 v_mov_b32 v90, 0
 v_mov_b32 v91, 0
 ds_read_b128 v[100:103], v3
 ds_read_b128 v[92:95], v2
 ds_read_b128 v[96:99], v2 offset:1024
 ds_read_b128 v[108:111], v4
 ds_read_b128 v[112:115], v4 offset:608
 s_waitcnt lgkmcnt(3)
 v_mfma_f32_32x32x16_bf16 v[36:51], v[92:95], v[12:15], v[20:35]
 v_mfma_f32_32x32x16_bf16 v[36:51], v[100:103], v[124:127], v[36:51]
 v_mov_b32 v68, 0
 v_mov_b32 v69, 0
 v_mov_b32 v70, 0
 v_mov_b32 v71, 0
 v_mov_b32 v72, 0
 v_mov_b32 v73, 0
 v_mov_b32 v74, 0
 v_mov_b32 v75, 0
 v_mov_b32 v116, 0
 v_mov_b32 v117, 0
 v_mov_b32 v118, 0
 v_mov_b32 v119, 0
 v_mov_b32 v120, 0
 v_mov_b32 v121, 0
 v_mov_b32 v122, 0
 v_mov_b32 v123, 0
 s_mov_b32 s38, 0
L_att_loop:
 s_cmp_eq_u32 s38, 1
 s_cbranch_scc0 L_att_nobar
 s_cmp_eq_u32 s37, 0
 s_cbranch_scc0 L_att_nobar
 s_waitcnt vmcnt(0)
 s_barrier
L_att_nobar:
 s_waitcnt lgkmcnt(2)
 v_mfma_f32_32x32x16_bf16 v[52:67], v[96:99], v[12:15], v[20:35]
 ds_read_b128 v[92:95], v2 offset:2048
 v_exp_f32 v36, v36
 v_exp_f32 v37, v37
 v_exp_f32 v38, v38
 v_exp_f32 v39, v39
 v_cvt_pk_bf16_f32 v68, v36, v37
 v_cvt_pk_bf16_f32 v69, v38, v39
 v_mfma_f32_32x32x16_bf16 v[76:91], v[120:123], v[72:75], v[76:91]
 v_exp_f32 v40, v40
 v_exp_f32 v41, v41
 v_exp_f32 v42, v42
 v_exp_f32 v43, v43
 v_cvt_pk_bf16_f32 v70, v40, v41
 v_cvt_pk_bf16_f32 v71, v42, v43
 v_mfma_f32_32x32x16_bf16 v[52:67], v[100:103], v[128:131], v[52:67]
 ds_read_b128 v[116:119], v4 offset:1216
 v_exp_f32 v44, v44
 v_exp_f32 v45, v45
 v_exp_f32 v46, v46
 v_exp_f32 v47, v47
 v_cvt_pk_bf16_f32 v72, v44, v45
 v_cvt_pk_bf16_f32 v73, v46, v47
 s_waitcnt lgkmcnt(3)
 v_mfma_f32_32x32x16_bf16 v[76:91], v[108:111], v[68:71], v[76:91]
 ds_read_b128 v[120:123], v4 offset:1824
 v_exp_f32 v48, v48
 v_exp_f32 v49, v49
 v_exp_f32 v50, v50
 v_exp_f32 v51, v51
 v_cvt_pk_bf16_f32 v74, v48, v49
 v_cvt_pk_bf16_f32 v75, v50, v51
 s_waitcnt lgkmcnt(2)
 v_mfma_f32_32x32x16_bf16 v[36:51], v[92:95], v[12:15], v[20:35]
 ds_read_b128 v[96:99], v2 offset:3072
 v_exp_f32 v52, v52
 v_exp_f32 v53, v53
 v_exp_f32 v54, v54
 v_exp_f32 v55, v55
 v_cvt_pk_bf16_f32 v68, v52, v53
 v_cvt_pk_bf16_f32 v69, v54, v55
 v_mfma_f32_32x32x16_bf16 v[76:91], v[112:115], v[72:75], v[76:91]
 ds_read_b128 v[104:107], v3 offset:512
 v_exp_f32 v56, v56
 v_exp_f32 v57, v57
 v_exp_f32 v58, v58
 v_exp_f32 v59, v59
 v_cvt_pk_bf16_f32 v70, v56, v57
 v_cvt_pk_bf16_f32 v71, v58, v59
 v_mfma_f32_32x32x16_bf16 v[36:51], v[100:103], v[132:135], v[36:51]
 ds_read_b128 v[108:111], v4 offset:2432
 v_exp_f32 v60, v60
 v_exp_f32 v61, v61
 v_exp_f32 v62, v62
 v_exp_f32 v63, v63
 v_cvt_pk_bf16_f32 v72, v60, v61
 v_cvt_pk_bf16_f32 v73, v62, v63
 s_waitcnt lgkmcnt(4)
 v_mfma_f32_32x32x16_bf16 v[76:91], v[116:119], v[68:71], v[76:91]
 ds_read_b128 v[112:115], v4 offset:3040
 v_exp_f32 v64, v64
 v_exp_f32 v65, v65
 v_exp_f32 v66, v66
 v_exp_f32 v67, v67
 v_cvt_pk_bf16_f32 v74, v64, v65
 v_cvt_pk_bf16_f32 v75, v66, v67
 s_waitcnt lgkmcnt(2)
 v_mfma_f32_32x32x16_bf16 v[52:67], v[96:99], v[12:15], v[20:35]
 ds_read_b128 v[92:95], v2 offset:4096
 v_exp_f32 v36, v36
 v_exp_f32 v37, v37
 v_exp_f32 v38, v38
 v_exp_f32 v39, v39
 v_cvt_pk_bf16_f32 v68, v36, v37
 v_cvt_pk_bf16_f32 v69, v38, v39
 v_mfma_f32_32x32x16_bf16 v[76:91], v[120:123], v[72:75], v[76:91]
 v_exp_f32 v40, v40
 v_exp_f32 v41, v41
 v_exp_f32 v42, v42
 v_exp_f32 v43, v43
 v_cvt_pk_bf16_f32 v70, v40, v41
 v_cvt_pk_bf16_f32 v71, v42, v43
 v_mfma_f32_32x32x16_bf16 v[52:67], v[100:103], v[136:139], v[52:67]
 ds_read_b128 v[116:119], v4 offset:3648
 v_exp_f32 v44, v44
 v_exp_f32 v45, v45
 v_exp_f32 v46, v46
 v_exp_f32 v47, v47
 v_cvt_pk_bf16_f32 v72, v44, v45
 v_cvt_pk_bf16_f32 v73, v46, v47
 s_waitcnt lgkmcnt(3)
 v_mfma_f32_32x32x16_bf16 v[76:91], v[108:111], v[68:71], v[76:91]
 ds_read_b128 v[120:123], v4 offset:4256
 v_exp_f32 v48, v48
 v_exp_f32 v49, v49
 v_exp_f32 v50, v50
 v_exp_f32 v51, v51
 v_cvt_pk_bf16_f32 v74, v48, v49
 v_cvt_pk_bf16_f32 v75, v50, v51
 s_waitcnt lgkmcnt(2)
 v_mfma_f32_32x32x16_bf16 v[36:51], v[92:95], v[12:15], v[20:35]
 ds_read_b128 v[96:99], v2 offset:5120
 v_exp_f32 v52, v52
 v_exp_f32 v53, v53
 v_exp_f32 v54, v54
 v_exp_f32 v55, v55
 v_cvt_pk_bf16_f32 v68, v52, v53
 v_cvt_pk_bf16_f32 v69, v54, v55
 v_mfma_f32_32x32x16_bf16 v[76:91], v[112:115], v[72:75], v[76:91]
 v_exp_f32 v56, v56
 v_exp_f32 v57, v57
 v_exp_f32 v58, v58
 v_exp_f32 v59, v59
 v_cvt_pk_bf16_f32 v70, v56, v57
 v_cvt_pk_bf16_f32 v71, v58, v59
 v_mfma_f32_32x32x16_bf16 v[36:51], v[104:107], v[124:127], v[36:51]
 ds_read_b128 v[108:111], v4 offset:4864
 v_exp_f32 v60, v60
 v_exp_f32 v61, v61
 v_exp_f32 v62, v62
 v_exp_f32 v63, v63
 v_cvt_pk_bf16_f32 v72, v60, v61
 v_cvt_pk_bf16_f32 v73, v62, v63
 s_waitcnt lgkmcnt(3)
 v_mfma_f32_32x32x16_bf16 v[76:91], v[116:119], v[68:71], v[76:91]
 ds_read_b128 v[112:115], v4 offset:5472
 v_exp_f32 v64, v64
 v_exp_f32 v65, v65
 v_exp_f32 v66, v66
 v_exp_f32 v67, v67
 v_cvt_pk_bf16_f32 v74, v64, v65
 v_cvt_pk_bf16_f32 v75, v66, v67
 s_waitcnt lgkmcnt(2)
 v_mfma_f32_32x32x16_bf16 v[52:67], v[96:99], v[12:15], v[20:35]
 ds_read_b128 v[92:95], v2 offset:6144
 v_exp_f32 v36, v36
 v_exp_f32 v37, v37
 v_exp_f32 v38, v38
 v_exp_f32 v39, v39
 v_cvt_pk_bf16_f32 v68, v36, v37
 v_cvt_pk_bf16_f32 v69, v38, v39
 v_mfma_f32_32x32x16_bf16 v[76:91], v[120:123], v[72:75], v[76:91]
 v_exp_f32 v40, v40
 v_exp_f32 v41, v41
 v_exp_f32 v42, v42
 v_exp_f32 v43, v43
 v_cvt_pk_bf16_f32 v70, v40, v41
 v_cvt_pk_bf16_f32 v71, v42, v43
 v_mfma_f32_32x32x16_bf16 v[52:67], v[104:107], v[128:131], v[52:67]
 ds_read_b128 v[116:119], v4 offset:6080
 v_exp_f32 v44, v44
 v_exp_f32 v45, v45
 v_exp_f32 v46, v46
 v_exp_f32 v47, v47
 v_cvt_pk_bf16_f32 v72, v44, v45
 v_cvt_pk_bf16_f32 v73, v46, v47
 s_waitcnt lgkmcnt(3)
 v_mfma_f32_32x32x16_bf16 v[76:91], v[108:111], v[68:71], v[76:91]
 ds_read_b128 v[120:123], v4 offset:6688
 v_exp_f32 v48, v48
 v_exp_f32 v49, v49
 v_exp_f32 v50, v50
 v_exp_f32 v51, v51
 v_cvt_pk_bf16_f32 v74, v48, v49
 v_cvt_pk_bf16_f32 v75, v50, v51
 s_waitcnt lgkmcnt(2)
 v_mfma_f32_32x32x16_bf16 v[36:51], v[92:95], v[12:15], v[20:35]
 ds_read_b128 v[96:99], v2 offset:7168
 v_exp_f32 v52, v52
 v_exp_f32 v53, v53
 v_exp_f32 v54, v54
 v_exp_f32 v55, v55
 v_cvt_pk_bf16_f32 v68, v52, v53
 v_cvt_pk_bf16_f32 v69, v54, v55
 v_mfma_f32_32x32x16_bf16 v[76:91], v[112:115], v[72:75], v[76:91]
 ds_read_b128 v[100:103], v3 offset:1024
 v_exp_f32 v56, v56
 v_exp_f32 v57, v57
 v_exp_f32 v58, v58
 v_exp_f32 v59, v59
 v_cvt_pk_bf16_f32 v70, v56, v57
 v_cvt_pk_bf16_f32 v71, v58, v59
 v_mfma_f32_32x32x16_bf16 v[36:51], v[104:107], v[132:135], v[36:51]
 ds_read_b128 v[108:111], v4 offset:7296
 v_exp_f32 v60, v60
 v_exp_f32 v61, v61
 v_exp_f32 v62, v62
 v_exp_f32 v63, v63
 v_cvt_pk_bf16_f32 v72, v60, v61
 v_cvt_pk_bf16_f32 v73, v62, v63
 s_waitcnt lgkmcnt(4)
 v_mfma_f32_32x32x16_bf16 v[76:91], v[116:119], v[68:71], v[76:91]
 ds_read_b128 v[112:115], v4 offset:7904
 v_exp_f32 v64, v64
 v_exp_f32 v65, v65
 v_exp_f32 v66, v66
 v_exp_f32 v67, v67
 v_cvt_pk_bf16_f32 v74, v64, v65
 v_cvt_pk_bf16_f32 v75, v66, v67
 s_waitcnt lgkmcnt(2)
 v_mfma_f32_32x32x16_bf16 v[52:67], v[96:99], v[12:15], v[20:35]
 ds_read_b128 v[92:95], v2 offset:8192
 v_exp_f32 v36, v36
 v_exp_f32 v37, v37
 v_exp_f32 v38, v38
 v_exp_f32 v39, v39
 v_cvt_pk_bf16_f32 v68, v36, v37
 v_cvt_pk_bf16_f32 v69, v38, v39
 v_mfma_f32_32x32x16_bf16 v[76:91], v[120:123], v[72:75], v[76:91]
 v_exp_f32 v40, v40
 v_exp_f32 v41, v41
 v_exp_f32 v42, v42
 v_exp_f32 v43, v43
 v_cvt_pk_bf16_f32 v70, v40, v41
 v_cvt_pk_bf16_f32 v71, v42, v43
 v_mfma_f32_32x32x16_bf16 v[52:67], v[104:107], v[136:139], v[52:67]
 ds_read_b128 v[116:119], v4 offset:8512
 v_exp_f32 v44, v44
 v_exp_f32 v45, v45
 v_exp_f32 v46, v46
 v_exp_f32 v47, v47
 v_cvt_pk_bf16_f32 v72, v44, v45
 v_cvt_pk_bf16_f32 v73, v46, v47
 s_waitcnt lgkmcnt(3)
 v_mfma_f32_32x32x16_bf16 v[76:91], v[108:111], v[68:71], v[76:91]
 ds_read_b128 v[120:123], v4 offset:9120
 v_exp_f32 v48, v48
 v_exp_f32 v49, v49
 v_exp_f32 v50, v50
 v_exp_f32 v51, v51
 v_cvt_pk_bf16_f32 v74, v48, v49
 v_cvt_pk_bf16_f32 v75, v50, v51
 s_waitcnt lgkmcnt(2)
 v_mfma_f32_32x32x16_bf16 v[36:51], v[92:95], v[12:15], v[20:35]
 ds_read_b128 v[96:99], v2 offset:9216
 v_exp_f32 v52, v52
 v_exp_f32 v53, v53
 v_exp_f32 v54, v54
 v_exp_f32 v55, v55
 v_cvt_pk_bf16_f32 v68, v52, v53
 v_cvt_pk_bf16_f32 v69, v54, v55
 v_mfma_f32_32x32x16_bf16 v[76:91], v[112:115], v[72:75], v[76:91]
 v_exp_f32 v56, v56
 v_exp_f32 v57, v57
 v_exp_f32 v58, v58
 v_exp_f32 v59, v59
 v_cvt_pk_bf16_f32 v70, v56, v57
 v_cvt_pk_bf16_f32 v71, v58, v59
 v_mfma_f32_32x32x16_bf16 v[36:51], v[100:103], v[124:127], v[36:51]
 ds_read_b128 v[108:111], v4 offset:9728
 v_exp_f32 v60, v60
 v_exp_f32 v61, v61
 v_exp_f32 v62, v62
 v_exp_f32 v63, v63
 v_cvt_pk_bf16_f32 v72, v60, v61
 v_cvt_pk_bf16_f32 v73, v62, v63
 s_waitcnt lgkmcnt(3)
 v_mfma_f32_32x32x16_bf16 v[76:91], v[116:119], v[68:71], v[76:91]
 ds_read_b128 v[112:115], v4 offset:10336
 v_exp_f32 v64, v64
 v_exp_f32 v65, v65
 v_exp_f32 v66, v66
 v_exp_f32 v67, v67
 v_cvt_pk_bf16_f32 v74, v64, v65
 v_cvt_pk_bf16_f32 v75, v66, v67
 v_add_u32 v2, 8192, v2
 v_add_u32 v3, 1024, v3
 v_add_u32 v4, 9728, v4
 s_add_u32 s38, s38, 1
 s_cmp_lt_u32 s38, 8
 s_cbranch_scc1 L_att_loop
 s_waitcnt lgkmcnt(0)
 v_mfma_f32_32x32x16_bf16 v[76:91], v[120:123], v[72:75], v[76:91]
 s_waitcnt lgkmcnt(0)
 s_nop 10
 v_mov_b32 v5, v86
 v_mov_b32 v6, v86
 s_nop 1
 v_permlane32_swap_b32 v5, v6
 s_cmp_eq_u32 s37, 0
 s_cbranch_scc0 L_att_fin
 v_mov_b32 v6, 0x5f800000
 v_cmp_nlt_f32 vcc, v5, v6
 s_nop 1
 s_cmp_eq_u64 vcc, 0
 s_cbranch_scc1 L_att_fin
 s_mov_b32 s37, 1
 s_mov_b32 s39, 16
 v_mov_b32 v2, v1
 v_and_b32 v9, 31, v0
 v_lshlrev_b32 v3, 4, v9
 v_add_u32 v3, 65536, v3
 v_subrev_u32 v4, 77824, v4
 s_branch L_att_max
L_att_fin:
 v_rcp_f32 v5, v5
 s_nop 0
 v_mul_f32 v76, v76, v5
 v_mul_f32 v77, v77, v5
 v_mul_f32 v78, v78, v5
 v_mul_f32 v79, v79, v5
 v_mul_f32 v80, v80, v5
 v_mul_f32 v81, v81, v5
 v_mul_f32 v82, v82, v5
 v_mul_f32 v83, v83, v5
 v_mul_f32 v84, v84, v5
 v_mul_f32 v85, v85, v5
 v_cvt_pk_bf16_f32 v68, v76, v77
 v_cvt_pk_bf16_f32 v69, v78, v79
 v_cvt_pk_bf16_f32 v70, v80, v81
 v_cvt_pk_bf16_f32 v71, v82, v83
 v_cvt_pk_bf16_f32 v72, v84, v85
 s_lshl_b32 s35, s33, 6
 s_add_u32 s35, s35, s34
 s_lshl_b32 s36, s33, 16
 s_lshl_b32 s54, s34, 9
 s_add_u32 s36, s36, s54
 buffer_store_dwordx4 v[68:71], v7, s[20:23], s36 offen
 s_lshl_b32 s36, s35, 7
 buffer_store_dword v72, v8, s[24:27], s36 offen
 s_branch L_att_end
L_att_helper:
 s_load_dwordx2 s[6:7], s[0:1], 32
 s_load_dwordx2 s[8:9], s[0:1], 40
 s_load_dwordx2 s[10:11], s[0:1], 48
 v_lshrrev_b32 v9, 3, v0
 v_and_b32 v10, 7, v0
 v_lshrrev_b32 v11, 1, v10
 v_bfe_u32 v12, v0, 4, 2
 v_xor_b32 v11, v11, v12
 v_lshlrev_b32 v11, 5, v11
 v_and_b32 v10, 1, v10
 v_lshlrev_b32 v10, 4, v10
 v_add_u32 v10, v10, v11
 v_mul_u32_u24 v2, 9216, v9
 v_add_u32 v2, v2, v10
 v_mul_u32_u24 v3, 1152, v9
 v_add_u32 v3, v3, v10
 v_lshrrev_b32 v9, 2, v0
 v_lshlrev_b32 v9, 7, v9
 v_and_b32 v10, 3, v0
 v_lshlrev_b32 v10, 3, v10
 v_add_u32 v9, v9, v10
 v_bfe_u32 v10, v0, 3, 2
 v_xor_b32 v11, 0, v10
 v_lshlrev_b32 v11, 5, v11
 v_add_u32 v11, v11, v9
 v_add_u32 v5, 151552, v11
 v_xor_b32 v11, 1, v10
 v_lshlrev_b32 v11, 5, v11
 v_add_u32 v11, v11, v9
 v_add_u32 v6, 151552, v11
 v_xor_b32 v11, 2, v10
 v_lshlrev_b32 v11, 5, v11
 v_add_u32 v11, v11, v9
 v_add_u32 v7, 151552, v11
 v_xor_b32 v11, 3, v10
 v_lshlrev_b32 v11, 5, v11
 v_add_u32 v11, v11, v9
 v_add_u32 v8, 151552, v11
 v_and_b32 v10, 15, v0
 v_lshrrev_b32 v11, 4, v0
 v_lshlrev_b32 v11, 4, v11
 v_mul_u32_u24 v12, 2304, v10
 v_sub_u32 v12, 9216, v12
 v_add_u32 v12, v12, v11
 v_mov_b32 v13, 0x7fffffff
 v_cmp_gt_u32 vcc, 2, v10
 s_nop 1
 v_cndmask_b32 v9, v13, v12, vcc
 s_waitcnt lgkmcnt(0)
 s_mov_b32 s20, s10
 s_mov_b32 s21, s11
 s_mov_b32 s22, 5308416
 s_mov_b32 s23, 0x20000
 s_mov_b32 s12, s4
 s_mov_b32 s13, s5
 s_mov_b32 s14, 13824
 s_mov_b32 s15, 0x20000
 s_add_u32 s24, s4, 33226752
 s_addc_u32 s25, s5, 0
 s_mov_b32 s26, 11206656
 s_mov_b32 s27, 0x20000
 s_add_u32 s28, s4, 44433408
 s_addc_u32 s29, s5, 0
 s_mov_b32 s30, 5308416
 s_mov_b32 s31, 0x20000
 s_cmp_ge_u32 s2, 144
 s_cbranch_scc1 L_att_hB
 s_cmp_ge_u32 s2, 72
 s_cselect_b32 s48, 1, 0
 s_cselect_b32 s44, s8, s6
 s_cselect_b32 s45, s9, s7
 s_mov_b32 s46, 5308416
 s_mov_b32 s47, 0x20000
 s_mul_i32 s54, s48, 72
 s_sub_u32 s51, s2, s54
 s_lshl_b32 s52, s51, 7
 s_mul_i32 s53, s51, 155648
 s_lshl_b32 s54, s48, 10
 s_add_u32 s53, s53, s54
 s_barrier
 s_mov_b32 m0, 151552
 s_add_u32 s54, s52, 0
 buffer_load_dwordx4 v2, s[44:47], s54 offen lds
 s_mov_b32 m0, 152576
 s_add_u32 s54, s52, 73728
 buffer_load_dwordx4 v2, s[44:47], s54 offen lds
 s_mov_b32 m0, 153600
 s_add_u32 s54, s52, 147456
 buffer_load_dwordx4 v2, s[44:47], s54 offen lds
 s_mov_b32 m0, 154624
 s_add_u32 s54, s52, 221184
 buffer_load_dwordx4 v2, s[44:47], s54 offen lds
 s_mov_b32 m0, 155648
 s_add_u32 s54, s52, 294912
 buffer_load_dwordx4 v2, s[44:47], s54 offen lds
 s_mov_b32 m0, 156672
 s_add_u32 s54, s52, 368640
 buffer_load_dwordx4 v2, s[44:47], s54 offen lds
 s_mov_b32 m0, 157696
 s_add_u32 s54, s52, 442368
 buffer_load_dwordx4 v2, s[44:47], s54 offen lds
 s_mov_b32 m0, 158720
 s_add_u32 s54, s52, 516096
 buffer_load_dwordx4 v2, s[44:47], s54 offen lds
 s_mov_b32 m0, 159744
 s_add_u32 s54, s52, 589824
 buffer_load_dwordx4 v2, s[44:47], s54 offen lds
 s_mov_b32 m0, 160768
 s_add_u32 s54, s52, 663552
 buffer_load_dwordx4 v2, s[44:47], s54 offen lds
 s_mov_b32 m0, 161792
 s_add_u32 s54, s52, 737280
 buffer_load_dwordx4 v2, s[44:47], s54 offen lds
 s_mov_b32 m0, 162816
 s_add_u32 s54, s52, 811008
 buffer_load_dwordx4 v2, s[44:47], s54 offen lds
 s_mov_b32 s54, 0
 buffer_load_dwordx4 v[48:51], v9, s[12:15], s54 offen
 buffer_load_dwordx4 v[52:55], v9, s[12:15], s54 offen offset:64
 s_mov_b32 s54, 128
 buffer_load_dwordx4 v[56:59], v9, s[12:15], s54 offen
 buffer_load_dwordx4 v[60:63], v9, s[12:15], s54 offen offset:64
 s_barrier
 s_waitcnt vmcnt(12)
 ds_read_b64_tr_b16 v[12:13], v5 offset:0
 ds_read_b64_tr_b16 v[14:15], v5 offset:2048
 ds_read_b64_tr_b16 v[16:17], v6 offset:0
 ds_read_b64_tr_b16 v[18:19], v6 offset:2048
 ds_read_b64_tr_b16 v[20:21], v7 offset:0
 ds_read_b64_tr_b16 v[22:23], v7 offset:2048
 ds_read_b64_tr_b16 v[24:25], v8 offset:0
 ds_read_b64_tr_b16 v[26:27], v8 offset:2048
 s_waitcnt lgkmcnt(0)
 s_mov_b32 m0, 151552
 s_add_u32 s54, s52, 884736
 buffer_load_dwordx4 v2, s[44:47], s54 offen lds
 s_mov_b32 m0, 152576
 s_add_u32 s54, s52, 958464
 buffer_load_dwordx4 v2, s[44:47], s54 offen lds
 s_mov_b32 m0, 153600
 s_add_u32 s54, s52, 1032192
 buffer_load_dwordx4 v2, s[44:47], s54 offen lds
 s_mov_b32 m0, 154624
 s_add_u32 s54, s52, 1105920
 buffer_load_dwordx4 v2, s[44:47], s54 offen lds
 s_mov_b32 s54, 256
 buffer_load_dwordx4 v[64:67], v9, s[12:15], s54 offen
 buffer_load_dwordx4 v[68:71], v9, s[12:15], s54 offen offset:64
 s_waitcnt vmcnt(8)
 v_cvt_pk_bf16_f32 v28, v48, v49
 v_cvt_pk_bf16_f32 v29, v50, v51
 v_cvt_pk_bf16_f32 v30, v52, v53
 v_cvt_pk_bf16_f32 v31, v54, v55
 s_add_u32 s54, s53, 0
 buffer_store_dwordx4 v[12:15], v1, s[24:27], s54 offen sc1
 s_add_u32 s54, s53, 38912
 buffer_store_dwordx4 v[16:19], v1, s[24:27], s54 offen sc1
 s_add_u32 s54, s53, 77824
 buffer_store_dwordx4 v[20:23], v1, s[24:27], s54 offen sc1
 s_add_u32 s54, s53, 116736
 buffer_store_dwordx4 v[24:27], v1, s[24:27], s54 offen sc1
 v_mfma_f32_16x16x32_bf16 v[32:35], v[12:15], v[28:31], 0
 v_mfma_f32_16x16x32_bf16 v[36:39], v[16:19], v[28:31], 0
 v_mfma_f32_16x16x32_bf16 v[40:43], v[20:23], v[28:31], 0
 v_mfma_f32_16x16x32_bf16 v[44:47], v[24:27], v[28:31], 0
 s_waitcnt vmcnt(18)
 ds_read_b64_tr_b16 v[12:13], v5 offset:4096
 ds_read_b64_tr_b16 v[14:15], v5 offset:6144
 ds_read_b64_tr_b16 v[16:17], v6 offset:4096
 ds_read_b64_tr_b16 v[18:19], v6 offset:6144
 ds_read_b64_tr_b16 v[20:21], v7 offset:4096
 ds_read_b64_tr_b16 v[22:23], v7 offset:6144
 ds_read_b64_tr_b16 v[24:25], v8 offset:4096
 ds_read_b64_tr_b16 v[26:27], v8 offset:6144
 s_waitcnt lgkmcnt(0)
 s_mov_b32 m0, 155648
 s_add_u32 s54, s52, 1179648
 buffer_load_dwordx4 v2, s[44:47], s54 offen lds
 s_mov_b32 m0, 156672
 s_add_u32 s54, s52, 1253376
 buffer_load_dwordx4 v2, s[44:47], s54 offen lds
 s_mov_b32 m0, 157696
 s_add_u32 s54, s52, 1327104
 buffer_load_dwordx4 v2, s[44:47], s54 offen lds
 s_mov_b32 m0, 158720
 s_add_u32 s54, s52, 1400832
 buffer_load_dwordx4 v2, s[44:47], s54 offen lds
 s_mov_b32 s54, 384
 buffer_load_dwordx4 v[48:51], v9, s[12:15], s54 offen
 buffer_load_dwordx4 v[52:55], v9, s[12:15], s54 offen offset:64
 s_waitcnt vmcnt(16)
 v_cvt_pk_bf16_f32 v28, v56, v57
 v_cvt_pk_bf16_f32 v29, v58, v59
 v_cvt_pk_bf16_f32 v30, v60, v61
 v_cvt_pk_bf16_f32 v31, v62, v63
 s_add_u32 s54, s53, 2048
 buffer_store_dwordx4 v[12:15], v1, s[24:27], s54 offen sc1
 s_add_u32 s54, s53, 40960
 buffer_store_dwordx4 v[16:19], v1, s[24:27], s54 offen sc1
 s_add_u32 s54, s53, 79872
 buffer_store_dwordx4 v[20:23], v1, s[24:27], s54 offen sc1
 s_add_u32 s54, s53, 118784
 buffer_store_dwordx4 v[24:27], v1, s[24:27], s54 offen sc1
 v_mfma_f32_16x16x32_bf16 v[32:35], v[12:15], v[28:31], v[32:35]
 v_mfma_f32_16x16x32_bf16 v[36:39], v[16:19], v[28:31], v[36:39]
 v_mfma_f32_16x16x32_bf16 v[40:43], v[20:23], v[28:31], v[40:43]
 v_mfma_f32_16x16x32_bf16 v[44:47], v[24:27], v[28:31], v[44:47]
 s_waitcnt vmcnt(24)
 ds_read_b64_tr_b16 v[12:13], v5 offset:8192
 ds_read_b64_tr_b16 v[14:15], v5 offset:10240
 ds_read_b64_tr_b16 v[16:17], v6 offset:8192
 ds_read_b64_tr_b16 v[18:19], v6 offset:10240
 ds_read_b64_tr_b16 v[20:21], v7 offset:8192
 ds_read_b64_tr_b16 v[22:23], v7 offset:10240
 ds_read_b64_tr_b16 v[24:25], v8 offset:8192
 ds_read_b64_tr_b16 v[26:27], v8 offset:10240
 s_waitcnt lgkmcnt(0)
 s_mov_b32 m0, 159744
 s_add_u32 s54, s52, 1474560
 buffer_load_dwordx4 v2, s[44:47], s54 offen lds
 s_mov_b32 m0, 160768
 s_add_u32 s54, s52, 1548288
 buffer_load_dwordx4 v2, s[44:47], s54 offen lds
 s_mov_b32 m0, 161792
 s_add_u32 s54, s52, 1622016
 buffer_load_dwordx4 v2, s[44:47], s54 offen lds
 s_mov_b32 m0, 162816
 s_add_u32 s54, s52, 1695744
 buffer_load_dwordx4 v2, s[44:47], s54 offen lds
 s_mov_b32 s54, 512
 buffer_load_dwordx4 v[56:59], v9, s[12:15], s54 offen
 buffer_load_dwordx4 v[60:63], v9, s[12:15], s54 offen offset:64
 s_waitcnt vmcnt(20)
 v_cvt_pk_bf16_f32 v28, v64, v65
 v_cvt_pk_bf16_f32 v29, v66, v67
 v_cvt_pk_bf16_f32 v30, v68, v69
 v_cvt_pk_bf16_f32 v31, v70, v71
 s_add_u32 s54, s53, 4096
 buffer_store_dwordx4 v[12:15], v1, s[24:27], s54 offen sc1
 s_add_u32 s54, s53, 43008
 buffer_store_dwordx4 v[16:19], v1, s[24:27], s54 offen sc1
 s_add_u32 s54, s53, 81920
 buffer_store_dwordx4 v[20:23], v1, s[24:27], s54 offen sc1
 s_add_u32 s54, s53, 120832
 buffer_store_dwordx4 v[24:27], v1, s[24:27], s54 offen sc1
 v_mfma_f32_16x16x32_bf16 v[32:35], v[12:15], v[28:31], v[32:35]
 v_mfma_f32_16x16x32_bf16 v[36:39], v[16:19], v[28:31], v[36:39]
 v_mfma_f32_16x16x32_bf16 v[40:43], v[20:23], v[28:31], v[40:43]
 v_mfma_f32_16x16x32_bf16 v[44:47], v[24:27], v[28:31], v[44:47]
 s_cmp_lt_u32 s2, 8
 s_cbranch_scc0 L_att_nopf
 s_getpc_b64 s[84:85]
L_att_pc1:
 s_add_u32 s84, s84, pg_kernel-L_att_pc1
 s_addc_u32 s85, s85, 0
 v_lshlrev_b32 v80, 7, v0
 v_add_u32 v80, 0, v80
 v_min_u32 v80, pg_kernel_codeend-pg_kernel-4, v80
 v_mov_b32 v81, s85
 v_add_co_u32 v80, vcc, s84, v80
 s_nop 1
 v_addc_co_u32 v81, vcc, 0, v81, vcc
 global_load_dword v83, v[80:81], off
 v_lshlrev_b32 v80, 7, v0
 v_add_u32 v80, 8192, v80
 v_min_u32 v80, pg_kernel_codeend-pg_kernel-4, v80
 v_mov_b32 v81, s85
 v_add_co_u32 v80, vcc, s84, v80
 s_nop 1
 v_addc_co_u32 v81, vcc, 0, v81, vcc
 global_load_dword v83, v[80:81], off
 v_lshlrev_b32 v80, 7, v0
 v_add_u32 v80, 16384, v80
 v_min_u32 v80, pg_kernel_codeend-pg_kernel-4, v80
 v_mov_b32 v81, s85
 v_add_co_u32 v80, vcc, s84, v80
 s_nop 1
 v_addc_co_u32 v81, vcc, 0, v81, vcc
 global_load_dword v83, v[80:81], off
 v_lshlrev_b32 v80, 7, v0
 v_add_u32 v80, 24576, v80
 v_min_u32 v80, pg_kernel_codeend-pg_kernel-4, v80
 v_mov_b32 v81, s85
 v_add_co_u32 v80, vcc, s84, v80
 s_nop 1
 v_addc_co_u32 v81, vcc, 0, v81, vcc
 global_load_dword v83, v[80:81], off
L_att_nopf:
 s_nop 0
 s_waitcnt vmcnt(26)
 ds_read_b64_tr_b16 v[12:13], v5 offset:0
 ds_read_b64_tr_b16 v[14:15], v5 offset:2048
 ds_read_b64_tr_b16 v[16:17], v6 offset:0
 ds_read_b64_tr_b16 v[18:19], v6 offset:2048
 ds_read_b64_tr_b16 v[20:21], v7 offset:0
 ds_read_b64_tr_b16 v[22:23], v7 offset:2048
 ds_read_b64_tr_b16 v[24:25], v8 offset:0
 ds_read_b64_tr_b16 v[26:27], v8 offset:2048
 s_waitcnt lgkmcnt(0)
 s_mov_b32 m0, 151552
 s_add_u32 s54, s52, 1769472
 buffer_load_dwordx4 v2, s[44:47], s54 offen lds
 s_mov_b32 m0, 152576
 s_add_u32 s54, s52, 1843200
 buffer_load_dwordx4 v2, s[44:47], s54 offen lds
 s_mov_b32 m0, 153600
 s_add_u32 s54, s52, 1916928
 buffer_load_dwordx4 v2, s[44:47], s54 offen lds
 s_mov_b32 m0, 154624
 s_add_u32 s54, s52, 1990656
 buffer_load_dwordx4 v2, s[44:47], s54 offen lds
 s_mov_b32 s54, 640
 buffer_load_dwordx4 v[64:67], v9, s[12:15], s54 offen
 buffer_load_dwordx4 v[68:71], v9, s[12:15], s54 offen offset:64
 s_waitcnt vmcnt(20)
 v_cvt_pk_bf16_f32 v28, v48, v49
 v_cvt_pk_bf16_f32 v29, v50, v51
 v_cvt_pk_bf16_f32 v30, v52, v53
 v_cvt_pk_bf16_f32 v31, v54, v55
 s_add_u32 s54, s53, 6144
 buffer_store_dwordx4 v[12:15], v1, s[24:27], s54 offen sc1
 s_add_u32 s54, s53, 45056
 buffer_store_dwordx4 v[16:19], v1, s[24:27], s54 offen sc1
 s_add_u32 s54, s53, 83968
 buffer_store_dwordx4 v[20:23], v1, s[24:27], s54 offen sc1
 s_add_u32 s54, s53, 122880
 buffer_store_dwordx4 v[24:27], v1, s[24:27], s54 offen sc1
 v_mfma_f32_16x16x32_bf16 v[32:35], v[12:15], v[28:31], v[32:35]
 v_mfma_f32_16x16x32_bf16 v[36:39], v[16:19], v[28:31], v[36:39]
 v_mfma_f32_16x16x32_bf16 v[40:43], v[20:23], v[28:31], v[40:43]
 v_mfma_f32_16x16x32_bf16 v[44:47], v[24:27], v[28:31], v[44:47]
 s_waitcnt vmcnt(26)
 ds_read_b64_tr_b16 v[12:13], v5 offset:4096
 ds_read_b64_tr_b16 v[14:15], v5 offset:6144
 ds_read_b64_tr_b16 v[16:17], v6 offset:4096
 ds_read_b64_tr_b16 v[18:19], v6 offset:6144
 ds_read_b64_tr_b16 v[20:21], v7 offset:4096
 ds_read_b64_tr_b16 v[22:23], v7 offset:6144
 ds_read_b64_tr_b16 v[24:25], v8 offset:4096
 ds_read_b64_tr_b16 v[26:27], v8 offset:6144
 s_waitcnt lgkmcnt(0)
 s_mov_b32 m0, 155648
 s_add_u32 s54, s52, 2064384
 buffer_load_dwordx4 v2, s[44:47], s54 offen lds
 s_mov_b32 m0, 156672
 s_add_u32 s54, s52, 2138112
 buffer_load_dwordx4 v2, s[44:47], s54 offen lds
 s_mov_b32 m0, 157696
 s_add_u32 s54, s52, 2211840
 buffer_load_dwordx4 v2, s[44:47], s54 offen lds
 s_mov_b32 m0, 158720
 s_add_u32 s54, s52, 2285568
 buffer_load_dwordx4 v2, s[44:47], s54 offen lds
 s_mov_b32 s54, 768
 buffer_load_dwordx4 v[48:51], v9, s[12:15], s54 offen
 buffer_load_dwordx4 v[52:55], v9, s[12:15], s54 offen offset:64
 s_waitcnt vmcnt(20)
 v_cvt_pk_bf16_f32 v28, v56, v57
 v_cvt_pk_bf16_f32 v29, v58, v59
 v_cvt_pk_bf16_f32 v30, v60, v61
 v_cvt_pk_bf16_f32 v31, v62, v63
 s_add_u32 s54, s53, 8192
 buffer_store_dwordx4 v[12:15], v1, s[24:27], s54 offen sc1
 s_add_u32 s54, s53, 47104
 buffer_store_dwordx4 v[16:19], v1, s[24:27], s54 offen sc1
 s_add_u32 s54, s53, 86016
 buffer_store_dwordx4 v[20:23], v1, s[24:27], s54 offen sc1
 s_add_u32 s54, s53, 124928
 buffer_store_dwordx4 v[24:27], v1, s[24:27], s54 offen sc1
 v_mfma_f32_16x16x32_bf16 v[32:35], v[12:15], v[28:31], v[32:35]
 v_mfma_f32_16x16x32_bf16 v[36:39], v[16:19], v[28:31], v[36:39]
 v_mfma_f32_16x16x32_bf16 v[40:43], v[20:23], v[28:31], v[40:43]
 v_mfma_f32_16x16x32_bf16 v[44:47], v[24:27], v[28:31], v[44:47]
 s_waitcnt vmcnt(26)
 ds_read_b64_tr_b16 v[12:13], v5 offset:8192
 ds_read_b64_tr_b16 v[14:15], v5 offset:10240
 ds_read_b64_tr_b16 v[16:17], v6 offset:8192
 ds_read_b64_tr_b16 v[18:19], v6 offset:10240
 ds_read_b64_tr_b16 v[20:21], v7 offset:8192
 ds_read_b64_tr_b16 v[22:23], v7 offset:10240
 ds_read_b64_tr_b16 v[24:25], v8 offset:8192
 ds_read_b64_tr_b16 v[26:27], v8 offset:10240
 s_waitcnt lgkmcnt(0)
 s_mov_b32 m0, 159744
 s_add_u32 s54, s52, 2359296
 buffer_load_dwordx4 v2, s[44:47], s54 offen lds
 s_mov_b32 m0, 160768
 s_add_u32 s54, s52, 2433024
 buffer_load_dwordx4 v2, s[44:47], s54 offen lds
 s_mov_b32 m0, 161792
 s_add_u32 s54, s52, 2506752
 buffer_load_dwordx4 v2, s[44:47], s54 offen lds
 s_mov_b32 m0, 162816
 s_add_u32 s54, s52, 2580480
 buffer_load_dwordx4 v2, s[44:47], s54 offen lds
 s_mov_b32 s54, 896
 buffer_load_dwordx4 v[56:59], v9, s[12:15], s54 offen
 buffer_load_dwordx4 v[60:63], v9, s[12:15], s54 offen offset:64
 s_waitcnt vmcnt(20)
 v_cvt_pk_bf16_f32 v28, v64, v65
 v_cvt_pk_bf16_f32 v29, v66, v67
 v_cvt_pk_bf16_f32 v30, v68, v69
 v_cvt_pk_bf16_f32 v31, v70, v71
 s_add_u32 s54, s53, 10240
 buffer_store_dwordx4 v[12:15], v1, s[24:27], s54 offen sc1
 s_add_u32 s54, s53, 49152
 buffer_store_dwordx4 v[16:19], v1, s[24:27], s54 offen sc1
 s_add_u32 s54, s53, 88064
 buffer_store_dwordx4 v[20:23], v1, s[24:27], s54 offen sc1
 s_add_u32 s54, s53, 126976
 buffer_store_dwordx4 v[24:27], v1, s[24:27], s54 offen sc1
 v_mfma_f32_16x16x32_bf16 v[32:35], v[12:15], v[28:31], v[32:35]
 v_mfma_f32_16x16x32_bf16 v[36:39], v[16:19], v[28:31], v[36:39]
 v_mfma_f32_16x16x32_bf16 v[40:43], v[20:23], v[28:31], v[40:43]
 v_mfma_f32_16x16x32_bf16 v[44:47], v[24:27], v[28:31], v[44:47]
 s_waitcnt vmcnt(26)
 ds_read_b64_tr_b16 v[12:13], v5 offset:0
 ds_read_b64_tr_b16 v[14:15], v5 offset:2048
 ds_read_b64_tr_b16 v[16:17], v6 offset:0
 ds_read_b64_tr_b16 v[18:19], v6 offset:2048
 ds_read_b64_tr_b16 v[20:21], v7 offset:0
 ds_read_b64_tr_b16 v[22:23], v7 offset:2048
 ds_read_b64_tr_b16 v[24:25], v8 offset:0
 ds_read_b64_tr_b16 v[26:27], v8 offset:2048
 s_waitcnt lgkmcnt(0)
 s_mov_b32 m0, 151552
 s_add_u32 s54, s52, 2654208
 buffer_load_dwordx4 v2, s[44:47], s54 offen lds
 s_mov_b32 m0, 152576
 s_add_u32 s54, s52, 2727936
 buffer_load_dwordx4 v2, s[44:47], s54 offen lds
 s_mov_b32 m0, 153600
 s_add_u32 s54, s52, 2801664
 buffer_load_dwordx4 v2, s[44:47], s54 offen lds
 s_mov_b32 m0, 154624
 s_add_u32 s54, s52, 2875392
 buffer_load_dwordx4 v2, s[44:47], s54 offen lds
 s_mov_b32 s54, 1024
 buffer_load_dwordx4 v[64:67], v9, s[12:15], s54 offen
 buffer_load_dwordx4 v[68:71], v9, s[12:15], s54 offen offset:64
 s_waitcnt vmcnt(20)
 v_cvt_pk_bf16_f32 v28, v48, v49
 v_cvt_pk_bf16_f32 v29, v50, v51
 v_cvt_pk_bf16_f32 v30, v52, v53
 v_cvt_pk_bf16_f32 v31, v54, v55
 s_add_u32 s54, s53, 12288
 buffer_store_dwordx4 v[12:15], v1, s[24:27], s54 offen sc1
 s_add_u32 s54, s53, 51200
 buffer_store_dwordx4 v[16:19], v1, s[24:27], s54 offen sc1
 s_add_u32 s54, s53, 90112
 buffer_store_dwordx4 v[20:23], v1, s[24:27], s54 offen sc1
 s_add_u32 s54, s53, 129024
 buffer_store_dwordx4 v[24:27], v1, s[24:27], s54 offen sc1
 v_mfma_f32_16x16x32_bf16 v[32:35], v[12:15], v[28:31], v[32:35]
 v_mfma_f32_16x16x32_bf16 v[36:39], v[16:19], v[28:31], v[36:39]
 v_mfma_f32_16x16x32_bf16 v[40:43], v[20:23], v[28:31], v[40:43]
 v_mfma_f32_16x16x32_bf16 v[44:47], v[24:27], v[28:31], v[44:47]
 s_waitcnt vmcnt(26)
 ds_read_b64_tr_b16 v[12:13], v5 offset:4096
 ds_read_b64_tr_b16 v[14:15], v5 offset:6144
 ds_read_b64_tr_b16 v[16:17], v6 offset:4096
 ds_read_b64_tr_b16 v[18:19], v6 offset:6144
 ds_read_b64_tr_b16 v[20:21], v7 offset:4096
 ds_read_b64_tr_b16 v[22:23], v7 offset:6144
 ds_read_b64_tr_b16 v[24:25], v8 offset:4096
 ds_read_b64_tr_b16 v[26:27], v8 offset:6144
 s_waitcnt lgkmcnt(0)
 s_mov_b32 m0, 155648
 s_add_u32 s54, s52, 2949120
 buffer_load_dwordx4 v2, s[44:47], s54 offen lds
 s_mov_b32 m0, 156672
 s_add_u32 s54, s52, 3022848
 buffer_load_dwordx4 v2, s[44:47], s54 offen lds
 s_mov_b32 m0, 157696
 s_add_u32 s54, s52, 3096576
 buffer_load_dwordx4 v2, s[44:47], s54 offen lds
 s_mov_b32 m0, 158720
 s_add_u32 s54, s52, 3170304
 buffer_load_dwordx4 v2, s[44:47], s54 offen lds
 s_mov_b32 s54, 1152
 buffer_load_dwordx4 v[48:51], v9, s[12:15], s54 offen
 buffer_load_dwordx4 v[52:55], v9, s[12:15], s54 offen offset:64
 s_waitcnt vmcnt(20)
 v_cvt_pk_bf16_f32 v28, v56, v57
 v_cvt_pk_bf16_f32 v29, v58, v59
 v_cvt_pk_bf16_f32 v30, v60, v61
 v_cvt_pk_bf16_f32 v31, v62, v63
 s_add_u32 s54, s53, 14336
 buffer_store_dwordx4 v[12:15], v1, s[24:27], s54 offen sc1
 s_add_u32 s54, s53, 53248
 buffer_store_dwordx4 v[16:19], v1, s[24:27], s54 offen sc1
 s_add_u32 s54, s53, 92160
 buffer_store_dwordx4 v[20:23], v1, s[24:27], s54 offen sc1
 s_add_u32 s54, s53, 131072
 buffer_store_dwordx4 v[24:27], v1, s[24:27], s54 offen sc1
 v_mfma_f32_16x16x32_bf16 v[32:35], v[12:15], v[28:31], v[32:35]
 v_mfma_f32_16x16x32_bf16 v[36:39], v[16:19], v[28:31], v[36:39]
 v_mfma_f32_16x16x32_bf16 v[40:43], v[20:23], v[28:31], v[40:43]
 v_mfma_f32_16x16x32_bf16 v[44:47], v[24:27], v[28:31], v[44:47]
 s_waitcnt vmcnt(26)
 ds_read_b64_tr_b16 v[12:13], v5 offset:8192
 ds_read_b64_tr_b16 v[14:15], v5 offset:10240
 ds_read_b64_tr_b16 v[16:17], v6 offset:8192
 ds_read_b64_tr_b16 v[18:19], v6 offset:10240
 ds_read_b64_tr_b16 v[20:21], v7 offset:8192
 ds_read_b64_tr_b16 v[22:23], v7 offset:10240
 ds_read_b64_tr_b16 v[24:25], v8 offset:8192
 ds_read_b64_tr_b16 v[26:27], v8 offset:10240
 s_waitcnt lgkmcnt(0)
 s_mov_b32 m0, 159744
 s_add_u32 s54, s52, 3244032
 buffer_load_dwordx4 v2, s[44:47], s54 offen lds
 s_mov_b32 m0, 160768
 s_add_u32 s54, s52, 3317760
 buffer_load_dwordx4 v2, s[44:47], s54 offen lds
 s_mov_b32 m0, 161792
 s_add_u32 s54, s52, 3391488
 buffer_load_dwordx4 v2, s[44:47], s54 offen lds
 s_mov_b32 m0, 162816
 s_add_u32 s54, s52, 3465216
 buffer_load_dwordx4 v2, s[44:47], s54 offen lds
 s_mov_b32 s54, 1280
 buffer_load_dwordx4 v[56:59], v9, s[12:15], s54 offen
 buffer_load_dwordx4 v[60:63], v9, s[12:15], s54 offen offset:64
 s_waitcnt vmcnt(20)
 v_cvt_pk_bf16_f32 v28, v64, v65
 v_cvt_pk_bf16_f32 v29, v66, v67
 v_cvt_pk_bf16_f32 v30, v68, v69
 v_cvt_pk_bf16_f32 v31, v70, v71
 s_add_u32 s54, s53, 16384
 buffer_store_dwordx4 v[12:15], v1, s[24:27], s54 offen sc1
 s_add_u32 s54, s53, 55296
 buffer_store_dwordx4 v[16:19], v1, s[24:27], s54 offen sc1
 s_add_u32 s54, s53, 94208
 buffer_store_dwordx4 v[20:23], v1, s[24:27], s54 offen sc1
 s_add_u32 s54, s53, 133120
 buffer_store_dwordx4 v[24:27], v1, s[24:27], s54 offen sc1
 v_mfma_f32_16x16x32_bf16 v[32:35], v[12:15], v[28:31], v[32:35]
 v_mfma_f32_16x16x32_bf16 v[36:39], v[16:19], v[28:31], v[36:39]
 v_mfma_f32_16x16x32_bf16 v[40:43], v[20:23], v[28:31], v[40:43]
 v_mfma_f32_16x16x32_bf16 v[44:47], v[24:27], v[28:31], v[44:47]
 s_waitcnt vmcnt(26)
 ds_read_b64_tr_b16 v[12:13], v5 offset:0
 ds_read_b64_tr_b16 v[14:15], v5 offset:2048
 ds_read_b64_tr_b16 v[16:17], v6 offset:0
 ds_read_b64_tr_b16 v[18:19], v6 offset:2048
 ds_read_b64_tr_b16 v[20:21], v7 offset:0
 ds_read_b64_tr_b16 v[22:23], v7 offset:2048
 ds_read_b64_tr_b16 v[24:25], v8 offset:0
 ds_read_b64_tr_b16 v[26:27], v8 offset:2048
 s_waitcnt lgkmcnt(0)
 s_mov_b32 m0, 151552
 s_add_u32 s54, s52, 3538944
 buffer_load_dwordx4 v2, s[44:47], s54 offen lds
 s_mov_b32 m0, 152576
 s_add_u32 s54, s52, 3612672
 buffer_load_dwordx4 v2, s[44:47], s54 offen lds
 s_mov_b32 m0, 153600
 s_add_u32 s54, s52, 3686400
 buffer_load_dwordx4 v2, s[44:47], s54 offen lds
 s_mov_b32 m0, 154624
 s_add_u32 s54, s52, 3760128
 buffer_load_dwordx4 v2, s[44:47], s54 offen lds
 s_mov_b32 s54, 1408
 buffer_load_dwordx4 v[64:67], v9, s[12:15], s54 offen
 buffer_load_dwordx4 v[68:71], v9, s[12:15], s54 offen offset:64
 s_waitcnt vmcnt(20)
 v_cvt_pk_bf16_f32 v28, v48, v49
 v_cvt_pk_bf16_f32 v29, v50, v51
 v_cvt_pk_bf16_f32 v30, v52, v53
 v_cvt_pk_bf16_f32 v31, v54, v55
 s_add_u32 s54, s53, 18432
 buffer_store_dwordx4 v[12:15], v1, s[24:27], s54 offen sc1
 s_add_u32 s54, s53, 57344
 buffer_store_dwordx4 v[16:19], v1, s[24:27], s54 offen sc1
 s_add_u32 s54, s53, 96256
 buffer_store_dwordx4 v[20:23], v1, s[24:27], s54 offen sc1
 s_add_u32 s54, s53, 135168
 buffer_store_dwordx4 v[24:27], v1, s[24:27], s54 offen sc1
 v_mfma_f32_16x16x32_bf16 v[32:35], v[12:15], v[28:31], v[32:35]
 v_mfma_f32_16x16x32_bf16 v[36:39], v[16:19], v[28:31], v[36:39]
 v_mfma_f32_16x16x32_bf16 v[40:43], v[20:23], v[28:31], v[40:43]
 v_mfma_f32_16x16x32_bf16 v[44:47], v[24:27], v[28:31], v[44:47]
 s_waitcnt vmcnt(26)
 ds_read_b64_tr_b16 v[12:13], v5 offset:4096
 ds_read_b64_tr_b16 v[14:15], v5 offset:6144
 ds_read_b64_tr_b16 v[16:17], v6 offset:4096
 ds_read_b64_tr_b16 v[18:19], v6 offset:6144
 ds_read_b64_tr_b16 v[20:21], v7 offset:4096
 ds_read_b64_tr_b16 v[22:23], v7 offset:6144
 ds_read_b64_tr_b16 v[24:25], v8 offset:4096
 ds_read_b64_tr_b16 v[26:27], v8 offset:6144
 s_waitcnt lgkmcnt(0)
 s_mov_b32 m0, 155648
 s_add_u32 s54, s52, 3833856
 buffer_load_dwordx4 v2, s[44:47], s54 offen lds
 s_mov_b32 m0, 156672
 s_add_u32 s54, s52, 3907584
 buffer_load_dwordx4 v2, s[44:47], s54 offen lds
 s_mov_b32 m0, 157696
 s_add_u32 s54, s52, 3981312
 buffer_load_dwordx4 v2, s[44:47], s54 offen lds
 s_mov_b32 m0, 158720
 s_add_u32 s54, s52, 4055040
 buffer_load_dwordx4 v2, s[44:47], s54 offen lds
 s_mov_b32 s54, 1536
 buffer_load_dwordx4 v[48:51], v9, s[12:15], s54 offen
 buffer_load_dwordx4 v[52:55], v9, s[12:15], s54 offen offset:64
 s_waitcnt vmcnt(20)
 v_cvt_pk_bf16_f32 v28, v56, v57
 v_cvt_pk_bf16_f32 v29, v58, v59
 v_cvt_pk_bf16_f32 v30, v60, v61
 v_cvt_pk_bf16_f32 v31, v62, v63
 s_add_u32 s54, s53, 20480
 buffer_store_dwordx4 v[12:15], v1, s[24:27], s54 offen sc1
 s_add_u32 s54, s53, 59392
 buffer_store_dwordx4 v[16:19], v1, s[24:27], s54 offen sc1
 s_add_u32 s54, s53, 98304
 buffer_store_dwordx4 v[20:23], v1, s[24:27], s54 offen sc1
 s_add_u32 s54, s53, 137216
 buffer_store_dwordx4 v[24:27], v1, s[24:27], s54 offen sc1
 v_mfma_f32_16x16x32_bf16 v[32:35], v[12:15], v[28:31], v[32:35]
 v_mfma_f32_16x16x32_bf16 v[36:39], v[16:19], v[28:31], v[36:39]
 v_mfma_f32_16x16x32_bf16 v[40:43], v[20:23], v[28:31], v[40:43]
 v_mfma_f32_16x16x32_bf16 v[44:47], v[24:27], v[28:31], v[44:47]
 s_waitcnt vmcnt(26)
 ds_read_b64_tr_b16 v[12:13], v5 offset:8192
 ds_read_b64_tr_b16 v[14:15], v5 offset:10240
 ds_read_b64_tr_b16 v[16:17], v6 offset:8192
 ds_read_b64_tr_b16 v[18:19], v6 offset:10240
 ds_read_b64_tr_b16 v[20:21], v7 offset:8192
 ds_read_b64_tr_b16 v[22:23], v7 offset:10240
 ds_read_b64_tr_b16 v[24:25], v8 offset:8192
 ds_read_b64_tr_b16 v[26:27], v8 offset:10240
 s_waitcnt lgkmcnt(0)
 s_mov_b32 m0, 159744
 s_add_u32 s54, s52, 4128768
 buffer_load_dwordx4 v2, s[44:47], s54 offen lds
 s_mov_b32 m0, 160768
 s_add_u32 s54, s52, 4202496
 buffer_load_dwordx4 v2, s[44:47], s54 offen lds
 s_mov_b32 m0, 161792
 s_add_u32 s54, s52, 4276224
 buffer_load_dwordx4 v2, s[44:47], s54 offen lds
 s_mov_b32 m0, 162816
 s_add_u32 s54, s52, 4349952
 buffer_load_dwordx4 v2, s[44:47], s54 offen lds
 s_mov_b32 s54, 1664
 buffer_load_dwordx4 v[56:59], v9, s[12:15], s54 offen
 buffer_load_dwordx4 v[60:63], v9, s[12:15], s54 offen offset:64
 s_waitcnt vmcnt(20)
 v_cvt_pk_bf16_f32 v28, v64, v65
 v_cvt_pk_bf16_f32 v29, v66, v67
 v_cvt_pk_bf16_f32 v30, v68, v69
 v_cvt_pk_bf16_f32 v31, v70, v71
 s_add_u32 s54, s53, 22528
 buffer_store_dwordx4 v[12:15], v1, s[24:27], s54 offen sc1
 s_add_u32 s54, s53, 61440
 buffer_store_dwordx4 v[16:19], v1, s[24:27], s54 offen sc1
 s_add_u32 s54, s53, 100352
 buffer_store_dwordx4 v[20:23], v1, s[24:27], s54 offen sc1
 s_add_u32 s54, s53, 139264
 buffer_store_dwordx4 v[24:27], v1, s[24:27], s54 offen sc1
 v_mfma_f32_16x16x32_bf16 v[32:35], v[12:15], v[28:31], v[32:35]
 v_mfma_f32_16x16x32_bf16 v[36:39], v[16:19], v[28:31], v[36:39]
 v_mfma_f32_16x16x32_bf16 v[40:43], v[20:23], v[28:31], v[40:43]
 v_mfma_f32_16x16x32_bf16 v[44:47], v[24:27], v[28:31], v[44:47]
 s_waitcnt vmcnt(26)
 ds_read_b64_tr_b16 v[12:13], v5 offset:0
 ds_read_b64_tr_b16 v[14:15], v5 offset:2048
 ds_read_b64_tr_b16 v[16:17], v6 offset:0
 ds_read_b64_tr_b16 v[18:19], v6 offset:2048
 ds_read_b64_tr_b16 v[20:21], v7 offset:0
 ds_read_b64_tr_b16 v[22:23], v7 offset:2048
 ds_read_b64_tr_b16 v[24:25], v8 offset:0
 ds_read_b64_tr_b16 v[26:27], v8 offset:2048
 s_waitcnt lgkmcnt(0)
 s_mov_b32 m0, 151552
 s_add_u32 s54, s52, 4423680
 buffer_load_dwordx4 v2, s[44:47], s54 offen lds
 s_mov_b32 m0, 152576
 s_add_u32 s54, s52, 4497408
 buffer_load_dwordx4 v2, s[44:47], s54 offen lds
 s_mov_b32 m0, 153600
 s_add_u32 s54, s52, 4571136
 buffer_load_dwordx4 v2, s[44:47], s54 offen lds
 s_mov_b32 m0, 154624
 s_add_u32 s54, s52, 4644864
 buffer_load_dwordx4 v2, s[44:47], s54 offen lds
 s_mov_b32 s54, 1792
 buffer_load_dwordx4 v[64:67], v9, s[12:15], s54 offen
 buffer_load_dwordx4 v[68:71], v9, s[12:15], s54 offen offset:64
 s_waitcnt vmcnt(20)
 v_cvt_pk_bf16_f32 v28, v48, v49
 v_cvt_pk_bf16_f32 v29, v50, v51
 v_cvt_pk_bf16_f32 v30, v52, v53
 v_cvt_pk_bf16_f32 v31, v54, v55
 s_add_u32 s54, s53, 24576
 buffer_store_dwordx4 v[12:15], v1, s[24:27], s54 offen sc1
 s_add_u32 s54, s53, 63488
 buffer_store_dwordx4 v[16:19], v1, s[24:27], s54 offen sc1
 s_add_u32 s54, s53, 102400
 buffer_store_dwordx4 v[20:23], v1, s[24:27], s54 offen sc1
 s_add_u32 s54, s53, 141312
 buffer_store_dwordx4 v[24:27], v1, s[24:27], s54 offen sc1
 v_mfma_f32_16x16x32_bf16 v[32:35], v[12:15], v[28:31], v[32:35]
 v_mfma_f32_16x16x32_bf16 v[36:39], v[16:19], v[28:31], v[36:39]
 v_mfma_f32_16x16x32_bf16 v[40:43], v[20:23], v[28:31], v[40:43]
 v_mfma_f32_16x16x32_bf16 v[44:47], v[24:27], v[28:31], v[44:47]
 s_waitcnt vmcnt(26)
 ds_read_b64_tr_b16 v[12:13], v5 offset:4096
 ds_read_b64_tr_b16 v[14:15], v5 offset:6144
 ds_read_b64_tr_b16 v[16:17], v6 offset:4096
 ds_read_b64_tr_b16 v[18:19], v6 offset:6144
 ds_read_b64_tr_b16 v[20:21], v7 offset:4096
 ds_read_b64_tr_b16 v[22:23], v7 offset:6144
 ds_read_b64_tr_b16 v[24:25], v8 offset:4096
 ds_read_b64_tr_b16 v[26:27], v8 offset:6144
 s_waitcnt lgkmcnt(0)
 s_mov_b32 m0, 155648
 s_add_u32 s54, s52, 4718592
 buffer_load_dwordx4 v2, s[44:47], s54 offen lds
 s_mov_b32 m0, 156672
 s_add_u32 s54, s52, 4792320
 buffer_load_dwordx4 v2, s[44:47], s54 offen lds
 s_mov_b32 m0, 157696
 s_add_u32 s54, s52, 4866048
 buffer_load_dwordx4 v2, s[44:47], s54 offen lds
 s_mov_b32 m0, 158720
 s_add_u32 s54, s52, 4939776
 buffer_load_dwordx4 v2, s[44:47], s54 offen lds
 s_mov_b32 s54, 1920
 buffer_load_dwordx4 v[48:51], v9, s[12:15], s54 offen
 buffer_load_dwordx4 v[52:55], v9, s[12:15], s54 offen offset:64
 s_waitcnt vmcnt(20)
 v_cvt_pk_bf16_f32 v28, v56, v57
 v_cvt_pk_bf16_f32 v29, v58, v59
 v_cvt_pk_bf16_f32 v30, v60, v61
 v_cvt_pk_bf16_f32 v31, v62, v63
 s_add_u32 s54, s53, 26624
 buffer_store_dwordx4 v[12:15], v1, s[24:27], s54 offen sc1
 s_add_u32 s54, s53, 65536
 buffer_store_dwordx4 v[16:19], v1, s[24:27], s54 offen sc1
 s_add_u32 s54, s53, 104448
 buffer_store_dwordx4 v[20:23], v1, s[24:27], s54 offen sc1
 s_add_u32 s54, s53, 143360
 buffer_store_dwordx4 v[24:27], v1, s[24:27], s54 offen sc1
 v_mfma_f32_16x16x32_bf16 v[32:35], v[12:15], v[28:31], v[32:35]
 v_mfma_f32_16x16x32_bf16 v[36:39], v[16:19], v[28:31], v[36:39]
 v_mfma_f32_16x16x32_bf16 v[40:43], v[20:23], v[28:31], v[40:43]
 v_mfma_f32_16x16x32_bf16 v[44:47], v[24:27], v[28:31], v[44:47]
 s_waitcnt vmcnt(26)
 ds_read_b64_tr_b16 v[12:13], v5 offset:8192
 ds_read_b64_tr_b16 v[14:15], v5 offset:10240
 ds_read_b64_tr_b16 v[16:17], v6 offset:8192
 ds_read_b64_tr_b16 v[18:19], v6 offset:10240
 ds_read_b64_tr_b16 v[20:21], v7 offset:8192
 ds_read_b64_tr_b16 v[22:23], v7 offset:10240
 ds_read_b64_tr_b16 v[24:25], v8 offset:8192
 ds_read_b64_tr_b16 v[26:27], v8 offset:10240
 s_waitcnt lgkmcnt(0)
 s_mov_b32 m0, 159744
 s_add_u32 s54, s52, 5013504
 buffer_load_dwordx4 v2, s[44:47], s54 offen lds
 s_mov_b32 m0, 160768
 s_add_u32 s54, s52, 5087232
 buffer_load_dwordx4 v2, s[44:47], s54 offen lds
 s_mov_b32 m0, 161792
 s_add_u32 s54, s52, 5160960
 buffer_load_dwordx4 v2, s[44:47], s54 offen lds
 s_mov_b32 m0, 162816
 s_add_u32 s54, s52, 5234688
 buffer_load_dwordx4 v2, s[44:47], s54 offen lds
 s_mov_b32 s54, 2048
 buffer_load_dwordx4 v[56:59], v9, s[12:15], s54 offen
 buffer_load_dwordx4 v[60:63], v9, s[12:15], s54 offen offset:64
 s_waitcnt vmcnt(20)
 v_cvt_pk_bf16_f32 v28, v64, v65
 v_cvt_pk_bf16_f32 v29, v66, v67
 v_cvt_pk_bf16_f32 v30, v68, v69
 v_cvt_pk_bf16_f32 v31, v70, v71
 s_add_u32 s54, s53, 28672
 buffer_store_dwordx4 v[12:15], v1, s[24:27], s54 offen sc1
 s_add_u32 s54, s53, 67584
 buffer_store_dwordx4 v[16:19], v1, s[24:27], s54 offen sc1
 s_add_u32 s54, s53, 106496
 buffer_store_dwordx4 v[20:23], v1, s[24:27], s54 offen sc1
 s_add_u32 s54, s53, 145408
 buffer_store_dwordx4 v[24:27], v1, s[24:27], s54 offen sc1
 v_mfma_f32_16x16x32_bf16 v[32:35], v[12:15], v[28:31], v[32:35]
 v_mfma_f32_16x16x32_bf16 v[36:39], v[16:19], v[28:31], v[36:39]
 v_mfma_f32_16x16x32_bf16 v[40:43], v[20:23], v[28:31], v[40:43]
 v_mfma_f32_16x16x32_bf16 v[44:47], v[24:27], v[28:31], v[44:47]
 s_waitcnt vmcnt(26)
 ds_read_b64_tr_b16 v[12:13], v5 offset:0
 ds_read_b64_tr_b16 v[14:15], v5 offset:2048
 ds_read_b64_tr_b16 v[16:17], v6 offset:0
 ds_read_b64_tr_b16 v[18:19], v6 offset:2048
 ds_read_b64_tr_b16 v[20:21], v7 offset:0
 ds_read_b64_tr_b16 v[22:23], v7 offset:2048
 ds_read_b64_tr_b16 v[24:25], v8 offset:0
 ds_read_b64_tr_b16 v[26:27], v8 offset:2048
 s_waitcnt lgkmcnt(0)
 s_mov_b32 s54, 2176
 buffer_load_dwordx4 v[64:67], v9, s[12:15], s54 offen
 buffer_load_dwordx4 v[68:71], v9, s[12:15], s54 offen offset:64
 s_waitcnt vmcnt(16)
 v_cvt_pk_bf16_f32 v28, v48, v49
 v_cvt_pk_bf16_f32 v29, v50, v51
 v_cvt_pk_bf16_f32 v30, v52, v53
 v_cvt_pk_bf16_f32 v31, v54, v55
 s_add_u32 s54, s53, 30720
 buffer_store_dwordx4 v[12:15], v1, s[24:27], s54 offen sc1
 s_add_u32 s54, s53, 69632
 buffer_store_dwordx4 v[16:19], v1, s[24:27], s54 offen sc1
 s_add_u32 s54, s53, 108544
 buffer_store_dwordx4 v[20:23], v1, s[24:27], s54 offen sc1
 s_add_u32 s54, s53, 147456
 buffer_store_dwordx4 v[24:27], v1, s[24:27], s54 offen sc1
 v_mfma_f32_16x16x32_bf16 v[32:35], v[12:15], v[28:31], v[32:35]
 v_mfma_f32_16x16x32_bf16 v[36:39], v[16:19], v[28:31], v[36:39]
 v_mfma_f32_16x16x32_bf16 v[40:43], v[20:23], v[28:31], v[40:43]
 v_mfma_f32_16x16x32_bf16 v[44:47], v[24:27], v[28:31], v[44:47]
 s_waitcnt vmcnt(22)
 ds_read_b64_tr_b16 v[12:13], v5 offset:4096
 ds_read_b64_tr_b16 v[14:15], v5 offset:6144
 ds_read_b64_tr_b16 v[16:17], v6 offset:4096
 ds_read_b64_tr_b16 v[18:19], v6 offset:6144
 ds_read_b64_tr_b16 v[20:21], v7 offset:4096
 ds_read_b64_tr_b16 v[22:23], v7 offset:6144
 ds_read_b64_tr_b16 v[24:25], v8 offset:4096
 ds_read_b64_tr_b16 v[26:27], v8 offset:6144
 s_waitcnt lgkmcnt(0)
 s_waitcnt vmcnt(10)
 v_cvt_pk_bf16_f32 v28, v56, v57
 v_cvt_pk_bf16_f32 v29, v58, v59
 v_cvt_pk_bf16_f32 v30, v60, v61
 v_cvt_pk_bf16_f32 v31, v62, v63
 s_add_u32 s54, s53, 32768
 buffer_store_dwordx4 v[12:15], v1, s[24:27], s54 offen sc1
 s_add_u32 s54, s53, 71680
 buffer_store_dwordx4 v[16:19], v1, s[24:27], s54 offen sc1
 s_add_u32 s54, s53, 110592
 buffer_store_dwordx4 v[20:23], v1, s[24:27], s54 offen sc1
 s_add_u32 s54, s53, 149504
 buffer_store_dwordx4 v[24:27], v1, s[24:27], s54 offen sc1
 v_mfma_f32_16x16x32_bf16 v[32:35], v[12:15], v[28:31], v[32:35]
 v_mfma_f32_16x16x32_bf16 v[36:39], v[16:19], v[28:31], v[36:39]
 v_mfma_f32_16x16x32_bf16 v[40:43], v[20:23], v[28:31], v[40:43]
 v_mfma_f32_16x16x32_bf16 v[44:47], v[24:27], v[28:31], v[44:47]
 s_waitcnt vmcnt(16)
 ds_read_b64_tr_b16 v[12:13], v5 offset:8192
 ds_read_b64_tr_b16 v[14:15], v5 offset:10240
 ds_read_b64_tr_b16 v[16:17], v6 offset:8192
 ds_read_b64_tr_b16 v[18:19], v6 offset:10240
 ds_read_b64_tr_b16 v[20:21], v7 offset:8192
 ds_read_b64_tr_b16 v[22:23], v7 offset:10240
 ds_read_b64_tr_b16 v[24:25], v8 offset:8192
 ds_read_b64_tr_b16 v[26:27], v8 offset:10240
 s_waitcnt lgkmcnt(0)
 s_waitcnt vmcnt(8)
 v_cvt_pk_bf16_f32 v28, v64, v65
 v_cvt_pk_bf16_f32 v29, v66, v67
 v_cvt_pk_bf16_f32 v30, v68, v69
 v_cvt_pk_bf16_f32 v31, v70, v71
 s_add_u32 s54, s53, 34816
 buffer_store_dwordx4 v[12:15], v1, s[24:27], s54 offen sc1
 s_add_u32 s54, s53, 73728
 buffer_store_dwordx4 v[16:19], v1, s[24:27], s54 offen sc1
 s_add_u32 s54, s53, 112640
 buffer_store_dwordx4 v[20:23], v1, s[24:27], s54 offen sc1
 s_add_u32 s54, s53, 151552
 buffer_store_dwordx4 v[24:27], v1, s[24:27], s54 offen sc1
 v_mfma_f32_16x16x32_bf16 v[32:35], v[12:15], v[28:31], v[32:35]
 v_mfma_f32_16x16x32_bf16 v[36:39], v[16:19], v[28:31], v[36:39]
 v_mfma_f32_16x16x32_bf16 v[40:43], v[20:23], v[28:31], v[40:43]
 v_mfma_f32_16x16x32_bf16 v[44:47], v[24:27], v[28:31], v[44:47]
 v_and_b32 v10, 15, v0
 v_lshrrev_b32 v11, 4, v0
 v_lshlrev_b32 v11, 5, v11
 v_lshlrev_b32 v12, 2, v10
 v_add_u32 v11, v11, v12
 v_add_u32 v11, 151552, v11
 v_mov_b32 v13, 0x30000
 v_cmp_gt_u32 vcc, 2, v10
 s_nop 1
 v_cndmask_b32 v11, v13, v11, vcc
 ds_write_b32 v11, v32 offset:0
 ds_write_b32 v11, v33 offset:8
 ds_write_b32 v11, v34 offset:16
 ds_write_b32 v11, v35 offset:24
 ds_write_b32 v11, v36 offset:128
 ds_write_b32 v11, v37 offset:136
 ds_write_b32 v11, v38 offset:144
 ds_write_b32 v11, v39 offset:152
 ds_write_b32 v11, v40 offset:256
 ds_write_b32 v11, v41 offset:264
 ds_write_b32 v11, v42 offset:272
 ds_write_b32 v11, v43 offset:280
 ds_write_b32 v11, v44 offset:384
 ds_write_b32 v11, v45 offset:392
 ds_write_b32 v11, v46 offset:400
 ds_write_b32 v11, v47 offset:408
 v_lshlrev_b32 v12, 3, v0
 v_add_u32 v12, 151552, v12
 v_cmp_gt_u32 vcc, 16, v0
 s_nop 1
 v_cndmask_b32 v12, v13, v12, vcc
 s_waitcnt lgkmcnt(0)
 ds_read_b64 v[48:49], v12 offset:0
 ds_read_b64 v[50:51], v12 offset:128
 ds_read_b64 v[52:53], v12 offset:256
 ds_read_b64 v[54:55], v12 offset:384
 s_waitcnt lgkmcnt(0)
 v_cvt_pk_bf16_f32 v12, v48, v48
 v_lshlrev_b32 v56, 16, v12
 v_sub_f32 v56, v48, v56
 v_cvt_pk_bf16_f32 v57, v49, v49
 v_lshlrev_b32 v57, 16, v57
 v_sub_f32 v57, v49, v57
 v_cvt_pk_bf16_f32 v13, v56, v49
 v_cvt_pk_bf16_f32 v14, v49, v57
 v_mov_b32 v15, 0
 s_add_u32 s54, s53, 36864
 buffer_store_dwordx4 v[12:15], v1, s[24:27], s54 offen
 v_cvt_pk_bf16_f32 v16, v50, v50
 v_lshlrev_b32 v56, 16, v16
 v_sub_f32 v56, v50, v56
 v_cvt_pk_bf16_f32 v57, v51, v51
 v_lshlrev_b32 v57, 16, v57
 v_sub_f32 v57, v51, v57
 v_cvt_pk_bf16_f32 v17, v56, v51
 v_cvt_pk_bf16_f32 v18, v51, v57
 v_mov_b32 v19, 0
 s_add_u32 s54, s53, 75776
 buffer_store_dwordx4 v[16:19], v1, s[24:27], s54 offen
 v_cvt_pk_bf16_f32 v20, v52, v52
 v_lshlrev_b32 v56, 16, v20
 v_sub_f32 v56, v52, v56
 v_cvt_pk_bf16_f32 v57, v53, v53
 v_lshlrev_b32 v57, 16, v57
 v_sub_f32 v57, v53, v57
 v_cvt_pk_bf16_f32 v21, v56, v53
 v_cvt_pk_bf16_f32 v22, v53, v57
 v_mov_b32 v23, 0
 s_add_u32 s54, s53, 114688
 buffer_store_dwordx4 v[20:23], v1, s[24:27], s54 offen
 v_cvt_pk_bf16_f32 v24, v54, v54
 v_lshlrev_b32 v56, 16, v24
 v_sub_f32 v56, v54, v56
 v_cvt_pk_bf16_f32 v57, v55, v55
 v_lshlrev_b32 v57, 16, v57
 v_sub_f32 v57, v55, v57
 v_cvt_pk_bf16_f32 v25, v56, v55
 v_cvt_pk_bf16_f32 v26, v55, v57
 v_mov_b32 v27, 0
 s_add_u32 s54, s53, 153600
 buffer_store_dwordx4 v[24:27], v1, s[24:27], s54 offen
 s_branch L_att_end
L_att_hB:
 s_sub_u32 s55, s2, 144
 s_barrier
 s_add_u32 s49, s55, 0
 s_mul_i32 s50, s49, 7282
 s_lshr_b32 s50, s50, 16
 s_mul_i32 s54, s50, 9
 s_sub_u32 s51, s49, s54
 s_mul_i32 s52, s50, 36864
 s_lshl_b32 s54, s51, 7
 s_add_u32 s52, s52, s54
 s_mul_i32 s53, s50, 36864
 s_lshl_b32 s54, s51, 12
 s_add_u32 s56, s53, s54
 s_mov_b32 m0, 151552
 s_add_u32 s54, s52, 0
 buffer_load_dwordx4 v3, s[20:23], s54 offen lds
 s_mov_b32 m0, 152576
 s_add_u32 s54, s52, 9216
 buffer_load_dwordx4 v3, s[20:23], s54 offen lds
 s_mov_b32 m0, 153600
 s_add_u32 s54, s52, 18432
 buffer_load_dwordx4 v3, s[20:23], s54 offen lds
 s_mov_b32 m0, 154624
 s_add_u32 s54, s52, 27648
 buffer_load_dwordx4 v3, s[20:23], s54 offen lds
 s_add_u32 s49, s55, 112
 s_mul_i32 s50, s49, 7282
 s_lshr_b32 s50, s50, 16
 s_mul_i32 s54, s50, 9
 s_sub_u32 s51, s49, s54
 s_mul_i32 s52, s50, 36864
 s_lshl_b32 s54, s51, 7
 s_add_u32 s52, s52, s54
 s_mul_i32 s53, s50, 36864
 s_lshl_b32 s54, s51, 12
 s_add_u32 s57, s53, s54
 s_mov_b32 m0, 155648
 s_add_u32 s54, s52, 0
 buffer_load_dwordx4 v3, s[20:23], s54 offen lds
 s_mov_b32 m0, 156672
 s_add_u32 s54, s52, 9216
 buffer_load_dwordx4 v3, s[20:23], s54 offen lds
 s_mov_b32 m0, 157696
 s_add_u32 s54, s52, 18432
 buffer_load_dwordx4 v3, s[20:23], s54 offen lds
 s_mov_b32 m0, 158720
 s_add_u32 s54, s52, 27648
 buffer_load_dwordx4 v3, s[20:23], s54 offen lds
 s_add_u32 s49, s55, 224
 s_mul_i32 s50, s49, 7282
 s_lshr_b32 s50, s50, 16
 s_mul_i32 s54, s50, 9
 s_sub_u32 s51, s49, s54
 s_mul_i32 s52, s50, 36864
 s_lshl_b32 s54, s51, 7
 s_add_u32 s52, s52, s54
 s_mul_i32 s53, s50, 36864
 s_lshl_b32 s54, s51, 12
 s_add_u32 s58, s53, s54
 s_mov_b32 m0, 159744
 s_add_u32 s54, s52, 0
 buffer_load_dwordx4 v3, s[20:23], s54 offen lds
 s_mov_b32 m0, 160768
 s_add_u32 s54, s52, 9216
 buffer_load_dwordx4 v3, s[20:23], s54 offen lds
 s_mov_b32 m0, 161792
 s_add_u32 s54, s52, 18432
 buffer_load_dwordx4 v3, s[20:23], s54 offen lds
 s_mov_b32 m0, 162816
 s_add_u32 s54, s52, 27648
 buffer_load_dwordx4 v3, s[20:23], s54 offen lds
 s_barrier
 s_waitcnt vmcnt(8)
 ds_read_b64_tr_b16 v[12:13], v5 offset:0
 ds_read_b64_tr_b16 v[14:15], v5 offset:2048
 ds_read_b64_tr_b16 v[16:17], v6 offset:0
 ds_read_b64_tr_b16 v[18:19], v6 offset:2048
 ds_read_b64_tr_b16 v[20:21], v7 offset:0
 ds_read_b64_tr_b16 v[22:23], v7 offset:2048
 ds_read_b64_tr_b16 v[24:25], v8 offset:0
 ds_read_b64_tr_b16 v[26:27], v8 offset:2048
 s_waitcnt lgkmcnt(0)
 s_add_u32 s49, s55, 336
 s_mul_i32 s50, s49, 7282
 s_lshr_b32 s50, s50, 16
 s_mul_i32 s54, s50, 9
 s_sub_u32 s51, s49, s54
 s_mul_i32 s52, s50, 36864
 s_lshl_b32 s54, s51, 7
 s_add_u32 s52, s52, s54
 s_mul_i32 s53, s50, 36864
 s_lshl_b32 s54, s51, 12
 s_add_u32 s59, s53, s54
 s_mov_b32 m0, 151552
 s_add_u32 s54, s52, 0
 buffer_load_dwordx4 v3, s[20:23], s54 offen lds
 s_mov_b32 m0, 152576
 s_add_u32 s54, s52, 9216
 buffer_load_dwordx4 v3, s[20:23], s54 offen lds
 s_mov_b32 m0, 153600
 s_add_u32 s54, s52, 18432
 buffer_load_dwordx4 v3, s[20:23], s54 offen lds
 s_mov_b32 m0, 154624
 s_add_u32 s54, s52, 27648
 buffer_load_dwordx4 v3, s[20:23], s54 offen lds
 s_add_u32 s54, s56, 0
 buffer_store_dwordx4 v[12:15], v1, s[28:31], s54 offen sc1
 s_add_u32 s54, s56, 1024
 buffer_store_dwordx4 v[16:19], v1, s[28:31], s54 offen sc1
 s_add_u32 s54, s56, 2048
 buffer_store_dwordx4 v[20:23], v1, s[28:31], s54 offen sc1
 s_add_u32 s54, s56, 3072
 buffer_store_dwordx4 v[24:27], v1, s[28:31], s54 offen sc1
 s_waitcnt vmcnt(12)
 ds_read_b64_tr_b16 v[12:13], v5 offset:4096
 ds_read_b64_tr_b16 v[14:15], v5 offset:6144
 ds_read_b64_tr_b16 v[16:17], v6 offset:4096
 ds_read_b64_tr_b16 v[18:19], v6 offset:6144
 ds_read_b64_tr_b16 v[20:21], v7 offset:4096
 ds_read_b64_tr_b16 v[22:23], v7 offset:6144
 ds_read_b64_tr_b16 v[24:25], v8 offset:4096
 ds_read_b64_tr_b16 v[26:27], v8 offset:6144
 s_waitcnt lgkmcnt(0)
 s_add_u32 s49, s55, 448
 s_mul_i32 s50, s49, 7282
 s_lshr_b32 s50, s50, 16
 s_mul_i32 s54, s50, 9
 s_sub_u32 s51, s49, s54
 s_mul_i32 s52, s50, 36864
 s_lshl_b32 s54, s51, 7
 s_add_u32 s52, s52, s54
 s_mul_i32 s53, s50, 36864
 s_lshl_b32 s54, s51, 12
 s_add_u32 s56, s53, s54
 s_mov_b32 m0, 155648
 s_add_u32 s54, s52, 0
 buffer_load_dwordx4 v3, s[20:23], s54 offen lds
 s_mov_b32 m0, 156672
 s_add_u32 s54, s52, 9216
 buffer_load_dwordx4 v3, s[20:23], s54 offen lds
 s_mov_b32 m0, 157696
 s_add_u32 s54, s52, 18432
 buffer_load_dwordx4 v3, s[20:23], s54 offen lds
 s_mov_b32 m0, 158720
 s_add_u32 s54, s52, 27648
 buffer_load_dwordx4 v3, s[20:23], s54 offen lds
 s_add_u32 s54, s57, 0
 buffer_store_dwordx4 v[12:15], v1, s[28:31], s54 offen sc1
 s_add_u32 s54, s57, 1024
 buffer_store_dwordx4 v[16:19], v1, s[28:31], s54 offen sc1
 s_add_u32 s54, s57, 2048
 buffer_store_dwordx4 v[20:23], v1, s[28:31], s54 offen sc1
 s_add_u32 s54, s57, 3072
 buffer_store_dwordx4 v[24:27], v1, s[28:31], s54 offen sc1
 s_waitcnt vmcnt(16)
 ds_read_b64_tr_b16 v[12:13], v5 offset:8192
 ds_read_b64_tr_b16 v[14:15], v5 offset:10240
 ds_read_b64_tr_b16 v[16:17], v6 offset:8192
 ds_read_b64_tr_b16 v[18:19], v6 offset:10240
 ds_read_b64_tr_b16 v[20:21], v7 offset:8192
 ds_read_b64_tr_b16 v[22:23], v7 offset:10240
 ds_read_b64_tr_b16 v[24:25], v8 offset:8192
 ds_read_b64_tr_b16 v[26:27], v8 offset:10240
 s_waitcnt lgkmcnt(0)
 s_add_u32 s49, s55, 560
 s_mul_i32 s50, s49, 7282
 s_lshr_b32 s50, s50, 16
 s_mul_i32 s54, s50, 9
 s_sub_u32 s51, s49, s54
 s_mul_i32 s52, s50, 36864
 s_lshl_b32 s54, s51, 7
 s_add_u32 s52, s52, s54
 s_mul_i32 s53, s50, 36864
 s_lshl_b32 s54, s51, 12
 s_add_u32 s57, s53, s54
 s_mov_b32 m0, 159744
 s_add_u32 s54, s52, 0
 buffer_load_dwordx4 v3, s[20:23], s54 offen lds
 s_mov_b32 m0, 160768
 s_add_u32 s54, s52, 9216
 buffer_load_dwordx4 v3, s[20:23], s54 offen lds
 s_mov_b32 m0, 161792
 s_add_u32 s54, s52, 18432
 buffer_load_dwordx4 v3, s[20:23], s54 offen lds
 s_mov_b32 m0, 162816
 s_add_u32 s54, s52, 27648
 buffer_load_dwordx4 v3, s[20:23], s54 offen lds
 s_add_u32 s54, s58, 0
 buffer_store_dwordx4 v[12:15], v1, s[28:31], s54 offen sc1
 s_add_u32 s54, s58, 1024
 buffer_store_dwordx4 v[16:19], v1, s[28:31], s54 offen sc1
 s_add_u32 s54, s58, 2048
 buffer_store_dwordx4 v[20:23], v1, s[28:31], s54 offen sc1
 s_add_u32 s54, s58, 3072
 buffer_store_dwordx4 v[24:27], v1, s[28:31], s54 offen sc1
 s_waitcnt vmcnt(20)
 ds_read_b64_tr_b16 v[12:13], v5 offset:0
 ds_read_b64_tr_b16 v[14:15], v5 offset:2048
 ds_read_b64_tr_b16 v[16:17], v6 offset:0
 ds_read_b64_tr_b16 v[18:19], v6 offset:2048
 ds_read_b64_tr_b16 v[20:21], v7 offset:0
 ds_read_b64_tr_b16 v[22:23], v7 offset:2048
 ds_read_b64_tr_b16 v[24:25], v8 offset:0
 ds_read_b64_tr_b16 v[26:27], v8 offset:2048
 s_waitcnt lgkmcnt(0)
 s_add_u32 s49, s55, 672
 s_mul_i32 s50, s49, 7282
 s_lshr_b32 s50, s50, 16
 s_mul_i32 s54, s50, 9
 s_sub_u32 s51, s49, s54
 s_mul_i32 s52, s50, 36864
 s_lshl_b32 s54, s51, 7
 s_add_u32 s52, s52, s54
 s_mul_i32 s53, s50, 36864
 s_lshl_b32 s54, s51, 12
 s_add_u32 s58, s53, s54
 s_mov_b32 m0, 151552
 s_add_u32 s54, s52, 0
 buffer_load_dwordx4 v3, s[20:23], s54 offen lds
 s_mov_b32 m0, 152576
 s_add_u32 s54, s52, 9216
 buffer_load_dwordx4 v3, s[20:23], s54 offen lds
 s_mov_b32 m0, 153600
 s_add_u32 s54, s52, 18432
 buffer_load_dwordx4 v3, s[20:23], s54 offen lds
 s_mov_b32 m0, 154624
 s_add_u32 s54, s52, 27648
 buffer_load_dwordx4 v3, s[20:23], s54 offen lds
 s_add_u32 s54, s59, 0
 buffer_store_dwordx4 v[12:15], v1, s[28:31], s54 offen sc1
 s_add_u32 s54, s59, 1024
 buffer_store_dwordx4 v[16:19], v1, s[28:31], s54 offen sc1
 s_add_u32 s54, s59, 2048
 buffer_store_dwordx4 v[20:23], v1, s[28:31], s54 offen sc1
 s_add_u32 s54, s59, 3072
 buffer_store_dwordx4 v[24:27], v1, s[28:31], s54 offen sc1
 s_waitcnt vmcnt(20)
 ds_read_b64_tr_b16 v[12:13], v5 offset:4096
 ds_read_b64_tr_b16 v[14:15], v5 offset:6144
 ds_read_b64_tr_b16 v[16:17], v6 offset:4096
 ds_read_b64_tr_b16 v[18:19], v6 offset:6144
 ds_read_b64_tr_b16 v[20:21], v7 offset:4096
 ds_read_b64_tr_b16 v[22:23], v7 offset:6144
 ds_read_b64_tr_b16 v[24:25], v8 offset:4096
 ds_read_b64_tr_b16 v[26:27], v8 offset:6144
 s_waitcnt lgkmcnt(0)
 s_add_u32 s49, s55, 784
 s_mul_i32 s50, s49, 7282
 s_lshr_b32 s50, s50, 16
 s_mul_i32 s54, s50, 9
 s_sub_u32 s51, s49, s54
 s_mul_i32 s52, s50, 36864
 s_lshl_b32 s54, s51, 7
 s_add_u32 s52, s52, s54
 s_mul_i32 s53, s50, 36864
 s_lshl_b32 s54, s51, 12
 s_add_u32 s59, s53, s54
 s_mov_b32 m0, 155648
 s_add_u32 s54, s52, 0
 buffer_load_dwordx4 v3, s[20:23], s54 offen lds
 s_mov_b32 m0, 156672
 s_add_u32 s54, s52, 9216
 buffer_load_dwordx4 v3, s[20:23], s54 offen lds
 s_mov_b32 m0, 157696
 s_add_u32 s54, s52, 18432
 buffer_load_dwordx4 v3, s[20:23], s54 offen lds
 s_mov_b32 m0, 158720
 s_add_u32 s54, s52, 27648
 buffer_load_dwordx4 v3, s[20:23], s54 offen lds
 s_add_u32 s54, s56, 0
 buffer_store_dwordx4 v[12:15], v1, s[28:31], s54 offen sc1
 s_add_u32 s54, s56, 1024
 buffer_store_dwordx4 v[16:19], v1, s[28:31], s54 offen sc1
 s_add_u32 s54, s56, 2048
 buffer_store_dwordx4 v[20:23], v1, s[28:31], s54 offen sc1
 s_add_u32 s54, s56, 3072
 buffer_store_dwordx4 v[24:27], v1, s[28:31], s54 offen sc1
 s_waitcnt vmcnt(20)
 ds_read_b64_tr_b16 v[12:13], v5 offset:8192
 ds_read_b64_tr_b16 v[14:15], v5 offset:10240
 ds_read_b64_tr_b16 v[16:17], v6 offset:8192
 ds_read_b64_tr_b16 v[18:19], v6 offset:10240
 ds_read_b64_tr_b16 v[20:21], v7 offset:8192
 ds_read_b64_tr_b16 v[22:23], v7 offset:10240
 ds_read_b64_tr_b16 v[24:25], v8 offset:8192
 ds_read_b64_tr_b16 v[26:27], v8 offset:10240
 s_waitcnt lgkmcnt(0)
 s_add_u32 s49, s55, 896
 s_mul_i32 s50, s49, 7282
 s_lshr_b32 s50, s50, 16
 s_mul_i32 s54, s50, 9
 s_sub_u32 s51, s49, s54
 s_mul_i32 s52, s50, 36864
 s_lshl_b32 s54, s51, 7
 s_add_u32 s52, s52, s54
 s_mul_i32 s53, s50, 36864
 s_lshl_b32 s54, s51, 12
 s_add_u32 s56, s53, s54
 s_mov_b32 m0, 159744
 s_add_u32 s54, s52, 0
 buffer_load_dwordx4 v3, s[20:23], s54 offen lds
 s_mov_b32 m0, 160768
 s_add_u32 s54, s52, 9216
 buffer_load_dwordx4 v3, s[20:23], s54 offen lds
 s_mov_b32 m0, 161792
 s_add_u32 s54, s52, 18432
 buffer_load_dwordx4 v3, s[20:23], s54 offen lds
 s_mov_b32 m0, 162816
 s_add_u32 s54, s52, 27648
 buffer_load_dwordx4 v3, s[20:23], s54 offen lds
 s_add_u32 s54, s57, 0
 buffer_store_dwordx4 v[12:15], v1, s[28:31], s54 offen sc1
 s_add_u32 s54, s57, 1024
 buffer_store_dwordx4 v[16:19], v1, s[28:31], s54 offen sc1
 s_add_u32 s54, s57, 2048
 buffer_store_dwordx4 v[20:23], v1, s[28:31], s54 offen sc1
 s_add_u32 s54, s57, 3072
 buffer_store_dwordx4 v[24:27], v1, s[28:31], s54 offen sc1
 s_waitcnt vmcnt(20)
 ds_read_b64_tr_b16 v[12:13], v5 offset:0
 ds_read_b64_tr_b16 v[14:15], v5 offset:2048
 ds_read_b64_tr_b16 v[16:17], v6 offset:0
 ds_read_b64_tr_b16 v[18:19], v6 offset:2048
 ds_read_b64_tr_b16 v[20:21], v7 offset:0
 ds_read_b64_tr_b16 v[22:23], v7 offset:2048
 ds_read_b64_tr_b16 v[24:25], v8 offset:0
 ds_read_b64_tr_b16 v[26:27], v8 offset:2048
 s_waitcnt lgkmcnt(0)
 s_add_u32 s49, s55, 1008
 s_mul_i32 s50, s49, 7282
 s_lshr_b32 s50, s50, 16
 s_mul_i32 s54, s50, 9
 s_sub_u32 s51, s49, s54
 s_mul_i32 s52, s50, 36864
 s_lshl_b32 s54, s51, 7
 s_add_u32 s52, s52, s54
 s_mul_i32 s53, s50, 36864
 s_lshl_b32 s54, s51, 12
 s_add_u32 s57, s53, s54
 s_mov_b32 m0, 151552
 s_add_u32 s54, s52, 0
 buffer_load_dwordx4 v3, s[20:23], s54 offen lds
 s_mov_b32 m0, 152576
 s_add_u32 s54, s52, 9216
 buffer_load_dwordx4 v3, s[20:23], s54 offen lds
 s_mov_b32 m0, 153600
 s_add_u32 s54, s52, 18432
 buffer_load_dwordx4 v3, s[20:23], s54 offen lds
 s_mov_b32 m0, 154624
 s_add_u32 s54, s52, 27648
 buffer_load_dwordx4 v3, s[20:23], s54 offen lds
 s_add_u32 s54, s58, 0
 buffer_store_dwordx4 v[12:15], v1, s[28:31], s54 offen sc1
 s_add_u32 s54, s58, 1024
 buffer_store_dwordx4 v[16:19], v1, s[28:31], s54 offen sc1
 s_add_u32 s54, s58, 2048
 buffer_store_dwordx4 v[20:23], v1, s[28:31], s54 offen sc1
 s_add_u32 s54, s58, 3072
 buffer_store_dwordx4 v[24:27], v1, s[28:31], s54 offen sc1
 s_waitcnt vmcnt(20)
 ds_read_b64_tr_b16 v[12:13], v5 offset:4096
 ds_read_b64_tr_b16 v[14:15], v5 offset:6144
 ds_read_b64_tr_b16 v[16:17], v6 offset:4096
 ds_read_b64_tr_b16 v[18:19], v6 offset:6144
 ds_read_b64_tr_b16 v[20:21], v7 offset:4096
 ds_read_b64_tr_b16 v[22:23], v7 offset:6144
 ds_read_b64_tr_b16 v[24:25], v8 offset:4096
 ds_read_b64_tr_b16 v[26:27], v8 offset:6144
 s_waitcnt lgkmcnt(0)
 s_add_u32 s49, s55, 1120
 s_mul_i32 s50, s49, 7282
 s_lshr_b32 s50, s50, 16
 s_mul_i32 s54, s50, 9
 s_sub_u32 s51, s49, s54
 s_mul_i32 s52, s50, 36864
 s_lshl_b32 s54, s51, 7
 s_add_u32 s52, s52, s54
 s_mul_i32 s53, s50, 36864
 s_lshl_b32 s54, s51, 12
 s_add_u32 s58, s53, s54
 s_mov_b32 m0, 155648
 s_add_u32 s54, s52, 0
 buffer_load_dwordx4 v3, s[20:23], s54 offen lds
 s_mov_b32 m0, 156672
 s_add_u32 s54, s52, 9216
 buffer_load_dwordx4 v3, s[20:23], s54 offen lds
 s_mov_b32 m0, 157696
 s_add_u32 s54, s52, 18432
 buffer_load_dwordx4 v3, s[20:23], s54 offen lds
 s_mov_b32 m0, 158720
 s_add_u32 s54, s52, 27648
 buffer_load_dwordx4 v3, s[20:23], s54 offen lds
 s_add_u32 s54, s59, 0
 buffer_store_dwordx4 v[12:15], v1, s[28:31], s54 offen sc1
 s_add_u32 s54, s59, 1024
 buffer_store_dwordx4 v[16:19], v1, s[28:31], s54 offen sc1
 s_add_u32 s54, s59, 2048
 buffer_store_dwordx4 v[20:23], v1, s[28:31], s54 offen sc1
 s_add_u32 s54, s59, 3072
 buffer_store_dwordx4 v[24:27], v1, s[28:31], s54 offen sc1
 s_waitcnt vmcnt(20)
 ds_read_b64_tr_b16 v[12:13], v5 offset:8192
 ds_read_b64_tr_b16 v[14:15], v5 offset:10240
 ds_read_b64_tr_b16 v[16:17], v6 offset:8192
 ds_read_b64_tr_b16 v[18:19], v6 offset:10240
 ds_read_b64_tr_b16 v[20:21], v7 offset:8192
 ds_read_b64_tr_b16 v[22:23], v7 offset:10240
 ds_read_b64_tr_b16 v[24:25], v8 offset:8192
 ds_read_b64_tr_b16 v[26:27], v8 offset:10240
 s_waitcnt lgkmcnt(0)
 s_add_u32 s54, s56, 0
 buffer_store_dwordx4 v[12:15], v1, s[28:31], s54 offen sc1
 s_add_u32 s54, s56, 1024
 buffer_store_dwordx4 v[16:19], v1, s[28:31], s54 offen sc1
 s_add_u32 s54, s56, 2048
 buffer_store_dwordx4 v[20:23], v1, s[28:31], s54 offen sc1
 s_add_u32 s54, s56, 3072
 buffer_store_dwordx4 v[24:27], v1, s[28:31], s54 offen sc1
 s_waitcnt vmcnt(16)
 ds_read_b64_tr_b16 v[12:13], v5 offset:0
 ds_read_b64_tr_b16 v[14:15], v5 offset:2048
 ds_read_b64_tr_b16 v[16:17], v6 offset:0
 ds_read_b64_tr_b16 v[18:19], v6 offset:2048
 ds_read_b64_tr_b16 v[20:21], v7 offset:0
 ds_read_b64_tr_b16 v[22:23], v7 offset:2048
 ds_read_b64_tr_b16 v[24:25], v8 offset:0
 ds_read_b64_tr_b16 v[26:27], v8 offset:2048
 s_waitcnt lgkmcnt(0)
 s_add_u32 s54, s57, 0
 buffer_store_dwordx4 v[12:15], v1, s[28:31], s54 offen sc1
 s_add_u32 s54, s57, 1024
 buffer_store_dwordx4 v[16:19], v1, s[28:31], s54 offen sc1
 s_add_u32 s54, s57, 2048
 buffer_store_dwordx4 v[20:23], v1, s[28:31], s54 offen sc1
 s_add_u32 s54, s57, 3072
 buffer_store_dwordx4 v[24:27], v1, s[28:31], s54 offen sc1
 s_waitcnt vmcnt(12)
 ds_read_b64_tr_b16 v[12:13], v5 offset:4096
 ds_read_b64_tr_b16 v[14:15], v5 offset:6144
 ds_read_b64_tr_b16 v[16:17], v6 offset:4096
 ds_read_b64_tr_b16 v[18:19], v6 offset:6144
 ds_read_b64_tr_b16 v[20:21], v7 offset:4096
 ds_read_b64_tr_b16 v[22:23], v7 offset:6144
 ds_read_b64_tr_b16 v[24:25], v8 offset:4096
 ds_read_b64_tr_b16 v[26:27], v8 offset:6144
 s_waitcnt lgkmcnt(0)
 s_add_u32 s54, s58, 0
 buffer_store_dwordx4 v[12:15], v1, s[28:31], s54 offen sc1
 s_add_u32 s54, s58, 1024
 buffer_store_dwordx4 v[16:19], v1, s[28:31], s54 offen sc1
 s_add_u32 s54, s58, 2048
 buffer_store_dwordx4 v[20:23], v1, s[28:31], s54 offen sc1
 s_add_u32 s54, s58, 3072
 buffer_store_dwordx4 v[24:27], v1, s[28:31], s54 offen sc1
 s_load_dwordx2 s[6:7], s[0:1], 16
 s_waitcnt lgkmcnt(0)
 s_mov_b32 s44, s6
 s_mov_b32 s45, s7
 s_mov_b32 s46, 663552
 s_mov_b32 s47, 0x20000
 s_lshr_b32 s54, s55, 3
 s_mul_i32 s54, s54, 47488
 v_lshlrev_b32 v10, 7, v0
 buffer_load_dword v40, v10, s[44:47], s54 offen
 s_add_u32 s54, s54, 8192
 buffer_load_dword v40, v10, s[44:47], s54 offen
 s_add_u32 s54, s54, 8192
 buffer_load_dword v40, v10, s[44:47], s54 offen
 s_add_u32 s54, s54, 8192
 buffer_load_dword v40, v10, s[44:47], s54 offen
 s_add_u32 s54, s54, 8192
 buffer_load_dword v40, v10, s[44:47], s54 offen
 s_add_u32 s54, s54, 8192
 buffer_load_dword v40, v10, s[44:47], s54 offen
 s_add_u32 s54, s54, 8192
 s_cmp_lt_u32 s55, 64
 s_cbranch_scc0 L_att_end
 s_waitcnt vmcnt(0)
 s_add_u32 s49, s55, 1232
 s_mul_i32 s50, s49, 7282
 s_lshr_b32 s50, s50, 16
 s_mul_i32 s54, s50, 9
 s_sub_u32 s51, s49, s54
 s_mul_i32 s52, s50, 36864
 s_lshl_b32 s54, s51, 7
 s_add_u32 s52, s52, s54
 s_mul_i32 s53, s50, 36864
 s_lshl_b32 s54, s51, 12
 s_add_u32 s59, s53, s54
 s_mov_b32 m0, 159744
 s_add_u32 s54, s52, 0
 buffer_load_dwordx4 v3, s[20:23], s54 offen lds
 s_mov_b32 m0, 160768
 s_add_u32 s54, s52, 9216
 buffer_load_dwordx4 v3, s[20:23], s54 offen lds
 s_mov_b32 m0, 161792
 s_add_u32 s54, s52, 18432
 buffer_load_dwordx4 v3, s[20:23], s54 offen lds
 s_mov_b32 m0, 162816
 s_add_u32 s54, s52, 27648
 buffer_load_dwordx4 v3, s[20:23], s54 offen lds
 s_waitcnt vmcnt(0)
 ds_read_b64_tr_b16 v[12:13], v5 offset:8192
 ds_read_b64_tr_b16 v[14:15], v5 offset:10240
 ds_read_b64_tr_b16 v[16:17], v6 offset:8192
 ds_read_b64_tr_b16 v[18:19], v6 offset:10240
 ds_read_b64_tr_b16 v[20:21], v7 offset:8192
 ds_read_b64_tr_b16 v[22:23], v7 offset:10240
 ds_read_b64_tr_b16 v[24:25], v8 offset:8192
 ds_read_b64_tr_b16 v[26:27], v8 offset:10240
 s_waitcnt lgkmcnt(0)
 s_add_u32 s54, s59, 0
 buffer_store_dwordx4 v[12:15], v1, s[28:31], s54 offen sc1
 s_add_u32 s54, s59, 1024
 buffer_store_dwordx4 v[16:19], v1, s[28:31], s54 offen sc1
 s_add_u32 s54, s59, 2048
 buffer_store_dwordx4 v[20:23], v1, s[28:31], s54 offen sc1
 s_add_u32 s54, s59, 3072
 buffer_store_dwordx4 v[24:27], v1, s[28:31], s54 offen sc1
L_att_end:
 s_endpgm
att_kernel_codeend:
.globl pg_kernel
.p2align 8
.type pg_kernel,@function
pg_kernel:
 s_cmp_ge_u32 s2, 256
 s_cbranch_scc1 L_pg_end
 s_load_dwordx2 s[4:5], s[0:1], 88
 v_lshrrev_b32 v14, 6, v0
 v_and_b32 v0, 63, v0
 v_readfirstlane_b32 s32, v14
 s_cmp_ge_u32 s2, 192
 s_cbranch_scc1 L_pg_g1
 s_load_dwordx2 s[6:7], s[0:1], 16
 s_load_dwordx2 s[8:9], s[0:1], 0
 v_lshlrev_b32 v1, 4, v0
 v_add_u32 v112, 0, v0
 v_mul_u32_u24 v113, 21846, v112
 v_lshrrev_b32 v113, 18, v113
 v_mul_u32_u24 v114, 12, v113
 v_sub_u32 v112, v112, v114
 v_lshrrev_b32 v114, 2, v113
 v_and_b32 v114, 1, v114
 v_lshlrev_b32 v114, 1, v114
 v_xor_b32 v112, v112, v114
 v_lshlrev_b32 v112, 4, v112
 v_mul_u32_u24 v113, 1152, v113
 v_add_u32 v2, v112, v113
 v_add_u32 v112, 64, v0
 v_mul_u32_u24 v113, 21846, v112
 v_lshrrev_b32 v113, 18, v113
 v_mul_u32_u24 v114, 12, v113
 v_sub_u32 v112, v112, v114
 v_lshrrev_b32 v114, 2, v113
 v_and_b32 v114, 1, v114
 v_lshlrev_b32 v114, 1, v114
 v_xor_b32 v112, v112, v114
 v_lshlrev_b32 v112, 4, v112
 v_mul_u32_u24 v113, 1152, v113
 v_add_u32 v3, v112, v113
 v_add_u32 v112, 128, v0
 v_mul_u32_u24 v113, 21846, v112
 v_lshrrev_b32 v113, 18, v113
 v_mul_u32_u24 v114, 12, v113
 v_sub_u32 v112, v112, v114
 v_lshrrev_b32 v114, 2, v113
 v_and_b32 v114, 1, v114
 v_lshlrev_b32 v114, 1, v114
 v_xor_b32 v112, v112, v114
 v_lshlrev_b32 v112, 4, v112
 v_mul_u32_u24 v113, 1152, v113
 v_add_u32 v4, v112, v113
 s_and_b32 s35, s2, 7
 s_lshl_b32 s33, s35, 2
 s_lshr_b32 s35, s2, 3
 s_and_b32 s36, s35, 3
 s_add_u32 s33, s33, s36
 s_lshr_b32 s34, s35, 2
 v_lshrrev_b32 v112, 4, v0
 v_bfe_u32 v113, v0, 2, 2
 v_and_b32 v114, 3, v0
 v_and_b32 v115, 15, v0
 v_lshrrev_b32 v116, 1, v112
 v_mul_u32_u24 v116, 18, v116
 v_and_b32 v117, 1, v112
 v_lshlrev_b32 v117, 2, v117
 v_add_u32 v116, v116, v117
 v_add_u32 v116, v116, v113
 v_lshrrev_b32 v117, 2, v116
 v_and_b32 v117, 1, v117
 v_lshlrev_b32 v117, 5, v117
 v_mul_u32_u24 v118, 192, v116
 v_lshlrev_b32 v119, 3, v114
 v_add_u32 v118, v118, v119
 v_add_u32 v5, v118, v117
 v_xor_b32 v117, 32, v117
 v_add_u32 v6, v118, v117
 v_add_u32 v7, 55296, v5
 v_add_u32 v8, 55296, v6
 v_lshlrev_b32 v116, 2, v112
 v_lshrrev_b32 v117, 1, v113
 v_add_u32 v116, v116, v117
 v_mul_u32_u24 v116, 18, v116
 v_and_b32 v117, 1, v113
 v_add_u32 v116, v116, v117
 v_add_u32 v116, 16, v116
 v_lshrrev_b32 v117, 2, v116
 v_and_b32 v117, 1, v117
 v_lshlrev_b32 v117, 5, v117
 v_mul_u32_u24 v118, 192, v116
 v_lshlrev_b32 v119, 3, v114
 v_add_u32 v118, v118, v119
 v_add_u32 v9, v118, v117
 v_xor_b32 v117, 32, v117
 v_add_u32 v10, v118, v117
 s_lshl_b32 s35, s33, 2
 s_add_u32 s35, s35, s32
 s_lshl_b32 s36, s35, 4
 v_add_u32 v116, s36, v115
 v_lshlrev_b32 v117, 15, v112
 v_lshlrev_b32 v118, 4, v116
 v_add_u32 v11, v117, v118
 v_lshlrev_b32 v117, 13, v112
 v_add_u32 v117, v117, v116
 v_lshlrev_b32 v12, 2, v117
 v_add_u32 v117, 0, v0
 v_mul_u32_u24 v118, 21846, v117
 v_lshrrev_b32 v118, 18, v118
 v_mul_u32_u24 v119, 12, v118
 v_sub_u32 v117, v117, v119
 v_lshlrev_b32 v117, 4, v117
 v_mul_u32_u24 v118, 1152, v118
 v_add_u32 v172, v117, v118
 v_add_u32 v117, 64, v0
 v_mul_u32_u24 v118, 21846, v117
 v_lshrrev_b32 v118, 18, v118
 v_mul_u32_u24 v119, 12, v118
 v_sub_u32 v117, v117, v119
 v_lshlrev_b32 v117, 4, v117
 v_mul_u32_u24 v118, 1152, v118
 v_add_u32 v173, v117, v118
 v_add_u32 v117, 128, v0
 v_mul_u32_u24 v118, 21846, v117
 v_lshrrev_b32 v118, 18, v118
 v_mul_u32_u24 v119, 12, v118
 v_sub_u32 v117, v117, v119
 v_lshlrev_b32 v117, 4, v117
 v_mul_u32_u24 v118, 1152, v118
 v_add_u32 v174, v117, v118
 v_mul_u32_u24 v117, 192, v115
 v_lshlrev_b32 v118, 3, v112
 v_add_u32 v117, v117, v118
 s_mul_i32 s36, s32, 3072
 s_add_u32 s36, s36, 110592
 v_add_u32 v13, s36, v117
 v_lshlrev_b32 v14, 4, v112
 s_waitcnt lgkmcnt(0)
 s_mov_b32 s12, s6
 s_mov_b32 s13, s7
 s_mov_b32 s14, 663552
 s_mov_b32 s15, 0x20000
 s_add_u32 s16, s4, 7274496
 s_addc_u32 s17, s5, 0
 s_mov_b32 s18, 2097152
 s_mov_b32 s19, 0x20000
 s_add_u32 s20, s4, 9371648
 s_addc_u32 s21, s5, 0
 s_mov_b32 s22, 262144
 s_mov_b32 s23, 0x20000
 s_mov_b32 s24, s4
 s_mov_b32 s25, s5
 s_mov_b32 s26, 13824
 s_mov_b32 s27, 0x20000
 s_mov_b32 s28, s8
 s_mov_b32 s29, s9
 s_mov_b32 s30, 2359296
 s_mov_b32 s31, 0x20000
 s_add_u32 s44, s4, 9633792
 s_addc_u32 s45, s5, 0
 s_mov_b32 s46, 2359296
 s_mov_b32 s47, 0x20000
 s_add_u32 s48, s4, 11993088
 s_addc_u32 s49, s5, 0
 s_mov_b32 s50, 2359296
 s_mov_b32 s51, 0x20000
 s_add_u32 s52, s4, 59179008
 s_addc_u32 s53, s5, 0
 s_mov_b32 s54, 98304
 s_mov_b32 s55, 0x20000
 s_lshl_b32 s35, s33, 2
 s_add_u32 s35, s35, s32
 s_mul_i32 s35, s35, 18432
 s_mul_i32 s36, s34, 192
 s_add_u32 s35, s35, s36
 s_mul_i32 s38, s32, 3072
 s_add_u32 m0, s38, 110592
 s_nop 0
 buffer_load_dwordx4 v172, s[28:31], s35 offen lds
 s_add_u32 m0, s38, 111616
 s_nop 0
 buffer_load_dwordx4 v173, s[28:31], s35 offen lds
 s_add_u32 m0, s38, 112640
 s_nop 0
 buffer_load_dwordx4 v174, s[28:31], s35 offen lds
 s_mul_i32 s37, s32, 18432
 s_mul_i32 s36, s34, 192
 s_add_u32 s37, s37, s36
 s_mul_i32 s38, s32, 3072
 s_add_u32 m0, s38, 0
 s_add_u32 s36, s37, 0
 buffer_load_dwordx4 v2, s[12:15], s36 offen lds
 s_add_u32 m0, s38, 1024
 s_add_u32 s36, s37, 0
 buffer_load_dwordx4 v3, s[12:15], s36 offen lds
 s_add_u32 m0, s38, 2048
 s_add_u32 s36, s37, 0
 buffer_load_dwordx4 v4, s[12:15], s36 offen lds
 s_add_u32 m0, s38, 12288
 s_add_u32 s36, s37, 73728
 buffer_load_dwordx4 v2, s[12:15], s36 offen lds
 s_add_u32 m0, s38, 13312
 s_add_u32 s36, s37, 73728
 buffer_load_dwordx4 v3, s[12:15], s36 offen lds
 s_add_u32 m0, s38, 14336
 s_add_u32 s36, s37, 73728
 buffer_load_dwordx4 v4, s[12:15], s36 offen lds
 s_add_u32 m0, s38, 24576
 s_add_u32 s36, s37, 147456
 buffer_load_dwordx4 v2, s[12:15], s36 offen lds
 s_add_u32 m0, s38, 25600
 s_add_u32 s36, s37, 147456
 buffer_load_dwordx4 v3, s[12:15], s36 offen lds
 s_add_u32 m0, s38, 26624
 s_add_u32 s36, s37, 147456
 buffer_load_dwordx4 v4, s[12:15], s36 offen lds
 s_mov_b32 s36, 0
 buffer_load_dwordx4 v[16:19], v11, s[16:19], s36 offen
 s_mov_b32 s36, 131072
 buffer_load_dwordx4 v[20:23], v11, s[16:19], s36 offen
 s_mov_b32 s36, 262144
 buffer_load_dwordx4 v[24:27], v11, s[16:19], s36 offen
 s_mov_b32 s36, 393216
 buffer_load_dwordx4 v[28:31], v11, s[16:19], s36 offen
 s_mov_b32 s36, 524288
 buffer_load_dwordx4 v[32:35], v11, s[16:19], s36 offen
 s_waitcnt vmcnt(5)
 s_barrier
 ds_read_b64_tr_b16 v[112:113], v5 offset:0
 ds_read_b64_tr_b16 v[114:115], v5 offset:1536
 ds_read_b64_tr_b16 v[116:117], v6 offset:0
 ds_read_b64_tr_b16 v[118:119], v6 offset:1536
 ds_read_b64_tr_b16 v[120:121], v5 offset:64
 ds_read_b64_tr_b16 v[122:123], v5 offset:1600
 ds_read_b64_tr_b16 v[124:125], v6 offset:64
 ds_read_b64_tr_b16 v[126:127], v6 offset:1600
 ds_read_b64_tr_b16 v[128:129], v5 offset:128
 ds_read_b64_tr_b16 v[130:131], v5 offset:1664
 ds_read_b64_tr_b16 v[132:133], v6 offset:128
 ds_read_b64_tr_b16 v[134:135], v6 offset:1664
 s_waitcnt vmcnt(4) lgkmcnt(0)
 v_mfma_f32_16x16x32_bf16 v[88:91], v[112:115], v[16:19], 0
 s_add_u32 m0, s38, 36864
 s_add_u32 s36, s37, 221184
 buffer_load_dwordx4 v2, s[12:15], s36 offen lds
 s_add_u32 m0, s38, 37888
 s_add_u32 s36, s37, 221184
 buffer_load_dwordx4 v3, s[12:15], s36 offen lds
 s_add_u32 m0, s38, 38912
 s_add_u32 s36, s37, 221184
 buffer_load_dwordx4 v4, s[12:15], s36 offen lds
 v_mfma_f32_16x16x32_bf16 v[92:95], v[116:119], v[16:19], 0
 s_add_u32 m0, s38, 49152
 s_add_u32 s36, s37, 294912
 buffer_load_dwordx4 v2, s[12:15], s36 offen lds
 s_add_u32 m0, s38, 50176
 s_add_u32 s36, s37, 294912
 buffer_load_dwordx4 v3, s[12:15], s36 offen lds
 ds_read_b64_tr_b16 v[136:137], v6 offset:6912
 v_mfma_f32_16x16x32_bf16 v[96:99], v[120:123], v[16:19], 0
 ds_read_b64_tr_b16 v[138:139], v6 offset:8448
 ds_read_b64_tr_b16 v[140:141], v5 offset:6912
 ds_read_b64_tr_b16 v[142:143], v5 offset:8448
 v_mfma_f32_16x16x32_bf16 v[100:103], v[124:127], v[16:19], 0
 ds_read_b64_tr_b16 v[144:145], v6 offset:6976
 ds_read_b64_tr_b16 v[146:147], v6 offset:8512
 ds_read_b64_tr_b16 v[148:149], v5 offset:6976
 v_mfma_f32_16x16x32_bf16 v[104:107], v[128:131], v[16:19], 0
 ds_read_b64_tr_b16 v[150:151], v5 offset:8512
 ds_read_b64_tr_b16 v[152:153], v6 offset:7040
 ds_read_b64_tr_b16 v[154:155], v6 offset:8576
 v_mfma_f32_16x16x32_bf16 v[108:111], v[132:135], v[16:19], 0
 ds_read_b64_tr_b16 v[156:157], v5 offset:7040
 ds_read_b64_tr_b16 v[158:159], v5 offset:8576
 s_waitcnt vmcnt(8) lgkmcnt(0)
 v_mfma_f32_16x16x32_bf16 v[88:91], v[136:139], v[20:23], v[88:91]
 s_add_u32 m0, s38, 51200
 s_add_u32 s36, s37, 294912
 buffer_load_dwordx4 v4, s[12:15], s36 offen lds
 s_add_u32 m0, s38, 61440
 s_add_u32 s36, s37, 368640
 buffer_load_dwordx4 v2, s[12:15], s36 offen lds
 s_add_u32 m0, s38, 62464
 s_add_u32 s36, s37, 368640
 buffer_load_dwordx4 v3, s[12:15], s36 offen lds
 v_mfma_f32_16x16x32_bf16 v[92:95], v[140:143], v[20:23], v[92:95]
 s_add_u32 m0, s38, 63488
 s_add_u32 s36, s37, 368640
 buffer_load_dwordx4 v4, s[12:15], s36 offen lds
 s_mov_b32 s36, 655360
 buffer_load_dwordx4 v[36:39], v11, s[16:19], s36 offen
 ds_read_b64_tr_b16 v[112:113], v5 offset:13824
 v_mfma_f32_16x16x32_bf16 v[96:99], v[144:147], v[20:23], v[96:99]
 ds_read_b64_tr_b16 v[114:115], v5 offset:15360
 ds_read_b64_tr_b16 v[116:117], v6 offset:13824
 ds_read_b64_tr_b16 v[118:119], v6 offset:15360
 v_mfma_f32_16x16x32_bf16 v[100:103], v[148:151], v[20:23], v[100:103]
 ds_read_b64_tr_b16 v[120:121], v5 offset:13888
 ds_read_b64_tr_b16 v[122:123], v5 offset:15424
 ds_read_b64_tr_b16 v[124:125], v6 offset:13888
 v_mfma_f32_16x16x32_bf16 v[104:107], v[152:155], v[20:23], v[104:107]
 ds_read_b64_tr_b16 v[126:127], v6 offset:15424
 ds_read_b64_tr_b16 v[128:129], v5 offset:13952
 ds_read_b64_tr_b16 v[130:131], v5 offset:15488
 v_mfma_f32_16x16x32_bf16 v[108:111], v[156:159], v[20:23], v[108:111]
 ds_read_b64_tr_b16 v[132:133], v6 offset:13952
 ds_read_b64_tr_b16 v[134:135], v6 offset:15488
 s_waitcnt vmcnt(12) lgkmcnt(0)
 v_mfma_f32_16x16x32_bf16 v[88:91], v[112:115], v[24:27], v[88:91]
 s_mov_b32 s36, 786432
 buffer_load_dwordx4 v[40:43], v11, s[16:19], s36 offen
 s_mov_b32 s36, 917504
 buffer_load_dwordx4 v[44:47], v11, s[16:19], s36 offen
 s_mov_b32 s36, 1048576
 buffer_load_dwordx4 v[48:51], v11, s[16:19], s36 offen
 v_mfma_f32_16x16x32_bf16 v[92:95], v[116:119], v[24:27], v[92:95]
 s_mov_b32 s36, 1179648
 buffer_load_dwordx4 v[52:55], v11, s[16:19], s36 offen
 s_add_u32 m0, s38, 73728
 s_add_u32 s36, s37, 442368
 buffer_load_dwordx4 v2, s[12:15], s36 offen lds
 ds_read_b64_tr_b16 v[136:137], v6 offset:20736
 v_mfma_f32_16x16x32_bf16 v[96:99], v[120:123], v[24:27], v[96:99]
 ds_read_b64_tr_b16 v[138:139], v6 offset:22272
 ds_read_b64_tr_b16 v[140:141], v5 offset:20736
 ds_read_b64_tr_b16 v[142:143], v5 offset:22272
 v_mfma_f32_16x16x32_bf16 v[100:103], v[124:127], v[24:27], v[100:103]
 ds_read_b64_tr_b16 v[144:145], v6 offset:20800
 ds_read_b64_tr_b16 v[146:147], v6 offset:22336
 ds_read_b64_tr_b16 v[148:149], v5 offset:20800
 v_mfma_f32_16x16x32_bf16 v[104:107], v[128:131], v[24:27], v[104:107]
 ds_read_b64_tr_b16 v[150:151], v5 offset:22336
 ds_read_b64_tr_b16 v[152:153], v6 offset:20864
 ds_read_b64_tr_b16 v[154:155], v6 offset:22400
 v_mfma_f32_16x16x32_bf16 v[108:111], v[132:135], v[24:27], v[108:111]
 ds_read_b64_tr_b16 v[156:157], v5 offset:20864
 ds_read_b64_tr_b16 v[158:159], v5 offset:22400
 s_waitcnt vmcnt(16) lgkmcnt(0)
 v_mfma_f32_16x16x32_bf16 v[88:91], v[136:139], v[28:31], v[88:91]
 s_add_u32 m0, s38, 74752
 s_add_u32 s36, s37, 442368
 buffer_load_dwordx4 v3, s[12:15], s36 offen lds
 s_add_u32 m0, s38, 75776
 s_add_u32 s36, s37, 442368
 buffer_load_dwordx4 v4, s[12:15], s36 offen lds
 s_add_u32 m0, s38, 86016
 s_add_u32 s36, s37, 516096
 buffer_load_dwordx4 v2, s[12:15], s36 offen lds
 v_mfma_f32_16x16x32_bf16 v[92:95], v[140:143], v[28:31], v[92:95]
 s_add_u32 m0, s38, 87040
 s_add_u32 s36, s37, 516096
 buffer_load_dwordx4 v3, s[12:15], s36 offen lds
 s_add_u32 m0, s38, 88064
 s_add_u32 s36, s37, 516096
 buffer_load_dwordx4 v4, s[12:15], s36 offen lds
 ds_read_b64_tr_b16 v[112:113], v5 offset:27648
 v_mfma_f32_16x16x32_bf16 v[96:99], v[144:147], v[28:31], v[96:99]
 ds_read_b64_tr_b16 v[114:115], v5 offset:29184
 ds_read_b64_tr_b16 v[116:117], v6 offset:27648
 ds_read_b64_tr_b16 v[118:119], v6 offset:29184
 v_mfma_f32_16x16x32_bf16 v[100:103], v[148:151], v[28:31], v[100:103]
 ds_read_b64_tr_b16 v[120:121], v5 offset:27712
 ds_read_b64_tr_b16 v[122:123], v5 offset:29248
 ds_read_b64_tr_b16 v[124:125], v6 offset:27712
 v_mfma_f32_16x16x32_bf16 v[104:107], v[152:155], v[28:31], v[104:107]
 ds_read_b64_tr_b16 v[126:127], v6 offset:29248
 ds_read_b64_tr_b16 v[128:129], v5 offset:27776
 ds_read_b64_tr_b16 v[130:131], v5 offset:29312
 v_mfma_f32_16x16x32_bf16 v[108:111], v[156:159], v[28:31], v[108:111]
 ds_read_b64_tr_b16 v[132:133], v6 offset:27776
 ds_read_b64_tr_b16 v[134:135], v6 offset:29312
 s_waitcnt vmcnt(20) lgkmcnt(0)
 s_waitcnt vmcnt(11)
 s_barrier
 v_mfma_f32_16x16x32_bf16 v[88:91], v[112:115], v[32:35], v[88:91]
 s_add_u32 m0, s38, 98304
 s_add_u32 s36, s37, 589824
 buffer_load_dwordx4 v2, s[12:15], s36 offen lds
 s_add_u32 m0, s38, 99328
 s_add_u32 s36, s37, 589824
 buffer_load_dwordx4 v3, s[12:15], s36 offen lds
 s_add_u32 m0, s38, 100352
 s_add_u32 s36, s37, 589824
 buffer_load_dwordx4 v4, s[12:15], s36 offen lds
 v_mfma_f32_16x16x32_bf16 v[92:95], v[116:119], v[32:35], v[92:95]
 s_mov_b32 s36, 1310720
 buffer_load_dwordx4 v[56:59], v11, s[16:19], s36 offen
 s_mov_b32 s36, 1441792
 buffer_load_dwordx4 v[60:63], v11, s[16:19], s36 offen
 ds_read_b64_tr_b16 v[136:137], v6 offset:34560
 v_mfma_f32_16x16x32_bf16 v[96:99], v[120:123], v[32:35], v[96:99]
 ds_read_b64_tr_b16 v[138:139], v6 offset:36096
 ds_read_b64_tr_b16 v[140:141], v5 offset:34560
 ds_read_b64_tr_b16 v[142:143], v5 offset:36096
 v_mfma_f32_16x16x32_bf16 v[100:103], v[124:127], v[32:35], v[100:103]
 ds_read_b64_tr_b16 v[144:145], v6 offset:34624
 ds_read_b64_tr_b16 v[146:147], v6 offset:36160
 ds_read_b64_tr_b16 v[148:149], v5 offset:34624
 v_mfma_f32_16x16x32_bf16 v[104:107], v[128:131], v[32:35], v[104:107]
 ds_read_b64_tr_b16 v[150:151], v5 offset:36160
 ds_read_b64_tr_b16 v[152:153], v6 offset:34688
 ds_read_b64_tr_b16 v[154:155], v6 offset:36224
 v_mfma_f32_16x16x32_bf16 v[108:111], v[132:135], v[32:35], v[108:111]
 ds_read_b64_tr_b16 v[156:157], v5 offset:34688
 ds_read_b64_tr_b16 v[158:159], v5 offset:36224
 s_waitcnt vmcnt(15) lgkmcnt(0)
 v_mfma_f32_16x16x32_bf16 v[88:91], v[136:139], v[36:39], v[88:91]
 s_mov_b32 s36, 1572864
 buffer_load_dwordx4 v[64:67], v11, s[16:19], s36 offen
 s_mov_b32 s36, 1703936
 buffer_load_dwordx4 v[68:71], v11, s[16:19], s36 offen
 s_mov_b32 s36, 1835008
 buffer_load_dwordx4 v[72:75], v11, s[16:19], s36 offen
 v_mfma_f32_16x16x32_bf16 v[92:95], v[140:143], v[36:39], v[92:95]
 s_mov_b32 s36, 1966080
 buffer_load_dwordx4 v[76:79], v11, s[16:19], s36 offen
 s_mov_b32 s36, 0
 buffer_load_dword v80, v12, s[20:23], s36 offen
 ds_read_b64_tr_b16 v[112:113], v5 offset:41472
 v_mfma_f32_16x16x32_bf16 v[96:99], v[144:147], v[36:39], v[96:99]
 ds_read_b64_tr_b16 v[114:115], v5 offset:43008
 ds_read_b64_tr_b16 v[116:117], v6 offset:41472
 ds_read_b64_tr_b16 v[118:119], v6 offset:43008
 v_mfma_f32_16x16x32_bf16 v[100:103], v[148:151], v[36:39], v[100:103]
 ds_read_b64_tr_b16 v[120:121], v5 offset:41536
 ds_read_b64_tr_b16 v[122:123], v5 offset:43072
 ds_read_b64_tr_b16 v[124:125], v6 offset:41536
 v_mfma_f32_16x16x32_bf16 v[104:107], v[152:155], v[36:39], v[104:107]
 ds_read_b64_tr_b16 v[126:127], v6 offset:43072
 ds_read_b64_tr_b16 v[128:129], v5 offset:41600
 ds_read_b64_tr_b16 v[130:131], v5 offset:43136
 v_mfma_f32_16x16x32_bf16 v[108:111], v[156:159], v[36:39], v[108:111]
 ds_read_b64_tr_b16 v[132:133], v6 offset:41600
 ds_read_b64_tr_b16 v[134:135], v6 offset:43136
 s_waitcnt vmcnt(19) lgkmcnt(0)
 v_mfma_f32_16x16x32_bf16 v[88:91], v[112:115], v[40:43], v[88:91]
 s_mov_b32 s36, 8192
 buffer_load_dword v81, v12, s[20:23], s36 offen
 s_mov_b32 s36, 16384
 buffer_load_dword v82, v12, s[20:23], s36 offen
 s_mov_b32 s36, 24576
 buffer_load_dword v83, v12, s[20:23], s36 offen
 v_mfma_f32_16x16x32_bf16 v[92:95], v[116:119], v[40:43], v[92:95]
 s_mov_b32 s36, 131072
 buffer_load_dword v84, v12, s[20:23], s36 offen
 s_mov_b32 s36, 139264
 buffer_load_dword v85, v12, s[20:23], s36 offen
 ds_read_b64_tr_b16 v[136:137], v6 offset:48384
 v_mfma_f32_16x16x32_bf16 v[96:99], v[120:123], v[40:43], v[96:99]
 ds_read_b64_tr_b16 v[138:139], v6 offset:49920
 ds_read_b64_tr_b16 v[140:141], v5 offset:48384
 ds_read_b64_tr_b16 v[142:143], v5 offset:49920
 v_mfma_f32_16x16x32_bf16 v[100:103], v[124:127], v[40:43], v[100:103]
 ds_read_b64_tr_b16 v[144:145], v6 offset:48448
 ds_read_b64_tr_b16 v[146:147], v6 offset:49984
 ds_read_b64_tr_b16 v[148:149], v5 offset:48448
 v_mfma_f32_16x16x32_bf16 v[104:107], v[128:131], v[40:43], v[104:107]
 ds_read_b64_tr_b16 v[150:151], v5 offset:49984
 ds_read_b64_tr_b16 v[152:153], v6 offset:48512
 ds_read_b64_tr_b16 v[154:155], v6 offset:50048
 v_mfma_f32_16x16x32_bf16 v[108:111], v[132:135], v[40:43], v[108:111]
 ds_read_b64_tr_b16 v[156:157], v5 offset:48512
 ds_read_b64_tr_b16 v[158:159], v5 offset:50048
 s_waitcnt vmcnt(23) lgkmcnt(0)
 v_mfma_f32_16x16x32_bf16 v[88:91], v[136:139], v[44:47], v[88:91]
 s_mov_b32 s36, 147456
 buffer_load_dword v86, v12, s[20:23], s36 offen
 s_mov_b32 s36, 155648
 buffer_load_dword v87, v12, s[20:23], s36 offen
 s_mul_i32 s35, s34, 384
 s_add_u32 s35, s35, 4608
 buffer_load_dwordx4 v[176:179], v14, s[24:27], s35 offen offset:0
 v_mfma_f32_16x16x32_bf16 v[92:95], v[140:143], v[44:47], v[92:95]
 buffer_load_dwordx4 v[180:183], v14, s[24:27], s35 offen offset:64
 buffer_load_dwordx4 v[184:187], v14, s[24:27], s35 offen offset:128
 ds_read_b64_tr_b16 v[112:113], v7 offset:0
 v_mfma_f32_16x16x32_bf16 v[96:99], v[144:147], v[44:47], v[96:99]
 ds_read_b64_tr_b16 v[114:115], v7 offset:1536
 ds_read_b64_tr_b16 v[116:117], v8 offset:0
 ds_read_b64_tr_b16 v[118:119], v8 offset:1536
 v_mfma_f32_16x16x32_bf16 v[100:103], v[148:151], v[44:47], v[100:103]
 ds_read_b64_tr_b16 v[120:121], v7 offset:64
 ds_read_b64_tr_b16 v[122:123], v7 offset:1600
 ds_read_b64_tr_b16 v[124:125], v8 offset:64
 v_mfma_f32_16x16x32_bf16 v[104:107], v[152:155], v[44:47], v[104:107]
 ds_read_b64_tr_b16 v[126:127], v8 offset:1600
 ds_read_b64_tr_b16 v[128:129], v7 offset:128
 ds_read_b64_tr_b16 v[130:131], v7 offset:1664
 v_mfma_f32_16x16x32_bf16 v[108:111], v[156:159], v[44:47], v[108:111]
 ds_read_b64_tr_b16 v[132:133], v8 offset:128
 ds_read_b64_tr_b16 v[134:135], v8 offset:1664
 s_waitcnt vmcnt(27) lgkmcnt(0)
 v_mfma_f32_16x16x32_bf16 v[88:91], v[112:115], v[48:51], v[88:91]
 buffer_load_dwordx4 v[188:191], v14, s[24:27], s35 offen offset:192
 buffer_load_dwordx4 v[192:195], v14, s[24:27], s35 offen offset:256
 buffer_load_dwordx4 v[196:199], v14, s[24:27], s35 offen offset:320
 v_mfma_f32_16x16x32_bf16 v[92:95], v[116:119], v[48:51], v[92:95]
 s_mul_i32 s35, s34, 384
 s_add_u32 s35, s35, 9216
 buffer_load_dwordx4 v[200:203], v14, s[24:27], s35 offen offset:0
 buffer_load_dwordx4 v[204:207], v14, s[24:27], s35 offen offset:64
 ds_read_b64_tr_b16 v[136:137], v8 offset:6912
 v_mfma_f32_16x16x32_bf16 v[96:99], v[120:123], v[48:51], v[96:99]
 ds_read_b64_tr_b16 v[138:139], v8 offset:8448
 ds_read_b64_tr_b16 v[140:141], v7 offset:6912
 ds_read_b64_tr_b16 v[142:143], v7 offset:8448
 v_mfma_f32_16x16x32_bf16 v[100:103], v[124:127], v[48:51], v[100:103]
 ds_read_b64_tr_b16 v[144:145], v8 offset:6976
 ds_read_b64_tr_b16 v[146:147], v8 offset:8512
 ds_read_b64_tr_b16 v[148:149], v7 offset:6976
 v_mfma_f32_16x16x32_bf16 v[104:107], v[128:131], v[48:51], v[104:107]
 ds_read_b64_tr_b16 v[150:151], v7 offset:8512
 ds_read_b64_tr_b16 v[152:153], v8 offset:7040
 ds_read_b64_tr_b16 v[154:155], v8 offset:8576
 v_mfma_f32_16x16x32_bf16 v[108:111], v[132:135], v[48:51], v[108:111]
 ds_read_b64_tr_b16 v[156:157], v7 offset:7040
 ds_read_b64_tr_b16 v[158:159], v7 offset:8576
 s_waitcnt vmcnt(31) lgkmcnt(0)
 s_waitcnt vmcnt(22)
 s_barrier
 v_mfma_f32_16x16x32_bf16 v[88:91], v[136:139], v[52:55], v[88:91]
 buffer_load_dwordx4 v[208:211], v14, s[24:27], s35 offen offset:128
 buffer_load_dwordx4 v[212:215], v14, s[24:27], s35 offen offset:192
 buffer_load_dwordx4 v[216:219], v14, s[24:27], s35 offen offset:256
 v_mfma_f32_16x16x32_bf16 v[92:95], v[140:143], v[52:55], v[92:95]
 buffer_load_dwordx4 v[220:223], v14, s[24:27], s35 offen offset:320
 ds_read_b64_tr_b16 v[112:113], v7 offset:13824
 ds_read_b64_tr_b16 v[114:115], v7 offset:15360
 v_mfma_f32_16x16x32_bf16 v[96:99], v[144:147], v[52:55], v[96:99]
 ds_read_b64_tr_b16 v[116:117], v8 offset:13824
 ds_read_b64_tr_b16 v[118:119], v8 offset:15360
 v_mfma_f32_16x16x32_bf16 v[100:103], v[148:151], v[52:55], v[100:103]
 ds_read_b64_tr_b16 v[120:121], v7 offset:13888
 ds_read_b64_tr_b16 v[122:123], v7 offset:15424
 ds_read_b64_tr_b16 v[124:125], v8 offset:13888
 v_mfma_f32_16x16x32_bf16 v[104:107], v[152:155], v[52:55], v[104:107]
 ds_read_b64_tr_b16 v[126:127], v8 offset:15424
 ds_read_b64_tr_b16 v[128:129], v7 offset:13952
 ds_read_b64_tr_b16 v[130:131], v7 offset:15488
 v_mfma_f32_16x16x32_bf16 v[108:111], v[156:159], v[52:55], v[108:111]
 ds_read_b64_tr_b16 v[132:133], v8 offset:13952
 ds_read_b64_tr_b16 v[134:135], v8 offset:15488
 s_waitcnt vmcnt(25) lgkmcnt(0)
 v_mfma_f32_16x16x32_bf16 v[88:91], v[112:115], v[56:59], v[88:91]
 ds_read_b64_tr_b16 v[136:137], v8 offset:20736
 ds_read_b64_tr_b16 v[138:139], v8 offset:22272
 v_mfma_f32_16x16x32_bf16 v[92:95], v[116:119], v[56:59], v[92:95]
 ds_read_b64_tr_b16 v[140:141], v7 offset:20736
 ds_read_b64_tr_b16 v[142:143], v7 offset:22272
 v_mfma_f32_16x16x32_bf16 v[96:99], v[120:123], v[56:59], v[96:99]
 ds_read_b64_tr_b16 v[144:145], v8 offset:20800
 ds_read_b64_tr_b16 v[146:147], v8 offset:22336
 v_mfma_f32_16x16x32_bf16 v[100:103], v[124:127], v[56:59], v[100:103]
 ds_read_b64_tr_b16 v[148:149], v7 offset:20800
 ds_read_b64_tr_b16 v[150:151], v7 offset:22336
 v_mfma_f32_16x16x32_bf16 v[104:107], v[128:131], v[56:59], v[104:107]
 ds_read_b64_tr_b16 v[152:153], v8 offset:20864
 ds_read_b64_tr_b16 v[154:155], v8 offset:22400
 v_mfma_f32_16x16x32_bf16 v[108:111], v[132:135], v[56:59], v[108:111]
 ds_read_b64_tr_b16 v[156:157], v7 offset:20864
 ds_read_b64_tr_b16 v[158:159], v7 offset:22400
 s_waitcnt vmcnt(24) lgkmcnt(0)
 v_mfma_f32_16x16x32_bf16 v[88:91], v[136:139], v[60:63], v[88:91]
 ds_read_b64_tr_b16 v[112:113], v7 offset:27648
 ds_read_b64_tr_b16 v[114:115], v7 offset:29184
 v_mfma_f32_16x16x32_bf16 v[92:95], v[140:143], v[60:63], v[92:95]
 ds_read_b64_tr_b16 v[116:117], v8 offset:27648
 ds_read_b64_tr_b16 v[118:119], v8 offset:29184
 v_mfma_f32_16x16x32_bf16 v[96:99], v[144:147], v[60:63], v[96:99]
 ds_read_b64_tr_b16 v[120:121], v7 offset:27712
 ds_read_b64_tr_b16 v[122:123], v7 offset:29248
 v_mfma_f32_16x16x32_bf16 v[100:103], v[148:151], v[60:63], v[100:103]
 ds_read_b64_tr_b16 v[124:125], v8 offset:27712
 ds_read_b64_tr_b16 v[126:127], v8 offset:29248
 v_mfma_f32_16x16x32_bf16 v[104:107], v[152:155], v[60:63], v[104:107]
 ds_read_b64_tr_b16 v[128:129], v7 offset:27776
 ds_read_b64_tr_b16 v[130:131], v7 offset:29312
 v_mfma_f32_16x16x32_bf16 v[108:111], v[156:159], v[60:63], v[108:111]
 ds_read_b64_tr_b16 v[132:133], v8 offset:27776
 ds_read_b64_tr_b16 v[134:135], v8 offset:29312
 s_waitcnt vmcnt(23) lgkmcnt(0)
 v_mfma_f32_16x16x32_bf16 v[88:91], v[112:115], v[64:67], v[88:91]
 ds_read_b64_tr_b16 v[136:137], v8 offset:34560
 ds_read_b64_tr_b16 v[138:139], v8 offset:36096
 v_mfma_f32_16x16x32_bf16 v[92:95], v[116:119], v[64:67], v[92:95]
 ds_read_b64_tr_b16 v[140:141], v7 offset:34560
 ds_read_b64_tr_b16 v[142:143], v7 offset:36096
 v_mfma_f32_16x16x32_bf16 v[96:99], v[120:123], v[64:67], v[96:99]
 ds_read_b64_tr_b16 v[144:145], v8 offset:34624
 ds_read_b64_tr_b16 v[146:147], v8 offset:36160
 v_mfma_f32_16x16x32_bf16 v[100:103], v[124:127], v[64:67], v[100:103]
 ds_read_b64_tr_b16 v[148:149], v7 offset:34624
 ds_read_b64_tr_b16 v[150:151], v7 offset:36160
 v_mfma_f32_16x16x32_bf16 v[104:107], v[128:131], v[64:67], v[104:107]
 ds_read_b64_tr_b16 v[152:153], v8 offset:34688
 ds_read_b64_tr_b16 v[154:155], v8 offset:36224
 v_mfma_f32_16x16x32_bf16 v[108:111], v[132:135], v[64:67], v[108:111]
 ds_read_b64_tr_b16 v[156:157], v7 offset:34688
 ds_read_b64_tr_b16 v[158:159], v7 offset:36224
 s_waitcnt vmcnt(22) lgkmcnt(0)
 v_mfma_f32_16x16x32_bf16 v[88:91], v[136:139], v[68:71], v[88:91]
 ds_read_b64_tr_b16 v[112:113], v7 offset:41472
 ds_read_b64_tr_b16 v[114:115], v7 offset:43008
 v_mfma_f32_16x16x32_bf16 v[92:95], v[140:143], v[68:71], v[92:95]
 ds_read_b64_tr_b16 v[116:117], v8 offset:41472
 ds_read_b64_tr_b16 v[118:119], v8 offset:43008
 v_mfma_f32_16x16x32_bf16 v[96:99], v[144:147], v[68:71], v[96:99]
 ds_read_b64_tr_b16 v[120:121], v7 offset:41536
 ds_read_b64_tr_b16 v[122:123], v7 offset:43072
 v_mfma_f32_16x16x32_bf16 v[100:103], v[148:151], v[68:71], v[100:103]
 ds_read_b64_tr_b16 v[124:125], v8 offset:41536
 ds_read_b64_tr_b16 v[126:127], v8 offset:43072
 v_mfma_f32_16x16x32_bf16 v[104:107], v[152:155], v[68:71], v[104:107]
 ds_read_b64_tr_b16 v[128:129], v7 offset:41600
 ds_read_b64_tr_b16 v[130:131], v7 offset:43136
 v_mfma_f32_16x16x32_bf16 v[108:111], v[156:159], v[68:71], v[108:111]
 ds_read_b64_tr_b16 v[132:133], v8 offset:41600
 ds_read_b64_tr_b16 v[134:135], v8 offset:43136
 s_waitcnt vmcnt(21) lgkmcnt(0)
 v_mfma_f32_16x16x32_bf16 v[88:91], v[112:115], v[72:75], v[88:91]
 ds_read_b64_tr_b16 v[136:137], v8 offset:48384
 ds_read_b64_tr_b16 v[138:139], v8 offset:49920
 v_mfma_f32_16x16x32_bf16 v[92:95], v[116:119], v[72:75], v[92:95]
 ds_read_b64_tr_b16 v[140:141], v7 offset:48384
 ds_read_b64_tr_b16 v[142:143], v7 offset:49920
 v_mfma_f32_16x16x32_bf16 v[96:99], v[120:123], v[72:75], v[96:99]
 ds_read_b64_tr_b16 v[144:145], v8 offset:48448
 ds_read_b64_tr_b16 v[146:147], v8 offset:49984
 v_mfma_f32_16x16x32_bf16 v[100:103], v[124:127], v[72:75], v[100:103]
 ds_read_b64_tr_b16 v[148:149], v7 offset:48448
 ds_read_b64_tr_b16 v[150:151], v7 offset:49984
 v_mfma_f32_16x16x32_bf16 v[104:107], v[128:131], v[72:75], v[104:107]
 ds_read_b64_tr_b16 v[152:153], v8 offset:48512
 ds_read_b64_tr_b16 v[154:155], v8 offset:50048
 v_mfma_f32_16x16x32_bf16 v[108:111], v[132:135], v[72:75], v[108:111]
 ds_read_b64_tr_b16 v[156:157], v7 offset:48512
 ds_read_b64_tr_b16 v[158:159], v7 offset:50048
 s_waitcnt vmcnt(20) lgkmcnt(0)
 v_mfma_f32_16x16x32_bf16 v[88:91], v[136:139], v[76:79], v[88:91]
 ds_read_b64_tr_b16 v[112:113], v9 offset:0
 ds_read_b64_tr_b16 v[114:115], v10 offset:6912
 v_mfma_f32_16x16x32_bf16 v[92:95], v[140:143], v[76:79], v[92:95]
 ds_read_b64_tr_b16 v[116:117], v10 offset:0
 ds_read_b64_tr_b16 v[118:119], v9 offset:6912
 v_mfma_f32_16x16x32_bf16 v[96:99], v[144:147], v[76:79], v[96:99]
 ds_read_b64_tr_b16 v[120:121], v9 offset:64
 ds_read_b64_tr_b16 v[122:123], v10 offset:6976
 v_mfma_f32_16x16x32_bf16 v[100:103], v[148:151], v[76:79], v[100:103]
 ds_read_b64_tr_b16 v[124:125], v10 offset:64
 ds_read_b64_tr_b16 v[126:127], v9 offset:6976
 v_mfma_f32_16x16x32_bf16 v[104:107], v[152:155], v[76:79], v[104:107]
 ds_read_b64_tr_b16 v[128:129], v9 offset:128
 ds_read_b64_tr_b16 v[130:131], v10 offset:7040
 v_mfma_f32_16x16x32_bf16 v[108:111], v[156:159], v[76:79], v[108:111]
 ds_read_b64_tr_b16 v[132:133], v10 offset:128
 ds_read_b64_tr_b16 v[134:135], v9 offset:7040
 s_waitcnt vmcnt(16) lgkmcnt(0)
 v_mfma_f32_16x16x32_bf16 v[88:91], v[112:115], v[80:83], v[88:91]
 ds_read_b64_tr_b16 v[136:137], v9 offset:55296
 ds_read_b64_tr_b16 v[138:139], v10 offset:62208
 v_mfma_f32_16x16x32_bf16 v[92:95], v[116:119], v[80:83], v[92:95]
 ds_read_b64_tr_b16 v[140:141], v10 offset:55296
 ds_read_b64_tr_b16 v[142:143], v9 offset:62208
 v_mfma_f32_16x16x32_bf16 v[96:99], v[120:123], v[80:83], v[96:99]
 ds_read_b64_tr_b16 v[144:145], v9 offset:55360
 ds_read_b64_tr_b16 v[146:147], v10 offset:62272
 v_mfma_f32_16x16x32_bf16 v[100:103], v[124:127], v[80:83], v[100:103]
 ds_read_b64_tr_b16 v[148:149], v10 offset:55360
 ds_read_b64_tr_b16 v[150:151], v9 offset:62272
 v_mfma_f32_16x16x32_bf16 v[104:107], v[128:131], v[80:83], v[104:107]
 ds_read_b64_tr_b16 v[152:153], v9 offset:55424
 ds_read_b64_tr_b16 v[154:155], v10 offset:62336
 v_mfma_f32_16x16x32_bf16 v[108:111], v[132:135], v[80:83], v[108:111]
 ds_read_b64_tr_b16 v[156:157], v10 offset:55424
 ds_read_b64_tr_b16 v[158:159], v9 offset:62336
 s_waitcnt vmcnt(12) lgkmcnt(0)
 v_mfma_f32_16x16x32_bf16 v[88:91], v[136:139], v[84:87], v[88:91]
 v_mfma_f32_16x16x32_bf16 v[92:95], v[140:143], v[84:87], v[92:95]
 v_mfma_f32_16x16x32_bf16 v[96:99], v[144:147], v[84:87], v[96:99]
 v_mfma_f32_16x16x32_bf16 v[100:103], v[148:151], v[84:87], v[100:103]
 v_mfma_f32_16x16x32_bf16 v[104:107], v[152:155], v[84:87], v[104:107]
 v_mfma_f32_16x16x32_bf16 v[108:111], v[156:159], v[84:87], v[108:111]
 ds_read_b64 v[160:161], v13 offset:0
 ds_read_b64 v[162:163], v13 offset:32
 ds_read_b64 v[164:165], v13 offset:64
 ds_read_b64 v[166:167], v13 offset:96
 ds_read_b64 v[168:169], v13 offset:128
 ds_read_b64 v[170:171], v13 offset:160
 s_waitcnt vmcnt(0) lgkmcnt(0)
 v_mov_b32 v14, 0
 v_mov_b32 v15, 0
 v_lshlrev_b32 v112, 16, v160
 v_and_b32 v113, 0xffff0000, v160
 v_lshlrev_b32 v114, 16, v161
 v_and_b32 v115, 0xffff0000, v161
 v_fma_f32 v112, v176, v88, v112
 v_fma_f32 v113, v177, v89, v113
 v_fma_f32 v114, v178, v90, v114
 v_fma_f32 v115, v179, v91, v115
 v_cvt_pk_bf16_f32 v16, v112, v113
 v_cvt_pk_bf16_f32 v17, v114, v115
 v_add_f32 v14, v14, v112
 v_fmac_f32 v15, v112, v112
 v_add_f32 v14, v14, v113
 v_fmac_f32 v15, v113, v113
 v_add_f32 v14, v14, v114
 v_fmac_f32 v15, v114, v114
 v_add_f32 v14, v14, v115
 v_fmac_f32 v15, v115, v115
 v_mul_f32 v112, v200, v112
 v_mul_f32 v113, v201, v113
 v_mul_f32 v114, v202, v114
 v_mul_f32 v115, v203, v115
 v_cvt_pk_bf16_f32 v32, v112, v113
 v_cvt_pk_bf16_f32 v33, v114, v115
 v_lshlrev_b32 v116, 16, v162
 v_and_b32 v117, 0xffff0000, v162
 v_lshlrev_b32 v118, 16, v163
 v_and_b32 v119, 0xffff0000, v163
 v_fma_f32 v116, v180, v92, v116
 v_fma_f32 v117, v181, v93, v117
 v_fma_f32 v118, v182, v94, v118
 v_fma_f32 v119, v183, v95, v119
 v_cvt_pk_bf16_f32 v18, v116, v117
 v_cvt_pk_bf16_f32 v19, v118, v119
 v_add_f32 v14, v14, v116
 v_fmac_f32 v15, v116, v116
 v_add_f32 v14, v14, v117
 v_fmac_f32 v15, v117, v117
 v_add_f32 v14, v14, v118
 v_fmac_f32 v15, v118, v118
 v_add_f32 v14, v14, v119
 v_fmac_f32 v15, v119, v119
 v_mul_f32 v116, v204, v116
 v_mul_f32 v117, v205, v117
 v_mul_f32 v118, v206, v118
 v_mul_f32 v119, v207, v119
 v_cvt_pk_bf16_f32 v34, v116, v117
 v_cvt_pk_bf16_f32 v35, v118, v119
 v_lshlrev_b32 v120, 16, v164
 v_and_b32 v121, 0xffff0000, v164
 v_lshlrev_b32 v122, 16, v165
 v_and_b32 v123, 0xffff0000, v165
 v_fma_f32 v120, v184, v96, v120
 v_fma_f32 v121, v185, v97, v121
 v_fma_f32 v122, v186, v98, v122
 v_fma_f32 v123, v187, v99, v123
 v_cvt_pk_bf16_f32 v20, v120, v121
 v_cvt_pk_bf16_f32 v21, v122, v123
 v_add_f32 v14, v14, v120
 v_fmac_f32 v15, v120, v120
 v_add_f32 v14, v14, v121
 v_fmac_f32 v15, v121, v121
 v_add_f32 v14, v14, v122
 v_fmac_f32 v15, v122, v122
 v_add_f32 v14, v14, v123
 v_fmac_f32 v15, v123, v123
 v_mul_f32 v120, v208, v120
 v_mul_f32 v121, v209, v121
 v_mul_f32 v122, v210, v122
 v_mul_f32 v123, v211, v123
 v_cvt_pk_bf16_f32 v36, v120, v121
 v_cvt_pk_bf16_f32 v37, v122, v123
 v_lshlrev_b32 v124, 16, v166
 v_and_b32 v125, 0xffff0000, v166
 v_lshlrev_b32 v126, 16, v167
 v_and_b32 v127, 0xffff0000, v167
 v_fma_f32 v124, v188, v100, v124
 v_fma_f32 v125, v189, v101, v125
 v_fma_f32 v126, v190, v102, v126
 v_fma_f32 v127, v191, v103, v127
 v_cvt_pk_bf16_f32 v22, v124, v125
 v_cvt_pk_bf16_f32 v23, v126, v127
 v_add_f32 v14, v14, v124
 v_fmac_f32 v15, v124, v124
 v_add_f32 v14, v14, v125
 v_fmac_f32 v15, v125, v125
 v_add_f32 v14, v14, v126
 v_fmac_f32 v15, v126, v126
 v_add_f32 v14, v14, v127
 v_fmac_f32 v15, v127, v127
 v_mul_f32 v124, v212, v124
 v_mul_f32 v125, v213, v125
 v_mul_f32 v126, v214, v126
 v_mul_f32 v127, v215, v127
 v_cvt_pk_bf16_f32 v38, v124, v125
 v_cvt_pk_bf16_f32 v39, v126, v127
 v_lshlrev_b32 v128, 16, v168
 v_and_b32 v129, 0xffff0000, v168
 v_lshlrev_b32 v130, 16, v169
 v_and_b32 v131, 0xffff0000, v169
 v_fma_f32 v128, v192, v104, v128
 v_fma_f32 v129, v193, v105, v129
 v_fma_f32 v130, v194, v106, v130
 v_fma_f32 v131, v195, v107, v131
 v_cvt_pk_bf16_f32 v24, v128, v129
 v_cvt_pk_bf16_f32 v25, v130, v131
 v_add_f32 v14, v14, v128
 v_fmac_f32 v15, v128, v128
 v_add_f32 v14, v14, v129
 v_fmac_f32 v15, v129, v129
 v_add_f32 v14, v14, v130
 v_fmac_f32 v15, v130, v130
 v_add_f32 v14, v14, v131
 v_fmac_f32 v15, v131, v131
 v_mul_f32 v128, v216, v128
 v_mul_f32 v129, v217, v129
 v_mul_f32 v130, v218, v130
 v_mul_f32 v131, v219, v131
 v_cvt_pk_bf16_f32 v40, v128, v129
 v_cvt_pk_bf16_f32 v41, v130, v131
 v_lshlrev_b32 v132, 16, v170
 v_and_b32 v133, 0xffff0000, v170
 v_lshlrev_b32 v134, 16, v171
 v_and_b32 v135, 0xffff0000, v171
 v_fma_f32 v132, v196, v108, v132
 v_fma_f32 v133, v197, v109, v133
 v_fma_f32 v134, v198, v110, v134
 v_fma_f32 v135, v199, v111, v135
 v_cvt_pk_bf16_f32 v26, v132, v133
 v_cvt_pk_bf16_f32 v27, v134, v135
 v_add_f32 v14, v14, v132
 v_fmac_f32 v15, v132, v132
 v_add_f32 v14, v14, v133
 v_fmac_f32 v15, v133, v133
 v_add_f32 v14, v14, v134
 v_fmac_f32 v15, v134, v134
 v_add_f32 v14, v14, v135
 v_fmac_f32 v15, v135, v135
 v_mul_f32 v132, v220, v132
 v_mul_f32 v133, v221, v133
 v_mul_f32 v134, v222, v134
 v_mul_f32 v135, v223, v135
 v_cvt_pk_bf16_f32 v42, v132, v133
 v_cvt_pk_bf16_f32 v43, v134, v135
 s_lshl_b32 s35, s33, 2
 s_add_u32 s35, s35, s32
 s_mul_i32 s37, s35, 18432
 s_mul_i32 s36, s34, 3072
 s_add_u32 s37, s37, s36
 buffer_store_dwordx4 v[32:35], v1, s[48:51], s37 offen offset:0 sc1
 buffer_store_dwordx4 v[36:39], v1, s[48:51], s37 offen offset:1024 sc1
 buffer_store_dwordx4 v[40:43], v1, s[48:51], s37 offen offset:2048 sc1
 buffer_store_dwordx4 v[16:19], v1, s[44:47], s37 offen offset:0 sc1
 buffer_store_dwordx4 v[20:23], v1, s[44:47], s37 offen offset:1024 sc1
 buffer_store_dwordx4 v[24:27], v1, s[44:47], s37 offen offset:2048 sc1
 v_mov_b32 v13, v14
 s_nop 1
 v_permlane32_swap_b32 v14, v13
 v_add_f32 v14, v14, v13
 v_mov_b32 v13, v14
 s_nop 1
 v_permlane16_swap_b32 v14, v13
 v_add_f32 v14, v14, v13
 v_mov_b32 v13, v15
 s_nop 1
 v_permlane32_swap_b32 v15, v13
 v_add_f32 v15, v15, v13
 v_mov_b32 v13, v15
 s_nop 1
 v_permlane16_swap_b32 v15, v13
 v_add_f32 v15, v15, v13
 v_lshlrev_b32 v12, 3, v0
 s_lshl_b32 s35, s35, 7
 s_lshl_b32 s36, s34, 14
 s_add_u32 s35, s35, s36
 s_mov_b64 s[56:57], exec
 s_mov_b64 exec, 0xffff
 buffer_store_dwordx2 v[14:15], v12, s[52:55], s35 offen sc1
 s_mov_b64 exec, s[56:57]
 s_waitcnt vmcnt(0)
 s_barrier
 s_cmp_eq_u32 s32, 0
 s_cbranch_scc0 L_pg_g1
 s_add_u32 s16, s4, 59310080
 s_addc_u32 s17, s5, 0
 s_mov_b32 s18, 24576
 s_mov_b32 s19, 0x20000
 s_lshr_b32 s35, s33, 2
 s_add_u32 s35, s35, 64
 s_lshl_b32 s35, s35, 7
 v_mov_b32 v12, s35
 v_mov_b32 v13, 1
 s_mov_b64 s[56:57], exec
 s_mov_b64 exec, 1
 buffer_atomic_add v13, v12, s[16:19], 0 offen sc1
 s_mov_b64 exec, s[56:57]
L_pg_g1:
 v_lshlrev_b32 v1, 4, v0
 v_add_u32 v2, 0, v1
 v_add_u32 v3, 38912, v1
 v_add_u32 v4, 77824, v1
 v_add_u32 v5, 116736, v1
 s_and_b32 s35, s2, 1
 s_lshl_b32 s33, s35, 2
 s_lshr_b32 s35, s2, 6
 s_add_u32 s33, s33, s35
 s_lshr_b32 s34, s2, 1
 s_and_b32 s34, s34, 3
 s_lshl_b32 s34, s34, 3
 s_lshr_b32 s35, s2, 3
 s_and_b32 s35, s35, 7
 s_add_u32 s34, s34, s35
 s_lshl_b32 s35, s33, 4
 s_lshl_b32 s36, s32, 2
 s_add_u32 s35, s35, s36
 s_mul_i32 s48, s35, 18432
 s_add_u32 s49, s48, 18432
 s_add_u32 s50, s48, 36864
 s_add_u32 s51, s48, 55296
 s_mul_i32 s46, s35, 147456
 s_mul_i32 s43, s34, 311296
 s_add_u32 s45, s34, 256
 s_mul_i32 s45, s45, 38912
 s_lshr_b32 s35, s32, 1
 s_mul_i32 s35, s35, 38912
 s_and_b32 s36, s32, 1
 s_lshl_b32 s40, s36, 11
 s_add_u32 s40, s40, s35
 s_add_u32 s39, s40, s43
 s_lshl_b32 s42, s36, 10
 s_add_u32 s42, s42, s35
 s_add_u32 s42, s42, 77824
 s_add_u32 s41, s42, s43
 s_mul_i32 s44, s32, 10
 s_min_u32 s44, s44, 28
 s_lshl_b32 s44, s44, 10
 s_mov_b32 s37, 0xbfb8aa3b
 s_and_b32 s35, s34, 1
 s_lshl_b32 s35, s35, 3
 v_add_u32 v6, s35, v1
 s_waitcnt lgkmcnt(0)
 s_add_u32 s12, s4, 33226752
 s_addc_u32 s13, s5, 0
 s_mov_b32 s14, 11206656
 s_mov_b32 s15, 0x20000
 s_add_u32 s16, s4, 11993088
 s_addc_u32 s17, s5, 0
 s_mov_b32 s18, 2359296
 s_mov_b32 s19, 0x20000
 s_add_u32 s20, s4, 14352384
 s_addc_u32 s21, s5, 0
 s_mov_b32 s22, 18874368
 s_mov_b32 s23, 0x20000
 s_add_u32 s24, s4, 59179008
 s_addc_u32 s25, s5, 0
 s_mov_b32 s26, 98304
 s_mov_b32 s27, 0x20000
 s_mov_b32 m0, s40
 s_nop 0
 buffer_load_dwordx4 v1, s[12:15], s39 offen lds
 buffer_load_dwordx4 v1, s[12:15], s39 offen offset:1024 lds
 s_add_u32 s39, s39, 4096
 s_add_u32 s40, s40, 4096
 s_mov_b32 m0, s42
 s_nop 0
 buffer_load_dwordx4 v1, s[12:15], s41 offen lds
 s_add_u32 s41, s41, 2048
 s_add_u32 s42, s42, 2048
 s_mov_b32 m0, s40
 s_nop 0
 buffer_load_dwordx4 v1, s[12:15], s39 offen lds
 buffer_load_dwordx4 v1, s[12:15], s39 offen offset:1024 lds
 s_add_u32 s39, s39, 4096
 s_add_u32 s40, s40, 4096
 s_mov_b32 m0, s42
 s_nop 0
 buffer_load_dwordx4 v1, s[12:15], s41 offen lds
 s_add_u32 s41, s41, 2048
 s_add_u32 s42, s42, 2048
 s_mov_b32 m0, s40
 s_nop 0
 buffer_load_dwordx4 v1, s[12:15], s39 offen lds
 buffer_load_dwordx4 v1, s[12:15], s39 offen offset:1024 lds
 s_add_u32 s39, s39, 4096
 s_add_u32 s40, s40, 4096
 s_mov_b32 m0, s42
 s_nop 0
 buffer_load_dwordx4 v1, s[12:15], s41 offen lds
 s_add_u32 s41, s41, 2048
 s_add_u32 s42, s42, 2048
 s_add_u32 s28, s4, 59310080
 s_addc_u32 s29, s5, 0
 s_mov_b32 s30, 24576
 s_mov_b32 s31, 0x20000
 s_cmp_eq_u32 s32, 0
 s_cbranch_scc0 L_pg_met
 s_add_u32 s35, s33, 64
 s_lshl_b32 s35, s35, 7
 v_mov_b32 v8, s35
 s_mov_b32 s36, 0
 s_mov_b64 s[56:57], exec
 s_mov_b64 exec, 1
L_pg_poll:
 buffer_load_dword v9, v8, s[28:31], 0 offen sc1
 s_waitcnt vmcnt(0)
 v_readfirstlane_b32 s35, v9
 s_nop 0
 s_cmp_ge_u32 s35, 24
 s_cbranch_scc1 L_pg_met0
 s_add_u32 s36, s36, 1
 s_cmp_lt_u32 s36, 0x100000
 s_cbranch_scc0 L_pg_met0
 s_sleep 2
 s_branch L_pg_poll
L_pg_met0:
 s_mov_b64 exec, s[56:57]
L_pg_met:
 s_barrier
 v_lshrrev_b32 v8, 4, v0
 v_lshlrev_b32 v8, 14, v8
 v_and_b32 v9, 15, v0
 v_lshlrev_b32 v9, 3, v9
 v_add_u32 v8, v8, v9
 v_add_u32 v9, 65536, v8
 v_mov_b32 v194, 0
 v_mov_b32 v195, 0
 v_mov_b32 v198, 0
 v_mov_b32 v199, 0
 v_mov_b32 v202, 0
 v_mov_b32 v203, 0
 v_mov_b32 v206, 0
 v_mov_b32 v207, 0
 s_lshl_b32 s35, s33, 4
 s_lshl_b32 s36, s32, 2
 s_add_u32 s35, s35, s36
 s_lshl_b32 s35, s35, 7
 buffer_load_dwordx2 v[192:193], v8, s[24:27], s35 offen offset:0 sc1
 buffer_load_dwordx2 v[196:197], v8, s[24:27], s35 offen offset:128 sc1
 buffer_load_dwordx2 v[200:201], v8, s[24:27], s35 offen offset:256 sc1
 buffer_load_dwordx2 v[204:205], v8, s[24:27], s35 offen offset:384 sc1
 s_mov_b64 s[56:57], exec
 s_mov_b64 exec, 0xffffffff
 buffer_load_dwordx2 v[194:195], v9, s[24:27], s35 offen offset:0 sc1
 buffer_load_dwordx2 v[198:199], v9, s[24:27], s35 offen offset:128 sc1
 buffer_load_dwordx2 v[202:203], v9, s[24:27], s35 offen offset:256 sc1
 buffer_load_dwordx2 v[206:207], v9, s[24:27], s35 offen offset:384 sc1
 s_mov_b64 exec, s[56:57]
 buffer_load_dwordx4 a[0:3], v1, s[16:19], s48 offen offset:0 sc1
 buffer_load_dwordx4 a[4:7], v1, s[16:19], s49 offen offset:0 sc1
 buffer_load_dwordx4 a[8:11], v1, s[16:19], s50 offen offset:0 sc1
 buffer_load_dwordx4 a[12:15], v1, s[16:19], s51 offen offset:0 sc1
 buffer_load_dwordx4 a[16:19], v1, s[16:19], s48 offen offset:1024 sc1
 buffer_load_dwordx4 a[20:23], v1, s[16:19], s49 offen offset:1024 sc1
 buffer_load_dwordx4 a[24:27], v1, s[16:19], s50 offen offset:1024 sc1
 buffer_load_dwordx4 a[28:31], v1, s[16:19], s51 offen offset:1024 sc1
 buffer_load_dwordx4 a[32:35], v1, s[16:19], s48 offen offset:2048 sc1
 buffer_load_dwordx4 a[36:39], v1, s[16:19], s49 offen offset:2048 sc1
 buffer_load_dwordx4 a[40:43], v1, s[16:19], s50 offen offset:2048 sc1
 buffer_load_dwordx4 a[44:47], v1, s[16:19], s51 offen offset:2048 sc1
 buffer_load_dwordx4 a[48:51], v1, s[16:19], s48 offen offset:3072 sc1
 s_add_u32 s48, s48, 4096
 buffer_load_dwordx4 a[52:55], v1, s[16:19], s49 offen offset:3072 sc1
 s_add_u32 s49, s49, 4096
 buffer_load_dwordx4 a[56:59], v1, s[16:19], s50 offen offset:3072 sc1
 s_add_u32 s50, s50, 4096
 buffer_load_dwordx4 a[60:63], v1, s[16:19], s51 offen offset:3072 sc1
 s_add_u32 s51, s51, 4096
 buffer_load_dwordx4 a[64:67], v1, s[16:19], s48 offen offset:0 sc1
 buffer_load_dwordx4 a[68:71], v1, s[16:19], s49 offen offset:0 sc1
 buffer_load_dwordx4 a[72:75], v1, s[16:19], s50 offen offset:0 sc1
 buffer_load_dwordx4 a[76:79], v1, s[16:19], s51 offen offset:0 sc1
 buffer_load_dwordx4 a[80:83], v1, s[16:19], s48 offen offset:1024 sc1
 buffer_load_dwordx4 a[84:87], v1, s[16:19], s49 offen offset:1024 sc1
 buffer_load_dwordx4 a[88:91], v1, s[16:19], s50 offen offset:1024 sc1
 buffer_load_dwordx4 a[92:95], v1, s[16:19], s51 offen offset:1024 sc1
 v_cmp_gt_u32 s[52:53], 16, v0
 s_waitcnt vmcnt(16)
 s_barrier
 ds_read_b128 v[40:43], v2 offset:0
 ds_read_b128 v[44:47], v2 offset:1024
 ds_read_b128 v[48:51], v3 offset:0
 ds_read_b128 v[52:55], v3 offset:1024
 s_waitcnt lgkmcnt(2)
 v_mfma_f32_16x16x32_bf16 v[64:67], v[40:43], a[0:3], 0
 ds_read_b128 v[56:59], v4 offset:0
 v_mfma_f32_16x16x32_bf16 v[68:71], v[40:43], a[4:7], 0
 ds_read_b128 v[60:63], v4 offset:1024
 v_mfma_f32_16x16x32_bf16 v[72:75], v[40:43], a[8:11], 0
 buffer_load_dwordx4 a[96:99], v1, s[16:19], s48 offen offset:2048 sc1
 v_mfma_f32_16x16x32_bf16 v[76:79], v[40:43], a[12:15], 0
 v_mfma_f32_16x16x32_bf16 v[80:83], v[44:47], a[0:3], 0
 buffer_load_dwordx4 a[100:103], v1, s[16:19], s49 offen offset:2048 sc1
 v_mfma_f32_16x16x32_bf16 v[84:87], v[44:47], a[4:7], 0
 v_mfma_f32_16x16x32_bf16 v[88:91], v[44:47], a[8:11], 0
 v_mfma_f32_16x16x32_bf16 v[92:95], v[44:47], a[12:15], 0
 s_waitcnt lgkmcnt(2)
 v_mfma_f32_16x16x32_bf16 v[96:99], v[48:51], a[0:3], 0
 ds_read_b128 v[40:43], v2 offset:2048
 v_mfma_f32_16x16x32_bf16 v[100:103], v[48:51], a[4:7], 0
 ds_read_b128 v[44:47], v2 offset:3072
 v_mfma_f32_16x16x32_bf16 v[104:107], v[48:51], a[8:11], 0
 buffer_load_dwordx4 a[104:107], v1, s[16:19], s50 offen offset:2048 sc1
 v_mfma_f32_16x16x32_bf16 v[108:111], v[48:51], a[12:15], 0
 v_mfma_f32_16x16x32_bf16 v[112:115], v[52:55], a[0:3], 0
 buffer_load_dwordx4 a[108:111], v1, s[16:19], s51 offen offset:2048 sc1
 v_mfma_f32_16x16x32_bf16 v[116:119], v[52:55], a[4:7], 0
 v_mfma_f32_16x16x32_bf16 v[120:123], v[52:55], a[8:11], 0
 v_mfma_f32_16x16x32_bf16 v[124:127], v[52:55], a[12:15], 0
 s_waitcnt lgkmcnt(2)
 v_mfma_f32_16x16x32_bf16 v[128:131], v[56:59], a[0:3], 0
 ds_read_b128 v[48:51], v3 offset:2048
 v_mfma_f32_16x16x32_bf16 v[132:135], v[56:59], a[4:7], 0
 ds_read_b128 v[52:55], v3 offset:3072
 v_mfma_f32_16x16x32_bf16 v[136:139], v[56:59], a[8:11], 0
 buffer_load_dwordx4 a[112:115], v1, s[16:19], s48 offen offset:3072 sc1
 s_add_u32 s48, s48, 4096
 v_mfma_f32_16x16x32_bf16 v[140:143], v[56:59], a[12:15], 0
 v_mfma_f32_16x16x32_bf16 v[144:147], v[60:63], a[0:3], 0
 buffer_load_dwordx4 a[116:119], v1, s[16:19], s49 offen offset:3072 sc1
 s_add_u32 s49, s49, 4096
 v_mfma_f32_16x16x32_bf16 v[148:151], v[60:63], a[4:7], 0
 v_mfma_f32_16x16x32_bf16 v[152:155], v[60:63], a[8:11], 0
 v_mfma_f32_16x16x32_bf16 v[156:159], v[60:63], a[12:15], 0
 s_waitcnt lgkmcnt(2)
 v_mfma_f32_16x16x32_bf16 v[64:67], v[40:43], a[16:19], v[64:67]
 ds_read_b128 v[56:59], v5 offset:0
 v_mfma_f32_16x16x32_bf16 v[68:71], v[40:43], a[20:23], v[68:71]
 ds_read_b128 v[60:63], v5 offset:1024
 v_mfma_f32_16x16x32_bf16 v[72:75], v[40:43], a[24:27], v[72:75]
 buffer_load_dwordx4 a[120:123], v1, s[16:19], s50 offen offset:3072 sc1
 s_add_u32 s50, s50, 4096
 v_mfma_f32_16x16x32_bf16 v[76:79], v[40:43], a[28:31], v[76:79]
 v_mfma_f32_16x16x32_bf16 v[80:83], v[44:47], a[16:19], v[80:83]
 v_mfma_f32_16x16x32_bf16 v[84:87], v[44:47], a[20:23], v[84:87]
 v_mfma_f32_16x16x32_bf16 v[88:91], v[44:47], a[24:27], v[88:91]
 v_mfma_f32_16x16x32_bf16 v[92:95], v[44:47], a[28:31], v[92:95]
 s_waitcnt vmcnt(15)
 s_barrier
 s_waitcnt lgkmcnt(2)
 v_mfma_f32_16x16x32_bf16 v[96:99], v[48:51], a[16:19], v[96:99]
 ds_read_b128 v[40:43], v2 offset:4096
 v_mfma_f32_16x16x32_bf16 v[100:103], v[48:51], a[20:23], v[100:103]
 ds_read_b128 v[44:47], v2 offset:5120
 v_mfma_f32_16x16x32_bf16 v[104:107], v[48:51], a[24:27], v[104:107]
 buffer_load_dwordx4 a[124:127], v1, s[16:19], s51 offen offset:3072 sc1
 s_add_u32 s51, s51, 4096
 v_mfma_f32_16x16x32_bf16 v[108:111], v[48:51], a[28:31], v[108:111]
 v_mfma_f32_16x16x32_bf16 v[112:115], v[52:55], a[16:19], v[112:115]
 v_mfma_f32_16x16x32_bf16 v[116:119], v[52:55], a[20:23], v[116:119]
 v_mfma_f32_16x16x32_bf16 v[120:123], v[52:55], a[24:27], v[120:123]
 v_mfma_f32_16x16x32_bf16 v[124:127], v[52:55], a[28:31], v[124:127]
 s_waitcnt lgkmcnt(2)
 v_mfma_f32_16x16x32_bf16 v[160:163], v[56:59], a[0:3], 0
 ds_read_b128 v[48:51], v3 offset:4096
 v_mfma_f32_16x16x32_bf16 v[164:167], v[56:59], a[4:7], 0
 ds_read_b128 v[52:55], v3 offset:5120
 v_mfma_f32_16x16x32_bf16 v[168:171], v[56:59], a[8:11], 0
 s_mov_b32 m0, s40
 s_nop 0
 buffer_load_dwordx4 v1, s[12:15], s39 offen lds
 v_mfma_f32_16x16x32_bf16 v[172:175], v[56:59], a[12:15], 0
 v_mfma_f32_16x16x32_bf16 v[176:179], v[60:63], a[0:3], 0
 v_mfma_f32_16x16x32_bf16 v[180:183], v[60:63], a[4:7], 0
 v_mfma_f32_16x16x32_bf16 v[184:187], v[60:63], a[8:11], 0
 v_mfma_f32_16x16x32_bf16 v[188:191], v[60:63], a[12:15], 0
 s_waitcnt lgkmcnt(2)
 v_mfma_f32_16x16x32_bf16 v[64:67], v[40:43], a[32:35], v[64:67]
 ds_read_b128 v[56:59], v4 offset:2048
 v_add_f32 v192, v192, v194
 v_mfma_f32_16x16x32_bf16 v[68:71], v[40:43], a[36:39], v[68:71]
 ds_read_b128 v[60:63], v4 offset:3072
 v_add_f32 v196, v196, v198
 v_mfma_f32_16x16x32_bf16 v[72:75], v[40:43], a[40:43], v[72:75]
 buffer_load_dwordx4 v1, s[12:15], s39 offen offset:1024 lds
 s_add_u32 s39, s39, 4096
 s_add_u32 s40, s40, 4096
 v_mfma_f32_16x16x32_bf16 v[76:79], v[40:43], a[44:47], v[76:79]
 v_add_f32 v200, v200, v202
 v_add_f32 v204, v204, v206
 v_mfma_f32_16x16x32_bf16 v[80:83], v[44:47], a[32:35], v[80:83]
 s_mov_b32 m0, s42
 s_nop 0
 buffer_load_dwordx4 v1, s[12:15], s41 offen lds
 s_add_u32 s41, s41, 2048
 s_add_u32 s42, s42, 2048
 v_mfma_f32_16x16x32_bf16 v[84:87], v[44:47], a[36:39], v[84:87]
 v_add_f32 v193, v193, v195
 v_add_f32 v197, v197, v199
 v_mfma_f32_16x16x32_bf16 v[88:91], v[44:47], a[40:43], v[88:91]
 buffer_load_dwordx4 a[128:131], v1, s[16:19], s48 offen offset:0 sc1
 v_mfma_f32_16x16x32_bf16 v[92:95], v[44:47], a[44:47], v[92:95]
 v_add_f32 v201, v201, v203
 v_add_f32 v205, v205, v207
 s_waitcnt lgkmcnt(2)
 v_mfma_f32_16x16x32_bf16 v[96:99], v[48:51], a[32:35], v[96:99]
 ds_read_b128 v[40:43], v2 offset:6144
 v_mov_b32 v208, v192
 v_mfma_f32_16x16x32_bf16 v[100:103], v[48:51], a[36:39], v[100:103]
 ds_read_b128 v[44:47], v2 offset:7168
 v_mov_b32 v210, v196
 v_mfma_f32_16x16x32_bf16 v[104:107], v[48:51], a[40:43], v[104:107]
 buffer_load_dwordx4 a[132:135], v1, s[16:19], s49 offen offset:0 sc1
 v_mfma_f32_16x16x32_bf16 v[108:111], v[48:51], a[44:47], v[108:111]
 v_mov_b32 v212, v200
 v_mov_b32 v214, v204
 v_mfma_f32_16x16x32_bf16 v[112:115], v[52:55], a[32:35], v[112:115]
 buffer_load_dwordx4 a[136:139], v1, s[16:19], s50 offen offset:0 sc1
 v_mfma_f32_16x16x32_bf16 v[116:119], v[52:55], a[36:39], v[116:119]
 s_nop 1
 v_permlane32_swap_b32 v192, v208
 s_nop 1
 v_permlane32_swap_b32 v196, v210
 v_mfma_f32_16x16x32_bf16 v[120:123], v[52:55], a[40:43], v[120:123]
 s_nop 1
 v_permlane32_swap_b32 v200, v212
 s_nop 1
 v_permlane32_swap_b32 v204, v214
 v_mfma_f32_16x16x32_bf16 v[124:127], v[52:55], a[44:47], v[124:127]
 v_add_f32 v192, v192, v208
 v_add_f32 v196, v196, v210
 s_waitcnt lgkmcnt(2)
 v_mfma_f32_16x16x32_bf16 v[128:131], v[56:59], a[16:19], v[128:131]
 ds_read_b128 v[48:51], v3 offset:6144
 v_add_f32 v200, v200, v212
 v_mfma_f32_16x16x32_bf16 v[132:135], v[56:59], a[20:23], v[132:135]
 ds_read_b128 v[52:55], v3 offset:7168
 v_add_f32 v204, v204, v214
 v_mfma_f32_16x16x32_bf16 v[136:139], v[56:59], a[24:27], v[136:139]
 buffer_load_dwordx4 a[140:143], v1, s[16:19], s51 offen offset:0 sc1
 v_mfma_f32_16x16x32_bf16 v[140:143], v[56:59], a[28:31], v[140:143]
 v_mov_b32 v208, v192
 v_mov_b32 v210, v196
 v_mfma_f32_16x16x32_bf16 v[144:147], v[60:63], a[16:19], v[144:147]
 buffer_load_dwordx4 a[144:147], v1, s[16:19], s48 offen offset:1024 sc1
 v_mfma_f32_16x16x32_bf16 v[148:151], v[60:63], a[20:23], v[148:151]
 v_mov_b32 v212, v200
 v_mov_b32 v214, v204
 v_mfma_f32_16x16x32_bf16 v[152:155], v[60:63], a[24:27], v[152:155]
 s_nop 1
 v_permlane16_swap_b32 v192, v208
 s_nop 1
 v_permlane16_swap_b32 v196, v210
 v_mfma_f32_16x16x32_bf16 v[156:159], v[60:63], a[28:31], v[156:159]
 s_nop 1
 v_permlane16_swap_b32 v200, v212
 s_nop 1
 v_permlane16_swap_b32 v204, v214
 s_waitcnt lgkmcnt(2)
 v_mfma_f32_16x16x32_bf16 v[64:67], v[40:43], a[48:51], v[64:67]
 ds_read_b128 v[56:59], v5 offset:2048
 v_add_f32 v192, v192, v208
 v_mfma_f32_16x16x32_bf16 v[68:71], v[40:43], a[52:55], v[68:71]
 ds_read_b128 v[60:63], v5 offset:3072
 v_add_f32 v196, v196, v210
 v_mfma_f32_16x16x32_bf16 v[72:75], v[40:43], a[56:59], v[72:75]
 buffer_load_dwordx4 a[148:151], v1, s[16:19], s49 offen offset:1024 sc1
 v_mfma_f32_16x16x32_bf16 v[76:79], v[40:43], a[60:63], v[76:79]
 v_add_f32 v200, v200, v212
 v_add_f32 v204, v204, v214
 v_mfma_f32_16x16x32_bf16 v[80:83], v[44:47], a[48:51], v[80:83]
 v_mov_b32 v208, v193
 v_mov_b32 v210, v197
 v_mfma_f32_16x16x32_bf16 v[84:87], v[44:47], a[52:55], v[84:87]
 v_mov_b32 v212, v201
 v_mov_b32 v214, v205
 v_mfma_f32_16x16x32_bf16 v[88:91], v[44:47], a[56:59], v[88:91]
 s_nop 1
 v_permlane32_swap_b32 v193, v208
 s_nop 1
 v_permlane32_swap_b32 v197, v210
 v_mfma_f32_16x16x32_bf16 v[92:95], v[44:47], a[60:63], v[92:95]
 s_nop 1
 v_permlane32_swap_b32 v201, v212
 s_nop 1
 v_permlane32_swap_b32 v205, v214
 s_waitcnt vmcnt(17)
 s_barrier
 s_waitcnt lgkmcnt(2)
 v_mfma_f32_16x16x32_bf16 v[96:99], v[48:51], a[48:51], v[96:99]
 ds_read_b128 v[40:43], v2 offset:8192
 v_add_f32 v193, v193, v208
 v_mfma_f32_16x16x32_bf16 v[100:103], v[48:51], a[52:55], v[100:103]
 ds_read_b128 v[44:47], v2 offset:9216
 v_add_f32 v197, v197, v210
 v_mfma_f32_16x16x32_bf16 v[104:107], v[48:51], a[56:59], v[104:107]
 buffer_load_dwordx4 a[152:155], v1, s[16:19], s50 offen offset:1024 sc1
 v_mfma_f32_16x16x32_bf16 v[108:111], v[48:51], a[60:63], v[108:111]
 v_add_f32 v201, v201, v212
 v_add_f32 v205, v205, v214
 v_mfma_f32_16x16x32_bf16 v[112:115], v[52:55], a[48:51], v[112:115]
 v_mov_b32 v208, v193
 v_mov_b32 v210, v197
 v_mfma_f32_16x16x32_bf16 v[116:119], v[52:55], a[52:55], v[116:119]
 v_mov_b32 v212, v201
 v_mov_b32 v214, v205
 v_mfma_f32_16x16x32_bf16 v[120:123], v[52:55], a[56:59], v[120:123]
 s_nop 1
 v_permlane16_swap_b32 v193, v208
 s_nop 1
 v_permlane16_swap_b32 v197, v210
 v_mfma_f32_16x16x32_bf16 v[124:127], v[52:55], a[60:63], v[124:127]
 s_nop 1
 v_permlane16_swap_b32 v201, v212
 s_nop 1
 v_permlane16_swap_b32 v205, v214
 s_waitcnt lgkmcnt(2)
 v_mfma_f32_16x16x32_bf16 v[160:163], v[56:59], a[16:19], v[160:163]
 ds_read_b128 v[48:51], v3 offset:8192
 v_add_f32 v193, v193, v208
 v_mfma_f32_16x16x32_bf16 v[164:167], v[56:59], a[20:23], v[164:167]
 ds_read_b128 v[52:55], v3 offset:9216
 v_add_f32 v197, v197, v210
 v_mfma_f32_16x16x32_bf16 v[168:171], v[56:59], a[24:27], v[168:171]
 buffer_load_dwordx4 a[156:159], v1, s[16:19], s51 offen offset:1024 sc1
 v_mfma_f32_16x16x32_bf16 v[172:175], v[56:59], a[28:31], v[172:175]
 v_add_f32 v201, v201, v212
 v_add_f32 v205, v205, v214
 v_mfma_f32_16x16x32_bf16 v[176:179], v[60:63], a[16:19], v[176:179]
 v_mul_f32 v192, 0x3ae38e39, v192
 v_mul_f32 v196, 0x3ae38e39, v196
 v_mfma_f32_16x16x32_bf16 v[180:183], v[60:63], a[20:23], v[180:183]
 v_mul_f32 v200, 0x3ae38e39, v200
 v_mul_f32 v204, 0x3ae38e39, v204
 v_mfma_f32_16x16x32_bf16 v[184:187], v[60:63], a[24:27], v[184:187]
 v_mul_f32 v193, 0x3ae38e39, v193
 v_mul_f32 v197, 0x3ae38e39, v197
 v_mfma_f32_16x16x32_bf16 v[188:191], v[60:63], a[28:31], v[188:191]
 v_mul_f32 v201, 0x3ae38e39, v201
 v_mul_f32 v205, 0x3ae38e39, v205
 s_waitcnt lgkmcnt(2)
 v_mfma_f32_16x16x32_bf16 v[64:67], v[40:43], a[64:67], v[64:67]
 ds_read_b128 v[56:59], v4 offset:4096
 v_fma_f32 v193, -v192, v192, v193
 v_mfma_f32_16x16x32_bf16 v[68:71], v[40:43], a[68:71], v[68:71]
 ds_read_b128 v[60:63], v4 offset:5120
 v_fma_f32 v197, -v196, v196, v197
 v_mfma_f32_16x16x32_bf16 v[72:75], v[40:43], a[72:75], v[72:75]
 s_mov_b32 m0, s40
 s_nop 0
 buffer_load_dwordx4 v1, s[12:15], s39 offen lds
 v_mfma_f32_16x16x32_bf16 v[76:79], v[40:43], a[76:79], v[76:79]
 v_fma_f32 v201, -v200, v200, v201
 v_fma_f32 v205, -v204, v204, v205
 v_mfma_f32_16x16x32_bf16 v[80:83], v[44:47], a[64:67], v[80:83]
 buffer_load_dwordx4 v1, s[12:15], s39 offen offset:1024 lds
 s_add_u32 s39, s39, 4096
 s_add_u32 s40, s40, 4096
 v_mfma_f32_16x16x32_bf16 v[84:87], v[44:47], a[68:71], v[84:87]
 v_max_f32 v193, 0, v193
 v_max_f32 v197, 0, v197
 v_mfma_f32_16x16x32_bf16 v[88:91], v[44:47], a[72:75], v[88:91]
 s_mov_b32 m0, s42
 s_nop 0
 buffer_load_dwordx4 v1, s[12:15], s41 offen lds
 s_add_u32 s41, s41, 2048
 s_add_u32 s42, s42, 2048
 v_mfma_f32_16x16x32_bf16 v[92:95], v[44:47], a[76:79], v[92:95]
 v_max_f32 v201, 0, v201
 v_max_f32 v205, 0, v205
 s_waitcnt lgkmcnt(2)
 v_mfma_f32_16x16x32_bf16 v[96:99], v[48:51], a[64:67], v[96:99]
 ds_read_b128 v[40:43], v2 offset:10240
 v_add_f32 v236, 0x3727c5ac, v193
 v_mfma_f32_16x16x32_bf16 v[100:103], v[48:51], a[68:71], v[100:103]
 ds_read_b128 v[44:47], v2 offset:11264
 v_add_f32 v237, 0x3727c5ac, v197
 v_mfma_f32_16x16x32_bf16 v[104:107], v[48:51], a[72:75], v[104:107]
 buffer_load_dwordx4 a[160:163], v1, s[16:19], s48 offen offset:2048 sc1
 v_mfma_f32_16x16x32_bf16 v[108:111], v[48:51], a[76:79], v[108:111]
 v_add_f32 v238, 0x3727c5ac, v201
 v_add_f32 v239, 0x3727c5ac, v205
 v_mfma_f32_16x16x32_bf16 v[112:115], v[52:55], a[64:67], v[112:115]
 buffer_load_dwordx4 a[164:167], v1, s[16:19], s49 offen offset:2048 sc1
 v_mfma_f32_16x16x32_bf16 v[116:119], v[52:55], a[68:71], v[116:119]
 v_rsq_f32 v208, v236
 v_rsq_f32 v210, v237
 v_mfma_f32_16x16x32_bf16 v[120:123], v[52:55], a[72:75], v[120:123]
 v_rsq_f32 v212, v238
 v_rsq_f32 v214, v239
 v_mfma_f32_16x16x32_bf16 v[124:127], v[52:55], a[76:79], v[124:127]
 v_sub_f32 v192, 0, v192
 v_sub_f32 v196, 0, v196
 s_waitcnt lgkmcnt(2)
 v_mfma_f32_16x16x32_bf16 v[128:131], v[56:59], a[32:35], v[128:131]
 ds_read_b128 v[48:51], v3 offset:10240
 v_sub_f32 v200, 0, v200
 v_mfma_f32_16x16x32_bf16 v[132:135], v[56:59], a[36:39], v[132:135]
 ds_read_b128 v[52:55], v3 offset:11264
 v_sub_f32 v204, 0, v204
 v_mfma_f32_16x16x32_bf16 v[136:139], v[56:59], a[40:43], v[136:139]
 buffer_load_dwordx4 a[168:171], v1, s[16:19], s50 offen offset:2048 sc1
 v_mfma_f32_16x16x32_bf16 v[140:143], v[56:59], a[44:47], v[140:143]
 v_mul_f32 v232, s37, v208
 v_mul_f32 v233, s37, v210
 v_mfma_f32_16x16x32_bf16 v[144:147], v[60:63], a[32:35], v[144:147]
 buffer_load_dwordx4 a[172:175], v1, s[16:19], s51 offen offset:2048 sc1
 v_mfma_f32_16x16x32_bf16 v[148:151], v[60:63], a[36:39], v[148:151]
 v_mul_f32 v234, s37, v212
 v_mul_f32 v235, s37, v214
 v_mfma_f32_16x16x32_bf16 v[152:155], v[60:63], a[40:43], v[152:155]
 v_mul_f32 v193, v236, v208
 v_mul_f32 v197, v237, v210
 v_mfma_f32_16x16x32_bf16 v[156:159], v[60:63], a[44:47], v[156:159]
 v_mul_f32 v201, v238, v212
 v_mul_f32 v205, v239, v214
 s_waitcnt lgkmcnt(2)
 v_mfma_f32_16x16x32_bf16 v[64:67], v[40:43], a[80:83], v[64:67]
 ds_read_b128 v[56:59], v5 offset:4096
 v_cndmask_b32 v192, 0, v192, s[52:53]
 v_mfma_f32_16x16x32_bf16 v[68:71], v[40:43], a[84:87], v[68:71]
 ds_read_b128 v[60:63], v5 offset:5120
 v_cndmask_b32 v196, 0, v196, s[52:53]
 v_mfma_f32_16x16x32_bf16 v[72:75], v[40:43], a[88:91], v[72:75]
 buffer_load_dwordx4 a[176:179], v1, s[16:19], s48 offen offset:3072 sc1
 s_add_u32 s48, s48, 4096
 v_mfma_f32_16x16x32_bf16 v[76:79], v[40:43], a[92:95], v[76:79]
 v_cndmask_b32 v200, 0, v200, s[52:53]
 v_cndmask_b32 v204, 0, v204, s[52:53]
 v_mfma_f32_16x16x32_bf16 v[80:83], v[44:47], a[80:83], v[80:83]
 buffer_load_dwordx4 a[180:183], v1, s[16:19], s49 offen offset:3072 sc1
 s_add_u32 s49, s49, 4096
 v_mfma_f32_16x16x32_bf16 v[84:87], v[44:47], a[84:87], v[84:87]
 v_cndmask_b32 v193, 0, v193, s[52:53]
 v_cndmask_b32 v197, 0, v197, s[52:53]
 v_mfma_f32_16x16x32_bf16 v[88:91], v[44:47], a[88:91], v[88:91]
 v_cndmask_b32 v201, 0, v201, s[52:53]
 v_cndmask_b32 v205, 0, v205, s[52:53]
 v_mfma_f32_16x16x32_bf16 v[92:95], v[44:47], a[92:95], v[92:95]
 v_cvt_pk_bf16_f32 v208, v192, v192
 v_cvt_pk_bf16_f32 v210, v196, v196
 s_waitcnt vmcnt(17)
 s_barrier
 s_waitcnt lgkmcnt(2)
 v_mfma_f32_16x16x32_bf16 v[96:99], v[48:51], a[80:83], v[96:99]
 ds_read_b128 v[40:43], v2 offset:12288
 v_cvt_pk_bf16_f32 v212, v200, v200
 v_mfma_f32_16x16x32_bf16 v[100:103], v[48:51], a[84:87], v[100:103]
 ds_read_b128 v[44:47], v2 offset:13312
 v_cvt_pk_bf16_f32 v214, v204, v204
 v_mfma_f32_16x16x32_bf16 v[104:107], v[48:51], a[88:91], v[104:107]
 buffer_load_dwordx4 a[184:187], v1, s[16:19], s50 offen offset:3072 sc1
 s_add_u32 s50, s50, 4096
 v_mfma_f32_16x16x32_bf16 v[108:111], v[48:51], a[92:95], v[108:111]
 v_lshlrev_b32 v208, 16, v208
 v_lshlrev_b32 v210, 16, v210
 v_mfma_f32_16x16x32_bf16 v[112:115], v[52:55], a[80:83], v[112:115]
 v_lshlrev_b32 v212, 16, v212
 v_lshlrev_b32 v214, 16, v214
 v_mfma_f32_16x16x32_bf16 v[116:119], v[52:55], a[84:87], v[116:119]
 v_sub_f32 v208, v192, v208
 v_sub_f32 v210, v196, v210
 v_mfma_f32_16x16x32_bf16 v[120:123], v[52:55], a[88:91], v[120:123]
 v_sub_f32 v212, v200, v212
 v_sub_f32 v214, v204, v214
 v_mfma_f32_16x16x32_bf16 v[124:127], v[52:55], a[92:95], v[124:127]
 v_cvt_pk_bf16_f32 v216, v192, v208
 v_cvt_pk_bf16_f32 v220, v196, v210
 s_waitcnt lgkmcnt(2)
 v_mfma_f32_16x16x32_bf16 v[160:163], v[56:59], a[32:35], v[160:163]
 ds_read_b128 v[48:51], v3 offset:12288
 v_cvt_pk_bf16_f32 v224, v200, v212
 v_mfma_f32_16x16x32_bf16 v[164:167], v[56:59], a[36:39], v[164:167]
 ds_read_b128 v[52:55], v3 offset:13312
 v_cvt_pk_bf16_f32 v228, v204, v214
 v_mfma_f32_16x16x32_bf16 v[168:171], v[56:59], a[40:43], v[168:171]
 buffer_load_dwordx4 a[188:191], v1, s[16:19], s51 offen offset:3072 sc1
 s_add_u32 s51, s51, 4096
 v_mfma_f32_16x16x32_bf16 v[172:175], v[56:59], a[44:47], v[172:175]
 v_cvt_pk_bf16_f32 v217, v192, v193
 v_cvt_pk_bf16_f32 v221, v196, v197
 v_mfma_f32_16x16x32_bf16 v[176:179], v[60:63], a[32:35], v[176:179]
 v_cvt_pk_bf16_f32 v225, v200, v201
 v_cvt_pk_bf16_f32 v229, v204, v205
 v_mfma_f32_16x16x32_bf16 v[180:183], v[60:63], a[36:39], v[180:183]
 v_cvt_pk_bf16_f32 v208, v193, v193
 v_cvt_pk_bf16_f32 v210, v197, v197
 v_mfma_f32_16x16x32_bf16 v[184:187], v[60:63], a[40:43], v[184:187]
 v_cvt_pk_bf16_f32 v212, v201, v201
 v_cvt_pk_bf16_f32 v214, v205, v205
 v_mfma_f32_16x16x32_bf16 v[188:191], v[60:63], a[44:47], v[188:191]
 v_lshlrev_b32 v208, 16, v208
 v_lshlrev_b32 v210, 16, v210
 s_waitcnt lgkmcnt(2)
 v_mfma_f32_16x16x32_bf16 v[64:67], v[40:43], a[96:99], v[64:67]
 ds_read_b128 v[56:59], v4 offset:6144
 v_lshlrev_b32 v212, 16, v212
 v_mfma_f32_16x16x32_bf16 v[68:71], v[40:43], a[100:103], v[68:71]
 ds_read_b128 v[60:63], v4 offset:7168
 v_lshlrev_b32 v214, 16, v214
 v_mfma_f32_16x16x32_bf16 v[72:75], v[40:43], a[104:107], v[72:75]
 s_mov_b32 m0, s40
 s_nop 0
 buffer_load_dwordx4 v1, s[12:15], s39 offen lds
 v_mfma_f32_16x16x32_bf16 v[76:79], v[40:43], a[108:111], v[76:79]
 v_sub_f32 v208, v193, v208
 v_sub_f32 v210, v197, v210
 v_mfma_f32_16x16x32_bf16 v[80:83], v[44:47], a[96:99], v[80:83]
 buffer_load_dwordx4 v1, s[12:15], s39 offen offset:1024 lds
 s_add_u32 s39, s39, 4096
 s_add_u32 s40, s40, 4096
 v_mfma_f32_16x16x32_bf16 v[84:87], v[44:47], a[100:103], v[84:87]
 v_sub_f32 v212, v201, v212
 v_sub_f32 v214, v205, v214
 v_mfma_f32_16x16x32_bf16 v[88:91], v[44:47], a[104:107], v[88:91]
 s_mov_b32 m0, s42
 s_nop 0
 buffer_load_dwordx4 v1, s[12:15], s41 offen lds
 s_add_u32 s41, s41, 2048
 s_add_u32 s42, s42, 2048
 v_mfma_f32_16x16x32_bf16 v[92:95], v[44:47], a[108:111], v[92:95]
 v_cvt_pk_bf16_f32 v218, v208, v193
 v_cvt_pk_bf16_f32 v222, v210, v197
 s_waitcnt lgkmcnt(2)
 v_mfma_f32_16x16x32_bf16 v[96:99], v[48:51], a[96:99], v[96:99]
 ds_read_b128 v[40:43], v2 offset:14336
 v_cvt_pk_bf16_f32 v226, v212, v201
 v_mfma_f32_16x16x32_bf16 v[100:103], v[48:51], a[100:103], v[100:103]
 ds_read_b128 v[44:47], v2 offset:15360
 v_cvt_pk_bf16_f32 v230, v214, v205
 v_mfma_f32_16x16x32_bf16 v[104:107], v[48:51], a[104:107], v[104:107]
 buffer_load_dwordx4 a[192:195], v1, s[16:19], s48 offen offset:0 sc1
 v_mfma_f32_16x16x32_bf16 v[108:111], v[48:51], a[108:111], v[108:111]
 v_mov_b32 v219, 0
 v_mov_b32 v223, 0
 v_mfma_f32_16x16x32_bf16 v[112:115], v[52:55], a[96:99], v[112:115]
 buffer_load_dwordx4 a[196:199], v1, s[16:19], s49 offen offset:0 sc1
 v_mfma_f32_16x16x32_bf16 v[116:119], v[52:55], a[100:103], v[116:119]
 v_mov_b32 v227, 0
 v_mov_b32 v231, 0
 v_mfma_f32_16x16x32_bf16 v[120:123], v[52:55], a[104:107], v[120:123]
 v_mfma_f32_16x16x32_bf16 v[124:127], v[52:55], a[108:111], v[124:127]
 s_waitcnt lgkmcnt(2)
 v_mfma_f32_16x16x32_bf16 v[128:131], v[56:59], a[48:51], v[128:131]
 ds_read_b128 v[48:51], v3 offset:14336
 v_mfma_f32_16x16x32_bf16 v[132:135], v[56:59], a[52:55], v[132:135]
 ds_read_b128 v[52:55], v3 offset:15360
 v_mfma_f32_16x16x32_bf16 v[136:139], v[56:59], a[56:59], v[136:139]
 buffer_load_dwordx4 a[200:203], v1, s[16:19], s50 offen offset:0 sc1
 v_mfma_f32_16x16x32_bf16 v[140:143], v[56:59], a[60:63], v[140:143]
 v_mfma_f32_16x16x32_bf16 v[144:147], v[60:63], a[48:51], v[144:147]
 buffer_load_dwordx4 a[204:207], v1, s[16:19], s51 offen offset:0 sc1
 v_mfma_f32_16x16x32_bf16 v[148:151], v[60:63], a[52:55], v[148:151]
 v_mfma_f32_16x16x32_bf16 v[152:155], v[60:63], a[56:59], v[152:155]
 v_mfma_f32_16x16x32_bf16 v[156:159], v[60:63], a[60:63], v[156:159]
 s_waitcnt lgkmcnt(2)
 v_mfma_f32_16x16x32_bf16 v[64:67], v[40:43], a[112:115], v[64:67]
 ds_read_b128 v[56:59], v5 offset:6144
 v_mfma_f32_16x16x32_bf16 v[68:71], v[40:43], a[116:119], v[68:71]
 ds_read_b128 v[60:63], v5 offset:7168
 v_mfma_f32_16x16x32_bf16 v[72:75], v[40:43], a[120:123], v[72:75]
 buffer_load_dwordx4 a[208:211], v1, s[16:19], s48 offen offset:1024 sc1
 v_mfma_f32_16x16x32_bf16 v[76:79], v[40:43], a[124:127], v[76:79]
 v_mfma_f32_16x16x32_bf16 v[80:83], v[44:47], a[112:115], v[80:83]
 buffer_load_dwordx4 a[212:215], v1, s[16:19], s49 offen offset:1024 sc1
 v_mfma_f32_16x16x32_bf16 v[84:87], v[44:47], a[116:119], v[84:87]
 v_mfma_f32_16x16x32_bf16 v[88:91], v[44:47], a[120:123], v[88:91]
 v_mfma_f32_16x16x32_bf16 v[92:95], v[44:47], a[124:127], v[92:95]
 s_waitcnt vmcnt(17)
 s_barrier
 s_waitcnt lgkmcnt(2)
 v_mfma_f32_16x16x32_bf16 v[96:99], v[48:51], a[112:115], v[96:99]
 ds_read_b128 v[40:43], v2 offset:16384
 v_mfma_f32_16x16x32_bf16 v[100:103], v[48:51], a[116:119], v[100:103]
 ds_read_b128 v[44:47], v2 offset:17408
 v_mfma_f32_16x16x32_bf16 v[104:107], v[48:51], a[120:123], v[104:107]
 buffer_load_dwordx4 a[216:219], v1, s[16:19], s50 offen offset:1024 sc1
 v_mfma_f32_16x16x32_bf16 v[108:111], v[48:51], a[124:127], v[108:111]
 v_mfma_f32_16x16x32_bf16 v[112:115], v[52:55], a[112:115], v[112:115]
 v_mfma_f32_16x16x32_bf16 v[116:119], v[52:55], a[116:119], v[116:119]
 v_mfma_f32_16x16x32_bf16 v[120:123], v[52:55], a[120:123], v[120:123]
 v_mfma_f32_16x16x32_bf16 v[124:127], v[52:55], a[124:127], v[124:127]
 s_waitcnt lgkmcnt(2)
 v_mfma_f32_16x16x32_bf16 v[160:163], v[56:59], a[48:51], v[160:163]
 ds_read_b128 v[48:51], v3 offset:16384
 v_mfma_f32_16x16x32_bf16 v[164:167], v[56:59], a[52:55], v[164:167]
 ds_read_b128 v[52:55], v3 offset:17408
 v_mfma_f32_16x16x32_bf16 v[168:171], v[56:59], a[56:59], v[168:171]
 buffer_load_dwordx4 a[220:223], v1, s[16:19], s51 offen offset:1024 sc1
 v_mfma_f32_16x16x32_bf16 v[172:175], v[56:59], a[60:63], v[172:175]
 v_mfma_f32_16x16x32_bf16 v[176:179], v[60:63], a[48:51], v[176:179]
 v_mfma_f32_16x16x32_bf16 v[180:183], v[60:63], a[52:55], v[180:183]
 v_mfma_f32_16x16x32_bf16 v[184:187], v[60:63], a[56:59], v[184:187]
 v_mfma_f32_16x16x32_bf16 v[188:191], v[60:63], a[60:63], v[188:191]
 s_waitcnt lgkmcnt(2)
 v_mfma_f32_16x16x32_bf16 v[64:67], v[40:43], a[128:131], v[64:67]
 ds_read_b128 v[56:59], v4 offset:8192
 v_mfma_f32_16x16x32_bf16 v[68:71], v[40:43], a[132:135], v[68:71]
 ds_read_b128 v[60:63], v4 offset:9216
 v_mfma_f32_16x16x32_bf16 v[72:75], v[40:43], a[136:139], v[72:75]
 s_mov_b32 m0, s40
 s_nop 0
 buffer_load_dwordx4 v1, s[12:15], s39 offen lds
 v_mfma_f32_16x16x32_bf16 v[76:79], v[40:43], a[140:143], v[76:79]
 v_mfma_f32_16x16x32_bf16 v[80:83], v[44:47], a[128:131], v[80:83]
 buffer_load_dwordx4 v1, s[12:15], s39 offen offset:1024 lds
 s_add_u32 s39, s39, 4096
 s_add_u32 s40, s40, 4096
 v_mfma_f32_16x16x32_bf16 v[84:87], v[44:47], a[132:135], v[84:87]
 v_mfma_f32_16x16x32_bf16 v[88:91], v[44:47], a[136:139], v[88:91]
 s_mov_b32 m0, s42
 s_nop 0
 buffer_load_dwordx4 v1, s[12:15], s41 offen lds
 s_add_u32 s41, s41, 2048
 s_add_u32 s42, s42, 2048
 v_mfma_f32_16x16x32_bf16 v[92:95], v[44:47], a[140:143], v[92:95]
 s_waitcnt lgkmcnt(2)
 v_mfma_f32_16x16x32_bf16 v[96:99], v[48:51], a[128:131], v[96:99]
 ds_read_b128 v[40:43], v2 offset:18432
 v_mfma_f32_16x16x32_bf16 v[100:103], v[48:51], a[132:135], v[100:103]
 ds_read_b128 v[44:47], v2 offset:19456
 v_mfma_f32_16x16x32_bf16 v[104:107], v[48:51], a[136:139], v[104:107]
 buffer_load_dwordx4 a[224:227], v1, s[16:19], s48 offen offset:2048 sc1
 v_mfma_f32_16x16x32_bf16 v[108:111], v[48:51], a[140:143], v[108:111]
 v_mfma_f32_16x16x32_bf16 v[112:115], v[52:55], a[128:131], v[112:115]
 buffer_load_dwordx4 a[228:231], v1, s[16:19], s49 offen offset:2048 sc1
 v_mfma_f32_16x16x32_bf16 v[116:119], v[52:55], a[132:135], v[116:119]
 v_mfma_f32_16x16x32_bf16 v[120:123], v[52:55], a[136:139], v[120:123]
 v_mfma_f32_16x16x32_bf16 v[124:127], v[52:55], a[140:143], v[124:127]
 s_waitcnt lgkmcnt(2)
 v_mfma_f32_16x16x32_bf16 v[128:131], v[56:59], a[64:67], v[128:131]
 ds_read_b128 v[48:51], v3 offset:18432
 v_mfma_f32_16x16x32_bf16 v[132:135], v[56:59], a[68:71], v[132:135]
 ds_read_b128 v[52:55], v3 offset:19456
 v_mfma_f32_16x16x32_bf16 v[136:139], v[56:59], a[72:75], v[136:139]
 buffer_load_dwordx4 a[232:235], v1, s[16:19], s50 offen offset:2048 sc1
 v_mfma_f32_16x16x32_bf16 v[140:143], v[56:59], a[76:79], v[140:143]
 v_mfma_f32_16x16x32_bf16 v[144:147], v[60:63], a[64:67], v[144:147]
 buffer_load_dwordx4 a[236:239], v1, s[16:19], s51 offen offset:2048 sc1
 v_mfma_f32_16x16x32_bf16 v[148:151], v[60:63], a[68:71], v[148:151]
 v_mfma_f32_16x16x32_bf16 v[152:155], v[60:63], a[72:75], v[152:155]
 v_mfma_f32_16x16x32_bf16 v[156:159], v[60:63], a[76:79], v[156:159]
 s_waitcnt lgkmcnt(2)
 v_mfma_f32_16x16x32_bf16 v[64:67], v[40:43], a[144:147], v[64:67]
 ds_read_b128 v[56:59], v5 offset:8192
 v_mfma_f32_16x16x32_bf16 v[68:71], v[40:43], a[148:151], v[68:71]
 ds_read_b128 v[60:63], v5 offset:9216
 v_mfma_f32_16x16x32_bf16 v[72:75], v[40:43], a[152:155], v[72:75]
 buffer_load_dwordx4 a[240:243], v1, s[16:19], s48 offen offset:3072 sc1
 s_add_u32 s48, s48, 4096
 v_mfma_f32_16x16x32_bf16 v[76:79], v[40:43], a[156:159], v[76:79]
 v_mfma_f32_16x16x32_bf16 v[80:83], v[44:47], a[144:147], v[80:83]
 buffer_load_dwordx4 a[244:247], v1, s[16:19], s49 offen offset:3072 sc1
 s_add_u32 s49, s49, 4096
 v_mfma_f32_16x16x32_bf16 v[84:87], v[44:47], a[148:151], v[84:87]
 v_mfma_f32_16x16x32_bf16 v[88:91], v[44:47], a[152:155], v[88:91]
 v_mfma_f32_16x16x32_bf16 v[92:95], v[44:47], a[156:159], v[92:95]
 s_waitcnt vmcnt(17)
 s_barrier
 s_waitcnt lgkmcnt(2)
 v_mfma_f32_16x16x32_bf16 v[96:99], v[48:51], a[144:147], v[96:99]
 ds_read_b128 v[40:43], v2 offset:20480
 v_mfma_f32_16x16x32_bf16 v[100:103], v[48:51], a[148:151], v[100:103]
 ds_read_b128 v[44:47], v2 offset:21504
 v_mfma_f32_16x16x32_bf16 v[104:107], v[48:51], a[152:155], v[104:107]
 buffer_load_dwordx4 a[248:251], v1, s[16:19], s50 offen offset:3072 sc1
 s_add_u32 s50, s50, 4096
 v_mfma_f32_16x16x32_bf16 v[108:111], v[48:51], a[156:159], v[108:111]
 v_mfma_f32_16x16x32_bf16 v[112:115], v[52:55], a[144:147], v[112:115]
 v_mfma_f32_16x16x32_bf16 v[116:119], v[52:55], a[148:151], v[116:119]
 v_mfma_f32_16x16x32_bf16 v[120:123], v[52:55], a[152:155], v[120:123]
 v_mfma_f32_16x16x32_bf16 v[124:127], v[52:55], a[156:159], v[124:127]
 s_waitcnt lgkmcnt(2)
 v_mfma_f32_16x16x32_bf16 v[160:163], v[56:59], a[64:67], v[160:163]
 ds_read_b128 v[48:51], v3 offset:20480
 v_mfma_f32_16x16x32_bf16 v[164:167], v[56:59], a[68:71], v[164:167]
 ds_read_b128 v[52:55], v3 offset:21504
 v_mfma_f32_16x16x32_bf16 v[168:171], v[56:59], a[72:75], v[168:171]
 buffer_load_dwordx4 a[252:255], v1, s[16:19], s51 offen offset:3072 sc1
 s_add_u32 s51, s51, 4096
 v_mfma_f32_16x16x32_bf16 v[172:175], v[56:59], a[76:79], v[172:175]
 v_mfma_f32_16x16x32_bf16 v[176:179], v[60:63], a[64:67], v[176:179]
 v_mfma_f32_16x16x32_bf16 v[180:183], v[60:63], a[68:71], v[180:183]
 v_mfma_f32_16x16x32_bf16 v[184:187], v[60:63], a[72:75], v[184:187]
 v_mfma_f32_16x16x32_bf16 v[188:191], v[60:63], a[76:79], v[188:191]
 s_waitcnt lgkmcnt(2)
 v_mfma_f32_16x16x32_bf16 v[64:67], v[40:43], a[160:163], v[64:67]
 ds_read_b128 v[56:59], v4 offset:10240
 v_mfma_f32_16x16x32_bf16 v[68:71], v[40:43], a[164:167], v[68:71]
 ds_read_b128 v[60:63], v4 offset:11264
 v_mfma_f32_16x16x32_bf16 v[72:75], v[40:43], a[168:171], v[72:75]
 s_mov_b32 m0, s40
 s_nop 0
 buffer_load_dwordx4 v1, s[12:15], s39 offen lds
 v_mfma_f32_16x16x32_bf16 v[76:79], v[40:43], a[172:175], v[76:79]
 v_mfma_f32_16x16x32_bf16 v[80:83], v[44:47], a[160:163], v[80:83]
 buffer_load_dwordx4 v1, s[12:15], s39 offen offset:1024 lds
 s_add_u32 s39, s39, 4096
 s_add_u32 s40, s40, 4096
 v_mfma_f32_16x16x32_bf16 v[84:87], v[44:47], a[164:167], v[84:87]
 v_mfma_f32_16x16x32_bf16 v[88:91], v[44:47], a[168:171], v[88:91]
 s_mov_b32 m0, s42
 s_nop 0
 buffer_load_dwordx4 v1, s[12:15], s41 offen lds
 s_add_u32 s41, s41, 2048
 s_add_u32 s42, s42, 2048
 v_mfma_f32_16x16x32_bf16 v[92:95], v[44:47], a[172:175], v[92:95]
 s_waitcnt lgkmcnt(2)
 v_mfma_f32_16x16x32_bf16 v[96:99], v[48:51], a[160:163], v[96:99]
 ds_read_b128 v[40:43], v2 offset:22528
 v_mfma_f32_16x16x32_bf16 v[100:103], v[48:51], a[164:167], v[100:103]
 ds_read_b128 v[44:47], v2 offset:23552
 v_mfma_f32_16x16x32_bf16 v[104:107], v[48:51], a[168:171], v[104:107]
 buffer_load_dwordx4 v[8:11], v1, s[16:19], s48 offen offset:0 sc1
 v_mfma_f32_16x16x32_bf16 v[108:111], v[48:51], a[172:175], v[108:111]
 v_mfma_f32_16x16x32_bf16 v[112:115], v[52:55], a[160:163], v[112:115]
 buffer_load_dwordx4 v[12:15], v1, s[16:19], s49 offen offset:0 sc1
 v_mfma_f32_16x16x32_bf16 v[116:119], v[52:55], a[164:167], v[116:119]
 v_mfma_f32_16x16x32_bf16 v[120:123], v[52:55], a[168:171], v[120:123]
 v_mfma_f32_16x16x32_bf16 v[124:127], v[52:55], a[172:175], v[124:127]
 s_waitcnt lgkmcnt(2)
 v_mfma_f32_16x16x32_bf16 v[128:131], v[56:59], a[80:83], v[128:131]
 ds_read_b128 v[48:51], v3 offset:22528
 v_mfma_f32_16x16x32_bf16 v[132:135], v[56:59], a[84:87], v[132:135]
 ds_read_b128 v[52:55], v3 offset:23552
 v_mfma_f32_16x16x32_bf16 v[136:139], v[56:59], a[88:91], v[136:139]
 buffer_load_dwordx4 v[16:19], v1, s[16:19], s50 offen offset:0 sc1
 v_mfma_f32_16x16x32_bf16 v[140:143], v[56:59], a[92:95], v[140:143]
 v_mfma_f32_16x16x32_bf16 v[144:147], v[60:63], a[80:83], v[144:147]
 buffer_load_dwordx4 v[20:23], v1, s[16:19], s51 offen offset:0 sc1
 v_mfma_f32_16x16x32_bf16 v[148:151], v[60:63], a[84:87], v[148:151]
 v_mfma_f32_16x16x32_bf16 v[152:155], v[60:63], a[88:91], v[152:155]
 v_mfma_f32_16x16x32_bf16 v[156:159], v[60:63], a[92:95], v[156:159]
 s_waitcnt lgkmcnt(2)
 v_mfma_f32_16x16x32_bf16 v[64:67], v[40:43], a[176:179], v[64:67]
 ds_read_b128 v[56:59], v5 offset:10240
 v_mfma_f32_16x16x32_bf16 v[68:71], v[40:43], a[180:183], v[68:71]
 ds_read_b128 v[60:63], v5 offset:11264
 v_mfma_f32_16x16x32_bf16 v[72:75], v[40:43], a[184:187], v[72:75]
 buffer_load_dwordx4 v[24:27], v1, s[16:19], s48 offen offset:1024 sc1
 v_mfma_f32_16x16x32_bf16 v[76:79], v[40:43], a[188:191], v[76:79]
 v_mfma_f32_16x16x32_bf16 v[80:83], v[44:47], a[176:179], v[80:83]
 buffer_load_dwordx4 v[28:31], v1, s[16:19], s49 offen offset:1024 sc1
 v_mfma_f32_16x16x32_bf16 v[84:87], v[44:47], a[180:183], v[84:87]
 v_mfma_f32_16x16x32_bf16 v[88:91], v[44:47], a[184:187], v[88:91]
 v_mfma_f32_16x16x32_bf16 v[92:95], v[44:47], a[188:191], v[92:95]
 s_waitcnt vmcnt(17)
 s_barrier
 s_waitcnt lgkmcnt(2)
 v_mfma_f32_16x16x32_bf16 v[96:99], v[48:51], a[176:179], v[96:99]
 ds_read_b128 v[40:43], v2 offset:24576
 v_mfma_f32_16x16x32_bf16 v[100:103], v[48:51], a[180:183], v[100:103]
 ds_read_b128 v[44:47], v2 offset:25600
 v_mfma_f32_16x16x32_bf16 v[104:107], v[48:51], a[184:187], v[104:107]
 buffer_load_dwordx4 v[32:35], v1, s[16:19], s50 offen offset:1024 sc1
 v_mfma_f32_16x16x32_bf16 v[108:111], v[48:51], a[188:191], v[108:111]
 v_mfma_f32_16x16x32_bf16 v[112:115], v[52:55], a[176:179], v[112:115]
 v_mfma_f32_16x16x32_bf16 v[116:119], v[52:55], a[180:183], v[116:119]
 v_mfma_f32_16x16x32_bf16 v[120:123], v[52:55], a[184:187], v[120:123]
 v_mfma_f32_16x16x32_bf16 v[124:127], v[52:55], a[188:191], v[124:127]
 s_waitcnt lgkmcnt(2)
 v_mfma_f32_16x16x32_bf16 v[160:163], v[56:59], a[80:83], v[160:163]
 ds_read_b128 v[48:51], v3 offset:24576
 v_mfma_f32_16x16x32_bf16 v[164:167], v[56:59], a[84:87], v[164:167]
 ds_read_b128 v[52:55], v3 offset:25600
 v_mfma_f32_16x16x32_bf16 v[168:171], v[56:59], a[88:91], v[168:171]
 buffer_load_dwordx4 v[36:39], v1, s[16:19], s51 offen offset:1024 sc1
 v_mfma_f32_16x16x32_bf16 v[172:175], v[56:59], a[92:95], v[172:175]
 v_mfma_f32_16x16x32_bf16 v[176:179], v[60:63], a[80:83], v[176:179]
 v_mfma_f32_16x16x32_bf16 v[180:183], v[60:63], a[84:87], v[180:183]
 v_mfma_f32_16x16x32_bf16 v[184:187], v[60:63], a[88:91], v[184:187]
 v_mfma_f32_16x16x32_bf16 v[188:191], v[60:63], a[92:95], v[188:191]
 s_waitcnt lgkmcnt(2)
 v_mfma_f32_16x16x32_bf16 v[64:67], v[40:43], a[192:195], v[64:67]
 ds_read_b128 v[56:59], v4 offset:12288
 v_mfma_f32_16x16x32_bf16 v[68:71], v[40:43], a[196:199], v[68:71]
 ds_read_b128 v[60:63], v4 offset:13312
 v_mfma_f32_16x16x32_bf16 v[72:75], v[40:43], a[200:203], v[72:75]
 s_mov_b32 m0, s40
 s_nop 0
 buffer_load_dwordx4 v1, s[12:15], s39 offen lds
 v_mfma_f32_16x16x32_bf16 v[76:79], v[40:43], a[204:207], v[76:79]
 v_mfma_f32_16x16x32_bf16 v[80:83], v[44:47], a[192:195], v[80:83]
 buffer_load_dwordx4 v1, s[12:15], s39 offen offset:1024 lds
 s_add_u32 s39, s39, 4096
 s_add_u32 s40, s40, 4096
 v_mfma_f32_16x16x32_bf16 v[84:87], v[44:47], a[196:199], v[84:87]
 v_mfma_f32_16x16x32_bf16 v[88:91], v[44:47], a[200:203], v[88:91]
 s_mov_b32 m0, s42
 s_nop 0
 buffer_load_dwordx4 v1, s[12:15], s41 offen lds
 s_add_u32 s41, s41, 2048
 s_add_u32 s42, s42, 2048
 v_mfma_f32_16x16x32_bf16 v[92:95], v[44:47], a[204:207], v[92:95]
 s_waitcnt lgkmcnt(2)
 v_mfma_f32_16x16x32_bf16 v[96:99], v[48:51], a[192:195], v[96:99]
 ds_read_b128 v[40:43], v2 offset:26624
 v_mfma_f32_16x16x32_bf16 v[100:103], v[48:51], a[196:199], v[100:103]
 ds_read_b128 v[44:47], v2 offset:27648
 v_mfma_f32_16x16x32_bf16 v[104:107], v[48:51], a[200:203], v[104:107]
 s_lshr_b32 s35, s32, 1
 s_add_u32 s35, s35, 2
 s_mul_i32 s35, s35, 38912
 s_and_b32 s36, s32, 1
 s_mul_i32 s36, s36, 10240
 s_add_u32 s36, s36, s35
 s_add_u32 s36, s36, 18432
 s_add_u32 s38, s36, s43
 s_mov_b32 m0, s36
 s_nop 0
 buffer_load_dwordx4 v1, s[12:15], s38 offen offset:0 lds
 v_mfma_f32_16x16x32_bf16 v[108:111], v[48:51], a[204:207], v[108:111]
 v_mfma_f32_16x16x32_bf16 v[112:115], v[52:55], a[192:195], v[112:115]
 buffer_load_dwordx4 v1, s[12:15], s38 offen offset:1024 lds
 v_mfma_f32_16x16x32_bf16 v[116:119], v[52:55], a[196:199], v[116:119]
 v_mfma_f32_16x16x32_bf16 v[120:123], v[52:55], a[200:203], v[120:123]
 v_mfma_f32_16x16x32_bf16 v[124:127], v[52:55], a[204:207], v[124:127]
 s_waitcnt lgkmcnt(2)
 v_mfma_f32_16x16x32_bf16 v[128:131], v[56:59], a[96:99], v[128:131]
 ds_read_b128 v[48:51], v3 offset:26624
 v_mfma_f32_16x16x32_bf16 v[132:135], v[56:59], a[100:103], v[132:135]
 ds_read_b128 v[52:55], v3 offset:27648
 v_mfma_f32_16x16x32_bf16 v[136:139], v[56:59], a[104:107], v[136:139]
 buffer_load_dwordx4 v1, s[12:15], s38 offen offset:2048 lds
 v_mfma_f32_16x16x32_bf16 v[140:143], v[56:59], a[108:111], v[140:143]
 v_mfma_f32_16x16x32_bf16 v[144:147], v[60:63], a[96:99], v[144:147]
 buffer_load_dwordx4 v1, s[12:15], s38 offen offset:3072 lds
 v_mfma_f32_16x16x32_bf16 v[148:151], v[60:63], a[100:103], v[148:151]
 v_mfma_f32_16x16x32_bf16 v[152:155], v[60:63], a[104:107], v[152:155]
 v_mfma_f32_16x16x32_bf16 v[156:159], v[60:63], a[108:111], v[156:159]
 s_waitcnt lgkmcnt(2)
 v_mfma_f32_16x16x32_bf16 v[64:67], v[40:43], a[208:211], v[64:67]
 ds_read_b128 v[56:59], v5 offset:12288
 v_mfma_f32_16x16x32_bf16 v[68:71], v[40:43], a[212:215], v[68:71]
 ds_read_b128 v[60:63], v5 offset:13312
 v_mfma_f32_16x16x32_bf16 v[72:75], v[40:43], a[216:219], v[72:75]
 s_add_u32 s38, s38, 4096
 s_add_u32 s36, s36, 4096
 s_mov_b32 m0, s36
 s_nop 0
 buffer_load_dwordx4 v1, s[12:15], s38 offen offset:0 lds
 v_mfma_f32_16x16x32_bf16 v[76:79], v[40:43], a[220:223], v[76:79]
 v_mfma_f32_16x16x32_bf16 v[80:83], v[44:47], a[208:211], v[80:83]
 buffer_load_dwordx4 v1, s[12:15], s38 offen offset:1024 lds
 v_mfma_f32_16x16x32_bf16 v[84:87], v[44:47], a[212:215], v[84:87]
 v_mfma_f32_16x16x32_bf16 v[88:91], v[44:47], a[216:219], v[88:91]
 v_mfma_f32_16x16x32_bf16 v[92:95], v[44:47], a[220:223], v[92:95]
 s_waitcnt vmcnt(17)
 s_barrier
 s_waitcnt lgkmcnt(2)
 v_mfma_f32_16x16x32_bf16 v[96:99], v[48:51], a[208:211], v[96:99]
 ds_read_b128 v[40:43], v2 offset:28672
 v_mfma_f32_16x16x32_bf16 v[100:103], v[48:51], a[212:215], v[100:103]
 ds_read_b128 v[44:47], v2 offset:29696
 v_mfma_f32_16x16x32_bf16 v[104:107], v[48:51], a[216:219], v[104:107]
 buffer_load_dwordx4 v1, s[12:15], s38 offen offset:2048 lds
 v_mfma_f32_16x16x32_bf16 v[108:111], v[48:51], a[220:223], v[108:111]
 v_mfma_f32_16x16x32_bf16 v[112:115], v[52:55], a[208:211], v[112:115]
 v_mfma_f32_16x16x32_bf16 v[116:119], v[52:55], a[212:215], v[116:119]
 v_mfma_f32_16x16x32_bf16 v[120:123], v[52:55], a[216:219], v[120:123]
 v_mfma_f32_16x16x32_bf16 v[124:127], v[52:55], a[220:223], v[124:127]
 s_waitcnt lgkmcnt(2)
 v_mfma_f32_16x16x32_bf16 v[160:163], v[56:59], a[96:99], v[160:163]
 ds_read_b128 v[48:51], v3 offset:28672
 v_mfma_f32_16x16x32_bf16 v[164:167], v[56:59], a[100:103], v[164:167]
 ds_read_b128 v[52:55], v3 offset:29696
 v_mfma_f32_16x16x32_bf16 v[168:171], v[56:59], a[104:107], v[168:171]
 buffer_load_dwordx4 v1, s[12:15], s38 offen offset:3072 lds
 v_mfma_f32_16x16x32_bf16 v[172:175], v[56:59], a[108:111], v[172:175]
 v_mfma_f32_16x16x32_bf16 v[176:179], v[60:63], a[96:99], v[176:179]
 v_mfma_f32_16x16x32_bf16 v[180:183], v[60:63], a[100:103], v[180:183]
 v_mfma_f32_16x16x32_bf16 v[184:187], v[60:63], a[104:107], v[184:187]
 v_mfma_f32_16x16x32_bf16 v[188:191], v[60:63], a[108:111], v[188:191]
 s_waitcnt lgkmcnt(2)
 v_mfma_f32_16x16x32_bf16 v[64:67], v[40:43], a[224:227], v[64:67]
 ds_read_b128 v[56:59], v4 offset:14336
 v_mfma_f32_16x16x32_bf16 v[68:71], v[40:43], a[228:231], v[68:71]
 ds_read_b128 v[60:63], v4 offset:15360
 v_mfma_f32_16x16x32_bf16 v[72:75], v[40:43], a[232:235], v[72:75]
 s_add_u32 s38, s38, 4096
 s_add_u32 s36, s36, 4096
 s_mov_b32 m0, s36
 s_nop 0
 buffer_load_dwordx4 v1, s[12:15], s38 offen offset:0 lds
 v_mfma_f32_16x16x32_bf16 v[76:79], v[40:43], a[236:239], v[76:79]
 v_mfma_f32_16x16x32_bf16 v[80:83], v[44:47], a[224:227], v[80:83]
 v_mfma_f32_16x16x32_bf16 v[84:87], v[44:47], a[228:231], v[84:87]
 v_mfma_f32_16x16x32_bf16 v[88:91], v[44:47], a[232:235], v[88:91]
 v_mfma_f32_16x16x32_bf16 v[92:95], v[44:47], a[236:239], v[92:95]
 s_waitcnt lgkmcnt(2)
 v_mfma_f32_16x16x32_bf16 v[96:99], v[48:51], a[224:227], v[96:99]
 ds_read_b128 v[40:43], v2 offset:30720
 v_mfma_f32_16x16x32_bf16 v[100:103], v[48:51], a[228:231], v[100:103]
 ds_read_b128 v[44:47], v2 offset:31744
 v_mfma_f32_16x16x32_bf16 v[104:107], v[48:51], a[232:235], v[104:107]
 buffer_load_dwordx4 v1, s[12:15], s38 offen offset:1024 lds
 v_mfma_f32_16x16x32_bf16 v[108:111], v[48:51], a[236:239], v[108:111]
 v_mfma_f32_16x16x32_bf16 v[112:115], v[52:55], a[224:227], v[112:115]
 v_mfma_f32_16x16x32_bf16 v[116:119], v[52:55], a[228:231], v[116:119]
 v_mfma_f32_16x16x32_bf16 v[120:123], v[52:55], a[232:235], v[120:123]
 v_mfma_f32_16x16x32_bf16 v[124:127], v[52:55], a[236:239], v[124:127]
 s_waitcnt lgkmcnt(2)
 v_mfma_f32_16x16x32_bf16 v[128:131], v[56:59], a[112:115], v[128:131]
 ds_read_b128 v[48:51], v3 offset:30720
 v_mfma_f32_16x16x32_bf16 v[132:135], v[56:59], a[116:119], v[132:135]
 ds_read_b128 v[52:55], v3 offset:31744
 v_mfma_f32_16x16x32_bf16 v[136:139], v[56:59], a[120:123], v[136:139]
 s_lshr_b32 s35, s32, 1
 s_mul_i32 s35, s35, 38912
 s_and_b32 s36, s32, 1
 s_lshl_b32 s36, s36, 10
 s_add_u32 s36, s36, s35
 s_add_u32 s36, s36, 36864
 s_add_u32 s38, s36, s43
 s_mov_b32 m0, s36
 s_nop 0
 buffer_load_dwordx4 v1, s[12:15], s38 offen lds
 v_mfma_f32_16x16x32_bf16 v[140:143], v[56:59], a[124:127], v[140:143]
 v_mfma_f32_16x16x32_bf16 v[144:147], v[60:63], a[112:115], v[144:147]
 v_mfma_f32_16x16x32_bf16 v[148:151], v[60:63], a[116:119], v[148:151]
 v_mfma_f32_16x16x32_bf16 v[152:155], v[60:63], a[120:123], v[152:155]
 v_mfma_f32_16x16x32_bf16 v[156:159], v[60:63], a[124:127], v[156:159]
 s_waitcnt lgkmcnt(2)
 v_mfma_f32_16x16x32_bf16 v[64:67], v[40:43], a[240:243], v[64:67]
 ds_read_b128 v[56:59], v5 offset:14336
 v_mfma_f32_16x16x32_bf16 v[68:71], v[40:43], a[244:247], v[68:71]
 ds_read_b128 v[60:63], v5 offset:15360
 v_mfma_f32_16x16x32_bf16 v[72:75], v[40:43], a[248:251], v[72:75]
 v_mfma_f32_16x16x32_bf16 v[76:79], v[40:43], a[252:255], v[76:79]
 v_mfma_f32_16x16x32_bf16 v[80:83], v[44:47], a[240:243], v[80:83]
 v_mfma_f32_16x16x32_bf16 v[84:87], v[44:47], a[244:247], v[84:87]
 v_mfma_f32_16x16x32_bf16 v[88:91], v[44:47], a[248:251], v[88:91]
 v_mfma_f32_16x16x32_bf16 v[92:95], v[44:47], a[252:255], v[92:95]
 s_waitcnt vmcnt(11)
 s_barrier
 s_waitcnt lgkmcnt(2)
 v_mfma_f32_16x16x32_bf16 v[96:99], v[48:51], a[240:243], v[96:99]
 ds_read_b128 v[40:43], v2 offset:32768
 v_mfma_f32_16x16x32_bf16 v[100:103], v[48:51], a[244:247], v[100:103]
 ds_read_b128 v[44:47], v2 offset:33792
 v_mfma_f32_16x16x32_bf16 v[104:107], v[48:51], a[248:251], v[104:107]
 v_mfma_f32_16x16x32_bf16 v[108:111], v[48:51], a[252:255], v[108:111]
 v_mfma_f32_16x16x32_bf16 v[112:115], v[52:55], a[240:243], v[112:115]
 v_mfma_f32_16x16x32_bf16 v[116:119], v[52:55], a[244:247], v[116:119]
 v_mfma_f32_16x16x32_bf16 v[120:123], v[52:55], a[248:251], v[120:123]
 v_mfma_f32_16x16x32_bf16 v[124:127], v[52:55], a[252:255], v[124:127]
 s_waitcnt lgkmcnt(2)
 v_mfma_f32_16x16x32_bf16 v[160:163], v[56:59], a[112:115], v[160:163]
 ds_read_b128 v[48:51], v3 offset:32768
 v_mfma_f32_16x16x32_bf16 v[164:167], v[56:59], a[116:119], v[164:167]
 ds_read_b128 v[52:55], v3 offset:33792
 v_mfma_f32_16x16x32_bf16 v[168:171], v[56:59], a[120:123], v[168:171]
 v_mfma_f32_16x16x32_bf16 v[172:175], v[56:59], a[124:127], v[172:175]
 v_mfma_f32_16x16x32_bf16 v[176:179], v[60:63], a[112:115], v[176:179]
 v_mfma_f32_16x16x32_bf16 v[180:183], v[60:63], a[116:119], v[180:183]
 v_mfma_f32_16x16x32_bf16 v[184:187], v[60:63], a[120:123], v[184:187]
 v_mfma_f32_16x16x32_bf16 v[188:191], v[60:63], a[124:127], v[188:191]
 s_waitcnt lgkmcnt(2)
 v_mfma_f32_16x16x32_bf16 v[64:67], v[40:43], v[8:11], v[64:67]
 ds_read_b128 v[56:59], v4 offset:16384
 v_mfma_f32_16x16x32_bf16 v[68:71], v[40:43], v[12:15], v[68:71]
 ds_read_b128 v[60:63], v4 offset:17408
 v_mfma_f32_16x16x32_bf16 v[72:75], v[40:43], v[16:19], v[72:75]
 v_mfma_f32_16x16x32_bf16 v[76:79], v[40:43], v[20:23], v[76:79]
 v_mfma_f32_16x16x32_bf16 v[80:83], v[44:47], v[8:11], v[80:83]
 v_mfma_f32_16x16x32_bf16 v[84:87], v[44:47], v[12:15], v[84:87]
 v_mfma_f32_16x16x32_bf16 v[88:91], v[44:47], v[16:19], v[88:91]
 v_mfma_f32_16x16x32_bf16 v[92:95], v[44:47], v[20:23], v[92:95]
 s_waitcnt lgkmcnt(2)
 v_mfma_f32_16x16x32_bf16 v[96:99], v[48:51], v[8:11], v[96:99]
 ds_read_b128 v[40:43], v2 offset:34816
 v_mfma_f32_16x16x32_bf16 v[100:103], v[48:51], v[12:15], v[100:103]
 ds_read_b128 v[44:47], v2 offset:35840
 v_mfma_f32_16x16x32_bf16 v[104:107], v[48:51], v[16:19], v[104:107]
 v_mfma_f32_16x16x32_bf16 v[108:111], v[48:51], v[20:23], v[108:111]
 v_mfma_f32_16x16x32_bf16 v[112:115], v[52:55], v[8:11], v[112:115]
 v_mfma_f32_16x16x32_bf16 v[116:119], v[52:55], v[12:15], v[116:119]
 v_mfma_f32_16x16x32_bf16 v[120:123], v[52:55], v[16:19], v[120:123]
 v_mfma_f32_16x16x32_bf16 v[124:127], v[52:55], v[20:23], v[124:127]
 s_waitcnt lgkmcnt(2)
 v_mfma_f32_16x16x32_bf16 v[128:131], v[56:59], a[128:131], v[128:131]
 ds_read_b128 v[48:51], v3 offset:34816
 v_mfma_f32_16x16x32_bf16 v[132:135], v[56:59], a[132:135], v[132:135]
 ds_read_b128 v[52:55], v3 offset:35840
 v_mfma_f32_16x16x32_bf16 v[136:139], v[56:59], a[136:139], v[136:139]
 v_mfma_f32_16x16x32_bf16 v[140:143], v[56:59], a[140:143], v[140:143]
 v_mfma_f32_16x16x32_bf16 v[144:147], v[60:63], a[128:131], v[144:147]
 v_mfma_f32_16x16x32_bf16 v[148:151], v[60:63], a[132:135], v[148:151]
 v_mfma_f32_16x16x32_bf16 v[152:155], v[60:63], a[136:139], v[152:155]
 v_mfma_f32_16x16x32_bf16 v[156:159], v[60:63], a[140:143], v[156:159]
 s_waitcnt lgkmcnt(2)
 v_mfma_f32_16x16x32_bf16 v[64:67], v[40:43], v[24:27], v[64:67]
 ds_read_b128 v[56:59], v5 offset:16384
 v_mfma_f32_16x16x32_bf16 v[68:71], v[40:43], v[28:31], v[68:71]
 ds_read_b128 v[60:63], v5 offset:17408
 v_mfma_f32_16x16x32_bf16 v[72:75], v[40:43], v[32:35], v[72:75]
 v_mfma_f32_16x16x32_bf16 v[76:79], v[40:43], v[36:39], v[76:79]
 v_mfma_f32_16x16x32_bf16 v[80:83], v[44:47], v[24:27], v[80:83]
 v_mfma_f32_16x16x32_bf16 v[84:87], v[44:47], v[28:31], v[84:87]
 v_mfma_f32_16x16x32_bf16 v[88:91], v[44:47], v[32:35], v[88:91]
 v_mfma_f32_16x16x32_bf16 v[92:95], v[44:47], v[36:39], v[92:95]
 s_waitcnt vmcnt(0)
 s_barrier
 s_waitcnt lgkmcnt(2)
 v_mfma_f32_16x16x32_bf16 v[96:99], v[48:51], v[24:27], v[96:99]
 ds_read_b128 v[40:43], v2 offset:36864
 v_mfma_f32_16x16x32_bf16 v[100:103], v[48:51], v[28:31], v[100:103]
 ds_read_b128 v[44:47], v2 offset:37888
 v_mfma_f32_16x16x32_bf16 v[104:107], v[48:51], v[32:35], v[104:107]
 v_mfma_f32_16x16x32_bf16 v[108:111], v[48:51], v[36:39], v[108:111]
 v_mfma_f32_16x16x32_bf16 v[112:115], v[52:55], v[24:27], v[112:115]
 v_mfma_f32_16x16x32_bf16 v[116:119], v[52:55], v[28:31], v[116:119]
 v_mfma_f32_16x16x32_bf16 v[120:123], v[52:55], v[32:35], v[120:123]
 v_mfma_f32_16x16x32_bf16 v[124:127], v[52:55], v[36:39], v[124:127]
 s_waitcnt lgkmcnt(2)
 v_mfma_f32_16x16x32_bf16 v[160:163], v[56:59], a[128:131], v[160:163]
 ds_read_b128 v[48:51], v3 offset:36864
 v_mfma_f32_16x16x32_bf16 v[164:167], v[56:59], a[132:135], v[164:167]
 ds_read_b128 v[52:55], v3 offset:37888
 v_mfma_f32_16x16x32_bf16 v[168:171], v[56:59], a[136:139], v[168:171]
 v_mfma_f32_16x16x32_bf16 v[172:175], v[56:59], a[140:143], v[172:175]
 v_mfma_f32_16x16x32_bf16 v[176:179], v[60:63], a[128:131], v[176:179]
 v_mfma_f32_16x16x32_bf16 v[180:183], v[60:63], a[132:135], v[180:183]
 v_mfma_f32_16x16x32_bf16 v[184:187], v[60:63], a[136:139], v[184:187]
 v_mfma_f32_16x16x32_bf16 v[188:191], v[60:63], a[140:143], v[188:191]
 s_waitcnt lgkmcnt(0)
 s_waitcnt vmcnt(0)
 s_barrier
 v_mfma_f32_16x16x32_bf16 v[64:67], v[40:43], v[216:219], v[64:67]
 ds_read_b128 v[56:59], v4 offset:18432
 v_mfma_f32_16x16x32_bf16 v[68:71], v[40:43], v[220:223], v[68:71]
 ds_read_b128 v[60:63], v4 offset:19456
 v_mfma_f32_16x16x32_bf16 v[72:75], v[40:43], v[224:227], v[72:75]
 s_add_u32 s38, s43, 155648
 s_add_u32 s38, s38, s44
 s_add_u32 s36, s44, 0
 s_mov_b32 m0, s36
 s_nop 0
 buffer_load_dwordx4 v1, s[12:15], s38 offen offset:0 lds
 v_mfma_f32_16x16x32_bf16 v[76:79], v[40:43], v[228:231], v[76:79]
 v_mfma_f32_16x16x32_bf16 v[80:83], v[44:47], v[216:219], v[80:83]
 buffer_load_dwordx4 v1, s[12:15], s38 offen offset:1024 lds
 v_mfma_f32_16x16x32_bf16 v[84:87], v[44:47], v[220:223], v[84:87]
 v_mfma_f32_16x16x32_bf16 v[88:91], v[44:47], v[224:227], v[88:91]
 buffer_load_dwordx4 v1, s[12:15], s38 offen offset:2048 lds
 v_mfma_f32_16x16x32_bf16 v[92:95], v[44:47], v[228:231], v[92:95]
 s_waitcnt lgkmcnt(2)
 v_mfma_f32_16x16x32_bf16 v[96:99], v[48:51], v[216:219], v[96:99]
 ds_read_b128 v[40:43], v5 offset:18432
 v_mfma_f32_16x16x32_bf16 v[100:103], v[48:51], v[220:223], v[100:103]
 ds_read_b128 v[44:47], v5 offset:19456
 v_mfma_f32_16x16x32_bf16 v[104:107], v[48:51], v[224:227], v[104:107]
 buffer_load_dwordx4 v1, s[12:15], s38 offen offset:3072 lds
 v_mfma_f32_16x16x32_bf16 v[108:111], v[48:51], v[228:231], v[108:111]
 v_mfma_f32_16x16x32_bf16 v[112:115], v[52:55], v[216:219], v[112:115]
 s_add_u32 s38, s38, 4096
 s_add_u32 s36, s36, 4096
 s_mov_b32 m0, s36
 s_nop 0
 buffer_load_dwordx4 v1, s[12:15], s38 offen offset:0 lds
 v_mfma_f32_16x16x32_bf16 v[116:119], v[52:55], v[220:223], v[116:119]
 v_mfma_f32_16x16x32_bf16 v[120:123], v[52:55], v[224:227], v[120:123]
 buffer_load_dwordx4 v1, s[12:15], s38 offen offset:1024 lds
 v_mfma_f32_16x16x32_bf16 v[124:127], v[52:55], v[228:231], v[124:127]
 s_waitcnt lgkmcnt(2)
 v_mfma_f32_16x16x32_bf16 v[128:131], v[56:59], a[144:147], v[128:131]
 ds_read_b128 v[48:51], v4 offset:20480
 v_mul_f32 v208, v232, v64
 v_mfma_f32_16x16x32_bf16 v[132:135], v[56:59], a[148:151], v[132:135]
 ds_read_b128 v[52:55], v4 offset:21504
 v_mul_f32 v209, v232, v65
 v_mfma_f32_16x16x32_bf16 v[136:139], v[56:59], a[152:155], v[136:139]
 buffer_load_dwordx4 v1, s[12:15], s38 offen offset:2048 lds
 v_mfma_f32_16x16x32_bf16 v[140:143], v[56:59], a[156:159], v[140:143]
 v_mul_f32 v210, v232, v66
 v_mul_f32 v211, v232, v67
 v_mfma_f32_16x16x32_bf16 v[144:147], v[60:63], a[144:147], v[144:147]
 buffer_load_dwordx4 v1, s[12:15], s38 offen offset:3072 lds
 v_mfma_f32_16x16x32_bf16 v[148:151], v[60:63], a[148:151], v[148:151]
 v_mul_f32 v212, v233, v68
 v_mul_f32 v213, v233, v69
 v_mfma_f32_16x16x32_bf16 v[152:155], v[60:63], a[152:155], v[152:155]
 v_mul_f32 v214, v233, v70
 v_mfma_f32_16x16x32_bf16 v[156:159], v[60:63], a[156:159], v[156:159]
 s_waitcnt lgkmcnt(2)
 v_mfma_f32_16x16x32_bf16 v[160:163], v[40:43], a[144:147], v[160:163]
 ds_read_b128 v[56:59], v5 offset:20480
 v_mul_f32 v215, v233, v71
 v_mfma_f32_16x16x32_bf16 v[164:167], v[40:43], a[148:151], v[164:167]
 ds_read_b128 v[60:63], v5 offset:21504
 v_mfma_f32_16x16x32_bf16 v[168:171], v[40:43], a[152:155], v[168:171]
 s_add_u32 s38, s38, 4096
 s_add_u32 s36, s36, 4096
 s_mov_b32 m0, s36
 s_nop 0
 buffer_load_dwordx4 v1, s[12:15], s38 offen offset:0 lds
 v_mfma_f32_16x16x32_bf16 v[172:175], v[40:43], a[156:159], v[172:175]
 v_exp_f32 v208, v208
 v_mfma_f32_16x16x32_bf16 v[176:179], v[44:47], a[144:147], v[176:179]
 buffer_load_dwordx4 v1, s[12:15], s38 offen offset:1024 lds
 v_mfma_f32_16x16x32_bf16 v[180:183], v[44:47], a[148:151], v[180:183]
 v_exp_f32 v209, v209
 v_mfma_f32_16x16x32_bf16 v[184:187], v[44:47], a[152:155], v[184:187]
 v_exp_f32 v210, v210
 v_mfma_f32_16x16x32_bf16 v[188:191], v[44:47], a[156:159], v[188:191]
 s_waitcnt lgkmcnt(2)
 v_mfma_f32_16x16x32_bf16 v[128:131], v[48:51], a[160:163], v[128:131]
 ds_read_b128 v[40:43], v4 offset:22528
 v_mfma_f32_16x16x32_bf16 v[132:135], v[48:51], a[164:167], v[132:135]
 ds_read_b128 v[44:47], v4 offset:23552
 v_mfma_f32_16x16x32_bf16 v[136:139], v[48:51], a[168:171], v[136:139]
 s_add_u32 s38, s43, 194560
 s_add_u32 s38, s38, s44
 s_add_u32 s36, s44, 38912
 s_mov_b32 m0, s36
 s_nop 0
 buffer_load_dwordx4 v1, s[12:15], s38 offen offset:0 lds
 v_mfma_f32_16x16x32_bf16 v[140:143], v[48:51], a[172:175], v[140:143]
 v_exp_f32 v211, v211
 v_mfma_f32_16x16x32_bf16 v[144:147], v[52:55], a[160:163], v[144:147]
 buffer_load_dwordx4 v1, s[12:15], s38 offen offset:1024 lds
 v_mfma_f32_16x16x32_bf16 v[148:151], v[52:55], a[164:167], v[148:151]
 v_exp_f32 v212, v212
 v_mfma_f32_16x16x32_bf16 v[152:155], v[52:55], a[168:171], v[152:155]
 v_exp_f32 v213, v213
 v_mfma_f32_16x16x32_bf16 v[156:159], v[52:55], a[172:175], v[156:159]
 v_exp_f32 v214, v214
 s_waitcnt lgkmcnt(2)
 v_mfma_f32_16x16x32_bf16 v[160:163], v[56:59], a[160:163], v[160:163]
 ds_read_b128 v[48:51], v5 offset:22528
 v_mfma_f32_16x16x32_bf16 v[164:167], v[56:59], a[164:167], v[164:167]
 ds_read_b128 v[52:55], v5 offset:23552
 v_mfma_f32_16x16x32_bf16 v[168:171], v[56:59], a[168:171], v[168:171]
 buffer_load_dwordx4 v1, s[12:15], s38 offen offset:2048 lds
 v_mfma_f32_16x16x32_bf16 v[172:175], v[56:59], a[172:175], v[172:175]
 v_exp_f32 v215, v215
 v_mfma_f32_16x16x32_bf16 v[176:179], v[60:63], a[160:163], v[176:179]
 v_mul_f32 v80, v64, v80
 v_mul_f32 v81, v65, v81
 v_mfma_f32_16x16x32_bf16 v[180:183], v[60:63], a[164:167], v[180:183]
 v_mul_f32 v82, v66, v82
 v_mul_f32 v83, v67, v83
 v_mfma_f32_16x16x32_bf16 v[184:187], v[60:63], a[168:171], v[184:187]
 v_mul_f32 v84, v68, v84
 v_mul_f32 v85, v69, v85
 v_mfma_f32_16x16x32_bf16 v[188:191], v[60:63], a[172:175], v[188:191]
 v_mul_f32 v86, v70, v86
 s_waitcnt lgkmcnt(2)
 v_mfma_f32_16x16x32_bf16 v[128:131], v[40:43], a[176:179], v[128:131]
 ds_read_b128 v[56:59], v4 offset:24576
 v_mul_f32 v87, v71, v87
 v_mfma_f32_16x16x32_bf16 v[132:135], v[40:43], a[180:183], v[132:135]
 ds_read_b128 v[60:63], v4 offset:25600
 v_fma_f32 v208, v208, v236, v236
 v_mfma_f32_16x16x32_bf16 v[136:139], v[40:43], a[184:187], v[136:139]
 buffer_load_dwordx4 v1, s[12:15], s38 offen offset:3072 lds
 v_mfma_f32_16x16x32_bf16 v[140:143], v[40:43], a[188:191], v[140:143]
 v_fma_f32 v209, v209, v236, v236
 v_fma_f32 v210, v210, v236, v236
 v_mfma_f32_16x16x32_bf16 v[144:147], v[44:47], a[176:179], v[144:147]
 v_fma_f32 v211, v211, v236, v236
 v_fma_f32 v212, v212, v237, v237
 v_mfma_f32_16x16x32_bf16 v[148:151], v[44:47], a[180:183], v[148:151]
 v_fma_f32 v213, v213, v237, v237
 v_fma_f32 v214, v214, v237, v237
 v_mfma_f32_16x16x32_bf16 v[152:155], v[44:47], a[184:187], v[152:155]
 v_fma_f32 v215, v215, v237, v237
 v_mfma_f32_16x16x32_bf16 v[156:159], v[44:47], a[188:191], v[156:159]
 s_waitcnt lgkmcnt(2)
 v_mfma_f32_16x16x32_bf16 v[160:163], v[48:51], a[176:179], v[160:163]
 ds_read_b128 v[40:43], v5 offset:24576
 v_mfma_f32_16x16x32_bf16 v[164:167], v[48:51], a[180:183], v[164:167]
 ds_read_b128 v[44:47], v5 offset:25600
 v_mfma_f32_16x16x32_bf16 v[168:171], v[48:51], a[184:187], v[168:171]
 s_add_u32 s38, s38, 4096
 s_add_u32 s36, s36, 4096
 s_mov_b32 m0, s36
 s_nop 0
 buffer_load_dwordx4 v1, s[12:15], s38 offen offset:0 lds
 v_mfma_f32_16x16x32_bf16 v[172:175], v[48:51], a[188:191], v[172:175]
 v_rcp_f32 v208, v208
 v_mfma_f32_16x16x32_bf16 v[176:179], v[52:55], a[176:179], v[176:179]
 v_rcp_f32 v209, v209
 v_mfma_f32_16x16x32_bf16 v[180:183], v[52:55], a[180:183], v[180:183]
 v_rcp_f32 v210, v210
 v_mfma_f32_16x16x32_bf16 v[184:187], v[52:55], a[184:187], v[184:187]
 v_rcp_f32 v211, v211
 v_mfma_f32_16x16x32_bf16 v[188:191], v[52:55], a[188:191], v[188:191]
 v_rcp_f32 v212, v212
 s_waitcnt lgkmcnt(2)
 v_mfma_f32_16x16x32_bf16 v[128:131], v[56:59], a[192:195], v[128:131]
 ds_read_b128 v[48:51], v4 offset:26624
 v_mfma_f32_16x16x32_bf16 v[132:135], v[56:59], a[196:199], v[132:135]
 ds_read_b128 v[52:55], v4 offset:27648
 v_mfma_f32_16x16x32_bf16 v[136:139], v[56:59], a[200:203], v[136:139]
 buffer_load_dwordx4 v1, s[12:15], s38 offen offset:1024 lds
 v_mfma_f32_16x16x32_bf16 v[140:143], v[56:59], a[204:207], v[140:143]
 v_rcp_f32 v213, v213
 v_mfma_f32_16x16x32_bf16 v[144:147], v[60:63], a[192:195], v[144:147]
 v_rcp_f32 v214, v214
 v_mfma_f32_16x16x32_bf16 v[148:151], v[60:63], a[196:199], v[148:151]
 v_rcp_f32 v215, v215
 v_mfma_f32_16x16x32_bf16 v[152:155], v[60:63], a[200:203], v[152:155]
 v_mul_f32 v80, v80, v208
 v_mul_f32 v81, v81, v209
 v_mfma_f32_16x16x32_bf16 v[156:159], v[60:63], a[204:207], v[156:159]
 v_mul_f32 v82, v82, v210
 s_waitcnt lgkmcnt(2)
 v_mfma_f32_16x16x32_bf16 v[160:163], v[40:43], a[192:195], v[160:163]
 ds_read_b128 v[56:59], v5 offset:26624
 v_mul_f32 v83, v83, v211
 v_mfma_f32_16x16x32_bf16 v[164:167], v[40:43], a[196:199], v[164:167]
 ds_read_b128 v[60:63], v5 offset:27648
 v_mul_f32 v84, v84, v212
 v_mfma_f32_16x16x32_bf16 v[168:171], v[40:43], a[200:203], v[168:171]
 buffer_load_dwordx4 v1, s[12:15], s38 offen offset:2048 lds
 v_mfma_f32_16x16x32_bf16 v[172:175], v[40:43], a[204:207], v[172:175]
 v_mul_f32 v85, v85, v213
 v_mul_f32 v86, v86, v214
 v_mfma_f32_16x16x32_bf16 v[176:179], v[44:47], a[192:195], v[176:179]
 v_mul_f32 v87, v87, v215
 v_cvt_pk_bf16_f32 v192, v80, v81
 v_mfma_f32_16x16x32_bf16 v[180:183], v[44:47], a[196:199], v[180:183]
 v_cvt_pk_bf16_f32 v193, v82, v83
 v_cvt_pk_bf16_f32 v196, v84, v85
 v_mfma_f32_16x16x32_bf16 v[184:187], v[44:47], a[200:203], v[184:187]
 v_cvt_pk_bf16_f32 v197, v86, v87
 v_mfma_f32_16x16x32_bf16 v[188:191], v[44:47], a[204:207], v[188:191]
 s_waitcnt lgkmcnt(2)
 v_mfma_f32_16x16x32_bf16 v[128:131], v[48:51], a[208:211], v[128:131]
 ds_read_b128 v[40:43], v4 offset:28672
 v_mul_f32 v208, v234, v72
 v_mfma_f32_16x16x32_bf16 v[132:135], v[48:51], a[212:215], v[132:135]
 ds_read_b128 v[44:47], v4 offset:29696
 v_mul_f32 v209, v234, v73
 v_mfma_f32_16x16x32_bf16 v[136:139], v[48:51], a[216:219], v[136:139]
 buffer_load_dwordx4 v1, s[12:15], s38 offen offset:3072 lds
 v_mfma_f32_16x16x32_bf16 v[140:143], v[48:51], a[220:223], v[140:143]
 v_mul_f32 v210, v234, v74
 v_mul_f32 v211, v234, v75
 v_mfma_f32_16x16x32_bf16 v[144:147], v[52:55], a[208:211], v[144:147]
 v_mul_f32 v212, v235, v76
 v_mul_f32 v213, v235, v77
 v_mfma_f32_16x16x32_bf16 v[148:151], v[52:55], a[212:215], v[148:151]
 v_mul_f32 v214, v235, v78
 v_mul_f32 v215, v235, v79
 v_mfma_f32_16x16x32_bf16 v[152:155], v[52:55], a[216:219], v[152:155]
 v_exp_f32 v208, v208
 v_mfma_f32_16x16x32_bf16 v[156:159], v[52:55], a[220:223], v[156:159]
 s_waitcnt lgkmcnt(2)
 v_mfma_f32_16x16x32_bf16 v[160:163], v[56:59], a[208:211], v[160:163]
 ds_read_b128 v[48:51], v5 offset:28672
 v_mfma_f32_16x16x32_bf16 v[164:167], v[56:59], a[212:215], v[164:167]
 ds_read_b128 v[52:55], v5 offset:29696
 v_mfma_f32_16x16x32_bf16 v[168:171], v[56:59], a[216:219], v[168:171]
 s_add_u32 s38, s38, 4096
 s_add_u32 s36, s36, 4096
 s_mov_b32 m0, s36
 s_nop 0
 buffer_load_dwordx4 v1, s[12:15], s38 offen offset:0 lds
 v_mfma_f32_16x16x32_bf16 v[172:175], v[56:59], a[220:223], v[172:175]
 v_exp_f32 v209, v209
 v_mfma_f32_16x16x32_bf16 v[176:179], v[60:63], a[208:211], v[176:179]
 v_exp_f32 v210, v210
 v_mfma_f32_16x16x32_bf16 v[180:183], v[60:63], a[212:215], v[180:183]
 v_exp_f32 v211, v211
 v_mfma_f32_16x16x32_bf16 v[184:187], v[60:63], a[216:219], v[184:187]
 v_exp_f32 v212, v212
 v_mfma_f32_16x16x32_bf16 v[188:191], v[60:63], a[220:223], v[188:191]
 v_exp_f32 v213, v213
 s_waitcnt lgkmcnt(2)
 v_mfma_f32_16x16x32_bf16 v[128:131], v[40:43], a[224:227], v[128:131]
 ds_read_b128 v[56:59], v4 offset:30720
 v_mfma_f32_16x16x32_bf16 v[132:135], v[40:43], a[228:231], v[132:135]
 ds_read_b128 v[60:63], v4 offset:31744
 v_mfma_f32_16x16x32_bf16 v[136:139], v[40:43], a[232:235], v[136:139]
 buffer_load_dwordx4 v1, s[12:15], s38 offen offset:1024 lds
 v_mfma_f32_16x16x32_bf16 v[140:143], v[40:43], a[236:239], v[140:143]
 v_exp_f32 v214, v214
 v_mfma_f32_16x16x32_bf16 v[144:147], v[44:47], a[224:227], v[144:147]
 v_exp_f32 v215, v215
 v_mfma_f32_16x16x32_bf16 v[148:151], v[44:47], a[228:231], v[148:151]
 v_mul_f32 v88, v72, v88
 v_mul_f32 v89, v73, v89
 v_mfma_f32_16x16x32_bf16 v[152:155], v[44:47], a[232:235], v[152:155]
 v_mul_f32 v90, v74, v90
 v_mul_f32 v91, v75, v91
 v_mfma_f32_16x16x32_bf16 v[156:159], v[44:47], a[236:239], v[156:159]
 v_mul_f32 v92, v76, v92
 s_waitcnt lgkmcnt(2)
 v_mfma_f32_16x16x32_bf16 v[160:163], v[48:51], a[224:227], v[160:163]
 ds_read_b128 v[40:43], v5 offset:30720
 v_mul_f32 v93, v77, v93
 v_mfma_f32_16x16x32_bf16 v[164:167], v[48:51], a[228:231], v[164:167]
 ds_read_b128 v[44:47], v5 offset:31744
 v_mul_f32 v94, v78, v94
 v_mfma_f32_16x16x32_bf16 v[168:171], v[48:51], a[232:235], v[168:171]
 v_mul_f32 v95, v79, v95
 v_fma_f32 v208, v208, v238, v238
 v_mfma_f32_16x16x32_bf16 v[172:175], v[48:51], a[236:239], v[172:175]
 v_fma_f32 v209, v209, v238, v238
 v_fma_f32 v210, v210, v238, v238
 v_mfma_f32_16x16x32_bf16 v[176:179], v[52:55], a[224:227], v[176:179]
 v_fma_f32 v211, v211, v238, v238
 v_fma_f32 v212, v212, v239, v239
 v_mfma_f32_16x16x32_bf16 v[180:183], v[52:55], a[228:231], v[180:183]
 v_fma_f32 v213, v213, v239, v239
 v_fma_f32 v214, v214, v239, v239
 v_mfma_f32_16x16x32_bf16 v[184:187], v[52:55], a[232:235], v[184:187]
 v_fma_f32 v215, v215, v239, v239
 v_mfma_f32_16x16x32_bf16 v[188:191], v[52:55], a[236:239], v[188:191]
 s_waitcnt lgkmcnt(2)
 v_mfma_f32_16x16x32_bf16 v[128:131], v[56:59], a[240:243], v[128:131]
 ds_read_b128 v[48:51], v4 offset:32768
 v_mfma_f32_16x16x32_bf16 v[132:135], v[56:59], a[244:247], v[132:135]
 ds_read_b128 v[52:55], v4 offset:33792
 v_mfma_f32_16x16x32_bf16 v[136:139], v[56:59], a[248:251], v[136:139]
 v_rcp_f32 v208, v208
 v_mfma_f32_16x16x32_bf16 v[140:143], v[56:59], a[252:255], v[140:143]
 v_rcp_f32 v209, v209
 v_mfma_f32_16x16x32_bf16 v[144:147], v[60:63], a[240:243], v[144:147]
 v_rcp_f32 v210, v210
 v_mfma_f32_16x16x32_bf16 v[148:151], v[60:63], a[244:247], v[148:151]
 v_rcp_f32 v211, v211
 v_mfma_f32_16x16x32_bf16 v[152:155], v[60:63], a[248:251], v[152:155]
 v_rcp_f32 v212, v212
 v_mfma_f32_16x16x32_bf16 v[156:159], v[60:63], a[252:255], v[156:159]
 v_rcp_f32 v213, v213
 s_waitcnt lgkmcnt(2)
 v_mfma_f32_16x16x32_bf16 v[160:163], v[40:43], a[240:243], v[160:163]
 ds_read_b128 v[56:59], v5 offset:32768
 v_mfma_f32_16x16x32_bf16 v[164:167], v[40:43], a[244:247], v[164:167]
 ds_read_b128 v[60:63], v5 offset:33792
 v_mfma_f32_16x16x32_bf16 v[168:171], v[40:43], a[248:251], v[168:171]
 v_rcp_f32 v214, v214
 v_mfma_f32_16x16x32_bf16 v[172:175], v[40:43], a[252:255], v[172:175]
 v_rcp_f32 v215, v215
 v_mfma_f32_16x16x32_bf16 v[176:179], v[44:47], a[240:243], v[176:179]
 v_mul_f32 v88, v88, v208
 v_mul_f32 v89, v89, v209
 v_mfma_f32_16x16x32_bf16 v[180:183], v[44:47], a[244:247], v[180:183]
 v_mul_f32 v90, v90, v210
 v_mul_f32 v91, v91, v211
 v_mfma_f32_16x16x32_bf16 v[184:187], v[44:47], a[248:251], v[184:187]
 v_mul_f32 v92, v92, v212
 v_mul_f32 v93, v93, v213
 v_mfma_f32_16x16x32_bf16 v[188:191], v[44:47], a[252:255], v[188:191]
 v_mul_f32 v94, v94, v214
 s_waitcnt lgkmcnt(2)
 v_mfma_f32_16x16x32_bf16 v[128:131], v[48:51], v[8:11], v[128:131]
 ds_read_b128 v[40:43], v4 offset:34816
 v_mul_f32 v95, v95, v215
 v_mfma_f32_16x16x32_bf16 v[132:135], v[48:51], v[12:15], v[132:135]
 ds_read_b128 v[44:47], v4 offset:35840
 v_cvt_pk_bf16_f32 v200, v88, v89
 v_mfma_f32_16x16x32_bf16 v[136:139], v[48:51], v[16:19], v[136:139]
 v_cvt_pk_bf16_f32 v201, v90, v91
 v_cvt_pk_bf16_f32 v204, v92, v93
 v_mfma_f32_16x16x32_bf16 v[140:143], v[48:51], v[20:23], v[140:143]
 v_cvt_pk_bf16_f32 v205, v94, v95
 v_mul_f32 v208, v232, v96
 v_mfma_f32_16x16x32_bf16 v[144:147], v[52:55], v[8:11], v[144:147]
 v_mul_f32 v209, v232, v97
 v_mul_f32 v210, v232, v98
 v_mfma_f32_16x16x32_bf16 v[148:151], v[52:55], v[12:15], v[148:151]
 v_mul_f32 v211, v232, v99
 v_mul_f32 v212, v233, v100
 v_mfma_f32_16x16x32_bf16 v[152:155], v[52:55], v[16:19], v[152:155]
 v_mul_f32 v213, v233, v101
 v_mfma_f32_16x16x32_bf16 v[156:159], v[52:55], v[20:23], v[156:159]
 s_waitcnt lgkmcnt(2)
 v_mfma_f32_16x16x32_bf16 v[160:163], v[56:59], v[8:11], v[160:163]
 ds_read_b128 v[48:51], v5 offset:34816
 v_mul_f32 v214, v233, v102
 v_mfma_f32_16x16x32_bf16 v[164:167], v[56:59], v[12:15], v[164:167]
 ds_read_b128 v[52:55], v5 offset:35840
 v_mul_f32 v215, v233, v103
 v_mfma_f32_16x16x32_bf16 v[168:171], v[56:59], v[16:19], v[168:171]
 v_exp_f32 v208, v208
 v_mfma_f32_16x16x32_bf16 v[172:175], v[56:59], v[20:23], v[172:175]
 v_exp_f32 v209, v209
 v_mfma_f32_16x16x32_bf16 v[176:179], v[60:63], v[8:11], v[176:179]
 v_exp_f32 v210, v210
 v_mfma_f32_16x16x32_bf16 v[180:183], v[60:63], v[12:15], v[180:183]
 v_exp_f32 v211, v211
 v_mfma_f32_16x16x32_bf16 v[184:187], v[60:63], v[16:19], v[184:187]
 v_exp_f32 v212, v212
 v_mfma_f32_16x16x32_bf16 v[188:191], v[60:63], v[20:23], v[188:191]
 s_waitcnt lgkmcnt(2)
 v_mfma_f32_16x16x32_bf16 v[128:131], v[40:43], v[24:27], v[128:131]
 ds_read_b128 v[56:59], v4 offset:36864
 v_mfma_f32_16x16x32_bf16 v[132:135], v[40:43], v[28:31], v[132:135]
 ds_read_b128 v[60:63], v4 offset:37888
 v_mfma_f32_16x16x32_bf16 v[136:139], v[40:43], v[32:35], v[136:139]
 v_exp_f32 v213, v213
 v_mfma_f32_16x16x32_bf16 v[140:143], v[40:43], v[36:39], v[140:143]
 v_exp_f32 v214, v214
 v_mfma_f32_16x16x32_bf16 v[144:147], v[44:47], v[24:27], v[144:147]
 v_exp_f32 v215, v215
 v_mfma_f32_16x16x32_bf16 v[148:151], v[44:47], v[28:31], v[148:151]
 v_mul_f32 v112, v96, v112
 v_mul_f32 v113, v97, v113
 v_mfma_f32_16x16x32_bf16 v[152:155], v[44:47], v[32:35], v[152:155]
 v_mul_f32 v114, v98, v114
 v_mul_f32 v115, v99, v115
 v_mfma_f32_16x16x32_bf16 v[156:159], v[44:47], v[36:39], v[156:159]
 v_mul_f32 v116, v100, v116
 s_waitcnt lgkmcnt(2)
 v_mfma_f32_16x16x32_bf16 v[160:163], v[48:51], v[24:27], v[160:163]
 ds_read_b128 v[40:43], v5 offset:36864
 v_mul_f32 v117, v101, v117
 v_mfma_f32_16x16x32_bf16 v[164:167], v[48:51], v[28:31], v[164:167]
 ds_read_b128 v[44:47], v5 offset:37888
 v_mul_f32 v118, v102, v118
 v_mfma_f32_16x16x32_bf16 v[168:171], v[48:51], v[32:35], v[168:171]
 v_mul_f32 v119, v103, v119
 v_fma_f32 v208, v208, v236, v236
 v_mfma_f32_16x16x32_bf16 v[172:175], v[48:51], v[36:39], v[172:175]
 v_fma_f32 v209, v209, v236, v236
 v_fma_f32 v210, v210, v236, v236
 v_mfma_f32_16x16x32_bf16 v[176:179], v[52:55], v[24:27], v[176:179]
 v_fma_f32 v211, v211, v236, v236
 v_fma_f32 v212, v212, v237, v237
 v_mfma_f32_16x16x32_bf16 v[180:183], v[52:55], v[28:31], v[180:183]
 v_fma_f32 v213, v213, v237, v237
 v_fma_f32 v214, v214, v237, v237
 v_mfma_f32_16x16x32_bf16 v[184:187], v[52:55], v[32:35], v[184:187]
 v_fma_f32 v215, v215, v237, v237
 v_mfma_f32_16x16x32_bf16 v[188:191], v[52:55], v[36:39], v[188:191]
 s_waitcnt lgkmcnt(0)
 s_waitcnt vmcnt(10)
 s_barrier
 v_mfma_f32_16x16x32_bf16 v[128:131], v[56:59], v[216:219], v[128:131]
 ds_read_b128 v[48:51], v2 offset:0
 v_mfma_f32_16x16x32_bf16 v[132:135], v[56:59], v[220:223], v[132:135]
 ds_read_b128 v[52:55], v2 offset:1024
 v_mfma_f32_16x16x32_bf16 v[136:139], v[56:59], v[224:227], v[136:139]
 s_add_u32 s38, s43, 233472
 s_add_u32 s38, s38, s44
 s_add_u32 s36, s44, 77824
 s_mov_b32 m0, s36
 s_nop 0
 buffer_load_dwordx4 v1, s[12:15], s38 offen offset:0 lds
 v_mfma_f32_16x16x32_bf16 v[140:143], v[56:59], v[228:231], v[140:143]
 v_rcp_f32 v208, v208
 v_mfma_f32_16x16x32_bf16 v[144:147], v[60:63], v[216:219], v[144:147]
 buffer_load_dwordx4 v1, s[12:15], s38 offen offset:1024 lds
 v_mfma_f32_16x16x32_bf16 v[148:151], v[60:63], v[220:223], v[148:151]
 v_rcp_f32 v209, v209
 v_mfma_f32_16x16x32_bf16 v[152:155], v[60:63], v[224:227], v[152:155]
 buffer_load_dwordx4 v1, s[12:15], s38 offen offset:2048 lds
 v_mfma_f32_16x16x32_bf16 v[156:159], v[60:63], v[228:231], v[156:159]
 v_rcp_f32 v210, v210
 s_waitcnt lgkmcnt(2)
 v_mfma_f32_16x16x32_bf16 v[160:163], v[40:43], v[216:219], v[160:163]
 ds_read_b128 v[56:59], v2 offset:2048
 v_mfma_f32_16x16x32_bf16 v[164:167], v[40:43], v[220:223], v[164:167]
 ds_read_b128 v[60:63], v2 offset:3072
 v_mfma_f32_16x16x32_bf16 v[168:171], v[40:43], v[224:227], v[168:171]
 buffer_load_dwordx4 v1, s[12:15], s38 offen offset:3072 lds
 v_mfma_f32_16x16x32_bf16 v[172:175], v[40:43], v[228:231], v[172:175]
 v_rcp_f32 v211, v211
 v_mfma_f32_16x16x32_bf16 v[176:179], v[44:47], v[216:219], v[176:179]
 s_add_u32 s38, s38, 4096
 s_add_u32 s36, s36, 4096
 s_mov_b32 m0, s36
 s_nop 0
 buffer_load_dwordx4 v1, s[12:15], s38 offen offset:0 lds
 v_mfma_f32_16x16x32_bf16 v[180:183], v[44:47], v[220:223], v[180:183]
 v_rcp_f32 v212, v212
 v_mfma_f32_16x16x32_bf16 v[184:187], v[44:47], v[224:227], v[184:187]
 v_rcp_f32 v213, v213
 v_mfma_f32_16x16x32_bf16 v[188:191], v[44:47], v[228:231], v[188:191]
 v_rcp_f32 v214, v214
 s_waitcnt lgkmcnt(2)
 v_mfma_f32_16x16x32_bf16 v[64:67], v[48:51], a[0:3], 0
 ds_read_b128 v[40:43], v2 offset:4096
 v_mfma_f32_16x16x32_bf16 v[68:71], v[48:51], a[4:7], 0
 ds_read_b128 v[44:47], v2 offset:5120
 v_mfma_f32_16x16x32_bf16 v[72:75], v[48:51], a[8:11], 0
 buffer_load_dwordx4 v1, s[12:15], s38 offen offset:1024 lds
 v_mfma_f32_16x16x32_bf16 v[76:79], v[48:51], a[12:15], 0
 v_rcp_f32 v215, v215
 v_mfma_f32_16x16x32_bf16 v[80:83], v[52:55], a[0:3], 0
 buffer_load_dwordx4 v1, s[12:15], s38 offen offset:2048 lds
 v_mfma_f32_16x16x32_bf16 v[84:87], v[52:55], a[4:7], 0
 v_mul_f32 v112, v112, v208
 v_mul_f32 v113, v113, v209
 v_mfma_f32_16x16x32_bf16 v[88:91], v[52:55], a[8:11], 0
 v_mul_f32 v114, v114, v210
 v_mul_f32 v115, v115, v211
 v_mfma_f32_16x16x32_bf16 v[92:95], v[52:55], a[12:15], 0
 v_mul_f32 v116, v116, v212
 s_waitcnt lgkmcnt(2)
 v_mfma_f32_16x16x32_bf16 v[64:67], v[56:59], a[16:19], v[64:67]
 ds_read_b128 v[48:51], v2 offset:6144
 v_mul_f32 v117, v117, v213
 v_mfma_f32_16x16x32_bf16 v[68:71], v[56:59], a[20:23], v[68:71]
 ds_read_b128 v[52:55], v2 offset:7168
 v_mul_f32 v118, v118, v214
 v_mfma_f32_16x16x32_bf16 v[72:75], v[56:59], a[24:27], v[72:75]
 buffer_load_dwordx4 v1, s[12:15], s38 offen offset:3072 lds
 v_mfma_f32_16x16x32_bf16 v[76:79], v[56:59], a[28:31], v[76:79]
 v_mul_f32 v119, v119, v215
 v_cvt_pk_bf16_f32 v194, v112, v113
 v_mfma_f32_16x16x32_bf16 v[80:83], v[60:63], a[16:19], v[80:83]
 s_add_u32 s38, s38, 4096
 s_add_u32 s36, s36, 4096
 s_mov_b32 m0, s36
 s_nop 0
 buffer_load_dwordx4 v1, s[12:15], s38 offen offset:0 lds
 v_mfma_f32_16x16x32_bf16 v[84:87], v[60:63], a[20:23], v[84:87]
 v_cvt_pk_bf16_f32 v195, v114, v115
 v_cvt_pk_bf16_f32 v198, v116, v117
 v_mfma_f32_16x16x32_bf16 v[88:91], v[60:63], a[24:27], v[88:91]
 v_cvt_pk_bf16_f32 v199, v118, v119
 v_mfma_f32_16x16x32_bf16 v[92:95], v[60:63], a[28:31], v[92:95]
 s_waitcnt lgkmcnt(2)
 v_mfma_f32_16x16x32_bf16 v[64:67], v[40:43], a[32:35], v[64:67]
 ds_read_b128 v[56:59], v2 offset:8192
 v_mul_f32 v208, v234, v104
 v_mfma_f32_16x16x32_bf16 v[68:71], v[40:43], a[36:39], v[68:71]
 ds_read_b128 v[60:63], v2 offset:9216
 v_mul_f32 v209, v234, v105
 v_mfma_f32_16x16x32_bf16 v[72:75], v[40:43], a[40:43], v[72:75]
 buffer_load_dwordx4 v1, s[12:15], s38 offen offset:1024 lds
 v_mfma_f32_16x16x32_bf16 v[76:79], v[40:43], a[44:47], v[76:79]
 v_mul_f32 v210, v234, v106
 v_mul_f32 v211, v234, v107
 v_mfma_f32_16x16x32_bf16 v[80:83], v[44:47], a[32:35], v[80:83]
 s_add_u32 s38, s43, 272384
 s_add_u32 s38, s38, s44
 s_add_u32 s36, s44, 116736
 s_mov_b32 m0, s36
 s_nop 0
 buffer_load_dwordx4 v1, s[12:15], s38 offen offset:0 lds
 v_mfma_f32_16x16x32_bf16 v[84:87], v[44:47], a[36:39], v[84:87]
 v_mul_f32 v212, v235, v108
 v_mul_f32 v213, v235, v109
 v_mfma_f32_16x16x32_bf16 v[88:91], v[44:47], a[40:43], v[88:91]
 v_mul_f32 v214, v235, v110
 v_mfma_f32_16x16x32_bf16 v[92:95], v[44:47], a[44:47], v[92:95]
 s_waitcnt lgkmcnt(2)
 v_mfma_f32_16x16x32_bf16 v[64:67], v[48:51], a[48:51], v[64:67]
 ds_read_b128 v[40:43], v2 offset:10240
 v_mul_f32 v215, v235, v111
 v_mfma_f32_16x16x32_bf16 v[68:71], v[48:51], a[52:55], v[68:71]
 ds_read_b128 v[44:47], v2 offset:11264
 v_mfma_f32_16x16x32_bf16 v[72:75], v[48:51], a[56:59], v[72:75]
 buffer_load_dwordx4 v1, s[12:15], s38 offen offset:1024 lds
 v_mfma_f32_16x16x32_bf16 v[76:79], v[48:51], a[60:63], v[76:79]
 v_exp_f32 v208, v208
 v_mfma_f32_16x16x32_bf16 v[80:83], v[52:55], a[48:51], v[80:83]
 v_exp_f32 v209, v209
 v_mfma_f32_16x16x32_bf16 v[84:87], v[52:55], a[52:55], v[84:87]
 v_exp_f32 v210, v210
 v_mfma_f32_16x16x32_bf16 v[88:91], v[52:55], a[56:59], v[88:91]
 v_exp_f32 v211, v211
 v_mfma_f32_16x16x32_bf16 v[92:95], v[52:55], a[60:63], v[92:95]
 s_waitcnt lgkmcnt(2)
 v_mfma_f32_16x16x32_bf16 v[64:67], v[56:59], a[64:67], v[64:67]
 ds_read_b128 v[48:51], v2 offset:12288
 v_mfma_f32_16x16x32_bf16 v[68:71], v[56:59], a[68:71], v[68:71]
 ds_read_b128 v[52:55], v2 offset:13312
 v_mfma_f32_16x16x32_bf16 v[72:75], v[56:59], a[72:75], v[72:75]
 buffer_load_dwordx4 v1, s[12:15], s38 offen offset:2048 lds
 v_mfma_f32_16x16x32_bf16 v[76:79], v[56:59], a[76:79], v[76:79]
 v_exp_f32 v212, v212
 v_mfma_f32_16x16x32_bf16 v[80:83], v[60:63], a[64:67], v[80:83]
 v_exp_f32 v213, v213
 v_mfma_f32_16x16x32_bf16 v[84:87], v[60:63], a[68:71], v[84:87]
 v_exp_f32 v214, v214
 v_mfma_f32_16x16x32_bf16 v[88:91], v[60:63], a[72:75], v[88:91]
 v_exp_f32 v215, v215
 v_mfma_f32_16x16x32_bf16 v[92:95], v[60:63], a[76:79], v[92:95]
 v_mul_f32 v120, v104, v120
 s_waitcnt lgkmcnt(2)
 v_mfma_f32_16x16x32_bf16 v[64:67], v[40:43], a[80:83], v[64:67]
 ds_read_b128 v[56:59], v2 offset:14336
 v_mul_f32 v121, v105, v121
 v_mfma_f32_16x16x32_bf16 v[68:71], v[40:43], a[84:87], v[68:71]
 ds_read_b128 v[60:63], v2 offset:15360
 v_mul_f32 v122, v106, v122
 v_mfma_f32_16x16x32_bf16 v[72:75], v[40:43], a[88:91], v[72:75]
 buffer_load_dwordx4 v1, s[12:15], s38 offen offset:3072 lds
 v_mfma_f32_16x16x32_bf16 v[76:79], v[40:43], a[92:95], v[76:79]
 v_mul_f32 v123, v107, v123
 v_mul_f32 v124, v108, v124
 v_mfma_f32_16x16x32_bf16 v[80:83], v[44:47], a[80:83], v[80:83]
 v_mul_f32 v125, v109, v125
 v_mul_f32 v126, v110, v126
 v_mfma_f32_16x16x32_bf16 v[84:87], v[44:47], a[84:87], v[84:87]
 v_mul_f32 v127, v111, v127
 v_fma_f32 v208, v208, v238, v238
 v_mfma_f32_16x16x32_bf16 v[88:91], v[44:47], a[88:91], v[88:91]
 v_fma_f32 v209, v209, v238, v238
 v_mfma_f32_16x16x32_bf16 v[92:95], v[44:47], a[92:95], v[92:95]
 s_waitcnt lgkmcnt(2)
 v_mfma_f32_16x16x32_bf16 v[64:67], v[48:51], a[96:99], v[64:67]
 ds_read_b128 v[40:43], v2 offset:16384
 v_fma_f32 v210, v210, v238, v238
 v_mfma_f32_16x16x32_bf16 v[68:71], v[48:51], a[100:103], v[68:71]
 ds_read_b128 v[44:47], v2 offset:17408
 v_fma_f32 v211, v211, v238, v238
 v_mfma_f32_16x16x32_bf16 v[72:75], v[48:51], a[104:107], v[72:75]
 s_add_u32 s38, s38, 4096
 s_add_u32 s36, s36, 4096
 s_mov_b32 m0, s36
 s_nop 0
 buffer_load_dwordx4 v1, s[12:15], s38 offen offset:0 lds
 v_mfma_f32_16x16x32_bf16 v[76:79], v[48:51], a[108:111], v[76:79]
 v_fma_f32 v212, v212, v239, v239
 v_fma_f32 v213, v213, v239, v239
 v_mfma_f32_16x16x32_bf16 v[80:83], v[52:55], a[96:99], v[80:83]
 v_fma_f32 v214, v214, v239, v239
 v_fma_f32 v215, v215, v239, v239
 v_mfma_f32_16x16x32_bf16 v[84:87], v[52:55], a[100:103], v[84:87]
 v_rcp_f32 v208, v208
 v_mfma_f32_16x16x32_bf16 v[88:91], v[52:55], a[104:107], v[88:91]
 v_rcp_f32 v209, v209
 v_mfma_f32_16x16x32_bf16 v[92:95], v[52:55], a[108:111], v[92:95]
 s_waitcnt lgkmcnt(2)
 v_mfma_f32_16x16x32_bf16 v[64:67], v[56:59], a[112:115], v[64:67]
 ds_read_b128 v[48:51], v2 offset:18432
 v_mfma_f32_16x16x32_bf16 v[68:71], v[56:59], a[116:119], v[68:71]
 ds_read_b128 v[52:55], v2 offset:19456
 v_mfma_f32_16x16x32_bf16 v[72:75], v[56:59], a[120:123], v[72:75]
 buffer_load_dwordx4 v1, s[12:15], s38 offen offset:1024 lds
 v_mfma_f32_16x16x32_bf16 v[76:79], v[56:59], a[124:127], v[76:79]
 v_rcp_f32 v210, v210
 v_mfma_f32_16x16x32_bf16 v[80:83], v[60:63], a[112:115], v[80:83]
 v_rcp_f32 v211, v211
 v_mfma_f32_16x16x32_bf16 v[84:87], v[60:63], a[116:119], v[84:87]
 v_rcp_f32 v212, v212
 v_mfma_f32_16x16x32_bf16 v[88:91], v[60:63], a[120:123], v[88:91]
 v_rcp_f32 v213, v213
 v_mfma_f32_16x16x32_bf16 v[92:95], v[60:63], a[124:127], v[92:95]
 v_rcp_f32 v214, v214
 s_waitcnt lgkmcnt(2)
 v_mfma_f32_16x16x32_bf16 v[64:67], v[40:43], a[128:131], v[64:67]
 ds_read_b128 v[56:59], v2 offset:20480
 v_mfma_f32_16x16x32_bf16 v[68:71], v[40:43], a[132:135], v[68:71]
 ds_read_b128 v[60:63], v2 offset:21504
 v_mfma_f32_16x16x32_bf16 v[72:75], v[40:43], a[136:139], v[72:75]
 buffer_load_dwordx4 v1, s[12:15], s38 offen offset:2048 lds
 v_mfma_f32_16x16x32_bf16 v[76:79], v[40:43], a[140:143], v[76:79]
 v_rcp_f32 v215, v215
 v_mfma_f32_16x16x32_bf16 v[80:83], v[44:47], a[128:131], v[80:83]
 v_mul_f32 v120, v120, v208
 v_mul_f32 v121, v121, v209
 v_mfma_f32_16x16x32_bf16 v[84:87], v[44:47], a[132:135], v[84:87]
 v_mul_f32 v122, v122, v210
 v_mul_f32 v123, v123, v211
 v_mfma_f32_16x16x32_bf16 v[88:91], v[44:47], a[136:139], v[88:91]
 v_mul_f32 v124, v124, v212
 v_mul_f32 v125, v125, v213
 v_mfma_f32_16x16x32_bf16 v[92:95], v[44:47], a[140:143], v[92:95]
 v_mul_f32 v126, v126, v214
 s_waitcnt lgkmcnt(2)
 v_mfma_f32_16x16x32_bf16 v[64:67], v[48:51], a[144:147], v[64:67]
 ds_read_b128 v[40:43], v2 offset:22528
 v_mul_f32 v127, v127, v215
 v_mfma_f32_16x16x32_bf16 v[68:71], v[48:51], a[148:151], v[68:71]
 ds_read_b128 v[44:47], v2 offset:23552
 v_cvt_pk_bf16_f32 v202, v120, v121
 v_mfma_f32_16x16x32_bf16 v[72:75], v[48:51], a[152:155], v[72:75]
 buffer_load_dwordx4 v1, s[12:15], s38 offen offset:3072 lds
 v_mfma_f32_16x16x32_bf16 v[76:79], v[48:51], a[156:159], v[76:79]
 v_cvt_pk_bf16_f32 v203, v122, v123
 v_cvt_pk_bf16_f32 v206, v124, v125
 v_mfma_f32_16x16x32_bf16 v[80:83], v[52:55], a[144:147], v[80:83]
 v_cvt_pk_bf16_f32 v207, v126, v127
 v_mfma_f32_16x16x32_bf16 v[84:87], v[52:55], a[148:151], v[84:87]
 s_lshl_b32 s47, s34, 2
 s_add_u32 s47, s47, 0
 s_lshl_b32 s47, s47, 10
 s_add_u32 s47, s47, s46
 buffer_store_dwordx4 v[192:195], v1, s[20:23], s47 offen sc1
 v_mfma_f32_16x16x32_bf16 v[88:91], v[52:55], a[152:155], v[88:91]
 s_add_u32 s47, s47, 147456
 buffer_store_dwordx4 v[196:199], v1, s[20:23], s47 offen sc1
 v_mfma_f32_16x16x32_bf16 v[92:95], v[52:55], a[156:159], v[92:95]
 s_waitcnt lgkmcnt(2)
 v_mfma_f32_16x16x32_bf16 v[64:67], v[56:59], a[160:163], v[64:67]
 ds_read_b128 v[48:51], v2 offset:24576
 v_mfma_f32_16x16x32_bf16 v[68:71], v[56:59], a[164:167], v[68:71]
 ds_read_b128 v[52:55], v2 offset:25600
 v_mfma_f32_16x16x32_bf16 v[72:75], v[56:59], a[168:171], v[72:75]
 s_add_u32 s38, s38, 4096
 s_add_u32 s36, s36, 4096
 s_mov_b32 m0, s36
 s_nop 0
 buffer_load_dwordx4 v1, s[12:15], s38 offen offset:0 lds
 v_mfma_f32_16x16x32_bf16 v[76:79], v[56:59], a[172:175], v[76:79]
 s_add_u32 s47, s47, 147456
 buffer_store_dwordx4 v[200:203], v1, s[20:23], s47 offen sc1
 v_mfma_f32_16x16x32_bf16 v[80:83], v[60:63], a[160:163], v[80:83]
 s_add_u32 s47, s47, 147456
 buffer_store_dwordx4 v[204:207], v1, s[20:23], s47 offen sc1
 v_mfma_f32_16x16x32_bf16 v[84:87], v[60:63], a[164:167], v[84:87]
 v_mul_f32 v208, v232, v128
 v_mul_f32 v209, v232, v129
 v_mfma_f32_16x16x32_bf16 v[88:91], v[60:63], a[168:171], v[88:91]
 v_mul_f32 v210, v232, v130
 v_mul_f32 v211, v232, v131
 v_mfma_f32_16x16x32_bf16 v[92:95], v[60:63], a[172:175], v[92:95]
 v_mul_f32 v212, v233, v132
 s_waitcnt lgkmcnt(2)
 v_mfma_f32_16x16x32_bf16 v[64:67], v[40:43], a[176:179], v[64:67]
 ds_read_b128 v[56:59], v2 offset:26624
 v_mul_f32 v213, v233, v133
 v_mfma_f32_16x16x32_bf16 v[68:71], v[40:43], a[180:183], v[68:71]
 ds_read_b128 v[60:63], v2 offset:27648
 v_mul_f32 v214, v233, v134
 v_mfma_f32_16x16x32_bf16 v[72:75], v[40:43], a[184:187], v[72:75]
 buffer_load_dwordx4 v1, s[12:15], s38 offen offset:1024 lds
 v_mfma_f32_16x16x32_bf16 v[76:79], v[40:43], a[188:191], v[76:79]
 v_mul_f32 v215, v233, v135
 v_mfma_f32_16x16x32_bf16 v[80:83], v[44:47], a[176:179], v[80:83]
 v_exp_f32 v208, v208
 v_mfma_f32_16x16x32_bf16 v[84:87], v[44:47], a[180:183], v[84:87]
 v_exp_f32 v209, v209
 v_mfma_f32_16x16x32_bf16 v[88:91], v[44:47], a[184:187], v[88:91]
 v_exp_f32 v210, v210
 v_mfma_f32_16x16x32_bf16 v[92:95], v[44:47], a[188:191], v[92:95]
 s_waitcnt lgkmcnt(2)
 v_mfma_f32_16x16x32_bf16 v[64:67], v[48:51], a[192:195], v[64:67]
 ds_read_b128 v[40:43], v2 offset:28672
 v_mfma_f32_16x16x32_bf16 v[68:71], v[48:51], a[196:199], v[68:71]
 ds_read_b128 v[44:47], v2 offset:29696
 v_mfma_f32_16x16x32_bf16 v[72:75], v[48:51], a[200:203], v[72:75]
 v_exp_f32 v211, v211
 v_mfma_f32_16x16x32_bf16 v[76:79], v[48:51], a[204:207], v[76:79]
 v_exp_f32 v212, v212
 v_mfma_f32_16x16x32_bf16 v[80:83], v[52:55], a[192:195], v[80:83]
 v_exp_f32 v213, v213
 v_mfma_f32_16x16x32_bf16 v[84:87], v[52:55], a[196:199], v[84:87]
 v_exp_f32 v214, v214
 v_mfma_f32_16x16x32_bf16 v[88:91], v[52:55], a[200:203], v[88:91]
 v_exp_f32 v215, v215
 v_mfma_f32_16x16x32_bf16 v[92:95], v[52:55], a[204:207], v[92:95]
 v_mul_f32 v144, v128, v144
 s_waitcnt lgkmcnt(2)
 v_mfma_f32_16x16x32_bf16 v[64:67], v[56:59], a[208:211], v[64:67]
 ds_read_b128 v[48:51], v2 offset:30720
 v_mul_f32 v145, v129, v145
 v_mfma_f32_16x16x32_bf16 v[68:71], v[56:59], a[212:215], v[68:71]
 ds_read_b128 v[52:55], v2 offset:31744
 v_mul_f32 v146, v130, v146
 v_mfma_f32_16x16x32_bf16 v[72:75], v[56:59], a[216:219], v[72:75]
 v_mul_f32 v147, v131, v147
 v_mul_f32 v148, v132, v148
 v_mfma_f32_16x16x32_bf16 v[76:79], v[56:59], a[220:223], v[76:79]
 v_mul_f32 v149, v133, v149
 v_mul_f32 v150, v134, v150
 v_mfma_f32_16x16x32_bf16 v[80:83], v[60:63], a[208:211], v[80:83]
 v_mul_f32 v151, v135, v151
 v_fma_f32 v208, v208, v236, v236
 v_mfma_f32_16x16x32_bf16 v[84:87], v[60:63], a[212:215], v[84:87]
 v_fma_f32 v209, v209, v236, v236
 v_fma_f32 v210, v210, v236, v236
 v_mfma_f32_16x16x32_bf16 v[88:91], v[60:63], a[216:219], v[88:91]
 v_fma_f32 v211, v211, v236, v236
 v_mfma_f32_16x16x32_bf16 v[92:95], v[60:63], a[220:223], v[92:95]
 s_waitcnt lgkmcnt(2)
 v_mfma_f32_16x16x32_bf16 v[64:67], v[40:43], a[224:227], v[64:67]
 ds_read_b128 v[56:59], v2 offset:32768
 v_fma_f32 v212, v212, v237, v237
 v_mfma_f32_16x16x32_bf16 v[68:71], v[40:43], a[228:231], v[68:71]
 ds_read_b128 v[60:63], v2 offset:33792
 v_fma_f32 v213, v213, v237, v237
 v_mfma_f32_16x16x32_bf16 v[72:75], v[40:43], a[232:235], v[72:75]
 v_fma_f32 v214, v214, v237, v237
 v_fma_f32 v215, v215, v237, v237
 v_mfma_f32_16x16x32_bf16 v[76:79], v[40:43], a[236:239], v[76:79]
 v_rcp_f32 v208, v208
 v_mfma_f32_16x16x32_bf16 v[80:83], v[44:47], a[224:227], v[80:83]
 v_rcp_f32 v209, v209
 v_mfma_f32_16x16x32_bf16 v[84:87], v[44:47], a[228:231], v[84:87]
 v_rcp_f32 v210, v210
 v_mfma_f32_16x16x32_bf16 v[88:91], v[44:47], a[232:235], v[88:91]
 v_rcp_f32 v211, v211
 v_mfma_f32_16x16x32_bf16 v[92:95], v[44:47], a[236:239], v[92:95]
 s_waitcnt lgkmcnt(2)
 v_mfma_f32_16x16x32_bf16 v[64:67], v[48:51], a[240:243], v[64:67]
 ds_read_b128 v[40:43], v2 offset:34816
 v_mfma_f32_16x16x32_bf16 v[68:71], v[48:51], a[244:247], v[68:71]
 ds_read_b128 v[44:47], v2 offset:35840
 v_mfma_f32_16x16x32_bf16 v[72:75], v[48:51], a[248:251], v[72:75]
 v_rcp_f32 v212, v212
 v_mfma_f32_16x16x32_bf16 v[76:79], v[48:51], a[252:255], v[76:79]
 v_rcp_f32 v213, v213
 v_mfma_f32_16x16x32_bf16 v[80:83], v[52:55], a[240:243], v[80:83]
 v_rcp_f32 v214, v214
 v_mfma_f32_16x16x32_bf16 v[84:87], v[52:55], a[244:247], v[84:87]
 v_rcp_f32 v215, v215
 v_mfma_f32_16x16x32_bf16 v[88:91], v[52:55], a[248:251], v[88:91]
 v_mul_f32 v144, v144, v208
 v_mul_f32 v145, v145, v209
 v_mfma_f32_16x16x32_bf16 v[92:95], v[52:55], a[252:255], v[92:95]
 v_mul_f32 v146, v146, v210
 s_waitcnt lgkmcnt(2)
 v_mfma_f32_16x16x32_bf16 v[64:67], v[56:59], v[8:11], v[64:67]
 ds_read_b128 v[48:51], v2 offset:36864
 v_mul_f32 v147, v147, v211
 v_mfma_f32_16x16x32_bf16 v[68:71], v[56:59], v[12:15], v[68:71]
 ds_read_b128 v[52:55], v2 offset:37888
 v_mul_f32 v148, v148, v212
 v_mfma_f32_16x16x32_bf16 v[72:75], v[56:59], v[16:19], v[72:75]
 v_mul_f32 v149, v149, v213
 v_mul_f32 v150, v150, v214
 v_mfma_f32_16x16x32_bf16 v[76:79], v[56:59], v[20:23], v[76:79]
 v_mul_f32 v151, v151, v215
 v_cvt_pk_bf16_f32 v192, v144, v145
 v_mfma_f32_16x16x32_bf16 v[80:83], v[60:63], v[8:11], v[80:83]
 v_cvt_pk_bf16_f32 v193, v146, v147
 v_cvt_pk_bf16_f32 v196, v148, v149
 v_mfma_f32_16x16x32_bf16 v[84:87], v[60:63], v[12:15], v[84:87]
 v_cvt_pk_bf16_f32 v197, v150, v151
 v_mul_f32 v208, v234, v136
 v_mfma_f32_16x16x32_bf16 v[88:91], v[60:63], v[16:19], v[88:91]
 v_mul_f32 v209, v234, v137
 v_mfma_f32_16x16x32_bf16 v[92:95], v[60:63], v[20:23], v[92:95]
 s_waitcnt lgkmcnt(0)
 s_waitcnt vmcnt(24)
 s_barrier
 v_mfma_f32_16x16x32_bf16 v[64:67], v[40:43], v[24:27], v[64:67]
 ds_read_b128 v[56:59], v3 offset:0
 v_mul_f32 v210, v234, v138
 v_mfma_f32_16x16x32_bf16 v[68:71], v[40:43], v[28:31], v[68:71]
 ds_read_b128 v[60:63], v3 offset:1024
 v_mul_f32 v211, v234, v139
 v_mfma_f32_16x16x32_bf16 v[72:75], v[40:43], v[32:35], v[72:75]
 s_add_u32 s38, s45, s44
 s_add_u32 s36, s44, 0
 s_mov_b32 m0, s36
 s_nop 0
 buffer_load_dwordx4 v1, s[12:15], s38 offen offset:0 lds
 v_mfma_f32_16x16x32_bf16 v[76:79], v[40:43], v[36:39], v[76:79]
 v_mul_f32 v212, v235, v140
 v_mul_f32 v213, v235, v141
 v_mfma_f32_16x16x32_bf16 v[80:83], v[44:47], v[24:27], v[80:83]
 buffer_load_dwordx4 v1, s[12:15], s38 offen offset:1024 lds
 v_mfma_f32_16x16x32_bf16 v[84:87], v[44:47], v[28:31], v[84:87]
 v_mul_f32 v214, v235, v142
 v_mul_f32 v215, v235, v143
 v_mfma_f32_16x16x32_bf16 v[88:91], v[44:47], v[32:35], v[88:91]
 v_exp_f32 v208, v208
 v_mfma_f32_16x16x32_bf16 v[92:95], v[44:47], v[36:39], v[92:95]
 s_waitcnt lgkmcnt(2)
 v_mfma_f32_16x16x32_bf16 v[64:67], v[48:51], v[216:219], v[64:67]
 ds_read_b128 v[40:43], v3 offset:2048
 v_mfma_f32_16x16x32_bf16 v[68:71], v[48:51], v[220:223], v[68:71]
 ds_read_b128 v[44:47], v3 offset:3072
 v_mfma_f32_16x16x32_bf16 v[72:75], v[48:51], v[224:227], v[72:75]
 buffer_load_dwordx4 v1, s[12:15], s38 offen offset:2048 lds
 v_mfma_f32_16x16x32_bf16 v[76:79], v[48:51], v[228:231], v[76:79]
 v_exp_f32 v209, v209
 v_mfma_f32_16x16x32_bf16 v[80:83], v[52:55], v[216:219], v[80:83]
 v_exp_f32 v210, v210
 v_mfma_f32_16x16x32_bf16 v[84:87], v[52:55], v[220:223], v[84:87]
 v_exp_f32 v211, v211
 v_mfma_f32_16x16x32_bf16 v[88:91], v[52:55], v[224:227], v[88:91]
 v_exp_f32 v212, v212
 v_mfma_f32_16x16x32_bf16 v[92:95], v[52:55], v[228:231], v[92:95]
 v_exp_f32 v213, v213
 s_waitcnt lgkmcnt(2)
 v_mfma_f32_16x16x32_bf16 v[96:99], v[56:59], a[0:3], 0
 ds_read_b128 v[48:51], v3 offset:4096
 v_mfma_f32_16x16x32_bf16 v[100:103], v[56:59], a[4:7], 0
 ds_read_b128 v[52:55], v3 offset:5120
 v_mfma_f32_16x16x32_bf16 v[104:107], v[56:59], a[8:11], 0
 buffer_load_dwordx4 v1, s[12:15], s38 offen offset:3072 lds
 v_mfma_f32_16x16x32_bf16 v[108:111], v[56:59], a[12:15], 0
 v_exp_f32 v214, v214
 v_mfma_f32_16x16x32_bf16 v[112:115], v[60:63], a[0:3], 0
 v_exp_f32 v215, v215
 v_mfma_f32_16x16x32_bf16 v[116:119], v[60:63], a[4:7], 0
 v_mul_f32 v152, v136, v152
 v_mul_f32 v153, v137, v153
 v_mfma_f32_16x16x32_bf16 v[120:123], v[60:63], a[8:11], 0
 v_mul_f32 v154, v138, v154
 v_mul_f32 v155, v139, v155
 v_mfma_f32_16x16x32_bf16 v[124:127], v[60:63], a[12:15], 0
 v_mul_f32 v156, v140, v156
 s_waitcnt lgkmcnt(2)
 v_mfma_f32_16x16x32_bf16 v[96:99], v[40:43], a[16:19], v[96:99]
 ds_read_b128 v[56:59], v3 offset:6144
 v_mul_f32 v157, v141, v157
 v_mfma_f32_16x16x32_bf16 v[100:103], v[40:43], a[20:23], v[100:103]
 ds_read_b128 v[60:63], v3 offset:7168
 v_mul_f32 v158, v142, v158
 v_mfma_f32_16x16x32_bf16 v[104:107], v[40:43], a[24:27], v[104:107]
 s_add_u32 s38, s38, 4096
 s_add_u32 s36, s36, 4096
 s_mov_b32 m0, s36
 s_nop 0
 buffer_load_dwordx4 v1, s[12:15], s38 offen offset:0 lds
 v_mfma_f32_16x16x32_bf16 v[108:111], v[40:43], a[28:31], v[108:111]
 v_mul_f32 v159, v143, v159
 v_fma_f32 v208, v208, v238, v238
 v_mfma_f32_16x16x32_bf16 v[112:115], v[44:47], a[16:19], v[112:115]
 v_fma_f32 v209, v209, v238, v238
 v_fma_f32 v210, v210, v238, v238
 v_mfma_f32_16x16x32_bf16 v[116:119], v[44:47], a[20:23], v[116:119]
 v_fma_f32 v211, v211, v238, v238
 v_fma_f32 v212, v212, v239, v239
 v_mfma_f32_16x16x32_bf16 v[120:123], v[44:47], a[24:27], v[120:123]
 v_fma_f32 v213, v213, v239, v239
 v_mfma_f32_16x16x32_bf16 v[124:127], v[44:47], a[28:31], v[124:127]
 s_waitcnt lgkmcnt(2)
 v_mfma_f32_16x16x32_bf16 v[96:99], v[48:51], a[32:35], v[96:99]
 ds_read_b128 v[40:43], v3 offset:8192
 v_fma_f32 v214, v214, v239, v239
 v_mfma_f32_16x16x32_bf16 v[100:103], v[48:51], a[36:39], v[100:103]
 ds_read_b128 v[44:47], v3 offset:9216
 v_fma_f32 v215, v215, v239, v239
 v_mfma_f32_16x16x32_bf16 v[104:107], v[48:51], a[40:43], v[104:107]
 buffer_load_dwordx4 v1, s[12:15], s38 offen offset:1024 lds
 v_mfma_f32_16x16x32_bf16 v[108:111], v[48:51], a[44:47], v[108:111]
 v_rcp_f32 v208, v208
 v_mfma_f32_16x16x32_bf16 v[112:115], v[52:55], a[32:35], v[112:115]
 v_rcp_f32 v209, v209
 v_mfma_f32_16x16x32_bf16 v[116:119], v[52:55], a[36:39], v[116:119]
 v_rcp_f32 v210, v210
 v_mfma_f32_16x16x32_bf16 v[120:123], v[52:55], a[40:43], v[120:123]
 v_rcp_f32 v211, v211
 v_mfma_f32_16x16x32_bf16 v[124:127], v[52:55], a[44:47], v[124:127]
 s_waitcnt lgkmcnt(2)
 v_mfma_f32_16x16x32_bf16 v[96:99], v[56:59], a[48:51], v[96:99]
 ds_read_b128 v[48:51], v3 offset:10240
 v_mfma_f32_16x16x32_bf16 v[100:103], v[56:59], a[52:55], v[100:103]
 ds_read_b128 v[52:55], v3 offset:11264
 v_mfma_f32_16x16x32_bf16 v[104:107], v[56:59], a[56:59], v[104:107]
 buffer_load_dwordx4 v1, s[12:15], s38 offen offset:2048 lds
 v_mfma_f32_16x16x32_bf16 v[108:111], v[56:59], a[60:63], v[108:111]
 v_rcp_f32 v212, v212
 v_mfma_f32_16x16x32_bf16 v[112:115], v[60:63], a[48:51], v[112:115]
 v_rcp_f32 v213, v213
 v_mfma_f32_16x16x32_bf16 v[116:119], v[60:63], a[52:55], v[116:119]
 v_rcp_f32 v214, v214
 v_mfma_f32_16x16x32_bf16 v[120:123], v[60:63], a[56:59], v[120:123]
 v_rcp_f32 v215, v215
 v_mfma_f32_16x16x32_bf16 v[124:127], v[60:63], a[60:63], v[124:127]
 v_mul_f32 v152, v152, v208
 s_waitcnt lgkmcnt(2)
 v_mfma_f32_16x16x32_bf16 v[96:99], v[40:43], a[64:67], v[96:99]
 ds_read_b128 v[56:59], v3 offset:12288
 v_mul_f32 v153, v153, v209
 v_mfma_f32_16x16x32_bf16 v[100:103], v[40:43], a[68:71], v[100:103]
 ds_read_b128 v[60:63], v3 offset:13312
 v_mul_f32 v154, v154, v210
 v_mfma_f32_16x16x32_bf16 v[104:107], v[40:43], a[72:75], v[104:107]
 buffer_load_dwordx4 v1, s[12:15], s38 offen offset:3072 lds
 v_mfma_f32_16x16x32_bf16 v[108:111], v[40:43], a[76:79], v[108:111]
 v_mul_f32 v155, v155, v211
 v_mul_f32 v156, v156, v212
 v_mfma_f32_16x16x32_bf16 v[112:115], v[44:47], a[64:67], v[112:115]
 v_mul_f32 v157, v157, v213
 v_mul_f32 v158, v158, v214
 v_mfma_f32_16x16x32_bf16 v[116:119], v[44:47], a[68:71], v[116:119]
 v_mul_f32 v159, v159, v215
 v_cvt_pk_bf16_f32 v200, v152, v153
 v_mfma_f32_16x16x32_bf16 v[120:123], v[44:47], a[72:75], v[120:123]
 v_cvt_pk_bf16_f32 v201, v154, v155
 v_mfma_f32_16x16x32_bf16 v[124:127], v[44:47], a[76:79], v[124:127]
 s_waitcnt lgkmcnt(2)
 v_mfma_f32_16x16x32_bf16 v[96:99], v[48:51], a[80:83], v[96:99]
 ds_read_b128 v[40:43], v3 offset:14336
 v_cvt_pk_bf16_f32 v204, v156, v157
 v_mfma_f32_16x16x32_bf16 v[100:103], v[48:51], a[84:87], v[100:103]
 ds_read_b128 v[44:47], v3 offset:15360
 v_cvt_pk_bf16_f32 v205, v158, v159
 v_mfma_f32_16x16x32_bf16 v[104:107], v[48:51], a[88:91], v[104:107]
 s_add_u32 s38, s38, 4096
 s_add_u32 s36, s36, 4096
 s_mov_b32 m0, s36
 s_nop 0
 buffer_load_dwordx4 v1, s[12:15], s38 offen offset:0 lds
 v_mfma_f32_16x16x32_bf16 v[108:111], v[48:51], a[92:95], v[108:111]
 v_mul_f32 v208, v232, v160
 v_mul_f32 v209, v232, v161
 v_mfma_f32_16x16x32_bf16 v[112:115], v[52:55], a[80:83], v[112:115]
 v_mul_f32 v210, v232, v162
 v_mul_f32 v211, v232, v163
 v_mfma_f32_16x16x32_bf16 v[116:119], v[52:55], a[84:87], v[116:119]
 v_mul_f32 v212, v233, v164
 v_mul_f32 v213, v233, v165
 v_mfma_f32_16x16x32_bf16 v[120:123], v[52:55], a[88:91], v[120:123]
 v_mul_f32 v214, v233, v166
 v_mfma_f32_16x16x32_bf16 v[124:127], v[52:55], a[92:95], v[124:127]
 s_waitcnt lgkmcnt(2)
 v_mfma_f32_16x16x32_bf16 v[96:99], v[56:59], a[96:99], v[96:99]
 ds_read_b128 v[48:51], v3 offset:16384
 v_mul_f32 v215, v233, v167
 v_mfma_f32_16x16x32_bf16 v[100:103], v[56:59], a[100:103], v[100:103]
 ds_read_b128 v[52:55], v3 offset:17408
 v_mfma_f32_16x16x32_bf16 v[104:107], v[56:59], a[104:107], v[104:107]
 buffer_load_dwordx4 v1, s[12:15], s38 offen offset:1024 lds
 v_mfma_f32_16x16x32_bf16 v[108:111], v[56:59], a[108:111], v[108:111]
 v_exp_f32 v208, v208
 v_mfma_f32_16x16x32_bf16 v[112:115], v[60:63], a[96:99], v[112:115]
 v_exp_f32 v209, v209
 v_mfma_f32_16x16x32_bf16 v[116:119], v[60:63], a[100:103], v[116:119]
 v_exp_f32 v210, v210
 v_mfma_f32_16x16x32_bf16 v[120:123], v[60:63], a[104:107], v[120:123]
 v_exp_f32 v211, v211
 v_mfma_f32_16x16x32_bf16 v[124:127], v[60:63], a[108:111], v[124:127]
 s_waitcnt lgkmcnt(2)
 v_mfma_f32_16x16x32_bf16 v[96:99], v[40:43], a[112:115], v[96:99]
 ds_read_b128 v[56:59], v3 offset:18432
 v_mfma_f32_16x16x32_bf16 v[100:103], v[40:43], a[116:119], v[100:103]
 ds_read_b128 v[60:63], v3 offset:19456
 v_mfma_f32_16x16x32_bf16 v[104:107], v[40:43], a[120:123], v[104:107]
 v_exp_f32 v212, v212
 v_mfma_f32_16x16x32_bf16 v[108:111], v[40:43], a[124:127], v[108:111]
 v_exp_f32 v213, v213
 v_mfma_f32_16x16x32_bf16 v[112:115], v[44:47], a[112:115], v[112:115]
 v_exp_f32 v214, v214
 v_mfma_f32_16x16x32_bf16 v[116:119], v[44:47], a[116:119], v[116:119]
 v_exp_f32 v215, v215
 v_mfma_f32_16x16x32_bf16 v[120:123], v[44:47], a[120:123], v[120:123]
 v_mul_f32 v176, v160, v176
 v_mul_f32 v177, v161, v177
 v_mfma_f32_16x16x32_bf16 v[124:127], v[44:47], a[124:127], v[124:127]
 v_mul_f32 v178, v162, v178
 s_waitcnt lgkmcnt(2)
 v_mfma_f32_16x16x32_bf16 v[96:99], v[48:51], a[128:131], v[96:99]
 ds_read_b128 v[40:43], v3 offset:20480
 v_mul_f32 v179, v163, v179
 v_mfma_f32_16x16x32_bf16 v[100:103], v[48:51], a[132:135], v[100:103]
 ds_read_b128 v[44:47], v3 offset:21504
 v_mul_f32 v180, v164, v180
 v_mfma_f32_16x16x32_bf16 v[104:107], v[48:51], a[136:139], v[104:107]
 v_mul_f32 v181, v165, v181
 v_mul_f32 v182, v166, v182
 v_mfma_f32_16x16x32_bf16 v[108:111], v[48:51], a[140:143], v[108:111]
 v_mul_f32 v183, v167, v183
 v_fma_f32 v208, v208, v236, v236
 v_mfma_f32_16x16x32_bf16 v[112:115], v[52:55], a[128:131], v[112:115]
 v_fma_f32 v209, v209, v236, v236
 v_fma_f32 v210, v210, v236, v236
 v_mfma_f32_16x16x32_bf16 v[116:119], v[52:55], a[132:135], v[116:119]
 v_fma_f32 v211, v211, v236, v236
 v_fma_f32 v212, v212, v237, v237
 v_mfma_f32_16x16x32_bf16 v[120:123], v[52:55], a[136:139], v[120:123]
 v_fma_f32 v213, v213, v237, v237
 v_mfma_f32_16x16x32_bf16 v[124:127], v[52:55], a[140:143], v[124:127]
 s_waitcnt lgkmcnt(2)
 v_mfma_f32_16x16x32_bf16 v[96:99], v[56:59], a[144:147], v[96:99]
 ds_read_b128 v[48:51], v3 offset:22528
 v_fma_f32 v214, v214, v237, v237
 v_mfma_f32_16x16x32_bf16 v[100:103], v[56:59], a[148:151], v[100:103]
 ds_read_b128 v[52:55], v3 offset:23552
 v_fma_f32 v215, v215, v237, v237
 v_mfma_f32_16x16x32_bf16 v[104:107], v[56:59], a[152:155], v[104:107]
 v_rcp_f32 v208, v208
 v_mfma_f32_16x16x32_bf16 v[108:111], v[56:59], a[156:159], v[108:111]
 v_rcp_f32 v209, v209
 v_mfma_f32_16x16x32_bf16 v[112:115], v[60:63], a[144:147], v[112:115]
 v_rcp_f32 v210, v210
 v_mfma_f32_16x16x32_bf16 v[116:119], v[60:63], a[148:151], v[116:119]
 v_rcp_f32 v211, v211
 v_mfma_f32_16x16x32_bf16 v[120:123], v[60:63], a[152:155], v[120:123]
 v_rcp_f32 v212, v212
 v_mfma_f32_16x16x32_bf16 v[124:127], v[60:63], a[156:159], v[124:127]
 s_waitcnt lgkmcnt(2)
 v_mfma_f32_16x16x32_bf16 v[96:99], v[40:43], a[160:163], v[96:99]
 ds_read_b128 v[56:59], v3 offset:24576
 v_mfma_f32_16x16x32_bf16 v[100:103], v[40:43], a[164:167], v[100:103]
 ds_read_b128 v[60:63], v3 offset:25600
 v_mfma_f32_16x16x32_bf16 v[104:107], v[40:43], a[168:171], v[104:107]
 v_rcp_f32 v213, v213
 v_mfma_f32_16x16x32_bf16 v[108:111], v[40:43], a[172:175], v[108:111]
 v_rcp_f32 v214, v214
 v_mfma_f32_16x16x32_bf16 v[112:115], v[44:47], a[160:163], v[112:115]
 v_rcp_f32 v215, v215
 v_mfma_f32_16x16x32_bf16 v[116:119], v[44:47], a[164:167], v[116:119]
 v_mul_f32 v176, v176, v208
 v_mul_f32 v177, v177, v209
 v_mfma_f32_16x16x32_bf16 v[120:123], v[44:47], a[168:171], v[120:123]
 v_mul_f32 v178, v178, v210
 v_mul_f32 v179, v179, v211
 v_mfma_f32_16x16x32_bf16 v[124:127], v[44:47], a[172:175], v[124:127]
 v_mul_f32 v180, v180, v212
 s_waitcnt lgkmcnt(2)
 v_mfma_f32_16x16x32_bf16 v[96:99], v[48:51], a[176:179], v[96:99]
 ds_read_b128 v[40:43], v3 offset:26624
 v_mul_f32 v181, v181, v213
 v_mfma_f32_16x16x32_bf16 v[100:103], v[48:51], a[180:183], v[100:103]
 ds_read_b128 v[44:47], v3 offset:27648
 v_mul_f32 v182, v182, v214
 v_mfma_f32_16x16x32_bf16 v[104:107], v[48:51], a[184:187], v[104:107]
 v_mul_f32 v183, v183, v215
 v_cvt_pk_bf16_f32 v194, v176, v177
 v_mfma_f32_16x16x32_bf16 v[108:111], v[48:51], a[188:191], v[108:111]
 v_cvt_pk_bf16_f32 v195, v178, v179
 v_cvt_pk_bf16_f32 v198, v180, v181
 v_mfma_f32_16x16x32_bf16 v[112:115], v[52:55], a[176:179], v[112:115]
 v_cvt_pk_bf16_f32 v199, v182, v183
 v_mul_f32 v208, v234, v168
 v_mfma_f32_16x16x32_bf16 v[116:119], v[52:55], a[180:183], v[116:119]
 v_mul_f32 v209, v234, v169
 v_mul_f32 v210, v234, v170
 v_mfma_f32_16x16x32_bf16 v[120:123], v[52:55], a[184:187], v[120:123]
 v_mul_f32 v211, v234, v171
 v_mfma_f32_16x16x32_bf16 v[124:127], v[52:55], a[188:191], v[124:127]
 s_waitcnt lgkmcnt(2)
 v_mfma_f32_16x16x32_bf16 v[96:99], v[56:59], a[192:195], v[96:99]
 ds_read_b128 v[48:51], v3 offset:28672
 v_mul_f32 v212, v235, v172
 v_mfma_f32_16x16x32_bf16 v[100:103], v[56:59], a[196:199], v[100:103]
 ds_read_b128 v[52:55], v3 offset:29696
 v_mul_f32 v213, v235, v173
 v_mfma_f32_16x16x32_bf16 v[104:107], v[56:59], a[200:203], v[104:107]
 v_mul_f32 v214, v235, v174
 v_mul_f32 v215, v235, v175
 v_mfma_f32_16x16x32_bf16 v[108:111], v[56:59], a[204:207], v[108:111]
 v_exp_f32 v208, v208
 v_mfma_f32_16x16x32_bf16 v[112:115], v[60:63], a[192:195], v[112:115]
 v_exp_f32 v209, v209
 v_mfma_f32_16x16x32_bf16 v[116:119], v[60:63], a[196:199], v[116:119]
 v_exp_f32 v210, v210
 v_mfma_f32_16x16x32_bf16 v[120:123], v[60:63], a[200:203], v[120:123]
 v_exp_f32 v211, v211
 v_mfma_f32_16x16x32_bf16 v[124:127], v[60:63], a[204:207], v[124:127]
 s_waitcnt lgkmcnt(2)
 v_mfma_f32_16x16x32_bf16 v[96:99], v[40:43], a[208:211], v[96:99]
 ds_read_b128 v[56:59], v3 offset:30720
 v_mfma_f32_16x16x32_bf16 v[100:103], v[40:43], a[212:215], v[100:103]
 ds_read_b128 v[60:63], v3 offset:31744
 v_mfma_f32_16x16x32_bf16 v[104:107], v[40:43], a[216:219], v[104:107]
 v_exp_f32 v212, v212
 v_mfma_f32_16x16x32_bf16 v[108:111], v[40:43], a[220:223], v[108:111]
 v_exp_f32 v213, v213
 v_mfma_f32_16x16x32_bf16 v[112:115], v[44:47], a[208:211], v[112:115]
 v_exp_f32 v214, v214
 v_mfma_f32_16x16x32_bf16 v[116:119], v[44:47], a[212:215], v[116:119]
 v_exp_f32 v215, v215
 v_mfma_f32_16x16x32_bf16 v[120:123], v[44:47], a[216:219], v[120:123]
 v_mul_f32 v184, v168, v184
 v_mul_f32 v185, v169, v185
 v_mfma_f32_16x16x32_bf16 v[124:127], v[44:47], a[220:223], v[124:127]
 v_mul_f32 v186, v170, v186
 s_waitcnt lgkmcnt(2)
 v_mfma_f32_16x16x32_bf16 v[96:99], v[48:51], a[224:227], v[96:99]
 ds_read_b128 v[40:43], v3 offset:32768
 v_mul_f32 v187, v171, v187
 v_mfma_f32_16x16x32_bf16 v[100:103], v[48:51], a[228:231], v[100:103]
 ds_read_b128 v[44:47], v3 offset:33792
 v_mul_f32 v188, v172, v188
 v_mfma_f32_16x16x32_bf16 v[104:107], v[48:51], a[232:235], v[104:107]
 v_mul_f32 v189, v173, v189
 v_mul_f32 v190, v174, v190
 v_mfma_f32_16x16x32_bf16 v[108:111], v[48:51], a[236:239], v[108:111]
 v_mul_f32 v191, v175, v191
 v_fma_f32 v208, v208, v238, v238
 v_mfma_f32_16x16x32_bf16 v[112:115], v[52:55], a[224:227], v[112:115]
 v_fma_f32 v209, v209, v238, v238
 v_fma_f32 v210, v210, v238, v238
 v_mfma_f32_16x16x32_bf16 v[116:119], v[52:55], a[228:231], v[116:119]
 v_fma_f32 v211, v211, v238, v238
 v_fma_f32 v212, v212, v239, v239
 v_mfma_f32_16x16x32_bf16 v[120:123], v[52:55], a[232:235], v[120:123]
 v_fma_f32 v213, v213, v239, v239
 v_mfma_f32_16x16x32_bf16 v[124:127], v[52:55], a[236:239], v[124:127]
 s_waitcnt lgkmcnt(2)
 v_mfma_f32_16x16x32_bf16 v[96:99], v[56:59], a[240:243], v[96:99]
 ds_read_b128 v[48:51], v3 offset:34816
 v_fma_f32 v214, v214, v239, v239
 v_mfma_f32_16x16x32_bf16 v[100:103], v[56:59], a[244:247], v[100:103]
 ds_read_b128 v[52:55], v3 offset:35840
 v_fma_f32 v215, v215, v239, v239
 v_mfma_f32_16x16x32_bf16 v[104:107], v[56:59], a[248:251], v[104:107]
 v_rcp_f32 v208, v208
 v_mfma_f32_16x16x32_bf16 v[108:111], v[56:59], a[252:255], v[108:111]
 v_rcp_f32 v209, v209
 v_mfma_f32_16x16x32_bf16 v[112:115], v[60:63], a[240:243], v[112:115]
 v_rcp_f32 v210, v210
 v_mfma_f32_16x16x32_bf16 v[116:119], v[60:63], a[244:247], v[116:119]
 v_rcp_f32 v211, v211
 v_mfma_f32_16x16x32_bf16 v[120:123], v[60:63], a[248:251], v[120:123]
 v_rcp_f32 v212, v212
 v_mfma_f32_16x16x32_bf16 v[124:127], v[60:63], a[252:255], v[124:127]
 s_waitcnt lgkmcnt(2)
 v_mfma_f32_16x16x32_bf16 v[96:99], v[40:43], v[8:11], v[96:99]
 ds_read_b128 v[56:59], v3 offset:36864
 v_mfma_f32_16x16x32_bf16 v[100:103], v[40:43], v[12:15], v[100:103]
 ds_read_b128 v[60:63], v3 offset:37888
 v_mfma_f32_16x16x32_bf16 v[104:107], v[40:43], v[16:19], v[104:107]
 v_rcp_f32 v213, v213
 v_mfma_f32_16x16x32_bf16 v[108:111], v[40:43], v[20:23], v[108:111]
 v_rcp_f32 v214, v214
 v_mfma_f32_16x16x32_bf16 v[112:115], v[44:47], v[8:11], v[112:115]
 v_rcp_f32 v215, v215
 v_mfma_f32_16x16x32_bf16 v[116:119], v[44:47], v[12:15], v[116:119]
 v_mul_f32 v184, v184, v208
 v_mul_f32 v185, v185, v209
 v_mfma_f32_16x16x32_bf16 v[120:123], v[44:47], v[16:19], v[120:123]
 v_mul_f32 v186, v186, v210
 v_mul_f32 v187, v187, v211
 v_mfma_f32_16x16x32_bf16 v[124:127], v[44:47], v[20:23], v[124:127]
 v_mul_f32 v188, v188, v212
 s_waitcnt vmcnt(24)
 s_barrier
 s_waitcnt lgkmcnt(2)
 v_mfma_f32_16x16x32_bf16 v[96:99], v[48:51], v[24:27], v[96:99]
 ds_read_b128 v[40:43], v4 offset:0
 v_mul_f32 v189, v189, v213
 v_mfma_f32_16x16x32_bf16 v[100:103], v[48:51], v[28:31], v[100:103]
 ds_read_b128 v[44:47], v4 offset:1024
 v_mul_f32 v190, v190, v214
 v_mfma_f32_16x16x32_bf16 v[104:107], v[48:51], v[32:35], v[104:107]
 v_mul_f32 v191, v191, v215
 v_cvt_pk_bf16_f32 v202, v184, v185
 v_mfma_f32_16x16x32_bf16 v[108:111], v[48:51], v[36:39], v[108:111]
 v_cvt_pk_bf16_f32 v203, v186, v187
 v_cvt_pk_bf16_f32 v206, v188, v189
 v_mfma_f32_16x16x32_bf16 v[112:115], v[52:55], v[24:27], v[112:115]
 v_cvt_pk_bf16_f32 v207, v190, v191
 v_mfma_f32_16x16x32_bf16 v[116:119], v[52:55], v[28:31], v[116:119]
 s_lshl_b32 s47, s34, 2
 s_add_u32 s47, s47, 1
 s_lshl_b32 s47, s47, 10
 s_add_u32 s47, s47, s46
 buffer_store_dwordx4 v[192:195], v1, s[20:23], s47 offen sc1
 v_mfma_f32_16x16x32_bf16 v[120:123], v[52:55], v[32:35], v[120:123]
 s_add_u32 s47, s47, 147456
 buffer_store_dwordx4 v[196:199], v1, s[20:23], s47 offen sc1
 v_mfma_f32_16x16x32_bf16 v[124:127], v[52:55], v[36:39], v[124:127]
 s_waitcnt lgkmcnt(2)
 v_mfma_f32_16x16x32_bf16 v[96:99], v[56:59], v[216:219], v[96:99]
 ds_read_b128 v[48:51], v4 offset:2048
 v_mfma_f32_16x16x32_bf16 v[100:103], v[56:59], v[220:223], v[100:103]
 ds_read_b128 v[52:55], v4 offset:3072
 v_mfma_f32_16x16x32_bf16 v[104:107], v[56:59], v[224:227], v[104:107]
 s_add_u32 s47, s47, 147456
 buffer_store_dwordx4 v[200:203], v1, s[20:23], s47 offen sc1
 v_mfma_f32_16x16x32_bf16 v[108:111], v[56:59], v[228:231], v[108:111]
 s_add_u32 s47, s47, 147456
 buffer_store_dwordx4 v[204:207], v1, s[20:23], s47 offen sc1
 v_mfma_f32_16x16x32_bf16 v[112:115], v[60:63], v[216:219], v[112:115]
 v_mul_f32 v208, v232, v64
 v_mul_f32 v209, v232, v65
 v_mfma_f32_16x16x32_bf16 v[116:119], v[60:63], v[220:223], v[116:119]
 v_mul_f32 v210, v232, v66
 v_mul_f32 v211, v232, v67
 v_mfma_f32_16x16x32_bf16 v[120:123], v[60:63], v[224:227], v[120:123]
 v_mul_f32 v212, v233, v68
 v_mul_f32 v213, v233, v69
 v_mfma_f32_16x16x32_bf16 v[124:127], v[60:63], v[228:231], v[124:127]
 v_mul_f32 v214, v233, v70
 s_waitcnt lgkmcnt(2)
 v_mfma_f32_16x16x32_bf16 v[128:131], v[40:43], a[0:3], 0
 ds_read_b128 v[56:59], v4 offset:4096
 v_mul_f32 v215, v233, v71
 v_mfma_f32_16x16x32_bf16 v[132:135], v[40:43], a[4:7], 0
 ds_read_b128 v[60:63], v4 offset:5120
 v_mfma_f32_16x16x32_bf16 v[136:139], v[40:43], a[8:11], 0
 v_exp_f32 v208, v208
 v_mfma_f32_16x16x32_bf16 v[140:143], v[40:43], a[12:15], 0
 v_exp_f32 v209, v209
 v_mfma_f32_16x16x32_bf16 v[144:147], v[44:47], a[0:3], 0
 v_exp_f32 v210, v210
 v_mfma_f32_16x16x32_bf16 v[148:151], v[44:47], a[4:7], 0
 v_exp_f32 v211, v211
 v_mfma_f32_16x16x32_bf16 v[152:155], v[44:47], a[8:11], 0
 v_exp_f32 v212, v212
 v_mfma_f32_16x16x32_bf16 v[156:159], v[44:47], a[12:15], 0
 s_waitcnt lgkmcnt(2)
 v_mfma_f32_16x16x32_bf16 v[128:131], v[48:51], a[16:19], v[128:131]
 ds_read_b128 v[40:43], v4 offset:6144
 v_mfma_f32_16x16x32_bf16 v[132:135], v[48:51], a[20:23], v[132:135]
 ds_read_b128 v[44:47], v4 offset:7168
 v_mfma_f32_16x16x32_bf16 v[136:139], v[48:51], a[24:27], v[136:139]
 v_exp_f32 v213, v213
 v_mfma_f32_16x16x32_bf16 v[140:143], v[48:51], a[28:31], v[140:143]
 v_exp_f32 v214, v214
 v_mfma_f32_16x16x32_bf16 v[144:147], v[52:55], a[16:19], v[144:147]
 v_exp_f32 v215, v215
 v_mfma_f32_16x16x32_bf16 v[148:151], v[52:55], a[20:23], v[148:151]
 v_mul_f32 v80, v64, v80
 v_mul_f32 v81, v65, v81
 v_mfma_f32_16x16x32_bf16 v[152:155], v[52:55], a[24:27], v[152:155]
 v_mul_f32 v82, v66, v82
 v_mul_f32 v83, v67, v83
 v_mfma_f32_16x16x32_bf16 v[156:159], v[52:55], a[28:31], v[156:159]
 v_mul_f32 v84, v68, v84
 s_waitcnt lgkmcnt(2)
 v_mfma_f32_16x16x32_bf16 v[128:131], v[56:59], a[32:35], v[128:131]
 ds_read_b128 v[48:51], v4 offset:8192
 v_mul_f32 v85, v69, v85
 v_mfma_f32_16x16x32_bf16 v[132:135], v[56:59], a[36:39], v[132:135]
 ds_read_b128 v[52:55], v4 offset:9216
 v_mul_f32 v86, v70, v86
 v_mfma_f32_16x16x32_bf16 v[136:139], v[56:59], a[40:43], v[136:139]
 v_mul_f32 v87, v71, v87
 v_fma_f32 v208, v208, v236, v236
 v_mfma_f32_16x16x32_bf16 v[140:143], v[56:59], a[44:47], v[140:143]
 v_fma_f32 v209, v209, v236, v236
 v_fma_f32 v210, v210, v236, v236
 v_mfma_f32_16x16x32_bf16 v[144:147], v[60:63], a[32:35], v[144:147]
 v_fma_f32 v211, v211, v236, v236
 v_fma_f32 v212, v212, v237, v237
 v_mfma_f32_16x16x32_bf16 v[148:151], v[60:63], a[36:39], v[148:151]
 v_fma_f32 v213, v213, v237, v237
 v_fma_f32 v214, v214, v237, v237
 v_mfma_f32_16x16x32_bf16 v[152:155], v[60:63], a[40:43], v[152:155]
 v_fma_f32 v215, v215, v237, v237
 v_mfma_f32_16x16x32_bf16 v[156:159], v[60:63], a[44:47], v[156:159]
 s_waitcnt lgkmcnt(2)
 v_mfma_f32_16x16x32_bf16 v[128:131], v[40:43], a[48:51], v[128:131]
 ds_read_b128 v[56:59], v4 offset:10240
 v_mfma_f32_16x16x32_bf16 v[132:135], v[40:43], a[52:55], v[132:135]
 ds_read_b128 v[60:63], v4 offset:11264
 v_mfma_f32_16x16x32_bf16 v[136:139], v[40:43], a[56:59], v[136:139]
 v_rcp_f32 v208, v208
 v_mfma_f32_16x16x32_bf16 v[140:143], v[40:43], a[60:63], v[140:143]
 v_rcp_f32 v209, v209
 v_mfma_f32_16x16x32_bf16 v[144:147], v[44:47], a[48:51], v[144:147]
 v_rcp_f32 v210, v210
 v_mfma_f32_16x16x32_bf16 v[148:151], v[44:47], a[52:55], v[148:151]
 v_rcp_f32 v211, v211
 v_mfma_f32_16x16x32_bf16 v[152:155], v[44:47], a[56:59], v[152:155]
 v_rcp_f32 v212, v212
 v_mfma_f32_16x16x32_bf16 v[156:159], v[44:47], a[60:63], v[156:159]
 v_rcp_f32 v213, v213
 s_waitcnt lgkmcnt(2)
 v_mfma_f32_16x16x32_bf16 v[128:131], v[48:51], a[64:67], v[128:131]
 ds_read_b128 v[40:43], v4 offset:12288
 v_mfma_f32_16x16x32_bf16 v[132:135], v[48:51], a[68:71], v[132:135]
 ds_read_b128 v[44:47], v4 offset:13312
 v_mfma_f32_16x16x32_bf16 v[136:139], v[48:51], a[72:75], v[136:139]
 v_rcp_f32 v214, v214
 v_mfma_f32_16x16x32_bf16 v[140:143], v[48:51], a[76:79], v[140:143]
 v_rcp_f32 v215, v215
 v_mfma_f32_16x16x32_bf16 v[144:147], v[52:55], a[64:67], v[144:147]
 v_mul_f32 v80, v80, v208
 v_mul_f32 v81, v81, v209
 v_mfma_f32_16x16x32_bf16 v[148:151], v[52:55], a[68:71], v[148:151]
 v_mul_f32 v82, v82, v210
 v_mul_f32 v83, v83, v211
 v_mfma_f32_16x16x32_bf16 v[152:155], v[52:55], a[72:75], v[152:155]
 v_mul_f32 v84, v84, v212
 v_mul_f32 v85, v85, v213
 v_mfma_f32_16x16x32_bf16 v[156:159], v[52:55], a[76:79], v[156:159]
 v_mul_f32 v86, v86, v214
 s_waitcnt lgkmcnt(2)
 v_mfma_f32_16x16x32_bf16 v[128:131], v[56:59], a[80:83], v[128:131]
 ds_read_b128 v[48:51], v4 offset:14336
 v_mul_f32 v87, v87, v215
 v_mfma_f32_16x16x32_bf16 v[132:135], v[56:59], a[84:87], v[132:135]
 ds_read_b128 v[52:55], v4 offset:15360
 v_cvt_pk_bf16_f32 v192, v80, v81
 v_mfma_f32_16x16x32_bf16 v[136:139], v[56:59], a[88:91], v[136:139]
 v_cvt_pk_bf16_f32 v193, v82, v83
 v_cvt_pk_bf16_f32 v196, v84, v85
 v_mfma_f32_16x16x32_bf16 v[140:143], v[56:59], a[92:95], v[140:143]
 v_cvt_pk_bf16_f32 v197, v86, v87
 v_mul_f32 v208, v234, v72
 v_mfma_f32_16x16x32_bf16 v[144:147], v[60:63], a[80:83], v[144:147]
 v_mul_f32 v209, v234, v73
 v_mul_f32 v210, v234, v74
 v_mfma_f32_16x16x32_bf16 v[148:151], v[60:63], a[84:87], v[148:151]
 v_mul_f32 v211, v234, v75
 v_mul_f32 v212, v235, v76
 v_mfma_f32_16x16x32_bf16 v[152:155], v[60:63], a[88:91], v[152:155]
 v_mul_f32 v213, v235, v77
 v_mfma_f32_16x16x32_bf16 v[156:159], v[60:63], a[92:95], v[156:159]
 s_waitcnt lgkmcnt(2)
 v_mfma_f32_16x16x32_bf16 v[128:131], v[40:43], a[96:99], v[128:131]
 ds_read_b128 v[56:59], v4 offset:16384
 v_mul_f32 v214, v235, v78
 v_mfma_f32_16x16x32_bf16 v[132:135], v[40:43], a[100:103], v[132:135]
 ds_read_b128 v[60:63], v4 offset:17408
 v_mul_f32 v215, v235, v79
 v_mfma_f32_16x16x32_bf16 v[136:139], v[40:43], a[104:107], v[136:139]
 v_exp_f32 v208, v208
 v_mfma_f32_16x16x32_bf16 v[140:143], v[40:43], a[108:111], v[140:143]
 v_exp_f32 v209, v209
 v_mfma_f32_16x16x32_bf16 v[144:147], v[44:47], a[96:99], v[144:147]
 v_exp_f32 v210, v210
 v_mfma_f32_16x16x32_bf16 v[148:151], v[44:47], a[100:103], v[148:151]
 v_exp_f32 v211, v211
 v_mfma_f32_16x16x32_bf16 v[152:155], v[44:47], a[104:107], v[152:155]
 v_exp_f32 v212, v212
 v_mfma_f32_16x16x32_bf16 v[156:159], v[44:47], a[108:111], v[156:159]
 s_waitcnt lgkmcnt(2)
 v_mfma_f32_16x16x32_bf16 v[128:131], v[48:51], a[112:115], v[128:131]
 ds_read_b128 v[40:43], v4 offset:18432
 v_mfma_f32_16x16x32_bf16 v[132:135], v[48:51], a[116:119], v[132:135]
 ds_read_b128 v[44:47], v4 offset:19456
 v_mfma_f32_16x16x32_bf16 v[136:139], v[48:51], a[120:123], v[136:139]
 v_exp_f32 v213, v213
 v_mfma_f32_16x16x32_bf16 v[140:143], v[48:51], a[124:127], v[140:143]
 v_exp_f32 v214, v214
 v_mfma_f32_16x16x32_bf16 v[144:147], v[52:55], a[112:115], v[144:147]
 v_exp_f32 v215, v215
 v_mfma_f32_16x16x32_bf16 v[148:151], v[52:55], a[116:119], v[148:151]
 v_mul_f32 v88, v72, v88
 v_mul_f32 v89, v73, v89
 v_mfma_f32_16x16x32_bf16 v[152:155], v[52:55], a[120:123], v[152:155]
 v_mul_f32 v90, v74, v90
 v_mul_f32 v91, v75, v91
 v_mfma_f32_16x16x32_bf16 v[156:159], v[52:55], a[124:127], v[156:159]
 v_mul_f32 v92, v76, v92
 s_waitcnt lgkmcnt(2)
 v_mfma_f32_16x16x32_bf16 v[128:131], v[56:59], a[128:131], v[128:131]
 ds_read_b128 v[48:51], v4 offset:20480
 v_mul_f32 v93, v77, v93
 v_mfma_f32_16x16x32_bf16 v[132:135], v[56:59], a[132:135], v[132:135]
 ds_read_b128 v[52:55], v4 offset:21504
 v_mul_f32 v94, v78, v94
 v_mfma_f32_16x16x32_bf16 v[136:139], v[56:59], a[136:139], v[136:139]
 v_mul_f32 v95, v79, v95
 v_fma_f32 v208, v208, v238, v238
 v_mfma_f32_16x16x32_bf16 v[140:143], v[56:59], a[140:143], v[140:143]
 v_fma_f32 v209, v209, v238, v238
 v_fma_f32 v210, v210, v238, v238
 v_mfma_f32_16x16x32_bf16 v[144:147], v[60:63], a[128:131], v[144:147]
 v_fma_f32 v211, v211, v238, v238
 v_fma_f32 v212, v212, v239, v239
 v_mfma_f32_16x16x32_bf16 v[148:151], v[60:63], a[132:135], v[148:151]
 v_fma_f32 v213, v213, v239, v239
 v_fma_f32 v214, v214, v239, v239
 v_mfma_f32_16x16x32_bf16 v[152:155], v[60:63], a[136:139], v[152:155]
 v_fma_f32 v215, v215, v239, v239
 v_mfma_f32_16x16x32_bf16 v[156:159], v[60:63], a[140:143], v[156:159]
 s_waitcnt lgkmcnt(2)
 v_mfma_f32_16x16x32_bf16 v[128:131], v[40:43], a[144:147], v[128:131]
 ds_read_b128 v[56:59], v4 offset:22528
 v_mfma_f32_16x16x32_bf16 v[132:135], v[40:43], a[148:151], v[132:135]
 ds_read_b128 v[60:63], v4 offset:23552
 v_mfma_f32_16x16x32_bf16 v[136:139], v[40:43], a[152:155], v[136:139]
 v_rcp_f32 v208, v208
 v_mfma_f32_16x16x32_bf16 v[140:143], v[40:43], a[156:159], v[140:143]
 v_rcp_f32 v209, v209
 v_mfma_f32_16x16x32_bf16 v[144:147], v[44:47], a[144:147], v[144:147]
 v_rcp_f32 v210, v210
 v_mfma_f32_16x16x32_bf16 v[148:151], v[44:47], a[148:151], v[148:151]
 v_rcp_f32 v211, v211
 v_mfma_f32_16x16x32_bf16 v[152:155], v[44:47], a[152:155], v[152:155]
 v_rcp_f32 v212, v212
 v_mfma_f32_16x16x32_bf16 v[156:159], v[44:47], a[156:159], v[156:159]
 v_rcp_f32 v213, v213
 s_waitcnt lgkmcnt(2)
 v_mfma_f32_16x16x32_bf16 v[128:131], v[48:51], a[160:163], v[128:131]
 ds_read_b128 v[40:43], v4 offset:24576
 v_mfma_f32_16x16x32_bf16 v[132:135], v[48:51], a[164:167], v[132:135]
 ds_read_b128 v[44:47], v4 offset:25600
 v_mfma_f32_16x16x32_bf16 v[136:139], v[48:51], a[168:171], v[136:139]
 v_rcp_f32 v214, v214
 v_mfma_f32_16x16x32_bf16 v[140:143], v[48:51], a[172:175], v[140:143]
 v_rcp_f32 v215, v215
 v_mfma_f32_16x16x32_bf16 v[144:147], v[52:55], a[160:163], v[144:147]
 v_mul_f32 v88, v88, v208
 v_mul_f32 v89, v89, v209
 v_mfma_f32_16x16x32_bf16 v[148:151], v[52:55], a[164:167], v[148:151]
 v_mul_f32 v90, v90, v210
 v_mul_f32 v91, v91, v211
 v_mfma_f32_16x16x32_bf16 v[152:155], v[52:55], a[168:171], v[152:155]
 v_mul_f32 v92, v92, v212
 v_mul_f32 v93, v93, v213
 v_mfma_f32_16x16x32_bf16 v[156:159], v[52:55], a[172:175], v[156:159]
 v_mul_f32 v94, v94, v214
 s_waitcnt lgkmcnt(2)
 v_mfma_f32_16x16x32_bf16 v[128:131], v[56:59], a[176:179], v[128:131]
 ds_read_b128 v[48:51], v4 offset:26624
 v_mul_f32 v95, v95, v215
 v_mfma_f32_16x16x32_bf16 v[132:135], v[56:59], a[180:183], v[132:135]
 ds_read_b128 v[52:55], v4 offset:27648
 v_cvt_pk_bf16_f32 v200, v88, v89
 v_mfma_f32_16x16x32_bf16 v[136:139], v[56:59], a[184:187], v[136:139]
 v_cvt_pk_bf16_f32 v201, v90, v91
 v_cvt_pk_bf16_f32 v204, v92, v93
 v_mfma_f32_16x16x32_bf16 v[140:143], v[56:59], a[188:191], v[140:143]
 v_cvt_pk_bf16_f32 v205, v94, v95
 v_mul_f32 v208, v232, v96
 v_mfma_f32_16x16x32_bf16 v[144:147], v[60:63], a[176:179], v[144:147]
 v_mul_f32 v209, v232, v97
 v_mul_f32 v210, v232, v98
 v_mfma_f32_16x16x32_bf16 v[148:151], v[60:63], a[180:183], v[148:151]
 v_mul_f32 v211, v232, v99
 v_mul_f32 v212, v233, v100
 v_mfma_f32_16x16x32_bf16 v[152:155], v[60:63], a[184:187], v[152:155]
 v_mul_f32 v213, v233, v101
 v_mfma_f32_16x16x32_bf16 v[156:159], v[60:63], a[188:191], v[156:159]
 s_waitcnt lgkmcnt(2)
 v_mfma_f32_16x16x32_bf16 v[128:131], v[40:43], a[192:195], v[128:131]
 ds_read_b128 v[56:59], v4 offset:28672
 v_mul_f32 v214, v233, v102
 v_mfma_f32_16x16x32_bf16 v[132:135], v[40:43], a[196:199], v[132:135]
 ds_read_b128 v[60:63], v4 offset:29696
 v_mul_f32 v215, v233, v103
 v_mfma_f32_16x16x32_bf16 v[136:139], v[40:43], a[200:203], v[136:139]
 v_exp_f32 v208, v208
 v_mfma_f32_16x16x32_bf16 v[140:143], v[40:43], a[204:207], v[140:143]
 v_exp_f32 v209, v209
 v_mfma_f32_16x16x32_bf16 v[144:147], v[44:47], a[192:195], v[144:147]
 v_exp_f32 v210, v210
 v_mfma_f32_16x16x32_bf16 v[148:151], v[44:47], a[196:199], v[148:151]
 v_exp_f32 v211, v211
 v_mfma_f32_16x16x32_bf16 v[152:155], v[44:47], a[200:203], v[152:155]
 v_exp_f32 v212, v212
 v_mfma_f32_16x16x32_bf16 v[156:159], v[44:47], a[204:207], v[156:159]
 s_waitcnt lgkmcnt(2)
 v_mfma_f32_16x16x32_bf16 v[128:131], v[48:51], a[208:211], v[128:131]
 ds_read_b128 v[40:43], v4 offset:30720
 v_mfma_f32_16x16x32_bf16 v[132:135], v[48:51], a[212:215], v[132:135]
 ds_read_b128 v[44:47], v4 offset:31744
 v_mfma_f32_16x16x32_bf16 v[136:139], v[48:51], a[216:219], v[136:139]
 v_exp_f32 v213, v213
 v_mfma_f32_16x16x32_bf16 v[140:143], v[48:51], a[220:223], v[140:143]
 v_exp_f32 v214, v214
 v_mfma_f32_16x16x32_bf16 v[144:147], v[52:55], a[208:211], v[144:147]
 v_exp_f32 v215, v215
 v_mfma_f32_16x16x32_bf16 v[148:151], v[52:55], a[212:215], v[148:151]
 v_mul_f32 v112, v96, v112
 v_mul_f32 v113, v97, v113
 v_mfma_f32_16x16x32_bf16 v[152:155], v[52:55], a[216:219], v[152:155]
 v_mul_f32 v114, v98, v114
 v_mul_f32 v115, v99, v115
 v_mfma_f32_16x16x32_bf16 v[156:159], v[52:55], a[220:223], v[156:159]
 v_mul_f32 v116, v100, v116
 s_waitcnt lgkmcnt(2)
 v_mfma_f32_16x16x32_bf16 v[128:131], v[56:59], a[224:227], v[128:131]
 ds_read_b128 v[48:51], v4 offset:32768
 v_mul_f32 v117, v101, v117
 v_mfma_f32_16x16x32_bf16 v[132:135], v[56:59], a[228:231], v[132:135]
 ds_read_b128 v[52:55], v4 offset:33792
 v_mul_f32 v118, v102, v118
 v_mfma_f32_16x16x32_bf16 v[136:139], v[56:59], a[232:235], v[136:139]
 v_mul_f32 v119, v103, v119
 v_fma_f32 v208, v208, v236, v236
 v_mfma_f32_16x16x32_bf16 v[140:143], v[56:59], a[236:239], v[140:143]
 v_fma_f32 v209, v209, v236, v236
 v_fma_f32 v210, v210, v236, v236
 v_mfma_f32_16x16x32_bf16 v[144:147], v[60:63], a[224:227], v[144:147]
 v_fma_f32 v211, v211, v236, v236
 v_fma_f32 v212, v212, v237, v237
 v_mfma_f32_16x16x32_bf16 v[148:151], v[60:63], a[228:231], v[148:151]
 v_fma_f32 v213, v213, v237, v237
 v_fma_f32 v214, v214, v237, v237
 v_mfma_f32_16x16x32_bf16 v[152:155], v[60:63], a[232:235], v[152:155]
 v_fma_f32 v215, v215, v237, v237
 v_mfma_f32_16x16x32_bf16 v[156:159], v[60:63], a[236:239], v[156:159]
 s_waitcnt lgkmcnt(2)
 v_mfma_f32_16x16x32_bf16 v[128:131], v[40:43], a[240:243], v[128:131]
 ds_read_b128 v[56:59], v4 offset:34816
 v_mfma_f32_16x16x32_bf16 v[132:135], v[40:43], a[244:247], v[132:135]
 ds_read_b128 v[60:63], v4 offset:35840
 v_mfma_f32_16x16x32_bf16 v[136:139], v[40:43], a[248:251], v[136:139]
 v_rcp_f32 v208, v208
 v_mfma_f32_16x16x32_bf16 v[140:143], v[40:43], a[252:255], v[140:143]
 v_rcp_f32 v209, v209
 v_mfma_f32_16x16x32_bf16 v[144:147], v[44:47], a[240:243], v[144:147]
 v_rcp_f32 v210, v210
 v_mfma_f32_16x16x32_bf16 v[148:151], v[44:47], a[244:247], v[148:151]
 v_rcp_f32 v211, v211
 v_mfma_f32_16x16x32_bf16 v[152:155], v[44:47], a[248:251], v[152:155]
 v_rcp_f32 v212, v212
 v_mfma_f32_16x16x32_bf16 v[156:159], v[44:47], a[252:255], v[156:159]
 v_rcp_f32 v213, v213
 s_waitcnt lgkmcnt(2)
 v_mfma_f32_16x16x32_bf16 v[128:131], v[48:51], v[8:11], v[128:131]
 ds_read_b128 v[40:43], v4 offset:36864
 v_mfma_f32_16x16x32_bf16 v[132:135], v[48:51], v[12:15], v[132:135]
 ds_read_b128 v[44:47], v4 offset:37888
 v_mfma_f32_16x16x32_bf16 v[136:139], v[48:51], v[16:19], v[136:139]
 v_rcp_f32 v214, v214
 v_mfma_f32_16x16x32_bf16 v[140:143], v[48:51], v[20:23], v[140:143]
 v_rcp_f32 v215, v215
 v_mfma_f32_16x16x32_bf16 v[144:147], v[52:55], v[8:11], v[144:147]
 v_mul_f32 v112, v112, v208
 v_mul_f32 v113, v113, v209
 v_mfma_f32_16x16x32_bf16 v[148:151], v[52:55], v[12:15], v[148:151]
 v_mul_f32 v114, v114, v210
 v_mul_f32 v115, v115, v211
 v_mfma_f32_16x16x32_bf16 v[152:155], v[52:55], v[16:19], v[152:155]
 v_mul_f32 v116, v116, v212
 v_mul_f32 v117, v117, v213
 v_mfma_f32_16x16x32_bf16 v[156:159], v[52:55], v[20:23], v[156:159]
 v_mul_f32 v118, v118, v214
 s_waitcnt vmcnt(14)
 s_barrier
 s_waitcnt lgkmcnt(2)
 v_mfma_f32_16x16x32_bf16 v[128:131], v[56:59], v[24:27], v[128:131]
 ds_read_b128 v[48:51], v5 offset:0
 v_mul_f32 v119, v119, v215
 v_mfma_f32_16x16x32_bf16 v[132:135], v[56:59], v[28:31], v[132:135]
 ds_read_b128 v[52:55], v5 offset:1024
 v_cvt_pk_bf16_f32 v194, v112, v113
 v_mfma_f32_16x16x32_bf16 v[136:139], v[56:59], v[32:35], v[136:139]
 v_cvt_pk_bf16_f32 v195, v114, v115
 v_cvt_pk_bf16_f32 v198, v116, v117
 v_mfma_f32_16x16x32_bf16 v[140:143], v[56:59], v[36:39], v[140:143]
 v_cvt_pk_bf16_f32 v199, v118, v119
 v_mul_f32 v208, v234, v104
 v_mfma_f32_16x16x32_bf16 v[144:147], v[60:63], v[24:27], v[144:147]
 v_mul_f32 v209, v234, v105
 v_mul_f32 v210, v234, v106
 v_mfma_f32_16x16x32_bf16 v[148:151], v[60:63], v[28:31], v[148:151]
 v_mul_f32 v211, v234, v107
 v_mul_f32 v212, v235, v108
 v_mfma_f32_16x16x32_bf16 v[152:155], v[60:63], v[32:35], v[152:155]
 v_mul_f32 v213, v235, v109
 v_mfma_f32_16x16x32_bf16 v[156:159], v[60:63], v[36:39], v[156:159]
 s_waitcnt lgkmcnt(2)
 v_mfma_f32_16x16x32_bf16 v[128:131], v[40:43], v[216:219], v[128:131]
 ds_read_b128 v[56:59], v5 offset:2048
 v_mul_f32 v214, v235, v110
 v_mfma_f32_16x16x32_bf16 v[132:135], v[40:43], v[220:223], v[132:135]
 ds_read_b128 v[60:63], v5 offset:3072
 v_mul_f32 v215, v235, v111
 v_mfma_f32_16x16x32_bf16 v[136:139], v[40:43], v[224:227], v[136:139]
 v_exp_f32 v208, v208
 v_mfma_f32_16x16x32_bf16 v[140:143], v[40:43], v[228:231], v[140:143]
 v_exp_f32 v209, v209
 v_mfma_f32_16x16x32_bf16 v[144:147], v[44:47], v[216:219], v[144:147]
 v_exp_f32 v210, v210
 v_mfma_f32_16x16x32_bf16 v[148:151], v[44:47], v[220:223], v[148:151]
 v_exp_f32 v211, v211
 v_mfma_f32_16x16x32_bf16 v[152:155], v[44:47], v[224:227], v[152:155]
 v_exp_f32 v212, v212
 v_mfma_f32_16x16x32_bf16 v[156:159], v[44:47], v[228:231], v[156:159]
 s_waitcnt lgkmcnt(2)
 v_mfma_f32_16x16x32_bf16 v[160:163], v[48:51], a[0:3], 0
 ds_read_b128 v[40:43], v5 offset:4096
 v_mfma_f32_16x16x32_bf16 v[164:167], v[48:51], a[4:7], 0
 ds_read_b128 v[44:47], v5 offset:5120
 v_mfma_f32_16x16x32_bf16 v[168:171], v[48:51], a[8:11], 0
 v_exp_f32 v213, v213
 v_mfma_f32_16x16x32_bf16 v[172:175], v[48:51], a[12:15], 0
 v_exp_f32 v214, v214
 v_mfma_f32_16x16x32_bf16 v[176:179], v[52:55], a[0:3], 0
 v_exp_f32 v215, v215
 v_mfma_f32_16x16x32_bf16 v[180:183], v[52:55], a[4:7], 0
 v_mul_f32 v120, v104, v120
 v_mul_f32 v121, v105, v121
 v_mfma_f32_16x16x32_bf16 v[184:187], v[52:55], a[8:11], 0
 v_mul_f32 v122, v106, v122
 v_mul_f32 v123, v107, v123
 v_mfma_f32_16x16x32_bf16 v[188:191], v[52:55], a[12:15], 0
 v_mul_f32 v124, v108, v124
 s_waitcnt lgkmcnt(2)
 v_mfma_f32_16x16x32_bf16 v[160:163], v[56:59], a[16:19], v[160:163]
 ds_read_b128 v[48:51], v5 offset:6144
 v_mul_f32 v125, v109, v125
 v_mfma_f32_16x16x32_bf16 v[164:167], v[56:59], a[20:23], v[164:167]
 ds_read_b128 v[52:55], v5 offset:7168
 v_mul_f32 v126, v110, v126
 v_mfma_f32_16x16x32_bf16 v[168:171], v[56:59], a[24:27], v[168:171]
 v_mul_f32 v127, v111, v127
 v_fma_f32 v208, v208, v238, v238
 v_mfma_f32_16x16x32_bf16 v[172:175], v[56:59], a[28:31], v[172:175]
 v_fma_f32 v209, v209, v238, v238
 v_fma_f32 v210, v210, v238, v238
 v_mfma_f32_16x16x32_bf16 v[176:179], v[60:63], a[16:19], v[176:179]
 v_fma_f32 v211, v211, v238, v238
 v_fma_f32 v212, v212, v239, v239
 v_mfma_f32_16x16x32_bf16 v[180:183], v[60:63], a[20:23], v[180:183]
 v_fma_f32 v213, v213, v239, v239
 v_fma_f32 v214, v214, v239, v239
 v_mfma_f32_16x16x32_bf16 v[184:187], v[60:63], a[24:27], v[184:187]
 v_fma_f32 v215, v215, v239, v239
 v_mfma_f32_16x16x32_bf16 v[188:191], v[60:63], a[28:31], v[188:191]
 s_waitcnt lgkmcnt(2)
 v_mfma_f32_16x16x32_bf16 v[160:163], v[40:43], a[32:35], v[160:163]
 ds_read_b128 v[56:59], v5 offset:8192
 v_mfma_f32_16x16x32_bf16 v[164:167], v[40:43], a[36:39], v[164:167]
 ds_read_b128 v[60:63], v5 offset:9216
 v_mfma_f32_16x16x32_bf16 v[168:171], v[40:43], a[40:43], v[168:171]
 v_rcp_f32 v208, v208
 v_mfma_f32_16x16x32_bf16 v[172:175], v[40:43], a[44:47], v[172:175]
 v_rcp_f32 v209, v209
 v_mfma_f32_16x16x32_bf16 v[176:179], v[44:47], a[32:35], v[176:179]
 v_rcp_f32 v210, v210
 v_mfma_f32_16x16x32_bf16 v[180:183], v[44:47], a[36:39], v[180:183]
 v_rcp_f32 v211, v211
 v_mfma_f32_16x16x32_bf16 v[184:187], v[44:47], a[40:43], v[184:187]
 v_rcp_f32 v212, v212
 v_mfma_f32_16x16x32_bf16 v[188:191], v[44:47], a[44:47], v[188:191]
 v_rcp_f32 v213, v213
 s_waitcnt lgkmcnt(2)
 v_mfma_f32_16x16x32_bf16 v[160:163], v[48:51], a[48:51], v[160:163]
 ds_read_b128 v[40:43], v5 offset:10240
 v_mfma_f32_16x16x32_bf16 v[164:167], v[48:51], a[52:55], v[164:167]
 ds_read_b128 v[44:47], v5 offset:11264
 v_mfma_f32_16x16x32_bf16 v[168:171], v[48:51], a[56:59], v[168:171]
 v_rcp_f32 v214, v214
 v_mfma_f32_16x16x32_bf16 v[172:175], v[48:51], a[60:63], v[172:175]
 v_rcp_f32 v215, v215
 v_mfma_f32_16x16x32_bf16 v[176:179], v[52:55], a[48:51], v[176:179]
 v_mul_f32 v120, v120, v208
 v_mul_f32 v121, v121, v209
 v_mfma_f32_16x16x32_bf16 v[180:183], v[52:55], a[52:55], v[180:183]
 v_mul_f32 v122, v122, v210
 v_mul_f32 v123, v123, v211
 v_mfma_f32_16x16x32_bf16 v[184:187], v[52:55], a[56:59], v[184:187]
 v_mul_f32 v124, v124, v212
 v_mul_f32 v125, v125, v213
 v_mfma_f32_16x16x32_bf16 v[188:191], v[52:55], a[60:63], v[188:191]
 v_mul_f32 v126, v126, v214
 s_waitcnt lgkmcnt(2)
 v_mfma_f32_16x16x32_bf16 v[160:163], v[56:59], a[64:67], v[160:163]
 ds_read_b128 v[48:51], v5 offset:12288
 v_mul_f32 v127, v127, v215
 v_mfma_f32_16x16x32_bf16 v[164:167], v[56:59], a[68:71], v[164:167]
 ds_read_b128 v[52:55], v5 offset:13312
 v_cvt_pk_bf16_f32 v202, v120, v121
 v_mfma_f32_16x16x32_bf16 v[168:171], v[56:59], a[72:75], v[168:171]
 v_cvt_pk_bf16_f32 v203, v122, v123
 v_cvt_pk_bf16_f32 v206, v124, v125
 v_mfma_f32_16x16x32_bf16 v[172:175], v[56:59], a[76:79], v[172:175]
 v_cvt_pk_bf16_f32 v207, v126, v127
 v_mfma_f32_16x16x32_bf16 v[176:179], v[60:63], a[64:67], v[176:179]
 s_lshl_b32 s47, s34, 2
 s_add_u32 s47, s47, 2
 s_lshl_b32 s47, s47, 10
 s_add_u32 s47, s47, s46
 buffer_store_dwordx4 v[192:195], v1, s[20:23], s47 offen sc1
 v_mfma_f32_16x16x32_bf16 v[180:183], v[60:63], a[68:71], v[180:183]
 s_add_u32 s47, s47, 147456
 buffer_store_dwordx4 v[196:199], v1, s[20:23], s47 offen sc1
 v_mfma_f32_16x16x32_bf16 v[184:187], v[60:63], a[72:75], v[184:187]
 s_add_u32 s47, s47, 147456
 buffer_store_dwordx4 v[200:203], v1, s[20:23], s47 offen sc1
 v_mfma_f32_16x16x32_bf16 v[188:191], v[60:63], a[76:79], v[188:191]
 s_waitcnt lgkmcnt(2)
 v_mfma_f32_16x16x32_bf16 v[160:163], v[40:43], a[80:83], v[160:163]
 ds_read_b128 v[56:59], v5 offset:14336
 v_mfma_f32_16x16x32_bf16 v[164:167], v[40:43], a[84:87], v[164:167]
 ds_read_b128 v[60:63], v5 offset:15360
 v_mfma_f32_16x16x32_bf16 v[168:171], v[40:43], a[88:91], v[168:171]
 s_add_u32 s47, s47, 147456
 buffer_store_dwordx4 v[204:207], v1, s[20:23], s47 offen sc1
 v_mfma_f32_16x16x32_bf16 v[172:175], v[40:43], a[92:95], v[172:175]
 v_mul_f32 v208, v232, v128
 v_mul_f32 v209, v232, v129
 v_mfma_f32_16x16x32_bf16 v[176:179], v[44:47], a[80:83], v[176:179]
 v_mul_f32 v210, v232, v130
 v_mul_f32 v211, v232, v131
 v_mfma_f32_16x16x32_bf16 v[180:183], v[44:47], a[84:87], v[180:183]
 v_mul_f32 v212, v233, v132
 v_mul_f32 v213, v233, v133
 v_mfma_f32_16x16x32_bf16 v[184:187], v[44:47], a[88:91], v[184:187]
 v_mul_f32 v214, v233, v134
 v_mul_f32 v215, v233, v135
 v_mfma_f32_16x16x32_bf16 v[188:191], v[44:47], a[92:95], v[188:191]
 v_exp_f32 v208, v208
 s_waitcnt lgkmcnt(2)
 v_mfma_f32_16x16x32_bf16 v[160:163], v[48:51], a[96:99], v[160:163]
 ds_read_b128 v[40:43], v5 offset:16384
 v_mfma_f32_16x16x32_bf16 v[164:167], v[48:51], a[100:103], v[164:167]
 ds_read_b128 v[44:47], v5 offset:17408
 v_mfma_f32_16x16x32_bf16 v[168:171], v[48:51], a[104:107], v[168:171]
 v_exp_f32 v209, v209
 v_mfma_f32_16x16x32_bf16 v[172:175], v[48:51], a[108:111], v[172:175]
 v_exp_f32 v210, v210
 v_mfma_f32_16x16x32_bf16 v[176:179], v[52:55], a[96:99], v[176:179]
 v_exp_f32 v211, v211
 v_mfma_f32_16x16x32_bf16 v[180:183], v[52:55], a[100:103], v[180:183]
 v_exp_f32 v212, v212
 v_mfma_f32_16x16x32_bf16 v[184:187], v[52:55], a[104:107], v[184:187]
 v_exp_f32 v213, v213
 v_mfma_f32_16x16x32_bf16 v[188:191], v[52:55], a[108:111], v[188:191]
 v_exp_f32 v214, v214
 s_waitcnt lgkmcnt(2)
 v_mfma_f32_16x16x32_bf16 v[160:163], v[56:59], a[112:115], v[160:163]
 ds_read_b128 v[48:51], v5 offset:18432
 v_mfma_f32_16x16x32_bf16 v[164:167], v[56:59], a[116:119], v[164:167]
 ds_read_b128 v[52:55], v5 offset:19456
 v_mfma_f32_16x16x32_bf16 v[168:171], v[56:59], a[120:123], v[168:171]
 v_exp_f32 v215, v215
 v_mfma_f32_16x16x32_bf16 v[172:175], v[56:59], a[124:127], v[172:175]
 v_mul_f32 v144, v128, v144
 v_mul_f32 v145, v129, v145
 v_mfma_f32_16x16x32_bf16 v[176:179], v[60:63], a[112:115], v[176:179]
 v_mul_f32 v146, v130, v146
 v_mul_f32 v147, v131, v147
 v_mfma_f32_16x16x32_bf16 v[180:183], v[60:63], a[116:119], v[180:183]
 v_mul_f32 v148, v132, v148
 v_mul_f32 v149, v133, v149
 v_mfma_f32_16x16x32_bf16 v[184:187], v[60:63], a[120:123], v[184:187]
 v_mul_f32 v150, v134, v150
 v_mul_f32 v151, v135, v151
 v_mfma_f32_16x16x32_bf16 v[188:191], v[60:63], a[124:127], v[188:191]
 v_fma_f32 v208, v208, v236, v236
 s_waitcnt lgkmcnt(2)
 v_mfma_f32_16x16x32_bf16 v[160:163], v[40:43], a[128:131], v[160:163]
 ds_read_b128 v[56:59], v5 offset:20480
 v_fma_f32 v209, v209, v236, v236
 v_mfma_f32_16x16x32_bf16 v[164:167], v[40:43], a[132:135], v[164:167]
 ds_read_b128 v[60:63], v5 offset:21504
 v_fma_f32 v210, v210, v236, v236
 v_mfma_f32_16x16x32_bf16 v[168:171], v[40:43], a[136:139], v[168:171]
 v_fma_f32 v211, v211, v236, v236
 v_fma_f32 v212, v212, v237, v237
 v_mfma_f32_16x16x32_bf16 v[172:175], v[40:43], a[140:143], v[172:175]
 v_fma_f32 v213, v213, v237, v237
 v_fma_f32 v214, v214, v237, v237
 v_mfma_f32_16x16x32_bf16 v[176:179], v[44:47], a[128:131], v[176:179]
 v_fma_f32 v215, v215, v237, v237
 v_mfma_f32_16x16x32_bf16 v[180:183], v[44:47], a[132:135], v[180:183]
 v_rcp_f32 v208, v208
 v_mfma_f32_16x16x32_bf16 v[184:187], v[44:47], a[136:139], v[184:187]
 v_rcp_f32 v209, v209
 v_mfma_f32_16x16x32_bf16 v[188:191], v[44:47], a[140:143], v[188:191]
 s_waitcnt lgkmcnt(2)
 v_mfma_f32_16x16x32_bf16 v[160:163], v[48:51], a[144:147], v[160:163]
 ds_read_b128 v[40:43], v5 offset:22528
 v_mfma_f32_16x16x32_bf16 v[164:167], v[48:51], a[148:151], v[164:167]
 ds_read_b128 v[44:47], v5 offset:23552
 v_mfma_f32_16x16x32_bf16 v[168:171], v[48:51], a[152:155], v[168:171]
 v_rcp_f32 v210, v210
 v_mfma_f32_16x16x32_bf16 v[172:175], v[48:51], a[156:159], v[172:175]
 v_rcp_f32 v211, v211
 v_mfma_f32_16x16x32_bf16 v[176:179], v[52:55], a[144:147], v[176:179]
 v_rcp_f32 v212, v212
 v_mfma_f32_16x16x32_bf16 v[180:183], v[52:55], a[148:151], v[180:183]
 v_rcp_f32 v213, v213
 v_mfma_f32_16x16x32_bf16 v[184:187], v[52:55], a[152:155], v[184:187]
 v_rcp_f32 v214, v214
 v_mfma_f32_16x16x32_bf16 v[188:191], v[52:55], a[156:159], v[188:191]
 v_rcp_f32 v215, v215
 s_waitcnt lgkmcnt(2)
 v_mfma_f32_16x16x32_bf16 v[160:163], v[56:59], a[160:163], v[160:163]
 ds_read_b128 v[48:51], v5 offset:24576
 v_mul_f32 v144, v144, v208
 v_mfma_f32_16x16x32_bf16 v[164:167], v[56:59], a[164:167], v[164:167]
 ds_read_b128 v[52:55], v5 offset:25600
 v_mul_f32 v145, v145, v209
 v_mfma_f32_16x16x32_bf16 v[168:171], v[56:59], a[168:171], v[168:171]
 v_mul_f32 v146, v146, v210
 v_mul_f32 v147, v147, v211
 v_mfma_f32_16x16x32_bf16 v[172:175], v[56:59], a[172:175], v[172:175]
 v_mul_f32 v148, v148, v212
 v_mul_f32 v149, v149, v213
 v_mfma_f32_16x16x32_bf16 v[176:179], v[60:63], a[160:163], v[176:179]
 v_mul_f32 v150, v150, v214
 v_mul_f32 v151, v151, v215
 v_mfma_f32_16x16x32_bf16 v[180:183], v[60:63], a[164:167], v[180:183]
 v_cvt_pk_bf16_f32 v192, v144, v145
 v_cvt_pk_bf16_f32 v193, v146, v147
 v_mfma_f32_16x16x32_bf16 v[184:187], v[60:63], a[168:171], v[184:187]
 v_cvt_pk_bf16_f32 v196, v148, v149
 v_mfma_f32_16x16x32_bf16 v[188:191], v[60:63], a[172:175], v[188:191]
 s_waitcnt lgkmcnt(2)
 v_mfma_f32_16x16x32_bf16 v[160:163], v[40:43], a[176:179], v[160:163]
 ds_read_b128 v[56:59], v5 offset:26624
 v_cvt_pk_bf16_f32 v197, v150, v151
 v_mfma_f32_16x16x32_bf16 v[164:167], v[40:43], a[180:183], v[164:167]
 ds_read_b128 v[60:63], v5 offset:27648
 v_mul_f32 v208, v234, v136
 v_mfma_f32_16x16x32_bf16 v[168:171], v[40:43], a[184:187], v[168:171]
 v_mul_f32 v209, v234, v137
 v_mul_f32 v210, v234, v138
 v_mfma_f32_16x16x32_bf16 v[172:175], v[40:43], a[188:191], v[172:175]
 v_mul_f32 v211, v234, v139
 v_mul_f32 v212, v235, v140
 v_mfma_f32_16x16x32_bf16 v[176:179], v[44:47], a[176:179], v[176:179]
 v_mul_f32 v213, v235, v141
 v_mul_f32 v214, v235, v142
 v_mfma_f32_16x16x32_bf16 v[180:183], v[44:47], a[180:183], v[180:183]
 v_mul_f32 v215, v235, v143
 v_mfma_f32_16x16x32_bf16 v[184:187], v[44:47], a[184:187], v[184:187]
 v_exp_f32 v208, v208
 v_mfma_f32_16x16x32_bf16 v[188:191], v[44:47], a[188:191], v[188:191]
 s_waitcnt lgkmcnt(2)
 v_mfma_f32_16x16x32_bf16 v[160:163], v[48:51], a[192:195], v[160:163]
 ds_read_b128 v[40:43], v5 offset:28672
 v_mfma_f32_16x16x32_bf16 v[164:167], v[48:51], a[196:199], v[164:167]
 ds_read_b128 v[44:47], v5 offset:29696
 v_mfma_f32_16x16x32_bf16 v[168:171], v[48:51], a[200:203], v[168:171]
 v_exp_f32 v209, v209
 v_mfma_f32_16x16x32_bf16 v[172:175], v[48:51], a[204:207], v[172:175]
 v_exp_f32 v210, v210
 v_mfma_f32_16x16x32_bf16 v[176:179], v[52:55], a[192:195], v[176:179]
 v_exp_f32 v211, v211
 v_mfma_f32_16x16x32_bf16 v[180:183], v[52:55], a[196:199], v[180:183]
 v_exp_f32 v212, v212
 v_mfma_f32_16x16x32_bf16 v[184:187], v[52:55], a[200:203], v[184:187]
 v_exp_f32 v213, v213
 v_mfma_f32_16x16x32_bf16 v[188:191], v[52:55], a[204:207], v[188:191]
 v_exp_f32 v214, v214
 s_waitcnt lgkmcnt(2)
 v_mfma_f32_16x16x32_bf16 v[160:163], v[56:59], a[208:211], v[160:163]
 ds_read_b128 v[48:51], v5 offset:30720
 v_mfma_f32_16x16x32_bf16 v[164:167], v[56:59], a[212:215], v[164:167]
 ds_read_b128 v[52:55], v5 offset:31744
 v_mfma_f32_16x16x32_bf16 v[168:171], v[56:59], a[216:219], v[168:171]
 v_exp_f32 v215, v215
 v_mfma_f32_16x16x32_bf16 v[172:175], v[56:59], a[220:223], v[172:175]
 v_mul_f32 v152, v136, v152
 v_mul_f32 v153, v137, v153
 v_mfma_f32_16x16x32_bf16 v[176:179], v[60:63], a[208:211], v[176:179]
 v_mul_f32 v154, v138, v154
 v_mul_f32 v155, v139, v155
 v_mfma_f32_16x16x32_bf16 v[180:183], v[60:63], a[212:215], v[180:183]
 v_mul_f32 v156, v140, v156
 v_mul_f32 v157, v141, v157
 v_mfma_f32_16x16x32_bf16 v[184:187], v[60:63], a[216:219], v[184:187]
 v_mul_f32 v158, v142, v158
 v_mul_f32 v159, v143, v159
 v_mfma_f32_16x16x32_bf16 v[188:191], v[60:63], a[220:223], v[188:191]
 v_fma_f32 v208, v208, v238, v238
 s_waitcnt lgkmcnt(2)
 v_mfma_f32_16x16x32_bf16 v[160:163], v[40:43], a[224:227], v[160:163]
 ds_read_b128 v[56:59], v5 offset:32768
 v_fma_f32 v209, v209, v238, v238
 v_mfma_f32_16x16x32_bf16 v[164:167], v[40:43], a[228:231], v[164:167]
 ds_read_b128 v[60:63], v5 offset:33792
 v_fma_f32 v210, v210, v238, v238
 v_mfma_f32_16x16x32_bf16 v[168:171], v[40:43], a[232:235], v[168:171]
 v_fma_f32 v211, v211, v238, v238
 v_fma_f32 v212, v212, v239, v239
 v_mfma_f32_16x16x32_bf16 v[172:175], v[40:43], a[236:239], v[172:175]
 v_fma_f32 v213, v213, v239, v239
 v_fma_f32 v214, v214, v239, v239
 v_mfma_f32_16x16x32_bf16 v[176:179], v[44:47], a[224:227], v[176:179]
 v_fma_f32 v215, v215, v239, v239
 v_mfma_f32_16x16x32_bf16 v[180:183], v[44:47], a[228:231], v[180:183]
 v_rcp_f32 v208, v208
 v_mfma_f32_16x16x32_bf16 v[184:187], v[44:47], a[232:235], v[184:187]
 v_rcp_f32 v209, v209
 v_mfma_f32_16x16x32_bf16 v[188:191], v[44:47], a[236:239], v[188:191]
 s_waitcnt lgkmcnt(2)
 v_mfma_f32_16x16x32_bf16 v[160:163], v[48:51], a[240:243], v[160:163]
 ds_read_b128 v[40:43], v5 offset:34816
 v_mfma_f32_16x16x32_bf16 v[164:167], v[48:51], a[244:247], v[164:167]
 ds_read_b128 v[44:47], v5 offset:35840
 v_mfma_f32_16x16x32_bf16 v[168:171], v[48:51], a[248:251], v[168:171]
 v_rcp_f32 v210, v210
 v_mfma_f32_16x16x32_bf16 v[172:175], v[48:51], a[252:255], v[172:175]
 v_rcp_f32 v211, v211
 v_mfma_f32_16x16x32_bf16 v[176:179], v[52:55], a[240:243], v[176:179]
 v_rcp_f32 v212, v212
 v_mfma_f32_16x16x32_bf16 v[180:183], v[52:55], a[244:247], v[180:183]
 v_rcp_f32 v213, v213
 v_mfma_f32_16x16x32_bf16 v[184:187], v[52:55], a[248:251], v[184:187]
 v_rcp_f32 v214, v214
 v_mfma_f32_16x16x32_bf16 v[188:191], v[52:55], a[252:255], v[188:191]
 v_rcp_f32 v215, v215
 s_waitcnt lgkmcnt(2)
 v_mfma_f32_16x16x32_bf16 v[160:163], v[56:59], v[8:11], v[160:163]
 ds_read_b128 v[48:51], v5 offset:36864
 v_mul_f32 v152, v152, v208
 v_mfma_f32_16x16x32_bf16 v[164:167], v[56:59], v[12:15], v[164:167]
 ds_read_b128 v[52:55], v5 offset:37888
 v_mul_f32 v153, v153, v209
 v_mfma_f32_16x16x32_bf16 v[168:171], v[56:59], v[16:19], v[168:171]
 v_mul_f32 v154, v154, v210
 v_mul_f32 v155, v155, v211
 v_mfma_f32_16x16x32_bf16 v[172:175], v[56:59], v[20:23], v[172:175]
 v_mul_f32 v156, v156, v212
 v_mul_f32 v157, v157, v213
 v_mfma_f32_16x16x32_bf16 v[176:179], v[60:63], v[8:11], v[176:179]
 v_mul_f32 v158, v158, v214
 v_mul_f32 v159, v159, v215
 v_mfma_f32_16x16x32_bf16 v[180:183], v[60:63], v[12:15], v[180:183]
 v_cvt_pk_bf16_f32 v200, v152, v153
 v_cvt_pk_bf16_f32 v201, v154, v155
 v_mfma_f32_16x16x32_bf16 v[184:187], v[60:63], v[16:19], v[184:187]
 v_cvt_pk_bf16_f32 v204, v156, v157
 v_mfma_f32_16x16x32_bf16 v[188:191], v[60:63], v[20:23], v[188:191]
 s_waitcnt vmcnt(8)
 s_waitcnt vmcnt(4)
 s_barrier
 s_add_u32 s28, s4, 59310080
 s_addc_u32 s29, s5, 0
 s_mov_b32 s30, 24576
 s_mov_b32 s31, 0x20000
 s_cmp_eq_u32 s32, 0
 s_cbranch_scc0 L_g1_nosig
 s_lshr_b32 s35, s34, 3
 s_lshl_b32 s36, s33, 2
 s_add_u32 s35, s35, s36
 s_add_u32 s35, s35, 72
 s_lshl_b32 s35, s35, 7
 v_mov_b32 v244, s35
 v_mov_b32 v245, 1
 s_mov_b64 s[56:57], exec
 s_mov_b64 exec, 1
 buffer_atomic_add v245, v244, s[28:31], 0 offen sc1
 s_mov_b64 exec, s[56:57]
L_g1_nosig:
 s_nop 0
 s_waitcnt lgkmcnt(2)
 s_nop 1
 v_mfma_f32_16x16x32_bf16 v[160:163], v[40:43], v[24:27], v[160:163]
 ds_read_b128 v[56:59], v2 offset:0
 v_cvt_pk_bf16_f32 v205, v158, v159
 v_mfma_f32_16x16x32_bf16 v[164:167], v[40:43], v[28:31], v[164:167]
 ds_read_b128 v[60:63], v2 offset:1024
 v_mfma_f32_16x16x32_bf16 v[168:171], v[40:43], v[32:35], v[168:171]
 v_mfma_f32_16x16x32_bf16 v[172:175], v[40:43], v[36:39], v[172:175]
 v_mfma_f32_16x16x32_bf16 v[176:179], v[44:47], v[24:27], v[176:179]
 v_mfma_f32_16x16x32_bf16 v[180:183], v[44:47], v[28:31], v[180:183]
 v_mfma_f32_16x16x32_bf16 v[184:187], v[44:47], v[32:35], v[184:187]
 v_mfma_f32_16x16x32_bf16 v[188:191], v[44:47], v[36:39], v[188:191]
 s_waitcnt lgkmcnt(2)
 v_mfma_f32_16x16x32_bf16 v[160:163], v[48:51], v[216:219], v[160:163]
 ds_read_b128 v[40:43], v2 offset:2048
 v_mfma_f32_16x16x32_bf16 v[164:167], v[48:51], v[220:223], v[164:167]
 ds_read_b128 v[44:47], v2 offset:3072
 v_mfma_f32_16x16x32_bf16 v[168:171], v[48:51], v[224:227], v[168:171]
 v_mfma_f32_16x16x32_bf16 v[172:175], v[48:51], v[228:231], v[172:175]
 v_mfma_f32_16x16x32_bf16 v[176:179], v[52:55], v[216:219], v[176:179]
 v_mfma_f32_16x16x32_bf16 v[180:183], v[52:55], v[220:223], v[180:183]
 v_mfma_f32_16x16x32_bf16 v[184:187], v[52:55], v[224:227], v[184:187]
 v_mfma_f32_16x16x32_bf16 v[188:191], v[52:55], v[228:231], v[188:191]
 s_waitcnt lgkmcnt(2)
 v_mfma_f32_16x16x32_bf16 v[64:67], v[56:59], a[0:3], 0
 ds_read_b128 v[48:51], v2 offset:4096
 v_mfma_f32_16x16x32_bf16 v[68:71], v[56:59], a[4:7], 0
 ds_read_b128 v[52:55], v2 offset:5120
 v_mfma_f32_16x16x32_bf16 v[72:75], v[56:59], a[8:11], 0
 v_mfma_f32_16x16x32_bf16 v[76:79], v[56:59], a[12:15], 0
 v_mfma_f32_16x16x32_bf16 v[80:83], v[60:63], a[0:3], 0
 v_mfma_f32_16x16x32_bf16 v[84:87], v[60:63], a[4:7], 0
 v_mfma_f32_16x16x32_bf16 v[88:91], v[60:63], a[8:11], 0
 v_mfma_f32_16x16x32_bf16 v[92:95], v[60:63], a[12:15], 0
 s_waitcnt lgkmcnt(2)
 v_mfma_f32_16x16x32_bf16 v[64:67], v[40:43], a[16:19], v[64:67]
 ds_read_b128 v[56:59], v2 offset:6144
 v_mul_f32 v208, v232, v160
 v_mfma_f32_16x16x32_bf16 v[68:71], v[40:43], a[20:23], v[68:71]
 ds_read_b128 v[60:63], v2 offset:7168
 v_mul_f32 v209, v232, v161
 v_mfma_f32_16x16x32_bf16 v[72:75], v[40:43], a[24:27], v[72:75]
 v_mul_f32 v210, v232, v162
 v_mul_f32 v211, v232, v163
 v_mfma_f32_16x16x32_bf16 v[76:79], v[40:43], a[28:31], v[76:79]
 v_mul_f32 v212, v233, v164
 v_mul_f32 v213, v233, v165
 v_mfma_f32_16x16x32_bf16 v[80:83], v[44:47], a[16:19], v[80:83]
 v_mul_f32 v214, v233, v166
 v_mul_f32 v215, v233, v167
 v_mfma_f32_16x16x32_bf16 v[84:87], v[44:47], a[20:23], v[84:87]
 v_exp_f32 v208, v208
 v_mfma_f32_16x16x32_bf16 v[88:91], v[44:47], a[24:27], v[88:91]
 v_exp_f32 v209, v209
 v_mfma_f32_16x16x32_bf16 v[92:95], v[44:47], a[28:31], v[92:95]
 s_cmp_lt_u32 s2, 8
 s_cbranch_scc0 L_g1_nopf
 s_cmp_eq_u32 s32, 0
 s_cbranch_scc0 L_g1_nopf
 s_getpc_b64 s[84:85]
L_pg_pc1:
 s_add_u32 s84, s84, L_pg_g2-L_pg_pc1
 s_addc_u32 s85, s85, 0
 v_lshlrev_b32 v240, 7, v0
 v_add_u32 v240, 0, v240
 v_min_u32 v240, pg_kernel_codeend-L_pg_g2-4, v240
 v_mov_b32 v241, s85
 v_add_co_u32 v240, vcc, s84, v240
 s_nop 1
 v_addc_co_u32 v241, vcc, 0, v241, vcc
 global_load_dword v243, v[240:241], off
 v_lshlrev_b32 v240, 7, v0
 v_add_u32 v240, 8192, v240
 v_min_u32 v240, pg_kernel_codeend-L_pg_g2-4, v240
 v_mov_b32 v241, s85
 v_add_co_u32 v240, vcc, s84, v240
 s_nop 1
 v_addc_co_u32 v241, vcc, 0, v241, vcc
 global_load_dword v243, v[240:241], off
 v_lshlrev_b32 v240, 7, v0
 v_add_u32 v240, 16384, v240
 v_min_u32 v240, pg_kernel_codeend-L_pg_g2-4, v240
 v_mov_b32 v241, s85
 v_add_co_u32 v240, vcc, s84, v240
 s_nop 1
 v_addc_co_u32 v241, vcc, 0, v241, vcc
 global_load_dword v243, v[240:241], off
 v_lshlrev_b32 v240, 7, v0
 v_add_u32 v240, 24576, v240
 v_min_u32 v240, pg_kernel_codeend-L_pg_g2-4, v240
 v_mov_b32 v241, s85
 v_add_co_u32 v240, vcc, s84, v240
 s_nop 1
 v_addc_co_u32 v241, vcc, 0, v241, vcc
 global_load_dword v243, v[240:241], off
 v_lshlrev_b32 v240, 7, v0
 v_add_u32 v240, 32768, v240
 v_min_u32 v240, pg_kernel_codeend-L_pg_g2-4, v240
 v_mov_b32 v241, s85
 v_add_co_u32 v240, vcc, s84, v240
 s_nop 1
 v_addc_co_u32 v241, vcc, 0, v241, vcc
 global_load_dword v243, v[240:241], off
 v_lshlrev_b32 v240, 7, v0
 v_add_u32 v240, 40960, v240
 v_min_u32 v240, pg_kernel_codeend-L_pg_g2-4, v240
 v_mov_b32 v241, s85
 v_add_co_u32 v240, vcc, s84, v240
 s_nop 1
 v_addc_co_u32 v241, vcc, 0, v241, vcc
 global_load_dword v243, v[240:241], off
 v_lshlrev_b32 v240, 7, v0
 v_add_u32 v240, 49152, v240
 v_min_u32 v240, pg_kernel_codeend-L_pg_g2-4, v240
 v_mov_b32 v241, s85
 v_add_co_u32 v240, vcc, s84, v240
 s_nop 1
 v_addc_co_u32 v241, vcc, 0, v241, vcc
 global_load_dword v243, v[240:241], off
L_g1_nopf:
 s_nop 0
 s_waitcnt lgkmcnt(2)
 v_mfma_f32_16x16x32_bf16 v[64:67], v[48:51], a[32:35], v[64:67]
 ds_read_b128 v[40:43], v2 offset:8192
 v_mfma_f32_16x16x32_bf16 v[68:71], v[48:51], a[36:39], v[68:71]
 ds_read_b128 v[44:47], v2 offset:9216
 v_mfma_f32_16x16x32_bf16 v[72:75], v[48:51], a[40:43], v[72:75]
 v_exp_f32 v210, v210
 v_mfma_f32_16x16x32_bf16 v[76:79], v[48:51], a[44:47], v[76:79]
 v_exp_f32 v211, v211
 v_mfma_f32_16x16x32_bf16 v[80:83], v[52:55], a[32:35], v[80:83]
 v_exp_f32 v212, v212
 v_mfma_f32_16x16x32_bf16 v[84:87], v[52:55], a[36:39], v[84:87]
 v_exp_f32 v213, v213
 v_mfma_f32_16x16x32_bf16 v[88:91], v[52:55], a[40:43], v[88:91]
 v_exp_f32 v214, v214
 v_mfma_f32_16x16x32_bf16 v[92:95], v[52:55], a[44:47], v[92:95]
 v_exp_f32 v215, v215
 s_waitcnt lgkmcnt(2)
 v_mfma_f32_16x16x32_bf16 v[64:67], v[56:59], a[48:51], v[64:67]
 ds_read_b128 v[48:51], v2 offset:10240
 v_mul_f32 v176, v160, v176
 v_mfma_f32_16x16x32_bf16 v[68:71], v[56:59], a[52:55], v[68:71]
 ds_read_b128 v[52:55], v2 offset:11264
 v_mul_f32 v177, v161, v177
 v_mfma_f32_16x16x32_bf16 v[72:75], v[56:59], a[56:59], v[72:75]
 v_mul_f32 v178, v162, v178
 v_mul_f32 v179, v163, v179
 v_mfma_f32_16x16x32_bf16 v[76:79], v[56:59], a[60:63], v[76:79]
 v_mul_f32 v180, v164, v180
 v_mul_f32 v181, v165, v181
 v_mfma_f32_16x16x32_bf16 v[80:83], v[60:63], a[48:51], v[80:83]
 v_mul_f32 v182, v166, v182
 v_mul_f32 v183, v167, v183
 v_mfma_f32_16x16x32_bf16 v[84:87], v[60:63], a[52:55], v[84:87]
 v_fma_f32 v208, v208, v236, v236
 v_fma_f32 v209, v209, v236, v236
 v_mfma_f32_16x16x32_bf16 v[88:91], v[60:63], a[56:59], v[88:91]
 v_fma_f32 v210, v210, v236, v236
 v_mfma_f32_16x16x32_bf16 v[92:95], v[60:63], a[60:63], v[92:95]
 s_waitcnt lgkmcnt(2)
 v_mfma_f32_16x16x32_bf16 v[64:67], v[40:43], a[64:67], v[64:67]
 ds_read_b128 v[56:59], v2 offset:12288
 v_fma_f32 v211, v211, v236, v236
 v_mfma_f32_16x16x32_bf16 v[68:71], v[40:43], a[68:71], v[68:71]
 ds_read_b128 v[60:63], v2 offset:13312
 v_fma_f32 v212, v212, v237, v237
 v_mfma_f32_16x16x32_bf16 v[72:75], v[40:43], a[72:75], v[72:75]
 v_fma_f32 v213, v213, v237, v237
 v_fma_f32 v214, v214, v237, v237
 v_mfma_f32_16x16x32_bf16 v[76:79], v[40:43], a[76:79], v[76:79]
 v_fma_f32 v215, v215, v237, v237
 v_mfma_f32_16x16x32_bf16 v[80:83], v[44:47], a[64:67], v[80:83]
 v_rcp_f32 v208, v208
 v_mfma_f32_16x16x32_bf16 v[84:87], v[44:47], a[68:71], v[84:87]
 v_rcp_f32 v209, v209
 v_mfma_f32_16x16x32_bf16 v[88:91], v[44:47], a[72:75], v[88:91]
 v_rcp_f32 v210, v210
 v_mfma_f32_16x16x32_bf16 v[92:95], v[44:47], a[76:79], v[92:95]
 s_waitcnt lgkmcnt(2)
 v_mfma_f32_16x16x32_bf16 v[64:67], v[48:51], a[80:83], v[64:67]
 ds_read_b128 v[40:43], v2 offset:14336
 v_mfma_f32_16x16x32_bf16 v[68:71], v[48:51], a[84:87], v[68:71]
 ds_read_b128 v[44:47], v2 offset:15360
 v_mfma_f32_16x16x32_bf16 v[72:75], v[48:51], a[88:91], v[72:75]
 v_rcp_f32 v211, v211
 v_mfma_f32_16x16x32_bf16 v[76:79], v[48:51], a[92:95], v[76:79]
 v_rcp_f32 v212, v212
 v_mfma_f32_16x16x32_bf16 v[80:83], v[52:55], a[80:83], v[80:83]
 v_rcp_f32 v213, v213
 v_mfma_f32_16x16x32_bf16 v[84:87], v[52:55], a[84:87], v[84:87]
 v_rcp_f32 v214, v214
 v_mfma_f32_16x16x32_bf16 v[88:91], v[52:55], a[88:91], v[88:91]
 v_rcp_f32 v215, v215
 v_mfma_f32_16x16x32_bf16 v[92:95], v[52:55], a[92:95], v[92:95]
 v_mul_f32 v176, v176, v208
 s_waitcnt lgkmcnt(2)
 v_mfma_f32_16x16x32_bf16 v[64:67], v[56:59], a[96:99], v[64:67]
 ds_read_b128 v[48:51], v2 offset:16384
 v_mul_f32 v177, v177, v209
 v_mfma_f32_16x16x32_bf16 v[68:71], v[56:59], a[100:103], v[68:71]
 ds_read_b128 v[52:55], v2 offset:17408
 v_mul_f32 v178, v178, v210
 v_mfma_f32_16x16x32_bf16 v[72:75], v[56:59], a[104:107], v[72:75]
 v_mul_f32 v179, v179, v211
 v_mul_f32 v180, v180, v212
 v_mfma_f32_16x16x32_bf16 v[76:79], v[56:59], a[108:111], v[76:79]
 v_mul_f32 v181, v181, v213
 v_mul_f32 v182, v182, v214
 v_mfma_f32_16x16x32_bf16 v[80:83], v[60:63], a[96:99], v[80:83]
 v_mul_f32 v183, v183, v215
 v_cvt_pk_bf16_f32 v194, v176, v177
 v_mfma_f32_16x16x32_bf16 v[84:87], v[60:63], a[100:103], v[84:87]
 v_cvt_pk_bf16_f32 v195, v178, v179
 v_cvt_pk_bf16_f32 v198, v180, v181
 v_mfma_f32_16x16x32_bf16 v[88:91], v[60:63], a[104:107], v[88:91]
 v_cvt_pk_bf16_f32 v199, v182, v183
 v_mfma_f32_16x16x32_bf16 v[92:95], v[60:63], a[108:111], v[92:95]
 s_and_b32 s35, s2, 1
 s_lshl_b32 s35, s35, 2
 s_bfe_u32 s36, s2, 0x20004
 s_add_u32 s35, s35, s36
 s_lshl_b32 s35, s35, 2
 s_bfe_u32 s36, s2, 0x20001
 s_add_u32 s35, s35, s36
 s_add_u32 s35, s35, 72
 s_lshl_b32 s35, s35, 7
 v_mov_b32 v246, s35
 s_mov_b64 s[56:57], exec
 s_mov_b64 exec, 1
 buffer_load_dword v247, v246, s[28:31], 0 offen sc1
 s_mov_b64 exec, s[56:57]
 s_waitcnt lgkmcnt(2)
 s_nop 2
 v_mfma_f32_16x16x32_bf16 v[64:67], v[40:43], a[112:115], v[64:67]
 ds_read_b128 v[56:59], v2 offset:18432
 v_mul_f32 v208, v234, v168
 v_mfma_f32_16x16x32_bf16 v[68:71], v[40:43], a[116:119], v[68:71]
 ds_read_b128 v[60:63], v2 offset:19456
 v_mul_f32 v209, v234, v169
 v_mfma_f32_16x16x32_bf16 v[72:75], v[40:43], a[120:123], v[72:75]
 v_mul_f32 v210, v234, v170
 v_mul_f32 v211, v234, v171
 v_mfma_f32_16x16x32_bf16 v[76:79], v[40:43], a[124:127], v[76:79]
 v_mul_f32 v212, v235, v172
 v_mul_f32 v213, v235, v173
 v_mfma_f32_16x16x32_bf16 v[80:83], v[44:47], a[112:115], v[80:83]
 v_mul_f32 v214, v235, v174
 v_mul_f32 v215, v235, v175
 v_mfma_f32_16x16x32_bf16 v[84:87], v[44:47], a[116:119], v[84:87]
 v_exp_f32 v208, v208
 v_mfma_f32_16x16x32_bf16 v[88:91], v[44:47], a[120:123], v[88:91]
 v_exp_f32 v209, v209
 v_mfma_f32_16x16x32_bf16 v[92:95], v[44:47], a[124:127], v[92:95]
 s_waitcnt lgkmcnt(2)
 v_mfma_f32_16x16x32_bf16 v[64:67], v[48:51], a[128:131], v[64:67]
 ds_read_b128 v[40:43], v2 offset:20480
 v_mfma_f32_16x16x32_bf16 v[68:71], v[48:51], a[132:135], v[68:71]
 ds_read_b128 v[44:47], v2 offset:21504
 v_mfma_f32_16x16x32_bf16 v[72:75], v[48:51], a[136:139], v[72:75]
 v_exp_f32 v210, v210
 v_mfma_f32_16x16x32_bf16 v[76:79], v[48:51], a[140:143], v[76:79]
 v_exp_f32 v211, v211
 v_mfma_f32_16x16x32_bf16 v[80:83], v[52:55], a[128:131], v[80:83]
 v_exp_f32 v212, v212
 v_mfma_f32_16x16x32_bf16 v[84:87], v[52:55], a[132:135], v[84:87]
 v_exp_f32 v213, v213
 v_mfma_f32_16x16x32_bf16 v[88:91], v[52:55], a[136:139], v[88:91]
 v_exp_f32 v214, v214
 v_mfma_f32_16x16x32_bf16 v[92:95], v[52:55], a[140:143], v[92:95]
 v_exp_f32 v215, v215
 s_waitcnt lgkmcnt(2)
 v_mfma_f32_16x16x32_bf16 v[64:67], v[56:59], a[144:147], v[64:67]
 ds_read_b128 v[48:51], v2 offset:22528
 v_mul_f32 v184, v168, v184
 v_mfma_f32_16x16x32_bf16 v[68:71], v[56:59], a[148:151], v[68:71]
 ds_read_b128 v[52:55], v2 offset:23552
 v_mul_f32 v185, v169, v185
 v_mfma_f32_16x16x32_bf16 v[72:75], v[56:59], a[152:155], v[72:75]
 v_mul_f32 v186, v170, v186
 v_mul_f32 v187, v171, v187
 v_mfma_f32_16x16x32_bf16 v[76:79], v[56:59], a[156:159], v[76:79]
 v_mul_f32 v188, v172, v188
 v_mul_f32 v189, v173, v189
 v_mfma_f32_16x16x32_bf16 v[80:83], v[60:63], a[144:147], v[80:83]
 v_mul_f32 v190, v174, v190
 v_mul_f32 v191, v175, v191
 v_mfma_f32_16x16x32_bf16 v[84:87], v[60:63], a[148:151], v[84:87]
 v_fma_f32 v208, v208, v238, v238
 v_fma_f32 v209, v209, v238, v238
 v_mfma_f32_16x16x32_bf16 v[88:91], v[60:63], a[152:155], v[88:91]
 v_fma_f32 v210, v210, v238, v238
 v_mfma_f32_16x16x32_bf16 v[92:95], v[60:63], a[156:159], v[92:95]
 s_waitcnt lgkmcnt(2)
 v_mfma_f32_16x16x32_bf16 v[64:67], v[40:43], a[160:163], v[64:67]
 ds_read_b128 v[56:59], v2 offset:24576
 v_fma_f32 v211, v211, v238, v238
 v_mfma_f32_16x16x32_bf16 v[68:71], v[40:43], a[164:167], v[68:71]
 ds_read_b128 v[60:63], v2 offset:25600
 v_fma_f32 v212, v212, v239, v239
 v_mfma_f32_16x16x32_bf16 v[72:75], v[40:43], a[168:171], v[72:75]
 v_fma_f32 v213, v213, v239, v239
 v_fma_f32 v214, v214, v239, v239
 v_mfma_f32_16x16x32_bf16 v[76:79], v[40:43], a[172:175], v[76:79]
 v_fma_f32 v215, v215, v239, v239
 v_mfma_f32_16x16x32_bf16 v[80:83], v[44:47], a[160:163], v[80:83]
 v_rcp_f32 v208, v208
 v_mfma_f32_16x16x32_bf16 v[84:87], v[44:47], a[164:167], v[84:87]
 v_rcp_f32 v209, v209
 v_mfma_f32_16x16x32_bf16 v[88:91], v[44:47], a[168:171], v[88:91]
 v_rcp_f32 v210, v210
 v_mfma_f32_16x16x32_bf16 v[92:95], v[44:47], a[172:175], v[92:95]
 s_waitcnt lgkmcnt(2)
 v_mfma_f32_16x16x32_bf16 v[64:67], v[48:51], a[176:179], v[64:67]
 ds_read_b128 v[40:43], v2 offset:26624
 v_mfma_f32_16x16x32_bf16 v[68:71], v[48:51], a[180:183], v[68:71]
 ds_read_b128 v[44:47], v2 offset:27648
 v_mfma_f32_16x16x32_bf16 v[72:75], v[48:51], a[184:187], v[72:75]
 v_rcp_f32 v211, v211
 v_mfma_f32_16x16x32_bf16 v[76:79], v[48:51], a[188:191], v[76:79]
 v_rcp_f32 v212, v212
 v_mfma_f32_16x16x32_bf16 v[80:83], v[52:55], a[176:179], v[80:83]
 v_rcp_f32 v213, v213
 v_mfma_f32_16x16x32_bf16 v[84:87], v[52:55], a[180:183], v[84:87]
 v_rcp_f32 v214, v214
 v_mfma_f32_16x16x32_bf16 v[88:91], v[52:55], a[184:187], v[88:91]
 v_rcp_f32 v215, v215
 v_mfma_f32_16x16x32_bf16 v[92:95], v[52:55], a[188:191], v[92:95]
 v_mul_f32 v184, v184, v208
 s_waitcnt lgkmcnt(2)
 v_mfma_f32_16x16x32_bf16 v[64:67], v[56:59], a[192:195], v[64:67]
 ds_read_b128 v[48:51], v2 offset:28672
 v_mul_f32 v185, v185, v209
 v_mfma_f32_16x16x32_bf16 v[68:71], v[56:59], a[196:199], v[68:71]
 ds_read_b128 v[52:55], v2 offset:29696
 v_mul_f32 v186, v186, v210
 v_mfma_f32_16x16x32_bf16 v[72:75], v[56:59], a[200:203], v[72:75]
 v_mul_f32 v187, v187, v211
 v_mul_f32 v188, v188, v212
 v_mfma_f32_16x16x32_bf16 v[76:79], v[56:59], a[204:207], v[76:79]
 v_mul_f32 v189, v189, v213
 v_mul_f32 v190, v190, v214
 v_mfma_f32_16x16x32_bf16 v[80:83], v[60:63], a[192:195], v[80:83]
 v_mul_f32 v191, v191, v215
 v_cvt_pk_bf16_f32 v202, v184, v185
 v_mfma_f32_16x16x32_bf16 v[84:87], v[60:63], a[196:199], v[84:87]
 v_cvt_pk_bf16_f32 v203, v186, v187
 v_cvt_pk_bf16_f32 v206, v188, v189
 v_mfma_f32_16x16x32_bf16 v[88:91], v[60:63], a[200:203], v[88:91]
 v_cvt_pk_bf16_f32 v207, v190, v191
 v_mfma_f32_16x16x32_bf16 v[92:95], v[60:63], a[204:207], v[92:95]
 s_waitcnt lgkmcnt(2)
 v_mfma_f32_16x16x32_bf16 v[64:67], v[40:43], a[208:211], v[64:67]
 ds_read_b128 v[56:59], v2 offset:30720
 v_mfma_f32_16x16x32_bf16 v[68:71], v[40:43], a[212:215], v[68:71]
 ds_read_b128 v[60:63], v2 offset:31744
 v_mfma_f32_16x16x32_bf16 v[72:75], v[40:43], a[216:219], v[72:75]
 s_lshl_b32 s47, s34, 2
 s_add_u32 s47, s47, 3
 s_lshl_b32 s47, s47, 10
 s_add_u32 s47, s47, s46
 buffer_store_dwordx4 v[192:195], v1, s[20:23], s47 offen sc1
 v_mfma_f32_16x16x32_bf16 v[76:79], v[40:43], a[220:223], v[76:79]
 s_add_u32 s47, s47, 147456
 buffer_store_dwordx4 v[196:199], v1, s[20:23], s47 offen sc1
 v_mfma_f32_16x16x32_bf16 v[80:83], v[44:47], a[208:211], v[80:83]
 s_add_u32 s47, s47, 147456
 buffer_store_dwordx4 v[200:203], v1, s[20:23], s47 offen sc1
 v_mfma_f32_16x16x32_bf16 v[84:87], v[44:47], a[212:215], v[84:87]
 s_add_u32 s47, s47, 147456
 buffer_store_dwordx4 v[204:207], v1, s[20:23], s47 offen sc1
 v_mfma_f32_16x16x32_bf16 v[88:91], v[44:47], a[216:219], v[88:91]
 v_mfma_f32_16x16x32_bf16 v[92:95], v[44:47], a[220:223], v[92:95]
 s_waitcnt lgkmcnt(2)
 v_mfma_f32_16x16x32_bf16 v[64:67], v[48:51], a[224:227], v[64:67]
 ds_read_b128 v[40:43], v2 offset:32768
 v_mfma_f32_16x16x32_bf16 v[68:71], v[48:51], a[228:231], v[68:71]
 ds_read_b128 v[44:47], v2 offset:33792
 v_mfma_f32_16x16x32_bf16 v[72:75], v[48:51], a[232:235], v[72:75]
 v_mfma_f32_16x16x32_bf16 v[76:79], v[48:51], a[236:239], v[76:79]
 v_mfma_f32_16x16x32_bf16 v[80:83], v[52:55], a[224:227], v[80:83]
 v_mfma_f32_16x16x32_bf16 v[84:87], v[52:55], a[228:231], v[84:87]
 v_mfma_f32_16x16x32_bf16 v[88:91], v[52:55], a[232:235], v[88:91]
 v_mfma_f32_16x16x32_bf16 v[92:95], v[52:55], a[236:239], v[92:95]
 s_waitcnt lgkmcnt(2)
 v_mfma_f32_16x16x32_bf16 v[64:67], v[56:59], a[240:243], v[64:67]
 ds_read_b128 v[48:51], v2 offset:34816
 v_mfma_f32_16x16x32_bf16 v[68:71], v[56:59], a[244:247], v[68:71]
 ds_read_b128 v[52:55], v2 offset:35840
 v_mfma_f32_16x16x32_bf16 v[72:75], v[56:59], a[248:251], v[72:75]
 v_mfma_f32_16x16x32_bf16 v[76:79], v[56:59], a[252:255], v[76:79]
 v_mfma_f32_16x16x32_bf16 v[80:83], v[60:63], a[240:243], v[80:83]
 v_mfma_f32_16x16x32_bf16 v[84:87], v[60:63], a[244:247], v[84:87]
 v_mfma_f32_16x16x32_bf16 v[88:91], v[60:63], a[248:251], v[88:91]
 v_mfma_f32_16x16x32_bf16 v[92:95], v[60:63], a[252:255], v[92:95]
 s_waitcnt vmcnt(4)
 v_readfirstlane_b32 s35, v247
 s_nop 0
 s_cmp_ge_u32 s35, 8
 s_cbranch_scc1 L_g1_early
 s_mov_b32 s36, 0
 s_mov_b64 s[56:57], exec
 s_mov_b64 exec, 1
L_g1_espin:
 buffer_load_dword v247, v246, s[28:31], 0 offen sc1
 s_waitcnt vmcnt(0)
 v_readfirstlane_b32 s35, v247
 s_nop 0
 s_cmp_ge_u32 s35, 8
 s_cbranch_scc1 L_g1_edone
 s_add_u32 s36, s36, 1
 s_cmp_lt_u32 s36, 0x100000
 s_cbranch_scc0 L_g1_edone
 s_sleep 2
 s_branch L_g1_espin
L_g1_edone:
 s_mov_b64 exec, s[56:57]
L_g1_early:
 s_nop 0
 s_waitcnt lgkmcnt(2)
 s_nop 1
 v_mfma_f32_16x16x32_bf16 v[64:67], v[40:43], v[8:11], v[64:67]
 ds_read_b128 v[56:59], v2 offset:36864
 v_mfma_f32_16x16x32_bf16 v[68:71], v[40:43], v[12:15], v[68:71]
 ds_read_b128 v[60:63], v2 offset:37888
 v_mfma_f32_16x16x32_bf16 v[72:75], v[40:43], v[16:19], v[72:75]
 v_mfma_f32_16x16x32_bf16 v[76:79], v[40:43], v[20:23], v[76:79]
 v_mfma_f32_16x16x32_bf16 v[80:83], v[44:47], v[8:11], v[80:83]
 v_mfma_f32_16x16x32_bf16 v[84:87], v[44:47], v[12:15], v[84:87]
 v_mfma_f32_16x16x32_bf16 v[88:91], v[44:47], v[16:19], v[88:91]
 v_mfma_f32_16x16x32_bf16 v[92:95], v[44:47], v[20:23], v[92:95]
 s_waitcnt lgkmcnt(2)
 v_mfma_f32_16x16x32_bf16 v[64:67], v[48:51], v[24:27], v[64:67]
 v_mfma_f32_16x16x32_bf16 v[68:71], v[48:51], v[28:31], v[68:71]
 v_mfma_f32_16x16x32_bf16 v[72:75], v[48:51], v[32:35], v[72:75]
 v_mfma_f32_16x16x32_bf16 v[76:79], v[48:51], v[36:39], v[76:79]
 v_mfma_f32_16x16x32_bf16 v[80:83], v[52:55], v[24:27], v[80:83]
 v_mfma_f32_16x16x32_bf16 v[84:87], v[52:55], v[28:31], v[84:87]
 v_mfma_f32_16x16x32_bf16 v[88:91], v[52:55], v[32:35], v[88:91]
 v_mfma_f32_16x16x32_bf16 v[92:95], v[52:55], v[36:39], v[92:95]
 s_waitcnt lgkmcnt(0)
 v_mfma_f32_16x16x32_bf16 v[64:67], v[56:59], v[216:219], v[64:67]
 v_mfma_f32_16x16x32_bf16 v[68:71], v[56:59], v[220:223], v[68:71]
 v_mfma_f32_16x16x32_bf16 v[72:75], v[56:59], v[224:227], v[72:75]
 v_mfma_f32_16x16x32_bf16 v[76:79], v[56:59], v[228:231], v[76:79]
 v_mfma_f32_16x16x32_bf16 v[80:83], v[60:63], v[216:219], v[80:83]
 v_mfma_f32_16x16x32_bf16 v[84:87], v[60:63], v[220:223], v[84:87]
 v_mfma_f32_16x16x32_bf16 v[88:91], v[60:63], v[224:227], v[88:91]
 v_mfma_f32_16x16x32_bf16 v[92:95], v[60:63], v[228:231], v[92:95]
 s_barrier
 s_nop 7
 v_mul_f32 v208, v232, v64
 v_mul_f32 v209, v232, v65
 v_mul_f32 v210, v232, v66
 v_mul_f32 v211, v232, v67
 v_mul_f32 v212, v233, v68
 v_mul_f32 v213, v233, v69
 v_mul_f32 v214, v233, v70
 v_mul_f32 v215, v233, v71
 v_exp_f32 v208, v208
 v_exp_f32 v209, v209
 v_exp_f32 v210, v210
 v_exp_f32 v211, v211
 v_exp_f32 v212, v212
 v_exp_f32 v213, v213
 v_exp_f32 v214, v214
 v_exp_f32 v215, v215
 v_mul_f32 v80, v64, v80
 v_mul_f32 v81, v65, v81
 v_mul_f32 v82, v66, v82
 v_mul_f32 v83, v67, v83
 v_mul_f32 v84, v68, v84
 v_mul_f32 v85, v69, v85
 v_mul_f32 v86, v70, v86
 v_mul_f32 v87, v71, v87
 v_fma_f32 v208, v208, v236, v236
 v_fma_f32 v209, v209, v236, v236
 v_fma_f32 v210, v210, v236, v236
 v_fma_f32 v211, v211, v236, v236
 v_fma_f32 v212, v212, v237, v237
 v_fma_f32 v213, v213, v237, v237
 v_fma_f32 v214, v214, v237, v237
 v_fma_f32 v215, v215, v237, v237
 v_rcp_f32 v208, v208
 v_rcp_f32 v209, v209
 v_rcp_f32 v210, v210
 v_rcp_f32 v211, v211
 v_rcp_f32 v212, v212
 v_rcp_f32 v213, v213
 v_rcp_f32 v214, v214
 v_rcp_f32 v215, v215
 v_mul_f32 v80, v80, v208
 v_mul_f32 v81, v81, v209
 v_mul_f32 v82, v82, v210
 v_mul_f32 v83, v83, v211
 v_mul_f32 v84, v84, v212
 v_mul_f32 v85, v85, v213
 v_mul_f32 v86, v86, v214
 v_mul_f32 v87, v87, v215
 v_cvt_pk_bf16_f32 v192, v80, v81
 v_cvt_pk_bf16_f32 v193, v82, v83
 v_cvt_pk_bf16_f32 v196, v84, v85
 v_cvt_pk_bf16_f32 v197, v86, v87
 v_mul_f32 v208, v234, v72
 v_mul_f32 v209, v234, v73
 v_mul_f32 v210, v234, v74
 v_mul_f32 v211, v234, v75
 v_mul_f32 v212, v235, v76
 v_mul_f32 v213, v235, v77
 v_mul_f32 v214, v235, v78
 v_mul_f32 v215, v235, v79
 v_exp_f32 v208, v208
 v_exp_f32 v209, v209
 v_exp_f32 v210, v210
 v_exp_f32 v211, v211
 v_exp_f32 v212, v212
 v_exp_f32 v213, v213
 v_exp_f32 v214, v214
 v_exp_f32 v215, v215
 v_mul_f32 v88, v72, v88
 v_mul_f32 v89, v73, v89
 v_mul_f32 v90, v74, v90
 v_mul_f32 v91, v75, v91
 v_mul_f32 v92, v76, v92
 v_mul_f32 v93, v77, v93
 v_mul_f32 v94, v78, v94
 v_mul_f32 v95, v79, v95
 v_fma_f32 v208, v208, v238, v238
 v_fma_f32 v209, v209, v238, v238
 v_fma_f32 v210, v210, v238, v238
 v_fma_f32 v211, v211, v238, v238
 v_fma_f32 v212, v212, v239, v239
 v_fma_f32 v213, v213, v239, v239
 v_fma_f32 v214, v214, v239, v239
 v_fma_f32 v215, v215, v239, v239
 v_rcp_f32 v208, v208
 v_rcp_f32 v209, v209
 v_rcp_f32 v210, v210
 v_rcp_f32 v211, v211
 v_rcp_f32 v212, v212
 v_rcp_f32 v213, v213
 v_rcp_f32 v214, v214
 v_rcp_f32 v215, v215
 v_mul_f32 v88, v88, v208
 v_mul_f32 v89, v89, v209
 v_mul_f32 v90, v90, v210
 v_mul_f32 v91, v91, v211
 v_mul_f32 v92, v92, v212
 v_mul_f32 v93, v93, v213
 v_mul_f32 v94, v94, v214
 v_mul_f32 v95, v95, v215
 v_cvt_pk_bf16_f32 v200, v88, v89
 v_cvt_pk_bf16_f32 v201, v90, v91
 v_cvt_pk_bf16_f32 v204, v92, v93
 v_cvt_pk_bf16_f32 v205, v94, v95
 s_lshr_b32 s47, s34, 1
 s_add_u32 s47, s47, 128
 s_lshl_b32 s47, s47, 10
 s_add_u32 s47, s47, s46
 buffer_store_dwordx2 v[192:193], v6, s[20:23], s47 offen sc1
 s_add_u32 s47, s47, 147456
 buffer_store_dwordx2 v[196:197], v6, s[20:23], s47 offen sc1
 s_add_u32 s47, s47, 147456
 buffer_store_dwordx2 v[200:201], v6, s[20:23], s47 offen sc1
 s_add_u32 s47, s47, 147456
 buffer_store_dwordx2 v[204:205], v6, s[20:23], s47 offen sc1
 s_mov_b32 s78, s33
 s_mov_b32 s79, s34
L_pg_g2:
 s_load_dwordx2 s[6:7], s[0:1], 72
 v_lshlrev_b32 v1, 4, v0
 v_add_u32 v2, 0, v1
 v_add_u32 v3, 36864, v1
 v_add_u32 v4, 73728, v1
 v_add_u32 v5, 110592, v1
 s_lshr_b32 s35, s2, 1
 s_and_b32 s35, s35, 3
 s_and_b32 s39, s2, 1
 s_lshl_b32 s33, s39, 3
 s_lshr_b32 s39, s2, 3
 s_and_b32 s40, s39, 7
 s_add_u32 s33, s33, s40
 s_lshr_b32 s34, s39, 3
 s_lshl_b32 s57, s33, 3
 s_lshl_b32 s40, s32, 1
 s_add_u32 s57, s57, s40
 s_mul_i32 s37, s57, 147456
 s_mul_i32 s41, s34, 9216
 s_lshr_b32 s39, s32, 1
 s_lshl_b32 s39, s39, 2
 s_and_b32 s40, s32, 1
 s_add_u32 s39, s39, s40
 s_mul_i32 s39, s39, 36864
 s_add_u32 s36, s41, s39
 s_mul_i32 s39, s32, 36864
 s_add_u32 s38, s41, s39
 s_mul_i32 s80, s32, 3
 s_lshl_b32 s42, s33, 2
 s_add_u32 s42, s42, s34
 s_mul_i32 s58, s34, 9
 s_lshl_b32 s39, s35, 1
 s_add_u32 s58, s58, s39
 s_lshl_b32 s39, s42, 7
 v_mov_b32 v6, s39
 s_waitcnt lgkmcnt(0)
 s_add_u32 s12, s4, 44433408
 s_addc_u32 s13, s5, 0
 s_mov_b32 s14, 5308416
 s_mov_b32 s15, 0x20000
 s_add_u32 s16, s4, 14352384
 s_addc_u32 s17, s5, 0
 s_mov_b32 s18, 18874368
 s_mov_b32 s19, 0x20000
 s_add_u32 s24, s4, 59375616
 s_addc_u32 s25, s5, 0
 s_mov_b32 s26, 16777216
 s_mov_b32 s27, 0x20000
 s_add_u32 s28, s4, 59310080
 s_addc_u32 s29, s5, 0
 s_mov_b32 s30, 24576
 s_mov_b32 s31, 0x20000
 s_add_u32 s44, s4, 9633792
 s_addc_u32 s45, s5, 0
 s_mov_b32 s46, 2359296
 s_mov_b32 s47, 0x20000
 s_mov_b32 s48, s4
 s_mov_b32 s49, s5
 s_mov_b32 s50, 13824
 s_mov_b32 s51, 0x20000
 s_mov_b32 s52, s6
 s_mov_b32 s53, s7
 s_mov_b32 s54, 2359296
 s_mov_b32 s55, 0x20000
 s_cmp_eq_u32 s35, 0
 s_cbranch_scc1 L_g2_v0
 s_cmp_eq_u32 s35, 1
 s_cbranch_scc1 L_g2_v1
 s_cmp_eq_u32 s35, 2
 s_cbranch_scc1 L_g2_v2
 s_branch L_g2_v3
L_g2_v0:
 s_mul_i32 s39, s32, 7168
 s_add_u32 m0, s39, 0
 s_add_u32 s40, s36, 2048
 buffer_load_dwordx4 v1, s[12:15], s40 offen offset:0 lds
 buffer_load_dwordx4 v1, s[12:15], s40 offen offset:1024 lds
 buffer_load_dwordx4 v1, s[12:15], s40 offen offset:2048 lds
 buffer_load_dwordx4 v1, s[12:15], s40 offen offset:3072 lds
 s_mul_i32 s39, s32, 7168
 s_add_u32 m0, s39, 4096
 s_add_u32 s40, s36, 6144
 buffer_load_dwordx4 v1, s[12:15], s40 offen offset:0 lds
 buffer_load_dwordx4 v1, s[12:15], s40 offen offset:1024 lds
 buffer_load_dwordx4 v1, s[12:15], s40 offen offset:2048 lds
 s_add_u32 s87, s37, 0
 buffer_load_dwordx4 a[0:3], v1, s[16:19], s87 offen sc1
 s_add_u32 s87, s37, 147456
 buffer_load_dwordx4 a[4:7], v1, s[16:19], s87 offen sc1
 s_add_u32 s87, s37, 1024
 buffer_load_dwordx4 a[8:11], v1, s[16:19], s87 offen sc1
 s_add_u32 s87, s37, 148480
 buffer_load_dwordx4 a[12:15], v1, s[16:19], s87 offen sc1
 s_waitcnt vmcnt(4)
 s_barrier
 s_cmp_eq_u32 s32, 0
 s_cbranch_scc0 L_g2_nolate0
 s_lshr_b32 s39, s79, 3
 s_lshl_b32 s40, s78, 2
 s_add_u32 s39, s39, s40
 s_add_u32 s39, s39, 128
 s_lshl_b32 s39, s39, 7
 v_mov_b32 v226, s39
 v_mov_b32 v225, 1
 s_mov_b64 s[76:77], exec
 s_mov_b64 exec, 1
 buffer_atomic_add v225, v226, s[28:31], 0 offen sc1
 s_mov_b64 exec, s[76:77]
L_g2_nolate0:
 s_lshr_b32 s39, s33, 1
 s_lshl_b32 s39, s39, 2
 s_add_u32 s39, s39, 128
 s_lshl_b32 s39, s39, 7
 v_mov_b32 v229, s39
 ds_read_b128 v[112:115], v2 offset:0
 ds_read_b128 v[116:119], v2 offset:1024
 ds_read_b128 v[120:123], v2 offset:2048
 ds_read_b128 v[124:127], v2 offset:3072
 ds_read_b128 v[128:131], v2 offset:4096
 ds_read_b128 v[132:135], v2 offset:5120
 ds_read_b128 v[136:139], v2 offset:6144
 s_waitcnt lgkmcnt(0)
 s_waitcnt vmcnt(2)
 v_mfma_f32_16x16x32_bf16 v[48:51], v[112:115], a[0:3], 0
 ds_read_b128 v[140:143], v2 offset:7168
 ds_read_b128 v[144:147], v2 offset:8192
 v_mfma_f32_16x16x32_bf16 v[84:87], v[112:115], a[4:7], 0
 ds_read_b128 v[148:151], v2 offset:9216
 v_mfma_f32_16x16x32_bf16 v[52:55], v[116:119], a[0:3], 0
 ds_read_b128 v[152:155], v2 offset:10240
 v_mfma_f32_16x16x32_bf16 v[88:91], v[116:119], a[4:7], 0
 ds_read_b128 v[156:159], v2 offset:11264
 ds_read_b128 v[160:163], v2 offset:12288
 v_mfma_f32_16x16x32_bf16 v[56:59], v[120:123], a[0:3], 0
 ds_read_b128 v[164:167], v2 offset:13312
 v_mfma_f32_16x16x32_bf16 v[92:95], v[120:123], a[4:7], 0
 s_mul_i32 s39, s32, 7168
 s_add_u32 m0, s39, 36864
 s_add_u32 s40, s36, 296960
 buffer_load_dwordx4 v1, s[12:15], s40 offen offset:0 lds
 v_mfma_f32_16x16x32_bf16 v[60:63], v[124:127], a[0:3], 0
 buffer_load_dwordx4 v1, s[12:15], s40 offen offset:1024 lds
 v_mfma_f32_16x16x32_bf16 v[96:99], v[124:127], a[4:7], 0
 buffer_load_dwordx4 v1, s[12:15], s40 offen offset:2048 lds
 buffer_load_dwordx4 v1, s[12:15], s40 offen offset:3072 lds
 v_mfma_f32_16x16x32_bf16 v[64:67], v[128:131], a[0:3], 0
 s_mul_i32 s39, s32, 7168
 s_add_u32 m0, s39, 40960
 s_add_u32 s40, s36, 301056
 buffer_load_dwordx4 v1, s[12:15], s40 offen offset:0 lds
 v_mfma_f32_16x16x32_bf16 v[100:103], v[128:131], a[4:7], 0
 buffer_load_dwordx4 v1, s[12:15], s40 offen offset:1024 lds
 v_mfma_f32_16x16x32_bf16 v[68:71], v[132:135], a[0:3], 0
 buffer_load_dwordx4 v1, s[12:15], s40 offen offset:2048 lds
 s_add_u32 s87, s37, 4096
 buffer_load_dwordx4 a[16:19], v1, s[16:19], s87 offen sc1
 v_mfma_f32_16x16x32_bf16 v[104:107], v[132:135], a[4:7], 0
 s_add_u32 s87, s37, 151552
 buffer_load_dwordx4 a[20:23], v1, s[16:19], s87 offen sc1
 v_mfma_f32_16x16x32_bf16 v[72:75], v[136:139], a[0:3], 0
 s_add_u32 s87, s37, 5120
 buffer_load_dwordx4 a[24:27], v1, s[16:19], s87 offen sc1
 v_mfma_f32_16x16x32_bf16 v[108:111], v[136:139], a[4:7], 0
 s_add_u32 s87, s37, 152576
 buffer_load_dwordx4 a[28:31], v1, s[16:19], s87 offen sc1
 s_waitcnt lgkmcnt(0)
 s_waitcnt vmcnt(11)
 v_mfma_f32_16x16x32_bf16 v[48:51], v[140:143], a[8:11], v[48:51]
 ds_read_b128 v[112:115], v2 offset:14336
 ds_read_b128 v[116:119], v2 offset:15360
 v_mfma_f32_16x16x32_bf16 v[84:87], v[140:143], a[12:15], v[84:87]
 ds_read_b128 v[120:123], v2 offset:16384
 v_mfma_f32_16x16x32_bf16 v[52:55], v[144:147], a[8:11], v[52:55]
 ds_read_b128 v[124:127], v2 offset:17408
 v_mfma_f32_16x16x32_bf16 v[88:91], v[144:147], a[12:15], v[88:91]
 ds_read_b128 v[128:131], v2 offset:18432
 ds_read_b128 v[132:135], v2 offset:19456
 v_mfma_f32_16x16x32_bf16 v[56:59], v[148:151], a[8:11], v[56:59]
 ds_read_b128 v[136:139], v2 offset:20480
 v_mfma_f32_16x16x32_bf16 v[92:95], v[148:151], a[12:15], v[92:95]
 s_add_u32 s87, s37, 8192
 buffer_load_dwordx4 a[32:35], v1, s[16:19], s87 offen sc1
 v_mfma_f32_16x16x32_bf16 v[60:63], v[152:155], a[8:11], v[60:63]
 s_add_u32 s87, s37, 155648
 buffer_load_dwordx4 a[36:39], v1, s[16:19], s87 offen sc1
 v_mfma_f32_16x16x32_bf16 v[96:99], v[152:155], a[12:15], v[96:99]
 s_mul_i32 s39, s32, 7168
 s_add_u32 m0, s39, 73728
 s_add_u32 s40, s36, 591872
 buffer_load_dwordx4 v1, s[12:15], s40 offen offset:0 lds
 buffer_load_dwordx4 v1, s[12:15], s40 offen offset:1024 lds
 v_mfma_f32_16x16x32_bf16 v[64:67], v[156:159], a[8:11], v[64:67]
 buffer_load_dwordx4 v1, s[12:15], s40 offen offset:2048 lds
 v_mfma_f32_16x16x32_bf16 v[100:103], v[156:159], a[12:15], v[100:103]
 buffer_load_dwordx4 v1, s[12:15], s40 offen offset:3072 lds
 v_mfma_f32_16x16x32_bf16 v[68:71], v[160:163], a[8:11], v[68:71]
 s_mul_i32 s39, s32, 7168
 s_add_u32 m0, s39, 77824
 s_add_u32 s40, s36, 595968
 buffer_load_dwordx4 v1, s[12:15], s40 offen offset:0 lds
 buffer_load_dwordx4 v1, s[12:15], s40 offen offset:1024 lds
 v_mfma_f32_16x16x32_bf16 v[104:107], v[160:163], a[12:15], v[104:107]
 buffer_load_dwordx4 v1, s[12:15], s40 offen offset:2048 lds
 v_mfma_f32_16x16x32_bf16 v[72:75], v[164:167], a[8:11], v[72:75]
 s_mul_i32 s39, s32, 7168
 s_add_u32 m0, s39, 110592
 s_add_u32 s40, s36, 886784
 buffer_load_dwordx4 v1, s[12:15], s40 offen offset:0 lds
 v_mfma_f32_16x16x32_bf16 v[108:111], v[164:167], a[12:15], v[108:111]
 buffer_load_dwordx4 v1, s[12:15], s40 offen offset:1024 lds
 s_waitcnt lgkmcnt(0)
 s_waitcnt vmcnt(13)
 v_mfma_f32_16x16x32_bf16 v[48:51], v[112:115], a[16:19], v[48:51]
 ds_read_b128 v[140:143], v2 offset:21504
 ds_read_b128 v[144:147], v2 offset:22528
 v_mfma_f32_16x16x32_bf16 v[84:87], v[112:115], a[20:23], v[84:87]
 ds_read_b128 v[148:151], v2 offset:23552
 v_mfma_f32_16x16x32_bf16 v[52:55], v[116:119], a[16:19], v[52:55]
 ds_read_b128 v[152:155], v2 offset:24576
 v_mfma_f32_16x16x32_bf16 v[88:91], v[116:119], a[20:23], v[88:91]
 ds_read_b128 v[156:159], v2 offset:25600
 ds_read_b128 v[160:163], v2 offset:26624
 v_mfma_f32_16x16x32_bf16 v[56:59], v[120:123], a[16:19], v[56:59]
 ds_read_b128 v[164:167], v2 offset:27648
 v_mfma_f32_16x16x32_bf16 v[92:95], v[120:123], a[20:23], v[92:95]
 buffer_load_dwordx4 v1, s[12:15], s40 offen offset:2048 lds
 v_mfma_f32_16x16x32_bf16 v[60:63], v[124:127], a[16:19], v[60:63]
 buffer_load_dwordx4 v1, s[12:15], s40 offen offset:3072 lds
 v_mfma_f32_16x16x32_bf16 v[96:99], v[124:127], a[20:23], v[96:99]
 s_mul_i32 s39, s32, 7168
 s_add_u32 m0, s39, 114688
 s_add_u32 s40, s36, 890880
 buffer_load_dwordx4 v1, s[12:15], s40 offen offset:0 lds
 buffer_load_dwordx4 v1, s[12:15], s40 offen offset:1024 lds
 v_mfma_f32_16x16x32_bf16 v[64:67], v[128:131], a[16:19], v[64:67]
 buffer_load_dwordx4 v1, s[12:15], s40 offen offset:2048 lds
 v_mfma_f32_16x16x32_bf16 v[100:103], v[128:131], a[20:23], v[100:103]
 s_add_u32 s87, s37, 9216
 buffer_load_dwordx4 a[40:43], v1, s[16:19], s87 offen sc1
 v_mfma_f32_16x16x32_bf16 v[68:71], v[132:135], a[16:19], v[68:71]
 s_add_u32 s87, s37, 156672
 buffer_load_dwordx4 a[44:47], v1, s[16:19], s87 offen sc1
 s_add_u32 s87, s37, 12288
 buffer_load_dwordx4 a[48:51], v1, s[16:19], s87 offen sc1
 v_mfma_f32_16x16x32_bf16 v[104:107], v[132:135], a[20:23], v[104:107]
 s_add_u32 s87, s37, 159744
 buffer_load_dwordx4 a[52:55], v1, s[16:19], s87 offen sc1
 v_mfma_f32_16x16x32_bf16 v[72:75], v[136:139], a[16:19], v[72:75]
 s_add_u32 s87, s37, 13312
 buffer_load_dwordx4 a[56:59], v1, s[16:19], s87 offen sc1
 v_mfma_f32_16x16x32_bf16 v[108:111], v[136:139], a[20:23], v[108:111]
 s_add_u32 s87, s37, 160768
 buffer_load_dwordx4 a[60:63], v1, s[16:19], s87 offen sc1
 s_waitcnt lgkmcnt(0)
 s_waitcnt vmcnt(26)
 s_barrier
 s_waitcnt vmcnt(22)
 v_mfma_f32_16x16x32_bf16 v[48:51], v[140:143], a[24:27], v[48:51]
 ds_read_b128 v[112:115], v3 offset:0
 ds_read_b128 v[116:119], v3 offset:1024
 v_mfma_f32_16x16x32_bf16 v[84:87], v[140:143], a[28:31], v[84:87]
 ds_read_b128 v[120:123], v3 offset:2048
 v_mfma_f32_16x16x32_bf16 v[52:55], v[144:147], a[24:27], v[52:55]
 ds_read_b128 v[124:127], v3 offset:3072
 v_mfma_f32_16x16x32_bf16 v[88:91], v[144:147], a[28:31], v[88:91]
 ds_read_b128 v[128:131], v3 offset:4096
 v_mfma_f32_16x16x32_bf16 v[56:59], v[148:151], a[24:27], v[56:59]
 ds_read_b128 v[132:135], v3 offset:5120
 v_mfma_f32_16x16x32_bf16 v[92:95], v[148:151], a[28:31], v[92:95]
 ds_read_b128 v[136:139], v3 offset:6144
 v_mfma_f32_16x16x32_bf16 v[60:63], v[152:155], a[24:27], v[60:63]
 s_mul_i32 s39, s32, 7168
 s_add_u32 m0, s39, 0
 s_add_u32 s40, s36, 75776
 buffer_load_dwordx4 v1, s[12:15], s40 offen offset:0 lds
 v_mfma_f32_16x16x32_bf16 v[96:99], v[152:155], a[28:31], v[96:99]
 buffer_load_dwordx4 v1, s[12:15], s40 offen offset:1024 lds
 buffer_load_dwordx4 v1, s[12:15], s40 offen offset:2048 lds
 v_mfma_f32_16x16x32_bf16 v[64:67], v[156:159], a[24:27], v[64:67]
 buffer_load_dwordx4 v1, s[12:15], s40 offen offset:3072 lds
 v_mfma_f32_16x16x32_bf16 v[100:103], v[156:159], a[28:31], v[100:103]
 s_mul_i32 s39, s32, 7168
 s_add_u32 m0, s39, 4096
 s_add_u32 s40, s36, 79872
 buffer_load_dwordx4 v1, s[12:15], s40 offen offset:0 lds
 v_mfma_f32_16x16x32_bf16 v[68:71], v[160:163], a[24:27], v[68:71]
 buffer_load_dwordx4 v1, s[12:15], s40 offen offset:1024 lds
 v_mfma_f32_16x16x32_bf16 v[104:107], v[160:163], a[28:31], v[104:107]
 buffer_load_dwordx4 v1, s[12:15], s40 offen offset:2048 lds
 v_mfma_f32_16x16x32_bf16 v[72:75], v[164:167], a[24:27], v[72:75]
 s_add_u32 s87, s37, 16384
 buffer_load_dwordx4 a[64:67], v1, s[16:19], s87 offen sc1
 v_mfma_f32_16x16x32_bf16 v[108:111], v[164:167], a[28:31], v[108:111]
 s_add_u32 s87, s37, 163840
 buffer_load_dwordx4 a[68:71], v1, s[16:19], s87 offen sc1
 s_waitcnt lgkmcnt(0)
 s_waitcnt vmcnt(29)
 v_mfma_f32_16x16x32_bf16 v[48:51], v[112:115], a[32:35], v[48:51]
 ds_read_b128 v[140:143], v3 offset:7168
 v_mfma_f32_16x16x32_bf16 v[84:87], v[112:115], a[36:39], v[84:87]
 ds_read_b128 v[144:147], v3 offset:8192
 v_mfma_f32_16x16x32_bf16 v[52:55], v[116:119], a[32:35], v[52:55]
 v_mfma_f32_16x16x32_bf16 v[88:91], v[116:119], a[36:39], v[88:91]
 ds_read_b128 v[148:151], v3 offset:9216
 v_mfma_f32_16x16x32_bf16 v[56:59], v[120:123], a[32:35], v[56:59]
 ds_read_b128 v[152:155], v3 offset:10240
 v_mfma_f32_16x16x32_bf16 v[92:95], v[120:123], a[36:39], v[92:95]
 v_mfma_f32_16x16x32_bf16 v[60:63], v[124:127], a[32:35], v[60:63]
 ds_read_b128 v[156:159], v3 offset:11264
 v_mfma_f32_16x16x32_bf16 v[96:99], v[124:127], a[36:39], v[96:99]
 ds_read_b128 v[160:163], v3 offset:12288
 v_mfma_f32_16x16x32_bf16 v[64:67], v[128:131], a[32:35], v[64:67]
 v_mfma_f32_16x16x32_bf16 v[100:103], v[128:131], a[36:39], v[100:103]
 ds_read_b128 v[164:167], v3 offset:13312
 v_mfma_f32_16x16x32_bf16 v[68:71], v[132:135], a[32:35], v[68:71]
 s_add_u32 s87, s37, 17408
 buffer_load_dwordx4 a[72:75], v1, s[16:19], s87 offen sc1
 v_mfma_f32_16x16x32_bf16 v[104:107], v[132:135], a[36:39], v[104:107]
 v_mfma_f32_16x16x32_bf16 v[72:75], v[136:139], a[32:35], v[72:75]
 s_add_u32 s87, s37, 164864
 buffer_load_dwordx4 a[76:79], v1, s[16:19], s87 offen sc1
 v_mfma_f32_16x16x32_bf16 v[108:111], v[136:139], a[36:39], v[108:111]
 s_waitcnt lgkmcnt(0)
 s_waitcnt vmcnt(15)
 v_mfma_f32_16x16x32_bf16 v[48:51], v[140:143], a[40:43], v[48:51]
 ds_read_b128 v[112:115], v3 offset:14336
 v_mfma_f32_16x16x32_bf16 v[84:87], v[140:143], a[44:47], v[84:87]
 ds_read_b128 v[116:119], v3 offset:15360
 v_mfma_f32_16x16x32_bf16 v[52:55], v[144:147], a[40:43], v[52:55]
 v_mfma_f32_16x16x32_bf16 v[88:91], v[144:147], a[44:47], v[88:91]
 ds_read_b128 v[120:123], v3 offset:16384
 v_mfma_f32_16x16x32_bf16 v[56:59], v[148:151], a[40:43], v[56:59]
 ds_read_b128 v[124:127], v3 offset:17408
 v_mfma_f32_16x16x32_bf16 v[92:95], v[148:151], a[44:47], v[92:95]
 v_mfma_f32_16x16x32_bf16 v[60:63], v[152:155], a[40:43], v[60:63]
 ds_read_b128 v[128:131], v3 offset:18432
 v_mfma_f32_16x16x32_bf16 v[96:99], v[152:155], a[44:47], v[96:99]
 ds_read_b128 v[132:135], v3 offset:19456
 v_mfma_f32_16x16x32_bf16 v[64:67], v[156:159], a[40:43], v[64:67]
 v_mfma_f32_16x16x32_bf16 v[100:103], v[156:159], a[44:47], v[100:103]
 ds_read_b128 v[136:139], v3 offset:20480
 v_mfma_f32_16x16x32_bf16 v[68:71], v[160:163], a[40:43], v[68:71]
 s_add_u32 s87, s37, 20480
 buffer_load_dwordx4 a[80:83], v1, s[16:19], s87 offen sc1
 v_mfma_f32_16x16x32_bf16 v[104:107], v[160:163], a[44:47], v[104:107]
 v_mfma_f32_16x16x32_bf16 v[72:75], v[164:167], a[40:43], v[72:75]
 s_add_u32 s87, s37, 167936
 buffer_load_dwordx4 a[84:87], v1, s[16:19], s87 offen sc1
 v_mfma_f32_16x16x32_bf16 v[108:111], v[164:167], a[44:47], v[108:111]
 s_waitcnt lgkmcnt(0)
 s_waitcnt vmcnt(15)
 v_mfma_f32_16x16x32_bf16 v[48:51], v[112:115], a[48:51], v[48:51]
 ds_read_b128 v[140:143], v3 offset:21504
 v_mfma_f32_16x16x32_bf16 v[84:87], v[112:115], a[52:55], v[84:87]
 ds_read_b128 v[144:147], v3 offset:22528
 v_mfma_f32_16x16x32_bf16 v[52:55], v[116:119], a[48:51], v[52:55]
 v_mfma_f32_16x16x32_bf16 v[88:91], v[116:119], a[52:55], v[88:91]
 ds_read_b128 v[148:151], v3 offset:23552
 v_mfma_f32_16x16x32_bf16 v[56:59], v[120:123], a[48:51], v[56:59]
 ds_read_b128 v[152:155], v3 offset:24576
 v_mfma_f32_16x16x32_bf16 v[92:95], v[120:123], a[52:55], v[92:95]
 v_mfma_f32_16x16x32_bf16 v[60:63], v[124:127], a[48:51], v[60:63]
 ds_read_b128 v[156:159], v3 offset:25600
 v_mfma_f32_16x16x32_bf16 v[96:99], v[124:127], a[52:55], v[96:99]
 ds_read_b128 v[160:163], v3 offset:26624
 v_mfma_f32_16x16x32_bf16 v[64:67], v[128:131], a[48:51], v[64:67]
 v_mfma_f32_16x16x32_bf16 v[100:103], v[128:131], a[52:55], v[100:103]
 ds_read_b128 v[164:167], v3 offset:27648
 v_mfma_f32_16x16x32_bf16 v[68:71], v[132:135], a[48:51], v[68:71]
 s_add_u32 s87, s37, 21504
 buffer_load_dwordx4 a[88:91], v1, s[16:19], s87 offen sc1
 v_mfma_f32_16x16x32_bf16 v[104:107], v[132:135], a[52:55], v[104:107]
 v_mfma_f32_16x16x32_bf16 v[72:75], v[136:139], a[48:51], v[72:75]
 s_add_u32 s87, s37, 168960
 buffer_load_dwordx4 a[92:95], v1, s[16:19], s87 offen sc1
 v_mfma_f32_16x16x32_bf16 v[108:111], v[136:139], a[52:55], v[108:111]
 s_waitcnt lgkmcnt(0)
 s_waitcnt vmcnt(28)
 s_barrier
 s_waitcnt vmcnt(15)
 s_mov_b64 s[76:77], exec
 s_mov_b64 exec, 1
 buffer_load_dword v230, v229, s[28:31], 0 offen sc1
 s_mov_b64 exec, s[76:77]
 s_nop 3
 v_mfma_f32_16x16x32_bf16 v[48:51], v[140:143], a[56:59], v[48:51]
 ds_read_b128 v[112:115], v4 offset:0
 ds_read_b128 v[116:119], v4 offset:1024
 v_mfma_f32_16x16x32_bf16 v[84:87], v[140:143], a[60:63], v[84:87]
 ds_read_b128 v[120:123], v4 offset:2048
 v_mfma_f32_16x16x32_bf16 v[52:55], v[144:147], a[56:59], v[52:55]
 ds_read_b128 v[124:127], v4 offset:3072
 v_mfma_f32_16x16x32_bf16 v[88:91], v[144:147], a[60:63], v[88:91]
 ds_read_b128 v[128:131], v4 offset:4096
 v_mfma_f32_16x16x32_bf16 v[56:59], v[148:151], a[56:59], v[56:59]
 ds_read_b128 v[132:135], v4 offset:5120
 v_mfma_f32_16x16x32_bf16 v[92:95], v[148:151], a[60:63], v[92:95]
 ds_read_b128 v[136:139], v4 offset:6144
 v_mfma_f32_16x16x32_bf16 v[60:63], v[152:155], a[56:59], v[60:63]
 s_mul_i32 s39, s32, 7168
 s_add_u32 m0, s39, 36864
 s_add_u32 s40, s36, 370688
 buffer_load_dwordx4 v1, s[12:15], s40 offen offset:0 lds
 v_mfma_f32_16x16x32_bf16 v[96:99], v[152:155], a[60:63], v[96:99]
 buffer_load_dwordx4 v1, s[12:15], s40 offen offset:1024 lds
 buffer_load_dwordx4 v1, s[12:15], s40 offen offset:2048 lds
 v_mfma_f32_16x16x32_bf16 v[64:67], v[156:159], a[56:59], v[64:67]
 buffer_load_dwordx4 v1, s[12:15], s40 offen offset:3072 lds
 v_mfma_f32_16x16x32_bf16 v[100:103], v[156:159], a[60:63], v[100:103]
 s_mul_i32 s39, s32, 7168
 s_add_u32 m0, s39, 40960
 s_add_u32 s40, s36, 374784
 buffer_load_dwordx4 v1, s[12:15], s40 offen offset:0 lds
 v_mfma_f32_16x16x32_bf16 v[68:71], v[160:163], a[56:59], v[68:71]
 buffer_load_dwordx4 v1, s[12:15], s40 offen offset:1024 lds
 v_mfma_f32_16x16x32_bf16 v[104:107], v[160:163], a[60:63], v[104:107]
 buffer_load_dwordx4 v1, s[12:15], s40 offen offset:2048 lds
 v_mfma_f32_16x16x32_bf16 v[72:75], v[164:167], a[56:59], v[72:75]
 s_add_u32 s87, s37, 24576
 buffer_load_dwordx4 a[96:99], v1, s[16:19], s87 offen sc1
 v_mfma_f32_16x16x32_bf16 v[108:111], v[164:167], a[60:63], v[108:111]
 s_add_u32 s87, s37, 172032
 buffer_load_dwordx4 a[100:103], v1, s[16:19], s87 offen sc1
 s_waitcnt lgkmcnt(0)
 s_waitcnt vmcnt(16)
 v_mfma_f32_16x16x32_bf16 v[48:51], v[112:115], a[64:67], v[48:51]
 ds_read_b128 v[140:143], v4 offset:7168
 v_mfma_f32_16x16x32_bf16 v[84:87], v[112:115], a[68:71], v[84:87]
 ds_read_b128 v[144:147], v4 offset:8192
 v_mfma_f32_16x16x32_bf16 v[52:55], v[116:119], a[64:67], v[52:55]
 v_mfma_f32_16x16x32_bf16 v[88:91], v[116:119], a[68:71], v[88:91]
 ds_read_b128 v[148:151], v4 offset:9216
 v_mfma_f32_16x16x32_bf16 v[56:59], v[120:123], a[64:67], v[56:59]
 ds_read_b128 v[152:155], v4 offset:10240
 v_mfma_f32_16x16x32_bf16 v[92:95], v[120:123], a[68:71], v[92:95]
 v_mfma_f32_16x16x32_bf16 v[60:63], v[124:127], a[64:67], v[60:63]
 ds_read_b128 v[156:159], v4 offset:11264
 v_mfma_f32_16x16x32_bf16 v[96:99], v[124:127], a[68:71], v[96:99]
 ds_read_b128 v[160:163], v4 offset:12288
 v_mfma_f32_16x16x32_bf16 v[64:67], v[128:131], a[64:67], v[64:67]
 v_mfma_f32_16x16x32_bf16 v[100:103], v[128:131], a[68:71], v[100:103]
 ds_read_b128 v[164:167], v4 offset:13312
 v_mfma_f32_16x16x32_bf16 v[68:71], v[132:135], a[64:67], v[68:71]
 s_add_u32 s87, s37, 25600
 buffer_load_dwordx4 a[104:107], v1, s[16:19], s87 offen sc1
 v_mfma_f32_16x16x32_bf16 v[104:107], v[132:135], a[68:71], v[104:107]
 v_mfma_f32_16x16x32_bf16 v[72:75], v[136:139], a[64:67], v[72:75]
 s_add_u32 s87, s37, 173056
 buffer_load_dwordx4 a[108:111], v1, s[16:19], s87 offen sc1
 v_mfma_f32_16x16x32_bf16 v[108:111], v[136:139], a[68:71], v[108:111]
 s_waitcnt lgkmcnt(0)
 s_waitcnt vmcnt(16)
 v_mfma_f32_16x16x32_bf16 v[48:51], v[140:143], a[72:75], v[48:51]
 ds_read_b128 v[112:115], v4 offset:14336
 v_mfma_f32_16x16x32_bf16 v[84:87], v[140:143], a[76:79], v[84:87]
 ds_read_b128 v[116:119], v4 offset:15360
 v_mfma_f32_16x16x32_bf16 v[52:55], v[144:147], a[72:75], v[52:55]
 v_mfma_f32_16x16x32_bf16 v[88:91], v[144:147], a[76:79], v[88:91]
 ds_read_b128 v[120:123], v4 offset:16384
 v_mfma_f32_16x16x32_bf16 v[56:59], v[148:151], a[72:75], v[56:59]
 ds_read_b128 v[124:127], v4 offset:17408
 v_mfma_f32_16x16x32_bf16 v[92:95], v[148:151], a[76:79], v[92:95]
 v_mfma_f32_16x16x32_bf16 v[60:63], v[152:155], a[72:75], v[60:63]
 ds_read_b128 v[128:131], v4 offset:18432
 v_mfma_f32_16x16x32_bf16 v[96:99], v[152:155], a[76:79], v[96:99]
 ds_read_b128 v[132:135], v4 offset:19456
 v_mfma_f32_16x16x32_bf16 v[64:67], v[156:159], a[72:75], v[64:67]
 v_mfma_f32_16x16x32_bf16 v[100:103], v[156:159], a[76:79], v[100:103]
 ds_read_b128 v[136:139], v4 offset:20480
 v_mfma_f32_16x16x32_bf16 v[68:71], v[160:163], a[72:75], v[68:71]
 s_add_u32 s87, s37, 28672
 buffer_load_dwordx4 a[112:115], v1, s[16:19], s87 offen sc1
 v_mfma_f32_16x16x32_bf16 v[104:107], v[160:163], a[76:79], v[104:107]
 v_mfma_f32_16x16x32_bf16 v[72:75], v[164:167], a[72:75], v[72:75]
 s_add_u32 s87, s37, 176128
 buffer_load_dwordx4 a[116:119], v1, s[16:19], s87 offen sc1
 v_mfma_f32_16x16x32_bf16 v[108:111], v[164:167], a[76:79], v[108:111]
 s_waitcnt lgkmcnt(0)
 s_waitcnt vmcnt(16)
 v_mfma_f32_16x16x32_bf16 v[48:51], v[112:115], a[80:83], v[48:51]
 ds_read_b128 v[140:143], v4 offset:21504
 v_mfma_f32_16x16x32_bf16 v[84:87], v[112:115], a[84:87], v[84:87]
 ds_read_b128 v[144:147], v4 offset:22528
 v_mfma_f32_16x16x32_bf16 v[52:55], v[116:119], a[80:83], v[52:55]
 v_mfma_f32_16x16x32_bf16 v[88:91], v[116:119], a[84:87], v[88:91]
 ds_read_b128 v[148:151], v4 offset:23552
 v_mfma_f32_16x16x32_bf16 v[56:59], v[120:123], a[80:83], v[56:59]
 ds_read_b128 v[152:155], v4 offset:24576
 v_mfma_f32_16x16x32_bf16 v[92:95], v[120:123], a[84:87], v[92:95]
 v_mfma_f32_16x16x32_bf16 v[60:63], v[124:127], a[80:83], v[60:63]
 ds_read_b128 v[156:159], v4 offset:25600
 v_mfma_f32_16x16x32_bf16 v[96:99], v[124:127], a[84:87], v[96:99]
 ds_read_b128 v[160:163], v4 offset:26624
 v_mfma_f32_16x16x32_bf16 v[64:67], v[128:131], a[80:83], v[64:67]
 v_mfma_f32_16x16x32_bf16 v[100:103], v[128:131], a[84:87], v[100:103]
 ds_read_b128 v[164:167], v4 offset:27648
 v_mfma_f32_16x16x32_bf16 v[68:71], v[132:135], a[80:83], v[68:71]
 s_add_u32 s87, s37, 29696
 buffer_load_dwordx4 a[120:123], v1, s[16:19], s87 offen sc1
 v_mfma_f32_16x16x32_bf16 v[104:107], v[132:135], a[84:87], v[104:107]
 v_mfma_f32_16x16x32_bf16 v[72:75], v[136:139], a[80:83], v[72:75]
 s_add_u32 s87, s37, 177152
 buffer_load_dwordx4 a[124:127], v1, s[16:19], s87 offen sc1
 v_mfma_f32_16x16x32_bf16 v[108:111], v[136:139], a[84:87], v[108:111]
 s_waitcnt lgkmcnt(0)
 s_waitcnt vmcnt(37)
 s_barrier
 s_waitcnt vmcnt(16)
 s_waitcnt vmcnt(15)
 v_readfirstlane_b32 s39, v230
 s_nop 0
 s_cmp_ge_u32 s39, 8
 s_cbranch_scc1 L_g2_lateok0
 s_mov_b32 s56, 0
 s_mov_b64 s[76:77], exec
 s_mov_b64 exec, 1
L_g2_lspin0:
 buffer_load_dword v230, v229, s[28:31], 0 offen sc1
 s_waitcnt vmcnt(0)
 v_readfirstlane_b32 s39, v230
 s_nop 0
 s_cmp_ge_u32 s39, 8
 s_cbranch_scc1 L_g2_ldone0
 s_add_u32 s56, s56, 1
 s_cmp_lt_u32 s56, 0x100000
 s_cbranch_scc0 L_g2_ldone0
 s_sleep 2
 s_branch L_g2_lspin0
L_g2_ldone0:
 s_mov_b64 exec, s[76:77]
L_g2_lateok0:
 s_nop 0
 s_nop 2
 v_mfma_f32_16x16x32_bf16 v[48:51], v[140:143], a[88:91], v[48:51]
 ds_read_b128 v[112:115], v5 offset:0
 ds_read_b128 v[116:119], v5 offset:1024
 v_mfma_f32_16x16x32_bf16 v[84:87], v[140:143], a[92:95], v[84:87]
 ds_read_b128 v[120:123], v5 offset:2048
 v_mfma_f32_16x16x32_bf16 v[52:55], v[144:147], a[88:91], v[52:55]
 ds_read_b128 v[124:127], v5 offset:3072
 v_mfma_f32_16x16x32_bf16 v[88:91], v[144:147], a[92:95], v[88:91]
 ds_read_b128 v[128:131], v5 offset:4096
 v_mfma_f32_16x16x32_bf16 v[56:59], v[148:151], a[88:91], v[56:59]
 ds_read_b128 v[132:135], v5 offset:5120
 v_mfma_f32_16x16x32_bf16 v[92:95], v[148:151], a[92:95], v[92:95]
 ds_read_b128 v[136:139], v5 offset:6144
 v_mfma_f32_16x16x32_bf16 v[60:63], v[152:155], a[88:91], v[60:63]
 s_mul_i32 s39, s32, 7168
 s_add_u32 m0, s39, 73728
 s_add_u32 s40, s36, 665600
 buffer_load_dwordx4 v1, s[12:15], s40 offen offset:0 lds
 v_mfma_f32_16x16x32_bf16 v[96:99], v[152:155], a[92:95], v[96:99]
 buffer_load_dwordx4 v1, s[12:15], s40 offen offset:1024 lds
 buffer_load_dwordx4 v1, s[12:15], s40 offen offset:2048 lds
 v_mfma_f32_16x16x32_bf16 v[64:67], v[156:159], a[88:91], v[64:67]
 buffer_load_dwordx4 v1, s[12:15], s40 offen offset:3072 lds
 v_mfma_f32_16x16x32_bf16 v[100:103], v[156:159], a[92:95], v[100:103]
 s_mul_i32 s39, s32, 7168
 s_add_u32 m0, s39, 77824
 s_add_u32 s40, s36, 669696
 buffer_load_dwordx4 v1, s[12:15], s40 offen offset:0 lds
 v_mfma_f32_16x16x32_bf16 v[68:71], v[160:163], a[88:91], v[68:71]
 buffer_load_dwordx4 v1, s[12:15], s40 offen offset:1024 lds
 v_mfma_f32_16x16x32_bf16 v[104:107], v[160:163], a[92:95], v[104:107]
 buffer_load_dwordx4 v1, s[12:15], s40 offen offset:2048 lds
 v_mfma_f32_16x16x32_bf16 v[72:75], v[164:167], a[88:91], v[72:75]
 s_add_u32 s87, s37, 2048
 buffer_load_dwordx4 a[128:131], v1, s[16:19], s87 offen sc1
 v_mfma_f32_16x16x32_bf16 v[108:111], v[164:167], a[92:95], v[108:111]
 s_add_u32 s87, s37, 149504
 buffer_load_dwordx4 a[132:135], v1, s[16:19], s87 offen sc1
 s_waitcnt lgkmcnt(0)
 s_waitcnt vmcnt(15)
 v_mfma_f32_16x16x32_bf16 v[48:51], v[112:115], a[96:99], v[48:51]
 ds_read_b128 v[140:143], v5 offset:7168
 v_mfma_f32_16x16x32_bf16 v[84:87], v[112:115], a[100:103], v[84:87]
 ds_read_b128 v[144:147], v5 offset:8192
 v_mfma_f32_16x16x32_bf16 v[52:55], v[116:119], a[96:99], v[52:55]
 v_mfma_f32_16x16x32_bf16 v[88:91], v[116:119], a[100:103], v[88:91]
 ds_read_b128 v[148:151], v5 offset:9216
 v_mfma_f32_16x16x32_bf16 v[56:59], v[120:123], a[96:99], v[56:59]
 ds_read_b128 v[152:155], v5 offset:10240
 v_mfma_f32_16x16x32_bf16 v[92:95], v[120:123], a[100:103], v[92:95]
 v_mfma_f32_16x16x32_bf16 v[60:63], v[124:127], a[96:99], v[60:63]
 ds_read_b128 v[156:159], v5 offset:11264
 v_mfma_f32_16x16x32_bf16 v[96:99], v[124:127], a[100:103], v[96:99]
 ds_read_b128 v[160:163], v5 offset:12288
 v_mfma_f32_16x16x32_bf16 v[64:67], v[128:131], a[96:99], v[64:67]
 v_mfma_f32_16x16x32_bf16 v[100:103], v[128:131], a[100:103], v[100:103]
 ds_read_b128 v[164:167], v5 offset:13312
 v_mfma_f32_16x16x32_bf16 v[68:71], v[132:135], a[96:99], v[68:71]
 s_add_u32 s87, s37, 3072
 buffer_load_dwordx4 a[136:139], v1, s[16:19], s87 offen sc1
 v_mfma_f32_16x16x32_bf16 v[104:107], v[132:135], a[100:103], v[104:107]
 v_mfma_f32_16x16x32_bf16 v[72:75], v[136:139], a[96:99], v[72:75]
 s_add_u32 s87, s37, 150528
 buffer_load_dwordx4 a[140:143], v1, s[16:19], s87 offen sc1
 v_mfma_f32_16x16x32_bf16 v[108:111], v[136:139], a[100:103], v[108:111]
 s_waitcnt lgkmcnt(0)
 s_waitcnt vmcnt(15)
 v_mfma_f32_16x16x32_bf16 v[48:51], v[140:143], a[104:107], v[48:51]
 ds_read_b128 v[112:115], v5 offset:14336
 v_mfma_f32_16x16x32_bf16 v[84:87], v[140:143], a[108:111], v[84:87]
 ds_read_b128 v[116:119], v5 offset:15360
 v_mfma_f32_16x16x32_bf16 v[52:55], v[144:147], a[104:107], v[52:55]
 v_mfma_f32_16x16x32_bf16 v[88:91], v[144:147], a[108:111], v[88:91]
 ds_read_b128 v[120:123], v5 offset:16384
 v_mfma_f32_16x16x32_bf16 v[56:59], v[148:151], a[104:107], v[56:59]
 ds_read_b128 v[124:127], v5 offset:17408
 v_mfma_f32_16x16x32_bf16 v[92:95], v[148:151], a[108:111], v[92:95]
 v_mfma_f32_16x16x32_bf16 v[60:63], v[152:155], a[104:107], v[60:63]
 ds_read_b128 v[128:131], v5 offset:18432
 v_mfma_f32_16x16x32_bf16 v[96:99], v[152:155], a[108:111], v[96:99]
 ds_read_b128 v[132:135], v5 offset:19456
 v_mfma_f32_16x16x32_bf16 v[64:67], v[156:159], a[104:107], v[64:67]
 v_mfma_f32_16x16x32_bf16 v[100:103], v[156:159], a[108:111], v[100:103]
 ds_read_b128 v[136:139], v5 offset:20480
 v_mfma_f32_16x16x32_bf16 v[68:71], v[160:163], a[104:107], v[68:71]
 s_add_u32 s87, s37, 6144
 buffer_load_dwordx4 a[144:147], v1, s[16:19], s87 offen sc1
 v_mfma_f32_16x16x32_bf16 v[104:107], v[160:163], a[108:111], v[104:107]
 v_mfma_f32_16x16x32_bf16 v[72:75], v[164:167], a[104:107], v[72:75]
 s_add_u32 s87, s37, 153600
 buffer_load_dwordx4 a[148:151], v1, s[16:19], s87 offen sc1
 v_mfma_f32_16x16x32_bf16 v[108:111], v[164:167], a[108:111], v[108:111]
 s_waitcnt lgkmcnt(0)
 s_waitcnt vmcnt(15)
 v_mfma_f32_16x16x32_bf16 v[48:51], v[112:115], a[112:115], v[48:51]
 ds_read_b128 v[140:143], v5 offset:21504
 v_mfma_f32_16x16x32_bf16 v[84:87], v[112:115], a[116:119], v[84:87]
 ds_read_b128 v[144:147], v5 offset:22528
 v_mfma_f32_16x16x32_bf16 v[52:55], v[116:119], a[112:115], v[52:55]
 v_mfma_f32_16x16x32_bf16 v[88:91], v[116:119], a[116:119], v[88:91]
 ds_read_b128 v[148:151], v5 offset:23552
 v_mfma_f32_16x16x32_bf16 v[56:59], v[120:123], a[112:115], v[56:59]
 ds_read_b128 v[152:155], v5 offset:24576
 v_mfma_f32_16x16x32_bf16 v[92:95], v[120:123], a[116:119], v[92:95]
 v_mfma_f32_16x16x32_bf16 v[60:63], v[124:127], a[112:115], v[60:63]
 ds_read_b128 v[156:159], v5 offset:25600
 v_mfma_f32_16x16x32_bf16 v[96:99], v[124:127], a[116:119], v[96:99]
 ds_read_b128 v[160:163], v5 offset:26624
 v_mfma_f32_16x16x32_bf16 v[64:67], v[128:131], a[112:115], v[64:67]
 v_mfma_f32_16x16x32_bf16 v[100:103], v[128:131], a[116:119], v[100:103]
 ds_read_b128 v[164:167], v5 offset:27648
 v_mfma_f32_16x16x32_bf16 v[68:71], v[132:135], a[112:115], v[68:71]
 s_add_u32 s87, s37, 7168
 buffer_load_dwordx4 a[152:155], v1, s[16:19], s87 offen sc1
 v_mfma_f32_16x16x32_bf16 v[104:107], v[132:135], a[116:119], v[104:107]
 v_mfma_f32_16x16x32_bf16 v[72:75], v[136:139], a[112:115], v[72:75]
 s_add_u32 s87, s37, 154624
 buffer_load_dwordx4 a[156:159], v1, s[16:19], s87 offen sc1
 v_mfma_f32_16x16x32_bf16 v[108:111], v[136:139], a[116:119], v[108:111]
 s_waitcnt lgkmcnt(0)
 s_waitcnt vmcnt(39)
 s_barrier
 s_waitcnt vmcnt(15)
 v_mfma_f32_16x16x32_bf16 v[48:51], v[140:143], a[120:123], v[48:51]
 ds_read_b128 v[112:115], v2 offset:0
 ds_read_b128 v[116:119], v2 offset:1024
 v_mfma_f32_16x16x32_bf16 v[84:87], v[140:143], a[124:127], v[84:87]
 ds_read_b128 v[120:123], v2 offset:2048
 v_mfma_f32_16x16x32_bf16 v[52:55], v[144:147], a[120:123], v[52:55]
 ds_read_b128 v[124:127], v2 offset:3072
 v_mfma_f32_16x16x32_bf16 v[88:91], v[144:147], a[124:127], v[88:91]
 ds_read_b128 v[128:131], v2 offset:4096
 v_mfma_f32_16x16x32_bf16 v[56:59], v[148:151], a[120:123], v[56:59]
 ds_read_b128 v[132:135], v2 offset:5120
 v_mfma_f32_16x16x32_bf16 v[92:95], v[148:151], a[124:127], v[92:95]
 ds_read_b128 v[136:139], v2 offset:6144
 v_mfma_f32_16x16x32_bf16 v[60:63], v[152:155], a[120:123], v[60:63]
 s_mul_i32 s39, s32, 7168
 s_add_u32 m0, s39, 110592
 s_add_u32 s40, s36, 960512
 buffer_load_dwordx4 v1, s[12:15], s40 offen offset:0 lds
 v_mfma_f32_16x16x32_bf16 v[96:99], v[152:155], a[124:127], v[96:99]
 buffer_load_dwordx4 v1, s[12:15], s40 offen offset:1024 lds
 buffer_load_dwordx4 v1, s[12:15], s40 offen offset:2048 lds
 v_mfma_f32_16x16x32_bf16 v[64:67], v[156:159], a[120:123], v[64:67]
 buffer_load_dwordx4 v1, s[12:15], s40 offen offset:3072 lds
 v_mfma_f32_16x16x32_bf16 v[100:103], v[156:159], a[124:127], v[100:103]
 s_mul_i32 s39, s32, 7168
 s_add_u32 m0, s39, 114688
 s_add_u32 s40, s36, 964608
 buffer_load_dwordx4 v1, s[12:15], s40 offen offset:0 lds
 v_mfma_f32_16x16x32_bf16 v[68:71], v[160:163], a[120:123], v[68:71]
 buffer_load_dwordx4 v1, s[12:15], s40 offen offset:1024 lds
 v_mfma_f32_16x16x32_bf16 v[104:107], v[160:163], a[124:127], v[104:107]
 buffer_load_dwordx4 v1, s[12:15], s40 offen offset:2048 lds
 v_mfma_f32_16x16x32_bf16 v[72:75], v[164:167], a[120:123], v[72:75]
 s_add_u32 s87, s37, 10240
 buffer_load_dwordx4 a[160:163], v1, s[16:19], s87 offen sc1
 v_mfma_f32_16x16x32_bf16 v[108:111], v[164:167], a[124:127], v[108:111]
 s_add_u32 s87, s37, 157696
 buffer_load_dwordx4 a[164:167], v1, s[16:19], s87 offen sc1
 s_waitcnt lgkmcnt(0)
 s_waitcnt vmcnt(15)
 v_mfma_f32_16x16x32_bf16 v[48:51], v[112:115], a[128:131], v[48:51]
 ds_read_b128 v[140:143], v2 offset:7168
 v_mfma_f32_16x16x32_bf16 v[84:87], v[112:115], a[132:135], v[84:87]
 ds_read_b128 v[144:147], v2 offset:8192
 v_mfma_f32_16x16x32_bf16 v[52:55], v[116:119], a[128:131], v[52:55]
 v_mfma_f32_16x16x32_bf16 v[88:91], v[116:119], a[132:135], v[88:91]
 ds_read_b128 v[148:151], v2 offset:9216
 v_mfma_f32_16x16x32_bf16 v[56:59], v[120:123], a[128:131], v[56:59]
 ds_read_b128 v[152:155], v2 offset:10240
 v_mfma_f32_16x16x32_bf16 v[92:95], v[120:123], a[132:135], v[92:95]
 v_mfma_f32_16x16x32_bf16 v[60:63], v[124:127], a[128:131], v[60:63]
 ds_read_b128 v[156:159], v2 offset:11264
 v_mfma_f32_16x16x32_bf16 v[96:99], v[124:127], a[132:135], v[96:99]
 ds_read_b128 v[160:163], v2 offset:12288
 v_mfma_f32_16x16x32_bf16 v[64:67], v[128:131], a[128:131], v[64:67]
 v_mfma_f32_16x16x32_bf16 v[100:103], v[128:131], a[132:135], v[100:103]
 ds_read_b128 v[164:167], v2 offset:13312
 v_mfma_f32_16x16x32_bf16 v[68:71], v[132:135], a[128:131], v[68:71]
 s_add_u32 s87, s37, 11264
 buffer_load_dwordx4 a[168:171], v1, s[16:19], s87 offen sc1
 v_mfma_f32_16x16x32_bf16 v[104:107], v[132:135], a[132:135], v[104:107]
 v_mfma_f32_16x16x32_bf16 v[72:75], v[136:139], a[128:131], v[72:75]
 s_add_u32 s87, s37, 158720
 buffer_load_dwordx4 a[172:175], v1, s[16:19], s87 offen sc1
 v_mfma_f32_16x16x32_bf16 v[108:111], v[136:139], a[132:135], v[108:111]
 s_waitcnt lgkmcnt(0)
 s_waitcnt vmcnt(15)
 v_mfma_f32_16x16x32_bf16 v[48:51], v[140:143], a[136:139], v[48:51]
 ds_read_b128 v[112:115], v2 offset:14336
 v_mfma_f32_16x16x32_bf16 v[84:87], v[140:143], a[140:143], v[84:87]
 ds_read_b128 v[116:119], v2 offset:15360
 v_mfma_f32_16x16x32_bf16 v[52:55], v[144:147], a[136:139], v[52:55]
 v_mfma_f32_16x16x32_bf16 v[88:91], v[144:147], a[140:143], v[88:91]
 ds_read_b128 v[120:123], v2 offset:16384
 v_mfma_f32_16x16x32_bf16 v[56:59], v[148:151], a[136:139], v[56:59]
 ds_read_b128 v[124:127], v2 offset:17408
 v_mfma_f32_16x16x32_bf16 v[92:95], v[148:151], a[140:143], v[92:95]
 v_mfma_f32_16x16x32_bf16 v[60:63], v[152:155], a[136:139], v[60:63]
 ds_read_b128 v[128:131], v2 offset:18432
 v_mfma_f32_16x16x32_bf16 v[96:99], v[152:155], a[140:143], v[96:99]
 ds_read_b128 v[132:135], v2 offset:19456
 v_mfma_f32_16x16x32_bf16 v[64:67], v[156:159], a[136:139], v[64:67]
 v_mfma_f32_16x16x32_bf16 v[100:103], v[156:159], a[140:143], v[100:103]
 ds_read_b128 v[136:139], v2 offset:20480
 v_mfma_f32_16x16x32_bf16 v[68:71], v[160:163], a[136:139], v[68:71]
 s_add_u32 s87, s37, 14336
 buffer_load_dwordx4 a[176:179], v1, s[16:19], s87 offen sc1
 v_mfma_f32_16x16x32_bf16 v[104:107], v[160:163], a[140:143], v[104:107]
 v_mfma_f32_16x16x32_bf16 v[72:75], v[164:167], a[136:139], v[72:75]
 s_add_u32 s87, s37, 161792
 buffer_load_dwordx4 a[180:183], v1, s[16:19], s87 offen sc1
 v_mfma_f32_16x16x32_bf16 v[108:111], v[164:167], a[140:143], v[108:111]
 s_waitcnt lgkmcnt(0)
 s_waitcnt vmcnt(15)
 v_mfma_f32_16x16x32_bf16 v[48:51], v[112:115], a[144:147], v[48:51]
 ds_read_b128 v[140:143], v2 offset:21504
 v_mfma_f32_16x16x32_bf16 v[84:87], v[112:115], a[148:151], v[84:87]
 ds_read_b128 v[144:147], v2 offset:22528
 v_mfma_f32_16x16x32_bf16 v[52:55], v[116:119], a[144:147], v[52:55]
 v_mfma_f32_16x16x32_bf16 v[88:91], v[116:119], a[148:151], v[88:91]
 ds_read_b128 v[148:151], v2 offset:23552
 v_mfma_f32_16x16x32_bf16 v[56:59], v[120:123], a[144:147], v[56:59]
 ds_read_b128 v[152:155], v2 offset:24576
 v_mfma_f32_16x16x32_bf16 v[92:95], v[120:123], a[148:151], v[92:95]
 v_mfma_f32_16x16x32_bf16 v[60:63], v[124:127], a[144:147], v[60:63]
 ds_read_b128 v[156:159], v2 offset:25600
 v_mfma_f32_16x16x32_bf16 v[96:99], v[124:127], a[148:151], v[96:99]
 ds_read_b128 v[160:163], v2 offset:26624
 v_mfma_f32_16x16x32_bf16 v[64:67], v[128:131], a[144:147], v[64:67]
 v_mfma_f32_16x16x32_bf16 v[100:103], v[128:131], a[148:151], v[100:103]
 ds_read_b128 v[164:167], v2 offset:27648
 v_mfma_f32_16x16x32_bf16 v[68:71], v[132:135], a[144:147], v[68:71]
 s_add_u32 s87, s37, 15360
 buffer_load_dwordx4 a[184:187], v1, s[16:19], s87 offen sc1
 v_mfma_f32_16x16x32_bf16 v[104:107], v[132:135], a[148:151], v[104:107]
 v_mfma_f32_16x16x32_bf16 v[72:75], v[136:139], a[144:147], v[72:75]
 s_add_u32 s87, s37, 162816
 buffer_load_dwordx4 a[188:191], v1, s[16:19], s87 offen sc1
 v_mfma_f32_16x16x32_bf16 v[108:111], v[136:139], a[148:151], v[108:111]
 s_waitcnt lgkmcnt(0)
 s_waitcnt vmcnt(38)
 s_barrier
 s_waitcnt vmcnt(15)
 v_mfma_f32_16x16x32_bf16 v[48:51], v[140:143], a[152:155], v[48:51]
 ds_read_b128 v[112:115], v3 offset:0
 ds_read_b128 v[116:119], v3 offset:1024
 v_mfma_f32_16x16x32_bf16 v[84:87], v[140:143], a[156:159], v[84:87]
 ds_read_b128 v[120:123], v3 offset:2048
 v_mfma_f32_16x16x32_bf16 v[52:55], v[144:147], a[152:155], v[52:55]
 ds_read_b128 v[124:127], v3 offset:3072
 v_mfma_f32_16x16x32_bf16 v[88:91], v[144:147], a[156:159], v[88:91]
 ds_read_b128 v[128:131], v3 offset:4096
 v_mfma_f32_16x16x32_bf16 v[56:59], v[148:151], a[152:155], v[56:59]
 ds_read_b128 v[132:135], v3 offset:5120
 v_mfma_f32_16x16x32_bf16 v[92:95], v[148:151], a[156:159], v[92:95]
 ds_read_b128 v[136:139], v3 offset:6144
 v_mfma_f32_16x16x32_bf16 v[60:63], v[152:155], a[152:155], v[60:63]
 s_mul_i32 s39, s32, 7168
 s_add_u32 m0, s39, 0
 s_add_u32 s40, s38, 4720640
 buffer_load_dwordx4 v1, s[12:15], s40 offen offset:0 lds
 v_mfma_f32_16x16x32_bf16 v[96:99], v[152:155], a[156:159], v[96:99]
 buffer_load_dwordx4 v1, s[12:15], s40 offen offset:1024 lds
 buffer_load_dwordx4 v1, s[12:15], s40 offen offset:2048 lds
 v_mfma_f32_16x16x32_bf16 v[64:67], v[156:159], a[152:155], v[64:67]
 buffer_load_dwordx4 v1, s[12:15], s40 offen offset:3072 lds
 v_mfma_f32_16x16x32_bf16 v[100:103], v[156:159], a[156:159], v[100:103]
 s_mul_i32 s39, s32, 7168
 s_add_u32 m0, s39, 4096
 s_add_u32 s40, s38, 4724736
 buffer_load_dwordx4 v1, s[12:15], s40 offen offset:0 lds
 v_mfma_f32_16x16x32_bf16 v[68:71], v[160:163], a[152:155], v[68:71]
 buffer_load_dwordx4 v1, s[12:15], s40 offen offset:1024 lds
 v_mfma_f32_16x16x32_bf16 v[104:107], v[160:163], a[156:159], v[104:107]
 buffer_load_dwordx4 v1, s[12:15], s40 offen offset:2048 lds
 v_mfma_f32_16x16x32_bf16 v[72:75], v[164:167], a[152:155], v[72:75]
 s_add_u32 s87, s37, 18432
 buffer_load_dwordx4 a[192:195], v1, s[16:19], s87 offen sc1
 v_mfma_f32_16x16x32_bf16 v[108:111], v[164:167], a[156:159], v[108:111]
 s_add_u32 s87, s37, 165888
 buffer_load_dwordx4 a[196:199], v1, s[16:19], s87 offen sc1
 s_waitcnt lgkmcnt(0)
 s_waitcnt vmcnt(15)
 v_mfma_f32_16x16x32_bf16 v[48:51], v[112:115], a[160:163], v[48:51]
 ds_read_b128 v[140:143], v3 offset:7168
 v_mfma_f32_16x16x32_bf16 v[84:87], v[112:115], a[164:167], v[84:87]
 ds_read_b128 v[144:147], v3 offset:8192
 v_mfma_f32_16x16x32_bf16 v[52:55], v[116:119], a[160:163], v[52:55]
 v_mfma_f32_16x16x32_bf16 v[88:91], v[116:119], a[164:167], v[88:91]
 ds_read_b128 v[148:151], v3 offset:9216
 v_mfma_f32_16x16x32_bf16 v[56:59], v[120:123], a[160:163], v[56:59]
 ds_read_b128 v[152:155], v3 offset:10240
 v_mfma_f32_16x16x32_bf16 v[92:95], v[120:123], a[164:167], v[92:95]
 v_mfma_f32_16x16x32_bf16 v[60:63], v[124:127], a[160:163], v[60:63]
 ds_read_b128 v[156:159], v3 offset:11264
 v_mfma_f32_16x16x32_bf16 v[96:99], v[124:127], a[164:167], v[96:99]
 ds_read_b128 v[160:163], v3 offset:12288
 v_mfma_f32_16x16x32_bf16 v[64:67], v[128:131], a[160:163], v[64:67]
 v_mfma_f32_16x16x32_bf16 v[100:103], v[128:131], a[164:167], v[100:103]
 ds_read_b128 v[164:167], v3 offset:13312
 v_mfma_f32_16x16x32_bf16 v[68:71], v[132:135], a[160:163], v[68:71]
 s_add_u32 s87, s37, 19456
 buffer_load_dwordx4 a[200:203], v1, s[16:19], s87 offen sc1
 v_mfma_f32_16x16x32_bf16 v[104:107], v[132:135], a[164:167], v[104:107]
 v_mfma_f32_16x16x32_bf16 v[72:75], v[136:139], a[160:163], v[72:75]
 s_add_u32 s87, s37, 166912
 buffer_load_dwordx4 a[204:207], v1, s[16:19], s87 offen sc1
 v_mfma_f32_16x16x32_bf16 v[108:111], v[136:139], a[164:167], v[108:111]
 s_waitcnt lgkmcnt(0)
 s_waitcnt vmcnt(15)
 v_mfma_f32_16x16x32_bf16 v[48:51], v[140:143], a[168:171], v[48:51]
 ds_read_b128 v[112:115], v3 offset:14336
 v_mfma_f32_16x16x32_bf16 v[84:87], v[140:143], a[172:175], v[84:87]
 ds_read_b128 v[116:119], v3 offset:15360
 v_mfma_f32_16x16x32_bf16 v[52:55], v[144:147], a[168:171], v[52:55]
 v_mfma_f32_16x16x32_bf16 v[88:91], v[144:147], a[172:175], v[88:91]
 ds_read_b128 v[120:123], v3 offset:16384
 v_mfma_f32_16x16x32_bf16 v[56:59], v[148:151], a[168:171], v[56:59]
 ds_read_b128 v[124:127], v3 offset:17408
 v_mfma_f32_16x16x32_bf16 v[92:95], v[148:151], a[172:175], v[92:95]
 v_mfma_f32_16x16x32_bf16 v[60:63], v[152:155], a[168:171], v[60:63]
 ds_read_b128 v[128:131], v3 offset:18432
 v_mfma_f32_16x16x32_bf16 v[96:99], v[152:155], a[172:175], v[96:99]
 ds_read_b128 v[132:135], v3 offset:19456
 v_mfma_f32_16x16x32_bf16 v[64:67], v[156:159], a[168:171], v[64:67]
 v_mfma_f32_16x16x32_bf16 v[100:103], v[156:159], a[172:175], v[100:103]
 ds_read_b128 v[136:139], v3 offset:20480
 v_mfma_f32_16x16x32_bf16 v[68:71], v[160:163], a[168:171], v[68:71]
 s_add_u32 s87, s37, 22528
 buffer_load_dwordx4 a[208:211], v1, s[16:19], s87 offen sc1
 v_mfma_f32_16x16x32_bf16 v[104:107], v[160:163], a[172:175], v[104:107]
 v_mfma_f32_16x16x32_bf16 v[72:75], v[164:167], a[168:171], v[72:75]
 s_add_u32 s87, s37, 169984
 buffer_load_dwordx4 a[212:215], v1, s[16:19], s87 offen sc1
 v_mfma_f32_16x16x32_bf16 v[108:111], v[164:167], a[172:175], v[108:111]
 s_waitcnt lgkmcnt(0)
 s_waitcnt vmcnt(15)
 v_mfma_f32_16x16x32_bf16 v[48:51], v[112:115], a[176:179], v[48:51]
 ds_read_b128 v[140:143], v3 offset:21504
 v_mfma_f32_16x16x32_bf16 v[84:87], v[112:115], a[180:183], v[84:87]
 ds_read_b128 v[144:147], v3 offset:22528
 v_mfma_f32_16x16x32_bf16 v[52:55], v[116:119], a[176:179], v[52:55]
 v_mfma_f32_16x16x32_bf16 v[88:91], v[116:119], a[180:183], v[88:91]
 ds_read_b128 v[148:151], v3 offset:23552
 v_mfma_f32_16x16x32_bf16 v[56:59], v[120:123], a[176:179], v[56:59]
 ds_read_b128 v[152:155], v3 offset:24576
 v_mfma_f32_16x16x32_bf16 v[92:95], v[120:123], a[180:183], v[92:95]
 v_mfma_f32_16x16x32_bf16 v[60:63], v[124:127], a[176:179], v[60:63]
 ds_read_b128 v[156:159], v3 offset:25600
 v_mfma_f32_16x16x32_bf16 v[96:99], v[124:127], a[180:183], v[96:99]
 ds_read_b128 v[160:163], v3 offset:26624
 v_mfma_f32_16x16x32_bf16 v[64:67], v[128:131], a[176:179], v[64:67]
 v_mfma_f32_16x16x32_bf16 v[100:103], v[128:131], a[180:183], v[100:103]
 ds_read_b128 v[164:167], v3 offset:27648
 v_mfma_f32_16x16x32_bf16 v[68:71], v[132:135], a[176:179], v[68:71]
 s_add_u32 s87, s37, 23552
 buffer_load_dwordx4 a[216:219], v1, s[16:19], s87 offen sc1
 v_mfma_f32_16x16x32_bf16 v[104:107], v[132:135], a[180:183], v[104:107]
 v_mfma_f32_16x16x32_bf16 v[72:75], v[136:139], a[176:179], v[72:75]
 s_add_u32 s87, s37, 171008
 buffer_load_dwordx4 a[220:223], v1, s[16:19], s87 offen sc1
 v_mfma_f32_16x16x32_bf16 v[108:111], v[136:139], a[180:183], v[108:111]
 s_waitcnt lgkmcnt(0)
 s_waitcnt vmcnt(38)
 s_barrier
 s_waitcnt vmcnt(15)
 v_mfma_f32_16x16x32_bf16 v[48:51], v[140:143], a[184:187], v[48:51]
 ds_read_b128 v[112:115], v4 offset:0
 v_mfma_f32_16x16x32_bf16 v[84:87], v[140:143], a[188:191], v[84:87]
 ds_read_b128 v[116:119], v4 offset:1024
 v_mfma_f32_16x16x32_bf16 v[52:55], v[144:147], a[184:187], v[52:55]
 v_mfma_f32_16x16x32_bf16 v[88:91], v[144:147], a[188:191], v[88:91]
 ds_read_b128 v[120:123], v4 offset:2048
 v_mfma_f32_16x16x32_bf16 v[56:59], v[148:151], a[184:187], v[56:59]
 ds_read_b128 v[124:127], v4 offset:3072
 v_mfma_f32_16x16x32_bf16 v[92:95], v[148:151], a[188:191], v[92:95]
 v_mfma_f32_16x16x32_bf16 v[60:63], v[152:155], a[184:187], v[60:63]
 ds_read_b128 v[128:131], v4 offset:4096
 v_mfma_f32_16x16x32_bf16 v[96:99], v[152:155], a[188:191], v[96:99]
 ds_read_b128 v[132:135], v4 offset:5120
 v_mfma_f32_16x16x32_bf16 v[64:67], v[156:159], a[184:187], v[64:67]
 v_mfma_f32_16x16x32_bf16 v[100:103], v[156:159], a[188:191], v[100:103]
 ds_read_b128 v[136:139], v4 offset:6144
 v_mfma_f32_16x16x32_bf16 v[68:71], v[160:163], a[184:187], v[68:71]
 s_add_u32 s87, s37, 26624
 buffer_load_dwordx4 a[224:227], v1, s[16:19], s87 offen sc1
 v_mfma_f32_16x16x32_bf16 v[104:107], v[160:163], a[188:191], v[104:107]
 v_mfma_f32_16x16x32_bf16 v[72:75], v[164:167], a[184:187], v[72:75]
 s_add_u32 s87, s37, 174080
 buffer_load_dwordx4 a[228:231], v1, s[16:19], s87 offen sc1
 v_mfma_f32_16x16x32_bf16 v[108:111], v[164:167], a[188:191], v[108:111]
 s_waitcnt lgkmcnt(0)
 s_waitcnt vmcnt(8)
 v_mfma_f32_16x16x32_bf16 v[48:51], v[112:115], a[192:195], v[48:51]
 ds_read_b128 v[140:143], v4 offset:7168
 v_mfma_f32_16x16x32_bf16 v[84:87], v[112:115], a[196:199], v[84:87]
 ds_read_b128 v[144:147], v4 offset:8192
 v_mfma_f32_16x16x32_bf16 v[52:55], v[116:119], a[192:195], v[52:55]
 v_mfma_f32_16x16x32_bf16 v[88:91], v[116:119], a[196:199], v[88:91]
 ds_read_b128 v[148:151], v4 offset:9216
 v_mfma_f32_16x16x32_bf16 v[56:59], v[120:123], a[192:195], v[56:59]
 ds_read_b128 v[152:155], v4 offset:10240
 v_mfma_f32_16x16x32_bf16 v[92:95], v[120:123], a[196:199], v[92:95]
 v_mfma_f32_16x16x32_bf16 v[60:63], v[124:127], a[192:195], v[60:63]
 ds_read_b128 v[156:159], v4 offset:11264
 v_mfma_f32_16x16x32_bf16 v[96:99], v[124:127], a[196:199], v[96:99]
 ds_read_b128 v[160:163], v4 offset:12288
 v_mfma_f32_16x16x32_bf16 v[64:67], v[128:131], a[192:195], v[64:67]
 v_mfma_f32_16x16x32_bf16 v[100:103], v[128:131], a[196:199], v[100:103]
 ds_read_b128 v[164:167], v4 offset:13312
 v_mfma_f32_16x16x32_bf16 v[68:71], v[132:135], a[192:195], v[68:71]
 s_add_u32 s87, s37, 27648
 buffer_load_dwordx4 a[232:235], v1, s[16:19], s87 offen sc1
 v_mfma_f32_16x16x32_bf16 v[104:107], v[132:135], a[196:199], v[104:107]
 v_mfma_f32_16x16x32_bf16 v[72:75], v[136:139], a[192:195], v[72:75]
 s_add_u32 s87, s37, 175104
 buffer_load_dwordx4 a[236:239], v1, s[16:19], s87 offen sc1
 v_mfma_f32_16x16x32_bf16 v[108:111], v[136:139], a[196:199], v[108:111]
 s_waitcnt lgkmcnt(0)
 s_waitcnt vmcnt(8)
 v_mfma_f32_16x16x32_bf16 v[48:51], v[140:143], a[200:203], v[48:51]
 ds_read_b128 v[112:115], v4 offset:14336
 v_mfma_f32_16x16x32_bf16 v[84:87], v[140:143], a[204:207], v[84:87]
 ds_read_b128 v[116:119], v4 offset:15360
 v_mfma_f32_16x16x32_bf16 v[52:55], v[144:147], a[200:203], v[52:55]
 v_mfma_f32_16x16x32_bf16 v[88:91], v[144:147], a[204:207], v[88:91]
 ds_read_b128 v[120:123], v4 offset:16384
 v_mfma_f32_16x16x32_bf16 v[56:59], v[148:151], a[200:203], v[56:59]
 ds_read_b128 v[124:127], v4 offset:17408
 v_mfma_f32_16x16x32_bf16 v[92:95], v[148:151], a[204:207], v[92:95]
 v_mfma_f32_16x16x32_bf16 v[60:63], v[152:155], a[200:203], v[60:63]
 ds_read_b128 v[128:131], v4 offset:18432
 v_mfma_f32_16x16x32_bf16 v[96:99], v[152:155], a[204:207], v[96:99]
 ds_read_b128 v[132:135], v4 offset:19456
 v_mfma_f32_16x16x32_bf16 v[64:67], v[156:159], a[200:203], v[64:67]
 v_mfma_f32_16x16x32_bf16 v[100:103], v[156:159], a[204:207], v[100:103]
 ds_read_b128 v[136:139], v4 offset:20480
 v_mfma_f32_16x16x32_bf16 v[68:71], v[160:163], a[200:203], v[68:71]
 s_add_u32 s87, s37, 30720
 buffer_load_dwordx4 a[240:243], v1, s[16:19], s87 offen sc1
 v_mfma_f32_16x16x32_bf16 v[104:107], v[160:163], a[204:207], v[104:107]
 v_mfma_f32_16x16x32_bf16 v[72:75], v[164:167], a[200:203], v[72:75]
 s_add_u32 s87, s37, 178176
 buffer_load_dwordx4 a[244:247], v1, s[16:19], s87 offen sc1
 v_mfma_f32_16x16x32_bf16 v[108:111], v[164:167], a[204:207], v[108:111]
 s_waitcnt lgkmcnt(0)
 s_waitcnt vmcnt(8)
 v_mfma_f32_16x16x32_bf16 v[48:51], v[112:115], a[208:211], v[48:51]
 ds_read_b128 v[140:143], v4 offset:21504
 v_mfma_f32_16x16x32_bf16 v[84:87], v[112:115], a[212:215], v[84:87]
 ds_read_b128 v[144:147], v4 offset:22528
 v_mfma_f32_16x16x32_bf16 v[52:55], v[116:119], a[208:211], v[52:55]
 v_mfma_f32_16x16x32_bf16 v[88:91], v[116:119], a[212:215], v[88:91]
 ds_read_b128 v[148:151], v4 offset:23552
 v_mfma_f32_16x16x32_bf16 v[56:59], v[120:123], a[208:211], v[56:59]
 ds_read_b128 v[152:155], v4 offset:24576
 v_mfma_f32_16x16x32_bf16 v[92:95], v[120:123], a[212:215], v[92:95]
 v_mfma_f32_16x16x32_bf16 v[60:63], v[124:127], a[208:211], v[60:63]
 ds_read_b128 v[156:159], v4 offset:25600
 v_mfma_f32_16x16x32_bf16 v[96:99], v[124:127], a[212:215], v[96:99]
 ds_read_b128 v[160:163], v4 offset:26624
 v_mfma_f32_16x16x32_bf16 v[64:67], v[128:131], a[208:211], v[64:67]
 v_mfma_f32_16x16x32_bf16 v[100:103], v[128:131], a[212:215], v[100:103]
 ds_read_b128 v[164:167], v4 offset:27648
 v_mfma_f32_16x16x32_bf16 v[68:71], v[132:135], a[208:211], v[68:71]
 s_add_u32 s87, s37, 31744
 buffer_load_dwordx4 a[248:251], v1, s[16:19], s87 offen sc1
 v_mfma_f32_16x16x32_bf16 v[104:107], v[132:135], a[212:215], v[104:107]
 v_mfma_f32_16x16x32_bf16 v[72:75], v[136:139], a[208:211], v[72:75]
 s_add_u32 s87, s37, 179200
 buffer_load_dwordx4 a[252:255], v1, s[16:19], s87 offen sc1
 v_mfma_f32_16x16x32_bf16 v[108:111], v[136:139], a[212:215], v[108:111]
 s_waitcnt lgkmcnt(0)
 s_waitcnt vmcnt(31)
 s_barrier
 s_waitcnt vmcnt(8)
 v_mfma_f32_16x16x32_bf16 v[48:51], v[140:143], a[216:219], v[48:51]
 ds_read_b128 v[112:115], v5 offset:0
 v_mfma_f32_16x16x32_bf16 v[84:87], v[140:143], a[220:223], v[84:87]
 ds_read_b128 v[116:119], v5 offset:1024
 v_mfma_f32_16x16x32_bf16 v[52:55], v[144:147], a[216:219], v[52:55]
 v_mfma_f32_16x16x32_bf16 v[88:91], v[144:147], a[220:223], v[88:91]
 ds_read_b128 v[120:123], v5 offset:2048
 v_mfma_f32_16x16x32_bf16 v[56:59], v[148:151], a[216:219], v[56:59]
 ds_read_b128 v[124:127], v5 offset:3072
 v_mfma_f32_16x16x32_bf16 v[92:95], v[148:151], a[220:223], v[92:95]
 v_mfma_f32_16x16x32_bf16 v[60:63], v[152:155], a[216:219], v[60:63]
 ds_read_b128 v[128:131], v5 offset:4096
 v_mfma_f32_16x16x32_bf16 v[96:99], v[152:155], a[220:223], v[96:99]
 ds_read_b128 v[132:135], v5 offset:5120
 v_mfma_f32_16x16x32_bf16 v[64:67], v[156:159], a[216:219], v[64:67]
 v_mfma_f32_16x16x32_bf16 v[100:103], v[156:159], a[220:223], v[100:103]
 ds_read_b128 v[136:139], v5 offset:6144
 v_mfma_f32_16x16x32_bf16 v[68:71], v[160:163], a[216:219], v[68:71]
 s_add_u32 s87, s37, 131072
 buffer_load_dwordx4 v[8:11], v1, s[16:19], s87 offen sc1
 v_mfma_f32_16x16x32_bf16 v[104:107], v[160:163], a[220:223], v[104:107]
 v_mfma_f32_16x16x32_bf16 v[72:75], v[164:167], a[216:219], v[72:75]
 s_add_u32 s87, s37, 278528
 buffer_load_dwordx4 v[12:15], v1, s[16:19], s87 offen sc1
 v_mfma_f32_16x16x32_bf16 v[108:111], v[164:167], a[220:223], v[108:111]
 s_waitcnt lgkmcnt(0)
 s_waitcnt vmcnt(8)
 v_mfma_f32_16x16x32_bf16 v[48:51], v[112:115], a[224:227], v[48:51]
 ds_read_b128 v[140:143], v5 offset:7168
 v_mfma_f32_16x16x32_bf16 v[84:87], v[112:115], a[228:231], v[84:87]
 ds_read_b128 v[144:147], v5 offset:8192
 v_mfma_f32_16x16x32_bf16 v[52:55], v[116:119], a[224:227], v[52:55]
 v_mfma_f32_16x16x32_bf16 v[88:91], v[116:119], a[228:231], v[88:91]
 ds_read_b128 v[148:151], v5 offset:9216
 v_mfma_f32_16x16x32_bf16 v[56:59], v[120:123], a[224:227], v[56:59]
 ds_read_b128 v[152:155], v5 offset:10240
 v_mfma_f32_16x16x32_bf16 v[92:95], v[120:123], a[228:231], v[92:95]
 v_mfma_f32_16x16x32_bf16 v[60:63], v[124:127], a[224:227], v[60:63]
 ds_read_b128 v[156:159], v5 offset:11264
 v_mfma_f32_16x16x32_bf16 v[96:99], v[124:127], a[228:231], v[96:99]
 ds_read_b128 v[160:163], v5 offset:12288
 v_mfma_f32_16x16x32_bf16 v[64:67], v[128:131], a[224:227], v[64:67]
 v_mfma_f32_16x16x32_bf16 v[100:103], v[128:131], a[228:231], v[100:103]
 ds_read_b128 v[164:167], v5 offset:13312
 v_mfma_f32_16x16x32_bf16 v[68:71], v[132:135], a[224:227], v[68:71]
 s_add_u32 s87, s37, 132096
 buffer_load_dwordx4 v[16:19], v1, s[16:19], s87 offen sc1
 v_mfma_f32_16x16x32_bf16 v[104:107], v[132:135], a[228:231], v[104:107]
 v_mfma_f32_16x16x32_bf16 v[72:75], v[136:139], a[224:227], v[72:75]
 s_add_u32 s87, s37, 279552
 buffer_load_dwordx4 v[20:23], v1, s[16:19], s87 offen sc1
 v_mfma_f32_16x16x32_bf16 v[108:111], v[136:139], a[228:231], v[108:111]
 s_waitcnt lgkmcnt(0)
 s_waitcnt vmcnt(8)
 v_mfma_f32_16x16x32_bf16 v[48:51], v[140:143], a[232:235], v[48:51]
 ds_read_b128 v[112:115], v5 offset:14336
 v_mfma_f32_16x16x32_bf16 v[84:87], v[140:143], a[236:239], v[84:87]
 ds_read_b128 v[116:119], v5 offset:15360
 v_mfma_f32_16x16x32_bf16 v[52:55], v[144:147], a[232:235], v[52:55]
 v_mfma_f32_16x16x32_bf16 v[88:91], v[144:147], a[236:239], v[88:91]
 ds_read_b128 v[120:123], v5 offset:16384
 v_mfma_f32_16x16x32_bf16 v[56:59], v[148:151], a[232:235], v[56:59]
 ds_read_b128 v[124:127], v5 offset:17408
 v_mfma_f32_16x16x32_bf16 v[92:95], v[148:151], a[236:239], v[92:95]
 v_mfma_f32_16x16x32_bf16 v[60:63], v[152:155], a[232:235], v[60:63]
 ds_read_b128 v[128:131], v5 offset:18432
 v_mfma_f32_16x16x32_bf16 v[96:99], v[152:155], a[236:239], v[96:99]
 ds_read_b128 v[132:135], v5 offset:19456
 v_mfma_f32_16x16x32_bf16 v[64:67], v[156:159], a[232:235], v[64:67]
 v_mfma_f32_16x16x32_bf16 v[100:103], v[156:159], a[236:239], v[100:103]
 ds_read_b128 v[136:139], v5 offset:20480
 v_mfma_f32_16x16x32_bf16 v[68:71], v[160:163], a[232:235], v[68:71]
 s_add_u32 s87, s37, 133120
 buffer_load_dwordx4 v[24:27], v1, s[16:19], s87 offen sc1
 v_mfma_f32_16x16x32_bf16 v[104:107], v[160:163], a[236:239], v[104:107]
 v_mfma_f32_16x16x32_bf16 v[72:75], v[164:167], a[232:235], v[72:75]
 s_add_u32 s87, s37, 280576
 buffer_load_dwordx4 v[28:31], v1, s[16:19], s87 offen sc1
 v_mfma_f32_16x16x32_bf16 v[108:111], v[164:167], a[236:239], v[108:111]
 s_waitcnt lgkmcnt(0)
 s_waitcnt vmcnt(8)
 v_mfma_f32_16x16x32_bf16 v[48:51], v[112:115], a[240:243], v[48:51]
 ds_read_b128 v[140:143], v5 offset:21504
 v_mfma_f32_16x16x32_bf16 v[84:87], v[112:115], a[244:247], v[84:87]
 ds_read_b128 v[144:147], v5 offset:22528
 v_mfma_f32_16x16x32_bf16 v[52:55], v[116:119], a[240:243], v[52:55]
 v_mfma_f32_16x16x32_bf16 v[88:91], v[116:119], a[244:247], v[88:91]
 ds_read_b128 v[148:151], v5 offset:23552
 v_mfma_f32_16x16x32_bf16 v[56:59], v[120:123], a[240:243], v[56:59]
 ds_read_b128 v[152:155], v5 offset:24576
 v_mfma_f32_16x16x32_bf16 v[92:95], v[120:123], a[244:247], v[92:95]
 v_mfma_f32_16x16x32_bf16 v[60:63], v[124:127], a[240:243], v[60:63]
 ds_read_b128 v[156:159], v5 offset:25600
 v_mfma_f32_16x16x32_bf16 v[96:99], v[124:127], a[244:247], v[96:99]
 ds_read_b128 v[160:163], v5 offset:26624
 v_mfma_f32_16x16x32_bf16 v[64:67], v[128:131], a[240:243], v[64:67]
 v_mfma_f32_16x16x32_bf16 v[100:103], v[128:131], a[244:247], v[100:103]
 ds_read_b128 v[164:167], v5 offset:27648
 v_mfma_f32_16x16x32_bf16 v[68:71], v[132:135], a[240:243], v[68:71]
 s_add_u32 s87, s37, 134144
 buffer_load_dwordx4 v[32:35], v1, s[16:19], s87 offen sc1
 v_mfma_f32_16x16x32_bf16 v[104:107], v[132:135], a[244:247], v[104:107]
 v_mfma_f32_16x16x32_bf16 v[72:75], v[136:139], a[240:243], v[72:75]
 s_add_u32 s87, s37, 281600
 buffer_load_dwordx4 v[36:39], v1, s[16:19], s87 offen sc1
 v_mfma_f32_16x16x32_bf16 v[108:111], v[136:139], a[244:247], v[108:111]
 s_waitcnt lgkmcnt(0)
 s_waitcnt vmcnt(24)
 s_barrier
 s_waitcnt vmcnt(8)
 v_mfma_f32_16x16x32_bf16 v[48:51], v[140:143], a[248:251], v[48:51]
 ds_read_b128 v[112:115], v2 offset:0
 v_mfma_f32_16x16x32_bf16 v[84:87], v[140:143], a[252:255], v[84:87]
 ds_read_b128 v[116:119], v2 offset:1024
 v_mfma_f32_16x16x32_bf16 v[52:55], v[144:147], a[248:251], v[52:55]
 ds_read_b128 v[120:123], v2 offset:2048
 v_mfma_f32_16x16x32_bf16 v[88:91], v[144:147], a[252:255], v[88:91]
 ds_read_b128 v[124:127], v2 offset:3072
 v_mfma_f32_16x16x32_bf16 v[56:59], v[148:151], a[248:251], v[56:59]
 ds_read_b128 v[128:131], v2 offset:4096
 v_mfma_f32_16x16x32_bf16 v[92:95], v[148:151], a[252:255], v[92:95]
 ds_read_b128 v[132:135], v2 offset:5120
 v_mfma_f32_16x16x32_bf16 v[60:63], v[152:155], a[248:251], v[60:63]
 ds_read_b128 v[136:139], v2 offset:6144
 v_mfma_f32_16x16x32_bf16 v[96:99], v[152:155], a[252:255], v[96:99]
 s_add_u32 s81, s80, 0
 s_and_b32 s82, s81, 15
 s_lshr_b32 s83, s82, 1
 s_lshl_b32 s83, s83, 2
 s_and_b32 s82, s82, 1
 s_add_u32 s83, s83, s82
 s_lshr_b32 s82, s81, 4
 s_lshl_b32 s82, s82, 1
 s_add_u32 s83, s83, s82
 s_add_u32 s83, s83, 0
 s_add_u32 s82, s81, 96
 s_cmp_ge_u32 s81, 32
 s_cselect_b32 s83, s82, s83
 s_mul_i32 s83, s83, 36864
 s_add_u32 s83, s83, s41
 s_add_u32 s40, s83, 0
 s_mul_i32 s39, s32, 6144
 s_add_u32 m0, s39, 36864
 s_nop 0
 buffer_load_dwordx4 v1, s[12:15], s40 offen offset:0 lds
 v_mfma_f32_16x16x32_bf16 v[64:67], v[156:159], a[248:251], v[64:67]
 buffer_load_dwordx4 v1, s[12:15], s40 offen offset:1024 lds
 v_mfma_f32_16x16x32_bf16 v[100:103], v[156:159], a[252:255], v[100:103]
 s_add_u32 s81, s80, 1
 s_and_b32 s82, s81, 15
 s_lshr_b32 s83, s82, 1
 s_lshl_b32 s83, s83, 2
 s_and_b32 s82, s82, 1
 s_add_u32 s83, s83, s82
 s_lshr_b32 s82, s81, 4
 s_lshl_b32 s82, s82, 1
 s_add_u32 s83, s83, s82
 s_add_u32 s83, s83, 0
 s_add_u32 s82, s81, 96
 s_cmp_ge_u32 s81, 32
 s_cselect_b32 s83, s82, s83
 s_mul_i32 s83, s83, 36864
 s_add_u32 s83, s83, s41
 s_add_u32 s40, s83, 0
 s_mul_i32 s39, s32, 6144
 s_add_u32 m0, s39, 38912
 s_nop 0
 buffer_load_dwordx4 v1, s[12:15], s40 offen offset:0 lds
 v_mfma_f32_16x16x32_bf16 v[68:71], v[160:163], a[248:251], v[68:71]
 buffer_load_dwordx4 v1, s[12:15], s40 offen offset:1024 lds
 v_mfma_f32_16x16x32_bf16 v[104:107], v[160:163], a[252:255], v[104:107]
 s_add_u32 s81, s80, 2
 s_and_b32 s82, s81, 15
 s_lshr_b32 s83, s82, 1
 s_lshl_b32 s83, s83, 2
 s_and_b32 s82, s82, 1
 s_add_u32 s83, s83, s82
 s_lshr_b32 s82, s81, 4
 s_lshl_b32 s82, s82, 1
 s_add_u32 s83, s83, s82
 s_add_u32 s83, s83, 0
 s_add_u32 s82, s81, 96
 s_cmp_ge_u32 s81, 32
 s_cselect_b32 s83, s82, s83
 s_mul_i32 s83, s83, 36864
 s_add_u32 s83, s83, s41
 s_add_u32 s40, s83, 0
 s_mul_i32 s39, s32, 6144
 s_add_u32 m0, s39, 40960
 s_nop 0
 buffer_load_dwordx4 v1, s[12:15], s40 offen offset:0 lds
 v_mfma_f32_16x16x32_bf16 v[72:75], v[164:167], a[248:251], v[72:75]
 buffer_load_dwordx4 v1, s[12:15], s40 offen offset:1024 lds
 v_mfma_f32_16x16x32_bf16 v[108:111], v[164:167], a[252:255], v[108:111]
 s_waitcnt lgkmcnt(0)
 s_waitcnt vmcnt(12)
 v_mfma_f32_16x16x32_bf16 v[48:51], v[112:115], v[8:11], v[48:51]
 ds_read_b128 v[140:143], v2 offset:7168
 v_mfma_f32_16x16x32_bf16 v[84:87], v[112:115], v[12:15], v[84:87]
 v_mfma_f32_16x16x32_bf16 v[52:55], v[116:119], v[8:11], v[52:55]
 ds_read_b128 v[144:147], v2 offset:8192
 v_mfma_f32_16x16x32_bf16 v[88:91], v[116:119], v[12:15], v[88:91]
 v_mfma_f32_16x16x32_bf16 v[56:59], v[120:123], v[8:11], v[56:59]
 ds_read_b128 v[148:151], v2 offset:9216
 v_mfma_f32_16x16x32_bf16 v[92:95], v[120:123], v[12:15], v[92:95]
 v_mfma_f32_16x16x32_bf16 v[60:63], v[124:127], v[8:11], v[60:63]
 ds_read_b128 v[152:155], v2 offset:10240
 v_mfma_f32_16x16x32_bf16 v[96:99], v[124:127], v[12:15], v[96:99]
 v_mfma_f32_16x16x32_bf16 v[64:67], v[128:131], v[8:11], v[64:67]
 ds_read_b128 v[156:159], v2 offset:11264
 v_mfma_f32_16x16x32_bf16 v[100:103], v[128:131], v[12:15], v[100:103]
 v_mfma_f32_16x16x32_bf16 v[68:71], v[132:135], v[8:11], v[68:71]
 ds_read_b128 v[160:163], v2 offset:12288
 v_mfma_f32_16x16x32_bf16 v[104:107], v[132:135], v[12:15], v[104:107]
 v_mfma_f32_16x16x32_bf16 v[72:75], v[136:139], v[8:11], v[72:75]
 ds_read_b128 v[164:167], v2 offset:13312
 v_mfma_f32_16x16x32_bf16 v[108:111], v[136:139], v[12:15], v[108:111]
 s_waitcnt lgkmcnt(0)
 s_waitcnt vmcnt(10)
 v_mfma_f32_16x16x32_bf16 v[48:51], v[140:143], v[16:19], v[48:51]
 ds_read_b128 v[112:115], v2 offset:14336
 v_mfma_f32_16x16x32_bf16 v[84:87], v[140:143], v[20:23], v[84:87]
 v_mfma_f32_16x16x32_bf16 v[52:55], v[144:147], v[16:19], v[52:55]
 ds_read_b128 v[116:119], v2 offset:15360
 v_mfma_f32_16x16x32_bf16 v[88:91], v[144:147], v[20:23], v[88:91]
 v_mfma_f32_16x16x32_bf16 v[56:59], v[148:151], v[16:19], v[56:59]
 ds_read_b128 v[120:123], v2 offset:16384
 v_mfma_f32_16x16x32_bf16 v[92:95], v[148:151], v[20:23], v[92:95]
 v_mfma_f32_16x16x32_bf16 v[60:63], v[152:155], v[16:19], v[60:63]
 ds_read_b128 v[124:127], v2 offset:17408
 v_mfma_f32_16x16x32_bf16 v[96:99], v[152:155], v[20:23], v[96:99]
 v_mfma_f32_16x16x32_bf16 v[64:67], v[156:159], v[16:19], v[64:67]
 ds_read_b128 v[128:131], v2 offset:18432
 v_mfma_f32_16x16x32_bf16 v[100:103], v[156:159], v[20:23], v[100:103]
 v_mfma_f32_16x16x32_bf16 v[68:71], v[160:163], v[16:19], v[68:71]
 ds_read_b128 v[132:135], v2 offset:19456
 v_mfma_f32_16x16x32_bf16 v[104:107], v[160:163], v[20:23], v[104:107]
 v_mfma_f32_16x16x32_bf16 v[72:75], v[164:167], v[16:19], v[72:75]
 ds_read_b128 v[136:139], v2 offset:20480
 v_mfma_f32_16x16x32_bf16 v[108:111], v[164:167], v[20:23], v[108:111]
 s_waitcnt lgkmcnt(0)
 s_waitcnt vmcnt(8)
 v_mfma_f32_16x16x32_bf16 v[48:51], v[112:115], v[24:27], v[48:51]
 ds_read_b128 v[140:143], v2 offset:21504
 v_mfma_f32_16x16x32_bf16 v[84:87], v[112:115], v[28:31], v[84:87]
 v_mfma_f32_16x16x32_bf16 v[52:55], v[116:119], v[24:27], v[52:55]
 ds_read_b128 v[144:147], v2 offset:22528
 v_mfma_f32_16x16x32_bf16 v[88:91], v[116:119], v[28:31], v[88:91]
 v_mfma_f32_16x16x32_bf16 v[56:59], v[120:123], v[24:27], v[56:59]
 ds_read_b128 v[148:151], v2 offset:23552
 v_mfma_f32_16x16x32_bf16 v[92:95], v[120:123], v[28:31], v[92:95]
 v_mfma_f32_16x16x32_bf16 v[60:63], v[124:127], v[24:27], v[60:63]
 ds_read_b128 v[152:155], v2 offset:24576
 v_mfma_f32_16x16x32_bf16 v[96:99], v[124:127], v[28:31], v[96:99]
 v_mfma_f32_16x16x32_bf16 v[64:67], v[128:131], v[24:27], v[64:67]
 ds_read_b128 v[156:159], v2 offset:25600
 v_mfma_f32_16x16x32_bf16 v[100:103], v[128:131], v[28:31], v[100:103]
 v_mfma_f32_16x16x32_bf16 v[68:71], v[132:135], v[24:27], v[68:71]
 ds_read_b128 v[160:163], v2 offset:26624
 v_mfma_f32_16x16x32_bf16 v[104:107], v[132:135], v[28:31], v[104:107]
 v_mfma_f32_16x16x32_bf16 v[72:75], v[136:139], v[24:27], v[72:75]
 ds_read_b128 v[164:167], v2 offset:27648
 v_mfma_f32_16x16x32_bf16 v[108:111], v[136:139], v[28:31], v[108:111]
 s_waitcnt lgkmcnt(0)
 s_waitcnt vmcnt(0)
 s_barrier
 s_waitcnt vmcnt(6)
 v_mfma_f32_16x16x32_bf16 v[48:51], v[140:143], v[32:35], v[48:51]
 ds_read_b128 v[112:115], v3 offset:0
 v_mfma_f32_16x16x32_bf16 v[84:87], v[140:143], v[36:39], v[84:87]
 ds_read_b128 v[116:119], v3 offset:1024
 v_mfma_f32_16x16x32_bf16 v[52:55], v[144:147], v[32:35], v[52:55]
 v_mfma_f32_16x16x32_bf16 v[88:91], v[144:147], v[36:39], v[88:91]
 s_add_u32 s81, s80, 12
 s_and_b32 s82, s81, 15
 s_lshr_b32 s83, s82, 1
 s_lshl_b32 s83, s83, 2
 s_and_b32 s82, s82, 1
 s_add_u32 s83, s83, s82
 s_lshr_b32 s82, s81, 4
 s_lshl_b32 s82, s82, 1
 s_add_u32 s83, s83, s82
 s_add_u32 s83, s83, 0
 s_add_u32 s82, s81, 96
 s_cmp_ge_u32 s81, 32
 s_cselect_b32 s83, s82, s83
 s_mul_i32 s83, s83, 36864
 s_add_u32 s83, s83, s41
 s_add_u32 s40, s83, 0
 s_mul_i32 s39, s32, 6144
 s_add_u32 m0, s39, 73728
 s_nop 0
 buffer_load_dwordx4 v1, s[12:15], s40 offen offset:0 lds
 v_mfma_f32_16x16x32_bf16 v[56:59], v[148:151], v[32:35], v[56:59]
 v_mfma_f32_16x16x32_bf16 v[92:95], v[148:151], v[36:39], v[92:95]
 buffer_load_dwordx4 v1, s[12:15], s40 offen offset:1024 lds
 v_mfma_f32_16x16x32_bf16 v[60:63], v[152:155], v[32:35], v[60:63]
 v_mfma_f32_16x16x32_bf16 v[96:99], v[152:155], v[36:39], v[96:99]
 s_add_u32 s81, s80, 13
 s_and_b32 s82, s81, 15
 s_lshr_b32 s83, s82, 1
 s_lshl_b32 s83, s83, 2
 s_and_b32 s82, s82, 1
 s_add_u32 s83, s83, s82
 s_lshr_b32 s82, s81, 4
 s_lshl_b32 s82, s82, 1
 s_add_u32 s83, s83, s82
 s_add_u32 s83, s83, 0
 s_add_u32 s82, s81, 96
 s_cmp_ge_u32 s81, 32
 s_cselect_b32 s83, s82, s83
 s_mul_i32 s83, s83, 36864
 s_add_u32 s83, s83, s41
 s_add_u32 s40, s83, 0
 s_mul_i32 s39, s32, 6144
 s_add_u32 m0, s39, 75776
 s_nop 0
 buffer_load_dwordx4 v1, s[12:15], s40 offen offset:0 lds
 v_mfma_f32_16x16x32_bf16 v[64:67], v[156:159], v[32:35], v[64:67]
 buffer_load_dwordx4 v1, s[12:15], s40 offen offset:1024 lds
 v_mfma_f32_16x16x32_bf16 v[100:103], v[156:159], v[36:39], v[100:103]
 v_mfma_f32_16x16x32_bf16 v[68:71], v[160:163], v[32:35], v[68:71]
 s_add_u32 s81, s80, 14
 s_and_b32 s82, s81, 15
 s_lshr_b32 s83, s82, 1
 s_lshl_b32 s83, s83, 2
 s_and_b32 s82, s82, 1
 s_add_u32 s83, s83, s82
 s_lshr_b32 s82, s81, 4
 s_lshl_b32 s82, s82, 1
 s_add_u32 s83, s83, s82
 s_add_u32 s83, s83, 0
 s_add_u32 s82, s81, 96
 s_cmp_ge_u32 s81, 32
 s_cselect_b32 s83, s82, s83
 s_mul_i32 s83, s83, 36864
 s_add_u32 s83, s83, s41
 s_add_u32 s40, s83, 0
 s_mul_i32 s39, s32, 6144
 s_add_u32 m0, s39, 77824
 s_nop 0
 buffer_load_dwordx4 v1, s[12:15], s40 offen offset:0 lds
 v_mfma_f32_16x16x32_bf16 v[104:107], v[160:163], v[36:39], v[104:107]
 v_mfma_f32_16x16x32_bf16 v[72:75], v[164:167], v[32:35], v[72:75]
 buffer_load_dwordx4 v1, s[12:15], s40 offen offset:1024 lds
 v_mfma_f32_16x16x32_bf16 v[108:111], v[164:167], v[36:39], v[108:111]
 s_waitcnt lgkmcnt(0)
 v_mfma_f32_16x16x32_bf16 v[40:43], v[112:115], a[0:3], 0
 ds_read_b128 v[124:127], v3 offset:2048
 ds_read_b128 v[128:131], v3 offset:3072
 ds_read_b128 v[136:139], v3 offset:4096
 v_mfma_f32_16x16x32_bf16 v[76:79], v[112:115], a[4:7], 0
 ds_read_b128 v[140:143], v3 offset:5120
 ds_read_b128 v[148:151], v3 offset:6144
 v_mfma_f32_16x16x32_bf16 v[44:47], v[116:119], a[0:3], 0
 ds_read_b128 v[152:155], v3 offset:7168
 v_lshrrev_b32 v224, 4, v0
 v_mfma_f32_16x16x32_bf16 v[80:83], v[116:119], a[4:7], 0
 v_lshlrev_b32 v224, 4, v224
 s_add_u32 s39, s58, 0
 s_and_b32 s40, s39, 1
 s_lshl_b32 s40, s40, 3
 s_lshr_b32 s39, s39, 1
 s_lshl_b32 s39, s39, 10
 s_add_u32 s39, s39, s40
 s_mul_i32 s40, s57, 18432
 s_add_u32 s39, s39, s40
 buffer_load_dwordx2 v[200:201], v1, s[44:47], s39 offen sc1
 s_add_u32 s39, s39, 18432
 s_waitcnt lgkmcnt(4)
 v_mfma_f32_16x16x32_bf16 v[40:43], v[124:127], a[8:11], v[40:43]
 v_cvt_pk_bf16_f32 v168, v48, v49
 v_cvt_pk_bf16_f32 v169, v50, v51
 v_cvt_pk_bf16_f32 v170, v52, v53
 v_cvt_pk_bf16_f32 v171, v54, v55
 v_mfma_f32_16x16x32_bf16 v[76:79], v[124:127], a[12:15], v[76:79]
 v_cvt_pk_bf16_f32 v172, v84, v85
 v_cvt_pk_bf16_f32 v173, v86, v87
 v_cvt_pk_bf16_f32 v174, v88, v89
 v_mfma_f32_16x16x32_bf16 v[44:47], v[128:131], a[8:11], v[44:47]
 v_cvt_pk_bf16_f32 v175, v90, v91
 ds_read_b128 v[112:115], v3 offset:8192
 ds_read_b128 v[116:119], v3 offset:9216
 v_mfma_f32_16x16x32_bf16 v[80:83], v[128:131], a[12:15], v[80:83]
 buffer_load_dwordx2 v[202:203], v1, s[44:47], s39 offen sc1
 s_add_u32 s39, s58, 0
 s_lshl_b32 s39, s39, 6
 s_add_u32 s39, s39, 11520
 buffer_load_dwordx4 v[212:215], v224, s[48:51], s39 offen
 s_add_u32 s39, s58, 1
 s_and_b32 s40, s39, 1
 s_lshl_b32 s40, s40, 3
 s_lshr_b32 s39, s39, 1
 s_lshl_b32 s39, s39, 10
 s_add_u32 s39, s39, s40
 s_mul_i32 s40, s57, 18432
 s_add_u32 s39, s39, s40
 buffer_load_dwordx2 v[204:205], v1, s[44:47], s39 offen sc1
 s_add_u32 s39, s39, 18432
 s_waitcnt lgkmcnt(4)
 v_mfma_f32_16x16x32_bf16 v[40:43], v[136:139], a[16:19], v[40:43]
 s_lshl_b32 s43, s42, 2
 s_add_u32 s43, s43, 1
 s_lshl_b32 s43, s43, 2
 s_add_u32 s43, s43, 0
 s_lshl_b32 s43, s43, 2
 s_add_u32 s43, s43, s32
 s_mul_i32 s43, s43, 3072
 buffer_store_dwordx4 v[168:171], v1, s[24:27], s43 offen offset:0 sc1
 buffer_store_dwordx4 v[172:175], v1, s[24:27], s43 offen offset:1024 sc1
 v_cvt_pk_bf16_f32 v176, v56, v57
 v_mfma_f32_16x16x32_bf16 v[76:79], v[136:139], a[20:23], v[76:79]
 v_cvt_pk_bf16_f32 v177, v58, v59
 v_cvt_pk_bf16_f32 v178, v60, v61
 v_cvt_pk_bf16_f32 v179, v62, v63
 v_mfma_f32_16x16x32_bf16 v[44:47], v[140:143], a[16:19], v[44:47]
 v_cvt_pk_bf16_f32 v180, v92, v93
 v_cvt_pk_bf16_f32 v181, v94, v95
 ds_read_b128 v[124:127], v3 offset:10240
 v_mfma_f32_16x16x32_bf16 v[80:83], v[140:143], a[20:23], v[80:83]
 ds_read_b128 v[128:131], v3 offset:11264
 buffer_load_dwordx2 v[206:207], v1, s[44:47], s39 offen sc1
 s_add_u32 s39, s58, 1
 s_lshl_b32 s39, s39, 6
 s_add_u32 s39, s39, 11520
 buffer_load_dwordx4 v[216:219], v224, s[48:51], s39 offen
 s_waitcnt lgkmcnt(4)
 v_mfma_f32_16x16x32_bf16 v[40:43], v[148:151], a[24:27], v[40:43]
 v_cvt_pk_bf16_f32 v182, v96, v97
 v_cvt_pk_bf16_f32 v183, v98, v99
 s_lshl_b32 s43, s42, 2
 s_add_u32 s43, s43, 2
 s_lshl_b32 s43, s43, 2
 s_add_u32 s43, s43, 0
 s_lshl_b32 s43, s43, 2
 s_add_u32 s43, s43, s32
 s_mul_i32 s43, s43, 3072
 buffer_store_dwordx4 v[176:179], v1, s[24:27], s43 offen offset:0 sc1
 v_mfma_f32_16x16x32_bf16 v[76:79], v[148:151], a[28:31], v[76:79]
 buffer_store_dwordx4 v[180:183], v1, s[24:27], s43 offen offset:1024 sc1
 v_cvt_pk_bf16_f32 v184, v64, v65
 v_mfma_f32_16x16x32_bf16 v[44:47], v[152:155], a[24:27], v[44:47]
 v_cvt_pk_bf16_f32 v185, v66, v67
 v_cvt_pk_bf16_f32 v186, v68, v69
 v_cvt_pk_bf16_f32 v187, v70, v71
 v_mfma_f32_16x16x32_bf16 v[80:83], v[152:155], a[28:31], v[80:83]
 ds_read_b128 v[136:139], v3 offset:12288
 ds_read_b128 v[140:143], v3 offset:13312
 s_waitcnt lgkmcnt(4)
 v_mfma_f32_16x16x32_bf16 v[40:43], v[112:115], a[32:35], v[40:43]
 v_cvt_pk_bf16_f32 v192, v72, v73
 v_cvt_pk_bf16_f32 v193, v74, v75
 v_cvt_pk_bf16_f32 v188, v100, v101
 v_mfma_f32_16x16x32_bf16 v[76:79], v[112:115], a[36:39], v[76:79]
 v_cvt_pk_bf16_f32 v189, v102, v103
 v_cvt_pk_bf16_f32 v190, v104, v105
 v_mfma_f32_16x16x32_bf16 v[44:47], v[116:119], a[32:35], v[44:47]
 v_cvt_pk_bf16_f32 v191, v106, v107
 v_cvt_pk_bf16_f32 v194, v108, v109
 v_cvt_pk_bf16_f32 v195, v110, v111
 v_mfma_f32_16x16x32_bf16 v[80:83], v[116:119], a[36:39], v[80:83]
 ds_read_b128 v[148:151], v3 offset:14336
 ds_read_b128 v[152:155], v3 offset:15360
 s_waitcnt lgkmcnt(4)
 v_mfma_f32_16x16x32_bf16 v[40:43], v[124:127], a[40:43], v[40:43]
 s_lshl_b32 s43, s42, 2
 s_add_u32 s43, s43, 3
 s_lshl_b32 s43, s43, 2
 s_add_u32 s43, s43, 0
 s_lshl_b32 s43, s43, 2
 s_add_u32 s43, s43, s32
 s_mul_i32 s43, s43, 3072
 buffer_store_dwordx4 v[184:187], v1, s[24:27], s43 offen offset:0 sc1
 buffer_store_dwordx4 v[188:191], v1, s[24:27], s43 offen offset:1024 sc1
 v_mfma_f32_16x16x32_bf16 v[76:79], v[124:127], a[44:47], v[76:79]
 buffer_store_dwordx4 v[192:195], v1, s[24:27], s43 offen offset:2048 sc1
 v_mfma_f32_16x16x32_bf16 v[44:47], v[128:131], a[40:43], v[44:47]
 ds_read_b128 v[112:115], v3 offset:16384
 v_mfma_f32_16x16x32_bf16 v[80:83], v[128:131], a[44:47], v[80:83]
 ds_read_b128 v[116:119], v3 offset:17408
 s_waitcnt lgkmcnt(4)
 v_mfma_f32_16x16x32_bf16 v[40:43], v[136:139], a[48:51], v[40:43]
 ds_read_b128 v[124:127], v3 offset:18432
 v_mfma_f32_16x16x32_bf16 v[76:79], v[136:139], a[52:55], v[76:79]
 v_mfma_f32_16x16x32_bf16 v[44:47], v[140:143], a[48:51], v[44:47]
 ds_read_b128 v[128:131], v3 offset:19456
 v_mfma_f32_16x16x32_bf16 v[80:83], v[140:143], a[52:55], v[80:83]
 s_waitcnt lgkmcnt(4)
 v_mfma_f32_16x16x32_bf16 v[40:43], v[148:151], a[56:59], v[40:43]
 ds_read_b128 v[136:139], v3 offset:20480
 v_mfma_f32_16x16x32_bf16 v[76:79], v[148:151], a[60:63], v[76:79]
 v_mfma_f32_16x16x32_bf16 v[44:47], v[152:155], a[56:59], v[44:47]
 ds_read_b128 v[140:143], v3 offset:21504
 v_mfma_f32_16x16x32_bf16 v[80:83], v[152:155], a[60:63], v[80:83]
 s_waitcnt lgkmcnt(4)
 v_mfma_f32_16x16x32_bf16 v[40:43], v[112:115], a[64:67], v[40:43]
 ds_read_b128 v[148:151], v3 offset:22528
 v_mfma_f32_16x16x32_bf16 v[76:79], v[112:115], a[68:71], v[76:79]
 v_mfma_f32_16x16x32_bf16 v[44:47], v[116:119], a[64:67], v[44:47]
 ds_read_b128 v[152:155], v3 offset:23552
 v_mfma_f32_16x16x32_bf16 v[80:83], v[116:119], a[68:71], v[80:83]
 s_waitcnt lgkmcnt(0)
 s_waitcnt vmcnt(13)
 s_barrier
 v_mfma_f32_16x16x32_bf16 v[40:43], v[124:127], a[72:75], v[40:43]
 ds_read_b128 v[112:115], v4 offset:0
 ds_read_b128 v[116:119], v4 offset:1024
 v_mfma_f32_16x16x32_bf16 v[76:79], v[124:127], a[76:79], v[76:79]
 s_add_u32 s81, s80, 24
 s_and_b32 s82, s81, 15
 s_lshr_b32 s83, s82, 1
 s_lshl_b32 s83, s83, 2
 s_and_b32 s82, s82, 1
 s_add_u32 s83, s83, s82
 s_lshr_b32 s82, s81, 4
 s_lshl_b32 s82, s82, 1
 s_add_u32 s83, s83, s82
 s_add_u32 s83, s83, 0
 s_add_u32 s82, s81, 96
 s_cmp_ge_u32 s81, 32
 s_cselect_b32 s83, s82, s83
 s_mul_i32 s83, s83, 36864
 s_add_u32 s83, s83, s41
 s_add_u32 s40, s83, 0
 s_mul_i32 s39, s32, 6144
 s_add_u32 m0, s39, 110592
 s_nop 0
 buffer_load_dwordx4 v1, s[12:15], s40 offen offset:0 lds
 v_mfma_f32_16x16x32_bf16 v[44:47], v[128:131], a[72:75], v[44:47]
 buffer_load_dwordx4 v1, s[12:15], s40 offen offset:1024 lds
 v_mfma_f32_16x16x32_bf16 v[80:83], v[128:131], a[76:79], v[80:83]
 s_add_u32 s81, s80, 25
 s_and_b32 s82, s81, 15
 s_lshr_b32 s83, s82, 1
 s_lshl_b32 s83, s83, 2
 s_and_b32 s82, s82, 1
 s_add_u32 s83, s83, s82
 s_lshr_b32 s82, s81, 4
 s_lshl_b32 s82, s82, 1
 s_add_u32 s83, s83, s82
 s_add_u32 s83, s83, 0
 s_add_u32 s82, s81, 96
 s_cmp_ge_u32 s81, 32
 s_cselect_b32 s83, s82, s83
 s_mul_i32 s83, s83, 36864
 s_add_u32 s83, s83, s41
 s_add_u32 s40, s83, 0
 s_mul_i32 s39, s32, 6144
 s_add_u32 m0, s39, 112640
 s_nop 0
 buffer_load_dwordx4 v1, s[12:15], s40 offen offset:0 lds
 s_waitcnt lgkmcnt(2)
 v_mfma_f32_16x16x32_bf16 v[40:43], v[136:139], a[80:83], v[40:43]
 ds_read_b128 v[124:127], v4 offset:2048
 ds_read_b128 v[128:131], v4 offset:3072
 v_mfma_f32_16x16x32_bf16 v[76:79], v[136:139], a[84:87], v[76:79]
 buffer_load_dwordx4 v1, s[12:15], s40 offen offset:1024 lds
 v_mfma_f32_16x16x32_bf16 v[44:47], v[140:143], a[80:83], v[44:47]
 s_add_u32 s81, s80, 26
 s_and_b32 s82, s81, 15
 s_lshr_b32 s83, s82, 1
 s_lshl_b32 s83, s83, 2
 s_and_b32 s82, s82, 1
 s_add_u32 s83, s83, s82
 s_lshr_b32 s82, s81, 4
 s_lshl_b32 s82, s82, 1
 s_add_u32 s83, s83, s82
 s_add_u32 s83, s83, 0
 s_add_u32 s82, s81, 96
 s_cmp_ge_u32 s81, 32
 s_cselect_b32 s83, s82, s83
 s_mul_i32 s83, s83, 36864
 s_add_u32 s83, s83, s41
 s_add_u32 s40, s83, 0
 s_mul_i32 s39, s32, 6144
 s_add_u32 m0, s39, 114688
 s_nop 0
 buffer_load_dwordx4 v1, s[12:15], s40 offen offset:0 lds
 v_mfma_f32_16x16x32_bf16 v[80:83], v[140:143], a[84:87], v[80:83]
 buffer_load_dwordx4 v1, s[12:15], s40 offen offset:1024 lds
 s_waitcnt lgkmcnt(4)
 v_mfma_f32_16x16x32_bf16 v[40:43], v[148:151], a[88:91], v[40:43]
 ds_read_b128 v[136:139], v4 offset:4096
 v_mfma_f32_16x16x32_bf16 v[76:79], v[148:151], a[92:95], v[76:79]
 v_mfma_f32_16x16x32_bf16 v[44:47], v[152:155], a[88:91], v[44:47]
 ds_read_b128 v[140:143], v4 offset:5120
 v_mfma_f32_16x16x32_bf16 v[80:83], v[152:155], a[92:95], v[80:83]
 s_waitcnt lgkmcnt(4)
 v_mfma_f32_16x16x32_bf16 v[40:43], v[112:115], a[96:99], v[40:43]
 ds_read_b128 v[148:151], v4 offset:6144
 v_mfma_f32_16x16x32_bf16 v[76:79], v[112:115], a[100:103], v[76:79]
 v_mfma_f32_16x16x32_bf16 v[44:47], v[116:119], a[96:99], v[44:47]
 ds_read_b128 v[152:155], v4 offset:7168
 v_mfma_f32_16x16x32_bf16 v[80:83], v[116:119], a[100:103], v[80:83]
 s_waitcnt lgkmcnt(4)
 v_mfma_f32_16x16x32_bf16 v[40:43], v[124:127], a[104:107], v[40:43]
 ds_read_b128 v[112:115], v4 offset:8192
 v_mfma_f32_16x16x32_bf16 v[76:79], v[124:127], a[108:111], v[76:79]
 v_mfma_f32_16x16x32_bf16 v[44:47], v[128:131], a[104:107], v[44:47]
 ds_read_b128 v[116:119], v4 offset:9216
 v_mfma_f32_16x16x32_bf16 v[80:83], v[128:131], a[108:111], v[80:83]
 s_waitcnt lgkmcnt(4)
 v_mfma_f32_16x16x32_bf16 v[40:43], v[136:139], a[112:115], v[40:43]
 ds_read_b128 v[124:127], v4 offset:10240
 v_mfma_f32_16x16x32_bf16 v[76:79], v[136:139], a[116:119], v[76:79]
 v_mfma_f32_16x16x32_bf16 v[44:47], v[140:143], a[112:115], v[44:47]
 ds_read_b128 v[128:131], v4 offset:11264
 v_mfma_f32_16x16x32_bf16 v[80:83], v[140:143], a[116:119], v[80:83]
 s_waitcnt lgkmcnt(4)
 v_mfma_f32_16x16x32_bf16 v[40:43], v[148:151], a[120:123], v[40:43]
 ds_read_b128 v[136:139], v4 offset:12288
 v_mfma_f32_16x16x32_bf16 v[76:79], v[148:151], a[124:127], v[76:79]
 v_mfma_f32_16x16x32_bf16 v[44:47], v[152:155], a[120:123], v[44:47]
 ds_read_b128 v[140:143], v4 offset:13312
 v_mfma_f32_16x16x32_bf16 v[80:83], v[152:155], a[124:127], v[80:83]
 s_waitcnt lgkmcnt(4)
 v_mfma_f32_16x16x32_bf16 v[40:43], v[112:115], a[128:131], v[40:43]
 ds_read_b128 v[148:151], v4 offset:14336
 v_mfma_f32_16x16x32_bf16 v[76:79], v[112:115], a[132:135], v[76:79]
 v_mfma_f32_16x16x32_bf16 v[44:47], v[116:119], a[128:131], v[44:47]
 ds_read_b128 v[152:155], v4 offset:15360
 v_mfma_f32_16x16x32_bf16 v[80:83], v[116:119], a[132:135], v[80:83]
 s_waitcnt lgkmcnt(4)
 v_mfma_f32_16x16x32_bf16 v[40:43], v[124:127], a[136:139], v[40:43]
 ds_read_b128 v[112:115], v4 offset:16384
 v_mfma_f32_16x16x32_bf16 v[76:79], v[124:127], a[140:143], v[76:79]
 v_mfma_f32_16x16x32_bf16 v[44:47], v[128:131], a[136:139], v[44:47]
 ds_read_b128 v[116:119], v4 offset:17408
 v_mfma_f32_16x16x32_bf16 v[80:83], v[128:131], a[140:143], v[80:83]
 s_waitcnt lgkmcnt(4)
 v_mfma_f32_16x16x32_bf16 v[40:43], v[136:139], a[144:147], v[40:43]
 ds_read_b128 v[124:127], v4 offset:18432
 v_mfma_f32_16x16x32_bf16 v[76:79], v[136:139], a[148:151], v[76:79]
 v_mfma_f32_16x16x32_bf16 v[44:47], v[140:143], a[144:147], v[44:47]
 ds_read_b128 v[128:131], v4 offset:19456
 v_mfma_f32_16x16x32_bf16 v[80:83], v[140:143], a[148:151], v[80:83]
 s_waitcnt lgkmcnt(4)
 v_mfma_f32_16x16x32_bf16 v[40:43], v[148:151], a[152:155], v[40:43]
 ds_read_b128 v[136:139], v4 offset:20480
 v_mfma_f32_16x16x32_bf16 v[76:79], v[148:151], a[156:159], v[76:79]
 v_mfma_f32_16x16x32_bf16 v[44:47], v[152:155], a[152:155], v[44:47]
 ds_read_b128 v[140:143], v4 offset:21504
 v_mfma_f32_16x16x32_bf16 v[80:83], v[152:155], a[156:159], v[80:83]
 s_waitcnt lgkmcnt(4)
 v_mfma_f32_16x16x32_bf16 v[40:43], v[112:115], a[160:163], v[40:43]
 ds_read_b128 v[148:151], v4 offset:22528
 v_mfma_f32_16x16x32_bf16 v[76:79], v[112:115], a[164:167], v[76:79]
 v_mfma_f32_16x16x32_bf16 v[44:47], v[116:119], a[160:163], v[44:47]
 ds_read_b128 v[152:155], v4 offset:23552
 v_mfma_f32_16x16x32_bf16 v[80:83], v[116:119], a[164:167], v[80:83]
 s_waitcnt lgkmcnt(0)
 s_waitcnt vmcnt(0)
 s_barrier
 v_mfma_f32_16x16x32_bf16 v[40:43], v[124:127], a[168:171], v[40:43]
 ds_read_b128 v[112:115], v5 offset:0
 v_mfma_f32_16x16x32_bf16 v[76:79], v[124:127], a[172:175], v[76:79]
 v_mfma_f32_16x16x32_bf16 v[44:47], v[128:131], a[168:171], v[44:47]
 ds_read_b128 v[116:119], v5 offset:1024
 v_mfma_f32_16x16x32_bf16 v[80:83], v[128:131], a[172:175], v[80:83]
 s_waitcnt lgkmcnt(2)
 v_mfma_f32_16x16x32_bf16 v[40:43], v[136:139], a[176:179], v[40:43]
 ds_read_b128 v[124:127], v5 offset:2048
 v_mfma_f32_16x16x32_bf16 v[76:79], v[136:139], a[180:183], v[76:79]
 v_mfma_f32_16x16x32_bf16 v[44:47], v[140:143], a[176:179], v[44:47]
 ds_read_b128 v[128:131], v5 offset:3072
 v_mfma_f32_16x16x32_bf16 v[80:83], v[140:143], a[180:183], v[80:83]
 s_waitcnt lgkmcnt(4)
 v_mfma_f32_16x16x32_bf16 v[40:43], v[148:151], a[184:187], v[40:43]
 ds_read_b128 v[136:139], v5 offset:4096
 v_mfma_f32_16x16x32_bf16 v[76:79], v[148:151], a[188:191], v[76:79]
 v_mfma_f32_16x16x32_bf16 v[44:47], v[152:155], a[184:187], v[44:47]
 ds_read_b128 v[140:143], v5 offset:5120
 v_mfma_f32_16x16x32_bf16 v[80:83], v[152:155], a[188:191], v[80:83]
 s_waitcnt lgkmcnt(4)
 v_mfma_f32_16x16x32_bf16 v[40:43], v[112:115], a[192:195], v[40:43]
 ds_read_b128 v[148:151], v5 offset:6144
 v_mfma_f32_16x16x32_bf16 v[76:79], v[112:115], a[196:199], v[76:79]
 v_mfma_f32_16x16x32_bf16 v[44:47], v[116:119], a[192:195], v[44:47]
 ds_read_b128 v[152:155], v5 offset:7168
 v_mfma_f32_16x16x32_bf16 v[80:83], v[116:119], a[196:199], v[80:83]
 s_waitcnt lgkmcnt(4)
 v_mfma_f32_16x16x32_bf16 v[40:43], v[124:127], a[200:203], v[40:43]
 ds_read_b128 v[112:115], v5 offset:8192
 v_mfma_f32_16x16x32_bf16 v[76:79], v[124:127], a[204:207], v[76:79]
 v_mfma_f32_16x16x32_bf16 v[44:47], v[128:131], a[200:203], v[44:47]
 ds_read_b128 v[116:119], v5 offset:9216
 v_mfma_f32_16x16x32_bf16 v[80:83], v[128:131], a[204:207], v[80:83]
 s_waitcnt lgkmcnt(4)
 s_waitcnt vmcnt(6)
 s_barrier
 s_cmp_eq_u32 s32, 0
 s_cbranch_scc0 L_g2_nosig0
 v_mov_b32 v225, 1
 s_mov_b64 s[76:77], exec
 s_mov_b64 exec, 1
 buffer_atomic_add v225, v6, s[28:31], 0 offen sc1
 s_mov_b64 exec, s[76:77]
L_g2_nosig0:
 s_nop 0
 s_nop 2
 v_mfma_f32_16x16x32_bf16 v[40:43], v[136:139], a[208:211], v[40:43]
 ds_read_b128 v[124:127], v5 offset:10240
 v_mfma_f32_16x16x32_bf16 v[76:79], v[136:139], a[212:215], v[76:79]
 v_mfma_f32_16x16x32_bf16 v[44:47], v[140:143], a[208:211], v[44:47]
 ds_read_b128 v[128:131], v5 offset:11264
 v_mfma_f32_16x16x32_bf16 v[80:83], v[140:143], a[212:215], v[80:83]
 s_waitcnt lgkmcnt(4)
 v_mfma_f32_16x16x32_bf16 v[40:43], v[148:151], a[216:219], v[40:43]
 ds_read_b128 v[136:139], v5 offset:12288
 v_mfma_f32_16x16x32_bf16 v[76:79], v[148:151], a[220:223], v[76:79]
 v_mfma_f32_16x16x32_bf16 v[44:47], v[152:155], a[216:219], v[44:47]
 ds_read_b128 v[140:143], v5 offset:13312
 v_mfma_f32_16x16x32_bf16 v[80:83], v[152:155], a[220:223], v[80:83]
 s_waitcnt lgkmcnt(4)
 v_mfma_f32_16x16x32_bf16 v[40:43], v[112:115], a[224:227], v[40:43]
 ds_read_b128 v[148:151], v5 offset:14336
 v_mfma_f32_16x16x32_bf16 v[76:79], v[112:115], a[228:231], v[76:79]
 v_mfma_f32_16x16x32_bf16 v[44:47], v[116:119], a[224:227], v[44:47]
 ds_read_b128 v[152:155], v5 offset:15360
 v_mfma_f32_16x16x32_bf16 v[80:83], v[116:119], a[228:231], v[80:83]
 s_waitcnt lgkmcnt(4)
 v_mfma_f32_16x16x32_bf16 v[40:43], v[124:127], a[232:235], v[40:43]
 ds_read_b128 v[112:115], v5 offset:16384
 v_mfma_f32_16x16x32_bf16 v[76:79], v[124:127], a[236:239], v[76:79]
 v_mfma_f32_16x16x32_bf16 v[44:47], v[128:131], a[232:235], v[44:47]
 ds_read_b128 v[116:119], v5 offset:17408
 v_mfma_f32_16x16x32_bf16 v[80:83], v[128:131], a[236:239], v[80:83]
 s_waitcnt lgkmcnt(4)
 v_mfma_f32_16x16x32_bf16 v[40:43], v[136:139], a[240:243], v[40:43]
 ds_read_b128 v[124:127], v5 offset:18432
 v_mfma_f32_16x16x32_bf16 v[76:79], v[136:139], a[244:247], v[76:79]
 v_mfma_f32_16x16x32_bf16 v[44:47], v[140:143], a[240:243], v[44:47]
 ds_read_b128 v[128:131], v5 offset:19456
 v_mfma_f32_16x16x32_bf16 v[80:83], v[140:143], a[244:247], v[80:83]
 s_waitcnt lgkmcnt(4)
 v_mfma_f32_16x16x32_bf16 v[40:43], v[148:151], a[248:251], v[40:43]
 ds_read_b128 v[136:139], v5 offset:20480
 v_mfma_f32_16x16x32_bf16 v[76:79], v[148:151], a[252:255], v[76:79]
 v_mfma_f32_16x16x32_bf16 v[44:47], v[152:155], a[248:251], v[44:47]
 ds_read_b128 v[140:143], v5 offset:21504
 v_mfma_f32_16x16x32_bf16 v[80:83], v[152:155], a[252:255], v[80:83]
 s_waitcnt lgkmcnt(4)
 v_mfma_f32_16x16x32_bf16 v[40:43], v[112:115], v[8:11], v[40:43]
 ds_read_b128 v[148:151], v5 offset:22528
 v_mfma_f32_16x16x32_bf16 v[76:79], v[112:115], v[12:15], v[76:79]
 v_mfma_f32_16x16x32_bf16 v[44:47], v[116:119], v[8:11], v[44:47]
 ds_read_b128 v[152:155], v5 offset:23552
 v_mfma_f32_16x16x32_bf16 v[80:83], v[116:119], v[12:15], v[80:83]
 s_waitcnt lgkmcnt(4)
 v_mfma_f32_16x16x32_bf16 v[40:43], v[124:127], v[16:19], v[40:43]
 v_mfma_f32_16x16x32_bf16 v[76:79], v[124:127], v[20:23], v[76:79]
 v_mfma_f32_16x16x32_bf16 v[44:47], v[128:131], v[16:19], v[44:47]
 v_mfma_f32_16x16x32_bf16 v[80:83], v[128:131], v[20:23], v[80:83]
 s_waitcnt lgkmcnt(2)
 v_mfma_f32_16x16x32_bf16 v[40:43], v[136:139], v[24:27], v[40:43]
 v_mfma_f32_16x16x32_bf16 v[76:79], v[136:139], v[28:31], v[76:79]
 v_mfma_f32_16x16x32_bf16 v[44:47], v[140:143], v[24:27], v[44:47]
 v_mfma_f32_16x16x32_bf16 v[80:83], v[140:143], v[28:31], v[80:83]
 s_waitcnt lgkmcnt(0)
 v_mfma_f32_16x16x32_bf16 v[40:43], v[148:151], v[32:35], v[40:43]
 v_mfma_f32_16x16x32_bf16 v[76:79], v[148:151], v[36:39], v[76:79]
 v_mfma_f32_16x16x32_bf16 v[44:47], v[152:155], v[32:35], v[44:47]
 v_mfma_f32_16x16x32_bf16 v[80:83], v[152:155], v[36:39], v[80:83]
 s_lshl_b32 s84, s42, 2
 s_add_u32 s84, s84, 0
 s_lshl_b32 s84, s84, 2
 s_add_u32 s84, s84, 1
 s_lshl_b32 s84, s84, 2
 s_add_u32 s84, s84, s32
 s_mul_i32 s84, s84, 3072
 s_lshl_b32 s85, s42, 2
 s_add_u32 s85, s85, 0
 s_lshl_b32 s85, s85, 2
 s_add_u32 s85, s85, 2
 s_lshl_b32 s85, s85, 2
 s_add_u32 s85, s85, s32
 s_mul_i32 s85, s85, 3072
 s_lshl_b32 s86, s42, 2
 s_add_u32 s86, s86, 0
 s_lshl_b32 s86, s86, 2
 s_add_u32 s86, s86, 3
 s_lshl_b32 s86, s86, 2
 s_add_u32 s86, s86, s32
 s_mul_i32 s86, s86, 3072
 s_mul_i32 s40, s32, 3584
 v_and_b32 v2, 15, v0
 v_mul_u32_u24 v2, 112, v2
 v_lshrrev_b32 v3, 4, v0
 v_lshlrev_b32 v3, 3, v3
 v_add_u32 v2, v2, v3
 v_add_u32 v2, s40, v2
 s_cmp_eq_u32 s32, 0
 s_cbranch_scc0 L_g2_met0
 s_mov_b32 s56, 0
 s_mov_b64 s[76:77], exec
 s_mov_b64 exec, 1
L_g2_poll0:
 buffer_load_dword v225, v6, s[28:31], 0 offen sc1
 s_waitcnt vmcnt(0)
 v_readfirstlane_b32 s39, v225
 s_nop 0
 s_cmp_ge_u32 s39, 4
 s_cbranch_scc1 L_g2_met0_0
 s_add_u32 s56, s56, 1
 s_cmp_lt_u32 s56, 0x100000
 s_cbranch_scc0 L_g2_met0_0
 s_sleep 2
 s_branch L_g2_poll0
L_g2_met0_0:
 s_mov_b64 exec, s[76:77]
L_g2_met0:
 s_barrier
 buffer_load_dwordx4 v[112:115], v1, s[24:27], s84 offen offset:0 sc1
 buffer_load_dwordx4 v[116:119], v1, s[24:27], s84 offen offset:1024 sc1
 buffer_load_dwordx4 v[124:127], v1, s[24:27], s85 offen offset:0 sc1
 buffer_load_dwordx4 v[128:131], v1, s[24:27], s85 offen offset:1024 sc1
 buffer_load_dwordx4 v[136:139], v1, s[24:27], s86 offen offset:0 sc1
 buffer_load_dwordx4 v[140:143], v1, s[24:27], s86 offen offset:1024 sc1
 s_mul_i32 s39, s32, 3584
 s_waitcnt vmcnt(0)
 v_lshlrev_b32 v4, 16, v112
 v_and_b32 v5, 0xffff0000, v112
 v_add_f32 v40, v40, v4
 v_add_f32 v41, v41, v5
 v_lshlrev_b32 v4, 16, v113
 v_and_b32 v5, 0xffff0000, v113
 v_add_f32 v42, v42, v4
 v_add_f32 v43, v43, v5
 v_lshlrev_b32 v4, 16, v124
 v_and_b32 v5, 0xffff0000, v124
 v_add_f32 v40, v40, v4
 v_add_f32 v41, v41, v5
 v_lshlrev_b32 v4, 16, v125
 v_and_b32 v5, 0xffff0000, v125
 v_add_f32 v42, v42, v4
 v_add_f32 v43, v43, v5
 v_lshlrev_b32 v4, 16, v136
 v_and_b32 v5, 0xffff0000, v136
 v_add_f32 v40, v40, v4
 v_add_f32 v41, v41, v5
 v_lshlrev_b32 v4, 16, v137
 v_and_b32 v5, 0xffff0000, v137
 v_add_f32 v42, v42, v4
 v_add_f32 v43, v43, v5
 v_lshlrev_b32 v4, 16, v200
 v_and_b32 v5, 0xffff0000, v200
 v_fma_f32 v40, v212, v40, v4
 v_fma_f32 v41, v213, v41, v5
 v_lshlrev_b32 v4, 16, v201
 v_and_b32 v5, 0xffff0000, v201
 v_fma_f32 v42, v214, v42, v4
 v_fma_f32 v43, v215, v43, v5
 v_cvt_pk_bf16_f32 v40, v40, v41
 v_cvt_pk_bf16_f32 v41, v42, v43
 ds_write_b64 v2, v[40:41] offset:0
 v_lshlrev_b32 v4, 16, v114
 v_and_b32 v5, 0xffff0000, v114
 v_add_f32 v44, v44, v4
 v_add_f32 v45, v45, v5
 v_lshlrev_b32 v4, 16, v115
 v_and_b32 v5, 0xffff0000, v115
 v_add_f32 v46, v46, v4
 v_add_f32 v47, v47, v5
 v_lshlrev_b32 v4, 16, v126
 v_and_b32 v5, 0xffff0000, v126
 v_add_f32 v44, v44, v4
 v_add_f32 v45, v45, v5
 v_lshlrev_b32 v4, 16, v127
 v_and_b32 v5, 0xffff0000, v127
 v_add_f32 v46, v46, v4
 v_add_f32 v47, v47, v5
 v_lshlrev_b32 v4, 16, v138
 v_and_b32 v5, 0xffff0000, v138
 v_add_f32 v44, v44, v4
 v_add_f32 v45, v45, v5
 v_lshlrev_b32 v4, 16, v139
 v_and_b32 v5, 0xffff0000, v139
 v_add_f32 v46, v46, v4
 v_add_f32 v47, v47, v5
 v_lshlrev_b32 v4, 16, v204
 v_and_b32 v5, 0xffff0000, v204
 v_fma_f32 v44, v216, v44, v4
 v_fma_f32 v45, v217, v45, v5
 v_lshlrev_b32 v4, 16, v205
 v_and_b32 v5, 0xffff0000, v205
 v_fma_f32 v46, v218, v46, v4
 v_fma_f32 v47, v219, v47, v5
 v_cvt_pk_bf16_f32 v44, v44, v45
 v_cvt_pk_bf16_f32 v45, v46, v47
 ds_write_b64 v2, v[44:45] offset:32
 v_lshlrev_b32 v4, 16, v116
 v_and_b32 v5, 0xffff0000, v116
 v_add_f32 v76, v76, v4
 v_add_f32 v77, v77, v5
 v_lshlrev_b32 v4, 16, v117
 v_and_b32 v5, 0xffff0000, v117
 v_add_f32 v78, v78, v4
 v_add_f32 v79, v79, v5
 v_lshlrev_b32 v4, 16, v128
 v_and_b32 v5, 0xffff0000, v128
 v_add_f32 v76, v76, v4
 v_add_f32 v77, v77, v5
 v_lshlrev_b32 v4, 16, v129
 v_and_b32 v5, 0xffff0000, v129
 v_add_f32 v78, v78, v4
 v_add_f32 v79, v79, v5
 v_lshlrev_b32 v4, 16, v140
 v_and_b32 v5, 0xffff0000, v140
 v_add_f32 v76, v76, v4
 v_add_f32 v77, v77, v5
 v_lshlrev_b32 v4, 16, v141
 v_and_b32 v5, 0xffff0000, v141
 v_add_f32 v78, v78, v4
 v_add_f32 v79, v79, v5
 v_lshlrev_b32 v4, 16, v202
 v_and_b32 v5, 0xffff0000, v202
 v_fma_f32 v76, v212, v76, v4
 v_fma_f32 v77, v213, v77, v5
 v_lshlrev_b32 v4, 16, v203
 v_and_b32 v5, 0xffff0000, v203
 v_fma_f32 v78, v214, v78, v4
 v_fma_f32 v79, v215, v79, v5
 v_cvt_pk_bf16_f32 v76, v76, v77
 v_cvt_pk_bf16_f32 v77, v78, v79
 ds_write_b64 v2, v[76:77] offset:1792
 v_lshlrev_b32 v4, 16, v118
 v_and_b32 v5, 0xffff0000, v118
 v_add_f32 v80, v80, v4
 v_add_f32 v81, v81, v5
 v_lshlrev_b32 v4, 16, v119
 v_and_b32 v5, 0xffff0000, v119
 v_add_f32 v82, v82, v4
 v_add_f32 v83, v83, v5
 v_lshlrev_b32 v4, 16, v130
 v_and_b32 v5, 0xffff0000, v130
 v_add_f32 v80, v80, v4
 v_add_f32 v81, v81, v5
 v_lshlrev_b32 v4, 16, v131
 v_and_b32 v5, 0xffff0000, v131
 v_add_f32 v82, v82, v4
 v_add_f32 v83, v83, v5
 v_lshlrev_b32 v4, 16, v142
 v_and_b32 v5, 0xffff0000, v142
 v_add_f32 v80, v80, v4
 v_add_f32 v81, v81, v5
 v_lshlrev_b32 v4, 16, v143
 v_and_b32 v5, 0xffff0000, v143
 v_add_f32 v82, v82, v4
 v_add_f32 v83, v83, v5
 v_lshlrev_b32 v4, 16, v206
 v_and_b32 v5, 0xffff0000, v206
 v_fma_f32 v80, v216, v80, v4
 v_fma_f32 v81, v217, v81, v5
 v_lshlrev_b32 v4, 16, v207
 v_and_b32 v5, 0xffff0000, v207
 v_fma_f32 v82, v218, v82, v4
 v_fma_f32 v83, v219, v83, v5
 v_cvt_pk_bf16_f32 v80, v80, v81
 v_cvt_pk_bf16_f32 v81, v82, v83
 ds_write_b64 v2, v[80:81] offset:1824
 s_lshl_b32 s40, s57, 4
 s_mul_i32 s40, s40, 1152
 s_lshl_b32 s43, s58, 5
 s_add_u32 s40, s40, s43
 s_waitcnt lgkmcnt(0)
 v_add_u32 v3, 0, v0
 v_mul_u32_u24 v4, 16384, v3
 v_lshrrev_b32 v4, 16, v4
 v_mul_u32_u24 v5, 4, v4
 v_sub_u32 v3, v3, v5
 v_lshlrev_b32 v3, 4, v3
 v_mul_u32_u24 v5, 112, v4
 v_add_u32 v5, v5, v3
 v_add_u32 v5, s39, v5
 ds_read_b128 v[168:171], v5
 v_mul_u32_u24 v4, 1152, v4
 v_add_u32 v226, v4, v3
 v_add_u32 v3, 64, v0
 v_mul_u32_u24 v4, 16384, v3
 v_lshrrev_b32 v4, 16, v4
 v_mul_u32_u24 v5, 4, v4
 v_sub_u32 v3, v3, v5
 v_lshlrev_b32 v3, 4, v3
 v_mul_u32_u24 v5, 112, v4
 v_add_u32 v5, v5, v3
 v_add_u32 v5, s39, v5
 ds_read_b128 v[172:175], v5
 v_mul_u32_u24 v4, 1152, v4
 v_add_u32 v227, v4, v3
 s_waitcnt lgkmcnt(0)
 buffer_store_dwordx4 v[168:171], v226, s[52:55], s40 offen
 buffer_store_dwordx4 v[172:175], v227, s[52:55], s40 offen
 s_branch L_g2a_done
L_g2_v1:
 s_mul_i32 s39, s32, 7168
 s_add_u32 m0, s39, 0
 s_add_u32 s40, s36, 1183744
 buffer_load_dwordx4 v1, s[12:15], s40 offen offset:0 lds
 buffer_load_dwordx4 v1, s[12:15], s40 offen offset:1024 lds
 buffer_load_dwordx4 v1, s[12:15], s40 offen offset:2048 lds
 buffer_load_dwordx4 v1, s[12:15], s40 offen offset:3072 lds
 s_mul_i32 s39, s32, 7168
 s_add_u32 m0, s39, 4096
 s_add_u32 s40, s36, 1187840
 buffer_load_dwordx4 v1, s[12:15], s40 offen offset:0 lds
 s_mul_i32 s39, s32, 7168
 s_add_u32 m0, s39, 5120
 s_add_u32 s40, s36, 1179648
 buffer_load_dwordx4 v1, s[12:15], s40 offen offset:0 lds
 buffer_load_dwordx4 v1, s[12:15], s40 offen offset:1024 lds
 s_add_u32 s87, s37, 32768
 buffer_load_dwordx4 a[0:3], v1, s[16:19], s87 offen sc1
 s_add_u32 s87, s37, 180224
 buffer_load_dwordx4 a[4:7], v1, s[16:19], s87 offen sc1
 s_add_u32 s87, s37, 33792
 buffer_load_dwordx4 a[8:11], v1, s[16:19], s87 offen sc1
 s_add_u32 s87, s37, 181248
 buffer_load_dwordx4 a[12:15], v1, s[16:19], s87 offen sc1
 s_waitcnt vmcnt(4)
 s_barrier
 s_cmp_eq_u32 s32, 0
 s_cbranch_scc0 L_g2_nolate1
 s_lshr_b32 s39, s79, 3
 s_lshl_b32 s40, s78, 2
 s_add_u32 s39, s39, s40
 s_add_u32 s39, s39, 128
 s_lshl_b32 s39, s39, 7
 v_mov_b32 v226, s39
 v_mov_b32 v225, 1
 s_mov_b64 s[76:77], exec
 s_mov_b64 exec, 1
 buffer_atomic_add v225, v226, s[28:31], 0 offen sc1
 s_mov_b64 exec, s[76:77]
L_g2_nolate1:
 s_lshr_b32 s39, s33, 1
 s_lshl_b32 s39, s39, 2
 s_add_u32 s39, s39, 129
 s_lshl_b32 s39, s39, 7
 v_mov_b32 v229, s39
 ds_read_b128 v[112:115], v2 offset:0
 ds_read_b128 v[116:119], v2 offset:1024
 ds_read_b128 v[120:123], v2 offset:2048
 ds_read_b128 v[124:127], v2 offset:3072
 ds_read_b128 v[128:131], v2 offset:4096
 ds_read_b128 v[132:135], v2 offset:5120
 ds_read_b128 v[136:139], v2 offset:6144
 s_waitcnt lgkmcnt(0)
 s_waitcnt vmcnt(2)
 v_mfma_f32_16x16x32_bf16 v[56:59], v[112:115], a[0:3], 0
 ds_read_b128 v[140:143], v2 offset:7168
 ds_read_b128 v[144:147], v2 offset:8192
 v_mfma_f32_16x16x32_bf16 v[92:95], v[112:115], a[4:7], 0
 ds_read_b128 v[148:151], v2 offset:9216
 v_mfma_f32_16x16x32_bf16 v[60:63], v[116:119], a[0:3], 0
 ds_read_b128 v[152:155], v2 offset:10240
 v_mfma_f32_16x16x32_bf16 v[96:99], v[116:119], a[4:7], 0
 ds_read_b128 v[156:159], v2 offset:11264
 ds_read_b128 v[160:163], v2 offset:12288
 v_mfma_f32_16x16x32_bf16 v[64:67], v[120:123], a[0:3], 0
 ds_read_b128 v[164:167], v2 offset:13312
 v_mfma_f32_16x16x32_bf16 v[100:103], v[120:123], a[4:7], 0
 s_mul_i32 s39, s32, 7168
 s_add_u32 m0, s39, 36864
 s_add_u32 s40, s36, 1478656
 buffer_load_dwordx4 v1, s[12:15], s40 offen offset:0 lds
 v_mfma_f32_16x16x32_bf16 v[68:71], v[124:127], a[0:3], 0
 buffer_load_dwordx4 v1, s[12:15], s40 offen offset:1024 lds
 v_mfma_f32_16x16x32_bf16 v[104:107], v[124:127], a[4:7], 0
 buffer_load_dwordx4 v1, s[12:15], s40 offen offset:2048 lds
 buffer_load_dwordx4 v1, s[12:15], s40 offen offset:3072 lds
 v_mfma_f32_16x16x32_bf16 v[72:75], v[128:131], a[0:3], 0
 s_mul_i32 s39, s32, 7168
 s_add_u32 m0, s39, 40960
 s_add_u32 s40, s36, 1482752
 buffer_load_dwordx4 v1, s[12:15], s40 offen offset:0 lds
 v_mfma_f32_16x16x32_bf16 v[108:111], v[128:131], a[4:7], 0
 s_mul_i32 s39, s32, 7168
 s_add_u32 m0, s39, 41984
 s_add_u32 s40, s36, 1474560
 buffer_load_dwordx4 v1, s[12:15], s40 offen offset:0 lds
 v_mfma_f32_16x16x32_bf16 v[40:43], v[132:135], a[0:3], 0
 buffer_load_dwordx4 v1, s[12:15], s40 offen offset:1024 lds
 s_add_u32 s87, s37, 36864
 buffer_load_dwordx4 a[16:19], v1, s[16:19], s87 offen sc1
 v_mfma_f32_16x16x32_bf16 v[76:79], v[132:135], a[4:7], 0
 s_add_u32 s87, s37, 184320
 buffer_load_dwordx4 a[20:23], v1, s[16:19], s87 offen sc1
 v_mfma_f32_16x16x32_bf16 v[44:47], v[136:139], a[0:3], 0
 s_add_u32 s87, s37, 37888
 buffer_load_dwordx4 a[24:27], v1, s[16:19], s87 offen sc1
 v_mfma_f32_16x16x32_bf16 v[80:83], v[136:139], a[4:7], 0
 s_add_u32 s87, s37, 185344
 buffer_load_dwordx4 a[28:31], v1, s[16:19], s87 offen sc1
 s_waitcnt lgkmcnt(0)
 s_waitcnt vmcnt(11)
 v_mfma_f32_16x16x32_bf16 v[56:59], v[140:143], a[8:11], v[56:59]
 ds_read_b128 v[112:115], v2 offset:14336
 ds_read_b128 v[116:119], v2 offset:15360
 v_mfma_f32_16x16x32_bf16 v[92:95], v[140:143], a[12:15], v[92:95]
 ds_read_b128 v[120:123], v2 offset:16384
 v_mfma_f32_16x16x32_bf16 v[60:63], v[144:147], a[8:11], v[60:63]
 ds_read_b128 v[124:127], v2 offset:17408
 v_mfma_f32_16x16x32_bf16 v[96:99], v[144:147], a[12:15], v[96:99]
 ds_read_b128 v[128:131], v2 offset:18432
 ds_read_b128 v[132:135], v2 offset:19456
 v_mfma_f32_16x16x32_bf16 v[64:67], v[148:151], a[8:11], v[64:67]
 ds_read_b128 v[136:139], v2 offset:20480
 v_mfma_f32_16x16x32_bf16 v[100:103], v[148:151], a[12:15], v[100:103]
 s_add_u32 s87, s37, 40960
 buffer_load_dwordx4 a[32:35], v1, s[16:19], s87 offen sc1
 v_mfma_f32_16x16x32_bf16 v[68:71], v[152:155], a[8:11], v[68:71]
 s_add_u32 s87, s37, 188416
 buffer_load_dwordx4 a[36:39], v1, s[16:19], s87 offen sc1
 v_mfma_f32_16x16x32_bf16 v[104:107], v[152:155], a[12:15], v[104:107]
 s_mul_i32 s39, s32, 7168
 s_add_u32 m0, s39, 73728
 s_add_u32 s40, s36, 1773568
 buffer_load_dwordx4 v1, s[12:15], s40 offen offset:0 lds
 buffer_load_dwordx4 v1, s[12:15], s40 offen offset:1024 lds
 v_mfma_f32_16x16x32_bf16 v[72:75], v[156:159], a[8:11], v[72:75]
 buffer_load_dwordx4 v1, s[12:15], s40 offen offset:2048 lds
 v_mfma_f32_16x16x32_bf16 v[108:111], v[156:159], a[12:15], v[108:111]
 buffer_load_dwordx4 v1, s[12:15], s40 offen offset:3072 lds
 v_mfma_f32_16x16x32_bf16 v[40:43], v[160:163], a[8:11], v[40:43]
 s_mul_i32 s39, s32, 7168
 s_add_u32 m0, s39, 77824
 s_add_u32 s40, s36, 1777664
 buffer_load_dwordx4 v1, s[12:15], s40 offen offset:0 lds
 s_mul_i32 s39, s32, 7168
 s_add_u32 m0, s39, 78848
 s_add_u32 s40, s36, 1769472
 buffer_load_dwordx4 v1, s[12:15], s40 offen offset:0 lds
 v_mfma_f32_16x16x32_bf16 v[76:79], v[160:163], a[12:15], v[76:79]
 buffer_load_dwordx4 v1, s[12:15], s40 offen offset:1024 lds
 v_mfma_f32_16x16x32_bf16 v[44:47], v[164:167], a[8:11], v[44:47]
 s_mul_i32 s39, s32, 7168
 s_add_u32 m0, s39, 110592
 s_add_u32 s40, s36, 2068480
 buffer_load_dwordx4 v1, s[12:15], s40 offen offset:0 lds
 v_mfma_f32_16x16x32_bf16 v[80:83], v[164:167], a[12:15], v[80:83]
 buffer_load_dwordx4 v1, s[12:15], s40 offen offset:1024 lds
 s_waitcnt lgkmcnt(0)
 s_waitcnt vmcnt(13)
 v_mfma_f32_16x16x32_bf16 v[56:59], v[112:115], a[16:19], v[56:59]
 ds_read_b128 v[140:143], v2 offset:21504
 ds_read_b128 v[144:147], v2 offset:22528
 v_mfma_f32_16x16x32_bf16 v[92:95], v[112:115], a[20:23], v[92:95]
 ds_read_b128 v[148:151], v2 offset:23552
 v_mfma_f32_16x16x32_bf16 v[60:63], v[116:119], a[16:19], v[60:63]
 ds_read_b128 v[152:155], v2 offset:24576
 v_mfma_f32_16x16x32_bf16 v[96:99], v[116:119], a[20:23], v[96:99]
 ds_read_b128 v[156:159], v2 offset:25600
 ds_read_b128 v[160:163], v2 offset:26624
 v_mfma_f32_16x16x32_bf16 v[64:67], v[120:123], a[16:19], v[64:67]
 ds_read_b128 v[164:167], v2 offset:27648
 v_mfma_f32_16x16x32_bf16 v[100:103], v[120:123], a[20:23], v[100:103]
 buffer_load_dwordx4 v1, s[12:15], s40 offen offset:2048 lds
 v_mfma_f32_16x16x32_bf16 v[68:71], v[124:127], a[16:19], v[68:71]
 buffer_load_dwordx4 v1, s[12:15], s40 offen offset:3072 lds
 v_mfma_f32_16x16x32_bf16 v[104:107], v[124:127], a[20:23], v[104:107]
 s_mul_i32 s39, s32, 7168
 s_add_u32 m0, s39, 114688
 s_add_u32 s40, s36, 2072576
 buffer_load_dwordx4 v1, s[12:15], s40 offen offset:0 lds
 s_mul_i32 s39, s32, 7168
 s_add_u32 m0, s39, 115712
 s_add_u32 s40, s36, 2064384
 buffer_load_dwordx4 v1, s[12:15], s40 offen offset:0 lds
 v_mfma_f32_16x16x32_bf16 v[72:75], v[128:131], a[16:19], v[72:75]
 buffer_load_dwordx4 v1, s[12:15], s40 offen offset:1024 lds
 v_mfma_f32_16x16x32_bf16 v[108:111], v[128:131], a[20:23], v[108:111]
 s_add_u32 s87, s37, 41984
 buffer_load_dwordx4 a[40:43], v1, s[16:19], s87 offen sc1
 v_mfma_f32_16x16x32_bf16 v[40:43], v[132:135], a[16:19], v[40:43]
 s_add_u32 s87, s37, 189440
 buffer_load_dwordx4 a[44:47], v1, s[16:19], s87 offen sc1
 s_add_u32 s87, s37, 45056
 buffer_load_dwordx4 a[48:51], v1, s[16:19], s87 offen sc1
 v_mfma_f32_16x16x32_bf16 v[76:79], v[132:135], a[20:23], v[76:79]
 s_add_u32 s87, s37, 192512
 buffer_load_dwordx4 a[52:55], v1, s[16:19], s87 offen sc1
 v_mfma_f32_16x16x32_bf16 v[44:47], v[136:139], a[16:19], v[44:47]
 s_add_u32 s87, s37, 46080
 buffer_load_dwordx4 a[56:59], v1, s[16:19], s87 offen sc1
 v_mfma_f32_16x16x32_bf16 v[80:83], v[136:139], a[20:23], v[80:83]
 s_add_u32 s87, s37, 193536
 buffer_load_dwordx4 a[60:63], v1, s[16:19], s87 offen sc1
 s_waitcnt lgkmcnt(0)
 s_waitcnt vmcnt(26)
 s_barrier
 s_waitcnt vmcnt(22)
 v_mfma_f32_16x16x32_bf16 v[56:59], v[140:143], a[24:27], v[56:59]
 ds_read_b128 v[112:115], v3 offset:0
 ds_read_b128 v[116:119], v3 offset:1024
 v_mfma_f32_16x16x32_bf16 v[92:95], v[140:143], a[28:31], v[92:95]
 ds_read_b128 v[120:123], v3 offset:2048
 v_mfma_f32_16x16x32_bf16 v[60:63], v[144:147], a[24:27], v[60:63]
 ds_read_b128 v[124:127], v3 offset:3072
 v_mfma_f32_16x16x32_bf16 v[96:99], v[144:147], a[28:31], v[96:99]
 ds_read_b128 v[128:131], v3 offset:4096
 v_mfma_f32_16x16x32_bf16 v[64:67], v[148:151], a[24:27], v[64:67]
 ds_read_b128 v[132:135], v3 offset:5120
 v_mfma_f32_16x16x32_bf16 v[100:103], v[148:151], a[28:31], v[100:103]
 ds_read_b128 v[136:139], v3 offset:6144
 v_mfma_f32_16x16x32_bf16 v[68:71], v[152:155], a[24:27], v[68:71]
 s_mul_i32 s39, s32, 7168
 s_add_u32 m0, s39, 0
 s_add_u32 s40, s36, 1257472
 buffer_load_dwordx4 v1, s[12:15], s40 offen offset:0 lds
 v_mfma_f32_16x16x32_bf16 v[104:107], v[152:155], a[28:31], v[104:107]
 buffer_load_dwordx4 v1, s[12:15], s40 offen offset:1024 lds
 buffer_load_dwordx4 v1, s[12:15], s40 offen offset:2048 lds
 v_mfma_f32_16x16x32_bf16 v[72:75], v[156:159], a[24:27], v[72:75]
 buffer_load_dwordx4 v1, s[12:15], s40 offen offset:3072 lds
 v_mfma_f32_16x16x32_bf16 v[108:111], v[156:159], a[28:31], v[108:111]
 s_mul_i32 s39, s32, 7168
 s_add_u32 m0, s39, 4096
 s_add_u32 s40, s36, 1261568
 buffer_load_dwordx4 v1, s[12:15], s40 offen offset:0 lds
 v_mfma_f32_16x16x32_bf16 v[40:43], v[160:163], a[24:27], v[40:43]
 s_mul_i32 s39, s32, 7168
 s_add_u32 m0, s39, 5120
 s_add_u32 s40, s36, 1253376
 buffer_load_dwordx4 v1, s[12:15], s40 offen offset:0 lds
 v_mfma_f32_16x16x32_bf16 v[76:79], v[160:163], a[28:31], v[76:79]
 buffer_load_dwordx4 v1, s[12:15], s40 offen offset:1024 lds
 v_mfma_f32_16x16x32_bf16 v[44:47], v[164:167], a[24:27], v[44:47]
 s_add_u32 s87, s37, 49152
 buffer_load_dwordx4 a[64:67], v1, s[16:19], s87 offen sc1
 v_mfma_f32_16x16x32_bf16 v[80:83], v[164:167], a[28:31], v[80:83]
 s_add_u32 s87, s37, 196608
 buffer_load_dwordx4 a[68:71], v1, s[16:19], s87 offen sc1
 s_waitcnt lgkmcnt(0)
 s_waitcnt vmcnt(29)
 v_mfma_f32_16x16x32_bf16 v[56:59], v[112:115], a[32:35], v[56:59]
 ds_read_b128 v[140:143], v3 offset:7168
 v_mfma_f32_16x16x32_bf16 v[92:95], v[112:115], a[36:39], v[92:95]
 ds_read_b128 v[144:147], v3 offset:8192
 v_mfma_f32_16x16x32_bf16 v[60:63], v[116:119], a[32:35], v[60:63]
 v_mfma_f32_16x16x32_bf16 v[96:99], v[116:119], a[36:39], v[96:99]
 ds_read_b128 v[148:151], v3 offset:9216
 v_mfma_f32_16x16x32_bf16 v[64:67], v[120:123], a[32:35], v[64:67]
 ds_read_b128 v[152:155], v3 offset:10240
 v_mfma_f32_16x16x32_bf16 v[100:103], v[120:123], a[36:39], v[100:103]
 v_mfma_f32_16x16x32_bf16 v[68:71], v[124:127], a[32:35], v[68:71]
 ds_read_b128 v[156:159], v3 offset:11264
 v_mfma_f32_16x16x32_bf16 v[104:107], v[124:127], a[36:39], v[104:107]
 ds_read_b128 v[160:163], v3 offset:12288
 v_mfma_f32_16x16x32_bf16 v[72:75], v[128:131], a[32:35], v[72:75]
 v_mfma_f32_16x16x32_bf16 v[108:111], v[128:131], a[36:39], v[108:111]
 ds_read_b128 v[164:167], v3 offset:13312
 v_mfma_f32_16x16x32_bf16 v[40:43], v[132:135], a[32:35], v[40:43]
 s_add_u32 s87, s37, 50176
 buffer_load_dwordx4 a[72:75], v1, s[16:19], s87 offen sc1
 v_mfma_f32_16x16x32_bf16 v[76:79], v[132:135], a[36:39], v[76:79]
 v_mfma_f32_16x16x32_bf16 v[44:47], v[136:139], a[32:35], v[44:47]
 s_add_u32 s87, s37, 197632
 buffer_load_dwordx4 a[76:79], v1, s[16:19], s87 offen sc1
 v_mfma_f32_16x16x32_bf16 v[80:83], v[136:139], a[36:39], v[80:83]
 s_waitcnt lgkmcnt(0)
 s_waitcnt vmcnt(15)
 v_mfma_f32_16x16x32_bf16 v[56:59], v[140:143], a[40:43], v[56:59]
 ds_read_b128 v[112:115], v3 offset:14336
 v_mfma_f32_16x16x32_bf16 v[92:95], v[140:143], a[44:47], v[92:95]
 ds_read_b128 v[116:119], v3 offset:15360
 v_mfma_f32_16x16x32_bf16 v[60:63], v[144:147], a[40:43], v[60:63]
 v_mfma_f32_16x16x32_bf16 v[96:99], v[144:147], a[44:47], v[96:99]
 ds_read_b128 v[120:123], v3 offset:16384
 v_mfma_f32_16x16x32_bf16 v[64:67], v[148:151], a[40:43], v[64:67]
 ds_read_b128 v[124:127], v3 offset:17408
 v_mfma_f32_16x16x32_bf16 v[100:103], v[148:151], a[44:47], v[100:103]
 v_mfma_f32_16x16x32_bf16 v[68:71], v[152:155], a[40:43], v[68:71]
 ds_read_b128 v[128:131], v3 offset:18432
 v_mfma_f32_16x16x32_bf16 v[104:107], v[152:155], a[44:47], v[104:107]
 ds_read_b128 v[132:135], v3 offset:19456
 v_mfma_f32_16x16x32_bf16 v[72:75], v[156:159], a[40:43], v[72:75]
 v_mfma_f32_16x16x32_bf16 v[108:111], v[156:159], a[44:47], v[108:111]
 ds_read_b128 v[136:139], v3 offset:20480
 v_mfma_f32_16x16x32_bf16 v[40:43], v[160:163], a[40:43], v[40:43]
 s_add_u32 s87, s37, 53248
 buffer_load_dwordx4 a[80:83], v1, s[16:19], s87 offen sc1
 v_mfma_f32_16x16x32_bf16 v[76:79], v[160:163], a[44:47], v[76:79]
 v_mfma_f32_16x16x32_bf16 v[44:47], v[164:167], a[40:43], v[44:47]
 s_add_u32 s87, s37, 200704
 buffer_load_dwordx4 a[84:87], v1, s[16:19], s87 offen sc1
 v_mfma_f32_16x16x32_bf16 v[80:83], v[164:167], a[44:47], v[80:83]
 s_waitcnt lgkmcnt(0)
 s_waitcnt vmcnt(15)
 v_mfma_f32_16x16x32_bf16 v[56:59], v[112:115], a[48:51], v[56:59]
 ds_read_b128 v[140:143], v3 offset:21504
 v_mfma_f32_16x16x32_bf16 v[92:95], v[112:115], a[52:55], v[92:95]
 ds_read_b128 v[144:147], v3 offset:22528
 v_mfma_f32_16x16x32_bf16 v[60:63], v[116:119], a[48:51], v[60:63]
 v_mfma_f32_16x16x32_bf16 v[96:99], v[116:119], a[52:55], v[96:99]
 ds_read_b128 v[148:151], v3 offset:23552
 v_mfma_f32_16x16x32_bf16 v[64:67], v[120:123], a[48:51], v[64:67]
 ds_read_b128 v[152:155], v3 offset:24576
 v_mfma_f32_16x16x32_bf16 v[100:103], v[120:123], a[52:55], v[100:103]
 v_mfma_f32_16x16x32_bf16 v[68:71], v[124:127], a[48:51], v[68:71]
 ds_read_b128 v[156:159], v3 offset:25600
 v_mfma_f32_16x16x32_bf16 v[104:107], v[124:127], a[52:55], v[104:107]
 ds_read_b128 v[160:163], v3 offset:26624
 v_mfma_f32_16x16x32_bf16 v[72:75], v[128:131], a[48:51], v[72:75]
 v_mfma_f32_16x16x32_bf16 v[108:111], v[128:131], a[52:55], v[108:111]
 ds_read_b128 v[164:167], v3 offset:27648
 v_mfma_f32_16x16x32_bf16 v[40:43], v[132:135], a[48:51], v[40:43]
 s_add_u32 s87, s37, 54272
 buffer_load_dwordx4 a[88:91], v1, s[16:19], s87 offen sc1
 v_mfma_f32_16x16x32_bf16 v[76:79], v[132:135], a[52:55], v[76:79]
 v_mfma_f32_16x16x32_bf16 v[44:47], v[136:139], a[48:51], v[44:47]
 s_add_u32 s87, s37, 201728
 buffer_load_dwordx4 a[92:95], v1, s[16:19], s87 offen sc1
 v_mfma_f32_16x16x32_bf16 v[80:83], v[136:139], a[52:55], v[80:83]
 s_waitcnt lgkmcnt(0)
 s_waitcnt vmcnt(28)
 s_barrier
 s_waitcnt vmcnt(15)
 s_mov_b64 s[76:77], exec
 s_mov_b64 exec, 1
 buffer_load_dword v230, v229, s[28:31], 0 offen sc1
 s_mov_b64 exec, s[76:77]
 s_nop 3
 v_mfma_f32_16x16x32_bf16 v[56:59], v[140:143], a[56:59], v[56:59]
 ds_read_b128 v[112:115], v4 offset:0
 ds_read_b128 v[116:119], v4 offset:1024
 v_mfma_f32_16x16x32_bf16 v[92:95], v[140:143], a[60:63], v[92:95]
 ds_read_b128 v[120:123], v4 offset:2048
 v_mfma_f32_16x16x32_bf16 v[60:63], v[144:147], a[56:59], v[60:63]
 ds_read_b128 v[124:127], v4 offset:3072
 v_mfma_f32_16x16x32_bf16 v[96:99], v[144:147], a[60:63], v[96:99]
 ds_read_b128 v[128:131], v4 offset:4096
 v_mfma_f32_16x16x32_bf16 v[64:67], v[148:151], a[56:59], v[64:67]
 ds_read_b128 v[132:135], v4 offset:5120
 v_mfma_f32_16x16x32_bf16 v[100:103], v[148:151], a[60:63], v[100:103]
 ds_read_b128 v[136:139], v4 offset:6144
 v_mfma_f32_16x16x32_bf16 v[68:71], v[152:155], a[56:59], v[68:71]
 s_mul_i32 s39, s32, 7168
 s_add_u32 m0, s39, 36864
 s_add_u32 s40, s36, 1552384
 buffer_load_dwordx4 v1, s[12:15], s40 offen offset:0 lds
 v_mfma_f32_16x16x32_bf16 v[104:107], v[152:155], a[60:63], v[104:107]
 buffer_load_dwordx4 v1, s[12:15], s40 offen offset:1024 lds
 buffer_load_dwordx4 v1, s[12:15], s40 offen offset:2048 lds
 v_mfma_f32_16x16x32_bf16 v[72:75], v[156:159], a[56:59], v[72:75]
 buffer_load_dwordx4 v1, s[12:15], s40 offen offset:3072 lds
 v_mfma_f32_16x16x32_bf16 v[108:111], v[156:159], a[60:63], v[108:111]
 s_mul_i32 s39, s32, 7168
 s_add_u32 m0, s39, 40960
 s_add_u32 s40, s36, 1556480
 buffer_load_dwordx4 v1, s[12:15], s40 offen offset:0 lds
 v_mfma_f32_16x16x32_bf16 v[40:43], v[160:163], a[56:59], v[40:43]
 s_mul_i32 s39, s32, 7168
 s_add_u32 m0, s39, 41984
 s_add_u32 s40, s36, 1548288
 buffer_load_dwordx4 v1, s[12:15], s40 offen offset:0 lds
 v_mfma_f32_16x16x32_bf16 v[76:79], v[160:163], a[60:63], v[76:79]
 buffer_load_dwordx4 v1, s[12:15], s40 offen offset:1024 lds
 v_mfma_f32_16x16x32_bf16 v[44:47], v[164:167], a[56:59], v[44:47]
 s_add_u32 s87, s37, 57344
 buffer_load_dwordx4 a[96:99], v1, s[16:19], s87 offen sc1
 v_mfma_f32_16x16x32_bf16 v[80:83], v[164:167], a[60:63], v[80:83]
 s_add_u32 s87, s37, 204800
 buffer_load_dwordx4 a[100:103], v1, s[16:19], s87 offen sc1
 s_waitcnt lgkmcnt(0)
 s_waitcnt vmcnt(16)
 v_mfma_f32_16x16x32_bf16 v[56:59], v[112:115], a[64:67], v[56:59]
 ds_read_b128 v[140:143], v4 offset:7168
 v_mfma_f32_16x16x32_bf16 v[92:95], v[112:115], a[68:71], v[92:95]
 ds_read_b128 v[144:147], v4 offset:8192
 v_mfma_f32_16x16x32_bf16 v[60:63], v[116:119], a[64:67], v[60:63]
 v_mfma_f32_16x16x32_bf16 v[96:99], v[116:119], a[68:71], v[96:99]
 ds_read_b128 v[148:151], v4 offset:9216
 v_mfma_f32_16x16x32_bf16 v[64:67], v[120:123], a[64:67], v[64:67]
 ds_read_b128 v[152:155], v4 offset:10240
 v_mfma_f32_16x16x32_bf16 v[100:103], v[120:123], a[68:71], v[100:103]
 v_mfma_f32_16x16x32_bf16 v[68:71], v[124:127], a[64:67], v[68:71]
 ds_read_b128 v[156:159], v4 offset:11264
 v_mfma_f32_16x16x32_bf16 v[104:107], v[124:127], a[68:71], v[104:107]
 ds_read_b128 v[160:163], v4 offset:12288
 v_mfma_f32_16x16x32_bf16 v[72:75], v[128:131], a[64:67], v[72:75]
 v_mfma_f32_16x16x32_bf16 v[108:111], v[128:131], a[68:71], v[108:111]
 ds_read_b128 v[164:167], v4 offset:13312
 v_mfma_f32_16x16x32_bf16 v[40:43], v[132:135], a[64:67], v[40:43]
 s_add_u32 s87, s37, 58368
 buffer_load_dwordx4 a[104:107], v1, s[16:19], s87 offen sc1
 v_mfma_f32_16x16x32_bf16 v[76:79], v[132:135], a[68:71], v[76:79]
 v_mfma_f32_16x16x32_bf16 v[44:47], v[136:139], a[64:67], v[44:47]
 s_add_u32 s87, s37, 205824
 buffer_load_dwordx4 a[108:111], v1, s[16:19], s87 offen sc1
 v_mfma_f32_16x16x32_bf16 v[80:83], v[136:139], a[68:71], v[80:83]
 s_waitcnt lgkmcnt(0)
 s_waitcnt vmcnt(16)
 v_mfma_f32_16x16x32_bf16 v[56:59], v[140:143], a[72:75], v[56:59]
 ds_read_b128 v[112:115], v4 offset:14336
 v_mfma_f32_16x16x32_bf16 v[92:95], v[140:143], a[76:79], v[92:95]
 ds_read_b128 v[116:119], v4 offset:15360
 v_mfma_f32_16x16x32_bf16 v[60:63], v[144:147], a[72:75], v[60:63]
 v_mfma_f32_16x16x32_bf16 v[96:99], v[144:147], a[76:79], v[96:99]
 ds_read_b128 v[120:123], v4 offset:16384
 v_mfma_f32_16x16x32_bf16 v[64:67], v[148:151], a[72:75], v[64:67]
 ds_read_b128 v[124:127], v4 offset:17408
 v_mfma_f32_16x16x32_bf16 v[100:103], v[148:151], a[76:79], v[100:103]
 v_mfma_f32_16x16x32_bf16 v[68:71], v[152:155], a[72:75], v[68:71]
 ds_read_b128 v[128:131], v4 offset:18432
 v_mfma_f32_16x16x32_bf16 v[104:107], v[152:155], a[76:79], v[104:107]
 ds_read_b128 v[132:135], v4 offset:19456
 v_mfma_f32_16x16x32_bf16 v[72:75], v[156:159], a[72:75], v[72:75]
 v_mfma_f32_16x16x32_bf16 v[108:111], v[156:159], a[76:79], v[108:111]
 ds_read_b128 v[136:139], v4 offset:20480
 v_mfma_f32_16x16x32_bf16 v[40:43], v[160:163], a[72:75], v[40:43]
 s_add_u32 s87, s37, 61440
 buffer_load_dwordx4 a[112:115], v1, s[16:19], s87 offen sc1
 v_mfma_f32_16x16x32_bf16 v[76:79], v[160:163], a[76:79], v[76:79]
 v_mfma_f32_16x16x32_bf16 v[44:47], v[164:167], a[72:75], v[44:47]
 s_add_u32 s87, s37, 208896
 buffer_load_dwordx4 a[116:119], v1, s[16:19], s87 offen sc1
 v_mfma_f32_16x16x32_bf16 v[80:83], v[164:167], a[76:79], v[80:83]
 s_waitcnt lgkmcnt(0)
 s_waitcnt vmcnt(16)
 v_mfma_f32_16x16x32_bf16 v[56:59], v[112:115], a[80:83], v[56:59]
 ds_read_b128 v[140:143], v4 offset:21504
 v_mfma_f32_16x16x32_bf16 v[92:95], v[112:115], a[84:87], v[92:95]
 ds_read_b128 v[144:147], v4 offset:22528
 v_mfma_f32_16x16x32_bf16 v[60:63], v[116:119], a[80:83], v[60:63]
 v_mfma_f32_16x16x32_bf16 v[96:99], v[116:119], a[84:87], v[96:99]
 ds_read_b128 v[148:151], v4 offset:23552
 v_mfma_f32_16x16x32_bf16 v[64:67], v[120:123], a[80:83], v[64:67]
 ds_read_b128 v[152:155], v4 offset:24576
 v_mfma_f32_16x16x32_bf16 v[100:103], v[120:123], a[84:87], v[100:103]
 v_mfma_f32_16x16x32_bf16 v[68:71], v[124:127], a[80:83], v[68:71]
 ds_read_b128 v[156:159], v4 offset:25600
 v_mfma_f32_16x16x32_bf16 v[104:107], v[124:127], a[84:87], v[104:107]
 ds_read_b128 v[160:163], v4 offset:26624
 v_mfma_f32_16x16x32_bf16 v[72:75], v[128:131], a[80:83], v[72:75]
 v_mfma_f32_16x16x32_bf16 v[108:111], v[128:131], a[84:87], v[108:111]
 ds_read_b128 v[164:167], v4 offset:27648
 v_mfma_f32_16x16x32_bf16 v[40:43], v[132:135], a[80:83], v[40:43]
 s_add_u32 s87, s37, 62464
 buffer_load_dwordx4 a[120:123], v1, s[16:19], s87 offen sc1
 v_mfma_f32_16x16x32_bf16 v[76:79], v[132:135], a[84:87], v[76:79]
 v_mfma_f32_16x16x32_bf16 v[44:47], v[136:139], a[80:83], v[44:47]
 s_add_u32 s87, s37, 209920
 buffer_load_dwordx4 a[124:127], v1, s[16:19], s87 offen sc1
 v_mfma_f32_16x16x32_bf16 v[80:83], v[136:139], a[84:87], v[80:83]
 s_waitcnt lgkmcnt(0)
 s_waitcnt vmcnt(37)
 s_barrier
 s_waitcnt vmcnt(16)
 s_waitcnt vmcnt(15)
 v_readfirstlane_b32 s39, v230
 s_nop 0
 s_cmp_ge_u32 s39, 8
 s_cbranch_scc1 L_g2_lateok1
 s_mov_b32 s56, 0
 s_mov_b64 s[76:77], exec
 s_mov_b64 exec, 1
L_g2_lspin1:
 buffer_load_dword v230, v229, s[28:31], 0 offen sc1
 s_waitcnt vmcnt(0)
 v_readfirstlane_b32 s39, v230
 s_nop 0
 s_cmp_ge_u32 s39, 8
 s_cbranch_scc1 L_g2_ldone1
 s_add_u32 s56, s56, 1
 s_cmp_lt_u32 s56, 0x100000
 s_cbranch_scc0 L_g2_ldone1
 s_sleep 2
 s_branch L_g2_lspin1
L_g2_ldone1:
 s_mov_b64 exec, s[76:77]
L_g2_lateok1:
 s_nop 0
 s_nop 2
 v_mfma_f32_16x16x32_bf16 v[56:59], v[140:143], a[88:91], v[56:59]
 ds_read_b128 v[112:115], v5 offset:0
 ds_read_b128 v[116:119], v5 offset:1024
 v_mfma_f32_16x16x32_bf16 v[92:95], v[140:143], a[92:95], v[92:95]
 ds_read_b128 v[120:123], v5 offset:2048
 v_mfma_f32_16x16x32_bf16 v[60:63], v[144:147], a[88:91], v[60:63]
 ds_read_b128 v[124:127], v5 offset:3072
 v_mfma_f32_16x16x32_bf16 v[96:99], v[144:147], a[92:95], v[96:99]
 ds_read_b128 v[128:131], v5 offset:4096
 v_mfma_f32_16x16x32_bf16 v[64:67], v[148:151], a[88:91], v[64:67]
 ds_read_b128 v[132:135], v5 offset:5120
 v_mfma_f32_16x16x32_bf16 v[100:103], v[148:151], a[92:95], v[100:103]
 ds_read_b128 v[136:139], v5 offset:6144
 v_mfma_f32_16x16x32_bf16 v[68:71], v[152:155], a[88:91], v[68:71]
 s_mul_i32 s39, s32, 7168
 s_add_u32 m0, s39, 73728
 s_add_u32 s40, s36, 1847296
 buffer_load_dwordx4 v1, s[12:15], s40 offen offset:0 lds
 v_mfma_f32_16x16x32_bf16 v[104:107], v[152:155], a[92:95], v[104:107]
 buffer_load_dwordx4 v1, s[12:15], s40 offen offset:1024 lds
 buffer_load_dwordx4 v1, s[12:15], s40 offen offset:2048 lds
 v_mfma_f32_16x16x32_bf16 v[72:75], v[156:159], a[88:91], v[72:75]
 buffer_load_dwordx4 v1, s[12:15], s40 offen offset:3072 lds
 v_mfma_f32_16x16x32_bf16 v[108:111], v[156:159], a[92:95], v[108:111]
 s_mul_i32 s39, s32, 7168
 s_add_u32 m0, s39, 77824
 s_add_u32 s40, s36, 1851392
 buffer_load_dwordx4 v1, s[12:15], s40 offen offset:0 lds
 v_mfma_f32_16x16x32_bf16 v[40:43], v[160:163], a[88:91], v[40:43]
 s_mul_i32 s39, s32, 7168
 s_add_u32 m0, s39, 78848
 s_add_u32 s40, s36, 1843200
 buffer_load_dwordx4 v1, s[12:15], s40 offen offset:0 lds
 v_mfma_f32_16x16x32_bf16 v[76:79], v[160:163], a[92:95], v[76:79]
 buffer_load_dwordx4 v1, s[12:15], s40 offen offset:1024 lds
 v_mfma_f32_16x16x32_bf16 v[44:47], v[164:167], a[88:91], v[44:47]
 s_add_u32 s87, s37, 34816
 buffer_load_dwordx4 a[128:131], v1, s[16:19], s87 offen sc1
 v_mfma_f32_16x16x32_bf16 v[80:83], v[164:167], a[92:95], v[80:83]
 s_add_u32 s87, s37, 182272
 buffer_load_dwordx4 a[132:135], v1, s[16:19], s87 offen sc1
 s_waitcnt lgkmcnt(0)
 s_waitcnt vmcnt(15)
 v_mfma_f32_16x16x32_bf16 v[56:59], v[112:115], a[96:99], v[56:59]
 ds_read_b128 v[140:143], v5 offset:7168
 v_mfma_f32_16x16x32_bf16 v[92:95], v[112:115], a[100:103], v[92:95]
 ds_read_b128 v[144:147], v5 offset:8192
 v_mfma_f32_16x16x32_bf16 v[60:63], v[116:119], a[96:99], v[60:63]
 v_mfma_f32_16x16x32_bf16 v[96:99], v[116:119], a[100:103], v[96:99]
 ds_read_b128 v[148:151], v5 offset:9216
 v_mfma_f32_16x16x32_bf16 v[64:67], v[120:123], a[96:99], v[64:67]
 ds_read_b128 v[152:155], v5 offset:10240
 v_mfma_f32_16x16x32_bf16 v[100:103], v[120:123], a[100:103], v[100:103]
 v_mfma_f32_16x16x32_bf16 v[68:71], v[124:127], a[96:99], v[68:71]
 ds_read_b128 v[156:159], v5 offset:11264
 v_mfma_f32_16x16x32_bf16 v[104:107], v[124:127], a[100:103], v[104:107]
 ds_read_b128 v[160:163], v5 offset:12288
 v_mfma_f32_16x16x32_bf16 v[72:75], v[128:131], a[96:99], v[72:75]
 v_mfma_f32_16x16x32_bf16 v[108:111], v[128:131], a[100:103], v[108:111]
 ds_read_b128 v[164:167], v5 offset:13312
 v_mfma_f32_16x16x32_bf16 v[40:43], v[132:135], a[96:99], v[40:43]
 s_add_u32 s87, s37, 35840
 buffer_load_dwordx4 a[136:139], v1, s[16:19], s87 offen sc1
 v_mfma_f32_16x16x32_bf16 v[76:79], v[132:135], a[100:103], v[76:79]
 v_mfma_f32_16x16x32_bf16 v[44:47], v[136:139], a[96:99], v[44:47]
 s_add_u32 s87, s37, 183296
 buffer_load_dwordx4 a[140:143], v1, s[16:19], s87 offen sc1
 v_mfma_f32_16x16x32_bf16 v[80:83], v[136:139], a[100:103], v[80:83]
 s_waitcnt lgkmcnt(0)
 s_waitcnt vmcnt(15)
 v_mfma_f32_16x16x32_bf16 v[56:59], v[140:143], a[104:107], v[56:59]
 ds_read_b128 v[112:115], v5 offset:14336
 v_mfma_f32_16x16x32_bf16 v[92:95], v[140:143], a[108:111], v[92:95]
 ds_read_b128 v[116:119], v5 offset:15360
 v_mfma_f32_16x16x32_bf16 v[60:63], v[144:147], a[104:107], v[60:63]
 v_mfma_f32_16x16x32_bf16 v[96:99], v[144:147], a[108:111], v[96:99]
 ds_read_b128 v[120:123], v5 offset:16384
 v_mfma_f32_16x16x32_bf16 v[64:67], v[148:151], a[104:107], v[64:67]
 ds_read_b128 v[124:127], v5 offset:17408
 v_mfma_f32_16x16x32_bf16 v[100:103], v[148:151], a[108:111], v[100:103]
 v_mfma_f32_16x16x32_bf16 v[68:71], v[152:155], a[104:107], v[68:71]
 ds_read_b128 v[128:131], v5 offset:18432
 v_mfma_f32_16x16x32_bf16 v[104:107], v[152:155], a[108:111], v[104:107]
 ds_read_b128 v[132:135], v5 offset:19456
 v_mfma_f32_16x16x32_bf16 v[72:75], v[156:159], a[104:107], v[72:75]
 v_mfma_f32_16x16x32_bf16 v[108:111], v[156:159], a[108:111], v[108:111]
 ds_read_b128 v[136:139], v5 offset:20480
 v_mfma_f32_16x16x32_bf16 v[40:43], v[160:163], a[104:107], v[40:43]
 s_add_u32 s87, s37, 38912
 buffer_load_dwordx4 a[144:147], v1, s[16:19], s87 offen sc1
 v_mfma_f32_16x16x32_bf16 v[76:79], v[160:163], a[108:111], v[76:79]
 v_mfma_f32_16x16x32_bf16 v[44:47], v[164:167], a[104:107], v[44:47]
 s_add_u32 s87, s37, 186368
 buffer_load_dwordx4 a[148:151], v1, s[16:19], s87 offen sc1
 v_mfma_f32_16x16x32_bf16 v[80:83], v[164:167], a[108:111], v[80:83]
 s_waitcnt lgkmcnt(0)
 s_waitcnt vmcnt(15)
 v_mfma_f32_16x16x32_bf16 v[56:59], v[112:115], a[112:115], v[56:59]
 ds_read_b128 v[140:143], v5 offset:21504
 v_mfma_f32_16x16x32_bf16 v[92:95], v[112:115], a[116:119], v[92:95]
 ds_read_b128 v[144:147], v5 offset:22528
 v_mfma_f32_16x16x32_bf16 v[60:63], v[116:119], a[112:115], v[60:63]
 v_mfma_f32_16x16x32_bf16 v[96:99], v[116:119], a[116:119], v[96:99]
 ds_read_b128 v[148:151], v5 offset:23552
 v_mfma_f32_16x16x32_bf16 v[64:67], v[120:123], a[112:115], v[64:67]
 ds_read_b128 v[152:155], v5 offset:24576
 v_mfma_f32_16x16x32_bf16 v[100:103], v[120:123], a[116:119], v[100:103]
 v_mfma_f32_16x16x32_bf16 v[68:71], v[124:127], a[112:115], v[68:71]
 ds_read_b128 v[156:159], v5 offset:25600
 v_mfma_f32_16x16x32_bf16 v[104:107], v[124:127], a[116:119], v[104:107]
 ds_read_b128 v[160:163], v5 offset:26624
 v_mfma_f32_16x16x32_bf16 v[72:75], v[128:131], a[112:115], v[72:75]
 v_mfma_f32_16x16x32_bf16 v[108:111], v[128:131], a[116:119], v[108:111]
 ds_read_b128 v[164:167], v5 offset:27648
 v_mfma_f32_16x16x32_bf16 v[40:43], v[132:135], a[112:115], v[40:43]
 s_add_u32 s87, s37, 39936
 buffer_load_dwordx4 a[152:155], v1, s[16:19], s87 offen sc1
 v_mfma_f32_16x16x32_bf16 v[76:79], v[132:135], a[116:119], v[76:79]
 v_mfma_f32_16x16x32_bf16 v[44:47], v[136:139], a[112:115], v[44:47]
 s_add_u32 s87, s37, 187392
 buffer_load_dwordx4 a[156:159], v1, s[16:19], s87 offen sc1
 v_mfma_f32_16x16x32_bf16 v[80:83], v[136:139], a[116:119], v[80:83]
 s_waitcnt lgkmcnt(0)
 s_waitcnt vmcnt(39)
 s_barrier
 s_waitcnt vmcnt(15)
 v_mfma_f32_16x16x32_bf16 v[56:59], v[140:143], a[120:123], v[56:59]
 ds_read_b128 v[112:115], v2 offset:0
 ds_read_b128 v[116:119], v2 offset:1024
 v_mfma_f32_16x16x32_bf16 v[92:95], v[140:143], a[124:127], v[92:95]
 ds_read_b128 v[120:123], v2 offset:2048
 v_mfma_f32_16x16x32_bf16 v[60:63], v[144:147], a[120:123], v[60:63]
 ds_read_b128 v[124:127], v2 offset:3072
 v_mfma_f32_16x16x32_bf16 v[96:99], v[144:147], a[124:127], v[96:99]
 ds_read_b128 v[128:131], v2 offset:4096
 v_mfma_f32_16x16x32_bf16 v[64:67], v[148:151], a[120:123], v[64:67]
 ds_read_b128 v[132:135], v2 offset:5120
 v_mfma_f32_16x16x32_bf16 v[100:103], v[148:151], a[124:127], v[100:103]
 ds_read_b128 v[136:139], v2 offset:6144
 v_mfma_f32_16x16x32_bf16 v[68:71], v[152:155], a[120:123], v[68:71]
 s_mul_i32 s39, s32, 7168
 s_add_u32 m0, s39, 110592
 s_add_u32 s40, s36, 2142208
 buffer_load_dwordx4 v1, s[12:15], s40 offen offset:0 lds
 v_mfma_f32_16x16x32_bf16 v[104:107], v[152:155], a[124:127], v[104:107]
 buffer_load_dwordx4 v1, s[12:15], s40 offen offset:1024 lds
 buffer_load_dwordx4 v1, s[12:15], s40 offen offset:2048 lds
 v_mfma_f32_16x16x32_bf16 v[72:75], v[156:159], a[120:123], v[72:75]
 buffer_load_dwordx4 v1, s[12:15], s40 offen offset:3072 lds
 v_mfma_f32_16x16x32_bf16 v[108:111], v[156:159], a[124:127], v[108:111]
 s_mul_i32 s39, s32, 7168
 s_add_u32 m0, s39, 114688
 s_add_u32 s40, s36, 2146304
 buffer_load_dwordx4 v1, s[12:15], s40 offen offset:0 lds
 v_mfma_f32_16x16x32_bf16 v[40:43], v[160:163], a[120:123], v[40:43]
 s_mul_i32 s39, s32, 7168
 s_add_u32 m0, s39, 115712
 s_add_u32 s40, s36, 2138112
 buffer_load_dwordx4 v1, s[12:15], s40 offen offset:0 lds
 v_mfma_f32_16x16x32_bf16 v[76:79], v[160:163], a[124:127], v[76:79]
 buffer_load_dwordx4 v1, s[12:15], s40 offen offset:1024 lds
 v_mfma_f32_16x16x32_bf16 v[44:47], v[164:167], a[120:123], v[44:47]
 s_add_u32 s87, s37, 43008
 buffer_load_dwordx4 a[160:163], v1, s[16:19], s87 offen sc1
 v_mfma_f32_16x16x32_bf16 v[80:83], v[164:167], a[124:127], v[80:83]
 s_add_u32 s87, s37, 190464
 buffer_load_dwordx4 a[164:167], v1, s[16:19], s87 offen sc1
 s_waitcnt lgkmcnt(0)
 s_waitcnt vmcnt(15)
 v_mfma_f32_16x16x32_bf16 v[56:59], v[112:115], a[128:131], v[56:59]
 ds_read_b128 v[140:143], v2 offset:7168
 v_mfma_f32_16x16x32_bf16 v[92:95], v[112:115], a[132:135], v[92:95]
 ds_read_b128 v[144:147], v2 offset:8192
 v_mfma_f32_16x16x32_bf16 v[60:63], v[116:119], a[128:131], v[60:63]
 v_mfma_f32_16x16x32_bf16 v[96:99], v[116:119], a[132:135], v[96:99]
 ds_read_b128 v[148:151], v2 offset:9216
 v_mfma_f32_16x16x32_bf16 v[64:67], v[120:123], a[128:131], v[64:67]
 ds_read_b128 v[152:155], v2 offset:10240
 v_mfma_f32_16x16x32_bf16 v[100:103], v[120:123], a[132:135], v[100:103]
 v_mfma_f32_16x16x32_bf16 v[68:71], v[124:127], a[128:131], v[68:71]
 ds_read_b128 v[156:159], v2 offset:11264
 v_mfma_f32_16x16x32_bf16 v[104:107], v[124:127], a[132:135], v[104:107]
 ds_read_b128 v[160:163], v2 offset:12288
 v_mfma_f32_16x16x32_bf16 v[72:75], v[128:131], a[128:131], v[72:75]
 v_mfma_f32_16x16x32_bf16 v[108:111], v[128:131], a[132:135], v[108:111]
 ds_read_b128 v[164:167], v2 offset:13312
 v_mfma_f32_16x16x32_bf16 v[40:43], v[132:135], a[128:131], v[40:43]
 s_add_u32 s87, s37, 44032
 buffer_load_dwordx4 a[168:171], v1, s[16:19], s87 offen sc1
 v_mfma_f32_16x16x32_bf16 v[76:79], v[132:135], a[132:135], v[76:79]
 v_mfma_f32_16x16x32_bf16 v[44:47], v[136:139], a[128:131], v[44:47]
 s_add_u32 s87, s37, 191488
 buffer_load_dwordx4 a[172:175], v1, s[16:19], s87 offen sc1
 v_mfma_f32_16x16x32_bf16 v[80:83], v[136:139], a[132:135], v[80:83]
 s_waitcnt lgkmcnt(0)
 s_waitcnt vmcnt(15)
 v_mfma_f32_16x16x32_bf16 v[56:59], v[140:143], a[136:139], v[56:59]
 ds_read_b128 v[112:115], v2 offset:14336
 v_mfma_f32_16x16x32_bf16 v[92:95], v[140:143], a[140:143], v[92:95]
 ds_read_b128 v[116:119], v2 offset:15360
 v_mfma_f32_16x16x32_bf16 v[60:63], v[144:147], a[136:139], v[60:63]
 v_mfma_f32_16x16x32_bf16 v[96:99], v[144:147], a[140:143], v[96:99]
 ds_read_b128 v[120:123], v2 offset:16384
 v_mfma_f32_16x16x32_bf16 v[64:67], v[148:151], a[136:139], v[64:67]
 ds_read_b128 v[124:127], v2 offset:17408
 v_mfma_f32_16x16x32_bf16 v[100:103], v[148:151], a[140:143], v[100:103]
 v_mfma_f32_16x16x32_bf16 v[68:71], v[152:155], a[136:139], v[68:71]
 ds_read_b128 v[128:131], v2 offset:18432
 v_mfma_f32_16x16x32_bf16 v[104:107], v[152:155], a[140:143], v[104:107]
 ds_read_b128 v[132:135], v2 offset:19456
 v_mfma_f32_16x16x32_bf16 v[72:75], v[156:159], a[136:139], v[72:75]
 v_mfma_f32_16x16x32_bf16 v[108:111], v[156:159], a[140:143], v[108:111]
 ds_read_b128 v[136:139], v2 offset:20480
 v_mfma_f32_16x16x32_bf16 v[40:43], v[160:163], a[136:139], v[40:43]
 s_add_u32 s87, s37, 47104
 buffer_load_dwordx4 a[176:179], v1, s[16:19], s87 offen sc1
 v_mfma_f32_16x16x32_bf16 v[76:79], v[160:163], a[140:143], v[76:79]
 v_mfma_f32_16x16x32_bf16 v[44:47], v[164:167], a[136:139], v[44:47]
 s_add_u32 s87, s37, 194560
 buffer_load_dwordx4 a[180:183], v1, s[16:19], s87 offen sc1
 v_mfma_f32_16x16x32_bf16 v[80:83], v[164:167], a[140:143], v[80:83]
 s_waitcnt lgkmcnt(0)
 s_waitcnt vmcnt(15)
 v_mfma_f32_16x16x32_bf16 v[56:59], v[112:115], a[144:147], v[56:59]
 ds_read_b128 v[140:143], v2 offset:21504
 v_mfma_f32_16x16x32_bf16 v[92:95], v[112:115], a[148:151], v[92:95]
 ds_read_b128 v[144:147], v2 offset:22528
 v_mfma_f32_16x16x32_bf16 v[60:63], v[116:119], a[144:147], v[60:63]
 v_mfma_f32_16x16x32_bf16 v[96:99], v[116:119], a[148:151], v[96:99]
 ds_read_b128 v[148:151], v2 offset:23552
 v_mfma_f32_16x16x32_bf16 v[64:67], v[120:123], a[144:147], v[64:67]
 ds_read_b128 v[152:155], v2 offset:24576
 v_mfma_f32_16x16x32_bf16 v[100:103], v[120:123], a[148:151], v[100:103]
 v_mfma_f32_16x16x32_bf16 v[68:71], v[124:127], a[144:147], v[68:71]
 ds_read_b128 v[156:159], v2 offset:25600
 v_mfma_f32_16x16x32_bf16 v[104:107], v[124:127], a[148:151], v[104:107]
 ds_read_b128 v[160:163], v2 offset:26624
 v_mfma_f32_16x16x32_bf16 v[72:75], v[128:131], a[144:147], v[72:75]
 v_mfma_f32_16x16x32_bf16 v[108:111], v[128:131], a[148:151], v[108:111]
 ds_read_b128 v[164:167], v2 offset:27648
 v_mfma_f32_16x16x32_bf16 v[40:43], v[132:135], a[144:147], v[40:43]
 s_add_u32 s87, s37, 48128
 buffer_load_dwordx4 a[184:187], v1, s[16:19], s87 offen sc1
 v_mfma_f32_16x16x32_bf16 v[76:79], v[132:135], a[148:151], v[76:79]
 v_mfma_f32_16x16x32_bf16 v[44:47], v[136:139], a[144:147], v[44:47]
 s_add_u32 s87, s37, 195584
 buffer_load_dwordx4 a[188:191], v1, s[16:19], s87 offen sc1
 v_mfma_f32_16x16x32_bf16 v[80:83], v[136:139], a[148:151], v[80:83]
 s_waitcnt lgkmcnt(0)
 s_waitcnt vmcnt(38)
 s_barrier
 s_waitcnt vmcnt(15)
 v_mfma_f32_16x16x32_bf16 v[56:59], v[140:143], a[152:155], v[56:59]
 ds_read_b128 v[112:115], v3 offset:0
 ds_read_b128 v[116:119], v3 offset:1024
 v_mfma_f32_16x16x32_bf16 v[92:95], v[140:143], a[156:159], v[92:95]
 ds_read_b128 v[120:123], v3 offset:2048
 v_mfma_f32_16x16x32_bf16 v[60:63], v[144:147], a[152:155], v[60:63]
 ds_read_b128 v[124:127], v3 offset:3072
 v_mfma_f32_16x16x32_bf16 v[96:99], v[144:147], a[156:159], v[96:99]
 ds_read_b128 v[128:131], v3 offset:4096
 v_mfma_f32_16x16x32_bf16 v[64:67], v[148:151], a[152:155], v[64:67]
 ds_read_b128 v[132:135], v3 offset:5120
 v_mfma_f32_16x16x32_bf16 v[100:103], v[148:151], a[156:159], v[100:103]
 ds_read_b128 v[136:139], v3 offset:6144
 v_mfma_f32_16x16x32_bf16 v[68:71], v[152:155], a[152:155], v[68:71]
 s_mul_i32 s39, s32, 7168
 s_add_u32 m0, s39, 0
 s_add_u32 s40, s38, 4870144
 buffer_load_dwordx4 v1, s[12:15], s40 offen offset:0 lds
 v_mfma_f32_16x16x32_bf16 v[104:107], v[152:155], a[156:159], v[104:107]
 buffer_load_dwordx4 v1, s[12:15], s40 offen offset:1024 lds
 buffer_load_dwordx4 v1, s[12:15], s40 offen offset:2048 lds
 v_mfma_f32_16x16x32_bf16 v[72:75], v[156:159], a[152:155], v[72:75]
 buffer_load_dwordx4 v1, s[12:15], s40 offen offset:3072 lds
 v_mfma_f32_16x16x32_bf16 v[108:111], v[156:159], a[156:159], v[108:111]
 s_mul_i32 s39, s32, 7168
 s_add_u32 m0, s39, 4096
 s_add_u32 s40, s38, 4874240
 buffer_load_dwordx4 v1, s[12:15], s40 offen offset:0 lds
 v_mfma_f32_16x16x32_bf16 v[40:43], v[160:163], a[152:155], v[40:43]
 s_mul_i32 s39, s32, 7168
 s_add_u32 m0, s39, 5120
 s_add_u32 s40, s38, 4866048
 buffer_load_dwordx4 v1, s[12:15], s40 offen offset:0 lds
 v_mfma_f32_16x16x32_bf16 v[76:79], v[160:163], a[156:159], v[76:79]
 buffer_load_dwordx4 v1, s[12:15], s40 offen offset:1024 lds
 v_mfma_f32_16x16x32_bf16 v[44:47], v[164:167], a[152:155], v[44:47]
 s_add_u32 s87, s37, 51200
 buffer_load_dwordx4 a[192:195], v1, s[16:19], s87 offen sc1
 v_mfma_f32_16x16x32_bf16 v[80:83], v[164:167], a[156:159], v[80:83]
 s_add_u32 s87, s37, 198656
 buffer_load_dwordx4 a[196:199], v1, s[16:19], s87 offen sc1
 s_waitcnt lgkmcnt(0)
 s_waitcnt vmcnt(15)
 v_mfma_f32_16x16x32_bf16 v[56:59], v[112:115], a[160:163], v[56:59]
 ds_read_b128 v[140:143], v3 offset:7168
 v_mfma_f32_16x16x32_bf16 v[92:95], v[112:115], a[164:167], v[92:95]
 ds_read_b128 v[144:147], v3 offset:8192
 v_mfma_f32_16x16x32_bf16 v[60:63], v[116:119], a[160:163], v[60:63]
 v_mfma_f32_16x16x32_bf16 v[96:99], v[116:119], a[164:167], v[96:99]
 ds_read_b128 v[148:151], v3 offset:9216
 v_mfma_f32_16x16x32_bf16 v[64:67], v[120:123], a[160:163], v[64:67]
 ds_read_b128 v[152:155], v3 offset:10240
 v_mfma_f32_16x16x32_bf16 v[100:103], v[120:123], a[164:167], v[100:103]
 v_mfma_f32_16x16x32_bf16 v[68:71], v[124:127], a[160:163], v[68:71]
 ds_read_b128 v[156:159], v3 offset:11264
 v_mfma_f32_16x16x32_bf16 v[104:107], v[124:127], a[164:167], v[104:107]
 ds_read_b128 v[160:163], v3 offset:12288
 v_mfma_f32_16x16x32_bf16 v[72:75], v[128:131], a[160:163], v[72:75]
 v_mfma_f32_16x16x32_bf16 v[108:111], v[128:131], a[164:167], v[108:111]
 ds_read_b128 v[164:167], v3 offset:13312
 v_mfma_f32_16x16x32_bf16 v[40:43], v[132:135], a[160:163], v[40:43]
 s_add_u32 s87, s37, 52224
 buffer_load_dwordx4 a[200:203], v1, s[16:19], s87 offen sc1
 v_mfma_f32_16x16x32_bf16 v[76:79], v[132:135], a[164:167], v[76:79]
 v_mfma_f32_16x16x32_bf16 v[44:47], v[136:139], a[160:163], v[44:47]
 s_add_u32 s87, s37, 199680
 buffer_load_dwordx4 a[204:207], v1, s[16:19], s87 offen sc1
 v_mfma_f32_16x16x32_bf16 v[80:83], v[136:139], a[164:167], v[80:83]
 s_waitcnt lgkmcnt(0)
 s_waitcnt vmcnt(15)
 v_mfma_f32_16x16x32_bf16 v[56:59], v[140:143], a[168:171], v[56:59]
 ds_read_b128 v[112:115], v3 offset:14336
 v_mfma_f32_16x16x32_bf16 v[92:95], v[140:143], a[172:175], v[92:95]
 ds_read_b128 v[116:119], v3 offset:15360
 v_mfma_f32_16x16x32_bf16 v[60:63], v[144:147], a[168:171], v[60:63]
 v_mfma_f32_16x16x32_bf16 v[96:99], v[144:147], a[172:175], v[96:99]
 ds_read_b128 v[120:123], v3 offset:16384
 v_mfma_f32_16x16x32_bf16 v[64:67], v[148:151], a[168:171], v[64:67]
 ds_read_b128 v[124:127], v3 offset:17408
 v_mfma_f32_16x16x32_bf16 v[100:103], v[148:151], a[172:175], v[100:103]
 v_mfma_f32_16x16x32_bf16 v[68:71], v[152:155], a[168:171], v[68:71]
 ds_read_b128 v[128:131], v3 offset:18432
 v_mfma_f32_16x16x32_bf16 v[104:107], v[152:155], a[172:175], v[104:107]
 ds_read_b128 v[132:135], v3 offset:19456
 v_mfma_f32_16x16x32_bf16 v[72:75], v[156:159], a[168:171], v[72:75]
 v_mfma_f32_16x16x32_bf16 v[108:111], v[156:159], a[172:175], v[108:111]
 ds_read_b128 v[136:139], v3 offset:20480
 v_mfma_f32_16x16x32_bf16 v[40:43], v[160:163], a[168:171], v[40:43]
 s_add_u32 s87, s37, 55296
 buffer_load_dwordx4 a[208:211], v1, s[16:19], s87 offen sc1
 v_mfma_f32_16x16x32_bf16 v[76:79], v[160:163], a[172:175], v[76:79]
 v_mfma_f32_16x16x32_bf16 v[44:47], v[164:167], a[168:171], v[44:47]
 s_add_u32 s87, s37, 202752
 buffer_load_dwordx4 a[212:215], v1, s[16:19], s87 offen sc1
 v_mfma_f32_16x16x32_bf16 v[80:83], v[164:167], a[172:175], v[80:83]
 s_waitcnt lgkmcnt(0)
 s_waitcnt vmcnt(15)
 v_mfma_f32_16x16x32_bf16 v[56:59], v[112:115], a[176:179], v[56:59]
 ds_read_b128 v[140:143], v3 offset:21504
 v_mfma_f32_16x16x32_bf16 v[92:95], v[112:115], a[180:183], v[92:95]
 ds_read_b128 v[144:147], v3 offset:22528
 v_mfma_f32_16x16x32_bf16 v[60:63], v[116:119], a[176:179], v[60:63]
 v_mfma_f32_16x16x32_bf16 v[96:99], v[116:119], a[180:183], v[96:99]
 ds_read_b128 v[148:151], v3 offset:23552
 v_mfma_f32_16x16x32_bf16 v[64:67], v[120:123], a[176:179], v[64:67]
 ds_read_b128 v[152:155], v3 offset:24576
 v_mfma_f32_16x16x32_bf16 v[100:103], v[120:123], a[180:183], v[100:103]
 v_mfma_f32_16x16x32_bf16 v[68:71], v[124:127], a[176:179], v[68:71]
 ds_read_b128 v[156:159], v3 offset:25600
 v_mfma_f32_16x16x32_bf16 v[104:107], v[124:127], a[180:183], v[104:107]
 ds_read_b128 v[160:163], v3 offset:26624
 v_mfma_f32_16x16x32_bf16 v[72:75], v[128:131], a[176:179], v[72:75]
 v_mfma_f32_16x16x32_bf16 v[108:111], v[128:131], a[180:183], v[108:111]
 ds_read_b128 v[164:167], v3 offset:27648
 v_mfma_f32_16x16x32_bf16 v[40:43], v[132:135], a[176:179], v[40:43]
 s_add_u32 s87, s37, 56320
 buffer_load_dwordx4 a[216:219], v1, s[16:19], s87 offen sc1
 v_mfma_f32_16x16x32_bf16 v[76:79], v[132:135], a[180:183], v[76:79]
 v_mfma_f32_16x16x32_bf16 v[44:47], v[136:139], a[176:179], v[44:47]
 s_add_u32 s87, s37, 203776
 buffer_load_dwordx4 a[220:223], v1, s[16:19], s87 offen sc1
 v_mfma_f32_16x16x32_bf16 v[80:83], v[136:139], a[180:183], v[80:83]
 s_waitcnt lgkmcnt(0)
 s_waitcnt vmcnt(38)
 s_barrier
 s_waitcnt vmcnt(15)
 v_mfma_f32_16x16x32_bf16 v[56:59], v[140:143], a[184:187], v[56:59]
 ds_read_b128 v[112:115], v4 offset:0
 v_mfma_f32_16x16x32_bf16 v[92:95], v[140:143], a[188:191], v[92:95]
 ds_read_b128 v[116:119], v4 offset:1024
 v_mfma_f32_16x16x32_bf16 v[60:63], v[144:147], a[184:187], v[60:63]
 v_mfma_f32_16x16x32_bf16 v[96:99], v[144:147], a[188:191], v[96:99]
 ds_read_b128 v[120:123], v4 offset:2048
 v_mfma_f32_16x16x32_bf16 v[64:67], v[148:151], a[184:187], v[64:67]
 ds_read_b128 v[124:127], v4 offset:3072
 v_mfma_f32_16x16x32_bf16 v[100:103], v[148:151], a[188:191], v[100:103]
 v_mfma_f32_16x16x32_bf16 v[68:71], v[152:155], a[184:187], v[68:71]
 ds_read_b128 v[128:131], v4 offset:4096
 v_mfma_f32_16x16x32_bf16 v[104:107], v[152:155], a[188:191], v[104:107]
 ds_read_b128 v[132:135], v4 offset:5120
 v_mfma_f32_16x16x32_bf16 v[72:75], v[156:159], a[184:187], v[72:75]
 v_mfma_f32_16x16x32_bf16 v[108:111], v[156:159], a[188:191], v[108:111]
 ds_read_b128 v[136:139], v4 offset:6144
 v_mfma_f32_16x16x32_bf16 v[40:43], v[160:163], a[184:187], v[40:43]
 s_add_u32 s87, s37, 59392
 buffer_load_dwordx4 a[224:227], v1, s[16:19], s87 offen sc1
 v_mfma_f32_16x16x32_bf16 v[76:79], v[160:163], a[188:191], v[76:79]
 v_mfma_f32_16x16x32_bf16 v[44:47], v[164:167], a[184:187], v[44:47]
 s_add_u32 s87, s37, 206848
 buffer_load_dwordx4 a[228:231], v1, s[16:19], s87 offen sc1
 v_mfma_f32_16x16x32_bf16 v[80:83], v[164:167], a[188:191], v[80:83]
 s_waitcnt lgkmcnt(0)
 s_waitcnt vmcnt(8)
 v_mfma_f32_16x16x32_bf16 v[56:59], v[112:115], a[192:195], v[56:59]
 ds_read_b128 v[140:143], v4 offset:7168
 v_mfma_f32_16x16x32_bf16 v[92:95], v[112:115], a[196:199], v[92:95]
 ds_read_b128 v[144:147], v4 offset:8192
 v_mfma_f32_16x16x32_bf16 v[60:63], v[116:119], a[192:195], v[60:63]
 v_mfma_f32_16x16x32_bf16 v[96:99], v[116:119], a[196:199], v[96:99]
 ds_read_b128 v[148:151], v4 offset:9216
 v_mfma_f32_16x16x32_bf16 v[64:67], v[120:123], a[192:195], v[64:67]
 ds_read_b128 v[152:155], v4 offset:10240
 v_mfma_f32_16x16x32_bf16 v[100:103], v[120:123], a[196:199], v[100:103]
 v_mfma_f32_16x16x32_bf16 v[68:71], v[124:127], a[192:195], v[68:71]
 ds_read_b128 v[156:159], v4 offset:11264
 v_mfma_f32_16x16x32_bf16 v[104:107], v[124:127], a[196:199], v[104:107]
 ds_read_b128 v[160:163], v4 offset:12288
 v_mfma_f32_16x16x32_bf16 v[72:75], v[128:131], a[192:195], v[72:75]
 v_mfma_f32_16x16x32_bf16 v[108:111], v[128:131], a[196:199], v[108:111]
 ds_read_b128 v[164:167], v4 offset:13312
 v_mfma_f32_16x16x32_bf16 v[40:43], v[132:135], a[192:195], v[40:43]
 s_add_u32 s87, s37, 60416
 buffer_load_dwordx4 a[232:235], v1, s[16:19], s87 offen sc1
 v_mfma_f32_16x16x32_bf16 v[76:79], v[132:135], a[196:199], v[76:79]
 v_mfma_f32_16x16x32_bf16 v[44:47], v[136:139], a[192:195], v[44:47]
 s_add_u32 s87, s37, 207872
 buffer_load_dwordx4 a[236:239], v1, s[16:19], s87 offen sc1
 v_mfma_f32_16x16x32_bf16 v[80:83], v[136:139], a[196:199], v[80:83]
 s_waitcnt lgkmcnt(0)
 s_waitcnt vmcnt(8)
 v_mfma_f32_16x16x32_bf16 v[56:59], v[140:143], a[200:203], v[56:59]
 ds_read_b128 v[112:115], v4 offset:14336
 v_mfma_f32_16x16x32_bf16 v[92:95], v[140:143], a[204:207], v[92:95]
 ds_read_b128 v[116:119], v4 offset:15360
 v_mfma_f32_16x16x32_bf16 v[60:63], v[144:147], a[200:203], v[60:63]
 v_mfma_f32_16x16x32_bf16 v[96:99], v[144:147], a[204:207], v[96:99]
 ds_read_b128 v[120:123], v4 offset:16384
 v_mfma_f32_16x16x32_bf16 v[64:67], v[148:151], a[200:203], v[64:67]
 ds_read_b128 v[124:127], v4 offset:17408
 v_mfma_f32_16x16x32_bf16 v[100:103], v[148:151], a[204:207], v[100:103]
 v_mfma_f32_16x16x32_bf16 v[68:71], v[152:155], a[200:203], v[68:71]
 ds_read_b128 v[128:131], v4 offset:18432
 v_mfma_f32_16x16x32_bf16 v[104:107], v[152:155], a[204:207], v[104:107]
 ds_read_b128 v[132:135], v4 offset:19456
 v_mfma_f32_16x16x32_bf16 v[72:75], v[156:159], a[200:203], v[72:75]
 v_mfma_f32_16x16x32_bf16 v[108:111], v[156:159], a[204:207], v[108:111]
 ds_read_b128 v[136:139], v4 offset:20480
 v_mfma_f32_16x16x32_bf16 v[40:43], v[160:163], a[200:203], v[40:43]
 s_add_u32 s87, s37, 63488
 buffer_load_dwordx4 a[240:243], v1, s[16:19], s87 offen sc1
 v_mfma_f32_16x16x32_bf16 v[76:79], v[160:163], a[204:207], v[76:79]
 v_mfma_f32_16x16x32_bf16 v[44:47], v[164:167], a[200:203], v[44:47]
 s_add_u32 s87, s37, 210944
 buffer_load_dwordx4 a[244:247], v1, s[16:19], s87 offen sc1
 v_mfma_f32_16x16x32_bf16 v[80:83], v[164:167], a[204:207], v[80:83]
 s_waitcnt lgkmcnt(0)
 s_waitcnt vmcnt(8)
 v_mfma_f32_16x16x32_bf16 v[56:59], v[112:115], a[208:211], v[56:59]
 ds_read_b128 v[140:143], v4 offset:21504
 v_mfma_f32_16x16x32_bf16 v[92:95], v[112:115], a[212:215], v[92:95]
 ds_read_b128 v[144:147], v4 offset:22528
 v_mfma_f32_16x16x32_bf16 v[60:63], v[116:119], a[208:211], v[60:63]
 v_mfma_f32_16x16x32_bf16 v[96:99], v[116:119], a[212:215], v[96:99]
 ds_read_b128 v[148:151], v4 offset:23552
 v_mfma_f32_16x16x32_bf16 v[64:67], v[120:123], a[208:211], v[64:67]
 ds_read_b128 v[152:155], v4 offset:24576
 v_mfma_f32_16x16x32_bf16 v[100:103], v[120:123], a[212:215], v[100:103]
 v_mfma_f32_16x16x32_bf16 v[68:71], v[124:127], a[208:211], v[68:71]
 ds_read_b128 v[156:159], v4 offset:25600
 v_mfma_f32_16x16x32_bf16 v[104:107], v[124:127], a[212:215], v[104:107]
 ds_read_b128 v[160:163], v4 offset:26624
 v_mfma_f32_16x16x32_bf16 v[72:75], v[128:131], a[208:211], v[72:75]
 v_mfma_f32_16x16x32_bf16 v[108:111], v[128:131], a[212:215], v[108:111]
 ds_read_b128 v[164:167], v4 offset:27648
 v_mfma_f32_16x16x32_bf16 v[40:43], v[132:135], a[208:211], v[40:43]
 s_add_u32 s87, s37, 64512
 buffer_load_dwordx4 a[248:251], v1, s[16:19], s87 offen sc1
 v_mfma_f32_16x16x32_bf16 v[76:79], v[132:135], a[212:215], v[76:79]
 v_mfma_f32_16x16x32_bf16 v[44:47], v[136:139], a[208:211], v[44:47]
 s_add_u32 s87, s37, 211968
 buffer_load_dwordx4 a[252:255], v1, s[16:19], s87 offen sc1
 v_mfma_f32_16x16x32_bf16 v[80:83], v[136:139], a[212:215], v[80:83]
 s_waitcnt lgkmcnt(0)
 s_waitcnt vmcnt(31)
 s_barrier
 s_waitcnt vmcnt(8)
 v_mfma_f32_16x16x32_bf16 v[56:59], v[140:143], a[216:219], v[56:59]
 ds_read_b128 v[112:115], v5 offset:0
 v_mfma_f32_16x16x32_bf16 v[92:95], v[140:143], a[220:223], v[92:95]
 ds_read_b128 v[116:119], v5 offset:1024
 v_mfma_f32_16x16x32_bf16 v[60:63], v[144:147], a[216:219], v[60:63]
 v_mfma_f32_16x16x32_bf16 v[96:99], v[144:147], a[220:223], v[96:99]
 ds_read_b128 v[120:123], v5 offset:2048
 v_mfma_f32_16x16x32_bf16 v[64:67], v[148:151], a[216:219], v[64:67]
 ds_read_b128 v[124:127], v5 offset:3072
 v_mfma_f32_16x16x32_bf16 v[100:103], v[148:151], a[220:223], v[100:103]
 v_mfma_f32_16x16x32_bf16 v[68:71], v[152:155], a[216:219], v[68:71]
 ds_read_b128 v[128:131], v5 offset:4096
 v_mfma_f32_16x16x32_bf16 v[104:107], v[152:155], a[220:223], v[104:107]
 ds_read_b128 v[132:135], v5 offset:5120
 v_mfma_f32_16x16x32_bf16 v[72:75], v[156:159], a[216:219], v[72:75]
 v_mfma_f32_16x16x32_bf16 v[108:111], v[156:159], a[220:223], v[108:111]
 ds_read_b128 v[136:139], v5 offset:6144
 v_mfma_f32_16x16x32_bf16 v[40:43], v[160:163], a[216:219], v[40:43]
 s_add_u32 s87, s37, 135168
 buffer_load_dwordx4 v[8:11], v1, s[16:19], s87 offen sc1
 v_mfma_f32_16x16x32_bf16 v[76:79], v[160:163], a[220:223], v[76:79]
 v_mfma_f32_16x16x32_bf16 v[44:47], v[164:167], a[216:219], v[44:47]
 s_add_u32 s87, s37, 282624
 buffer_load_dwordx4 v[12:15], v1, s[16:19], s87 offen sc1
 v_mfma_f32_16x16x32_bf16 v[80:83], v[164:167], a[220:223], v[80:83]
 s_waitcnt lgkmcnt(0)
 s_waitcnt vmcnt(8)
 v_mfma_f32_16x16x32_bf16 v[56:59], v[112:115], a[224:227], v[56:59]
 ds_read_b128 v[140:143], v5 offset:7168
 v_mfma_f32_16x16x32_bf16 v[92:95], v[112:115], a[228:231], v[92:95]
 ds_read_b128 v[144:147], v5 offset:8192
 v_mfma_f32_16x16x32_bf16 v[60:63], v[116:119], a[224:227], v[60:63]
 v_mfma_f32_16x16x32_bf16 v[96:99], v[116:119], a[228:231], v[96:99]
 ds_read_b128 v[148:151], v5 offset:9216
 v_mfma_f32_16x16x32_bf16 v[64:67], v[120:123], a[224:227], v[64:67]
 ds_read_b128 v[152:155], v5 offset:10240
 v_mfma_f32_16x16x32_bf16 v[100:103], v[120:123], a[228:231], v[100:103]
 v_mfma_f32_16x16x32_bf16 v[68:71], v[124:127], a[224:227], v[68:71]
 ds_read_b128 v[156:159], v5 offset:11264
 v_mfma_f32_16x16x32_bf16 v[104:107], v[124:127], a[228:231], v[104:107]
 ds_read_b128 v[160:163], v5 offset:12288
 v_mfma_f32_16x16x32_bf16 v[72:75], v[128:131], a[224:227], v[72:75]
 v_mfma_f32_16x16x32_bf16 v[108:111], v[128:131], a[228:231], v[108:111]
 ds_read_b128 v[164:167], v5 offset:13312
 v_mfma_f32_16x16x32_bf16 v[40:43], v[132:135], a[224:227], v[40:43]
 s_add_u32 s87, s37, 136192
 buffer_load_dwordx4 v[16:19], v1, s[16:19], s87 offen sc1
 v_mfma_f32_16x16x32_bf16 v[76:79], v[132:135], a[228:231], v[76:79]
 v_mfma_f32_16x16x32_bf16 v[44:47], v[136:139], a[224:227], v[44:47]
 s_add_u32 s87, s37, 283648
 buffer_load_dwordx4 v[20:23], v1, s[16:19], s87 offen sc1
 v_mfma_f32_16x16x32_bf16 v[80:83], v[136:139], a[228:231], v[80:83]
 s_waitcnt lgkmcnt(0)
 s_waitcnt vmcnt(8)
 v_mfma_f32_16x16x32_bf16 v[56:59], v[140:143], a[232:235], v[56:59]
 ds_read_b128 v[112:115], v5 offset:14336
 v_mfma_f32_16x16x32_bf16 v[92:95], v[140:143], a[236:239], v[92:95]
 ds_read_b128 v[116:119], v5 offset:15360
 v_mfma_f32_16x16x32_bf16 v[60:63], v[144:147], a[232:235], v[60:63]
 v_mfma_f32_16x16x32_bf16 v[96:99], v[144:147], a[236:239], v[96:99]
 ds_read_b128 v[120:123], v5 offset:16384
 v_mfma_f32_16x16x32_bf16 v[64:67], v[148:151], a[232:235], v[64:67]
 ds_read_b128 v[124:127], v5 offset:17408
 v_mfma_f32_16x16x32_bf16 v[100:103], v[148:151], a[236:239], v[100:103]
 v_mfma_f32_16x16x32_bf16 v[68:71], v[152:155], a[232:235], v[68:71]
 ds_read_b128 v[128:131], v5 offset:18432
 v_mfma_f32_16x16x32_bf16 v[104:107], v[152:155], a[236:239], v[104:107]
 ds_read_b128 v[132:135], v5 offset:19456
 v_mfma_f32_16x16x32_bf16 v[72:75], v[156:159], a[232:235], v[72:75]
 v_mfma_f32_16x16x32_bf16 v[108:111], v[156:159], a[236:239], v[108:111]
 ds_read_b128 v[136:139], v5 offset:20480
 v_mfma_f32_16x16x32_bf16 v[40:43], v[160:163], a[232:235], v[40:43]
 s_add_u32 s87, s37, 137216
 buffer_load_dwordx4 v[24:27], v1, s[16:19], s87 offen sc1
 v_mfma_f32_16x16x32_bf16 v[76:79], v[160:163], a[236:239], v[76:79]
 v_mfma_f32_16x16x32_bf16 v[44:47], v[164:167], a[232:235], v[44:47]
 s_add_u32 s87, s37, 284672
 buffer_load_dwordx4 v[28:31], v1, s[16:19], s87 offen sc1
 v_mfma_f32_16x16x32_bf16 v[80:83], v[164:167], a[236:239], v[80:83]
 s_waitcnt lgkmcnt(0)
 s_waitcnt vmcnt(8)
 v_mfma_f32_16x16x32_bf16 v[56:59], v[112:115], a[240:243], v[56:59]
 ds_read_b128 v[140:143], v5 offset:21504
 v_mfma_f32_16x16x32_bf16 v[92:95], v[112:115], a[244:247], v[92:95]
 ds_read_b128 v[144:147], v5 offset:22528
 v_mfma_f32_16x16x32_bf16 v[60:63], v[116:119], a[240:243], v[60:63]
 v_mfma_f32_16x16x32_bf16 v[96:99], v[116:119], a[244:247], v[96:99]
 ds_read_b128 v[148:151], v5 offset:23552
 v_mfma_f32_16x16x32_bf16 v[64:67], v[120:123], a[240:243], v[64:67]
 ds_read_b128 v[152:155], v5 offset:24576
 v_mfma_f32_16x16x32_bf16 v[100:103], v[120:123], a[244:247], v[100:103]
 v_mfma_f32_16x16x32_bf16 v[68:71], v[124:127], a[240:243], v[68:71]
 ds_read_b128 v[156:159], v5 offset:25600
 v_mfma_f32_16x16x32_bf16 v[104:107], v[124:127], a[244:247], v[104:107]
 ds_read_b128 v[160:163], v5 offset:26624
 v_mfma_f32_16x16x32_bf16 v[72:75], v[128:131], a[240:243], v[72:75]
 v_mfma_f32_16x16x32_bf16 v[108:111], v[128:131], a[244:247], v[108:111]
 ds_read_b128 v[164:167], v5 offset:27648
 v_mfma_f32_16x16x32_bf16 v[40:43], v[132:135], a[240:243], v[40:43]
 s_add_u32 s87, s37, 138240
 buffer_load_dwordx4 v[32:35], v1, s[16:19], s87 offen sc1
 v_mfma_f32_16x16x32_bf16 v[76:79], v[132:135], a[244:247], v[76:79]
 v_mfma_f32_16x16x32_bf16 v[44:47], v[136:139], a[240:243], v[44:47]
 s_add_u32 s87, s37, 285696
 buffer_load_dwordx4 v[36:39], v1, s[16:19], s87 offen sc1
 v_mfma_f32_16x16x32_bf16 v[80:83], v[136:139], a[244:247], v[80:83]
 s_waitcnt lgkmcnt(0)
 s_waitcnt vmcnt(24)
 s_barrier
 s_waitcnt vmcnt(8)
 v_mfma_f32_16x16x32_bf16 v[56:59], v[140:143], a[248:251], v[56:59]
 ds_read_b128 v[112:115], v2 offset:0
 v_mfma_f32_16x16x32_bf16 v[92:95], v[140:143], a[252:255], v[92:95]
 ds_read_b128 v[116:119], v2 offset:1024
 v_mfma_f32_16x16x32_bf16 v[60:63], v[144:147], a[248:251], v[60:63]
 ds_read_b128 v[120:123], v2 offset:2048
 v_mfma_f32_16x16x32_bf16 v[96:99], v[144:147], a[252:255], v[96:99]
 ds_read_b128 v[124:127], v2 offset:3072
 v_mfma_f32_16x16x32_bf16 v[64:67], v[148:151], a[248:251], v[64:67]
 ds_read_b128 v[128:131], v2 offset:4096
 v_mfma_f32_16x16x32_bf16 v[100:103], v[148:151], a[252:255], v[100:103]
 ds_read_b128 v[132:135], v2 offset:5120
 v_mfma_f32_16x16x32_bf16 v[68:71], v[152:155], a[248:251], v[68:71]
 ds_read_b128 v[136:139], v2 offset:6144
 v_mfma_f32_16x16x32_bf16 v[104:107], v[152:155], a[252:255], v[104:107]
 s_add_u32 s81, s80, 0
 s_and_b32 s82, s81, 15
 s_lshr_b32 s83, s82, 1
 s_lshl_b32 s83, s83, 2
 s_and_b32 s82, s82, 1
 s_add_u32 s83, s83, s82
 s_lshr_b32 s82, s81, 4
 s_lshl_b32 s82, s82, 1
 s_add_u32 s83, s83, s82
 s_add_u32 s83, s83, 32
 s_add_u32 s82, s81, 100
 s_cmp_ge_u32 s81, 32
 s_cselect_b32 s83, s82, s83
 s_mul_i32 s83, s83, 36864
 s_add_u32 s83, s83, s41
 s_add_u32 s40, s83, 2048
 s_mul_i32 s39, s32, 6144
 s_add_u32 m0, s39, 36864
 s_nop 0
 buffer_load_dwordx4 v1, s[12:15], s40 offen offset:0 lds
 v_mfma_f32_16x16x32_bf16 v[72:75], v[156:159], a[248:251], v[72:75]
 buffer_load_dwordx4 v1, s[12:15], s40 offen offset:1024 lds
 v_mfma_f32_16x16x32_bf16 v[108:111], v[156:159], a[252:255], v[108:111]
 s_add_u32 s81, s80, 1
 s_and_b32 s82, s81, 15
 s_lshr_b32 s83, s82, 1
 s_lshl_b32 s83, s83, 2
 s_and_b32 s82, s82, 1
 s_add_u32 s83, s83, s82
 s_lshr_b32 s82, s81, 4
 s_lshl_b32 s82, s82, 1
 s_add_u32 s83, s83, s82
 s_add_u32 s83, s83, 32
 s_add_u32 s82, s81, 100
 s_cmp_ge_u32 s81, 32
 s_cselect_b32 s83, s82, s83
 s_mul_i32 s83, s83, 36864
 s_add_u32 s83, s83, s41
 s_add_u32 s40, s83, 2048
 s_mul_i32 s39, s32, 6144
 s_add_u32 m0, s39, 38912
 s_nop 0
 buffer_load_dwordx4 v1, s[12:15], s40 offen offset:0 lds
 v_mfma_f32_16x16x32_bf16 v[40:43], v[160:163], a[248:251], v[40:43]
 buffer_load_dwordx4 v1, s[12:15], s40 offen offset:1024 lds
 v_mfma_f32_16x16x32_bf16 v[76:79], v[160:163], a[252:255], v[76:79]
 s_add_u32 s81, s80, 2
 s_and_b32 s82, s81, 15
 s_lshr_b32 s83, s82, 1
 s_lshl_b32 s83, s83, 2
 s_and_b32 s82, s82, 1
 s_add_u32 s83, s83, s82
 s_lshr_b32 s82, s81, 4
 s_lshl_b32 s82, s82, 1
 s_add_u32 s83, s83, s82
 s_add_u32 s83, s83, 32
 s_add_u32 s82, s81, 100
 s_cmp_ge_u32 s81, 32
 s_cselect_b32 s83, s82, s83
 s_mul_i32 s83, s83, 36864
 s_add_u32 s83, s83, s41
 s_add_u32 s40, s83, 2048
 s_mul_i32 s39, s32, 6144
 s_add_u32 m0, s39, 40960
 s_nop 0
 buffer_load_dwordx4 v1, s[12:15], s40 offen offset:0 lds
 v_mfma_f32_16x16x32_bf16 v[44:47], v[164:167], a[248:251], v[44:47]
 buffer_load_dwordx4 v1, s[12:15], s40 offen offset:1024 lds
 v_mfma_f32_16x16x32_bf16 v[80:83], v[164:167], a[252:255], v[80:83]
 s_waitcnt lgkmcnt(0)
 s_waitcnt vmcnt(12)
 v_mfma_f32_16x16x32_bf16 v[56:59], v[112:115], v[8:11], v[56:59]
 ds_read_b128 v[140:143], v2 offset:7168
 v_mfma_f32_16x16x32_bf16 v[92:95], v[112:115], v[12:15], v[92:95]
 v_mfma_f32_16x16x32_bf16 v[60:63], v[116:119], v[8:11], v[60:63]
 ds_read_b128 v[144:147], v2 offset:8192
 v_mfma_f32_16x16x32_bf16 v[96:99], v[116:119], v[12:15], v[96:99]
 v_mfma_f32_16x16x32_bf16 v[64:67], v[120:123], v[8:11], v[64:67]
 ds_read_b128 v[148:151], v2 offset:9216
 v_mfma_f32_16x16x32_bf16 v[100:103], v[120:123], v[12:15], v[100:103]
 v_mfma_f32_16x16x32_bf16 v[68:71], v[124:127], v[8:11], v[68:71]
 ds_read_b128 v[152:155], v2 offset:10240
 v_mfma_f32_16x16x32_bf16 v[104:107], v[124:127], v[12:15], v[104:107]
 v_mfma_f32_16x16x32_bf16 v[72:75], v[128:131], v[8:11], v[72:75]
 ds_read_b128 v[156:159], v2 offset:11264
 v_mfma_f32_16x16x32_bf16 v[108:111], v[128:131], v[12:15], v[108:111]
 v_mfma_f32_16x16x32_bf16 v[40:43], v[132:135], v[8:11], v[40:43]
 ds_read_b128 v[160:163], v2 offset:12288
 v_mfma_f32_16x16x32_bf16 v[76:79], v[132:135], v[12:15], v[76:79]
 v_mfma_f32_16x16x32_bf16 v[44:47], v[136:139], v[8:11], v[44:47]
 ds_read_b128 v[164:167], v2 offset:13312
 v_mfma_f32_16x16x32_bf16 v[80:83], v[136:139], v[12:15], v[80:83]
 s_waitcnt lgkmcnt(0)
 s_waitcnt vmcnt(10)
 v_mfma_f32_16x16x32_bf16 v[56:59], v[140:143], v[16:19], v[56:59]
 ds_read_b128 v[112:115], v2 offset:14336
 v_mfma_f32_16x16x32_bf16 v[92:95], v[140:143], v[20:23], v[92:95]
 v_mfma_f32_16x16x32_bf16 v[60:63], v[144:147], v[16:19], v[60:63]
 ds_read_b128 v[116:119], v2 offset:15360
 v_mfma_f32_16x16x32_bf16 v[96:99], v[144:147], v[20:23], v[96:99]
 v_mfma_f32_16x16x32_bf16 v[64:67], v[148:151], v[16:19], v[64:67]
 ds_read_b128 v[120:123], v2 offset:16384
 v_mfma_f32_16x16x32_bf16 v[100:103], v[148:151], v[20:23], v[100:103]
 v_mfma_f32_16x16x32_bf16 v[68:71], v[152:155], v[16:19], v[68:71]
 ds_read_b128 v[124:127], v2 offset:17408
 v_mfma_f32_16x16x32_bf16 v[104:107], v[152:155], v[20:23], v[104:107]
 v_mfma_f32_16x16x32_bf16 v[72:75], v[156:159], v[16:19], v[72:75]
 ds_read_b128 v[128:131], v2 offset:18432
 v_mfma_f32_16x16x32_bf16 v[108:111], v[156:159], v[20:23], v[108:111]
 v_mfma_f32_16x16x32_bf16 v[40:43], v[160:163], v[16:19], v[40:43]
 ds_read_b128 v[132:135], v2 offset:19456
 v_mfma_f32_16x16x32_bf16 v[76:79], v[160:163], v[20:23], v[76:79]
 v_mfma_f32_16x16x32_bf16 v[44:47], v[164:167], v[16:19], v[44:47]
 ds_read_b128 v[136:139], v2 offset:20480
 v_mfma_f32_16x16x32_bf16 v[80:83], v[164:167], v[20:23], v[80:83]
 s_waitcnt lgkmcnt(0)
 s_waitcnt vmcnt(8)
 v_mfma_f32_16x16x32_bf16 v[56:59], v[112:115], v[24:27], v[56:59]
 ds_read_b128 v[140:143], v2 offset:21504
 v_mfma_f32_16x16x32_bf16 v[92:95], v[112:115], v[28:31], v[92:95]
 v_mfma_f32_16x16x32_bf16 v[60:63], v[116:119], v[24:27], v[60:63]
 ds_read_b128 v[144:147], v2 offset:22528
 v_mfma_f32_16x16x32_bf16 v[96:99], v[116:119], v[28:31], v[96:99]
 v_mfma_f32_16x16x32_bf16 v[64:67], v[120:123], v[24:27], v[64:67]
 ds_read_b128 v[148:151], v2 offset:23552
 v_mfma_f32_16x16x32_bf16 v[100:103], v[120:123], v[28:31], v[100:103]
 v_mfma_f32_16x16x32_bf16 v[68:71], v[124:127], v[24:27], v[68:71]
 ds_read_b128 v[152:155], v2 offset:24576
 v_mfma_f32_16x16x32_bf16 v[104:107], v[124:127], v[28:31], v[104:107]
 v_mfma_f32_16x16x32_bf16 v[72:75], v[128:131], v[24:27], v[72:75]
 ds_read_b128 v[156:159], v2 offset:25600
 v_mfma_f32_16x16x32_bf16 v[108:111], v[128:131], v[28:31], v[108:111]
 v_mfma_f32_16x16x32_bf16 v[40:43], v[132:135], v[24:27], v[40:43]
 ds_read_b128 v[160:163], v2 offset:26624
 v_mfma_f32_16x16x32_bf16 v[76:79], v[132:135], v[28:31], v[76:79]
 v_mfma_f32_16x16x32_bf16 v[44:47], v[136:139], v[24:27], v[44:47]
 ds_read_b128 v[164:167], v2 offset:27648
 v_mfma_f32_16x16x32_bf16 v[80:83], v[136:139], v[28:31], v[80:83]
 s_waitcnt lgkmcnt(0)
 s_waitcnt vmcnt(0)
 s_barrier
 s_waitcnt vmcnt(6)
 v_mfma_f32_16x16x32_bf16 v[56:59], v[140:143], v[32:35], v[56:59]
 ds_read_b128 v[112:115], v3 offset:0
 v_mfma_f32_16x16x32_bf16 v[92:95], v[140:143], v[36:39], v[92:95]
 ds_read_b128 v[116:119], v3 offset:1024
 v_mfma_f32_16x16x32_bf16 v[60:63], v[144:147], v[32:35], v[60:63]
 v_mfma_f32_16x16x32_bf16 v[96:99], v[144:147], v[36:39], v[96:99]
 s_add_u32 s81, s80, 12
 s_and_b32 s82, s81, 15
 s_lshr_b32 s83, s82, 1
 s_lshl_b32 s83, s83, 2
 s_and_b32 s82, s82, 1
 s_add_u32 s83, s83, s82
 s_lshr_b32 s82, s81, 4
 s_lshl_b32 s82, s82, 1
 s_add_u32 s83, s83, s82
 s_add_u32 s83, s83, 32
 s_add_u32 s82, s81, 100
 s_cmp_ge_u32 s81, 32
 s_cselect_b32 s83, s82, s83
 s_mul_i32 s83, s83, 36864
 s_add_u32 s83, s83, s41
 s_add_u32 s40, s83, 2048
 s_mul_i32 s39, s32, 6144
 s_add_u32 m0, s39, 73728
 s_nop 0
 buffer_load_dwordx4 v1, s[12:15], s40 offen offset:0 lds
 v_mfma_f32_16x16x32_bf16 v[64:67], v[148:151], v[32:35], v[64:67]
 v_mfma_f32_16x16x32_bf16 v[100:103], v[148:151], v[36:39], v[100:103]
 buffer_load_dwordx4 v1, s[12:15], s40 offen offset:1024 lds
 v_mfma_f32_16x16x32_bf16 v[68:71], v[152:155], v[32:35], v[68:71]
 v_mfma_f32_16x16x32_bf16 v[104:107], v[152:155], v[36:39], v[104:107]
 s_add_u32 s81, s80, 13
 s_and_b32 s82, s81, 15
 s_lshr_b32 s83, s82, 1
 s_lshl_b32 s83, s83, 2
 s_and_b32 s82, s82, 1
 s_add_u32 s83, s83, s82
 s_lshr_b32 s82, s81, 4
 s_lshl_b32 s82, s82, 1
 s_add_u32 s83, s83, s82
 s_add_u32 s83, s83, 32
 s_add_u32 s82, s81, 100
 s_cmp_ge_u32 s81, 32
 s_cselect_b32 s83, s82, s83
 s_mul_i32 s83, s83, 36864
 s_add_u32 s83, s83, s41
 s_add_u32 s40, s83, 2048
 s_mul_i32 s39, s32, 6144
 s_add_u32 m0, s39, 75776
 s_nop 0
 buffer_load_dwordx4 v1, s[12:15], s40 offen offset:0 lds
 v_mfma_f32_16x16x32_bf16 v[72:75], v[156:159], v[32:35], v[72:75]
 buffer_load_dwordx4 v1, s[12:15], s40 offen offset:1024 lds
 v_mfma_f32_16x16x32_bf16 v[108:111], v[156:159], v[36:39], v[108:111]
 v_mfma_f32_16x16x32_bf16 v[40:43], v[160:163], v[32:35], v[40:43]
 s_add_u32 s81, s80, 14
 s_and_b32 s82, s81, 15
 s_lshr_b32 s83, s82, 1
 s_lshl_b32 s83, s83, 2
 s_and_b32 s82, s82, 1
 s_add_u32 s83, s83, s82
 s_lshr_b32 s82, s81, 4
 s_lshl_b32 s82, s82, 1
 s_add_u32 s83, s83, s82
 s_add_u32 s83, s83, 32
 s_add_u32 s82, s81, 100
 s_cmp_ge_u32 s81, 32
 s_cselect_b32 s83, s82, s83
 s_mul_i32 s83, s83, 36864
 s_add_u32 s83, s83, s41
 s_add_u32 s40, s83, 2048
 s_mul_i32 s39, s32, 6144
 s_add_u32 m0, s39, 77824
 s_nop 0
 buffer_load_dwordx4 v1, s[12:15], s40 offen offset:0 lds
 v_mfma_f32_16x16x32_bf16 v[76:79], v[160:163], v[36:39], v[76:79]
 v_mfma_f32_16x16x32_bf16 v[44:47], v[164:167], v[32:35], v[44:47]
 buffer_load_dwordx4 v1, s[12:15], s40 offen offset:1024 lds
 v_mfma_f32_16x16x32_bf16 v[80:83], v[164:167], v[36:39], v[80:83]
 s_waitcnt lgkmcnt(0)
 v_mfma_f32_16x16x32_bf16 v[48:51], v[112:115], a[0:3], 0
 ds_read_b128 v[124:127], v3 offset:2048
 ds_read_b128 v[128:131], v3 offset:3072
 ds_read_b128 v[136:139], v3 offset:4096
 v_mfma_f32_16x16x32_bf16 v[84:87], v[112:115], a[4:7], 0
 ds_read_b128 v[140:143], v3 offset:5120
 ds_read_b128 v[148:151], v3 offset:6144
 v_mfma_f32_16x16x32_bf16 v[52:55], v[116:119], a[0:3], 0
 ds_read_b128 v[152:155], v3 offset:7168
 v_lshrrev_b32 v224, 4, v0
 v_mfma_f32_16x16x32_bf16 v[88:91], v[116:119], a[4:7], 0
 v_lshlrev_b32 v224, 4, v224
 s_add_u32 s39, s58, 0
 s_and_b32 s40, s39, 1
 s_lshl_b32 s40, s40, 3
 s_lshr_b32 s39, s39, 1
 s_lshl_b32 s39, s39, 10
 s_add_u32 s39, s39, s40
 s_mul_i32 s40, s57, 18432
 s_add_u32 s39, s39, s40
 buffer_load_dwordx2 v[200:201], v1, s[44:47], s39 offen sc1
 s_add_u32 s39, s39, 18432
 s_waitcnt lgkmcnt(4)
 v_mfma_f32_16x16x32_bf16 v[48:51], v[124:127], a[8:11], v[48:51]
 v_cvt_pk_bf16_f32 v176, v56, v57
 v_cvt_pk_bf16_f32 v177, v58, v59
 v_cvt_pk_bf16_f32 v178, v60, v61
 v_cvt_pk_bf16_f32 v179, v62, v63
 v_mfma_f32_16x16x32_bf16 v[84:87], v[124:127], a[12:15], v[84:87]
 v_cvt_pk_bf16_f32 v180, v92, v93
 v_cvt_pk_bf16_f32 v181, v94, v95
 v_cvt_pk_bf16_f32 v182, v96, v97
 v_mfma_f32_16x16x32_bf16 v[52:55], v[128:131], a[8:11], v[52:55]
 v_cvt_pk_bf16_f32 v183, v98, v99
 ds_read_b128 v[112:115], v3 offset:8192
 ds_read_b128 v[116:119], v3 offset:9216
 v_mfma_f32_16x16x32_bf16 v[88:91], v[128:131], a[12:15], v[88:91]
 buffer_load_dwordx2 v[202:203], v1, s[44:47], s39 offen sc1
 s_add_u32 s39, s58, 0
 s_lshl_b32 s39, s39, 6
 s_add_u32 s39, s39, 11520
 buffer_load_dwordx4 v[212:215], v224, s[48:51], s39 offen
 s_add_u32 s39, s58, 1
 s_and_b32 s40, s39, 1
 s_lshl_b32 s40, s40, 3
 s_lshr_b32 s39, s39, 1
 s_lshl_b32 s39, s39, 10
 s_add_u32 s39, s39, s40
 s_mul_i32 s40, s57, 18432
 s_add_u32 s39, s39, s40
 buffer_load_dwordx2 v[204:205], v1, s[44:47], s39 offen sc1
 s_add_u32 s39, s39, 18432
 s_waitcnt lgkmcnt(4)
 v_mfma_f32_16x16x32_bf16 v[48:51], v[136:139], a[16:19], v[48:51]
 s_lshl_b32 s43, s42, 2
 s_add_u32 s43, s43, 2
 s_lshl_b32 s43, s43, 2
 s_add_u32 s43, s43, 1
 s_lshl_b32 s43, s43, 2
 s_add_u32 s43, s43, s32
 s_mul_i32 s43, s43, 3072
 buffer_store_dwordx4 v[176:179], v1, s[24:27], s43 offen offset:0 sc1
 buffer_store_dwordx4 v[180:183], v1, s[24:27], s43 offen offset:1024 sc1
 v_cvt_pk_bf16_f32 v184, v64, v65
 v_mfma_f32_16x16x32_bf16 v[84:87], v[136:139], a[20:23], v[84:87]
 v_cvt_pk_bf16_f32 v185, v66, v67
 v_cvt_pk_bf16_f32 v186, v68, v69
 v_cvt_pk_bf16_f32 v187, v70, v71
 v_mfma_f32_16x16x32_bf16 v[52:55], v[140:143], a[16:19], v[52:55]
 v_cvt_pk_bf16_f32 v192, v72, v73
 v_cvt_pk_bf16_f32 v193, v74, v75
 ds_read_b128 v[124:127], v3 offset:10240
 v_mfma_f32_16x16x32_bf16 v[88:91], v[140:143], a[20:23], v[88:91]
 ds_read_b128 v[128:131], v3 offset:11264
 buffer_load_dwordx2 v[206:207], v1, s[44:47], s39 offen sc1
 s_add_u32 s39, s58, 1
 s_lshl_b32 s39, s39, 6
 s_add_u32 s39, s39, 11520
 buffer_load_dwordx4 v[216:219], v224, s[48:51], s39 offen
 s_waitcnt lgkmcnt(4)
 v_mfma_f32_16x16x32_bf16 v[48:51], v[148:151], a[24:27], v[48:51]
 v_cvt_pk_bf16_f32 v188, v100, v101
 v_cvt_pk_bf16_f32 v189, v102, v103
 v_cvt_pk_bf16_f32 v190, v104, v105
 v_mfma_f32_16x16x32_bf16 v[84:87], v[148:151], a[28:31], v[84:87]
 v_cvt_pk_bf16_f32 v191, v106, v107
 v_cvt_pk_bf16_f32 v194, v108, v109
 v_mfma_f32_16x16x32_bf16 v[52:55], v[152:155], a[24:27], v[52:55]
 v_cvt_pk_bf16_f32 v195, v110, v111
 s_lshl_b32 s43, s42, 2
 s_add_u32 s43, s43, 3
 s_lshl_b32 s43, s43, 2
 s_add_u32 s43, s43, 1
 s_lshl_b32 s43, s43, 2
 s_add_u32 s43, s43, s32
 s_mul_i32 s43, s43, 3072
 buffer_store_dwordx4 v[184:187], v1, s[24:27], s43 offen offset:0 sc1
 buffer_store_dwordx4 v[188:191], v1, s[24:27], s43 offen offset:1024 sc1
 v_mfma_f32_16x16x32_bf16 v[88:91], v[152:155], a[28:31], v[88:91]
 ds_read_b128 v[136:139], v3 offset:12288
 ds_read_b128 v[140:143], v3 offset:13312
 s_waitcnt lgkmcnt(4)
 v_mfma_f32_16x16x32_bf16 v[48:51], v[112:115], a[32:35], v[48:51]
 buffer_store_dwordx4 v[192:195], v1, s[24:27], s43 offen offset:2048 sc1
 v_cvt_pk_bf16_f32 v168, v40, v41
 v_cvt_pk_bf16_f32 v169, v42, v43
 v_mfma_f32_16x16x32_bf16 v[84:87], v[112:115], a[36:39], v[84:87]
 v_cvt_pk_bf16_f32 v170, v44, v45
 v_cvt_pk_bf16_f32 v171, v46, v47
 v_mfma_f32_16x16x32_bf16 v[52:55], v[116:119], a[32:35], v[52:55]
 v_cvt_pk_bf16_f32 v172, v76, v77
 v_cvt_pk_bf16_f32 v173, v78, v79
 v_cvt_pk_bf16_f32 v174, v80, v81
 v_mfma_f32_16x16x32_bf16 v[88:91], v[116:119], a[36:39], v[88:91]
 ds_read_b128 v[148:151], v3 offset:14336
 ds_read_b128 v[152:155], v3 offset:15360
 s_waitcnt lgkmcnt(4)
 v_mfma_f32_16x16x32_bf16 v[48:51], v[124:127], a[40:43], v[48:51]
 v_cvt_pk_bf16_f32 v175, v82, v83
 s_lshl_b32 s43, s42, 2
 s_add_u32 s43, s43, 0
 s_lshl_b32 s43, s43, 2
 s_add_u32 s43, s43, 1
 s_lshl_b32 s43, s43, 2
 s_add_u32 s43, s43, s32
 s_mul_i32 s43, s43, 3072
 buffer_store_dwordx4 v[168:171], v1, s[24:27], s43 offen offset:0 sc1
 v_mfma_f32_16x16x32_bf16 v[84:87], v[124:127], a[44:47], v[84:87]
 buffer_store_dwordx4 v[172:175], v1, s[24:27], s43 offen offset:1024 sc1
 v_mfma_f32_16x16x32_bf16 v[52:55], v[128:131], a[40:43], v[52:55]
 ds_read_b128 v[112:115], v3 offset:16384
 v_mfma_f32_16x16x32_bf16 v[88:91], v[128:131], a[44:47], v[88:91]
 ds_read_b128 v[116:119], v3 offset:17408
 s_waitcnt lgkmcnt(4)
 v_mfma_f32_16x16x32_bf16 v[48:51], v[136:139], a[48:51], v[48:51]
 ds_read_b128 v[124:127], v3 offset:18432
 v_mfma_f32_16x16x32_bf16 v[84:87], v[136:139], a[52:55], v[84:87]
 v_mfma_f32_16x16x32_bf16 v[52:55], v[140:143], a[48:51], v[52:55]
 ds_read_b128 v[128:131], v3 offset:19456
 v_mfma_f32_16x16x32_bf16 v[88:91], v[140:143], a[52:55], v[88:91]
 s_waitcnt lgkmcnt(4)
 v_mfma_f32_16x16x32_bf16 v[48:51], v[148:151], a[56:59], v[48:51]
 ds_read_b128 v[136:139], v3 offset:20480
 v_mfma_f32_16x16x32_bf16 v[84:87], v[148:151], a[60:63], v[84:87]
 v_mfma_f32_16x16x32_bf16 v[52:55], v[152:155], a[56:59], v[52:55]
 ds_read_b128 v[140:143], v3 offset:21504
 v_mfma_f32_16x16x32_bf16 v[88:91], v[152:155], a[60:63], v[88:91]
 s_waitcnt lgkmcnt(4)
 v_mfma_f32_16x16x32_bf16 v[48:51], v[112:115], a[64:67], v[48:51]
 ds_read_b128 v[148:151], v3 offset:22528
 v_mfma_f32_16x16x32_bf16 v[84:87], v[112:115], a[68:71], v[84:87]
 v_mfma_f32_16x16x32_bf16 v[52:55], v[116:119], a[64:67], v[52:55]
 ds_read_b128 v[152:155], v3 offset:23552
 v_mfma_f32_16x16x32_bf16 v[88:91], v[116:119], a[68:71], v[88:91]
 s_waitcnt lgkmcnt(0)
 s_waitcnt vmcnt(13)
 s_barrier
 v_mfma_f32_16x16x32_bf16 v[48:51], v[124:127], a[72:75], v[48:51]
 ds_read_b128 v[112:115], v4 offset:0
 ds_read_b128 v[116:119], v4 offset:1024
 v_mfma_f32_16x16x32_bf16 v[84:87], v[124:127], a[76:79], v[84:87]
 s_add_u32 s81, s80, 24
 s_and_b32 s82, s81, 15
 s_lshr_b32 s83, s82, 1
 s_lshl_b32 s83, s83, 2
 s_and_b32 s82, s82, 1
 s_add_u32 s83, s83, s82
 s_lshr_b32 s82, s81, 4
 s_lshl_b32 s82, s82, 1
 s_add_u32 s83, s83, s82
 s_add_u32 s83, s83, 32
 s_add_u32 s82, s81, 100
 s_cmp_ge_u32 s81, 32
 s_cselect_b32 s83, s82, s83
 s_mul_i32 s83, s83, 36864
 s_add_u32 s83, s83, s41
 s_add_u32 s40, s83, 2048
 s_mul_i32 s39, s32, 6144
 s_add_u32 m0, s39, 110592
 s_nop 0
 buffer_load_dwordx4 v1, s[12:15], s40 offen offset:0 lds
 v_mfma_f32_16x16x32_bf16 v[52:55], v[128:131], a[72:75], v[52:55]
 buffer_load_dwordx4 v1, s[12:15], s40 offen offset:1024 lds
 v_mfma_f32_16x16x32_bf16 v[88:91], v[128:131], a[76:79], v[88:91]
 s_add_u32 s81, s80, 25
 s_and_b32 s82, s81, 15
 s_lshr_b32 s83, s82, 1
 s_lshl_b32 s83, s83, 2
 s_and_b32 s82, s82, 1
 s_add_u32 s83, s83, s82
 s_lshr_b32 s82, s81, 4
 s_lshl_b32 s82, s82, 1
 s_add_u32 s83, s83, s82
 s_add_u32 s83, s83, 32
 s_add_u32 s82, s81, 100
 s_cmp_ge_u32 s81, 32
 s_cselect_b32 s83, s82, s83
 s_mul_i32 s83, s83, 36864
 s_add_u32 s83, s83, s41
 s_add_u32 s40, s83, 2048
 s_mul_i32 s39, s32, 6144
 s_add_u32 m0, s39, 112640
 s_nop 0
 buffer_load_dwordx4 v1, s[12:15], s40 offen offset:0 lds
 s_waitcnt lgkmcnt(2)
 v_mfma_f32_16x16x32_bf16 v[48:51], v[136:139], a[80:83], v[48:51]
 ds_read_b128 v[124:127], v4 offset:2048
 ds_read_b128 v[128:131], v4 offset:3072
 v_mfma_f32_16x16x32_bf16 v[84:87], v[136:139], a[84:87], v[84:87]
 buffer_load_dwordx4 v1, s[12:15], s40 offen offset:1024 lds
 v_mfma_f32_16x16x32_bf16 v[52:55], v[140:143], a[80:83], v[52:55]
 s_add_u32 s81, s80, 26
 s_and_b32 s82, s81, 15
 s_lshr_b32 s83, s82, 1
 s_lshl_b32 s83, s83, 2
 s_and_b32 s82, s82, 1
 s_add_u32 s83, s83, s82
 s_lshr_b32 s82, s81, 4
 s_lshl_b32 s82, s82, 1
 s_add_u32 s83, s83, s82
 s_add_u32 s83, s83, 32
 s_add_u32 s82, s81, 100
 s_cmp_ge_u32 s81, 32
 s_cselect_b32 s83, s82, s83
 s_mul_i32 s83, s83, 36864
 s_add_u32 s83, s83, s41
 s_add_u32 s40, s83, 2048
 s_mul_i32 s39, s32, 6144
 s_add_u32 m0, s39, 114688
 s_nop 0
 buffer_load_dwordx4 v1, s[12:15], s40 offen offset:0 lds
 v_mfma_f32_16x16x32_bf16 v[88:91], v[140:143], a[84:87], v[88:91]
 buffer_load_dwordx4 v1, s[12:15], s40 offen offset:1024 lds
 s_waitcnt lgkmcnt(4)
 v_mfma_f32_16x16x32_bf16 v[48:51], v[148:151], a[88:91], v[48:51]
 ds_read_b128 v[136:139], v4 offset:4096
 v_mfma_f32_16x16x32_bf16 v[84:87], v[148:151], a[92:95], v[84:87]
 v_mfma_f32_16x16x32_bf16 v[52:55], v[152:155], a[88:91], v[52:55]
 ds_read_b128 v[140:143], v4 offset:5120
 v_mfma_f32_16x16x32_bf16 v[88:91], v[152:155], a[92:95], v[88:91]
 s_waitcnt lgkmcnt(4)
 v_mfma_f32_16x16x32_bf16 v[48:51], v[112:115], a[96:99], v[48:51]
 ds_read_b128 v[148:151], v4 offset:6144
 v_mfma_f32_16x16x32_bf16 v[84:87], v[112:115], a[100:103], v[84:87]
 v_mfma_f32_16x16x32_bf16 v[52:55], v[116:119], a[96:99], v[52:55]
 ds_read_b128 v[152:155], v4 offset:7168
 v_mfma_f32_16x16x32_bf16 v[88:91], v[116:119], a[100:103], v[88:91]
 s_waitcnt lgkmcnt(4)
 v_mfma_f32_16x16x32_bf16 v[48:51], v[124:127], a[104:107], v[48:51]
 ds_read_b128 v[112:115], v4 offset:8192
 v_mfma_f32_16x16x32_bf16 v[84:87], v[124:127], a[108:111], v[84:87]
 v_mfma_f32_16x16x32_bf16 v[52:55], v[128:131], a[104:107], v[52:55]
 ds_read_b128 v[116:119], v4 offset:9216
 v_mfma_f32_16x16x32_bf16 v[88:91], v[128:131], a[108:111], v[88:91]
 s_waitcnt lgkmcnt(4)
 v_mfma_f32_16x16x32_bf16 v[48:51], v[136:139], a[112:115], v[48:51]
 ds_read_b128 v[124:127], v4 offset:10240
 v_mfma_f32_16x16x32_bf16 v[84:87], v[136:139], a[116:119], v[84:87]
 v_mfma_f32_16x16x32_bf16 v[52:55], v[140:143], a[112:115], v[52:55]
 ds_read_b128 v[128:131], v4 offset:11264
 v_mfma_f32_16x16x32_bf16 v[88:91], v[140:143], a[116:119], v[88:91]
 s_waitcnt lgkmcnt(4)
 v_mfma_f32_16x16x32_bf16 v[48:51], v[148:151], a[120:123], v[48:51]
 ds_read_b128 v[136:139], v4 offset:12288
 v_mfma_f32_16x16x32_bf16 v[84:87], v[148:151], a[124:127], v[84:87]
 v_mfma_f32_16x16x32_bf16 v[52:55], v[152:155], a[120:123], v[52:55]
 ds_read_b128 v[140:143], v4 offset:13312
 v_mfma_f32_16x16x32_bf16 v[88:91], v[152:155], a[124:127], v[88:91]
 s_waitcnt lgkmcnt(4)
 v_mfma_f32_16x16x32_bf16 v[48:51], v[112:115], a[128:131], v[48:51]
 ds_read_b128 v[148:151], v4 offset:14336
 v_mfma_f32_16x16x32_bf16 v[84:87], v[112:115], a[132:135], v[84:87]
 v_mfma_f32_16x16x32_bf16 v[52:55], v[116:119], a[128:131], v[52:55]
 ds_read_b128 v[152:155], v4 offset:15360
 v_mfma_f32_16x16x32_bf16 v[88:91], v[116:119], a[132:135], v[88:91]
 s_waitcnt lgkmcnt(4)
 v_mfma_f32_16x16x32_bf16 v[48:51], v[124:127], a[136:139], v[48:51]
 ds_read_b128 v[112:115], v4 offset:16384
 v_mfma_f32_16x16x32_bf16 v[84:87], v[124:127], a[140:143], v[84:87]
 v_mfma_f32_16x16x32_bf16 v[52:55], v[128:131], a[136:139], v[52:55]
 ds_read_b128 v[116:119], v4 offset:17408
 v_mfma_f32_16x16x32_bf16 v[88:91], v[128:131], a[140:143], v[88:91]
 s_waitcnt lgkmcnt(4)
 v_mfma_f32_16x16x32_bf16 v[48:51], v[136:139], a[144:147], v[48:51]
 ds_read_b128 v[124:127], v4 offset:18432
 v_mfma_f32_16x16x32_bf16 v[84:87], v[136:139], a[148:151], v[84:87]
 v_mfma_f32_16x16x32_bf16 v[52:55], v[140:143], a[144:147], v[52:55]
 ds_read_b128 v[128:131], v4 offset:19456
 v_mfma_f32_16x16x32_bf16 v[88:91], v[140:143], a[148:151], v[88:91]
 s_waitcnt lgkmcnt(4)
 v_mfma_f32_16x16x32_bf16 v[48:51], v[148:151], a[152:155], v[48:51]
 ds_read_b128 v[136:139], v4 offset:20480
 v_mfma_f32_16x16x32_bf16 v[84:87], v[148:151], a[156:159], v[84:87]
 v_mfma_f32_16x16x32_bf16 v[52:55], v[152:155], a[152:155], v[52:55]
 ds_read_b128 v[140:143], v4 offset:21504
 v_mfma_f32_16x16x32_bf16 v[88:91], v[152:155], a[156:159], v[88:91]
 s_waitcnt lgkmcnt(4)
 v_mfma_f32_16x16x32_bf16 v[48:51], v[112:115], a[160:163], v[48:51]
 ds_read_b128 v[148:151], v4 offset:22528
 v_mfma_f32_16x16x32_bf16 v[84:87], v[112:115], a[164:167], v[84:87]
 v_mfma_f32_16x16x32_bf16 v[52:55], v[116:119], a[160:163], v[52:55]
 ds_read_b128 v[152:155], v4 offset:23552
 v_mfma_f32_16x16x32_bf16 v[88:91], v[116:119], a[164:167], v[88:91]
 s_waitcnt lgkmcnt(0)
 s_waitcnt vmcnt(0)
 s_barrier
 v_mfma_f32_16x16x32_bf16 v[48:51], v[124:127], a[168:171], v[48:51]
 ds_read_b128 v[112:115], v5 offset:0
 v_mfma_f32_16x16x32_bf16 v[84:87], v[124:127], a[172:175], v[84:87]
 v_mfma_f32_16x16x32_bf16 v[52:55], v[128:131], a[168:171], v[52:55]
 ds_read_b128 v[116:119], v5 offset:1024
 v_mfma_f32_16x16x32_bf16 v[88:91], v[128:131], a[172:175], v[88:91]
 s_waitcnt lgkmcnt(2)
 v_mfma_f32_16x16x32_bf16 v[48:51], v[136:139], a[176:179], v[48:51]
 ds_read_b128 v[124:127], v5 offset:2048
 v_mfma_f32_16x16x32_bf16 v[84:87], v[136:139], a[180:183], v[84:87]
 v_mfma_f32_16x16x32_bf16 v[52:55], v[140:143], a[176:179], v[52:55]
 ds_read_b128 v[128:131], v5 offset:3072
 v_mfma_f32_16x16x32_bf16 v[88:91], v[140:143], a[180:183], v[88:91]
 s_waitcnt lgkmcnt(4)
 v_mfma_f32_16x16x32_bf16 v[48:51], v[148:151], a[184:187], v[48:51]
 ds_read_b128 v[136:139], v5 offset:4096
 v_mfma_f32_16x16x32_bf16 v[84:87], v[148:151], a[188:191], v[84:87]
 v_mfma_f32_16x16x32_bf16 v[52:55], v[152:155], a[184:187], v[52:55]
 ds_read_b128 v[140:143], v5 offset:5120
 v_mfma_f32_16x16x32_bf16 v[88:91], v[152:155], a[188:191], v[88:91]
 s_waitcnt lgkmcnt(4)
 v_mfma_f32_16x16x32_bf16 v[48:51], v[112:115], a[192:195], v[48:51]
 ds_read_b128 v[148:151], v5 offset:6144
 v_mfma_f32_16x16x32_bf16 v[84:87], v[112:115], a[196:199], v[84:87]
 v_mfma_f32_16x16x32_bf16 v[52:55], v[116:119], a[192:195], v[52:55]
 ds_read_b128 v[152:155], v5 offset:7168
 v_mfma_f32_16x16x32_bf16 v[88:91], v[116:119], a[196:199], v[88:91]
 s_waitcnt lgkmcnt(4)
 v_mfma_f32_16x16x32_bf16 v[48:51], v[124:127], a[200:203], v[48:51]
 ds_read_b128 v[112:115], v5 offset:8192
 v_mfma_f32_16x16x32_bf16 v[84:87], v[124:127], a[204:207], v[84:87]
 v_mfma_f32_16x16x32_bf16 v[52:55], v[128:131], a[200:203], v[52:55]
 ds_read_b128 v[116:119], v5 offset:9216
 v_mfma_f32_16x16x32_bf16 v[88:91], v[128:131], a[204:207], v[88:91]
 s_waitcnt lgkmcnt(4)
 s_waitcnt vmcnt(6)
 s_barrier
 s_cmp_eq_u32 s32, 0
 s_cbranch_scc0 L_g2_nosig1
 v_mov_b32 v225, 1
 s_mov_b64 s[76:77], exec
 s_mov_b64 exec, 1
 buffer_atomic_add v225, v6, s[28:31], 0 offen sc1
 s_mov_b64 exec, s[76:77]
L_g2_nosig1:
 s_nop 0
 s_nop 2
 v_mfma_f32_16x16x32_bf16 v[48:51], v[136:139], a[208:211], v[48:51]
 ds_read_b128 v[124:127], v5 offset:10240
 v_mfma_f32_16x16x32_bf16 v[84:87], v[136:139], a[212:215], v[84:87]
 v_mfma_f32_16x16x32_bf16 v[52:55], v[140:143], a[208:211], v[52:55]
 ds_read_b128 v[128:131], v5 offset:11264
 v_mfma_f32_16x16x32_bf16 v[88:91], v[140:143], a[212:215], v[88:91]
 s_waitcnt lgkmcnt(4)
 v_mfma_f32_16x16x32_bf16 v[48:51], v[148:151], a[216:219], v[48:51]
 ds_read_b128 v[136:139], v5 offset:12288
 v_mfma_f32_16x16x32_bf16 v[84:87], v[148:151], a[220:223], v[84:87]
 v_mfma_f32_16x16x32_bf16 v[52:55], v[152:155], a[216:219], v[52:55]
 ds_read_b128 v[140:143], v5 offset:13312
 v_mfma_f32_16x16x32_bf16 v[88:91], v[152:155], a[220:223], v[88:91]
 s_waitcnt lgkmcnt(4)
 v_mfma_f32_16x16x32_bf16 v[48:51], v[112:115], a[224:227], v[48:51]
 ds_read_b128 v[148:151], v5 offset:14336
 v_mfma_f32_16x16x32_bf16 v[84:87], v[112:115], a[228:231], v[84:87]
 v_mfma_f32_16x16x32_bf16 v[52:55], v[116:119], a[224:227], v[52:55]
 ds_read_b128 v[152:155], v5 offset:15360
 v_mfma_f32_16x16x32_bf16 v[88:91], v[116:119], a[228:231], v[88:91]
 s_waitcnt lgkmcnt(4)
 v_mfma_f32_16x16x32_bf16 v[48:51], v[124:127], a[232:235], v[48:51]
 ds_read_b128 v[112:115], v5 offset:16384
 v_mfma_f32_16x16x32_bf16 v[84:87], v[124:127], a[236:239], v[84:87]
 v_mfma_f32_16x16x32_bf16 v[52:55], v[128:131], a[232:235], v[52:55]
 ds_read_b128 v[116:119], v5 offset:17408
 v_mfma_f32_16x16x32_bf16 v[88:91], v[128:131], a[236:239], v[88:91]
 s_waitcnt lgkmcnt(4)
 v_mfma_f32_16x16x32_bf16 v[48:51], v[136:139], a[240:243], v[48:51]
 ds_read_b128 v[124:127], v5 offset:18432
 v_mfma_f32_16x16x32_bf16 v[84:87], v[136:139], a[244:247], v[84:87]
 v_mfma_f32_16x16x32_bf16 v[52:55], v[140:143], a[240:243], v[52:55]
 ds_read_b128 v[128:131], v5 offset:19456
 v_mfma_f32_16x16x32_bf16 v[88:91], v[140:143], a[244:247], v[88:91]
 s_waitcnt lgkmcnt(4)
 v_mfma_f32_16x16x32_bf16 v[48:51], v[148:151], a[248:251], v[48:51]
 ds_read_b128 v[136:139], v5 offset:20480
 v_mfma_f32_16x16x32_bf16 v[84:87], v[148:151], a[252:255], v[84:87]
 v_mfma_f32_16x16x32_bf16 v[52:55], v[152:155], a[248:251], v[52:55]
 ds_read_b128 v[140:143], v5 offset:21504
 v_mfma_f32_16x16x32_bf16 v[88:91], v[152:155], a[252:255], v[88:91]
 s_waitcnt lgkmcnt(4)
 v_mfma_f32_16x16x32_bf16 v[48:51], v[112:115], v[8:11], v[48:51]
 ds_read_b128 v[148:151], v5 offset:22528
 v_mfma_f32_16x16x32_bf16 v[84:87], v[112:115], v[12:15], v[84:87]
 v_mfma_f32_16x16x32_bf16 v[52:55], v[116:119], v[8:11], v[52:55]
 ds_read_b128 v[152:155], v5 offset:23552
 v_mfma_f32_16x16x32_bf16 v[88:91], v[116:119], v[12:15], v[88:91]
 s_waitcnt lgkmcnt(4)
 v_mfma_f32_16x16x32_bf16 v[48:51], v[124:127], v[16:19], v[48:51]
 v_mfma_f32_16x16x32_bf16 v[84:87], v[124:127], v[20:23], v[84:87]
 v_mfma_f32_16x16x32_bf16 v[52:55], v[128:131], v[16:19], v[52:55]
 v_mfma_f32_16x16x32_bf16 v[88:91], v[128:131], v[20:23], v[88:91]
 s_waitcnt lgkmcnt(2)
 v_mfma_f32_16x16x32_bf16 v[48:51], v[136:139], v[24:27], v[48:51]
 v_mfma_f32_16x16x32_bf16 v[84:87], v[136:139], v[28:31], v[84:87]
 v_mfma_f32_16x16x32_bf16 v[52:55], v[140:143], v[24:27], v[52:55]
 v_mfma_f32_16x16x32_bf16 v[88:91], v[140:143], v[28:31], v[88:91]
 s_waitcnt lgkmcnt(0)
 v_mfma_f32_16x16x32_bf16 v[48:51], v[148:151], v[32:35], v[48:51]
 v_mfma_f32_16x16x32_bf16 v[84:87], v[148:151], v[36:39], v[84:87]
 v_mfma_f32_16x16x32_bf16 v[52:55], v[152:155], v[32:35], v[52:55]
 v_mfma_f32_16x16x32_bf16 v[88:91], v[152:155], v[36:39], v[88:91]
 s_lshl_b32 s84, s42, 2
 s_add_u32 s84, s84, 1
 s_lshl_b32 s84, s84, 2
 s_add_u32 s84, s84, 0
 s_lshl_b32 s84, s84, 2
 s_add_u32 s84, s84, s32
 s_mul_i32 s84, s84, 3072
 s_lshl_b32 s85, s42, 2
 s_add_u32 s85, s85, 1
 s_lshl_b32 s85, s85, 2
 s_add_u32 s85, s85, 2
 s_lshl_b32 s85, s85, 2
 s_add_u32 s85, s85, s32
 s_mul_i32 s85, s85, 3072
 s_lshl_b32 s86, s42, 2
 s_add_u32 s86, s86, 1
 s_lshl_b32 s86, s86, 2
 s_add_u32 s86, s86, 3
 s_lshl_b32 s86, s86, 2
 s_add_u32 s86, s86, s32
 s_mul_i32 s86, s86, 3072
 s_mul_i32 s40, s32, 3584
 v_and_b32 v2, 15, v0
 v_mul_u32_u24 v2, 112, v2
 v_lshrrev_b32 v3, 4, v0
 v_lshlrev_b32 v3, 3, v3
 v_add_u32 v2, v2, v3
 v_add_u32 v2, s40, v2
 s_cmp_eq_u32 s32, 0
 s_cbranch_scc0 L_g2_met1
 s_mov_b32 s56, 0
 s_mov_b64 s[76:77], exec
 s_mov_b64 exec, 1
L_g2_poll1:
 buffer_load_dword v225, v6, s[28:31], 0 offen sc1
 s_waitcnt vmcnt(0)
 v_readfirstlane_b32 s39, v225
 s_nop 0
 s_cmp_ge_u32 s39, 4
 s_cbranch_scc1 L_g2_met0_1
 s_add_u32 s56, s56, 1
 s_cmp_lt_u32 s56, 0x100000
 s_cbranch_scc0 L_g2_met0_1
 s_sleep 2
 s_branch L_g2_poll1
L_g2_met0_1:
 s_mov_b64 exec, s[76:77]
L_g2_met1:
 s_barrier
 buffer_load_dwordx4 v[112:115], v1, s[24:27], s84 offen offset:0 sc1
 buffer_load_dwordx4 v[116:119], v1, s[24:27], s84 offen offset:1024 sc1
 buffer_load_dwordx4 v[124:127], v1, s[24:27], s85 offen offset:0 sc1
 buffer_load_dwordx4 v[128:131], v1, s[24:27], s85 offen offset:1024 sc1
 buffer_load_dwordx4 v[136:139], v1, s[24:27], s86 offen offset:0 sc1
 buffer_load_dwordx4 v[140:143], v1, s[24:27], s86 offen offset:1024 sc1
 s_mul_i32 s39, s32, 3584
 s_waitcnt vmcnt(0)
 v_lshlrev_b32 v4, 16, v112
 v_and_b32 v5, 0xffff0000, v112
 v_add_f32 v48, v48, v4
 v_add_f32 v49, v49, v5
 v_lshlrev_b32 v4, 16, v113
 v_and_b32 v5, 0xffff0000, v113
 v_add_f32 v50, v50, v4
 v_add_f32 v51, v51, v5
 v_lshlrev_b32 v4, 16, v124
 v_and_b32 v5, 0xffff0000, v124
 v_add_f32 v48, v48, v4
 v_add_f32 v49, v49, v5
 v_lshlrev_b32 v4, 16, v125
 v_and_b32 v5, 0xffff0000, v125
 v_add_f32 v50, v50, v4
 v_add_f32 v51, v51, v5
 v_lshlrev_b32 v4, 16, v136
 v_and_b32 v5, 0xffff0000, v136
 v_add_f32 v48, v48, v4
 v_add_f32 v49, v49, v5
 v_lshlrev_b32 v4, 16, v137
 v_and_b32 v5, 0xffff0000, v137
 v_add_f32 v50, v50, v4
 v_add_f32 v51, v51, v5
 v_lshlrev_b32 v4, 16, v200
 v_and_b32 v5, 0xffff0000, v200
 v_fma_f32 v48, v212, v48, v4
 v_fma_f32 v49, v213, v49, v5
 v_lshlrev_b32 v4, 16, v201
 v_and_b32 v5, 0xffff0000, v201
 v_fma_f32 v50, v214, v50, v4
 v_fma_f32 v51, v215, v51, v5
 v_cvt_pk_bf16_f32 v48, v48, v49
 v_cvt_pk_bf16_f32 v49, v50, v51
 ds_write_b64 v2, v[48:49] offset:0
 v_lshlrev_b32 v4, 16, v114
 v_and_b32 v5, 0xffff0000, v114
 v_add_f32 v52, v52, v4
 v_add_f32 v53, v53, v5
 v_lshlrev_b32 v4, 16, v115
 v_and_b32 v5, 0xffff0000, v115
 v_add_f32 v54, v54, v4
 v_add_f32 v55, v55, v5
 v_lshlrev_b32 v4, 16, v126
 v_and_b32 v5, 0xffff0000, v126
 v_add_f32 v52, v52, v4
 v_add_f32 v53, v53, v5
 v_lshlrev_b32 v4, 16, v127
 v_and_b32 v5, 0xffff0000, v127
 v_add_f32 v54, v54, v4
 v_add_f32 v55, v55, v5
 v_lshlrev_b32 v4, 16, v138
 v_and_b32 v5, 0xffff0000, v138
 v_add_f32 v52, v52, v4
 v_add_f32 v53, v53, v5
 v_lshlrev_b32 v4, 16, v139
 v_and_b32 v5, 0xffff0000, v139
 v_add_f32 v54, v54, v4
 v_add_f32 v55, v55, v5
 v_lshlrev_b32 v4, 16, v204
 v_and_b32 v5, 0xffff0000, v204
 v_fma_f32 v52, v216, v52, v4
 v_fma_f32 v53, v217, v53, v5
 v_lshlrev_b32 v4, 16, v205
 v_and_b32 v5, 0xffff0000, v205
 v_fma_f32 v54, v218, v54, v4
 v_fma_f32 v55, v219, v55, v5
 v_cvt_pk_bf16_f32 v52, v52, v53
 v_cvt_pk_bf16_f32 v53, v54, v55
 ds_write_b64 v2, v[52:53] offset:32
 v_lshlrev_b32 v4, 16, v116
 v_and_b32 v5, 0xffff0000, v116
 v_add_f32 v84, v84, v4
 v_add_f32 v85, v85, v5
 v_lshlrev_b32 v4, 16, v117
 v_and_b32 v5, 0xffff0000, v117
 v_add_f32 v86, v86, v4
 v_add_f32 v87, v87, v5
 v_lshlrev_b32 v4, 16, v128
 v_and_b32 v5, 0xffff0000, v128
 v_add_f32 v84, v84, v4
 v_add_f32 v85, v85, v5
 v_lshlrev_b32 v4, 16, v129
 v_and_b32 v5, 0xffff0000, v129
 v_add_f32 v86, v86, v4
 v_add_f32 v87, v87, v5
 v_lshlrev_b32 v4, 16, v140
 v_and_b32 v5, 0xffff0000, v140
 v_add_f32 v84, v84, v4
 v_add_f32 v85, v85, v5
 v_lshlrev_b32 v4, 16, v141
 v_and_b32 v5, 0xffff0000, v141
 v_add_f32 v86, v86, v4
 v_add_f32 v87, v87, v5
 v_lshlrev_b32 v4, 16, v202
 v_and_b32 v5, 0xffff0000, v202
 v_fma_f32 v84, v212, v84, v4
 v_fma_f32 v85, v213, v85, v5
 v_lshlrev_b32 v4, 16, v203
 v_and_b32 v5, 0xffff0000, v203
 v_fma_f32 v86, v214, v86, v4
 v_fma_f32 v87, v215, v87, v5
 v_cvt_pk_bf16_f32 v84, v84, v85
 v_cvt_pk_bf16_f32 v85, v86, v87
 ds_write_b64 v2, v[84:85] offset:1792
 v_lshlrev_b32 v4, 16, v118
 v_and_b32 v5, 0xffff0000, v118
 v_add_f32 v88, v88, v4
 v_add_f32 v89, v89, v5
 v_lshlrev_b32 v4, 16, v119
 v_and_b32 v5, 0xffff0000, v119
 v_add_f32 v90, v90, v4
 v_add_f32 v91, v91, v5
 v_lshlrev_b32 v4, 16, v130
 v_and_b32 v5, 0xffff0000, v130
 v_add_f32 v88, v88, v4
 v_add_f32 v89, v89, v5
 v_lshlrev_b32 v4, 16, v131
 v_and_b32 v5, 0xffff0000, v131
 v_add_f32 v90, v90, v4
 v_add_f32 v91, v91, v5
 v_lshlrev_b32 v4, 16, v142
 v_and_b32 v5, 0xffff0000, v142
 v_add_f32 v88, v88, v4
 v_add_f32 v89, v89, v5
 v_lshlrev_b32 v4, 16, v143
 v_and_b32 v5, 0xffff0000, v143
 v_add_f32 v90, v90, v4
 v_add_f32 v91, v91, v5
 v_lshlrev_b32 v4, 16, v206
 v_and_b32 v5, 0xffff0000, v206
 v_fma_f32 v88, v216, v88, v4
 v_fma_f32 v89, v217, v89, v5
 v_lshlrev_b32 v4, 16, v207
 v_and_b32 v5, 0xffff0000, v207
 v_fma_f32 v90, v218, v90, v4
 v_fma_f32 v91, v219, v91, v5
 v_cvt_pk_bf16_f32 v88, v88, v89
 v_cvt_pk_bf16_f32 v89, v90, v91
 ds_write_b64 v2, v[88:89] offset:1824
 s_lshl_b32 s40, s57, 4
 s_mul_i32 s40, s40, 1152
 s_lshl_b32 s43, s58, 5
 s_add_u32 s40, s40, s43
 s_waitcnt lgkmcnt(0)
 v_add_u32 v3, 0, v0
 v_mul_u32_u24 v4, 16384, v3
 v_lshrrev_b32 v4, 16, v4
 v_mul_u32_u24 v5, 4, v4
 v_sub_u32 v3, v3, v5
 v_lshlrev_b32 v3, 4, v3
 v_mul_u32_u24 v5, 112, v4
 v_add_u32 v5, v5, v3
 v_add_u32 v5, s39, v5
 ds_read_b128 v[168:171], v5
 v_mul_u32_u24 v4, 1152, v4
 v_add_u32 v226, v4, v3
 v_add_u32 v3, 64, v0
 v_mul_u32_u24 v4, 16384, v3
 v_lshrrev_b32 v4, 16, v4
 v_mul_u32_u24 v5, 4, v4
 v_sub_u32 v3, v3, v5
 v_lshlrev_b32 v3, 4, v3
 v_mul_u32_u24 v5, 112, v4
 v_add_u32 v5, v5, v3
 v_add_u32 v5, s39, v5
 ds_read_b128 v[172:175], v5
 v_mul_u32_u24 v4, 1152, v4
 v_add_u32 v227, v4, v3
 s_waitcnt lgkmcnt(0)
 buffer_store_dwordx4 v[168:171], v226, s[52:55], s40 offen
 buffer_store_dwordx4 v[172:175], v227, s[52:55], s40 offen
 s_branch L_g2a_done
L_g2_v2:
 s_mul_i32 s39, s32, 7168
 s_add_u32 m0, s39, 0
 s_add_u32 s40, s36, 2365440
 buffer_load_dwordx4 v1, s[12:15], s40 offen offset:0 lds
 buffer_load_dwordx4 v1, s[12:15], s40 offen offset:1024 lds
 buffer_load_dwordx4 v1, s[12:15], s40 offen offset:2048 lds
 s_mul_i32 s39, s32, 7168
 s_add_u32 m0, s39, 3072
 s_add_u32 s40, s36, 2359296
 buffer_load_dwordx4 v1, s[12:15], s40 offen offset:0 lds
 buffer_load_dwordx4 v1, s[12:15], s40 offen offset:1024 lds
 buffer_load_dwordx4 v1, s[12:15], s40 offen offset:2048 lds
 buffer_load_dwordx4 v1, s[12:15], s40 offen offset:3072 lds
 s_add_u32 s87, s37, 65536
 buffer_load_dwordx4 a[0:3], v1, s[16:19], s87 offen sc1
 s_add_u32 s87, s37, 212992
 buffer_load_dwordx4 a[4:7], v1, s[16:19], s87 offen sc1
 s_add_u32 s87, s37, 66560
 buffer_load_dwordx4 a[8:11], v1, s[16:19], s87 offen sc1
 s_add_u32 s87, s37, 214016
 buffer_load_dwordx4 a[12:15], v1, s[16:19], s87 offen sc1
 s_waitcnt vmcnt(4)
 s_barrier
 s_cmp_eq_u32 s32, 0
 s_cbranch_scc0 L_g2_nolate2
 s_lshr_b32 s39, s79, 3
 s_lshl_b32 s40, s78, 2
 s_add_u32 s39, s39, s40
 s_add_u32 s39, s39, 128
 s_lshl_b32 s39, s39, 7
 v_mov_b32 v226, s39
 v_mov_b32 v225, 1
 s_mov_b64 s[76:77], exec
 s_mov_b64 exec, 1
 buffer_atomic_add v225, v226, s[28:31], 0 offen sc1
 s_mov_b64 exec, s[76:77]
L_g2_nolate2:
 s_lshr_b32 s39, s33, 1
 s_lshl_b32 s39, s39, 2
 s_add_u32 s39, s39, 130
 s_lshl_b32 s39, s39, 7
 v_mov_b32 v229, s39
 ds_read_b128 v[112:115], v2 offset:0
 ds_read_b128 v[116:119], v2 offset:1024
 ds_read_b128 v[120:123], v2 offset:2048
 ds_read_b128 v[124:127], v2 offset:3072
 ds_read_b128 v[128:131], v2 offset:4096
 ds_read_b128 v[132:135], v2 offset:5120
 ds_read_b128 v[136:139], v2 offset:6144
 s_waitcnt lgkmcnt(0)
 s_waitcnt vmcnt(2)
 v_mfma_f32_16x16x32_bf16 v[64:67], v[112:115], a[0:3], 0
 ds_read_b128 v[140:143], v2 offset:7168
 ds_read_b128 v[144:147], v2 offset:8192
 v_mfma_f32_16x16x32_bf16 v[100:103], v[112:115], a[4:7], 0
 ds_read_b128 v[148:151], v2 offset:9216
 v_mfma_f32_16x16x32_bf16 v[68:71], v[116:119], a[0:3], 0
 ds_read_b128 v[152:155], v2 offset:10240
 v_mfma_f32_16x16x32_bf16 v[104:107], v[116:119], a[4:7], 0
 ds_read_b128 v[156:159], v2 offset:11264
 ds_read_b128 v[160:163], v2 offset:12288
 v_mfma_f32_16x16x32_bf16 v[72:75], v[120:123], a[0:3], 0
 ds_read_b128 v[164:167], v2 offset:13312
 v_mfma_f32_16x16x32_bf16 v[108:111], v[120:123], a[4:7], 0
 s_mul_i32 s39, s32, 7168
 s_add_u32 m0, s39, 36864
 s_add_u32 s40, s36, 2660352
 buffer_load_dwordx4 v1, s[12:15], s40 offen offset:0 lds
 v_mfma_f32_16x16x32_bf16 v[40:43], v[124:127], a[0:3], 0
 buffer_load_dwordx4 v1, s[12:15], s40 offen offset:1024 lds
 v_mfma_f32_16x16x32_bf16 v[76:79], v[124:127], a[4:7], 0
 buffer_load_dwordx4 v1, s[12:15], s40 offen offset:2048 lds
 s_mul_i32 s39, s32, 7168
 s_add_u32 m0, s39, 39936
 s_add_u32 s40, s36, 2654208
 buffer_load_dwordx4 v1, s[12:15], s40 offen offset:0 lds
 v_mfma_f32_16x16x32_bf16 v[44:47], v[128:131], a[0:3], 0
 buffer_load_dwordx4 v1, s[12:15], s40 offen offset:1024 lds
 v_mfma_f32_16x16x32_bf16 v[80:83], v[128:131], a[4:7], 0
 buffer_load_dwordx4 v1, s[12:15], s40 offen offset:2048 lds
 v_mfma_f32_16x16x32_bf16 v[48:51], v[132:135], a[0:3], 0
 buffer_load_dwordx4 v1, s[12:15], s40 offen offset:3072 lds
 s_add_u32 s87, s37, 69632
 buffer_load_dwordx4 a[16:19], v1, s[16:19], s87 offen sc1
 v_mfma_f32_16x16x32_bf16 v[84:87], v[132:135], a[4:7], 0
 s_add_u32 s87, s37, 217088
 buffer_load_dwordx4 a[20:23], v1, s[16:19], s87 offen sc1
 v_mfma_f32_16x16x32_bf16 v[52:55], v[136:139], a[0:3], 0
 s_add_u32 s87, s37, 70656
 buffer_load_dwordx4 a[24:27], v1, s[16:19], s87 offen sc1
 v_mfma_f32_16x16x32_bf16 v[88:91], v[136:139], a[4:7], 0
 s_add_u32 s87, s37, 218112
 buffer_load_dwordx4 a[28:31], v1, s[16:19], s87 offen sc1
 s_waitcnt lgkmcnt(0)
 s_waitcnt vmcnt(11)
 v_mfma_f32_16x16x32_bf16 v[64:67], v[140:143], a[8:11], v[64:67]
 ds_read_b128 v[112:115], v2 offset:14336
 ds_read_b128 v[116:119], v2 offset:15360
 v_mfma_f32_16x16x32_bf16 v[100:103], v[140:143], a[12:15], v[100:103]
 ds_read_b128 v[120:123], v2 offset:16384
 v_mfma_f32_16x16x32_bf16 v[68:71], v[144:147], a[8:11], v[68:71]
 ds_read_b128 v[124:127], v2 offset:17408
 v_mfma_f32_16x16x32_bf16 v[104:107], v[144:147], a[12:15], v[104:107]
 ds_read_b128 v[128:131], v2 offset:18432
 ds_read_b128 v[132:135], v2 offset:19456
 v_mfma_f32_16x16x32_bf16 v[72:75], v[148:151], a[8:11], v[72:75]
 ds_read_b128 v[136:139], v2 offset:20480
 v_mfma_f32_16x16x32_bf16 v[108:111], v[148:151], a[12:15], v[108:111]
 s_add_u32 s87, s37, 73728
 buffer_load_dwordx4 a[32:35], v1, s[16:19], s87 offen sc1
 v_mfma_f32_16x16x32_bf16 v[40:43], v[152:155], a[8:11], v[40:43]
 s_add_u32 s87, s37, 221184
 buffer_load_dwordx4 a[36:39], v1, s[16:19], s87 offen sc1
 v_mfma_f32_16x16x32_bf16 v[76:79], v[152:155], a[12:15], v[76:79]
 s_mul_i32 s39, s32, 7168
 s_add_u32 m0, s39, 73728
 s_add_u32 s40, s36, 2955264
 buffer_load_dwordx4 v1, s[12:15], s40 offen offset:0 lds
 buffer_load_dwordx4 v1, s[12:15], s40 offen offset:1024 lds
 v_mfma_f32_16x16x32_bf16 v[44:47], v[156:159], a[8:11], v[44:47]
 buffer_load_dwordx4 v1, s[12:15], s40 offen offset:2048 lds
 v_mfma_f32_16x16x32_bf16 v[80:83], v[156:159], a[12:15], v[80:83]
 s_mul_i32 s39, s32, 7168
 s_add_u32 m0, s39, 76800
 s_add_u32 s40, s36, 2949120
 buffer_load_dwordx4 v1, s[12:15], s40 offen offset:0 lds
 v_mfma_f32_16x16x32_bf16 v[48:51], v[160:163], a[8:11], v[48:51]
 buffer_load_dwordx4 v1, s[12:15], s40 offen offset:1024 lds
 buffer_load_dwordx4 v1, s[12:15], s40 offen offset:2048 lds
 v_mfma_f32_16x16x32_bf16 v[84:87], v[160:163], a[12:15], v[84:87]
 buffer_load_dwordx4 v1, s[12:15], s40 offen offset:3072 lds
 v_mfma_f32_16x16x32_bf16 v[52:55], v[164:167], a[8:11], v[52:55]
 s_mul_i32 s39, s32, 7168
 s_add_u32 m0, s39, 110592
 s_add_u32 s40, s36, 3250176
 buffer_load_dwordx4 v1, s[12:15], s40 offen offset:0 lds
 v_mfma_f32_16x16x32_bf16 v[88:91], v[164:167], a[12:15], v[88:91]
 buffer_load_dwordx4 v1, s[12:15], s40 offen offset:1024 lds
 s_waitcnt lgkmcnt(0)
 s_waitcnt vmcnt(13)
 v_mfma_f32_16x16x32_bf16 v[64:67], v[112:115], a[16:19], v[64:67]
 ds_read_b128 v[140:143], v2 offset:21504
 ds_read_b128 v[144:147], v2 offset:22528
 v_mfma_f32_16x16x32_bf16 v[100:103], v[112:115], a[20:23], v[100:103]
 ds_read_b128 v[148:151], v2 offset:23552
 v_mfma_f32_16x16x32_bf16 v[68:71], v[116:119], a[16:19], v[68:71]
 ds_read_b128 v[152:155], v2 offset:24576
 v_mfma_f32_16x16x32_bf16 v[104:107], v[116:119], a[20:23], v[104:107]
 ds_read_b128 v[156:159], v2 offset:25600
 ds_read_b128 v[160:163], v2 offset:26624
 v_mfma_f32_16x16x32_bf16 v[72:75], v[120:123], a[16:19], v[72:75]
 ds_read_b128 v[164:167], v2 offset:27648
 v_mfma_f32_16x16x32_bf16 v[108:111], v[120:123], a[20:23], v[108:111]
 buffer_load_dwordx4 v1, s[12:15], s40 offen offset:2048 lds
 v_mfma_f32_16x16x32_bf16 v[40:43], v[124:127], a[16:19], v[40:43]
 s_mul_i32 s39, s32, 7168
 s_add_u32 m0, s39, 113664
 s_add_u32 s40, s36, 3244032
 buffer_load_dwordx4 v1, s[12:15], s40 offen offset:0 lds
 v_mfma_f32_16x16x32_bf16 v[76:79], v[124:127], a[20:23], v[76:79]
 buffer_load_dwordx4 v1, s[12:15], s40 offen offset:1024 lds
 buffer_load_dwordx4 v1, s[12:15], s40 offen offset:2048 lds
 v_mfma_f32_16x16x32_bf16 v[44:47], v[128:131], a[16:19], v[44:47]
 buffer_load_dwordx4 v1, s[12:15], s40 offen offset:3072 lds
 v_mfma_f32_16x16x32_bf16 v[80:83], v[128:131], a[20:23], v[80:83]
 s_add_u32 s87, s37, 74752
 buffer_load_dwordx4 a[40:43], v1, s[16:19], s87 offen sc1
 v_mfma_f32_16x16x32_bf16 v[48:51], v[132:135], a[16:19], v[48:51]
 s_add_u32 s87, s37, 222208
 buffer_load_dwordx4 a[44:47], v1, s[16:19], s87 offen sc1
 s_add_u32 s87, s37, 77824
 buffer_load_dwordx4 a[48:51], v1, s[16:19], s87 offen sc1
 v_mfma_f32_16x16x32_bf16 v[84:87], v[132:135], a[20:23], v[84:87]
 s_add_u32 s87, s37, 225280
 buffer_load_dwordx4 a[52:55], v1, s[16:19], s87 offen sc1
 v_mfma_f32_16x16x32_bf16 v[52:55], v[136:139], a[16:19], v[52:55]
 s_add_u32 s87, s37, 78848
 buffer_load_dwordx4 a[56:59], v1, s[16:19], s87 offen sc1
 v_mfma_f32_16x16x32_bf16 v[88:91], v[136:139], a[20:23], v[88:91]
 s_add_u32 s87, s37, 226304
 buffer_load_dwordx4 a[60:63], v1, s[16:19], s87 offen sc1
 s_waitcnt lgkmcnt(0)
 s_waitcnt vmcnt(26)
 s_barrier
 s_waitcnt vmcnt(22)
 v_mfma_f32_16x16x32_bf16 v[64:67], v[140:143], a[24:27], v[64:67]
 ds_read_b128 v[112:115], v3 offset:0
 ds_read_b128 v[116:119], v3 offset:1024
 v_mfma_f32_16x16x32_bf16 v[100:103], v[140:143], a[28:31], v[100:103]
 ds_read_b128 v[120:123], v3 offset:2048
 v_mfma_f32_16x16x32_bf16 v[68:71], v[144:147], a[24:27], v[68:71]
 ds_read_b128 v[124:127], v3 offset:3072
 v_mfma_f32_16x16x32_bf16 v[104:107], v[144:147], a[28:31], v[104:107]
 ds_read_b128 v[128:131], v3 offset:4096
 v_mfma_f32_16x16x32_bf16 v[72:75], v[148:151], a[24:27], v[72:75]
 ds_read_b128 v[132:135], v3 offset:5120
 v_mfma_f32_16x16x32_bf16 v[108:111], v[148:151], a[28:31], v[108:111]
 ds_read_b128 v[136:139], v3 offset:6144
 v_mfma_f32_16x16x32_bf16 v[40:43], v[152:155], a[24:27], v[40:43]
 s_mul_i32 s39, s32, 7168
 s_add_u32 m0, s39, 0
 s_add_u32 s40, s36, 2439168
 buffer_load_dwordx4 v1, s[12:15], s40 offen offset:0 lds
 v_mfma_f32_16x16x32_bf16 v[76:79], v[152:155], a[28:31], v[76:79]
 buffer_load_dwordx4 v1, s[12:15], s40 offen offset:1024 lds
 buffer_load_dwordx4 v1, s[12:15], s40 offen offset:2048 lds
 v_mfma_f32_16x16x32_bf16 v[44:47], v[156:159], a[24:27], v[44:47]
 s_mul_i32 s39, s32, 7168
 s_add_u32 m0, s39, 3072
 s_add_u32 s40, s36, 2433024
 buffer_load_dwordx4 v1, s[12:15], s40 offen offset:0 lds
 v_mfma_f32_16x16x32_bf16 v[80:83], v[156:159], a[28:31], v[80:83]
 buffer_load_dwordx4 v1, s[12:15], s40 offen offset:1024 lds
 v_mfma_f32_16x16x32_bf16 v[48:51], v[160:163], a[24:27], v[48:51]
 buffer_load_dwordx4 v1, s[12:15], s40 offen offset:2048 lds
 v_mfma_f32_16x16x32_bf16 v[84:87], v[160:163], a[28:31], v[84:87]
 buffer_load_dwordx4 v1, s[12:15], s40 offen offset:3072 lds
 v_mfma_f32_16x16x32_bf16 v[52:55], v[164:167], a[24:27], v[52:55]
 s_add_u32 s87, s37, 81920
 buffer_load_dwordx4 a[64:67], v1, s[16:19], s87 offen sc1
 v_mfma_f32_16x16x32_bf16 v[88:91], v[164:167], a[28:31], v[88:91]
 s_add_u32 s87, s37, 229376
 buffer_load_dwordx4 a[68:71], v1, s[16:19], s87 offen sc1
 s_waitcnt lgkmcnt(0)
 s_waitcnt vmcnt(29)
 v_mfma_f32_16x16x32_bf16 v[64:67], v[112:115], a[32:35], v[64:67]
 ds_read_b128 v[140:143], v3 offset:7168
 v_mfma_f32_16x16x32_bf16 v[100:103], v[112:115], a[36:39], v[100:103]
 ds_read_b128 v[144:147], v3 offset:8192
 v_mfma_f32_16x16x32_bf16 v[68:71], v[116:119], a[32:35], v[68:71]
 v_mfma_f32_16x16x32_bf16 v[104:107], v[116:119], a[36:39], v[104:107]
 ds_read_b128 v[148:151], v3 offset:9216
 v_mfma_f32_16x16x32_bf16 v[72:75], v[120:123], a[32:35], v[72:75]
 ds_read_b128 v[152:155], v3 offset:10240
 v_mfma_f32_16x16x32_bf16 v[108:111], v[120:123], a[36:39], v[108:111]
 v_mfma_f32_16x16x32_bf16 v[40:43], v[124:127], a[32:35], v[40:43]
 ds_read_b128 v[156:159], v3 offset:11264
 v_mfma_f32_16x16x32_bf16 v[76:79], v[124:127], a[36:39], v[76:79]
 ds_read_b128 v[160:163], v3 offset:12288
 v_mfma_f32_16x16x32_bf16 v[44:47], v[128:131], a[32:35], v[44:47]
 v_mfma_f32_16x16x32_bf16 v[80:83], v[128:131], a[36:39], v[80:83]
 ds_read_b128 v[164:167], v3 offset:13312
 v_mfma_f32_16x16x32_bf16 v[48:51], v[132:135], a[32:35], v[48:51]
 s_add_u32 s87, s37, 82944
 buffer_load_dwordx4 a[72:75], v1, s[16:19], s87 offen sc1
 v_mfma_f32_16x16x32_bf16 v[84:87], v[132:135], a[36:39], v[84:87]
 v_mfma_f32_16x16x32_bf16 v[52:55], v[136:139], a[32:35], v[52:55]
 s_add_u32 s87, s37, 230400
 buffer_load_dwordx4 a[76:79], v1, s[16:19], s87 offen sc1
 v_mfma_f32_16x16x32_bf16 v[88:91], v[136:139], a[36:39], v[88:91]
 s_waitcnt lgkmcnt(0)
 s_waitcnt vmcnt(15)
 v_mfma_f32_16x16x32_bf16 v[64:67], v[140:143], a[40:43], v[64:67]
 ds_read_b128 v[112:115], v3 offset:14336
 v_mfma_f32_16x16x32_bf16 v[100:103], v[140:143], a[44:47], v[100:103]
 ds_read_b128 v[116:119], v3 offset:15360
 v_mfma_f32_16x16x32_bf16 v[68:71], v[144:147], a[40:43], v[68:71]
 v_mfma_f32_16x16x32_bf16 v[104:107], v[144:147], a[44:47], v[104:107]
 ds_read_b128 v[120:123], v3 offset:16384
 v_mfma_f32_16x16x32_bf16 v[72:75], v[148:151], a[40:43], v[72:75]
 ds_read_b128 v[124:127], v3 offset:17408
 v_mfma_f32_16x16x32_bf16 v[108:111], v[148:151], a[44:47], v[108:111]
 v_mfma_f32_16x16x32_bf16 v[40:43], v[152:155], a[40:43], v[40:43]
 ds_read_b128 v[128:131], v3 offset:18432
 v_mfma_f32_16x16x32_bf16 v[76:79], v[152:155], a[44:47], v[76:79]
 ds_read_b128 v[132:135], v3 offset:19456
 v_mfma_f32_16x16x32_bf16 v[44:47], v[156:159], a[40:43], v[44:47]
 v_mfma_f32_16x16x32_bf16 v[80:83], v[156:159], a[44:47], v[80:83]
 ds_read_b128 v[136:139], v3 offset:20480
 v_mfma_f32_16x16x32_bf16 v[48:51], v[160:163], a[40:43], v[48:51]
 s_add_u32 s87, s37, 86016
 buffer_load_dwordx4 a[80:83], v1, s[16:19], s87 offen sc1
 v_mfma_f32_16x16x32_bf16 v[84:87], v[160:163], a[44:47], v[84:87]
 v_mfma_f32_16x16x32_bf16 v[52:55], v[164:167], a[40:43], v[52:55]
 s_add_u32 s87, s37, 233472
 buffer_load_dwordx4 a[84:87], v1, s[16:19], s87 offen sc1
 v_mfma_f32_16x16x32_bf16 v[88:91], v[164:167], a[44:47], v[88:91]
 s_waitcnt lgkmcnt(0)
 s_waitcnt vmcnt(15)
 v_mfma_f32_16x16x32_bf16 v[64:67], v[112:115], a[48:51], v[64:67]
 ds_read_b128 v[140:143], v3 offset:21504
 v_mfma_f32_16x16x32_bf16 v[100:103], v[112:115], a[52:55], v[100:103]
 ds_read_b128 v[144:147], v3 offset:22528
 v_mfma_f32_16x16x32_bf16 v[68:71], v[116:119], a[48:51], v[68:71]
 v_mfma_f32_16x16x32_bf16 v[104:107], v[116:119], a[52:55], v[104:107]
 ds_read_b128 v[148:151], v3 offset:23552
 v_mfma_f32_16x16x32_bf16 v[72:75], v[120:123], a[48:51], v[72:75]
 ds_read_b128 v[152:155], v3 offset:24576
 v_mfma_f32_16x16x32_bf16 v[108:111], v[120:123], a[52:55], v[108:111]
 v_mfma_f32_16x16x32_bf16 v[40:43], v[124:127], a[48:51], v[40:43]
 ds_read_b128 v[156:159], v3 offset:25600
 v_mfma_f32_16x16x32_bf16 v[76:79], v[124:127], a[52:55], v[76:79]
 ds_read_b128 v[160:163], v3 offset:26624
 v_mfma_f32_16x16x32_bf16 v[44:47], v[128:131], a[48:51], v[44:47]
 v_mfma_f32_16x16x32_bf16 v[80:83], v[128:131], a[52:55], v[80:83]
 ds_read_b128 v[164:167], v3 offset:27648
 v_mfma_f32_16x16x32_bf16 v[48:51], v[132:135], a[48:51], v[48:51]
 s_add_u32 s87, s37, 87040
 buffer_load_dwordx4 a[88:91], v1, s[16:19], s87 offen sc1
 v_mfma_f32_16x16x32_bf16 v[84:87], v[132:135], a[52:55], v[84:87]
 v_mfma_f32_16x16x32_bf16 v[52:55], v[136:139], a[48:51], v[52:55]
 s_add_u32 s87, s37, 234496
 buffer_load_dwordx4 a[92:95], v1, s[16:19], s87 offen sc1
 v_mfma_f32_16x16x32_bf16 v[88:91], v[136:139], a[52:55], v[88:91]
 s_waitcnt lgkmcnt(0)
 s_waitcnt vmcnt(28)
 s_barrier
 s_waitcnt vmcnt(15)
 s_mov_b64 s[76:77], exec
 s_mov_b64 exec, 1
 buffer_load_dword v230, v229, s[28:31], 0 offen sc1
 s_mov_b64 exec, s[76:77]
 s_nop 3
 v_mfma_f32_16x16x32_bf16 v[64:67], v[140:143], a[56:59], v[64:67]
 ds_read_b128 v[112:115], v4 offset:0
 ds_read_b128 v[116:119], v4 offset:1024
 v_mfma_f32_16x16x32_bf16 v[100:103], v[140:143], a[60:63], v[100:103]
 ds_read_b128 v[120:123], v4 offset:2048
 v_mfma_f32_16x16x32_bf16 v[68:71], v[144:147], a[56:59], v[68:71]
 ds_read_b128 v[124:127], v4 offset:3072
 v_mfma_f32_16x16x32_bf16 v[104:107], v[144:147], a[60:63], v[104:107]
 ds_read_b128 v[128:131], v4 offset:4096
 v_mfma_f32_16x16x32_bf16 v[72:75], v[148:151], a[56:59], v[72:75]
 ds_read_b128 v[132:135], v4 offset:5120
 v_mfma_f32_16x16x32_bf16 v[108:111], v[148:151], a[60:63], v[108:111]
 ds_read_b128 v[136:139], v4 offset:6144
 v_mfma_f32_16x16x32_bf16 v[40:43], v[152:155], a[56:59], v[40:43]
 s_mul_i32 s39, s32, 7168
 s_add_u32 m0, s39, 36864
 s_add_u32 s40, s36, 2734080
 buffer_load_dwordx4 v1, s[12:15], s40 offen offset:0 lds
 v_mfma_f32_16x16x32_bf16 v[76:79], v[152:155], a[60:63], v[76:79]
 buffer_load_dwordx4 v1, s[12:15], s40 offen offset:1024 lds
 buffer_load_dwordx4 v1, s[12:15], s40 offen offset:2048 lds
 v_mfma_f32_16x16x32_bf16 v[44:47], v[156:159], a[56:59], v[44:47]
 s_mul_i32 s39, s32, 7168
 s_add_u32 m0, s39, 39936
 s_add_u32 s40, s36, 2727936
 buffer_load_dwordx4 v1, s[12:15], s40 offen offset:0 lds
 v_mfma_f32_16x16x32_bf16 v[80:83], v[156:159], a[60:63], v[80:83]
 buffer_load_dwordx4 v1, s[12:15], s40 offen offset:1024 lds
 v_mfma_f32_16x16x32_bf16 v[48:51], v[160:163], a[56:59], v[48:51]
 buffer_load_dwordx4 v1, s[12:15], s40 offen offset:2048 lds
 v_mfma_f32_16x16x32_bf16 v[84:87], v[160:163], a[60:63], v[84:87]
 buffer_load_dwordx4 v1, s[12:15], s40 offen offset:3072 lds
 v_mfma_f32_16x16x32_bf16 v[52:55], v[164:167], a[56:59], v[52:55]
 s_add_u32 s87, s37, 90112
 buffer_load_dwordx4 a[96:99], v1, s[16:19], s87 offen sc1
 v_mfma_f32_16x16x32_bf16 v[88:91], v[164:167], a[60:63], v[88:91]
 s_add_u32 s87, s37, 237568
 buffer_load_dwordx4 a[100:103], v1, s[16:19], s87 offen sc1
 s_waitcnt lgkmcnt(0)
 s_waitcnt vmcnt(16)
 v_mfma_f32_16x16x32_bf16 v[64:67], v[112:115], a[64:67], v[64:67]
 ds_read_b128 v[140:143], v4 offset:7168
 v_mfma_f32_16x16x32_bf16 v[100:103], v[112:115], a[68:71], v[100:103]
 ds_read_b128 v[144:147], v4 offset:8192
 v_mfma_f32_16x16x32_bf16 v[68:71], v[116:119], a[64:67], v[68:71]
 v_mfma_f32_16x16x32_bf16 v[104:107], v[116:119], a[68:71], v[104:107]
 ds_read_b128 v[148:151], v4 offset:9216
 v_mfma_f32_16x16x32_bf16 v[72:75], v[120:123], a[64:67], v[72:75]
 ds_read_b128 v[152:155], v4 offset:10240
 v_mfma_f32_16x16x32_bf16 v[108:111], v[120:123], a[68:71], v[108:111]
 v_mfma_f32_16x16x32_bf16 v[40:43], v[124:127], a[64:67], v[40:43]
 ds_read_b128 v[156:159], v4 offset:11264
 v_mfma_f32_16x16x32_bf16 v[76:79], v[124:127], a[68:71], v[76:79]
 ds_read_b128 v[160:163], v4 offset:12288
 v_mfma_f32_16x16x32_bf16 v[44:47], v[128:131], a[64:67], v[44:47]
 v_mfma_f32_16x16x32_bf16 v[80:83], v[128:131], a[68:71], v[80:83]
 ds_read_b128 v[164:167], v4 offset:13312
 v_mfma_f32_16x16x32_bf16 v[48:51], v[132:135], a[64:67], v[48:51]
 s_add_u32 s87, s37, 91136
 buffer_load_dwordx4 a[104:107], v1, s[16:19], s87 offen sc1
 v_mfma_f32_16x16x32_bf16 v[84:87], v[132:135], a[68:71], v[84:87]
 v_mfma_f32_16x16x32_bf16 v[52:55], v[136:139], a[64:67], v[52:55]
 s_add_u32 s87, s37, 238592
 buffer_load_dwordx4 a[108:111], v1, s[16:19], s87 offen sc1
 v_mfma_f32_16x16x32_bf16 v[88:91], v[136:139], a[68:71], v[88:91]
 s_waitcnt lgkmcnt(0)
 s_waitcnt vmcnt(16)
 v_mfma_f32_16x16x32_bf16 v[64:67], v[140:143], a[72:75], v[64:67]
 ds_read_b128 v[112:115], v4 offset:14336
 v_mfma_f32_16x16x32_bf16 v[100:103], v[140:143], a[76:79], v[100:103]
 ds_read_b128 v[116:119], v4 offset:15360
 v_mfma_f32_16x16x32_bf16 v[68:71], v[144:147], a[72:75], v[68:71]
 v_mfma_f32_16x16x32_bf16 v[104:107], v[144:147], a[76:79], v[104:107]
 ds_read_b128 v[120:123], v4 offset:16384
 v_mfma_f32_16x16x32_bf16 v[72:75], v[148:151], a[72:75], v[72:75]
 ds_read_b128 v[124:127], v4 offset:17408
 v_mfma_f32_16x16x32_bf16 v[108:111], v[148:151], a[76:79], v[108:111]
 v_mfma_f32_16x16x32_bf16 v[40:43], v[152:155], a[72:75], v[40:43]
 ds_read_b128 v[128:131], v4 offset:18432
 v_mfma_f32_16x16x32_bf16 v[76:79], v[152:155], a[76:79], v[76:79]
 ds_read_b128 v[132:135], v4 offset:19456
 v_mfma_f32_16x16x32_bf16 v[44:47], v[156:159], a[72:75], v[44:47]
 v_mfma_f32_16x16x32_bf16 v[80:83], v[156:159], a[76:79], v[80:83]
 ds_read_b128 v[136:139], v4 offset:20480
 v_mfma_f32_16x16x32_bf16 v[48:51], v[160:163], a[72:75], v[48:51]
 s_add_u32 s87, s37, 94208
 buffer_load_dwordx4 a[112:115], v1, s[16:19], s87 offen sc1
 v_mfma_f32_16x16x32_bf16 v[84:87], v[160:163], a[76:79], v[84:87]
 v_mfma_f32_16x16x32_bf16 v[52:55], v[164:167], a[72:75], v[52:55]
 s_add_u32 s87, s37, 241664
 buffer_load_dwordx4 a[116:119], v1, s[16:19], s87 offen sc1
 v_mfma_f32_16x16x32_bf16 v[88:91], v[164:167], a[76:79], v[88:91]
 s_waitcnt lgkmcnt(0)
 s_waitcnt vmcnt(16)
 v_mfma_f32_16x16x32_bf16 v[64:67], v[112:115], a[80:83], v[64:67]
 ds_read_b128 v[140:143], v4 offset:21504
 v_mfma_f32_16x16x32_bf16 v[100:103], v[112:115], a[84:87], v[100:103]
 ds_read_b128 v[144:147], v4 offset:22528
 v_mfma_f32_16x16x32_bf16 v[68:71], v[116:119], a[80:83], v[68:71]
 v_mfma_f32_16x16x32_bf16 v[104:107], v[116:119], a[84:87], v[104:107]
 ds_read_b128 v[148:151], v4 offset:23552
 v_mfma_f32_16x16x32_bf16 v[72:75], v[120:123], a[80:83], v[72:75]
 ds_read_b128 v[152:155], v4 offset:24576
 v_mfma_f32_16x16x32_bf16 v[108:111], v[120:123], a[84:87], v[108:111]
 v_mfma_f32_16x16x32_bf16 v[40:43], v[124:127], a[80:83], v[40:43]
 ds_read_b128 v[156:159], v4 offset:25600
 v_mfma_f32_16x16x32_bf16 v[76:79], v[124:127], a[84:87], v[76:79]
 ds_read_b128 v[160:163], v4 offset:26624
 v_mfma_f32_16x16x32_bf16 v[44:47], v[128:131], a[80:83], v[44:47]
 v_mfma_f32_16x16x32_bf16 v[80:83], v[128:131], a[84:87], v[80:83]
 ds_read_b128 v[164:167], v4 offset:27648
 v_mfma_f32_16x16x32_bf16 v[48:51], v[132:135], a[80:83], v[48:51]
 s_add_u32 s87, s37, 95232
 buffer_load_dwordx4 a[120:123], v1, s[16:19], s87 offen sc1
 v_mfma_f32_16x16x32_bf16 v[84:87], v[132:135], a[84:87], v[84:87]
 v_mfma_f32_16x16x32_bf16 v[52:55], v[136:139], a[80:83], v[52:55]
 s_add_u32 s87, s37, 242688
 buffer_load_dwordx4 a[124:127], v1, s[16:19], s87 offen sc1
 v_mfma_f32_16x16x32_bf16 v[88:91], v[136:139], a[84:87], v[88:91]
 s_waitcnt lgkmcnt(0)
 s_waitcnt vmcnt(37)
 s_barrier
 s_waitcnt vmcnt(16)
 s_waitcnt vmcnt(15)
 v_readfirstlane_b32 s39, v230
 s_nop 0
 s_cmp_ge_u32 s39, 8
 s_cbranch_scc1 L_g2_lateok2
 s_mov_b32 s56, 0
 s_mov_b64 s[76:77], exec
 s_mov_b64 exec, 1
L_g2_lspin2:
 buffer_load_dword v230, v229, s[28:31], 0 offen sc1
 s_waitcnt vmcnt(0)
 v_readfirstlane_b32 s39, v230
 s_nop 0
 s_cmp_ge_u32 s39, 8
 s_cbranch_scc1 L_g2_ldone2
 s_add_u32 s56, s56, 1
 s_cmp_lt_u32 s56, 0x100000
 s_cbranch_scc0 L_g2_ldone2
 s_sleep 2
 s_branch L_g2_lspin2
L_g2_ldone2:
 s_mov_b64 exec, s[76:77]
L_g2_lateok2:
 s_nop 0
 s_nop 2
 v_mfma_f32_16x16x32_bf16 v[64:67], v[140:143], a[88:91], v[64:67]
 ds_read_b128 v[112:115], v5 offset:0
 ds_read_b128 v[116:119], v5 offset:1024
 v_mfma_f32_16x16x32_bf16 v[100:103], v[140:143], a[92:95], v[100:103]
 ds_read_b128 v[120:123], v5 offset:2048
 v_mfma_f32_16x16x32_bf16 v[68:71], v[144:147], a[88:91], v[68:71]
 ds_read_b128 v[124:127], v5 offset:3072
 v_mfma_f32_16x16x32_bf16 v[104:107], v[144:147], a[92:95], v[104:107]
 ds_read_b128 v[128:131], v5 offset:4096
 v_mfma_f32_16x16x32_bf16 v[72:75], v[148:151], a[88:91], v[72:75]
 ds_read_b128 v[132:135], v5 offset:5120
 v_mfma_f32_16x16x32_bf16 v[108:111], v[148:151], a[92:95], v[108:111]
 ds_read_b128 v[136:139], v5 offset:6144
 v_mfma_f32_16x16x32_bf16 v[40:43], v[152:155], a[88:91], v[40:43]
 s_mul_i32 s39, s32, 7168
 s_add_u32 m0, s39, 73728
 s_add_u32 s40, s36, 3028992
 buffer_load_dwordx4 v1, s[12:15], s40 offen offset:0 lds
 v_mfma_f32_16x16x32_bf16 v[76:79], v[152:155], a[92:95], v[76:79]
 buffer_load_dwordx4 v1, s[12:15], s40 offen offset:1024 lds
 buffer_load_dwordx4 v1, s[12:15], s40 offen offset:2048 lds
 v_mfma_f32_16x16x32_bf16 v[44:47], v[156:159], a[88:91], v[44:47]
 s_mul_i32 s39, s32, 7168
 s_add_u32 m0, s39, 76800
 s_add_u32 s40, s36, 3022848
 buffer_load_dwordx4 v1, s[12:15], s40 offen offset:0 lds
 v_mfma_f32_16x16x32_bf16 v[80:83], v[156:159], a[92:95], v[80:83]
 buffer_load_dwordx4 v1, s[12:15], s40 offen offset:1024 lds
 v_mfma_f32_16x16x32_bf16 v[48:51], v[160:163], a[88:91], v[48:51]
 buffer_load_dwordx4 v1, s[12:15], s40 offen offset:2048 lds
 v_mfma_f32_16x16x32_bf16 v[84:87], v[160:163], a[92:95], v[84:87]
 buffer_load_dwordx4 v1, s[12:15], s40 offen offset:3072 lds
 v_mfma_f32_16x16x32_bf16 v[52:55], v[164:167], a[88:91], v[52:55]
 s_add_u32 s87, s37, 67584
 buffer_load_dwordx4 a[128:131], v1, s[16:19], s87 offen sc1
 v_mfma_f32_16x16x32_bf16 v[88:91], v[164:167], a[92:95], v[88:91]
 s_add_u32 s87, s37, 215040
 buffer_load_dwordx4 a[132:135], v1, s[16:19], s87 offen sc1
 s_waitcnt lgkmcnt(0)
 s_waitcnt vmcnt(15)
 v_mfma_f32_16x16x32_bf16 v[64:67], v[112:115], a[96:99], v[64:67]
 ds_read_b128 v[140:143], v5 offset:7168
 v_mfma_f32_16x16x32_bf16 v[100:103], v[112:115], a[100:103], v[100:103]
 ds_read_b128 v[144:147], v5 offset:8192
 v_mfma_f32_16x16x32_bf16 v[68:71], v[116:119], a[96:99], v[68:71]
 v_mfma_f32_16x16x32_bf16 v[104:107], v[116:119], a[100:103], v[104:107]
 ds_read_b128 v[148:151], v5 offset:9216
 v_mfma_f32_16x16x32_bf16 v[72:75], v[120:123], a[96:99], v[72:75]
 ds_read_b128 v[152:155], v5 offset:10240
 v_mfma_f32_16x16x32_bf16 v[108:111], v[120:123], a[100:103], v[108:111]
 v_mfma_f32_16x16x32_bf16 v[40:43], v[124:127], a[96:99], v[40:43]
 ds_read_b128 v[156:159], v5 offset:11264
 v_mfma_f32_16x16x32_bf16 v[76:79], v[124:127], a[100:103], v[76:79]
 ds_read_b128 v[160:163], v5 offset:12288
 v_mfma_f32_16x16x32_bf16 v[44:47], v[128:131], a[96:99], v[44:47]
 v_mfma_f32_16x16x32_bf16 v[80:83], v[128:131], a[100:103], v[80:83]
 ds_read_b128 v[164:167], v5 offset:13312
 v_mfma_f32_16x16x32_bf16 v[48:51], v[132:135], a[96:99], v[48:51]
 s_add_u32 s87, s37, 68608
 buffer_load_dwordx4 a[136:139], v1, s[16:19], s87 offen sc1
 v_mfma_f32_16x16x32_bf16 v[84:87], v[132:135], a[100:103], v[84:87]
 v_mfma_f32_16x16x32_bf16 v[52:55], v[136:139], a[96:99], v[52:55]
 s_add_u32 s87, s37, 216064
 buffer_load_dwordx4 a[140:143], v1, s[16:19], s87 offen sc1
 v_mfma_f32_16x16x32_bf16 v[88:91], v[136:139], a[100:103], v[88:91]
 s_waitcnt lgkmcnt(0)
 s_waitcnt vmcnt(15)
 v_mfma_f32_16x16x32_bf16 v[64:67], v[140:143], a[104:107], v[64:67]
 ds_read_b128 v[112:115], v5 offset:14336
 v_mfma_f32_16x16x32_bf16 v[100:103], v[140:143], a[108:111], v[100:103]
 ds_read_b128 v[116:119], v5 offset:15360
 v_mfma_f32_16x16x32_bf16 v[68:71], v[144:147], a[104:107], v[68:71]
 v_mfma_f32_16x16x32_bf16 v[104:107], v[144:147], a[108:111], v[104:107]
 ds_read_b128 v[120:123], v5 offset:16384
 v_mfma_f32_16x16x32_bf16 v[72:75], v[148:151], a[104:107], v[72:75]
 ds_read_b128 v[124:127], v5 offset:17408
 v_mfma_f32_16x16x32_bf16 v[108:111], v[148:151], a[108:111], v[108:111]
 v_mfma_f32_16x16x32_bf16 v[40:43], v[152:155], a[104:107], v[40:43]
 ds_read_b128 v[128:131], v5 offset:18432
 v_mfma_f32_16x16x32_bf16 v[76:79], v[152:155], a[108:111], v[76:79]
 ds_read_b128 v[132:135], v5 offset:19456
 v_mfma_f32_16x16x32_bf16 v[44:47], v[156:159], a[104:107], v[44:47]
 v_mfma_f32_16x16x32_bf16 v[80:83], v[156:159], a[108:111], v[80:83]
 ds_read_b128 v[136:139], v5 offset:20480
 v_mfma_f32_16x16x32_bf16 v[48:51], v[160:163], a[104:107], v[48:51]
 s_add_u32 s87, s37, 71680
 buffer_load_dwordx4 a[144:147], v1, s[16:19], s87 offen sc1
 v_mfma_f32_16x16x32_bf16 v[84:87], v[160:163], a[108:111], v[84:87]
 v_mfma_f32_16x16x32_bf16 v[52:55], v[164:167], a[104:107], v[52:55]
 s_add_u32 s87, s37, 219136
 buffer_load_dwordx4 a[148:151], v1, s[16:19], s87 offen sc1
 v_mfma_f32_16x16x32_bf16 v[88:91], v[164:167], a[108:111], v[88:91]
 s_waitcnt lgkmcnt(0)
 s_waitcnt vmcnt(15)
 v_mfma_f32_16x16x32_bf16 v[64:67], v[112:115], a[112:115], v[64:67]
 ds_read_b128 v[140:143], v5 offset:21504
 v_mfma_f32_16x16x32_bf16 v[100:103], v[112:115], a[116:119], v[100:103]
 ds_read_b128 v[144:147], v5 offset:22528
 v_mfma_f32_16x16x32_bf16 v[68:71], v[116:119], a[112:115], v[68:71]
 v_mfma_f32_16x16x32_bf16 v[104:107], v[116:119], a[116:119], v[104:107]
 ds_read_b128 v[148:151], v5 offset:23552
 v_mfma_f32_16x16x32_bf16 v[72:75], v[120:123], a[112:115], v[72:75]
 ds_read_b128 v[152:155], v5 offset:24576
 v_mfma_f32_16x16x32_bf16 v[108:111], v[120:123], a[116:119], v[108:111]
 v_mfma_f32_16x16x32_bf16 v[40:43], v[124:127], a[112:115], v[40:43]
 ds_read_b128 v[156:159], v5 offset:25600
 v_mfma_f32_16x16x32_bf16 v[76:79], v[124:127], a[116:119], v[76:79]
 ds_read_b128 v[160:163], v5 offset:26624
 v_mfma_f32_16x16x32_bf16 v[44:47], v[128:131], a[112:115], v[44:47]
 v_mfma_f32_16x16x32_bf16 v[80:83], v[128:131], a[116:119], v[80:83]
 ds_read_b128 v[164:167], v5 offset:27648
 v_mfma_f32_16x16x32_bf16 v[48:51], v[132:135], a[112:115], v[48:51]
 s_add_u32 s87, s37, 72704
 buffer_load_dwordx4 a[152:155], v1, s[16:19], s87 offen sc1
 v_mfma_f32_16x16x32_bf16 v[84:87], v[132:135], a[116:119], v[84:87]
 v_mfma_f32_16x16x32_bf16 v[52:55], v[136:139], a[112:115], v[52:55]
 s_add_u32 s87, s37, 220160
 buffer_load_dwordx4 a[156:159], v1, s[16:19], s87 offen sc1
 v_mfma_f32_16x16x32_bf16 v[88:91], v[136:139], a[116:119], v[88:91]
 s_waitcnt lgkmcnt(0)
 s_waitcnt vmcnt(39)
 s_barrier
 s_waitcnt vmcnt(15)
 v_mfma_f32_16x16x32_bf16 v[64:67], v[140:143], a[120:123], v[64:67]
 ds_read_b128 v[112:115], v2 offset:0
 ds_read_b128 v[116:119], v2 offset:1024
 v_mfma_f32_16x16x32_bf16 v[100:103], v[140:143], a[124:127], v[100:103]
 ds_read_b128 v[120:123], v2 offset:2048
 v_mfma_f32_16x16x32_bf16 v[68:71], v[144:147], a[120:123], v[68:71]
 ds_read_b128 v[124:127], v2 offset:3072
 v_mfma_f32_16x16x32_bf16 v[104:107], v[144:147], a[124:127], v[104:107]
 ds_read_b128 v[128:131], v2 offset:4096
 v_mfma_f32_16x16x32_bf16 v[72:75], v[148:151], a[120:123], v[72:75]
 ds_read_b128 v[132:135], v2 offset:5120
 v_mfma_f32_16x16x32_bf16 v[108:111], v[148:151], a[124:127], v[108:111]
 ds_read_b128 v[136:139], v2 offset:6144
 v_mfma_f32_16x16x32_bf16 v[40:43], v[152:155], a[120:123], v[40:43]
 s_mul_i32 s39, s32, 7168
 s_add_u32 m0, s39, 110592
 s_add_u32 s40, s36, 3323904
 buffer_load_dwordx4 v1, s[12:15], s40 offen offset:0 lds
 v_mfma_f32_16x16x32_bf16 v[76:79], v[152:155], a[124:127], v[76:79]
 buffer_load_dwordx4 v1, s[12:15], s40 offen offset:1024 lds
 buffer_load_dwordx4 v1, s[12:15], s40 offen offset:2048 lds
 v_mfma_f32_16x16x32_bf16 v[44:47], v[156:159], a[120:123], v[44:47]
 s_mul_i32 s39, s32, 7168
 s_add_u32 m0, s39, 113664
 s_add_u32 s40, s36, 3317760
 buffer_load_dwordx4 v1, s[12:15], s40 offen offset:0 lds
 v_mfma_f32_16x16x32_bf16 v[80:83], v[156:159], a[124:127], v[80:83]
 buffer_load_dwordx4 v1, s[12:15], s40 offen offset:1024 lds
 v_mfma_f32_16x16x32_bf16 v[48:51], v[160:163], a[120:123], v[48:51]
 buffer_load_dwordx4 v1, s[12:15], s40 offen offset:2048 lds
 v_mfma_f32_16x16x32_bf16 v[84:87], v[160:163], a[124:127], v[84:87]
 buffer_load_dwordx4 v1, s[12:15], s40 offen offset:3072 lds
 v_mfma_f32_16x16x32_bf16 v[52:55], v[164:167], a[120:123], v[52:55]
 s_add_u32 s87, s37, 75776
 buffer_load_dwordx4 a[160:163], v1, s[16:19], s87 offen sc1
 v_mfma_f32_16x16x32_bf16 v[88:91], v[164:167], a[124:127], v[88:91]
 s_add_u32 s87, s37, 223232
 buffer_load_dwordx4 a[164:167], v1, s[16:19], s87 offen sc1
 s_waitcnt lgkmcnt(0)
 s_waitcnt vmcnt(15)
 v_mfma_f32_16x16x32_bf16 v[64:67], v[112:115], a[128:131], v[64:67]
 ds_read_b128 v[140:143], v2 offset:7168
 v_mfma_f32_16x16x32_bf16 v[100:103], v[112:115], a[132:135], v[100:103]
 ds_read_b128 v[144:147], v2 offset:8192
 v_mfma_f32_16x16x32_bf16 v[68:71], v[116:119], a[128:131], v[68:71]
 v_mfma_f32_16x16x32_bf16 v[104:107], v[116:119], a[132:135], v[104:107]
 ds_read_b128 v[148:151], v2 offset:9216
 v_mfma_f32_16x16x32_bf16 v[72:75], v[120:123], a[128:131], v[72:75]
 ds_read_b128 v[152:155], v2 offset:10240
 v_mfma_f32_16x16x32_bf16 v[108:111], v[120:123], a[132:135], v[108:111]
 v_mfma_f32_16x16x32_bf16 v[40:43], v[124:127], a[128:131], v[40:43]
 ds_read_b128 v[156:159], v2 offset:11264
 v_mfma_f32_16x16x32_bf16 v[76:79], v[124:127], a[132:135], v[76:79]
 ds_read_b128 v[160:163], v2 offset:12288
 v_mfma_f32_16x16x32_bf16 v[44:47], v[128:131], a[128:131], v[44:47]
 v_mfma_f32_16x16x32_bf16 v[80:83], v[128:131], a[132:135], v[80:83]
 ds_read_b128 v[164:167], v2 offset:13312
 v_mfma_f32_16x16x32_bf16 v[48:51], v[132:135], a[128:131], v[48:51]
 s_add_u32 s87, s37, 76800
 buffer_load_dwordx4 a[168:171], v1, s[16:19], s87 offen sc1
 v_mfma_f32_16x16x32_bf16 v[84:87], v[132:135], a[132:135], v[84:87]
 v_mfma_f32_16x16x32_bf16 v[52:55], v[136:139], a[128:131], v[52:55]
 s_add_u32 s87, s37, 224256
 buffer_load_dwordx4 a[172:175], v1, s[16:19], s87 offen sc1
 v_mfma_f32_16x16x32_bf16 v[88:91], v[136:139], a[132:135], v[88:91]
 s_waitcnt lgkmcnt(0)
 s_waitcnt vmcnt(15)
 v_mfma_f32_16x16x32_bf16 v[64:67], v[140:143], a[136:139], v[64:67]
 ds_read_b128 v[112:115], v2 offset:14336
 v_mfma_f32_16x16x32_bf16 v[100:103], v[140:143], a[140:143], v[100:103]
 ds_read_b128 v[116:119], v2 offset:15360
 v_mfma_f32_16x16x32_bf16 v[68:71], v[144:147], a[136:139], v[68:71]
 v_mfma_f32_16x16x32_bf16 v[104:107], v[144:147], a[140:143], v[104:107]
 ds_read_b128 v[120:123], v2 offset:16384
 v_mfma_f32_16x16x32_bf16 v[72:75], v[148:151], a[136:139], v[72:75]
 ds_read_b128 v[124:127], v2 offset:17408
 v_mfma_f32_16x16x32_bf16 v[108:111], v[148:151], a[140:143], v[108:111]
 v_mfma_f32_16x16x32_bf16 v[40:43], v[152:155], a[136:139], v[40:43]
 ds_read_b128 v[128:131], v2 offset:18432
 v_mfma_f32_16x16x32_bf16 v[76:79], v[152:155], a[140:143], v[76:79]
 ds_read_b128 v[132:135], v2 offset:19456
 v_mfma_f32_16x16x32_bf16 v[44:47], v[156:159], a[136:139], v[44:47]
 v_mfma_f32_16x16x32_bf16 v[80:83], v[156:159], a[140:143], v[80:83]
 ds_read_b128 v[136:139], v2 offset:20480
 v_mfma_f32_16x16x32_bf16 v[48:51], v[160:163], a[136:139], v[48:51]
 s_add_u32 s87, s37, 79872
 buffer_load_dwordx4 a[176:179], v1, s[16:19], s87 offen sc1
 v_mfma_f32_16x16x32_bf16 v[84:87], v[160:163], a[140:143], v[84:87]
 v_mfma_f32_16x16x32_bf16 v[52:55], v[164:167], a[136:139], v[52:55]
 s_add_u32 s87, s37, 227328
 buffer_load_dwordx4 a[180:183], v1, s[16:19], s87 offen sc1
 v_mfma_f32_16x16x32_bf16 v[88:91], v[164:167], a[140:143], v[88:91]
 s_waitcnt lgkmcnt(0)
 s_waitcnt vmcnt(15)
 v_mfma_f32_16x16x32_bf16 v[64:67], v[112:115], a[144:147], v[64:67]
 ds_read_b128 v[140:143], v2 offset:21504
 v_mfma_f32_16x16x32_bf16 v[100:103], v[112:115], a[148:151], v[100:103]
 ds_read_b128 v[144:147], v2 offset:22528
 v_mfma_f32_16x16x32_bf16 v[68:71], v[116:119], a[144:147], v[68:71]
 v_mfma_f32_16x16x32_bf16 v[104:107], v[116:119], a[148:151], v[104:107]
 ds_read_b128 v[148:151], v2 offset:23552
 v_mfma_f32_16x16x32_bf16 v[72:75], v[120:123], a[144:147], v[72:75]
 ds_read_b128 v[152:155], v2 offset:24576
 v_mfma_f32_16x16x32_bf16 v[108:111], v[120:123], a[148:151], v[108:111]
 v_mfma_f32_16x16x32_bf16 v[40:43], v[124:127], a[144:147], v[40:43]
 ds_read_b128 v[156:159], v2 offset:25600
 v_mfma_f32_16x16x32_bf16 v[76:79], v[124:127], a[148:151], v[76:79]
 ds_read_b128 v[160:163], v2 offset:26624
 v_mfma_f32_16x16x32_bf16 v[44:47], v[128:131], a[144:147], v[44:47]
 v_mfma_f32_16x16x32_bf16 v[80:83], v[128:131], a[148:151], v[80:83]
 ds_read_b128 v[164:167], v2 offset:27648
 v_mfma_f32_16x16x32_bf16 v[48:51], v[132:135], a[144:147], v[48:51]
 s_add_u32 s87, s37, 80896
 buffer_load_dwordx4 a[184:187], v1, s[16:19], s87 offen sc1
 v_mfma_f32_16x16x32_bf16 v[84:87], v[132:135], a[148:151], v[84:87]
 v_mfma_f32_16x16x32_bf16 v[52:55], v[136:139], a[144:147], v[52:55]
 s_add_u32 s87, s37, 228352
 buffer_load_dwordx4 a[188:191], v1, s[16:19], s87 offen sc1
 v_mfma_f32_16x16x32_bf16 v[88:91], v[136:139], a[148:151], v[88:91]
 s_waitcnt lgkmcnt(0)
 s_waitcnt vmcnt(38)
 s_barrier
 s_waitcnt vmcnt(15)
 v_mfma_f32_16x16x32_bf16 v[64:67], v[140:143], a[152:155], v[64:67]
 ds_read_b128 v[112:115], v3 offset:0
 ds_read_b128 v[116:119], v3 offset:1024
 v_mfma_f32_16x16x32_bf16 v[100:103], v[140:143], a[156:159], v[100:103]
 ds_read_b128 v[120:123], v3 offset:2048
 v_mfma_f32_16x16x32_bf16 v[68:71], v[144:147], a[152:155], v[68:71]
 ds_read_b128 v[124:127], v3 offset:3072
 v_mfma_f32_16x16x32_bf16 v[104:107], v[144:147], a[156:159], v[104:107]
 ds_read_b128 v[128:131], v3 offset:4096
 v_mfma_f32_16x16x32_bf16 v[72:75], v[148:151], a[152:155], v[72:75]
 ds_read_b128 v[132:135], v3 offset:5120
 v_mfma_f32_16x16x32_bf16 v[108:111], v[148:151], a[156:159], v[108:111]
 ds_read_b128 v[136:139], v3 offset:6144
 v_mfma_f32_16x16x32_bf16 v[40:43], v[152:155], a[152:155], v[40:43]
 s_mul_i32 s39, s32, 7168
 s_add_u32 m0, s39, 0
 s_add_u32 s40, s38, 5019648
 buffer_load_dwordx4 v1, s[12:15], s40 offen offset:0 lds
 v_mfma_f32_16x16x32_bf16 v[76:79], v[152:155], a[156:159], v[76:79]
 buffer_load_dwordx4 v1, s[12:15], s40 offen offset:1024 lds
 buffer_load_dwordx4 v1, s[12:15], s40 offen offset:2048 lds
 v_mfma_f32_16x16x32_bf16 v[44:47], v[156:159], a[152:155], v[44:47]
 s_mul_i32 s39, s32, 7168
 s_add_u32 m0, s39, 3072
 s_add_u32 s40, s38, 5013504
 buffer_load_dwordx4 v1, s[12:15], s40 offen offset:0 lds
 v_mfma_f32_16x16x32_bf16 v[80:83], v[156:159], a[156:159], v[80:83]
 buffer_load_dwordx4 v1, s[12:15], s40 offen offset:1024 lds
 v_mfma_f32_16x16x32_bf16 v[48:51], v[160:163], a[152:155], v[48:51]
 buffer_load_dwordx4 v1, s[12:15], s40 offen offset:2048 lds
 v_mfma_f32_16x16x32_bf16 v[84:87], v[160:163], a[156:159], v[84:87]
 buffer_load_dwordx4 v1, s[12:15], s40 offen offset:3072 lds
 v_mfma_f32_16x16x32_bf16 v[52:55], v[164:167], a[152:155], v[52:55]
 s_add_u32 s87, s37, 83968
 buffer_load_dwordx4 a[192:195], v1, s[16:19], s87 offen sc1
 v_mfma_f32_16x16x32_bf16 v[88:91], v[164:167], a[156:159], v[88:91]
 s_add_u32 s87, s37, 231424
 buffer_load_dwordx4 a[196:199], v1, s[16:19], s87 offen sc1
 s_waitcnt lgkmcnt(0)
 s_waitcnt vmcnt(15)
 v_mfma_f32_16x16x32_bf16 v[64:67], v[112:115], a[160:163], v[64:67]
 ds_read_b128 v[140:143], v3 offset:7168
 v_mfma_f32_16x16x32_bf16 v[100:103], v[112:115], a[164:167], v[100:103]
 ds_read_b128 v[144:147], v3 offset:8192
 v_mfma_f32_16x16x32_bf16 v[68:71], v[116:119], a[160:163], v[68:71]
 v_mfma_f32_16x16x32_bf16 v[104:107], v[116:119], a[164:167], v[104:107]
 ds_read_b128 v[148:151], v3 offset:9216
 v_mfma_f32_16x16x32_bf16 v[72:75], v[120:123], a[160:163], v[72:75]
 ds_read_b128 v[152:155], v3 offset:10240
 v_mfma_f32_16x16x32_bf16 v[108:111], v[120:123], a[164:167], v[108:111]
 v_mfma_f32_16x16x32_bf16 v[40:43], v[124:127], a[160:163], v[40:43]
 ds_read_b128 v[156:159], v3 offset:11264
 v_mfma_f32_16x16x32_bf16 v[76:79], v[124:127], a[164:167], v[76:79]
 ds_read_b128 v[160:163], v3 offset:12288
 v_mfma_f32_16x16x32_bf16 v[44:47], v[128:131], a[160:163], v[44:47]
 v_mfma_f32_16x16x32_bf16 v[80:83], v[128:131], a[164:167], v[80:83]
 ds_read_b128 v[164:167], v3 offset:13312
 v_mfma_f32_16x16x32_bf16 v[48:51], v[132:135], a[160:163], v[48:51]
 s_add_u32 s87, s37, 84992
 buffer_load_dwordx4 a[200:203], v1, s[16:19], s87 offen sc1
 v_mfma_f32_16x16x32_bf16 v[84:87], v[132:135], a[164:167], v[84:87]
 v_mfma_f32_16x16x32_bf16 v[52:55], v[136:139], a[160:163], v[52:55]
 s_add_u32 s87, s37, 232448
 buffer_load_dwordx4 a[204:207], v1, s[16:19], s87 offen sc1
 v_mfma_f32_16x16x32_bf16 v[88:91], v[136:139], a[164:167], v[88:91]
 s_waitcnt lgkmcnt(0)
 s_waitcnt vmcnt(15)
 v_mfma_f32_16x16x32_bf16 v[64:67], v[140:143], a[168:171], v[64:67]
 ds_read_b128 v[112:115], v3 offset:14336
 v_mfma_f32_16x16x32_bf16 v[100:103], v[140:143], a[172:175], v[100:103]
 ds_read_b128 v[116:119], v3 offset:15360
 v_mfma_f32_16x16x32_bf16 v[68:71], v[144:147], a[168:171], v[68:71]
 v_mfma_f32_16x16x32_bf16 v[104:107], v[144:147], a[172:175], v[104:107]
 ds_read_b128 v[120:123], v3 offset:16384
 v_mfma_f32_16x16x32_bf16 v[72:75], v[148:151], a[168:171], v[72:75]
 ds_read_b128 v[124:127], v3 offset:17408
 v_mfma_f32_16x16x32_bf16 v[108:111], v[148:151], a[172:175], v[108:111]
 v_mfma_f32_16x16x32_bf16 v[40:43], v[152:155], a[168:171], v[40:43]
 ds_read_b128 v[128:131], v3 offset:18432
 v_mfma_f32_16x16x32_bf16 v[76:79], v[152:155], a[172:175], v[76:79]
 ds_read_b128 v[132:135], v3 offset:19456
 v_mfma_f32_16x16x32_bf16 v[44:47], v[156:159], a[168:171], v[44:47]
 v_mfma_f32_16x16x32_bf16 v[80:83], v[156:159], a[172:175], v[80:83]
 ds_read_b128 v[136:139], v3 offset:20480
 v_mfma_f32_16x16x32_bf16 v[48:51], v[160:163], a[168:171], v[48:51]
 s_add_u32 s87, s37, 88064
 buffer_load_dwordx4 a[208:211], v1, s[16:19], s87 offen sc1
 v_mfma_f32_16x16x32_bf16 v[84:87], v[160:163], a[172:175], v[84:87]
 v_mfma_f32_16x16x32_bf16 v[52:55], v[164:167], a[168:171], v[52:55]
 s_add_u32 s87, s37, 235520
 buffer_load_dwordx4 a[212:215], v1, s[16:19], s87 offen sc1
 v_mfma_f32_16x16x32_bf16 v[88:91], v[164:167], a[172:175], v[88:91]
 s_waitcnt lgkmcnt(0)
 s_waitcnt vmcnt(15)
 v_mfma_f32_16x16x32_bf16 v[64:67], v[112:115], a[176:179], v[64:67]
 ds_read_b128 v[140:143], v3 offset:21504
 v_mfma_f32_16x16x32_bf16 v[100:103], v[112:115], a[180:183], v[100:103]
 ds_read_b128 v[144:147], v3 offset:22528
 v_mfma_f32_16x16x32_bf16 v[68:71], v[116:119], a[176:179], v[68:71]
 v_mfma_f32_16x16x32_bf16 v[104:107], v[116:119], a[180:183], v[104:107]
 ds_read_b128 v[148:151], v3 offset:23552
 v_mfma_f32_16x16x32_bf16 v[72:75], v[120:123], a[176:179], v[72:75]
 ds_read_b128 v[152:155], v3 offset:24576
 v_mfma_f32_16x16x32_bf16 v[108:111], v[120:123], a[180:183], v[108:111]
 v_mfma_f32_16x16x32_bf16 v[40:43], v[124:127], a[176:179], v[40:43]
 ds_read_b128 v[156:159], v3 offset:25600
 v_mfma_f32_16x16x32_bf16 v[76:79], v[124:127], a[180:183], v[76:79]
 ds_read_b128 v[160:163], v3 offset:26624
 v_mfma_f32_16x16x32_bf16 v[44:47], v[128:131], a[176:179], v[44:47]
 v_mfma_f32_16x16x32_bf16 v[80:83], v[128:131], a[180:183], v[80:83]
 ds_read_b128 v[164:167], v3 offset:27648
 v_mfma_f32_16x16x32_bf16 v[48:51], v[132:135], a[176:179], v[48:51]
 s_add_u32 s87, s37, 89088
 buffer_load_dwordx4 a[216:219], v1, s[16:19], s87 offen sc1
 v_mfma_f32_16x16x32_bf16 v[84:87], v[132:135], a[180:183], v[84:87]
 v_mfma_f32_16x16x32_bf16 v[52:55], v[136:139], a[176:179], v[52:55]
 s_add_u32 s87, s37, 236544
 buffer_load_dwordx4 a[220:223], v1, s[16:19], s87 offen sc1
 v_mfma_f32_16x16x32_bf16 v[88:91], v[136:139], a[180:183], v[88:91]
 s_waitcnt lgkmcnt(0)
 s_waitcnt vmcnt(38)
 s_barrier
 s_waitcnt vmcnt(15)
 v_mfma_f32_16x16x32_bf16 v[64:67], v[140:143], a[184:187], v[64:67]
 ds_read_b128 v[112:115], v4 offset:0
 v_mfma_f32_16x16x32_bf16 v[100:103], v[140:143], a[188:191], v[100:103]
 ds_read_b128 v[116:119], v4 offset:1024
 v_mfma_f32_16x16x32_bf16 v[68:71], v[144:147], a[184:187], v[68:71]
 v_mfma_f32_16x16x32_bf16 v[104:107], v[144:147], a[188:191], v[104:107]
 ds_read_b128 v[120:123], v4 offset:2048
 v_mfma_f32_16x16x32_bf16 v[72:75], v[148:151], a[184:187], v[72:75]
 ds_read_b128 v[124:127], v4 offset:3072
 v_mfma_f32_16x16x32_bf16 v[108:111], v[148:151], a[188:191], v[108:111]
 v_mfma_f32_16x16x32_bf16 v[40:43], v[152:155], a[184:187], v[40:43]
 ds_read_b128 v[128:131], v4 offset:4096
 v_mfma_f32_16x16x32_bf16 v[76:79], v[152:155], a[188:191], v[76:79]
 ds_read_b128 v[132:135], v4 offset:5120
 v_mfma_f32_16x16x32_bf16 v[44:47], v[156:159], a[184:187], v[44:47]
 v_mfma_f32_16x16x32_bf16 v[80:83], v[156:159], a[188:191], v[80:83]
 ds_read_b128 v[136:139], v4 offset:6144
 v_mfma_f32_16x16x32_bf16 v[48:51], v[160:163], a[184:187], v[48:51]
 s_add_u32 s87, s37, 92160
 buffer_load_dwordx4 a[224:227], v1, s[16:19], s87 offen sc1
 v_mfma_f32_16x16x32_bf16 v[84:87], v[160:163], a[188:191], v[84:87]
 v_mfma_f32_16x16x32_bf16 v[52:55], v[164:167], a[184:187], v[52:55]
 s_add_u32 s87, s37, 239616
 buffer_load_dwordx4 a[228:231], v1, s[16:19], s87 offen sc1
 v_mfma_f32_16x16x32_bf16 v[88:91], v[164:167], a[188:191], v[88:91]
 s_waitcnt lgkmcnt(0)
 s_waitcnt vmcnt(8)
 v_mfma_f32_16x16x32_bf16 v[64:67], v[112:115], a[192:195], v[64:67]
 ds_read_b128 v[140:143], v4 offset:7168
 v_mfma_f32_16x16x32_bf16 v[100:103], v[112:115], a[196:199], v[100:103]
 ds_read_b128 v[144:147], v4 offset:8192
 v_mfma_f32_16x16x32_bf16 v[68:71], v[116:119], a[192:195], v[68:71]
 v_mfma_f32_16x16x32_bf16 v[104:107], v[116:119], a[196:199], v[104:107]
 ds_read_b128 v[148:151], v4 offset:9216
 v_mfma_f32_16x16x32_bf16 v[72:75], v[120:123], a[192:195], v[72:75]
 ds_read_b128 v[152:155], v4 offset:10240
 v_mfma_f32_16x16x32_bf16 v[108:111], v[120:123], a[196:199], v[108:111]
 v_mfma_f32_16x16x32_bf16 v[40:43], v[124:127], a[192:195], v[40:43]
 ds_read_b128 v[156:159], v4 offset:11264
 v_mfma_f32_16x16x32_bf16 v[76:79], v[124:127], a[196:199], v[76:79]
 ds_read_b128 v[160:163], v4 offset:12288
 v_mfma_f32_16x16x32_bf16 v[44:47], v[128:131], a[192:195], v[44:47]
 v_mfma_f32_16x16x32_bf16 v[80:83], v[128:131], a[196:199], v[80:83]
 ds_read_b128 v[164:167], v4 offset:13312
 v_mfma_f32_16x16x32_bf16 v[48:51], v[132:135], a[192:195], v[48:51]
 s_add_u32 s87, s37, 93184
 buffer_load_dwordx4 a[232:235], v1, s[16:19], s87 offen sc1
 v_mfma_f32_16x16x32_bf16 v[84:87], v[132:135], a[196:199], v[84:87]
 v_mfma_f32_16x16x32_bf16 v[52:55], v[136:139], a[192:195], v[52:55]
 s_add_u32 s87, s37, 240640
 buffer_load_dwordx4 a[236:239], v1, s[16:19], s87 offen sc1
 v_mfma_f32_16x16x32_bf16 v[88:91], v[136:139], a[196:199], v[88:91]
 s_waitcnt lgkmcnt(0)
 s_waitcnt vmcnt(8)
 v_mfma_f32_16x16x32_bf16 v[64:67], v[140:143], a[200:203], v[64:67]
 ds_read_b128 v[112:115], v4 offset:14336
 v_mfma_f32_16x16x32_bf16 v[100:103], v[140:143], a[204:207], v[100:103]
 ds_read_b128 v[116:119], v4 offset:15360
 v_mfma_f32_16x16x32_bf16 v[68:71], v[144:147], a[200:203], v[68:71]
 v_mfma_f32_16x16x32_bf16 v[104:107], v[144:147], a[204:207], v[104:107]
 ds_read_b128 v[120:123], v4 offset:16384
 v_mfma_f32_16x16x32_bf16 v[72:75], v[148:151], a[200:203], v[72:75]
 ds_read_b128 v[124:127], v4 offset:17408
 v_mfma_f32_16x16x32_bf16 v[108:111], v[148:151], a[204:207], v[108:111]
 v_mfma_f32_16x16x32_bf16 v[40:43], v[152:155], a[200:203], v[40:43]
 ds_read_b128 v[128:131], v4 offset:18432
 v_mfma_f32_16x16x32_bf16 v[76:79], v[152:155], a[204:207], v[76:79]
 ds_read_b128 v[132:135], v4 offset:19456
 v_mfma_f32_16x16x32_bf16 v[44:47], v[156:159], a[200:203], v[44:47]
 v_mfma_f32_16x16x32_bf16 v[80:83], v[156:159], a[204:207], v[80:83]
 ds_read_b128 v[136:139], v4 offset:20480
 v_mfma_f32_16x16x32_bf16 v[48:51], v[160:163], a[200:203], v[48:51]
 s_add_u32 s87, s37, 96256
 buffer_load_dwordx4 a[240:243], v1, s[16:19], s87 offen sc1
 v_mfma_f32_16x16x32_bf16 v[84:87], v[160:163], a[204:207], v[84:87]
 v_mfma_f32_16x16x32_bf16 v[52:55], v[164:167], a[200:203], v[52:55]
 s_add_u32 s87, s37, 243712
 buffer_load_dwordx4 a[244:247], v1, s[16:19], s87 offen sc1
 v_mfma_f32_16x16x32_bf16 v[88:91], v[164:167], a[204:207], v[88:91]
 s_waitcnt lgkmcnt(0)
 s_waitcnt vmcnt(8)
 v_mfma_f32_16x16x32_bf16 v[64:67], v[112:115], a[208:211], v[64:67]
 ds_read_b128 v[140:143], v4 offset:21504
 v_mfma_f32_16x16x32_bf16 v[100:103], v[112:115], a[212:215], v[100:103]
 ds_read_b128 v[144:147], v4 offset:22528
 v_mfma_f32_16x16x32_bf16 v[68:71], v[116:119], a[208:211], v[68:71]
 v_mfma_f32_16x16x32_bf16 v[104:107], v[116:119], a[212:215], v[104:107]
 ds_read_b128 v[148:151], v4 offset:23552
 v_mfma_f32_16x16x32_bf16 v[72:75], v[120:123], a[208:211], v[72:75]
 ds_read_b128 v[152:155], v4 offset:24576
 v_mfma_f32_16x16x32_bf16 v[108:111], v[120:123], a[212:215], v[108:111]
 v_mfma_f32_16x16x32_bf16 v[40:43], v[124:127], a[208:211], v[40:43]
 ds_read_b128 v[156:159], v4 offset:25600
 v_mfma_f32_16x16x32_bf16 v[76:79], v[124:127], a[212:215], v[76:79]
 ds_read_b128 v[160:163], v4 offset:26624
 v_mfma_f32_16x16x32_bf16 v[44:47], v[128:131], a[208:211], v[44:47]
 v_mfma_f32_16x16x32_bf16 v[80:83], v[128:131], a[212:215], v[80:83]
 ds_read_b128 v[164:167], v4 offset:27648
 v_mfma_f32_16x16x32_bf16 v[48:51], v[132:135], a[208:211], v[48:51]
 s_add_u32 s87, s37, 97280
 buffer_load_dwordx4 a[248:251], v1, s[16:19], s87 offen sc1
 v_mfma_f32_16x16x32_bf16 v[84:87], v[132:135], a[212:215], v[84:87]
 v_mfma_f32_16x16x32_bf16 v[52:55], v[136:139], a[208:211], v[52:55]
 s_add_u32 s87, s37, 244736
 buffer_load_dwordx4 a[252:255], v1, s[16:19], s87 offen sc1
 v_mfma_f32_16x16x32_bf16 v[88:91], v[136:139], a[212:215], v[88:91]
 s_waitcnt lgkmcnt(0)
 s_waitcnt vmcnt(31)
 s_barrier
 s_waitcnt vmcnt(8)
 v_mfma_f32_16x16x32_bf16 v[64:67], v[140:143], a[216:219], v[64:67]
 ds_read_b128 v[112:115], v5 offset:0
 v_mfma_f32_16x16x32_bf16 v[100:103], v[140:143], a[220:223], v[100:103]
 ds_read_b128 v[116:119], v5 offset:1024
 v_mfma_f32_16x16x32_bf16 v[68:71], v[144:147], a[216:219], v[68:71]
 v_mfma_f32_16x16x32_bf16 v[104:107], v[144:147], a[220:223], v[104:107]
 ds_read_b128 v[120:123], v5 offset:2048
 v_mfma_f32_16x16x32_bf16 v[72:75], v[148:151], a[216:219], v[72:75]
 ds_read_b128 v[124:127], v5 offset:3072
 v_mfma_f32_16x16x32_bf16 v[108:111], v[148:151], a[220:223], v[108:111]
 v_mfma_f32_16x16x32_bf16 v[40:43], v[152:155], a[216:219], v[40:43]
 ds_read_b128 v[128:131], v5 offset:4096
 v_mfma_f32_16x16x32_bf16 v[76:79], v[152:155], a[220:223], v[76:79]
 ds_read_b128 v[132:135], v5 offset:5120
 v_mfma_f32_16x16x32_bf16 v[44:47], v[156:159], a[216:219], v[44:47]
 v_mfma_f32_16x16x32_bf16 v[80:83], v[156:159], a[220:223], v[80:83]
 ds_read_b128 v[136:139], v5 offset:6144
 v_mfma_f32_16x16x32_bf16 v[48:51], v[160:163], a[216:219], v[48:51]
 s_add_u32 s87, s37, 139264
 buffer_load_dwordx4 v[8:11], v1, s[16:19], s87 offen sc1
 v_mfma_f32_16x16x32_bf16 v[84:87], v[160:163], a[220:223], v[84:87]
 v_mfma_f32_16x16x32_bf16 v[52:55], v[164:167], a[216:219], v[52:55]
 s_add_u32 s87, s37, 286720
 buffer_load_dwordx4 v[12:15], v1, s[16:19], s87 offen sc1
 v_mfma_f32_16x16x32_bf16 v[88:91], v[164:167], a[220:223], v[88:91]
 s_waitcnt lgkmcnt(0)
 s_waitcnt vmcnt(8)
 v_mfma_f32_16x16x32_bf16 v[64:67], v[112:115], a[224:227], v[64:67]
 ds_read_b128 v[140:143], v5 offset:7168
 v_mfma_f32_16x16x32_bf16 v[100:103], v[112:115], a[228:231], v[100:103]
 ds_read_b128 v[144:147], v5 offset:8192
 v_mfma_f32_16x16x32_bf16 v[68:71], v[116:119], a[224:227], v[68:71]
 v_mfma_f32_16x16x32_bf16 v[104:107], v[116:119], a[228:231], v[104:107]
 ds_read_b128 v[148:151], v5 offset:9216
 v_mfma_f32_16x16x32_bf16 v[72:75], v[120:123], a[224:227], v[72:75]
 ds_read_b128 v[152:155], v5 offset:10240
 v_mfma_f32_16x16x32_bf16 v[108:111], v[120:123], a[228:231], v[108:111]
 v_mfma_f32_16x16x32_bf16 v[40:43], v[124:127], a[224:227], v[40:43]
 ds_read_b128 v[156:159], v5 offset:11264
 v_mfma_f32_16x16x32_bf16 v[76:79], v[124:127], a[228:231], v[76:79]
 ds_read_b128 v[160:163], v5 offset:12288
 v_mfma_f32_16x16x32_bf16 v[44:47], v[128:131], a[224:227], v[44:47]
 v_mfma_f32_16x16x32_bf16 v[80:83], v[128:131], a[228:231], v[80:83]
 ds_read_b128 v[164:167], v5 offset:13312
 v_mfma_f32_16x16x32_bf16 v[48:51], v[132:135], a[224:227], v[48:51]
 s_add_u32 s87, s37, 140288
 buffer_load_dwordx4 v[16:19], v1, s[16:19], s87 offen sc1
 v_mfma_f32_16x16x32_bf16 v[84:87], v[132:135], a[228:231], v[84:87]
 v_mfma_f32_16x16x32_bf16 v[52:55], v[136:139], a[224:227], v[52:55]
 s_add_u32 s87, s37, 287744
 buffer_load_dwordx4 v[20:23], v1, s[16:19], s87 offen sc1
 v_mfma_f32_16x16x32_bf16 v[88:91], v[136:139], a[228:231], v[88:91]
 s_waitcnt lgkmcnt(0)
 s_waitcnt vmcnt(8)
 v_mfma_f32_16x16x32_bf16 v[64:67], v[140:143], a[232:235], v[64:67]
 ds_read_b128 v[112:115], v5 offset:14336
 v_mfma_f32_16x16x32_bf16 v[100:103], v[140:143], a[236:239], v[100:103]
 ds_read_b128 v[116:119], v5 offset:15360
 v_mfma_f32_16x16x32_bf16 v[68:71], v[144:147], a[232:235], v[68:71]
 v_mfma_f32_16x16x32_bf16 v[104:107], v[144:147], a[236:239], v[104:107]
 ds_read_b128 v[120:123], v5 offset:16384
 v_mfma_f32_16x16x32_bf16 v[72:75], v[148:151], a[232:235], v[72:75]
 ds_read_b128 v[124:127], v5 offset:17408
 v_mfma_f32_16x16x32_bf16 v[108:111], v[148:151], a[236:239], v[108:111]
 v_mfma_f32_16x16x32_bf16 v[40:43], v[152:155], a[232:235], v[40:43]
 ds_read_b128 v[128:131], v5 offset:18432
 v_mfma_f32_16x16x32_bf16 v[76:79], v[152:155], a[236:239], v[76:79]
 ds_read_b128 v[132:135], v5 offset:19456
 v_mfma_f32_16x16x32_bf16 v[44:47], v[156:159], a[232:235], v[44:47]
 v_mfma_f32_16x16x32_bf16 v[80:83], v[156:159], a[236:239], v[80:83]
 ds_read_b128 v[136:139], v5 offset:20480
 v_mfma_f32_16x16x32_bf16 v[48:51], v[160:163], a[232:235], v[48:51]
 s_add_u32 s87, s37, 141312
 buffer_load_dwordx4 v[24:27], v1, s[16:19], s87 offen sc1
 v_mfma_f32_16x16x32_bf16 v[84:87], v[160:163], a[236:239], v[84:87]
 v_mfma_f32_16x16x32_bf16 v[52:55], v[164:167], a[232:235], v[52:55]
 s_add_u32 s87, s37, 288768
 buffer_load_dwordx4 v[28:31], v1, s[16:19], s87 offen sc1
 v_mfma_f32_16x16x32_bf16 v[88:91], v[164:167], a[236:239], v[88:91]
 s_waitcnt lgkmcnt(0)
 s_waitcnt vmcnt(8)
 v_mfma_f32_16x16x32_bf16 v[64:67], v[112:115], a[240:243], v[64:67]
 ds_read_b128 v[140:143], v5 offset:21504
 v_mfma_f32_16x16x32_bf16 v[100:103], v[112:115], a[244:247], v[100:103]
 ds_read_b128 v[144:147], v5 offset:22528
 v_mfma_f32_16x16x32_bf16 v[68:71], v[116:119], a[240:243], v[68:71]
 v_mfma_f32_16x16x32_bf16 v[104:107], v[116:119], a[244:247], v[104:107]
 ds_read_b128 v[148:151], v5 offset:23552
 v_mfma_f32_16x16x32_bf16 v[72:75], v[120:123], a[240:243], v[72:75]
 ds_read_b128 v[152:155], v5 offset:24576
 v_mfma_f32_16x16x32_bf16 v[108:111], v[120:123], a[244:247], v[108:111]
 v_mfma_f32_16x16x32_bf16 v[40:43], v[124:127], a[240:243], v[40:43]
 ds_read_b128 v[156:159], v5 offset:25600
 v_mfma_f32_16x16x32_bf16 v[76:79], v[124:127], a[244:247], v[76:79]
 ds_read_b128 v[160:163], v5 offset:26624
 v_mfma_f32_16x16x32_bf16 v[44:47], v[128:131], a[240:243], v[44:47]
 v_mfma_f32_16x16x32_bf16 v[80:83], v[128:131], a[244:247], v[80:83]
 ds_read_b128 v[164:167], v5 offset:27648
 v_mfma_f32_16x16x32_bf16 v[48:51], v[132:135], a[240:243], v[48:51]
 s_add_u32 s87, s37, 142336
 buffer_load_dwordx4 v[32:35], v1, s[16:19], s87 offen sc1
 v_mfma_f32_16x16x32_bf16 v[84:87], v[132:135], a[244:247], v[84:87]
 v_mfma_f32_16x16x32_bf16 v[52:55], v[136:139], a[240:243], v[52:55]
 s_add_u32 s87, s37, 289792
 buffer_load_dwordx4 v[36:39], v1, s[16:19], s87 offen sc1
 v_mfma_f32_16x16x32_bf16 v[88:91], v[136:139], a[244:247], v[88:91]
 s_waitcnt lgkmcnt(0)
 s_waitcnt vmcnt(24)
 s_barrier
 s_waitcnt vmcnt(8)
 v_mfma_f32_16x16x32_bf16 v[64:67], v[140:143], a[248:251], v[64:67]
 ds_read_b128 v[112:115], v2 offset:0
 v_mfma_f32_16x16x32_bf16 v[100:103], v[140:143], a[252:255], v[100:103]
 ds_read_b128 v[116:119], v2 offset:1024
 v_mfma_f32_16x16x32_bf16 v[68:71], v[144:147], a[248:251], v[68:71]
 ds_read_b128 v[120:123], v2 offset:2048
 v_mfma_f32_16x16x32_bf16 v[104:107], v[144:147], a[252:255], v[104:107]
 ds_read_b128 v[124:127], v2 offset:3072
 v_mfma_f32_16x16x32_bf16 v[72:75], v[148:151], a[248:251], v[72:75]
 ds_read_b128 v[128:131], v2 offset:4096
 v_mfma_f32_16x16x32_bf16 v[108:111], v[148:151], a[252:255], v[108:111]
 ds_read_b128 v[132:135], v2 offset:5120
 v_mfma_f32_16x16x32_bf16 v[40:43], v[152:155], a[248:251], v[40:43]
 ds_read_b128 v[136:139], v2 offset:6144
 v_mfma_f32_16x16x32_bf16 v[76:79], v[152:155], a[252:255], v[76:79]
 s_add_u32 s81, s80, 0
 s_and_b32 s82, s81, 15
 s_lshr_b32 s83, s82, 1
 s_lshl_b32 s83, s83, 2
 s_and_b32 s82, s82, 1
 s_add_u32 s83, s83, s82
 s_lshr_b32 s82, s81, 4
 s_lshl_b32 s82, s82, 1
 s_add_u32 s83, s83, s82
 s_add_u32 s83, s83, 64
 s_add_u32 s82, s81, 104
 s_cmp_ge_u32 s81, 32
 s_cselect_b32 s83, s82, s83
 s_mul_i32 s83, s83, 36864
 s_add_u32 s83, s83, s41
 s_add_u32 s40, s83, 4096
 s_mul_i32 s39, s32, 6144
 s_add_u32 m0, s39, 36864
 s_nop 0
 buffer_load_dwordx4 v1, s[12:15], s40 offen offset:0 lds
 v_mfma_f32_16x16x32_bf16 v[44:47], v[156:159], a[248:251], v[44:47]
 buffer_load_dwordx4 v1, s[12:15], s40 offen offset:1024 lds
 v_mfma_f32_16x16x32_bf16 v[80:83], v[156:159], a[252:255], v[80:83]
 s_add_u32 s81, s80, 1
 s_and_b32 s82, s81, 15
 s_lshr_b32 s83, s82, 1
 s_lshl_b32 s83, s83, 2
 s_and_b32 s82, s82, 1
 s_add_u32 s83, s83, s82
 s_lshr_b32 s82, s81, 4
 s_lshl_b32 s82, s82, 1
 s_add_u32 s83, s83, s82
 s_add_u32 s83, s83, 64
 s_add_u32 s82, s81, 104
 s_cmp_ge_u32 s81, 32
 s_cselect_b32 s83, s82, s83
 s_mul_i32 s83, s83, 36864
 s_add_u32 s83, s83, s41
 s_add_u32 s40, s83, 4096
 s_mul_i32 s39, s32, 6144
 s_add_u32 m0, s39, 38912
 s_nop 0
 buffer_load_dwordx4 v1, s[12:15], s40 offen offset:0 lds
 v_mfma_f32_16x16x32_bf16 v[48:51], v[160:163], a[248:251], v[48:51]
 buffer_load_dwordx4 v1, s[12:15], s40 offen offset:1024 lds
 v_mfma_f32_16x16x32_bf16 v[84:87], v[160:163], a[252:255], v[84:87]
 s_add_u32 s81, s80, 2
 s_and_b32 s82, s81, 15
 s_lshr_b32 s83, s82, 1
 s_lshl_b32 s83, s83, 2
 s_and_b32 s82, s82, 1
 s_add_u32 s83, s83, s82
 s_lshr_b32 s82, s81, 4
 s_lshl_b32 s82, s82, 1
 s_add_u32 s83, s83, s82
 s_add_u32 s83, s83, 64
 s_add_u32 s82, s81, 104
 s_cmp_ge_u32 s81, 32
 s_cselect_b32 s83, s82, s83
 s_mul_i32 s83, s83, 36864
 s_add_u32 s83, s83, s41
 s_add_u32 s40, s83, 4096
 s_mul_i32 s39, s32, 6144
 s_add_u32 m0, s39, 40960
 s_nop 0
 buffer_load_dwordx4 v1, s[12:15], s40 offen offset:0 lds
 v_mfma_f32_16x16x32_bf16 v[52:55], v[164:167], a[248:251], v[52:55]
 buffer_load_dwordx4 v1, s[12:15], s40 offen offset:1024 lds
 v_mfma_f32_16x16x32_bf16 v[88:91], v[164:167], a[252:255], v[88:91]
 s_waitcnt lgkmcnt(0)
 s_waitcnt vmcnt(12)
 v_mfma_f32_16x16x32_bf16 v[64:67], v[112:115], v[8:11], v[64:67]
 ds_read_b128 v[140:143], v2 offset:7168
 v_mfma_f32_16x16x32_bf16 v[100:103], v[112:115], v[12:15], v[100:103]
 v_mfma_f32_16x16x32_bf16 v[68:71], v[116:119], v[8:11], v[68:71]
 ds_read_b128 v[144:147], v2 offset:8192
 v_mfma_f32_16x16x32_bf16 v[104:107], v[116:119], v[12:15], v[104:107]
 v_mfma_f32_16x16x32_bf16 v[72:75], v[120:123], v[8:11], v[72:75]
 ds_read_b128 v[148:151], v2 offset:9216
 v_mfma_f32_16x16x32_bf16 v[108:111], v[120:123], v[12:15], v[108:111]
 v_mfma_f32_16x16x32_bf16 v[40:43], v[124:127], v[8:11], v[40:43]
 ds_read_b128 v[152:155], v2 offset:10240
 v_mfma_f32_16x16x32_bf16 v[76:79], v[124:127], v[12:15], v[76:79]
 v_mfma_f32_16x16x32_bf16 v[44:47], v[128:131], v[8:11], v[44:47]
 ds_read_b128 v[156:159], v2 offset:11264
 v_mfma_f32_16x16x32_bf16 v[80:83], v[128:131], v[12:15], v[80:83]
 v_mfma_f32_16x16x32_bf16 v[48:51], v[132:135], v[8:11], v[48:51]
 ds_read_b128 v[160:163], v2 offset:12288
 v_mfma_f32_16x16x32_bf16 v[84:87], v[132:135], v[12:15], v[84:87]
 v_mfma_f32_16x16x32_bf16 v[52:55], v[136:139], v[8:11], v[52:55]
 ds_read_b128 v[164:167], v2 offset:13312
 v_mfma_f32_16x16x32_bf16 v[88:91], v[136:139], v[12:15], v[88:91]
 s_waitcnt lgkmcnt(0)
 s_waitcnt vmcnt(10)
 v_mfma_f32_16x16x32_bf16 v[64:67], v[140:143], v[16:19], v[64:67]
 ds_read_b128 v[112:115], v2 offset:14336
 v_mfma_f32_16x16x32_bf16 v[100:103], v[140:143], v[20:23], v[100:103]
 v_mfma_f32_16x16x32_bf16 v[68:71], v[144:147], v[16:19], v[68:71]
 ds_read_b128 v[116:119], v2 offset:15360
 v_mfma_f32_16x16x32_bf16 v[104:107], v[144:147], v[20:23], v[104:107]
 v_mfma_f32_16x16x32_bf16 v[72:75], v[148:151], v[16:19], v[72:75]
 ds_read_b128 v[120:123], v2 offset:16384
 v_mfma_f32_16x16x32_bf16 v[108:111], v[148:151], v[20:23], v[108:111]
 v_mfma_f32_16x16x32_bf16 v[40:43], v[152:155], v[16:19], v[40:43]
 ds_read_b128 v[124:127], v2 offset:17408
 v_mfma_f32_16x16x32_bf16 v[76:79], v[152:155], v[20:23], v[76:79]
 v_mfma_f32_16x16x32_bf16 v[44:47], v[156:159], v[16:19], v[44:47]
 ds_read_b128 v[128:131], v2 offset:18432
 v_mfma_f32_16x16x32_bf16 v[80:83], v[156:159], v[20:23], v[80:83]
 v_mfma_f32_16x16x32_bf16 v[48:51], v[160:163], v[16:19], v[48:51]
 ds_read_b128 v[132:135], v2 offset:19456
 v_mfma_f32_16x16x32_bf16 v[84:87], v[160:163], v[20:23], v[84:87]
 v_mfma_f32_16x16x32_bf16 v[52:55], v[164:167], v[16:19], v[52:55]
 ds_read_b128 v[136:139], v2 offset:20480
 v_mfma_f32_16x16x32_bf16 v[88:91], v[164:167], v[20:23], v[88:91]
 s_waitcnt lgkmcnt(0)
 s_waitcnt vmcnt(8)
 v_mfma_f32_16x16x32_bf16 v[64:67], v[112:115], v[24:27], v[64:67]
 ds_read_b128 v[140:143], v2 offset:21504
 v_mfma_f32_16x16x32_bf16 v[100:103], v[112:115], v[28:31], v[100:103]
 v_mfma_f32_16x16x32_bf16 v[68:71], v[116:119], v[24:27], v[68:71]
 ds_read_b128 v[144:147], v2 offset:22528
 v_mfma_f32_16x16x32_bf16 v[104:107], v[116:119], v[28:31], v[104:107]
 v_mfma_f32_16x16x32_bf16 v[72:75], v[120:123], v[24:27], v[72:75]
 ds_read_b128 v[148:151], v2 offset:23552
 v_mfma_f32_16x16x32_bf16 v[108:111], v[120:123], v[28:31], v[108:111]
 v_mfma_f32_16x16x32_bf16 v[40:43], v[124:127], v[24:27], v[40:43]
 ds_read_b128 v[152:155], v2 offset:24576
 v_mfma_f32_16x16x32_bf16 v[76:79], v[124:127], v[28:31], v[76:79]
 v_mfma_f32_16x16x32_bf16 v[44:47], v[128:131], v[24:27], v[44:47]
 ds_read_b128 v[156:159], v2 offset:25600
 v_mfma_f32_16x16x32_bf16 v[80:83], v[128:131], v[28:31], v[80:83]
 v_mfma_f32_16x16x32_bf16 v[48:51], v[132:135], v[24:27], v[48:51]
 ds_read_b128 v[160:163], v2 offset:26624
 v_mfma_f32_16x16x32_bf16 v[84:87], v[132:135], v[28:31], v[84:87]
 v_mfma_f32_16x16x32_bf16 v[52:55], v[136:139], v[24:27], v[52:55]
 ds_read_b128 v[164:167], v2 offset:27648
 v_mfma_f32_16x16x32_bf16 v[88:91], v[136:139], v[28:31], v[88:91]
 s_waitcnt lgkmcnt(0)
 s_waitcnt vmcnt(0)
 s_barrier
 s_waitcnt vmcnt(6)
 v_mfma_f32_16x16x32_bf16 v[64:67], v[140:143], v[32:35], v[64:67]
 ds_read_b128 v[112:115], v3 offset:0
 v_mfma_f32_16x16x32_bf16 v[100:103], v[140:143], v[36:39], v[100:103]
 ds_read_b128 v[116:119], v3 offset:1024
 v_mfma_f32_16x16x32_bf16 v[68:71], v[144:147], v[32:35], v[68:71]
 v_mfma_f32_16x16x32_bf16 v[104:107], v[144:147], v[36:39], v[104:107]
 s_add_u32 s81, s80, 12
 s_and_b32 s82, s81, 15
 s_lshr_b32 s83, s82, 1
 s_lshl_b32 s83, s83, 2
 s_and_b32 s82, s82, 1
 s_add_u32 s83, s83, s82
 s_lshr_b32 s82, s81, 4
 s_lshl_b32 s82, s82, 1
 s_add_u32 s83, s83, s82
 s_add_u32 s83, s83, 64
 s_add_u32 s82, s81, 104
 s_cmp_ge_u32 s81, 32
 s_cselect_b32 s83, s82, s83
 s_mul_i32 s83, s83, 36864
 s_add_u32 s83, s83, s41
 s_add_u32 s40, s83, 4096
 s_mul_i32 s39, s32, 6144
 s_add_u32 m0, s39, 73728
 s_nop 0
 buffer_load_dwordx4 v1, s[12:15], s40 offen offset:0 lds
 v_mfma_f32_16x16x32_bf16 v[72:75], v[148:151], v[32:35], v[72:75]
 v_mfma_f32_16x16x32_bf16 v[108:111], v[148:151], v[36:39], v[108:111]
 buffer_load_dwordx4 v1, s[12:15], s40 offen offset:1024 lds
 v_mfma_f32_16x16x32_bf16 v[40:43], v[152:155], v[32:35], v[40:43]
 v_mfma_f32_16x16x32_bf16 v[76:79], v[152:155], v[36:39], v[76:79]
 s_add_u32 s81, s80, 13
 s_and_b32 s82, s81, 15
 s_lshr_b32 s83, s82, 1
 s_lshl_b32 s83, s83, 2
 s_and_b32 s82, s82, 1
 s_add_u32 s83, s83, s82
 s_lshr_b32 s82, s81, 4
 s_lshl_b32 s82, s82, 1
 s_add_u32 s83, s83, s82
 s_add_u32 s83, s83, 64
 s_add_u32 s82, s81, 104
 s_cmp_ge_u32 s81, 32
 s_cselect_b32 s83, s82, s83
 s_mul_i32 s83, s83, 36864
 s_add_u32 s83, s83, s41
 s_add_u32 s40, s83, 4096
 s_mul_i32 s39, s32, 6144
 s_add_u32 m0, s39, 75776
 s_nop 0
 buffer_load_dwordx4 v1, s[12:15], s40 offen offset:0 lds
 v_mfma_f32_16x16x32_bf16 v[44:47], v[156:159], v[32:35], v[44:47]
 buffer_load_dwordx4 v1, s[12:15], s40 offen offset:1024 lds
 v_mfma_f32_16x16x32_bf16 v[80:83], v[156:159], v[36:39], v[80:83]
 v_mfma_f32_16x16x32_bf16 v[48:51], v[160:163], v[32:35], v[48:51]
 s_add_u32 s81, s80, 14
 s_and_b32 s82, s81, 15
 s_lshr_b32 s83, s82, 1
 s_lshl_b32 s83, s83, 2
 s_and_b32 s82, s82, 1
 s_add_u32 s83, s83, s82
 s_lshr_b32 s82, s81, 4
 s_lshl_b32 s82, s82, 1
 s_add_u32 s83, s83, s82
 s_add_u32 s83, s83, 64
 s_add_u32 s82, s81, 104
 s_cmp_ge_u32 s81, 32
 s_cselect_b32 s83, s82, s83
 s_mul_i32 s83, s83, 36864
 s_add_u32 s83, s83, s41
 s_add_u32 s40, s83, 4096
 s_mul_i32 s39, s32, 6144
 s_add_u32 m0, s39, 77824
 s_nop 0
 buffer_load_dwordx4 v1, s[12:15], s40 offen offset:0 lds
 v_mfma_f32_16x16x32_bf16 v[84:87], v[160:163], v[36:39], v[84:87]
 v_mfma_f32_16x16x32_bf16 v[52:55], v[164:167], v[32:35], v[52:55]
 buffer_load_dwordx4 v1, s[12:15], s40 offen offset:1024 lds
 v_mfma_f32_16x16x32_bf16 v[88:91], v[164:167], v[36:39], v[88:91]
 s_waitcnt lgkmcnt(0)
 v_mfma_f32_16x16x32_bf16 v[56:59], v[112:115], a[0:3], 0
 ds_read_b128 v[124:127], v3 offset:2048
 ds_read_b128 v[128:131], v3 offset:3072
 ds_read_b128 v[136:139], v3 offset:4096
 v_mfma_f32_16x16x32_bf16 v[92:95], v[112:115], a[4:7], 0
 ds_read_b128 v[140:143], v3 offset:5120
 ds_read_b128 v[148:151], v3 offset:6144
 v_mfma_f32_16x16x32_bf16 v[60:63], v[116:119], a[0:3], 0
 ds_read_b128 v[152:155], v3 offset:7168
 v_lshrrev_b32 v224, 4, v0
 v_mfma_f32_16x16x32_bf16 v[96:99], v[116:119], a[4:7], 0
 v_lshlrev_b32 v224, 4, v224
 s_add_u32 s39, s58, 0
 s_and_b32 s40, s39, 1
 s_lshl_b32 s40, s40, 3
 s_lshr_b32 s39, s39, 1
 s_lshl_b32 s39, s39, 10
 s_add_u32 s39, s39, s40
 s_mul_i32 s40, s57, 18432
 s_add_u32 s39, s39, s40
 buffer_load_dwordx2 v[200:201], v1, s[44:47], s39 offen sc1
 s_add_u32 s39, s39, 18432
 s_waitcnt lgkmcnt(4)
 v_mfma_f32_16x16x32_bf16 v[56:59], v[124:127], a[8:11], v[56:59]
 v_cvt_pk_bf16_f32 v184, v64, v65
 v_cvt_pk_bf16_f32 v185, v66, v67
 v_cvt_pk_bf16_f32 v186, v68, v69
 v_cvt_pk_bf16_f32 v187, v70, v71
 v_mfma_f32_16x16x32_bf16 v[92:95], v[124:127], a[12:15], v[92:95]
 v_cvt_pk_bf16_f32 v192, v72, v73
 v_cvt_pk_bf16_f32 v193, v74, v75
 v_cvt_pk_bf16_f32 v188, v100, v101
 v_mfma_f32_16x16x32_bf16 v[60:63], v[128:131], a[8:11], v[60:63]
 v_cvt_pk_bf16_f32 v189, v102, v103
 ds_read_b128 v[112:115], v3 offset:8192
 ds_read_b128 v[116:119], v3 offset:9216
 v_mfma_f32_16x16x32_bf16 v[96:99], v[128:131], a[12:15], v[96:99]
 buffer_load_dwordx2 v[202:203], v1, s[44:47], s39 offen sc1
 s_add_u32 s39, s58, 0
 s_lshl_b32 s39, s39, 6
 s_add_u32 s39, s39, 11520
 buffer_load_dwordx4 v[212:215], v224, s[48:51], s39 offen
 s_add_u32 s39, s58, 1
 s_and_b32 s40, s39, 1
 s_lshl_b32 s40, s40, 3
 s_lshr_b32 s39, s39, 1
 s_lshl_b32 s39, s39, 10
 s_add_u32 s39, s39, s40
 s_mul_i32 s40, s57, 18432
 s_add_u32 s39, s39, s40
 buffer_load_dwordx2 v[204:205], v1, s[44:47], s39 offen sc1
 s_add_u32 s39, s39, 18432
 s_waitcnt lgkmcnt(4)
 v_mfma_f32_16x16x32_bf16 v[56:59], v[136:139], a[16:19], v[56:59]
 v_cvt_pk_bf16_f32 v190, v104, v105
 v_cvt_pk_bf16_f32 v191, v106, v107
 v_cvt_pk_bf16_f32 v194, v108, v109
 v_mfma_f32_16x16x32_bf16 v[92:95], v[136:139], a[20:23], v[92:95]
 v_cvt_pk_bf16_f32 v195, v110, v111
 s_lshl_b32 s43, s42, 2
 s_add_u32 s43, s43, 3
 s_lshl_b32 s43, s43, 2
 s_add_u32 s43, s43, 2
 s_lshl_b32 s43, s43, 2
 s_add_u32 s43, s43, s32
 s_mul_i32 s43, s43, 3072
 buffer_store_dwordx4 v[184:187], v1, s[24:27], s43 offen offset:0 sc1
 buffer_store_dwordx4 v[188:191], v1, s[24:27], s43 offen offset:1024 sc1
 v_mfma_f32_16x16x32_bf16 v[60:63], v[140:143], a[16:19], v[60:63]
 buffer_store_dwordx4 v[192:195], v1, s[24:27], s43 offen offset:2048 sc1
 v_cvt_pk_bf16_f32 v168, v40, v41
 ds_read_b128 v[124:127], v3 offset:10240
 v_mfma_f32_16x16x32_bf16 v[96:99], v[140:143], a[20:23], v[96:99]
 ds_read_b128 v[128:131], v3 offset:11264
 buffer_load_dwordx2 v[206:207], v1, s[44:47], s39 offen sc1
 s_add_u32 s39, s58, 1
 s_lshl_b32 s39, s39, 6
 s_add_u32 s39, s39, 11520
 buffer_load_dwordx4 v[216:219], v224, s[48:51], s39 offen
 s_waitcnt lgkmcnt(4)
 v_mfma_f32_16x16x32_bf16 v[56:59], v[148:151], a[24:27], v[56:59]
 v_cvt_pk_bf16_f32 v169, v42, v43
 v_cvt_pk_bf16_f32 v170, v44, v45
 v_cvt_pk_bf16_f32 v171, v46, v47
 v_mfma_f32_16x16x32_bf16 v[92:95], v[148:151], a[28:31], v[92:95]
 v_cvt_pk_bf16_f32 v172, v76, v77
 v_cvt_pk_bf16_f32 v173, v78, v79
 v_mfma_f32_16x16x32_bf16 v[60:63], v[152:155], a[24:27], v[60:63]
 v_cvt_pk_bf16_f32 v174, v80, v81
 v_cvt_pk_bf16_f32 v175, v82, v83
 s_lshl_b32 s43, s42, 2
 s_add_u32 s43, s43, 0
 s_lshl_b32 s43, s43, 2
 s_add_u32 s43, s43, 2
 s_lshl_b32 s43, s43, 2
 s_add_u32 s43, s43, s32
 s_mul_i32 s43, s43, 3072
 buffer_store_dwordx4 v[168:171], v1, s[24:27], s43 offen offset:0 sc1
 v_mfma_f32_16x16x32_bf16 v[96:99], v[152:155], a[28:31], v[96:99]
 ds_read_b128 v[136:139], v3 offset:12288
 ds_read_b128 v[140:143], v3 offset:13312
 s_waitcnt lgkmcnt(4)
 v_mfma_f32_16x16x32_bf16 v[56:59], v[112:115], a[32:35], v[56:59]
 buffer_store_dwordx4 v[172:175], v1, s[24:27], s43 offen offset:1024 sc1
 v_cvt_pk_bf16_f32 v176, v48, v49
 v_cvt_pk_bf16_f32 v177, v50, v51
 v_mfma_f32_16x16x32_bf16 v[92:95], v[112:115], a[36:39], v[92:95]
 v_cvt_pk_bf16_f32 v178, v52, v53
 v_cvt_pk_bf16_f32 v179, v54, v55
 v_mfma_f32_16x16x32_bf16 v[60:63], v[116:119], a[32:35], v[60:63]
 v_cvt_pk_bf16_f32 v180, v84, v85
 v_cvt_pk_bf16_f32 v181, v86, v87
 v_cvt_pk_bf16_f32 v182, v88, v89
 v_mfma_f32_16x16x32_bf16 v[96:99], v[116:119], a[36:39], v[96:99]
 ds_read_b128 v[148:151], v3 offset:14336
 ds_read_b128 v[152:155], v3 offset:15360
 s_waitcnt lgkmcnt(4)
 v_mfma_f32_16x16x32_bf16 v[56:59], v[124:127], a[40:43], v[56:59]
 v_cvt_pk_bf16_f32 v183, v90, v91
 s_lshl_b32 s43, s42, 2
 s_add_u32 s43, s43, 1
 s_lshl_b32 s43, s43, 2
 s_add_u32 s43, s43, 2
 s_lshl_b32 s43, s43, 2
 s_add_u32 s43, s43, s32
 s_mul_i32 s43, s43, 3072
 buffer_store_dwordx4 v[176:179], v1, s[24:27], s43 offen offset:0 sc1
 v_mfma_f32_16x16x32_bf16 v[92:95], v[124:127], a[44:47], v[92:95]
 buffer_store_dwordx4 v[180:183], v1, s[24:27], s43 offen offset:1024 sc1
 v_mfma_f32_16x16x32_bf16 v[60:63], v[128:131], a[40:43], v[60:63]
 ds_read_b128 v[112:115], v3 offset:16384
 v_mfma_f32_16x16x32_bf16 v[96:99], v[128:131], a[44:47], v[96:99]
 ds_read_b128 v[116:119], v3 offset:17408
 s_waitcnt lgkmcnt(4)
 v_mfma_f32_16x16x32_bf16 v[56:59], v[136:139], a[48:51], v[56:59]
 ds_read_b128 v[124:127], v3 offset:18432
 v_mfma_f32_16x16x32_bf16 v[92:95], v[136:139], a[52:55], v[92:95]
 v_mfma_f32_16x16x32_bf16 v[60:63], v[140:143], a[48:51], v[60:63]
 ds_read_b128 v[128:131], v3 offset:19456
 v_mfma_f32_16x16x32_bf16 v[96:99], v[140:143], a[52:55], v[96:99]
 s_waitcnt lgkmcnt(4)
 v_mfma_f32_16x16x32_bf16 v[56:59], v[148:151], a[56:59], v[56:59]
 ds_read_b128 v[136:139], v3 offset:20480
 v_mfma_f32_16x16x32_bf16 v[92:95], v[148:151], a[60:63], v[92:95]
 v_mfma_f32_16x16x32_bf16 v[60:63], v[152:155], a[56:59], v[60:63]
 ds_read_b128 v[140:143], v3 offset:21504
 v_mfma_f32_16x16x32_bf16 v[96:99], v[152:155], a[60:63], v[96:99]
 s_waitcnt lgkmcnt(4)
 v_mfma_f32_16x16x32_bf16 v[56:59], v[112:115], a[64:67], v[56:59]
 ds_read_b128 v[148:151], v3 offset:22528
 v_mfma_f32_16x16x32_bf16 v[92:95], v[112:115], a[68:71], v[92:95]
 v_mfma_f32_16x16x32_bf16 v[60:63], v[116:119], a[64:67], v[60:63]
 ds_read_b128 v[152:155], v3 offset:23552
 v_mfma_f32_16x16x32_bf16 v[96:99], v[116:119], a[68:71], v[96:99]
 s_waitcnt lgkmcnt(0)
 s_waitcnt vmcnt(13)
 s_barrier
 v_mfma_f32_16x16x32_bf16 v[56:59], v[124:127], a[72:75], v[56:59]
 ds_read_b128 v[112:115], v4 offset:0
 ds_read_b128 v[116:119], v4 offset:1024
 v_mfma_f32_16x16x32_bf16 v[92:95], v[124:127], a[76:79], v[92:95]
 s_add_u32 s81, s80, 24
 s_and_b32 s82, s81, 15
 s_lshr_b32 s83, s82, 1
 s_lshl_b32 s83, s83, 2
 s_and_b32 s82, s82, 1
 s_add_u32 s83, s83, s82
 s_lshr_b32 s82, s81, 4
 s_lshl_b32 s82, s82, 1
 s_add_u32 s83, s83, s82
 s_add_u32 s83, s83, 64
 s_add_u32 s82, s81, 104
 s_cmp_ge_u32 s81, 32
 s_cselect_b32 s83, s82, s83
 s_mul_i32 s83, s83, 36864
 s_add_u32 s83, s83, s41
 s_add_u32 s40, s83, 4096
 s_mul_i32 s39, s32, 6144
 s_add_u32 m0, s39, 110592
 s_nop 0
 buffer_load_dwordx4 v1, s[12:15], s40 offen offset:0 lds
 v_mfma_f32_16x16x32_bf16 v[60:63], v[128:131], a[72:75], v[60:63]
 buffer_load_dwordx4 v1, s[12:15], s40 offen offset:1024 lds
 v_mfma_f32_16x16x32_bf16 v[96:99], v[128:131], a[76:79], v[96:99]
 s_add_u32 s81, s80, 25
 s_and_b32 s82, s81, 15
 s_lshr_b32 s83, s82, 1
 s_lshl_b32 s83, s83, 2
 s_and_b32 s82, s82, 1
 s_add_u32 s83, s83, s82
 s_lshr_b32 s82, s81, 4
 s_lshl_b32 s82, s82, 1
 s_add_u32 s83, s83, s82
 s_add_u32 s83, s83, 64
 s_add_u32 s82, s81, 104
 s_cmp_ge_u32 s81, 32
 s_cselect_b32 s83, s82, s83
 s_mul_i32 s83, s83, 36864
 s_add_u32 s83, s83, s41
 s_add_u32 s40, s83, 4096
 s_mul_i32 s39, s32, 6144
 s_add_u32 m0, s39, 112640
 s_nop 0
 buffer_load_dwordx4 v1, s[12:15], s40 offen offset:0 lds
 s_waitcnt lgkmcnt(2)
 v_mfma_f32_16x16x32_bf16 v[56:59], v[136:139], a[80:83], v[56:59]
 ds_read_b128 v[124:127], v4 offset:2048
 ds_read_b128 v[128:131], v4 offset:3072
 v_mfma_f32_16x16x32_bf16 v[92:95], v[136:139], a[84:87], v[92:95]
 buffer_load_dwordx4 v1, s[12:15], s40 offen offset:1024 lds
 v_mfma_f32_16x16x32_bf16 v[60:63], v[140:143], a[80:83], v[60:63]
 s_add_u32 s81, s80, 26
 s_and_b32 s82, s81, 15
 s_lshr_b32 s83, s82, 1
 s_lshl_b32 s83, s83, 2
 s_and_b32 s82, s82, 1
 s_add_u32 s83, s83, s82
 s_lshr_b32 s82, s81, 4
 s_lshl_b32 s82, s82, 1
 s_add_u32 s83, s83, s82
 s_add_u32 s83, s83, 64
 s_add_u32 s82, s81, 104
 s_cmp_ge_u32 s81, 32
 s_cselect_b32 s83, s82, s83
 s_mul_i32 s83, s83, 36864
 s_add_u32 s83, s83, s41
 s_add_u32 s40, s83, 4096
 s_mul_i32 s39, s32, 6144
 s_add_u32 m0, s39, 114688
 s_nop 0
 buffer_load_dwordx4 v1, s[12:15], s40 offen offset:0 lds
 v_mfma_f32_16x16x32_bf16 v[96:99], v[140:143], a[84:87], v[96:99]
 buffer_load_dwordx4 v1, s[12:15], s40 offen offset:1024 lds
 s_waitcnt lgkmcnt(4)
 v_mfma_f32_16x16x32_bf16 v[56:59], v[148:151], a[88:91], v[56:59]
 ds_read_b128 v[136:139], v4 offset:4096
 v_mfma_f32_16x16x32_bf16 v[92:95], v[148:151], a[92:95], v[92:95]
 v_mfma_f32_16x16x32_bf16 v[60:63], v[152:155], a[88:91], v[60:63]
 ds_read_b128 v[140:143], v4 offset:5120
 v_mfma_f32_16x16x32_bf16 v[96:99], v[152:155], a[92:95], v[96:99]
 s_waitcnt lgkmcnt(4)
 v_mfma_f32_16x16x32_bf16 v[56:59], v[112:115], a[96:99], v[56:59]
 ds_read_b128 v[148:151], v4 offset:6144
 v_mfma_f32_16x16x32_bf16 v[92:95], v[112:115], a[100:103], v[92:95]
 v_mfma_f32_16x16x32_bf16 v[60:63], v[116:119], a[96:99], v[60:63]
 ds_read_b128 v[152:155], v4 offset:7168
 v_mfma_f32_16x16x32_bf16 v[96:99], v[116:119], a[100:103], v[96:99]
 s_waitcnt lgkmcnt(4)
 v_mfma_f32_16x16x32_bf16 v[56:59], v[124:127], a[104:107], v[56:59]
 ds_read_b128 v[112:115], v4 offset:8192
 v_mfma_f32_16x16x32_bf16 v[92:95], v[124:127], a[108:111], v[92:95]
 v_mfma_f32_16x16x32_bf16 v[60:63], v[128:131], a[104:107], v[60:63]
 ds_read_b128 v[116:119], v4 offset:9216
 v_mfma_f32_16x16x32_bf16 v[96:99], v[128:131], a[108:111], v[96:99]
 s_waitcnt lgkmcnt(4)
 v_mfma_f32_16x16x32_bf16 v[56:59], v[136:139], a[112:115], v[56:59]
 ds_read_b128 v[124:127], v4 offset:10240
 v_mfma_f32_16x16x32_bf16 v[92:95], v[136:139], a[116:119], v[92:95]
 v_mfma_f32_16x16x32_bf16 v[60:63], v[140:143], a[112:115], v[60:63]
 ds_read_b128 v[128:131], v4 offset:11264
 v_mfma_f32_16x16x32_bf16 v[96:99], v[140:143], a[116:119], v[96:99]
 s_waitcnt lgkmcnt(4)
 v_mfma_f32_16x16x32_bf16 v[56:59], v[148:151], a[120:123], v[56:59]
 ds_read_b128 v[136:139], v4 offset:12288
 v_mfma_f32_16x16x32_bf16 v[92:95], v[148:151], a[124:127], v[92:95]
 v_mfma_f32_16x16x32_bf16 v[60:63], v[152:155], a[120:123], v[60:63]
 ds_read_b128 v[140:143], v4 offset:13312
 v_mfma_f32_16x16x32_bf16 v[96:99], v[152:155], a[124:127], v[96:99]
 s_waitcnt lgkmcnt(4)
 v_mfma_f32_16x16x32_bf16 v[56:59], v[112:115], a[128:131], v[56:59]
 ds_read_b128 v[148:151], v4 offset:14336
 v_mfma_f32_16x16x32_bf16 v[92:95], v[112:115], a[132:135], v[92:95]
 v_mfma_f32_16x16x32_bf16 v[60:63], v[116:119], a[128:131], v[60:63]
 ds_read_b128 v[152:155], v4 offset:15360
 v_mfma_f32_16x16x32_bf16 v[96:99], v[116:119], a[132:135], v[96:99]
 s_waitcnt lgkmcnt(4)
 v_mfma_f32_16x16x32_bf16 v[56:59], v[124:127], a[136:139], v[56:59]
 ds_read_b128 v[112:115], v4 offset:16384
 v_mfma_f32_16x16x32_bf16 v[92:95], v[124:127], a[140:143], v[92:95]
 v_mfma_f32_16x16x32_bf16 v[60:63], v[128:131], a[136:139], v[60:63]
 ds_read_b128 v[116:119], v4 offset:17408
 v_mfma_f32_16x16x32_bf16 v[96:99], v[128:131], a[140:143], v[96:99]
 s_waitcnt lgkmcnt(4)
 v_mfma_f32_16x16x32_bf16 v[56:59], v[136:139], a[144:147], v[56:59]
 ds_read_b128 v[124:127], v4 offset:18432
 v_mfma_f32_16x16x32_bf16 v[92:95], v[136:139], a[148:151], v[92:95]
 v_mfma_f32_16x16x32_bf16 v[60:63], v[140:143], a[144:147], v[60:63]
 ds_read_b128 v[128:131], v4 offset:19456
 v_mfma_f32_16x16x32_bf16 v[96:99], v[140:143], a[148:151], v[96:99]
 s_waitcnt lgkmcnt(4)
 v_mfma_f32_16x16x32_bf16 v[56:59], v[148:151], a[152:155], v[56:59]
 ds_read_b128 v[136:139], v4 offset:20480
 v_mfma_f32_16x16x32_bf16 v[92:95], v[148:151], a[156:159], v[92:95]
 v_mfma_f32_16x16x32_bf16 v[60:63], v[152:155], a[152:155], v[60:63]
 ds_read_b128 v[140:143], v4 offset:21504
 v_mfma_f32_16x16x32_bf16 v[96:99], v[152:155], a[156:159], v[96:99]
 s_waitcnt lgkmcnt(4)
 v_mfma_f32_16x16x32_bf16 v[56:59], v[112:115], a[160:163], v[56:59]
 ds_read_b128 v[148:151], v4 offset:22528
 v_mfma_f32_16x16x32_bf16 v[92:95], v[112:115], a[164:167], v[92:95]
 v_mfma_f32_16x16x32_bf16 v[60:63], v[116:119], a[160:163], v[60:63]
 ds_read_b128 v[152:155], v4 offset:23552
 v_mfma_f32_16x16x32_bf16 v[96:99], v[116:119], a[164:167], v[96:99]
 s_waitcnt lgkmcnt(0)
 s_waitcnt vmcnt(0)
 s_barrier
 v_mfma_f32_16x16x32_bf16 v[56:59], v[124:127], a[168:171], v[56:59]
 ds_read_b128 v[112:115], v5 offset:0
 v_mfma_f32_16x16x32_bf16 v[92:95], v[124:127], a[172:175], v[92:95]
 v_mfma_f32_16x16x32_bf16 v[60:63], v[128:131], a[168:171], v[60:63]
 ds_read_b128 v[116:119], v5 offset:1024
 v_mfma_f32_16x16x32_bf16 v[96:99], v[128:131], a[172:175], v[96:99]
 s_waitcnt lgkmcnt(2)
 v_mfma_f32_16x16x32_bf16 v[56:59], v[136:139], a[176:179], v[56:59]
 ds_read_b128 v[124:127], v5 offset:2048
 v_mfma_f32_16x16x32_bf16 v[92:95], v[136:139], a[180:183], v[92:95]
 v_mfma_f32_16x16x32_bf16 v[60:63], v[140:143], a[176:179], v[60:63]
 ds_read_b128 v[128:131], v5 offset:3072
 v_mfma_f32_16x16x32_bf16 v[96:99], v[140:143], a[180:183], v[96:99]
 s_waitcnt lgkmcnt(4)
 v_mfma_f32_16x16x32_bf16 v[56:59], v[148:151], a[184:187], v[56:59]
 ds_read_b128 v[136:139], v5 offset:4096
 v_mfma_f32_16x16x32_bf16 v[92:95], v[148:151], a[188:191], v[92:95]
 v_mfma_f32_16x16x32_bf16 v[60:63], v[152:155], a[184:187], v[60:63]
 ds_read_b128 v[140:143], v5 offset:5120
 v_mfma_f32_16x16x32_bf16 v[96:99], v[152:155], a[188:191], v[96:99]
 s_waitcnt lgkmcnt(4)
 v_mfma_f32_16x16x32_bf16 v[56:59], v[112:115], a[192:195], v[56:59]
 ds_read_b128 v[148:151], v5 offset:6144
 v_mfma_f32_16x16x32_bf16 v[92:95], v[112:115], a[196:199], v[92:95]
 v_mfma_f32_16x16x32_bf16 v[60:63], v[116:119], a[192:195], v[60:63]
 ds_read_b128 v[152:155], v5 offset:7168
 v_mfma_f32_16x16x32_bf16 v[96:99], v[116:119], a[196:199], v[96:99]
 s_waitcnt lgkmcnt(4)
 v_mfma_f32_16x16x32_bf16 v[56:59], v[124:127], a[200:203], v[56:59]
 ds_read_b128 v[112:115], v5 offset:8192
 v_mfma_f32_16x16x32_bf16 v[92:95], v[124:127], a[204:207], v[92:95]
 v_mfma_f32_16x16x32_bf16 v[60:63], v[128:131], a[200:203], v[60:63]
 ds_read_b128 v[116:119], v5 offset:9216
 v_mfma_f32_16x16x32_bf16 v[96:99], v[128:131], a[204:207], v[96:99]
 s_waitcnt lgkmcnt(4)
 s_waitcnt vmcnt(6)
 s_barrier
 s_cmp_eq_u32 s32, 0
 s_cbranch_scc0 L_g2_nosig2
 v_mov_b32 v225, 1
 s_mov_b64 s[76:77], exec
 s_mov_b64 exec, 1
 buffer_atomic_add v225, v6, s[28:31], 0 offen sc1
 s_mov_b64 exec, s[76:77]
L_g2_nosig2:
 s_nop 0
 s_nop 2
 v_mfma_f32_16x16x32_bf16 v[56:59], v[136:139], a[208:211], v[56:59]
 ds_read_b128 v[124:127], v5 offset:10240
 v_mfma_f32_16x16x32_bf16 v[92:95], v[136:139], a[212:215], v[92:95]
 v_mfma_f32_16x16x32_bf16 v[60:63], v[140:143], a[208:211], v[60:63]
 ds_read_b128 v[128:131], v5 offset:11264
 v_mfma_f32_16x16x32_bf16 v[96:99], v[140:143], a[212:215], v[96:99]
 s_waitcnt lgkmcnt(4)
 v_mfma_f32_16x16x32_bf16 v[56:59], v[148:151], a[216:219], v[56:59]
 ds_read_b128 v[136:139], v5 offset:12288
 v_mfma_f32_16x16x32_bf16 v[92:95], v[148:151], a[220:223], v[92:95]
 v_mfma_f32_16x16x32_bf16 v[60:63], v[152:155], a[216:219], v[60:63]
 ds_read_b128 v[140:143], v5 offset:13312
 v_mfma_f32_16x16x32_bf16 v[96:99], v[152:155], a[220:223], v[96:99]
 s_waitcnt lgkmcnt(4)
 v_mfma_f32_16x16x32_bf16 v[56:59], v[112:115], a[224:227], v[56:59]
 ds_read_b128 v[148:151], v5 offset:14336
 v_mfma_f32_16x16x32_bf16 v[92:95], v[112:115], a[228:231], v[92:95]
 v_mfma_f32_16x16x32_bf16 v[60:63], v[116:119], a[224:227], v[60:63]
 ds_read_b128 v[152:155], v5 offset:15360
 v_mfma_f32_16x16x32_bf16 v[96:99], v[116:119], a[228:231], v[96:99]
 s_waitcnt lgkmcnt(4)
 v_mfma_f32_16x16x32_bf16 v[56:59], v[124:127], a[232:235], v[56:59]
 ds_read_b128 v[112:115], v5 offset:16384
 v_mfma_f32_16x16x32_bf16 v[92:95], v[124:127], a[236:239], v[92:95]
 v_mfma_f32_16x16x32_bf16 v[60:63], v[128:131], a[232:235], v[60:63]
 ds_read_b128 v[116:119], v5 offset:17408
 v_mfma_f32_16x16x32_bf16 v[96:99], v[128:131], a[236:239], v[96:99]
 s_waitcnt lgkmcnt(4)
 v_mfma_f32_16x16x32_bf16 v[56:59], v[136:139], a[240:243], v[56:59]
 ds_read_b128 v[124:127], v5 offset:18432
 v_mfma_f32_16x16x32_bf16 v[92:95], v[136:139], a[244:247], v[92:95]
 v_mfma_f32_16x16x32_bf16 v[60:63], v[140:143], a[240:243], v[60:63]
 ds_read_b128 v[128:131], v5 offset:19456
 v_mfma_f32_16x16x32_bf16 v[96:99], v[140:143], a[244:247], v[96:99]
 s_waitcnt lgkmcnt(4)
 v_mfma_f32_16x16x32_bf16 v[56:59], v[148:151], a[248:251], v[56:59]
 ds_read_b128 v[136:139], v5 offset:20480
 v_mfma_f32_16x16x32_bf16 v[92:95], v[148:151], a[252:255], v[92:95]
 v_mfma_f32_16x16x32_bf16 v[60:63], v[152:155], a[248:251], v[60:63]
 ds_read_b128 v[140:143], v5 offset:21504
 v_mfma_f32_16x16x32_bf16 v[96:99], v[152:155], a[252:255], v[96:99]
 s_waitcnt lgkmcnt(4)
 v_mfma_f32_16x16x32_bf16 v[56:59], v[112:115], v[8:11], v[56:59]
 ds_read_b128 v[148:151], v5 offset:22528
 v_mfma_f32_16x16x32_bf16 v[92:95], v[112:115], v[12:15], v[92:95]
 v_mfma_f32_16x16x32_bf16 v[60:63], v[116:119], v[8:11], v[60:63]
 ds_read_b128 v[152:155], v5 offset:23552
 v_mfma_f32_16x16x32_bf16 v[96:99], v[116:119], v[12:15], v[96:99]
 s_waitcnt lgkmcnt(4)
 v_mfma_f32_16x16x32_bf16 v[56:59], v[124:127], v[16:19], v[56:59]
 v_mfma_f32_16x16x32_bf16 v[92:95], v[124:127], v[20:23], v[92:95]
 v_mfma_f32_16x16x32_bf16 v[60:63], v[128:131], v[16:19], v[60:63]
 v_mfma_f32_16x16x32_bf16 v[96:99], v[128:131], v[20:23], v[96:99]
 s_waitcnt lgkmcnt(2)
 v_mfma_f32_16x16x32_bf16 v[56:59], v[136:139], v[24:27], v[56:59]
 v_mfma_f32_16x16x32_bf16 v[92:95], v[136:139], v[28:31], v[92:95]
 v_mfma_f32_16x16x32_bf16 v[60:63], v[140:143], v[24:27], v[60:63]
 v_mfma_f32_16x16x32_bf16 v[96:99], v[140:143], v[28:31], v[96:99]
 s_waitcnt lgkmcnt(0)
 v_mfma_f32_16x16x32_bf16 v[56:59], v[148:151], v[32:35], v[56:59]
 v_mfma_f32_16x16x32_bf16 v[92:95], v[148:151], v[36:39], v[92:95]
 v_mfma_f32_16x16x32_bf16 v[60:63], v[152:155], v[32:35], v[60:63]
 v_mfma_f32_16x16x32_bf16 v[96:99], v[152:155], v[36:39], v[96:99]
 s_lshl_b32 s84, s42, 2
 s_add_u32 s84, s84, 2
 s_lshl_b32 s84, s84, 2
 s_add_u32 s84, s84, 0
 s_lshl_b32 s84, s84, 2
 s_add_u32 s84, s84, s32
 s_mul_i32 s84, s84, 3072
 s_lshl_b32 s85, s42, 2
 s_add_u32 s85, s85, 2
 s_lshl_b32 s85, s85, 2
 s_add_u32 s85, s85, 1
 s_lshl_b32 s85, s85, 2
 s_add_u32 s85, s85, s32
 s_mul_i32 s85, s85, 3072
 s_lshl_b32 s86, s42, 2
 s_add_u32 s86, s86, 2
 s_lshl_b32 s86, s86, 2
 s_add_u32 s86, s86, 3
 s_lshl_b32 s86, s86, 2
 s_add_u32 s86, s86, s32
 s_mul_i32 s86, s86, 3072
 s_mul_i32 s40, s32, 3584
 v_and_b32 v2, 15, v0
 v_mul_u32_u24 v2, 112, v2
 v_lshrrev_b32 v3, 4, v0
 v_lshlrev_b32 v3, 3, v3
 v_add_u32 v2, v2, v3
 v_add_u32 v2, s40, v2
 s_cmp_eq_u32 s32, 0
 s_cbranch_scc0 L_g2_met2
 s_mov_b32 s56, 0
 s_mov_b64 s[76:77], exec
 s_mov_b64 exec, 1
L_g2_poll2:
 buffer_load_dword v225, v6, s[28:31], 0 offen sc1
 s_waitcnt vmcnt(0)
 v_readfirstlane_b32 s39, v225
 s_nop 0
 s_cmp_ge_u32 s39, 4
 s_cbranch_scc1 L_g2_met0_2
 s_add_u32 s56, s56, 1
 s_cmp_lt_u32 s56, 0x100000
 s_cbranch_scc0 L_g2_met0_2
 s_sleep 2
 s_branch L_g2_poll2
L_g2_met0_2:
 s_mov_b64 exec, s[76:77]
L_g2_met2:
 s_barrier
 buffer_load_dwordx4 v[112:115], v1, s[24:27], s84 offen offset:0 sc1
 buffer_load_dwordx4 v[116:119], v1, s[24:27], s84 offen offset:1024 sc1
 buffer_load_dwordx4 v[124:127], v1, s[24:27], s85 offen offset:0 sc1
 buffer_load_dwordx4 v[128:131], v1, s[24:27], s85 offen offset:1024 sc1
 buffer_load_dwordx4 v[136:139], v1, s[24:27], s86 offen offset:0 sc1
 buffer_load_dwordx4 v[140:143], v1, s[24:27], s86 offen offset:1024 sc1
 s_mul_i32 s39, s32, 3584
 s_waitcnt vmcnt(0)
 v_lshlrev_b32 v4, 16, v112
 v_and_b32 v5, 0xffff0000, v112
 v_add_f32 v56, v56, v4
 v_add_f32 v57, v57, v5
 v_lshlrev_b32 v4, 16, v113
 v_and_b32 v5, 0xffff0000, v113
 v_add_f32 v58, v58, v4
 v_add_f32 v59, v59, v5
 v_lshlrev_b32 v4, 16, v124
 v_and_b32 v5, 0xffff0000, v124
 v_add_f32 v56, v56, v4
 v_add_f32 v57, v57, v5
 v_lshlrev_b32 v4, 16, v125
 v_and_b32 v5, 0xffff0000, v125
 v_add_f32 v58, v58, v4
 v_add_f32 v59, v59, v5
 v_lshlrev_b32 v4, 16, v136
 v_and_b32 v5, 0xffff0000, v136
 v_add_f32 v56, v56, v4
 v_add_f32 v57, v57, v5
 v_lshlrev_b32 v4, 16, v137
 v_and_b32 v5, 0xffff0000, v137
 v_add_f32 v58, v58, v4
 v_add_f32 v59, v59, v5
 v_lshlrev_b32 v4, 16, v200
 v_and_b32 v5, 0xffff0000, v200
 v_fma_f32 v56, v212, v56, v4
 v_fma_f32 v57, v213, v57, v5
 v_lshlrev_b32 v4, 16, v201
 v_and_b32 v5, 0xffff0000, v201
 v_fma_f32 v58, v214, v58, v4
 v_fma_f32 v59, v215, v59, v5
 v_cvt_pk_bf16_f32 v56, v56, v57
 v_cvt_pk_bf16_f32 v57, v58, v59
 ds_write_b64 v2, v[56:57] offset:0
 v_lshlrev_b32 v4, 16, v114
 v_and_b32 v5, 0xffff0000, v114
 v_add_f32 v60, v60, v4
 v_add_f32 v61, v61, v5
 v_lshlrev_b32 v4, 16, v115
 v_and_b32 v5, 0xffff0000, v115
 v_add_f32 v62, v62, v4
 v_add_f32 v63, v63, v5
 v_lshlrev_b32 v4, 16, v126
 v_and_b32 v5, 0xffff0000, v126
 v_add_f32 v60, v60, v4
 v_add_f32 v61, v61, v5
 v_lshlrev_b32 v4, 16, v127
 v_and_b32 v5, 0xffff0000, v127
 v_add_f32 v62, v62, v4
 v_add_f32 v63, v63, v5
 v_lshlrev_b32 v4, 16, v138
 v_and_b32 v5, 0xffff0000, v138
 v_add_f32 v60, v60, v4
 v_add_f32 v61, v61, v5
 v_lshlrev_b32 v4, 16, v139
 v_and_b32 v5, 0xffff0000, v139
 v_add_f32 v62, v62, v4
 v_add_f32 v63, v63, v5
 v_lshlrev_b32 v4, 16, v204
 v_and_b32 v5, 0xffff0000, v204
 v_fma_f32 v60, v216, v60, v4
 v_fma_f32 v61, v217, v61, v5
 v_lshlrev_b32 v4, 16, v205
 v_and_b32 v5, 0xffff0000, v205
 v_fma_f32 v62, v218, v62, v4
 v_fma_f32 v63, v219, v63, v5
 v_cvt_pk_bf16_f32 v60, v60, v61
 v_cvt_pk_bf16_f32 v61, v62, v63
 ds_write_b64 v2, v[60:61] offset:32
 v_lshlrev_b32 v4, 16, v116
 v_and_b32 v5, 0xffff0000, v116
 v_add_f32 v92, v92, v4
 v_add_f32 v93, v93, v5
 v_lshlrev_b32 v4, 16, v117
 v_and_b32 v5, 0xffff0000, v117
 v_add_f32 v94, v94, v4
 v_add_f32 v95, v95, v5
 v_lshlrev_b32 v4, 16, v128
 v_and_b32 v5, 0xffff0000, v128
 v_add_f32 v92, v92, v4
 v_add_f32 v93, v93, v5
 v_lshlrev_b32 v4, 16, v129
 v_and_b32 v5, 0xffff0000, v129
 v_add_f32 v94, v94, v4
 v_add_f32 v95, v95, v5
 v_lshlrev_b32 v4, 16, v140
 v_and_b32 v5, 0xffff0000, v140
 v_add_f32 v92, v92, v4
 v_add_f32 v93, v93, v5
 v_lshlrev_b32 v4, 16, v141
 v_and_b32 v5, 0xffff0000, v141
 v_add_f32 v94, v94, v4
 v_add_f32 v95, v95, v5
 v_lshlrev_b32 v4, 16, v202
 v_and_b32 v5, 0xffff0000, v202
 v_fma_f32 v92, v212, v92, v4
 v_fma_f32 v93, v213, v93, v5
 v_lshlrev_b32 v4, 16, v203
 v_and_b32 v5, 0xffff0000, v203
 v_fma_f32 v94, v214, v94, v4
 v_fma_f32 v95, v215, v95, v5
 v_cvt_pk_bf16_f32 v92, v92, v93
 v_cvt_pk_bf16_f32 v93, v94, v95
 ds_write_b64 v2, v[92:93] offset:1792
 v_lshlrev_b32 v4, 16, v118
 v_and_b32 v5, 0xffff0000, v118
 v_add_f32 v96, v96, v4
 v_add_f32 v97, v97, v5
 v_lshlrev_b32 v4, 16, v119
 v_and_b32 v5, 0xffff0000, v119
 v_add_f32 v98, v98, v4
 v_add_f32 v99, v99, v5
 v_lshlrev_b32 v4, 16, v130
 v_and_b32 v5, 0xffff0000, v130
 v_add_f32 v96, v96, v4
 v_add_f32 v97, v97, v5
 v_lshlrev_b32 v4, 16, v131
 v_and_b32 v5, 0xffff0000, v131
 v_add_f32 v98, v98, v4
 v_add_f32 v99, v99, v5
 v_lshlrev_b32 v4, 16, v142
 v_and_b32 v5, 0xffff0000, v142
 v_add_f32 v96, v96, v4
 v_add_f32 v97, v97, v5
 v_lshlrev_b32 v4, 16, v143
 v_and_b32 v5, 0xffff0000, v143
 v_add_f32 v98, v98, v4
 v_add_f32 v99, v99, v5
 v_lshlrev_b32 v4, 16, v206
 v_and_b32 v5, 0xffff0000, v206
 v_fma_f32 v96, v216, v96, v4
 v_fma_f32 v97, v217, v97, v5
 v_lshlrev_b32 v4, 16, v207
 v_and_b32 v5, 0xffff0000, v207
 v_fma_f32 v98, v218, v98, v4
 v_fma_f32 v99, v219, v99, v5
 v_cvt_pk_bf16_f32 v96, v96, v97
 v_cvt_pk_bf16_f32 v97, v98, v99
 ds_write_b64 v2, v[96:97] offset:1824
 s_lshl_b32 s40, s57, 4
 s_mul_i32 s40, s40, 1152
 s_lshl_b32 s43, s58, 5
 s_add_u32 s40, s40, s43
 s_waitcnt lgkmcnt(0)
 v_add_u32 v3, 0, v0
 v_mul_u32_u24 v4, 16384, v3
 v_lshrrev_b32 v4, 16, v4
 v_mul_u32_u24 v5, 4, v4
 v_sub_u32 v3, v3, v5
 v_lshlrev_b32 v3, 4, v3
 v_mul_u32_u24 v5, 112, v4
 v_add_u32 v5, v5, v3
 v_add_u32 v5, s39, v5
 ds_read_b128 v[168:171], v5
 v_mul_u32_u24 v4, 1152, v4
 v_add_u32 v226, v4, v3
 v_add_u32 v3, 64, v0
 v_mul_u32_u24 v4, 16384, v3
 v_lshrrev_b32 v4, 16, v4
 v_mul_u32_u24 v5, 4, v4
 v_sub_u32 v3, v3, v5
 v_lshlrev_b32 v3, 4, v3
 v_mul_u32_u24 v5, 112, v4
 v_add_u32 v5, v5, v3
 v_add_u32 v5, s39, v5
 ds_read_b128 v[172:175], v5
 v_mul_u32_u24 v4, 1152, v4
 v_add_u32 v227, v4, v3
 s_waitcnt lgkmcnt(0)
 buffer_store_dwordx4 v[168:171], v226, s[52:55], s40 offen
 buffer_store_dwordx4 v[172:175], v227, s[52:55], s40 offen
 s_branch L_g2a_done
L_g2_v3:
 s_mul_i32 s39, s32, 6144
 s_add_u32 m0, s39, 0
 s_add_u32 s40, s36, 3538944
 buffer_load_dwordx4 v1, s[12:15], s40 offen offset:0 lds
 buffer_load_dwordx4 v1, s[12:15], s40 offen offset:1024 lds
 buffer_load_dwordx4 v1, s[12:15], s40 offen offset:2048 lds
 buffer_load_dwordx4 v1, s[12:15], s40 offen offset:3072 lds
 s_mul_i32 s39, s32, 6144
 s_add_u32 m0, s39, 4096
 s_add_u32 s40, s36, 3543040
 buffer_load_dwordx4 v1, s[12:15], s40 offen offset:0 lds
 buffer_load_dwordx4 v1, s[12:15], s40 offen offset:1024 lds
 s_add_u32 s87, s37, 98304
 buffer_load_dwordx4 a[0:3], v1, s[16:19], s87 offen sc1
 s_add_u32 s87, s37, 245760
 buffer_load_dwordx4 a[4:7], v1, s[16:19], s87 offen sc1
 s_add_u32 s87, s37, 99328
 buffer_load_dwordx4 a[8:11], v1, s[16:19], s87 offen sc1
 s_add_u32 s87, s37, 246784
 buffer_load_dwordx4 a[12:15], v1, s[16:19], s87 offen sc1
 s_waitcnt vmcnt(4)
 s_barrier
 s_cmp_eq_u32 s32, 0
 s_cbranch_scc0 L_g2_nolate3
 s_lshr_b32 s39, s79, 3
 s_lshl_b32 s40, s78, 2
 s_add_u32 s39, s39, s40
 s_add_u32 s39, s39, 128
 s_lshl_b32 s39, s39, 7
 v_mov_b32 v226, s39
 v_mov_b32 v225, 1
 s_mov_b64 s[76:77], exec
 s_mov_b64 exec, 1
 buffer_atomic_add v225, v226, s[28:31], 0 offen sc1
 s_mov_b64 exec, s[76:77]
L_g2_nolate3:
 s_lshr_b32 s39, s33, 1
 s_lshl_b32 s39, s39, 2
 s_add_u32 s39, s39, 131
 s_lshl_b32 s39, s39, 7
 v_mov_b32 v229, s39
 ds_read_b128 v[112:115], v2 offset:0
 ds_read_b128 v[116:119], v2 offset:1024
 ds_read_b128 v[120:123], v2 offset:2048
 ds_read_b128 v[124:127], v2 offset:3072
 ds_read_b128 v[128:131], v2 offset:4096
 ds_read_b128 v[132:135], v2 offset:5120
 s_waitcnt lgkmcnt(0)
 s_waitcnt vmcnt(2)
 v_mfma_f32_16x16x32_bf16 v[40:43], v[112:115], a[0:3], 0
 ds_read_b128 v[140:143], v2 offset:6144
 ds_read_b128 v[144:147], v2 offset:7168
 v_mfma_f32_16x16x32_bf16 v[76:79], v[112:115], a[4:7], 0
 ds_read_b128 v[148:151], v2 offset:8192
 v_mfma_f32_16x16x32_bf16 v[44:47], v[116:119], a[0:3], 0
 ds_read_b128 v[152:155], v2 offset:9216
 ds_read_b128 v[156:159], v2 offset:10240
 v_mfma_f32_16x16x32_bf16 v[80:83], v[116:119], a[4:7], 0
 ds_read_b128 v[160:163], v2 offset:11264
 v_mfma_f32_16x16x32_bf16 v[48:51], v[120:123], a[0:3], 0
 s_mul_i32 s39, s32, 6144
 s_add_u32 m0, s39, 36864
 s_add_u32 s40, s36, 3833856
 buffer_load_dwordx4 v1, s[12:15], s40 offen offset:0 lds
 buffer_load_dwordx4 v1, s[12:15], s40 offen offset:1024 lds
 v_mfma_f32_16x16x32_bf16 v[84:87], v[120:123], a[4:7], 0
 buffer_load_dwordx4 v1, s[12:15], s40 offen offset:2048 lds
 v_mfma_f32_16x16x32_bf16 v[52:55], v[124:127], a[0:3], 0
 buffer_load_dwordx4 v1, s[12:15], s40 offen offset:3072 lds
 v_mfma_f32_16x16x32_bf16 v[88:91], v[124:127], a[4:7], 0
 s_mul_i32 s39, s32, 6144
 s_add_u32 m0, s39, 40960
 s_add_u32 s40, s36, 3837952
 buffer_load_dwordx4 v1, s[12:15], s40 offen offset:0 lds
 buffer_load_dwordx4 v1, s[12:15], s40 offen offset:1024 lds
 v_mfma_f32_16x16x32_bf16 v[56:59], v[128:131], a[0:3], 0
 s_add_u32 s87, s37, 102400
 buffer_load_dwordx4 a[16:19], v1, s[16:19], s87 offen sc1
 v_mfma_f32_16x16x32_bf16 v[92:95], v[128:131], a[4:7], 0
 s_add_u32 s87, s37, 249856
 buffer_load_dwordx4 a[20:23], v1, s[16:19], s87 offen sc1
 s_add_u32 s87, s37, 103424
 buffer_load_dwordx4 a[24:27], v1, s[16:19], s87 offen sc1
 v_mfma_f32_16x16x32_bf16 v[60:63], v[132:135], a[0:3], 0
 s_add_u32 s87, s37, 250880
 buffer_load_dwordx4 a[28:31], v1, s[16:19], s87 offen sc1
 v_mfma_f32_16x16x32_bf16 v[96:99], v[132:135], a[4:7], 0
 s_add_u32 s87, s37, 106496
 buffer_load_dwordx4 a[32:35], v1, s[16:19], s87 offen sc1
 s_waitcnt lgkmcnt(0)
 s_waitcnt vmcnt(11)
 v_mfma_f32_16x16x32_bf16 v[40:43], v[140:143], a[8:11], v[40:43]
 ds_read_b128 v[112:115], v2 offset:12288
 ds_read_b128 v[116:119], v2 offset:13312
 v_mfma_f32_16x16x32_bf16 v[76:79], v[140:143], a[12:15], v[76:79]
 ds_read_b128 v[120:123], v2 offset:14336
 v_mfma_f32_16x16x32_bf16 v[44:47], v[144:147], a[8:11], v[44:47]
 ds_read_b128 v[124:127], v2 offset:15360
 ds_read_b128 v[128:131], v2 offset:16384
 v_mfma_f32_16x16x32_bf16 v[80:83], v[144:147], a[12:15], v[80:83]
 ds_read_b128 v[132:135], v2 offset:17408
 v_mfma_f32_16x16x32_bf16 v[48:51], v[148:151], a[8:11], v[48:51]
 s_add_u32 s87, s37, 253952
 buffer_load_dwordx4 a[36:39], v1, s[16:19], s87 offen sc1
 s_mul_i32 s39, s32, 6144
 s_add_u32 m0, s39, 73728
 s_add_u32 s40, s36, 4128768
 buffer_load_dwordx4 v1, s[12:15], s40 offen offset:0 lds
 v_mfma_f32_16x16x32_bf16 v[84:87], v[148:151], a[12:15], v[84:87]
 buffer_load_dwordx4 v1, s[12:15], s40 offen offset:1024 lds
 v_mfma_f32_16x16x32_bf16 v[52:55], v[152:155], a[8:11], v[52:55]
 buffer_load_dwordx4 v1, s[12:15], s40 offen offset:2048 lds
 v_mfma_f32_16x16x32_bf16 v[88:91], v[152:155], a[12:15], v[88:91]
 buffer_load_dwordx4 v1, s[12:15], s40 offen offset:3072 lds
 s_mul_i32 s39, s32, 6144
 s_add_u32 m0, s39, 77824
 s_add_u32 s40, s36, 4132864
 buffer_load_dwordx4 v1, s[12:15], s40 offen offset:0 lds
 v_mfma_f32_16x16x32_bf16 v[56:59], v[156:159], a[8:11], v[56:59]
 buffer_load_dwordx4 v1, s[12:15], s40 offen offset:1024 lds
 v_mfma_f32_16x16x32_bf16 v[92:95], v[156:159], a[12:15], v[92:95]
 s_mul_i32 s39, s32, 6144
 s_add_u32 m0, s39, 110592
 s_add_u32 s40, s36, 4423680
 buffer_load_dwordx4 v1, s[12:15], s40 offen offset:0 lds
 buffer_load_dwordx4 v1, s[12:15], s40 offen offset:1024 lds
 v_mfma_f32_16x16x32_bf16 v[60:63], v[160:163], a[8:11], v[60:63]
 buffer_load_dwordx4 v1, s[12:15], s40 offen offset:2048 lds
 v_mfma_f32_16x16x32_bf16 v[96:99], v[160:163], a[12:15], v[96:99]
 buffer_load_dwordx4 v1, s[12:15], s40 offen offset:3072 lds
 s_waitcnt lgkmcnt(0)
 s_waitcnt vmcnt(14)
 v_mfma_f32_16x16x32_bf16 v[40:43], v[112:115], a[16:19], v[40:43]
 ds_read_b128 v[140:143], v2 offset:18432
 ds_read_b128 v[144:147], v2 offset:19456
 v_mfma_f32_16x16x32_bf16 v[76:79], v[112:115], a[20:23], v[76:79]
 ds_read_b128 v[148:151], v2 offset:20480
 v_mfma_f32_16x16x32_bf16 v[44:47], v[116:119], a[16:19], v[44:47]
 ds_read_b128 v[152:155], v2 offset:21504
 v_mfma_f32_16x16x32_bf16 v[80:83], v[116:119], a[20:23], v[80:83]
 ds_read_b128 v[156:159], v2 offset:22528
 v_mfma_f32_16x16x32_bf16 v[48:51], v[120:123], a[16:19], v[48:51]
 ds_read_b128 v[160:163], v2 offset:23552
 v_mfma_f32_16x16x32_bf16 v[84:87], v[120:123], a[20:23], v[84:87]
 s_mul_i32 s39, s32, 6144
 s_add_u32 m0, s39, 114688
 s_add_u32 s40, s36, 4427776
 buffer_load_dwordx4 v1, s[12:15], s40 offen offset:0 lds
 v_mfma_f32_16x16x32_bf16 v[52:55], v[124:127], a[16:19], v[52:55]
 buffer_load_dwordx4 v1, s[12:15], s40 offen offset:1024 lds
 s_add_u32 s87, s37, 107520
 buffer_load_dwordx4 a[40:43], v1, s[16:19], s87 offen sc1
 v_mfma_f32_16x16x32_bf16 v[88:91], v[124:127], a[20:23], v[88:91]
 s_add_u32 s87, s37, 254976
 buffer_load_dwordx4 a[44:47], v1, s[16:19], s87 offen sc1
 v_mfma_f32_16x16x32_bf16 v[56:59], v[128:131], a[16:19], v[56:59]
 s_add_u32 s87, s37, 110592
 buffer_load_dwordx4 a[48:51], v1, s[16:19], s87 offen sc1
 v_mfma_f32_16x16x32_bf16 v[92:95], v[128:131], a[20:23], v[92:95]
 s_add_u32 s87, s37, 258048
 buffer_load_dwordx4 a[52:55], v1, s[16:19], s87 offen sc1
 v_mfma_f32_16x16x32_bf16 v[60:63], v[132:135], a[16:19], v[60:63]
 s_add_u32 s87, s37, 111616
 buffer_load_dwordx4 a[56:59], v1, s[16:19], s87 offen sc1
 v_mfma_f32_16x16x32_bf16 v[96:99], v[132:135], a[20:23], v[96:99]
 s_add_u32 s87, s37, 259072
 buffer_load_dwordx4 a[60:63], v1, s[16:19], s87 offen sc1
 s_waitcnt lgkmcnt(0)
 s_waitcnt vmcnt(24)
 s_barrier
 s_waitcnt vmcnt(20)
 v_mfma_f32_16x16x32_bf16 v[40:43], v[140:143], a[24:27], v[40:43]
 ds_read_b128 v[112:115], v3 offset:0
 ds_read_b128 v[116:119], v3 offset:1024
 v_mfma_f32_16x16x32_bf16 v[76:79], v[140:143], a[28:31], v[76:79]
 ds_read_b128 v[120:123], v3 offset:2048
 v_mfma_f32_16x16x32_bf16 v[44:47], v[144:147], a[24:27], v[44:47]
 ds_read_b128 v[124:127], v3 offset:3072
 v_mfma_f32_16x16x32_bf16 v[80:83], v[144:147], a[28:31], v[80:83]
 ds_read_b128 v[128:131], v3 offset:4096
 v_mfma_f32_16x16x32_bf16 v[48:51], v[148:151], a[24:27], v[48:51]
 ds_read_b128 v[132:135], v3 offset:5120
 v_mfma_f32_16x16x32_bf16 v[84:87], v[148:151], a[28:31], v[84:87]
 s_mul_i32 s39, s32, 6144
 s_add_u32 m0, s39, 0
 s_add_u32 s40, s36, 3612672
 buffer_load_dwordx4 v1, s[12:15], s40 offen offset:0 lds
 v_mfma_f32_16x16x32_bf16 v[52:55], v[152:155], a[24:27], v[52:55]
 buffer_load_dwordx4 v1, s[12:15], s40 offen offset:1024 lds
 buffer_load_dwordx4 v1, s[12:15], s40 offen offset:2048 lds
 v_mfma_f32_16x16x32_bf16 v[88:91], v[152:155], a[28:31], v[88:91]
 buffer_load_dwordx4 v1, s[12:15], s40 offen offset:3072 lds
 v_mfma_f32_16x16x32_bf16 v[56:59], v[156:159], a[24:27], v[56:59]
 s_mul_i32 s39, s32, 6144
 s_add_u32 m0, s39, 4096
 s_add_u32 s40, s36, 3616768
 buffer_load_dwordx4 v1, s[12:15], s40 offen offset:0 lds
 v_mfma_f32_16x16x32_bf16 v[92:95], v[156:159], a[28:31], v[92:95]
 buffer_load_dwordx4 v1, s[12:15], s40 offen offset:1024 lds
 v_mfma_f32_16x16x32_bf16 v[60:63], v[160:163], a[24:27], v[60:63]
 s_add_u32 s87, s37, 114688
 buffer_load_dwordx4 a[64:67], v1, s[16:19], s87 offen sc1
 v_mfma_f32_16x16x32_bf16 v[96:99], v[160:163], a[28:31], v[96:99]
 s_add_u32 s87, s37, 262144
 buffer_load_dwordx4 a[68:71], v1, s[16:19], s87 offen sc1
 s_waitcnt lgkmcnt(0)
 s_waitcnt vmcnt(26)
 v_mfma_f32_16x16x32_bf16 v[40:43], v[112:115], a[32:35], v[40:43]
 ds_read_b128 v[140:143], v3 offset:6144
 v_mfma_f32_16x16x32_bf16 v[76:79], v[112:115], a[36:39], v[76:79]
 ds_read_b128 v[144:147], v3 offset:7168
 v_mfma_f32_16x16x32_bf16 v[44:47], v[116:119], a[32:35], v[44:47]
 v_mfma_f32_16x16x32_bf16 v[80:83], v[116:119], a[36:39], v[80:83]
 ds_read_b128 v[148:151], v3 offset:8192
 v_mfma_f32_16x16x32_bf16 v[48:51], v[120:123], a[32:35], v[48:51]
 ds_read_b128 v[152:155], v3 offset:9216
 v_mfma_f32_16x16x32_bf16 v[84:87], v[120:123], a[36:39], v[84:87]
 v_mfma_f32_16x16x32_bf16 v[52:55], v[124:127], a[32:35], v[52:55]
 ds_read_b128 v[156:159], v3 offset:10240
 v_mfma_f32_16x16x32_bf16 v[88:91], v[124:127], a[36:39], v[88:91]
 ds_read_b128 v[160:163], v3 offset:11264
 v_mfma_f32_16x16x32_bf16 v[56:59], v[128:131], a[32:35], v[56:59]
 v_mfma_f32_16x16x32_bf16 v[92:95], v[128:131], a[36:39], v[92:95]
 s_add_u32 s87, s37, 115712
 buffer_load_dwordx4 a[72:75], v1, s[16:19], s87 offen sc1
 v_mfma_f32_16x16x32_bf16 v[60:63], v[132:135], a[32:35], v[60:63]
 s_add_u32 s87, s37, 263168
 buffer_load_dwordx4 a[76:79], v1, s[16:19], s87 offen sc1
 v_mfma_f32_16x16x32_bf16 v[96:99], v[132:135], a[36:39], v[96:99]
 s_waitcnt lgkmcnt(0)
 s_waitcnt vmcnt(14)
 v_mfma_f32_16x16x32_bf16 v[40:43], v[140:143], a[40:43], v[40:43]
 ds_read_b128 v[112:115], v3 offset:12288
 v_mfma_f32_16x16x32_bf16 v[76:79], v[140:143], a[44:47], v[76:79]
 ds_read_b128 v[116:119], v3 offset:13312
 v_mfma_f32_16x16x32_bf16 v[44:47], v[144:147], a[40:43], v[44:47]
 v_mfma_f32_16x16x32_bf16 v[80:83], v[144:147], a[44:47], v[80:83]
 ds_read_b128 v[120:123], v3 offset:14336
 v_mfma_f32_16x16x32_bf16 v[48:51], v[148:151], a[40:43], v[48:51]
 ds_read_b128 v[124:127], v3 offset:15360
 v_mfma_f32_16x16x32_bf16 v[84:87], v[148:151], a[44:47], v[84:87]
 v_mfma_f32_16x16x32_bf16 v[52:55], v[152:155], a[40:43], v[52:55]
 ds_read_b128 v[128:131], v3 offset:16384
 v_mfma_f32_16x16x32_bf16 v[88:91], v[152:155], a[44:47], v[88:91]
 ds_read_b128 v[132:135], v3 offset:17408
 v_mfma_f32_16x16x32_bf16 v[56:59], v[156:159], a[40:43], v[56:59]
 v_mfma_f32_16x16x32_bf16 v[92:95], v[156:159], a[44:47], v[92:95]
 s_add_u32 s87, s37, 118784
 buffer_load_dwordx4 a[80:83], v1, s[16:19], s87 offen sc1
 v_mfma_f32_16x16x32_bf16 v[60:63], v[160:163], a[40:43], v[60:63]
 s_add_u32 s87, s37, 266240
 buffer_load_dwordx4 a[84:87], v1, s[16:19], s87 offen sc1
 v_mfma_f32_16x16x32_bf16 v[96:99], v[160:163], a[44:47], v[96:99]
 s_waitcnt lgkmcnt(0)
 s_waitcnt vmcnt(14)
 v_mfma_f32_16x16x32_bf16 v[40:43], v[112:115], a[48:51], v[40:43]
 ds_read_b128 v[140:143], v3 offset:18432
 v_mfma_f32_16x16x32_bf16 v[76:79], v[112:115], a[52:55], v[76:79]
 ds_read_b128 v[144:147], v3 offset:19456
 v_mfma_f32_16x16x32_bf16 v[44:47], v[116:119], a[48:51], v[44:47]
 v_mfma_f32_16x16x32_bf16 v[80:83], v[116:119], a[52:55], v[80:83]
 ds_read_b128 v[148:151], v3 offset:20480
 v_mfma_f32_16x16x32_bf16 v[48:51], v[120:123], a[48:51], v[48:51]
 ds_read_b128 v[152:155], v3 offset:21504
 v_mfma_f32_16x16x32_bf16 v[84:87], v[120:123], a[52:55], v[84:87]
 v_mfma_f32_16x16x32_bf16 v[52:55], v[124:127], a[48:51], v[52:55]
 ds_read_b128 v[156:159], v3 offset:22528
 v_mfma_f32_16x16x32_bf16 v[88:91], v[124:127], a[52:55], v[88:91]
 ds_read_b128 v[160:163], v3 offset:23552
 v_mfma_f32_16x16x32_bf16 v[56:59], v[128:131], a[48:51], v[56:59]
 v_mfma_f32_16x16x32_bf16 v[92:95], v[128:131], a[52:55], v[92:95]
 s_add_u32 s87, s37, 119808
 buffer_load_dwordx4 a[88:91], v1, s[16:19], s87 offen sc1
 v_mfma_f32_16x16x32_bf16 v[60:63], v[132:135], a[48:51], v[60:63]
 s_add_u32 s87, s37, 267264
 buffer_load_dwordx4 a[92:95], v1, s[16:19], s87 offen sc1
 v_mfma_f32_16x16x32_bf16 v[96:99], v[132:135], a[52:55], v[96:99]
 s_waitcnt lgkmcnt(0)
 s_waitcnt vmcnt(26)
 s_barrier
 s_waitcnt vmcnt(14)
 s_mov_b64 s[76:77], exec
 s_mov_b64 exec, 1
 buffer_load_dword v230, v229, s[28:31], 0 offen sc1
 s_mov_b64 exec, s[76:77]
 s_nop 3
 v_mfma_f32_16x16x32_bf16 v[40:43], v[140:143], a[56:59], v[40:43]
 ds_read_b128 v[112:115], v4 offset:0
 ds_read_b128 v[116:119], v4 offset:1024
 v_mfma_f32_16x16x32_bf16 v[76:79], v[140:143], a[60:63], v[76:79]
 ds_read_b128 v[120:123], v4 offset:2048
 v_mfma_f32_16x16x32_bf16 v[44:47], v[144:147], a[56:59], v[44:47]
 ds_read_b128 v[124:127], v4 offset:3072
 v_mfma_f32_16x16x32_bf16 v[80:83], v[144:147], a[60:63], v[80:83]
 ds_read_b128 v[128:131], v4 offset:4096
 v_mfma_f32_16x16x32_bf16 v[48:51], v[148:151], a[56:59], v[48:51]
 ds_read_b128 v[132:135], v4 offset:5120
 v_mfma_f32_16x16x32_bf16 v[84:87], v[148:151], a[60:63], v[84:87]
 s_mul_i32 s39, s32, 6144
 s_add_u32 m0, s39, 36864
 s_add_u32 s40, s36, 3907584
 buffer_load_dwordx4 v1, s[12:15], s40 offen offset:0 lds
 v_mfma_f32_16x16x32_bf16 v[52:55], v[152:155], a[56:59], v[52:55]
 buffer_load_dwordx4 v1, s[12:15], s40 offen offset:1024 lds
 buffer_load_dwordx4 v1, s[12:15], s40 offen offset:2048 lds
 v_mfma_f32_16x16x32_bf16 v[88:91], v[152:155], a[60:63], v[88:91]
 buffer_load_dwordx4 v1, s[12:15], s40 offen offset:3072 lds
 v_mfma_f32_16x16x32_bf16 v[56:59], v[156:159], a[56:59], v[56:59]
 s_mul_i32 s39, s32, 6144
 s_add_u32 m0, s39, 40960
 s_add_u32 s40, s36, 3911680
 buffer_load_dwordx4 v1, s[12:15], s40 offen offset:0 lds
 v_mfma_f32_16x16x32_bf16 v[92:95], v[156:159], a[60:63], v[92:95]
 buffer_load_dwordx4 v1, s[12:15], s40 offen offset:1024 lds
 v_mfma_f32_16x16x32_bf16 v[60:63], v[160:163], a[56:59], v[60:63]
 s_add_u32 s87, s37, 122880
 buffer_load_dwordx4 a[96:99], v1, s[16:19], s87 offen sc1
 v_mfma_f32_16x16x32_bf16 v[96:99], v[160:163], a[60:63], v[96:99]
 s_add_u32 s87, s37, 270336
 buffer_load_dwordx4 a[100:103], v1, s[16:19], s87 offen sc1
 s_waitcnt lgkmcnt(0)
 s_waitcnt vmcnt(15)
 v_mfma_f32_16x16x32_bf16 v[40:43], v[112:115], a[64:67], v[40:43]
 ds_read_b128 v[140:143], v4 offset:6144
 v_mfma_f32_16x16x32_bf16 v[76:79], v[112:115], a[68:71], v[76:79]
 ds_read_b128 v[144:147], v4 offset:7168
 v_mfma_f32_16x16x32_bf16 v[44:47], v[116:119], a[64:67], v[44:47]
 v_mfma_f32_16x16x32_bf16 v[80:83], v[116:119], a[68:71], v[80:83]
 ds_read_b128 v[148:151], v4 offset:8192
 v_mfma_f32_16x16x32_bf16 v[48:51], v[120:123], a[64:67], v[48:51]
 ds_read_b128 v[152:155], v4 offset:9216
 v_mfma_f32_16x16x32_bf16 v[84:87], v[120:123], a[68:71], v[84:87]
 v_mfma_f32_16x16x32_bf16 v[52:55], v[124:127], a[64:67], v[52:55]
 ds_read_b128 v[156:159], v4 offset:10240
 v_mfma_f32_16x16x32_bf16 v[88:91], v[124:127], a[68:71], v[88:91]
 ds_read_b128 v[160:163], v4 offset:11264
 v_mfma_f32_16x16x32_bf16 v[56:59], v[128:131], a[64:67], v[56:59]
 v_mfma_f32_16x16x32_bf16 v[92:95], v[128:131], a[68:71], v[92:95]
 s_add_u32 s87, s37, 123904
 buffer_load_dwordx4 a[104:107], v1, s[16:19], s87 offen sc1
 v_mfma_f32_16x16x32_bf16 v[60:63], v[132:135], a[64:67], v[60:63]
 s_add_u32 s87, s37, 271360
 buffer_load_dwordx4 a[108:111], v1, s[16:19], s87 offen sc1
 v_mfma_f32_16x16x32_bf16 v[96:99], v[132:135], a[68:71], v[96:99]
 s_waitcnt lgkmcnt(0)
 s_waitcnt vmcnt(15)
 v_mfma_f32_16x16x32_bf16 v[40:43], v[140:143], a[72:75], v[40:43]
 ds_read_b128 v[112:115], v4 offset:12288
 v_mfma_f32_16x16x32_bf16 v[76:79], v[140:143], a[76:79], v[76:79]
 ds_read_b128 v[116:119], v4 offset:13312
 v_mfma_f32_16x16x32_bf16 v[44:47], v[144:147], a[72:75], v[44:47]
 v_mfma_f32_16x16x32_bf16 v[80:83], v[144:147], a[76:79], v[80:83]
 ds_read_b128 v[120:123], v4 offset:14336
 v_mfma_f32_16x16x32_bf16 v[48:51], v[148:151], a[72:75], v[48:51]
 ds_read_b128 v[124:127], v4 offset:15360
 v_mfma_f32_16x16x32_bf16 v[84:87], v[148:151], a[76:79], v[84:87]
 v_mfma_f32_16x16x32_bf16 v[52:55], v[152:155], a[72:75], v[52:55]
 ds_read_b128 v[128:131], v4 offset:16384
 v_mfma_f32_16x16x32_bf16 v[88:91], v[152:155], a[76:79], v[88:91]
 ds_read_b128 v[132:135], v4 offset:17408
 v_mfma_f32_16x16x32_bf16 v[56:59], v[156:159], a[72:75], v[56:59]
 v_mfma_f32_16x16x32_bf16 v[92:95], v[156:159], a[76:79], v[92:95]
 s_add_u32 s87, s37, 126976
 buffer_load_dwordx4 a[112:115], v1, s[16:19], s87 offen sc1
 v_mfma_f32_16x16x32_bf16 v[60:63], v[160:163], a[72:75], v[60:63]
 s_add_u32 s87, s37, 274432
 buffer_load_dwordx4 a[116:119], v1, s[16:19], s87 offen sc1
 v_mfma_f32_16x16x32_bf16 v[96:99], v[160:163], a[76:79], v[96:99]
 s_waitcnt lgkmcnt(0)
 s_waitcnt vmcnt(15)
 v_mfma_f32_16x16x32_bf16 v[40:43], v[112:115], a[80:83], v[40:43]
 ds_read_b128 v[140:143], v4 offset:18432
 v_mfma_f32_16x16x32_bf16 v[76:79], v[112:115], a[84:87], v[76:79]
 ds_read_b128 v[144:147], v4 offset:19456
 v_mfma_f32_16x16x32_bf16 v[44:47], v[116:119], a[80:83], v[44:47]
 v_mfma_f32_16x16x32_bf16 v[80:83], v[116:119], a[84:87], v[80:83]
 ds_read_b128 v[148:151], v4 offset:20480
 v_mfma_f32_16x16x32_bf16 v[48:51], v[120:123], a[80:83], v[48:51]
 ds_read_b128 v[152:155], v4 offset:21504
 v_mfma_f32_16x16x32_bf16 v[84:87], v[120:123], a[84:87], v[84:87]
 v_mfma_f32_16x16x32_bf16 v[52:55], v[124:127], a[80:83], v[52:55]
 ds_read_b128 v[156:159], v4 offset:22528
 v_mfma_f32_16x16x32_bf16 v[88:91], v[124:127], a[84:87], v[88:91]
 ds_read_b128 v[160:163], v4 offset:23552
 v_mfma_f32_16x16x32_bf16 v[56:59], v[128:131], a[80:83], v[56:59]
 v_mfma_f32_16x16x32_bf16 v[92:95], v[128:131], a[84:87], v[92:95]
 s_add_u32 s87, s37, 128000
 buffer_load_dwordx4 a[120:123], v1, s[16:19], s87 offen sc1
 v_mfma_f32_16x16x32_bf16 v[60:63], v[132:135], a[80:83], v[60:63]
 s_add_u32 s87, s37, 275456
 buffer_load_dwordx4 a[124:127], v1, s[16:19], s87 offen sc1
 v_mfma_f32_16x16x32_bf16 v[96:99], v[132:135], a[84:87], v[96:99]
 s_waitcnt lgkmcnt(0)
 s_waitcnt vmcnt(35)
 s_barrier
 s_waitcnt vmcnt(15)
 s_waitcnt vmcnt(14)
 v_readfirstlane_b32 s39, v230
 s_nop 0
 s_cmp_ge_u32 s39, 8
 s_cbranch_scc1 L_g2_lateok3
 s_mov_b32 s56, 0
 s_mov_b64 s[76:77], exec
 s_mov_b64 exec, 1
L_g2_lspin3:
 buffer_load_dword v230, v229, s[28:31], 0 offen sc1
 s_waitcnt vmcnt(0)
 v_readfirstlane_b32 s39, v230
 s_nop 0
 s_cmp_ge_u32 s39, 8
 s_cbranch_scc1 L_g2_ldone3
 s_add_u32 s56, s56, 1
 s_cmp_lt_u32 s56, 0x100000
 s_cbranch_scc0 L_g2_ldone3
 s_sleep 2
 s_branch L_g2_lspin3
L_g2_ldone3:
 s_mov_b64 exec, s[76:77]
L_g2_lateok3:
 s_nop 0
 s_nop 2
 v_mfma_f32_16x16x32_bf16 v[40:43], v[140:143], a[88:91], v[40:43]
 ds_read_b128 v[112:115], v5 offset:0
 ds_read_b128 v[116:119], v5 offset:1024
 v_mfma_f32_16x16x32_bf16 v[76:79], v[140:143], a[92:95], v[76:79]
 ds_read_b128 v[120:123], v5 offset:2048
 v_mfma_f32_16x16x32_bf16 v[44:47], v[144:147], a[88:91], v[44:47]
 ds_read_b128 v[124:127], v5 offset:3072
 v_mfma_f32_16x16x32_bf16 v[80:83], v[144:147], a[92:95], v[80:83]
 ds_read_b128 v[128:131], v5 offset:4096
 v_mfma_f32_16x16x32_bf16 v[48:51], v[148:151], a[88:91], v[48:51]
 ds_read_b128 v[132:135], v5 offset:5120
 v_mfma_f32_16x16x32_bf16 v[84:87], v[148:151], a[92:95], v[84:87]
 s_mul_i32 s39, s32, 6144
 s_add_u32 m0, s39, 73728
 s_add_u32 s40, s36, 4202496
 buffer_load_dwordx4 v1, s[12:15], s40 offen offset:0 lds
 v_mfma_f32_16x16x32_bf16 v[52:55], v[152:155], a[88:91], v[52:55]
 buffer_load_dwordx4 v1, s[12:15], s40 offen offset:1024 lds
 buffer_load_dwordx4 v1, s[12:15], s40 offen offset:2048 lds
 v_mfma_f32_16x16x32_bf16 v[88:91], v[152:155], a[92:95], v[88:91]
 buffer_load_dwordx4 v1, s[12:15], s40 offen offset:3072 lds
 v_mfma_f32_16x16x32_bf16 v[56:59], v[156:159], a[88:91], v[56:59]
 s_mul_i32 s39, s32, 6144
 s_add_u32 m0, s39, 77824
 s_add_u32 s40, s36, 4206592
 buffer_load_dwordx4 v1, s[12:15], s40 offen offset:0 lds
 v_mfma_f32_16x16x32_bf16 v[92:95], v[156:159], a[92:95], v[92:95]
 buffer_load_dwordx4 v1, s[12:15], s40 offen offset:1024 lds
 v_mfma_f32_16x16x32_bf16 v[60:63], v[160:163], a[88:91], v[60:63]
 s_add_u32 s87, s37, 100352
 buffer_load_dwordx4 a[128:131], v1, s[16:19], s87 offen sc1
 v_mfma_f32_16x16x32_bf16 v[96:99], v[160:163], a[92:95], v[96:99]
 s_add_u32 s87, s37, 247808
 buffer_load_dwordx4 a[132:135], v1, s[16:19], s87 offen sc1
 s_waitcnt lgkmcnt(0)
 s_waitcnt vmcnt(14)
 v_mfma_f32_16x16x32_bf16 v[40:43], v[112:115], a[96:99], v[40:43]
 ds_read_b128 v[140:143], v5 offset:6144
 v_mfma_f32_16x16x32_bf16 v[76:79], v[112:115], a[100:103], v[76:79]
 ds_read_b128 v[144:147], v5 offset:7168
 v_mfma_f32_16x16x32_bf16 v[44:47], v[116:119], a[96:99], v[44:47]
 v_mfma_f32_16x16x32_bf16 v[80:83], v[116:119], a[100:103], v[80:83]
 ds_read_b128 v[148:151], v5 offset:8192
 v_mfma_f32_16x16x32_bf16 v[48:51], v[120:123], a[96:99], v[48:51]
 ds_read_b128 v[152:155], v5 offset:9216
 v_mfma_f32_16x16x32_bf16 v[84:87], v[120:123], a[100:103], v[84:87]
 v_mfma_f32_16x16x32_bf16 v[52:55], v[124:127], a[96:99], v[52:55]
 ds_read_b128 v[156:159], v5 offset:10240
 v_mfma_f32_16x16x32_bf16 v[88:91], v[124:127], a[100:103], v[88:91]
 ds_read_b128 v[160:163], v5 offset:11264
 v_mfma_f32_16x16x32_bf16 v[56:59], v[128:131], a[96:99], v[56:59]
 v_mfma_f32_16x16x32_bf16 v[92:95], v[128:131], a[100:103], v[92:95]
 s_add_u32 s87, s37, 101376
 buffer_load_dwordx4 a[136:139], v1, s[16:19], s87 offen sc1
 v_mfma_f32_16x16x32_bf16 v[60:63], v[132:135], a[96:99], v[60:63]
 s_add_u32 s87, s37, 248832
 buffer_load_dwordx4 a[140:143], v1, s[16:19], s87 offen sc1
 v_mfma_f32_16x16x32_bf16 v[96:99], v[132:135], a[100:103], v[96:99]
 s_waitcnt lgkmcnt(0)
 s_waitcnt vmcnt(14)
 v_mfma_f32_16x16x32_bf16 v[40:43], v[140:143], a[104:107], v[40:43]
 ds_read_b128 v[112:115], v5 offset:12288
 v_mfma_f32_16x16x32_bf16 v[76:79], v[140:143], a[108:111], v[76:79]
 ds_read_b128 v[116:119], v5 offset:13312
 v_mfma_f32_16x16x32_bf16 v[44:47], v[144:147], a[104:107], v[44:47]
 v_mfma_f32_16x16x32_bf16 v[80:83], v[144:147], a[108:111], v[80:83]
 ds_read_b128 v[120:123], v5 offset:14336
 v_mfma_f32_16x16x32_bf16 v[48:51], v[148:151], a[104:107], v[48:51]
 ds_read_b128 v[124:127], v5 offset:15360
 v_mfma_f32_16x16x32_bf16 v[84:87], v[148:151], a[108:111], v[84:87]
 v_mfma_f32_16x16x32_bf16 v[52:55], v[152:155], a[104:107], v[52:55]
 ds_read_b128 v[128:131], v5 offset:16384
 v_mfma_f32_16x16x32_bf16 v[88:91], v[152:155], a[108:111], v[88:91]
 ds_read_b128 v[132:135], v5 offset:17408
 v_mfma_f32_16x16x32_bf16 v[56:59], v[156:159], a[104:107], v[56:59]
 v_mfma_f32_16x16x32_bf16 v[92:95], v[156:159], a[108:111], v[92:95]
 s_add_u32 s87, s37, 104448
 buffer_load_dwordx4 a[144:147], v1, s[16:19], s87 offen sc1
 v_mfma_f32_16x16x32_bf16 v[60:63], v[160:163], a[104:107], v[60:63]
 s_add_u32 s87, s37, 251904
 buffer_load_dwordx4 a[148:151], v1, s[16:19], s87 offen sc1
 v_mfma_f32_16x16x32_bf16 v[96:99], v[160:163], a[108:111], v[96:99]
 s_waitcnt lgkmcnt(0)
 s_waitcnt vmcnt(14)
 v_mfma_f32_16x16x32_bf16 v[40:43], v[112:115], a[112:115], v[40:43]
 ds_read_b128 v[140:143], v5 offset:18432
 v_mfma_f32_16x16x32_bf16 v[76:79], v[112:115], a[116:119], v[76:79]
 ds_read_b128 v[144:147], v5 offset:19456
 v_mfma_f32_16x16x32_bf16 v[44:47], v[116:119], a[112:115], v[44:47]
 v_mfma_f32_16x16x32_bf16 v[80:83], v[116:119], a[116:119], v[80:83]
 ds_read_b128 v[148:151], v5 offset:20480
 v_mfma_f32_16x16x32_bf16 v[48:51], v[120:123], a[112:115], v[48:51]
 ds_read_b128 v[152:155], v5 offset:21504
 v_mfma_f32_16x16x32_bf16 v[84:87], v[120:123], a[116:119], v[84:87]
 v_mfma_f32_16x16x32_bf16 v[52:55], v[124:127], a[112:115], v[52:55]
 ds_read_b128 v[156:159], v5 offset:22528
 v_mfma_f32_16x16x32_bf16 v[88:91], v[124:127], a[116:119], v[88:91]
 ds_read_b128 v[160:163], v5 offset:23552
 v_mfma_f32_16x16x32_bf16 v[56:59], v[128:131], a[112:115], v[56:59]
 v_mfma_f32_16x16x32_bf16 v[92:95], v[128:131], a[116:119], v[92:95]
 s_add_u32 s87, s37, 105472
 buffer_load_dwordx4 a[152:155], v1, s[16:19], s87 offen sc1
 v_mfma_f32_16x16x32_bf16 v[60:63], v[132:135], a[112:115], v[60:63]
 s_add_u32 s87, s37, 252928
 buffer_load_dwordx4 a[156:159], v1, s[16:19], s87 offen sc1
 v_mfma_f32_16x16x32_bf16 v[96:99], v[132:135], a[116:119], v[96:99]
 s_waitcnt lgkmcnt(0)
 s_waitcnt vmcnt(37)
 s_barrier
 s_waitcnt vmcnt(14)
 v_mfma_f32_16x16x32_bf16 v[40:43], v[140:143], a[120:123], v[40:43]
 ds_read_b128 v[112:115], v2 offset:0
 ds_read_b128 v[116:119], v2 offset:1024
 v_mfma_f32_16x16x32_bf16 v[76:79], v[140:143], a[124:127], v[76:79]
 ds_read_b128 v[120:123], v2 offset:2048
 v_mfma_f32_16x16x32_bf16 v[44:47], v[144:147], a[120:123], v[44:47]
 ds_read_b128 v[124:127], v2 offset:3072
 v_mfma_f32_16x16x32_bf16 v[80:83], v[144:147], a[124:127], v[80:83]
 ds_read_b128 v[128:131], v2 offset:4096
 v_mfma_f32_16x16x32_bf16 v[48:51], v[148:151], a[120:123], v[48:51]
 ds_read_b128 v[132:135], v2 offset:5120
 v_mfma_f32_16x16x32_bf16 v[84:87], v[148:151], a[124:127], v[84:87]
 s_mul_i32 s39, s32, 6144
 s_add_u32 m0, s39, 110592
 s_add_u32 s40, s36, 4497408
 buffer_load_dwordx4 v1, s[12:15], s40 offen offset:0 lds
 v_mfma_f32_16x16x32_bf16 v[52:55], v[152:155], a[120:123], v[52:55]
 buffer_load_dwordx4 v1, s[12:15], s40 offen offset:1024 lds
 buffer_load_dwordx4 v1, s[12:15], s40 offen offset:2048 lds
 v_mfma_f32_16x16x32_bf16 v[88:91], v[152:155], a[124:127], v[88:91]
 buffer_load_dwordx4 v1, s[12:15], s40 offen offset:3072 lds
 v_mfma_f32_16x16x32_bf16 v[56:59], v[156:159], a[120:123], v[56:59]
 s_mul_i32 s39, s32, 6144
 s_add_u32 m0, s39, 114688
 s_add_u32 s40, s36, 4501504
 buffer_load_dwordx4 v1, s[12:15], s40 offen offset:0 lds
 v_mfma_f32_16x16x32_bf16 v[92:95], v[156:159], a[124:127], v[92:95]
 buffer_load_dwordx4 v1, s[12:15], s40 offen offset:1024 lds
 v_mfma_f32_16x16x32_bf16 v[60:63], v[160:163], a[120:123], v[60:63]
 s_add_u32 s87, s37, 108544
 buffer_load_dwordx4 a[160:163], v1, s[16:19], s87 offen sc1
 v_mfma_f32_16x16x32_bf16 v[96:99], v[160:163], a[124:127], v[96:99]
 s_add_u32 s87, s37, 256000
 buffer_load_dwordx4 a[164:167], v1, s[16:19], s87 offen sc1
 s_waitcnt lgkmcnt(0)
 s_waitcnt vmcnt(14)
 v_mfma_f32_16x16x32_bf16 v[40:43], v[112:115], a[128:131], v[40:43]
 ds_read_b128 v[140:143], v2 offset:6144
 v_mfma_f32_16x16x32_bf16 v[76:79], v[112:115], a[132:135], v[76:79]
 ds_read_b128 v[144:147], v2 offset:7168
 v_mfma_f32_16x16x32_bf16 v[44:47], v[116:119], a[128:131], v[44:47]
 v_mfma_f32_16x16x32_bf16 v[80:83], v[116:119], a[132:135], v[80:83]
 ds_read_b128 v[148:151], v2 offset:8192
 v_mfma_f32_16x16x32_bf16 v[48:51], v[120:123], a[128:131], v[48:51]
 ds_read_b128 v[152:155], v2 offset:9216
 v_mfma_f32_16x16x32_bf16 v[84:87], v[120:123], a[132:135], v[84:87]
 v_mfma_f32_16x16x32_bf16 v[52:55], v[124:127], a[128:131], v[52:55]
 ds_read_b128 v[156:159], v2 offset:10240
 v_mfma_f32_16x16x32_bf16 v[88:91], v[124:127], a[132:135], v[88:91]
 ds_read_b128 v[160:163], v2 offset:11264
 v_mfma_f32_16x16x32_bf16 v[56:59], v[128:131], a[128:131], v[56:59]
 v_mfma_f32_16x16x32_bf16 v[92:95], v[128:131], a[132:135], v[92:95]
 s_add_u32 s87, s37, 109568
 buffer_load_dwordx4 a[168:171], v1, s[16:19], s87 offen sc1
 v_mfma_f32_16x16x32_bf16 v[60:63], v[132:135], a[128:131], v[60:63]
 s_add_u32 s87, s37, 257024
 buffer_load_dwordx4 a[172:175], v1, s[16:19], s87 offen sc1
 v_mfma_f32_16x16x32_bf16 v[96:99], v[132:135], a[132:135], v[96:99]
 s_waitcnt lgkmcnt(0)
 s_waitcnt vmcnt(14)
 v_mfma_f32_16x16x32_bf16 v[40:43], v[140:143], a[136:139], v[40:43]
 ds_read_b128 v[112:115], v2 offset:12288
 v_mfma_f32_16x16x32_bf16 v[76:79], v[140:143], a[140:143], v[76:79]
 ds_read_b128 v[116:119], v2 offset:13312
 v_mfma_f32_16x16x32_bf16 v[44:47], v[144:147], a[136:139], v[44:47]
 v_mfma_f32_16x16x32_bf16 v[80:83], v[144:147], a[140:143], v[80:83]
 ds_read_b128 v[120:123], v2 offset:14336
 v_mfma_f32_16x16x32_bf16 v[48:51], v[148:151], a[136:139], v[48:51]
 ds_read_b128 v[124:127], v2 offset:15360
 v_mfma_f32_16x16x32_bf16 v[84:87], v[148:151], a[140:143], v[84:87]
 v_mfma_f32_16x16x32_bf16 v[52:55], v[152:155], a[136:139], v[52:55]
 ds_read_b128 v[128:131], v2 offset:16384
 v_mfma_f32_16x16x32_bf16 v[88:91], v[152:155], a[140:143], v[88:91]
 ds_read_b128 v[132:135], v2 offset:17408
 v_mfma_f32_16x16x32_bf16 v[56:59], v[156:159], a[136:139], v[56:59]
 v_mfma_f32_16x16x32_bf16 v[92:95], v[156:159], a[140:143], v[92:95]
 s_add_u32 s87, s37, 112640
 buffer_load_dwordx4 a[176:179], v1, s[16:19], s87 offen sc1
 v_mfma_f32_16x16x32_bf16 v[60:63], v[160:163], a[136:139], v[60:63]
 s_add_u32 s87, s37, 260096
 buffer_load_dwordx4 a[180:183], v1, s[16:19], s87 offen sc1
 v_mfma_f32_16x16x32_bf16 v[96:99], v[160:163], a[140:143], v[96:99]
 s_waitcnt lgkmcnt(0)
 s_waitcnt vmcnt(14)
 v_mfma_f32_16x16x32_bf16 v[40:43], v[112:115], a[144:147], v[40:43]
 ds_read_b128 v[140:143], v2 offset:18432
 v_mfma_f32_16x16x32_bf16 v[76:79], v[112:115], a[148:151], v[76:79]
 ds_read_b128 v[144:147], v2 offset:19456
 v_mfma_f32_16x16x32_bf16 v[44:47], v[116:119], a[144:147], v[44:47]
 v_mfma_f32_16x16x32_bf16 v[80:83], v[116:119], a[148:151], v[80:83]
 ds_read_b128 v[148:151], v2 offset:20480
 v_mfma_f32_16x16x32_bf16 v[48:51], v[120:123], a[144:147], v[48:51]
 ds_read_b128 v[152:155], v2 offset:21504
 v_mfma_f32_16x16x32_bf16 v[84:87], v[120:123], a[148:151], v[84:87]
 v_mfma_f32_16x16x32_bf16 v[52:55], v[124:127], a[144:147], v[52:55]
 ds_read_b128 v[156:159], v2 offset:22528
 v_mfma_f32_16x16x32_bf16 v[88:91], v[124:127], a[148:151], v[88:91]
 ds_read_b128 v[160:163], v2 offset:23552
 v_mfma_f32_16x16x32_bf16 v[56:59], v[128:131], a[144:147], v[56:59]
 v_mfma_f32_16x16x32_bf16 v[92:95], v[128:131], a[148:151], v[92:95]
 s_add_u32 s87, s37, 113664
 buffer_load_dwordx4 a[184:187], v1, s[16:19], s87 offen sc1
 v_mfma_f32_16x16x32_bf16 v[60:63], v[132:135], a[144:147], v[60:63]
 s_add_u32 s87, s37, 261120
 buffer_load_dwordx4 a[188:191], v1, s[16:19], s87 offen sc1
 v_mfma_f32_16x16x32_bf16 v[96:99], v[132:135], a[148:151], v[96:99]
 s_waitcnt lgkmcnt(0)
 s_waitcnt vmcnt(36)
 s_barrier
 s_waitcnt vmcnt(14)
 v_mfma_f32_16x16x32_bf16 v[40:43], v[140:143], a[152:155], v[40:43]
 ds_read_b128 v[112:115], v3 offset:0
 ds_read_b128 v[116:119], v3 offset:1024
 v_mfma_f32_16x16x32_bf16 v[76:79], v[140:143], a[156:159], v[76:79]
 ds_read_b128 v[120:123], v3 offset:2048
 v_mfma_f32_16x16x32_bf16 v[44:47], v[144:147], a[152:155], v[44:47]
 ds_read_b128 v[124:127], v3 offset:3072
 v_mfma_f32_16x16x32_bf16 v[80:83], v[144:147], a[156:159], v[80:83]
 ds_read_b128 v[128:131], v3 offset:4096
 v_mfma_f32_16x16x32_bf16 v[48:51], v[148:151], a[152:155], v[48:51]
 ds_read_b128 v[132:135], v3 offset:5120
 v_mfma_f32_16x16x32_bf16 v[84:87], v[148:151], a[156:159], v[84:87]
 s_mul_i32 s39, s32, 6144
 s_add_u32 m0, s39, 0
 s_add_u32 s40, s38, 5160960
 buffer_load_dwordx4 v1, s[12:15], s40 offen offset:0 lds
 v_mfma_f32_16x16x32_bf16 v[52:55], v[152:155], a[152:155], v[52:55]
 buffer_load_dwordx4 v1, s[12:15], s40 offen offset:1024 lds
 buffer_load_dwordx4 v1, s[12:15], s40 offen offset:2048 lds
 v_mfma_f32_16x16x32_bf16 v[88:91], v[152:155], a[156:159], v[88:91]
 buffer_load_dwordx4 v1, s[12:15], s40 offen offset:3072 lds
 v_mfma_f32_16x16x32_bf16 v[56:59], v[156:159], a[152:155], v[56:59]
 s_mul_i32 s39, s32, 6144
 s_add_u32 m0, s39, 4096
 s_add_u32 s40, s38, 5165056
 buffer_load_dwordx4 v1, s[12:15], s40 offen offset:0 lds
 v_mfma_f32_16x16x32_bf16 v[92:95], v[156:159], a[156:159], v[92:95]
 buffer_load_dwordx4 v1, s[12:15], s40 offen offset:1024 lds
 v_mfma_f32_16x16x32_bf16 v[60:63], v[160:163], a[152:155], v[60:63]
 s_add_u32 s87, s37, 116736
 buffer_load_dwordx4 a[192:195], v1, s[16:19], s87 offen sc1
 v_mfma_f32_16x16x32_bf16 v[96:99], v[160:163], a[156:159], v[96:99]
 s_add_u32 s87, s37, 264192
 buffer_load_dwordx4 a[196:199], v1, s[16:19], s87 offen sc1
 s_waitcnt lgkmcnt(0)
 s_waitcnt vmcnt(14)
 v_mfma_f32_16x16x32_bf16 v[40:43], v[112:115], a[160:163], v[40:43]
 ds_read_b128 v[140:143], v3 offset:6144
 v_mfma_f32_16x16x32_bf16 v[76:79], v[112:115], a[164:167], v[76:79]
 ds_read_b128 v[144:147], v3 offset:7168
 v_mfma_f32_16x16x32_bf16 v[44:47], v[116:119], a[160:163], v[44:47]
 v_mfma_f32_16x16x32_bf16 v[80:83], v[116:119], a[164:167], v[80:83]
 ds_read_b128 v[148:151], v3 offset:8192
 v_mfma_f32_16x16x32_bf16 v[48:51], v[120:123], a[160:163], v[48:51]
 ds_read_b128 v[152:155], v3 offset:9216
 v_mfma_f32_16x16x32_bf16 v[84:87], v[120:123], a[164:167], v[84:87]
 v_mfma_f32_16x16x32_bf16 v[52:55], v[124:127], a[160:163], v[52:55]
 ds_read_b128 v[156:159], v3 offset:10240
 v_mfma_f32_16x16x32_bf16 v[88:91], v[124:127], a[164:167], v[88:91]
 ds_read_b128 v[160:163], v3 offset:11264
 v_mfma_f32_16x16x32_bf16 v[56:59], v[128:131], a[160:163], v[56:59]
 v_mfma_f32_16x16x32_bf16 v[92:95], v[128:131], a[164:167], v[92:95]
 s_add_u32 s87, s37, 117760
 buffer_load_dwordx4 a[200:203], v1, s[16:19], s87 offen sc1
 v_mfma_f32_16x16x32_bf16 v[60:63], v[132:135], a[160:163], v[60:63]
 s_add_u32 s87, s37, 265216
 buffer_load_dwordx4 a[204:207], v1, s[16:19], s87 offen sc1
 v_mfma_f32_16x16x32_bf16 v[96:99], v[132:135], a[164:167], v[96:99]
 s_waitcnt lgkmcnt(0)
 s_waitcnt vmcnt(14)
 v_mfma_f32_16x16x32_bf16 v[40:43], v[140:143], a[168:171], v[40:43]
 ds_read_b128 v[112:115], v3 offset:12288
 v_mfma_f32_16x16x32_bf16 v[76:79], v[140:143], a[172:175], v[76:79]
 ds_read_b128 v[116:119], v3 offset:13312
 v_mfma_f32_16x16x32_bf16 v[44:47], v[144:147], a[168:171], v[44:47]
 v_mfma_f32_16x16x32_bf16 v[80:83], v[144:147], a[172:175], v[80:83]
 ds_read_b128 v[120:123], v3 offset:14336
 v_mfma_f32_16x16x32_bf16 v[48:51], v[148:151], a[168:171], v[48:51]
 ds_read_b128 v[124:127], v3 offset:15360
 v_mfma_f32_16x16x32_bf16 v[84:87], v[148:151], a[172:175], v[84:87]
 v_mfma_f32_16x16x32_bf16 v[52:55], v[152:155], a[168:171], v[52:55]
 ds_read_b128 v[128:131], v3 offset:16384
 v_mfma_f32_16x16x32_bf16 v[88:91], v[152:155], a[172:175], v[88:91]
 ds_read_b128 v[132:135], v3 offset:17408
 v_mfma_f32_16x16x32_bf16 v[56:59], v[156:159], a[168:171], v[56:59]
 v_mfma_f32_16x16x32_bf16 v[92:95], v[156:159], a[172:175], v[92:95]
 s_add_u32 s87, s37, 120832
 buffer_load_dwordx4 a[208:211], v1, s[16:19], s87 offen sc1
 v_mfma_f32_16x16x32_bf16 v[60:63], v[160:163], a[168:171], v[60:63]
 s_add_u32 s87, s37, 268288
 buffer_load_dwordx4 a[212:215], v1, s[16:19], s87 offen sc1
 v_mfma_f32_16x16x32_bf16 v[96:99], v[160:163], a[172:175], v[96:99]
 s_waitcnt lgkmcnt(0)
 s_waitcnt vmcnt(14)
 v_mfma_f32_16x16x32_bf16 v[40:43], v[112:115], a[176:179], v[40:43]
 ds_read_b128 v[140:143], v3 offset:18432
 v_mfma_f32_16x16x32_bf16 v[76:79], v[112:115], a[180:183], v[76:79]
 ds_read_b128 v[144:147], v3 offset:19456
 v_mfma_f32_16x16x32_bf16 v[44:47], v[116:119], a[176:179], v[44:47]
 v_mfma_f32_16x16x32_bf16 v[80:83], v[116:119], a[180:183], v[80:83]
 ds_read_b128 v[148:151], v3 offset:20480
 v_mfma_f32_16x16x32_bf16 v[48:51], v[120:123], a[176:179], v[48:51]
 ds_read_b128 v[152:155], v3 offset:21504
 v_mfma_f32_16x16x32_bf16 v[84:87], v[120:123], a[180:183], v[84:87]
 v_mfma_f32_16x16x32_bf16 v[52:55], v[124:127], a[176:179], v[52:55]
 ds_read_b128 v[156:159], v3 offset:22528
 v_mfma_f32_16x16x32_bf16 v[88:91], v[124:127], a[180:183], v[88:91]
 ds_read_b128 v[160:163], v3 offset:23552
 v_mfma_f32_16x16x32_bf16 v[56:59], v[128:131], a[176:179], v[56:59]
 v_mfma_f32_16x16x32_bf16 v[92:95], v[128:131], a[180:183], v[92:95]
 s_add_u32 s87, s37, 121856
 buffer_load_dwordx4 a[216:219], v1, s[16:19], s87 offen sc1
 v_mfma_f32_16x16x32_bf16 v[60:63], v[132:135], a[176:179], v[60:63]
 s_add_u32 s87, s37, 269312
 buffer_load_dwordx4 a[220:223], v1, s[16:19], s87 offen sc1
 v_mfma_f32_16x16x32_bf16 v[96:99], v[132:135], a[180:183], v[96:99]
 s_waitcnt lgkmcnt(0)
 s_waitcnt vmcnt(36)
 s_barrier
 s_waitcnt vmcnt(14)
 v_mfma_f32_16x16x32_bf16 v[40:43], v[140:143], a[184:187], v[40:43]
 ds_read_b128 v[112:115], v4 offset:0
 v_mfma_f32_16x16x32_bf16 v[76:79], v[140:143], a[188:191], v[76:79]
 ds_read_b128 v[116:119], v4 offset:1024
 v_mfma_f32_16x16x32_bf16 v[44:47], v[144:147], a[184:187], v[44:47]
 v_mfma_f32_16x16x32_bf16 v[80:83], v[144:147], a[188:191], v[80:83]
 ds_read_b128 v[120:123], v4 offset:2048
 v_mfma_f32_16x16x32_bf16 v[48:51], v[148:151], a[184:187], v[48:51]
 ds_read_b128 v[124:127], v4 offset:3072
 v_mfma_f32_16x16x32_bf16 v[84:87], v[148:151], a[188:191], v[84:87]
 v_mfma_f32_16x16x32_bf16 v[52:55], v[152:155], a[184:187], v[52:55]
 ds_read_b128 v[128:131], v4 offset:4096
 v_mfma_f32_16x16x32_bf16 v[88:91], v[152:155], a[188:191], v[88:91]
 ds_read_b128 v[132:135], v4 offset:5120
 v_mfma_f32_16x16x32_bf16 v[56:59], v[156:159], a[184:187], v[56:59]
 v_mfma_f32_16x16x32_bf16 v[92:95], v[156:159], a[188:191], v[92:95]
 s_add_u32 s87, s37, 124928
 buffer_load_dwordx4 a[224:227], v1, s[16:19], s87 offen sc1
 v_mfma_f32_16x16x32_bf16 v[60:63], v[160:163], a[184:187], v[60:63]
 s_add_u32 s87, s37, 272384
 buffer_load_dwordx4 a[228:231], v1, s[16:19], s87 offen sc1
 v_mfma_f32_16x16x32_bf16 v[96:99], v[160:163], a[188:191], v[96:99]
 s_waitcnt lgkmcnt(0)
 s_waitcnt vmcnt(8)
 v_mfma_f32_16x16x32_bf16 v[40:43], v[112:115], a[192:195], v[40:43]
 ds_read_b128 v[140:143], v4 offset:6144
 v_mfma_f32_16x16x32_bf16 v[76:79], v[112:115], a[196:199], v[76:79]
 ds_read_b128 v[144:147], v4 offset:7168
 v_mfma_f32_16x16x32_bf16 v[44:47], v[116:119], a[192:195], v[44:47]
 v_mfma_f32_16x16x32_bf16 v[80:83], v[116:119], a[196:199], v[80:83]
 ds_read_b128 v[148:151], v4 offset:8192
 v_mfma_f32_16x16x32_bf16 v[48:51], v[120:123], a[192:195], v[48:51]
 ds_read_b128 v[152:155], v4 offset:9216
 v_mfma_f32_16x16x32_bf16 v[84:87], v[120:123], a[196:199], v[84:87]
 v_mfma_f32_16x16x32_bf16 v[52:55], v[124:127], a[192:195], v[52:55]
 ds_read_b128 v[156:159], v4 offset:10240
 v_mfma_f32_16x16x32_bf16 v[88:91], v[124:127], a[196:199], v[88:91]
 ds_read_b128 v[160:163], v4 offset:11264
 v_mfma_f32_16x16x32_bf16 v[56:59], v[128:131], a[192:195], v[56:59]
 v_mfma_f32_16x16x32_bf16 v[92:95], v[128:131], a[196:199], v[92:95]
 s_add_u32 s87, s37, 125952
 buffer_load_dwordx4 a[232:235], v1, s[16:19], s87 offen sc1
 v_mfma_f32_16x16x32_bf16 v[60:63], v[132:135], a[192:195], v[60:63]
 s_add_u32 s87, s37, 273408
 buffer_load_dwordx4 a[236:239], v1, s[16:19], s87 offen sc1
 v_mfma_f32_16x16x32_bf16 v[96:99], v[132:135], a[196:199], v[96:99]
 s_waitcnt lgkmcnt(0)
 s_waitcnt vmcnt(8)
 v_mfma_f32_16x16x32_bf16 v[40:43], v[140:143], a[200:203], v[40:43]
 ds_read_b128 v[112:115], v4 offset:12288
 v_mfma_f32_16x16x32_bf16 v[76:79], v[140:143], a[204:207], v[76:79]
 ds_read_b128 v[116:119], v4 offset:13312
 v_mfma_f32_16x16x32_bf16 v[44:47], v[144:147], a[200:203], v[44:47]
 v_mfma_f32_16x16x32_bf16 v[80:83], v[144:147], a[204:207], v[80:83]
 ds_read_b128 v[120:123], v4 offset:14336
 v_mfma_f32_16x16x32_bf16 v[48:51], v[148:151], a[200:203], v[48:51]
 ds_read_b128 v[124:127], v4 offset:15360
 v_mfma_f32_16x16x32_bf16 v[84:87], v[148:151], a[204:207], v[84:87]
 v_mfma_f32_16x16x32_bf16 v[52:55], v[152:155], a[200:203], v[52:55]
 ds_read_b128 v[128:131], v4 offset:16384
 v_mfma_f32_16x16x32_bf16 v[88:91], v[152:155], a[204:207], v[88:91]
 ds_read_b128 v[132:135], v4 offset:17408
 v_mfma_f32_16x16x32_bf16 v[56:59], v[156:159], a[200:203], v[56:59]
 v_mfma_f32_16x16x32_bf16 v[92:95], v[156:159], a[204:207], v[92:95]
 s_add_u32 s87, s37, 129024
 buffer_load_dwordx4 a[240:243], v1, s[16:19], s87 offen sc1
 v_mfma_f32_16x16x32_bf16 v[60:63], v[160:163], a[200:203], v[60:63]
 s_add_u32 s87, s37, 276480
 buffer_load_dwordx4 a[244:247], v1, s[16:19], s87 offen sc1
 v_mfma_f32_16x16x32_bf16 v[96:99], v[160:163], a[204:207], v[96:99]
 s_waitcnt lgkmcnt(0)
 s_waitcnt vmcnt(8)
 v_mfma_f32_16x16x32_bf16 v[40:43], v[112:115], a[208:211], v[40:43]
 ds_read_b128 v[140:143], v4 offset:18432
 v_mfma_f32_16x16x32_bf16 v[76:79], v[112:115], a[212:215], v[76:79]
 ds_read_b128 v[144:147], v4 offset:19456
 v_mfma_f32_16x16x32_bf16 v[44:47], v[116:119], a[208:211], v[44:47]
 v_mfma_f32_16x16x32_bf16 v[80:83], v[116:119], a[212:215], v[80:83]
 ds_read_b128 v[148:151], v4 offset:20480
 v_mfma_f32_16x16x32_bf16 v[48:51], v[120:123], a[208:211], v[48:51]
 ds_read_b128 v[152:155], v4 offset:21504
 v_mfma_f32_16x16x32_bf16 v[84:87], v[120:123], a[212:215], v[84:87]
 v_mfma_f32_16x16x32_bf16 v[52:55], v[124:127], a[208:211], v[52:55]
 ds_read_b128 v[156:159], v4 offset:22528
 v_mfma_f32_16x16x32_bf16 v[88:91], v[124:127], a[212:215], v[88:91]
 ds_read_b128 v[160:163], v4 offset:23552
 v_mfma_f32_16x16x32_bf16 v[56:59], v[128:131], a[208:211], v[56:59]
 v_mfma_f32_16x16x32_bf16 v[92:95], v[128:131], a[212:215], v[92:95]
 s_add_u32 s87, s37, 130048
 buffer_load_dwordx4 a[248:251], v1, s[16:19], s87 offen sc1
 v_mfma_f32_16x16x32_bf16 v[60:63], v[132:135], a[208:211], v[60:63]
 s_add_u32 s87, s37, 277504
 buffer_load_dwordx4 a[252:255], v1, s[16:19], s87 offen sc1
 v_mfma_f32_16x16x32_bf16 v[96:99], v[132:135], a[212:215], v[96:99]
 s_waitcnt lgkmcnt(0)
 s_waitcnt vmcnt(30)
 s_barrier
 s_waitcnt vmcnt(8)
 v_mfma_f32_16x16x32_bf16 v[40:43], v[140:143], a[216:219], v[40:43]
 ds_read_b128 v[112:115], v5 offset:0
 v_mfma_f32_16x16x32_bf16 v[76:79], v[140:143], a[220:223], v[76:79]
 ds_read_b128 v[116:119], v5 offset:1024
 v_mfma_f32_16x16x32_bf16 v[44:47], v[144:147], a[216:219], v[44:47]
 v_mfma_f32_16x16x32_bf16 v[80:83], v[144:147], a[220:223], v[80:83]
 ds_read_b128 v[120:123], v5 offset:2048
 v_mfma_f32_16x16x32_bf16 v[48:51], v[148:151], a[216:219], v[48:51]
 ds_read_b128 v[124:127], v5 offset:3072
 v_mfma_f32_16x16x32_bf16 v[84:87], v[148:151], a[220:223], v[84:87]
 v_mfma_f32_16x16x32_bf16 v[52:55], v[152:155], a[216:219], v[52:55]
 ds_read_b128 v[128:131], v5 offset:4096
 v_mfma_f32_16x16x32_bf16 v[88:91], v[152:155], a[220:223], v[88:91]
 ds_read_b128 v[132:135], v5 offset:5120
 v_mfma_f32_16x16x32_bf16 v[56:59], v[156:159], a[216:219], v[56:59]
 v_mfma_f32_16x16x32_bf16 v[92:95], v[156:159], a[220:223], v[92:95]
 s_add_u32 s87, s37, 143360
 buffer_load_dwordx4 v[8:11], v1, s[16:19], s87 offen sc1
 v_mfma_f32_16x16x32_bf16 v[60:63], v[160:163], a[216:219], v[60:63]
 s_add_u32 s87, s37, 290816
 buffer_load_dwordx4 v[12:15], v1, s[16:19], s87 offen sc1
 v_mfma_f32_16x16x32_bf16 v[96:99], v[160:163], a[220:223], v[96:99]
 s_waitcnt lgkmcnt(0)
 s_waitcnt vmcnt(8)
 v_mfma_f32_16x16x32_bf16 v[40:43], v[112:115], a[224:227], v[40:43]
 ds_read_b128 v[140:143], v5 offset:6144
 v_mfma_f32_16x16x32_bf16 v[76:79], v[112:115], a[228:231], v[76:79]
 ds_read_b128 v[144:147], v5 offset:7168
 v_mfma_f32_16x16x32_bf16 v[44:47], v[116:119], a[224:227], v[44:47]
 v_mfma_f32_16x16x32_bf16 v[80:83], v[116:119], a[228:231], v[80:83]
 ds_read_b128 v[148:151], v5 offset:8192
 v_mfma_f32_16x16x32_bf16 v[48:51], v[120:123], a[224:227], v[48:51]
 ds_read_b128 v[152:155], v5 offset:9216
 v_mfma_f32_16x16x32_bf16 v[84:87], v[120:123], a[228:231], v[84:87]
 v_mfma_f32_16x16x32_bf16 v[52:55], v[124:127], a[224:227], v[52:55]
 ds_read_b128 v[156:159], v5 offset:10240
 v_mfma_f32_16x16x32_bf16 v[88:91], v[124:127], a[228:231], v[88:91]
 ds_read_b128 v[160:163], v5 offset:11264
 v_mfma_f32_16x16x32_bf16 v[56:59], v[128:131], a[224:227], v[56:59]
 v_mfma_f32_16x16x32_bf16 v[92:95], v[128:131], a[228:231], v[92:95]
 s_add_u32 s87, s37, 144384
 buffer_load_dwordx4 v[16:19], v1, s[16:19], s87 offen sc1
 v_mfma_f32_16x16x32_bf16 v[60:63], v[132:135], a[224:227], v[60:63]
 s_add_u32 s87, s37, 291840
 buffer_load_dwordx4 v[20:23], v1, s[16:19], s87 offen sc1
 v_mfma_f32_16x16x32_bf16 v[96:99], v[132:135], a[228:231], v[96:99]
 s_waitcnt lgkmcnt(0)
 s_waitcnt vmcnt(8)
 v_mfma_f32_16x16x32_bf16 v[40:43], v[140:143], a[232:235], v[40:43]
 ds_read_b128 v[112:115], v5 offset:12288
 v_mfma_f32_16x16x32_bf16 v[76:79], v[140:143], a[236:239], v[76:79]
 ds_read_b128 v[116:119], v5 offset:13312
 v_mfma_f32_16x16x32_bf16 v[44:47], v[144:147], a[232:235], v[44:47]
 v_mfma_f32_16x16x32_bf16 v[80:83], v[144:147], a[236:239], v[80:83]
 ds_read_b128 v[120:123], v5 offset:14336
 v_mfma_f32_16x16x32_bf16 v[48:51], v[148:151], a[232:235], v[48:51]
 ds_read_b128 v[124:127], v5 offset:15360
 v_mfma_f32_16x16x32_bf16 v[84:87], v[148:151], a[236:239], v[84:87]
 v_mfma_f32_16x16x32_bf16 v[52:55], v[152:155], a[232:235], v[52:55]
 ds_read_b128 v[128:131], v5 offset:16384
 v_mfma_f32_16x16x32_bf16 v[88:91], v[152:155], a[236:239], v[88:91]
 ds_read_b128 v[132:135], v5 offset:17408
 v_mfma_f32_16x16x32_bf16 v[56:59], v[156:159], a[232:235], v[56:59]
 v_mfma_f32_16x16x32_bf16 v[92:95], v[156:159], a[236:239], v[92:95]
 s_add_u32 s87, s37, 145408
 buffer_load_dwordx4 v[24:27], v1, s[16:19], s87 offen sc1
 v_mfma_f32_16x16x32_bf16 v[60:63], v[160:163], a[232:235], v[60:63]
 s_add_u32 s87, s37, 292864
 buffer_load_dwordx4 v[28:31], v1, s[16:19], s87 offen sc1
 v_mfma_f32_16x16x32_bf16 v[96:99], v[160:163], a[236:239], v[96:99]
 s_waitcnt lgkmcnt(0)
 s_waitcnt vmcnt(8)
 v_mfma_f32_16x16x32_bf16 v[40:43], v[112:115], a[240:243], v[40:43]
 ds_read_b128 v[140:143], v5 offset:18432
 v_mfma_f32_16x16x32_bf16 v[76:79], v[112:115], a[244:247], v[76:79]
 ds_read_b128 v[144:147], v5 offset:19456
 v_mfma_f32_16x16x32_bf16 v[44:47], v[116:119], a[240:243], v[44:47]
 v_mfma_f32_16x16x32_bf16 v[80:83], v[116:119], a[244:247], v[80:83]
 ds_read_b128 v[148:151], v5 offset:20480
 v_mfma_f32_16x16x32_bf16 v[48:51], v[120:123], a[240:243], v[48:51]
 ds_read_b128 v[152:155], v5 offset:21504
 v_mfma_f32_16x16x32_bf16 v[84:87], v[120:123], a[244:247], v[84:87]
 v_mfma_f32_16x16x32_bf16 v[52:55], v[124:127], a[240:243], v[52:55]
 ds_read_b128 v[156:159], v5 offset:22528
 v_mfma_f32_16x16x32_bf16 v[88:91], v[124:127], a[244:247], v[88:91]
 ds_read_b128 v[160:163], v5 offset:23552
 v_mfma_f32_16x16x32_bf16 v[56:59], v[128:131], a[240:243], v[56:59]
 v_mfma_f32_16x16x32_bf16 v[92:95], v[128:131], a[244:247], v[92:95]
 s_add_u32 s87, s37, 146432
 buffer_load_dwordx4 v[32:35], v1, s[16:19], s87 offen sc1
 v_mfma_f32_16x16x32_bf16 v[60:63], v[132:135], a[240:243], v[60:63]
 s_add_u32 s87, s37, 293888
 buffer_load_dwordx4 v[36:39], v1, s[16:19], s87 offen sc1
 v_mfma_f32_16x16x32_bf16 v[96:99], v[132:135], a[244:247], v[96:99]
 s_waitcnt lgkmcnt(0)
 s_waitcnt vmcnt(24)
 s_barrier
 s_waitcnt vmcnt(8)
 v_mfma_f32_16x16x32_bf16 v[40:43], v[140:143], a[248:251], v[40:43]
 ds_read_b128 v[112:115], v2 offset:0
 ds_read_b128 v[116:119], v2 offset:1024
 v_mfma_f32_16x16x32_bf16 v[76:79], v[140:143], a[252:255], v[76:79]
 ds_read_b128 v[120:123], v2 offset:2048
 v_mfma_f32_16x16x32_bf16 v[44:47], v[144:147], a[248:251], v[44:47]
 ds_read_b128 v[124:127], v2 offset:3072
 v_mfma_f32_16x16x32_bf16 v[80:83], v[144:147], a[252:255], v[80:83]
 ds_read_b128 v[128:131], v2 offset:4096
 v_mfma_f32_16x16x32_bf16 v[48:51], v[148:151], a[248:251], v[48:51]
 ds_read_b128 v[132:135], v2 offset:5120
 s_add_u32 s81, s80, 0
 s_and_b32 s82, s81, 15
 s_lshr_b32 s83, s82, 1
 s_lshl_b32 s83, s83, 2
 s_and_b32 s82, s82, 1
 s_add_u32 s83, s83, s82
 s_lshr_b32 s82, s81, 4
 s_lshl_b32 s82, s82, 1
 s_add_u32 s83, s83, s82
 s_add_u32 s83, s83, 96
 s_add_u32 s82, s81, 108
 s_cmp_ge_u32 s81, 32
 s_cselect_b32 s83, s82, s83
 s_mul_i32 s83, s83, 36864
 s_add_u32 s83, s83, s41
 s_add_u32 s40, s83, 6144
 s_mul_i32 s39, s32, 9216
 s_add_u32 m0, s39, 36864
 s_nop 0
 buffer_load_dwordx4 v1, s[12:15], s40 offen offset:0 lds
 v_mfma_f32_16x16x32_bf16 v[84:87], v[148:151], a[252:255], v[84:87]
 buffer_load_dwordx4 v1, s[12:15], s40 offen offset:1024 lds
 v_mfma_f32_16x16x32_bf16 v[52:55], v[152:155], a[248:251], v[52:55]
 buffer_load_dwordx4 v1, s[12:15], s40 offen offset:2048 lds
 v_mfma_f32_16x16x32_bf16 v[88:91], v[152:155], a[252:255], v[88:91]
 s_add_u32 s81, s80, 1
 s_and_b32 s82, s81, 15
 s_lshr_b32 s83, s82, 1
 s_lshl_b32 s83, s83, 2
 s_and_b32 s82, s82, 1
 s_add_u32 s83, s83, s82
 s_lshr_b32 s82, s81, 4
 s_lshl_b32 s82, s82, 1
 s_add_u32 s83, s83, s82
 s_add_u32 s83, s83, 96
 s_add_u32 s82, s81, 108
 s_cmp_ge_u32 s81, 32
 s_cselect_b32 s83, s82, s83
 s_mul_i32 s83, s83, 36864
 s_add_u32 s83, s83, s41
 s_add_u32 s40, s83, 6144
 s_mul_i32 s39, s32, 9216
 s_add_u32 m0, s39, 39936
 s_nop 0
 buffer_load_dwordx4 v1, s[12:15], s40 offen offset:0 lds
 v_mfma_f32_16x16x32_bf16 v[56:59], v[156:159], a[248:251], v[56:59]
 buffer_load_dwordx4 v1, s[12:15], s40 offen offset:1024 lds
 buffer_load_dwordx4 v1, s[12:15], s40 offen offset:2048 lds
 v_mfma_f32_16x16x32_bf16 v[92:95], v[156:159], a[252:255], v[92:95]
 s_add_u32 s81, s80, 2
 s_and_b32 s82, s81, 15
 s_lshr_b32 s83, s82, 1
 s_lshl_b32 s83, s83, 2
 s_and_b32 s82, s82, 1
 s_add_u32 s83, s83, s82
 s_lshr_b32 s82, s81, 4
 s_lshl_b32 s82, s82, 1
 s_add_u32 s83, s83, s82
 s_add_u32 s83, s83, 96
 s_add_u32 s82, s81, 108
 s_cmp_ge_u32 s81, 32
 s_cselect_b32 s83, s82, s83
 s_mul_i32 s83, s83, 36864
 s_add_u32 s83, s83, s41
 s_add_u32 s40, s83, 6144
 s_mul_i32 s39, s32, 9216
 s_add_u32 m0, s39, 43008
 s_nop 0
 buffer_load_dwordx4 v1, s[12:15], s40 offen offset:0 lds
 v_mfma_f32_16x16x32_bf16 v[60:63], v[160:163], a[248:251], v[60:63]
 buffer_load_dwordx4 v1, s[12:15], s40 offen offset:1024 lds
 v_mfma_f32_16x16x32_bf16 v[96:99], v[160:163], a[252:255], v[96:99]
 buffer_load_dwordx4 v1, s[12:15], s40 offen offset:2048 lds
 s_waitcnt lgkmcnt(0)
 s_waitcnt vmcnt(15)
 v_mfma_f32_16x16x32_bf16 v[40:43], v[112:115], v[8:11], v[40:43]
 ds_read_b128 v[140:143], v2 offset:6144
 v_mfma_f32_16x16x32_bf16 v[76:79], v[112:115], v[12:15], v[76:79]
 v_mfma_f32_16x16x32_bf16 v[44:47], v[116:119], v[8:11], v[44:47]
 ds_read_b128 v[144:147], v2 offset:7168
 v_mfma_f32_16x16x32_bf16 v[80:83], v[116:119], v[12:15], v[80:83]
 v_mfma_f32_16x16x32_bf16 v[48:51], v[120:123], v[8:11], v[48:51]
 ds_read_b128 v[148:151], v2 offset:8192
 v_mfma_f32_16x16x32_bf16 v[84:87], v[120:123], v[12:15], v[84:87]
 v_mfma_f32_16x16x32_bf16 v[52:55], v[124:127], v[8:11], v[52:55]
 ds_read_b128 v[152:155], v2 offset:9216
 v_mfma_f32_16x16x32_bf16 v[88:91], v[124:127], v[12:15], v[88:91]
 v_mfma_f32_16x16x32_bf16 v[56:59], v[128:131], v[8:11], v[56:59]
 ds_read_b128 v[156:159], v2 offset:10240
 v_mfma_f32_16x16x32_bf16 v[92:95], v[128:131], v[12:15], v[92:95]
 v_mfma_f32_16x16x32_bf16 v[60:63], v[132:135], v[8:11], v[60:63]
 ds_read_b128 v[160:163], v2 offset:11264
 v_mfma_f32_16x16x32_bf16 v[96:99], v[132:135], v[12:15], v[96:99]
 s_waitcnt lgkmcnt(0)
 s_waitcnt vmcnt(13)
 v_mfma_f32_16x16x32_bf16 v[40:43], v[140:143], v[16:19], v[40:43]
 ds_read_b128 v[112:115], v2 offset:12288
 v_mfma_f32_16x16x32_bf16 v[76:79], v[140:143], v[20:23], v[76:79]
 v_mfma_f32_16x16x32_bf16 v[44:47], v[144:147], v[16:19], v[44:47]
 ds_read_b128 v[116:119], v2 offset:13312
 v_mfma_f32_16x16x32_bf16 v[80:83], v[144:147], v[20:23], v[80:83]
 v_mfma_f32_16x16x32_bf16 v[48:51], v[148:151], v[16:19], v[48:51]
 ds_read_b128 v[120:123], v2 offset:14336
 v_mfma_f32_16x16x32_bf16 v[84:87], v[148:151], v[20:23], v[84:87]
 v_mfma_f32_16x16x32_bf16 v[52:55], v[152:155], v[16:19], v[52:55]
 ds_read_b128 v[124:127], v2 offset:15360
 v_mfma_f32_16x16x32_bf16 v[88:91], v[152:155], v[20:23], v[88:91]
 v_mfma_f32_16x16x32_bf16 v[56:59], v[156:159], v[16:19], v[56:59]
 ds_read_b128 v[128:131], v2 offset:16384
 v_mfma_f32_16x16x32_bf16 v[92:95], v[156:159], v[20:23], v[92:95]
 v_mfma_f32_16x16x32_bf16 v[60:63], v[160:163], v[16:19], v[60:63]
 ds_read_b128 v[132:135], v2 offset:17408
 v_mfma_f32_16x16x32_bf16 v[96:99], v[160:163], v[20:23], v[96:99]
 s_waitcnt lgkmcnt(0)
 s_waitcnt vmcnt(11)
 v_mfma_f32_16x16x32_bf16 v[40:43], v[112:115], v[24:27], v[40:43]
 ds_read_b128 v[140:143], v2 offset:18432
 v_mfma_f32_16x16x32_bf16 v[76:79], v[112:115], v[28:31], v[76:79]
 v_mfma_f32_16x16x32_bf16 v[44:47], v[116:119], v[24:27], v[44:47]
 ds_read_b128 v[144:147], v2 offset:19456
 v_mfma_f32_16x16x32_bf16 v[80:83], v[116:119], v[28:31], v[80:83]
 v_mfma_f32_16x16x32_bf16 v[48:51], v[120:123], v[24:27], v[48:51]
 ds_read_b128 v[148:151], v2 offset:20480
 v_mfma_f32_16x16x32_bf16 v[84:87], v[120:123], v[28:31], v[84:87]
 v_mfma_f32_16x16x32_bf16 v[52:55], v[124:127], v[24:27], v[52:55]
 ds_read_b128 v[152:155], v2 offset:21504
 v_mfma_f32_16x16x32_bf16 v[88:91], v[124:127], v[28:31], v[88:91]
 v_mfma_f32_16x16x32_bf16 v[56:59], v[128:131], v[24:27], v[56:59]
 ds_read_b128 v[156:159], v2 offset:22528
 v_mfma_f32_16x16x32_bf16 v[92:95], v[128:131], v[28:31], v[92:95]
 v_mfma_f32_16x16x32_bf16 v[60:63], v[132:135], v[24:27], v[60:63]
 ds_read_b128 v[160:163], v2 offset:23552
 v_mfma_f32_16x16x32_bf16 v[96:99], v[132:135], v[28:31], v[96:99]
 s_waitcnt lgkmcnt(0)
 s_waitcnt vmcnt(0)
 s_barrier
 s_waitcnt vmcnt(9)
 v_mfma_f32_16x16x32_bf16 v[40:43], v[140:143], v[32:35], v[40:43]
 ds_read_b128 v[112:115], v3 offset:0
 v_mfma_f32_16x16x32_bf16 v[76:79], v[140:143], v[36:39], v[76:79]
 ds_read_b128 v[116:119], v3 offset:1024
 v_mfma_f32_16x16x32_bf16 v[44:47], v[144:147], v[32:35], v[44:47]
 ds_read_b128 v[120:123], v3 offset:2048
 v_mfma_f32_16x16x32_bf16 v[80:83], v[144:147], v[36:39], v[80:83]
 s_add_u32 s81, s80, 12
 s_and_b32 s82, s81, 15
 s_lshr_b32 s83, s82, 1
 s_lshl_b32 s83, s83, 2
 s_and_b32 s82, s82, 1
 s_add_u32 s83, s83, s82
 s_lshr_b32 s82, s81, 4
 s_lshl_b32 s82, s82, 1
 s_add_u32 s83, s83, s82
 s_add_u32 s83, s83, 96
 s_add_u32 s82, s81, 108
 s_cmp_ge_u32 s81, 32
 s_cselect_b32 s83, s82, s83
 s_mul_i32 s83, s83, 36864
 s_add_u32 s83, s83, s41
 s_add_u32 s40, s83, 6144
 s_mul_i32 s39, s32, 9216
 s_add_u32 m0, s39, 73728
 s_nop 0
 buffer_load_dwordx4 v1, s[12:15], s40 offen offset:0 lds
 v_mfma_f32_16x16x32_bf16 v[48:51], v[148:151], v[32:35], v[48:51]
 buffer_load_dwordx4 v1, s[12:15], s40 offen offset:1024 lds
 v_mfma_f32_16x16x32_bf16 v[84:87], v[148:151], v[36:39], v[84:87]
 buffer_load_dwordx4 v1, s[12:15], s40 offen offset:2048 lds
 v_mfma_f32_16x16x32_bf16 v[52:55], v[152:155], v[32:35], v[52:55]
 s_add_u32 s81, s80, 13
 s_and_b32 s82, s81, 15
 s_lshr_b32 s83, s82, 1
 s_lshl_b32 s83, s83, 2
 s_and_b32 s82, s82, 1
 s_add_u32 s83, s83, s82
 s_lshr_b32 s82, s81, 4
 s_lshl_b32 s82, s82, 1
 s_add_u32 s83, s83, s82
 s_add_u32 s83, s83, 96
 s_add_u32 s82, s81, 108
 s_cmp_ge_u32 s81, 32
 s_cselect_b32 s83, s82, s83
 s_mul_i32 s83, s83, 36864
 s_add_u32 s83, s83, s41
 s_add_u32 s40, s83, 6144
 s_mul_i32 s39, s32, 9216
 s_add_u32 m0, s39, 76800
 s_nop 0
 buffer_load_dwordx4 v1, s[12:15], s40 offen offset:0 lds
 v_mfma_f32_16x16x32_bf16 v[88:91], v[152:155], v[36:39], v[88:91]
 buffer_load_dwordx4 v1, s[12:15], s40 offen offset:1024 lds
 v_mfma_f32_16x16x32_bf16 v[56:59], v[156:159], v[32:35], v[56:59]
 buffer_load_dwordx4 v1, s[12:15], s40 offen offset:2048 lds
 v_mfma_f32_16x16x32_bf16 v[92:95], v[156:159], v[36:39], v[92:95]
 s_add_u32 s81, s80, 14
 s_and_b32 s82, s81, 15
 s_lshr_b32 s83, s82, 1
 s_lshl_b32 s83, s83, 2
 s_and_b32 s82, s82, 1
 s_add_u32 s83, s83, s82
 s_lshr_b32 s82, s81, 4
 s_lshl_b32 s82, s82, 1
 s_add_u32 s83, s83, s82
 s_add_u32 s83, s83, 96
 s_add_u32 s82, s81, 108
 s_cmp_ge_u32 s81, 32
 s_cselect_b32 s83, s82, s83
 s_mul_i32 s83, s83, 36864
 s_add_u32 s83, s83, s41
 s_add_u32 s40, s83, 6144
 s_mul_i32 s39, s32, 9216
 s_add_u32 m0, s39, 79872
 s_nop 0
 buffer_load_dwordx4 v1, s[12:15], s40 offen offset:0 lds
 v_mfma_f32_16x16x32_bf16 v[60:63], v[160:163], v[32:35], v[60:63]
 buffer_load_dwordx4 v1, s[12:15], s40 offen offset:1024 lds
 v_mfma_f32_16x16x32_bf16 v[96:99], v[160:163], v[36:39], v[96:99]
 buffer_load_dwordx4 v1, s[12:15], s40 offen offset:2048 lds
 s_waitcnt lgkmcnt(0)
 v_mfma_f32_16x16x32_bf16 v[64:67], v[112:115], a[0:3], 0
 ds_read_b128 v[124:127], v3 offset:3072
 ds_read_b128 v[128:131], v3 offset:4096
 v_mfma_f32_16x16x32_bf16 v[100:103], v[112:115], a[4:7], 0
 ds_read_b128 v[132:135], v3 offset:5120
 ds_read_b128 v[136:139], v3 offset:6144
 v_mfma_f32_16x16x32_bf16 v[68:71], v[116:119], a[0:3], 0
 ds_read_b128 v[140:143], v3 offset:7168
 ds_read_b128 v[144:147], v3 offset:8192
 v_mfma_f32_16x16x32_bf16 v[104:107], v[116:119], a[4:7], 0
 ds_read_b128 v[148:151], v3 offset:9216
 ds_read_b128 v[152:155], v3 offset:10240
 v_mfma_f32_16x16x32_bf16 v[72:75], v[120:123], a[0:3], 0
 ds_read_b128 v[156:159], v3 offset:11264
 v_lshrrev_b32 v224, 4, v0
 v_mfma_f32_16x16x32_bf16 v[108:111], v[120:123], a[4:7], 0
 v_lshlrev_b32 v224, 4, v224
 s_add_u32 s39, s58, 0
 s_and_b32 s40, s39, 1
 s_lshl_b32 s40, s40, 3
 s_lshr_b32 s39, s39, 1
 s_lshl_b32 s39, s39, 10
 s_add_u32 s39, s39, s40
 s_mul_i32 s40, s57, 18432
 s_add_u32 s39, s39, s40
 buffer_load_dwordx2 v[200:201], v1, s[44:47], s39 offen sc1
 s_add_u32 s39, s39, 18432
 s_waitcnt lgkmcnt(6)
 v_mfma_f32_16x16x32_bf16 v[64:67], v[124:127], a[8:11], v[64:67]
 v_cvt_pk_bf16_f32 v168, v40, v41
 v_cvt_pk_bf16_f32 v169, v42, v43
 v_cvt_pk_bf16_f32 v170, v44, v45
 v_mfma_f32_16x16x32_bf16 v[100:103], v[124:127], a[12:15], v[100:103]
 v_cvt_pk_bf16_f32 v171, v46, v47
 v_cvt_pk_bf16_f32 v172, v76, v77
 v_mfma_f32_16x16x32_bf16 v[68:71], v[128:131], a[8:11], v[68:71]
 v_cvt_pk_bf16_f32 v173, v78, v79
 v_cvt_pk_bf16_f32 v174, v80, v81
 v_mfma_f32_16x16x32_bf16 v[104:107], v[128:131], a[12:15], v[104:107]
 v_cvt_pk_bf16_f32 v175, v82, v83
 ds_read_b128 v[112:115], v3 offset:12288
 ds_read_b128 v[116:119], v3 offset:13312
 v_mfma_f32_16x16x32_bf16 v[72:75], v[132:135], a[8:11], v[72:75]
 ds_read_b128 v[120:123], v3 offset:14336
 buffer_load_dwordx2 v[202:203], v1, s[44:47], s39 offen sc1
 v_mfma_f32_16x16x32_bf16 v[108:111], v[132:135], a[12:15], v[108:111]
 s_add_u32 s39, s58, 0
 s_lshl_b32 s39, s39, 6
 s_add_u32 s39, s39, 11520
 buffer_load_dwordx4 v[212:215], v224, s[48:51], s39 offen
 s_add_u32 s39, s58, 1
 s_and_b32 s40, s39, 1
 s_lshl_b32 s40, s40, 3
 s_lshr_b32 s39, s39, 1
 s_lshl_b32 s39, s39, 10
 s_add_u32 s39, s39, s40
 s_mul_i32 s40, s57, 18432
 s_add_u32 s39, s39, s40
 buffer_load_dwordx2 v[204:205], v1, s[44:47], s39 offen sc1
 s_add_u32 s39, s39, 18432
 s_waitcnt lgkmcnt(6)
 v_mfma_f32_16x16x32_bf16 v[64:67], v[136:139], a[16:19], v[64:67]
 s_lshl_b32 s43, s42, 2
 s_add_u32 s43, s43, 0
 s_lshl_b32 s43, s43, 2
 s_add_u32 s43, s43, 3
 s_lshl_b32 s43, s43, 2
 s_add_u32 s43, s43, s32
 s_mul_i32 s43, s43, 3072
 buffer_store_dwordx4 v[168:171], v1, s[24:27], s43 offen offset:0 sc1
 buffer_store_dwordx4 v[172:175], v1, s[24:27], s43 offen offset:1024 sc1
 v_cvt_pk_bf16_f32 v176, v48, v49
 v_mfma_f32_16x16x32_bf16 v[100:103], v[136:139], a[20:23], v[100:103]
 v_cvt_pk_bf16_f32 v177, v50, v51
 v_cvt_pk_bf16_f32 v178, v52, v53
 v_mfma_f32_16x16x32_bf16 v[68:71], v[140:143], a[16:19], v[68:71]
 v_cvt_pk_bf16_f32 v179, v54, v55
 v_cvt_pk_bf16_f32 v180, v84, v85
 v_mfma_f32_16x16x32_bf16 v[104:107], v[140:143], a[20:23], v[104:107]
 v_cvt_pk_bf16_f32 v181, v86, v87
 ds_read_b128 v[124:127], v3 offset:15360
 ds_read_b128 v[128:131], v3 offset:16384
 v_mfma_f32_16x16x32_bf16 v[72:75], v[144:147], a[16:19], v[72:75]
 ds_read_b128 v[132:135], v3 offset:17408
 buffer_load_dwordx2 v[206:207], v1, s[44:47], s39 offen sc1
 v_mfma_f32_16x16x32_bf16 v[108:111], v[144:147], a[20:23], v[108:111]
 s_add_u32 s39, s58, 1
 s_lshl_b32 s39, s39, 6
 s_add_u32 s39, s39, 11520
 buffer_load_dwordx4 v[216:219], v224, s[48:51], s39 offen
 s_add_u32 s39, s58, 2
 s_and_b32 s40, s39, 1
 s_lshl_b32 s40, s40, 3
 s_lshr_b32 s39, s39, 1
 s_lshl_b32 s39, s39, 10
 s_add_u32 s39, s39, s40
 s_mul_i32 s40, s57, 18432
 s_add_u32 s39, s39, s40
 buffer_load_dwordx2 v[208:209], v1, s[44:47], s39 offen sc1
 s_add_u32 s39, s39, 18432
 s_waitcnt lgkmcnt(6)
 v_mfma_f32_16x16x32_bf16 v[64:67], v[148:151], a[24:27], v[64:67]
 v_cvt_pk_bf16_f32 v182, v88, v89
 v_cvt_pk_bf16_f32 v183, v90, v91
 s_lshl_b32 s43, s42, 2
 s_add_u32 s43, s43, 1
 s_lshl_b32 s43, s43, 2
 s_add_u32 s43, s43, 3
 s_lshl_b32 s43, s43, 2
 s_add_u32 s43, s43, s32
 s_mul_i32 s43, s43, 3072
 buffer_store_dwordx4 v[176:179], v1, s[24:27], s43 offen offset:0 sc1
 v_mfma_f32_16x16x32_bf16 v[100:103], v[148:151], a[28:31], v[100:103]
 buffer_store_dwordx4 v[180:183], v1, s[24:27], s43 offen offset:1024 sc1
 v_cvt_pk_bf16_f32 v184, v56, v57
 v_mfma_f32_16x16x32_bf16 v[68:71], v[152:155], a[24:27], v[68:71]
 v_cvt_pk_bf16_f32 v185, v58, v59
 v_cvt_pk_bf16_f32 v186, v60, v61
 v_mfma_f32_16x16x32_bf16 v[104:107], v[152:155], a[28:31], v[104:107]
 v_cvt_pk_bf16_f32 v187, v62, v63
 ds_read_b128 v[136:139], v3 offset:18432
 v_mfma_f32_16x16x32_bf16 v[72:75], v[156:159], a[24:27], v[72:75]
 ds_read_b128 v[140:143], v3 offset:19456
 ds_read_b128 v[144:147], v3 offset:20480
 v_mfma_f32_16x16x32_bf16 v[108:111], v[156:159], a[28:31], v[108:111]
 buffer_load_dwordx2 v[210:211], v1, s[44:47], s39 offen sc1
 s_add_u32 s39, s58, 2
 s_lshl_b32 s39, s39, 6
 s_add_u32 s39, s39, 11520
 buffer_load_dwordx4 v[220:223], v224, s[48:51], s39 offen
 s_waitcnt lgkmcnt(6)
 v_mfma_f32_16x16x32_bf16 v[64:67], v[112:115], a[32:35], v[64:67]
 v_cvt_pk_bf16_f32 v188, v92, v93
 v_cvt_pk_bf16_f32 v189, v94, v95
 v_mfma_f32_16x16x32_bf16 v[100:103], v[112:115], a[36:39], v[100:103]
 v_cvt_pk_bf16_f32 v190, v96, v97
 v_mfma_f32_16x16x32_bf16 v[68:71], v[116:119], a[32:35], v[68:71]
 v_cvt_pk_bf16_f32 v191, v98, v99
 s_lshl_b32 s43, s42, 2
 s_add_u32 s43, s43, 2
 s_lshl_b32 s43, s43, 2
 s_add_u32 s43, s43, 3
 s_lshl_b32 s43, s43, 2
 s_add_u32 s43, s43, s32
 s_mul_i32 s43, s43, 3072
 buffer_store_dwordx4 v[184:187], v1, s[24:27], s43 offen offset:0 sc1
 v_mfma_f32_16x16x32_bf16 v[104:107], v[116:119], a[36:39], v[104:107]
 buffer_store_dwordx4 v[188:191], v1, s[24:27], s43 offen offset:1024 sc1
 v_mfma_f32_16x16x32_bf16 v[72:75], v[120:123], a[32:35], v[72:75]
 ds_read_b128 v[148:151], v3 offset:21504
 ds_read_b128 v[152:155], v3 offset:22528
 v_mfma_f32_16x16x32_bf16 v[108:111], v[120:123], a[36:39], v[108:111]
 ds_read_b128 v[156:159], v3 offset:23552
 s_waitcnt lgkmcnt(6)
 v_mfma_f32_16x16x32_bf16 v[64:67], v[124:127], a[40:43], v[64:67]
 ds_read_b128 v[112:115], v3 offset:24576
 v_mfma_f32_16x16x32_bf16 v[100:103], v[124:127], a[44:47], v[100:103]
 v_mfma_f32_16x16x32_bf16 v[68:71], v[128:131], a[40:43], v[68:71]
 ds_read_b128 v[116:119], v3 offset:25600
 v_mfma_f32_16x16x32_bf16 v[104:107], v[128:131], a[44:47], v[104:107]
 v_mfma_f32_16x16x32_bf16 v[72:75], v[132:135], a[40:43], v[72:75]
 ds_read_b128 v[120:123], v3 offset:26624
 v_mfma_f32_16x16x32_bf16 v[108:111], v[132:135], a[44:47], v[108:111]
 s_waitcnt lgkmcnt(6)
 v_mfma_f32_16x16x32_bf16 v[64:67], v[136:139], a[48:51], v[64:67]
 ds_read_b128 v[124:127], v3 offset:27648
 v_mfma_f32_16x16x32_bf16 v[100:103], v[136:139], a[52:55], v[100:103]
 v_mfma_f32_16x16x32_bf16 v[68:71], v[140:143], a[48:51], v[68:71]
 ds_read_b128 v[128:131], v3 offset:28672
 v_mfma_f32_16x16x32_bf16 v[104:107], v[140:143], a[52:55], v[104:107]
 v_mfma_f32_16x16x32_bf16 v[72:75], v[144:147], a[48:51], v[72:75]
 ds_read_b128 v[132:135], v3 offset:29696
 v_mfma_f32_16x16x32_bf16 v[108:111], v[144:147], a[52:55], v[108:111]
 s_waitcnt lgkmcnt(6)
 v_mfma_f32_16x16x32_bf16 v[64:67], v[148:151], a[56:59], v[64:67]
 ds_read_b128 v[136:139], v3 offset:30720
 v_mfma_f32_16x16x32_bf16 v[100:103], v[148:151], a[60:63], v[100:103]
 v_mfma_f32_16x16x32_bf16 v[68:71], v[152:155], a[56:59], v[68:71]
 ds_read_b128 v[140:143], v3 offset:31744
 v_mfma_f32_16x16x32_bf16 v[104:107], v[152:155], a[60:63], v[104:107]
 v_mfma_f32_16x16x32_bf16 v[72:75], v[156:159], a[56:59], v[72:75]
 ds_read_b128 v[144:147], v3 offset:32768
 v_mfma_f32_16x16x32_bf16 v[108:111], v[156:159], a[60:63], v[108:111]
 s_waitcnt lgkmcnt(6)
 v_mfma_f32_16x16x32_bf16 v[64:67], v[112:115], a[64:67], v[64:67]
 ds_read_b128 v[148:151], v3 offset:33792
 v_mfma_f32_16x16x32_bf16 v[100:103], v[112:115], a[68:71], v[100:103]
 v_mfma_f32_16x16x32_bf16 v[68:71], v[116:119], a[64:67], v[68:71]
 ds_read_b128 v[152:155], v3 offset:34816
 v_mfma_f32_16x16x32_bf16 v[104:107], v[116:119], a[68:71], v[104:107]
 v_mfma_f32_16x16x32_bf16 v[72:75], v[120:123], a[64:67], v[72:75]
 ds_read_b128 v[156:159], v3 offset:35840
 v_mfma_f32_16x16x32_bf16 v[108:111], v[120:123], a[68:71], v[108:111]
 s_waitcnt lgkmcnt(0)
 s_waitcnt vmcnt(15)
 s_barrier
 v_mfma_f32_16x16x32_bf16 v[64:67], v[124:127], a[72:75], v[64:67]
 ds_read_b128 v[112:115], v4 offset:0
 v_mfma_f32_16x16x32_bf16 v[100:103], v[124:127], a[76:79], v[100:103]
 ds_read_b128 v[116:119], v4 offset:1024
 v_mfma_f32_16x16x32_bf16 v[68:71], v[128:131], a[72:75], v[68:71]
 ds_read_b128 v[120:123], v4 offset:2048
 v_mfma_f32_16x16x32_bf16 v[104:107], v[128:131], a[76:79], v[104:107]
 s_add_u32 s81, s80, 24
 s_and_b32 s82, s81, 15
 s_lshr_b32 s83, s82, 1
 s_lshl_b32 s83, s83, 2
 s_and_b32 s82, s82, 1
 s_add_u32 s83, s83, s82
 s_lshr_b32 s82, s81, 4
 s_lshl_b32 s82, s82, 1
 s_add_u32 s83, s83, s82
 s_add_u32 s83, s83, 96
 s_add_u32 s82, s81, 108
 s_cmp_ge_u32 s81, 32
 s_cselect_b32 s83, s82, s83
 s_mul_i32 s83, s83, 36864
 s_add_u32 s83, s83, s41
 s_add_u32 s40, s83, 6144
 s_mul_i32 s39, s32, 9216
 s_add_u32 m0, s39, 110592
 s_nop 0
 buffer_load_dwordx4 v1, s[12:15], s40 offen offset:0 lds
 v_mfma_f32_16x16x32_bf16 v[72:75], v[132:135], a[72:75], v[72:75]
 buffer_load_dwordx4 v1, s[12:15], s40 offen offset:1024 lds
 v_mfma_f32_16x16x32_bf16 v[108:111], v[132:135], a[76:79], v[108:111]
 buffer_load_dwordx4 v1, s[12:15], s40 offen offset:2048 lds
 s_waitcnt lgkmcnt(3)
 v_mfma_f32_16x16x32_bf16 v[64:67], v[136:139], a[80:83], v[64:67]
 ds_read_b128 v[124:127], v4 offset:3072
 v_mfma_f32_16x16x32_bf16 v[100:103], v[136:139], a[84:87], v[100:103]
 ds_read_b128 v[128:131], v4 offset:4096
 v_mfma_f32_16x16x32_bf16 v[68:71], v[140:143], a[80:83], v[68:71]
 ds_read_b128 v[132:135], v4 offset:5120
 v_mfma_f32_16x16x32_bf16 v[104:107], v[140:143], a[84:87], v[104:107]
 s_add_u32 s81, s80, 25
 s_and_b32 s82, s81, 15
 s_lshr_b32 s83, s82, 1
 s_lshl_b32 s83, s83, 2
 s_and_b32 s82, s82, 1
 s_add_u32 s83, s83, s82
 s_lshr_b32 s82, s81, 4
 s_lshl_b32 s82, s82, 1
 s_add_u32 s83, s83, s82
 s_add_u32 s83, s83, 96
 s_add_u32 s82, s81, 108
 s_cmp_ge_u32 s81, 32
 s_cselect_b32 s83, s82, s83
 s_mul_i32 s83, s83, 36864
 s_add_u32 s83, s83, s41
 s_add_u32 s40, s83, 6144
 s_mul_i32 s39, s32, 9216
 s_add_u32 m0, s39, 113664
 s_nop 0
 buffer_load_dwordx4 v1, s[12:15], s40 offen offset:0 lds
 v_mfma_f32_16x16x32_bf16 v[72:75], v[144:147], a[80:83], v[72:75]
 buffer_load_dwordx4 v1, s[12:15], s40 offen offset:1024 lds
 v_mfma_f32_16x16x32_bf16 v[108:111], v[144:147], a[84:87], v[108:111]
 buffer_load_dwordx4 v1, s[12:15], s40 offen offset:2048 lds
 s_waitcnt lgkmcnt(6)
 v_mfma_f32_16x16x32_bf16 v[64:67], v[148:151], a[88:91], v[64:67]
 ds_read_b128 v[136:139], v4 offset:6144
 v_mfma_f32_16x16x32_bf16 v[100:103], v[148:151], a[92:95], v[100:103]
 ds_read_b128 v[140:143], v4 offset:7168
 v_mfma_f32_16x16x32_bf16 v[68:71], v[152:155], a[88:91], v[68:71]
 ds_read_b128 v[144:147], v4 offset:8192
 v_mfma_f32_16x16x32_bf16 v[104:107], v[152:155], a[92:95], v[104:107]
 s_add_u32 s81, s80, 26
 s_and_b32 s82, s81, 15
 s_lshr_b32 s83, s82, 1
 s_lshl_b32 s83, s83, 2
 s_and_b32 s82, s82, 1
 s_add_u32 s83, s83, s82
 s_lshr_b32 s82, s81, 4
 s_lshl_b32 s82, s82, 1
 s_add_u32 s83, s83, s82
 s_add_u32 s83, s83, 96
 s_add_u32 s82, s81, 108
 s_cmp_ge_u32 s81, 32
 s_cselect_b32 s83, s82, s83
 s_mul_i32 s83, s83, 36864
 s_add_u32 s83, s83, s41
 s_add_u32 s40, s83, 6144
 s_mul_i32 s39, s32, 9216
 s_add_u32 m0, s39, 116736
 s_nop 0
 buffer_load_dwordx4 v1, s[12:15], s40 offen offset:0 lds
 v_mfma_f32_16x16x32_bf16 v[72:75], v[156:159], a[88:91], v[72:75]
 buffer_load_dwordx4 v1, s[12:15], s40 offen offset:1024 lds
 v_mfma_f32_16x16x32_bf16 v[108:111], v[156:159], a[92:95], v[108:111]
 buffer_load_dwordx4 v1, s[12:15], s40 offen offset:2048 lds
 s_waitcnt lgkmcnt(6)
 v_mfma_f32_16x16x32_bf16 v[64:67], v[112:115], a[96:99], v[64:67]
 ds_read_b128 v[148:151], v4 offset:9216
 v_mfma_f32_16x16x32_bf16 v[100:103], v[112:115], a[100:103], v[100:103]
 v_mfma_f32_16x16x32_bf16 v[68:71], v[116:119], a[96:99], v[68:71]
 ds_read_b128 v[152:155], v4 offset:10240
 v_mfma_f32_16x16x32_bf16 v[104:107], v[116:119], a[100:103], v[104:107]
 v_mfma_f32_16x16x32_bf16 v[72:75], v[120:123], a[96:99], v[72:75]
 ds_read_b128 v[156:159], v4 offset:11264
 v_mfma_f32_16x16x32_bf16 v[108:111], v[120:123], a[100:103], v[108:111]
 s_waitcnt lgkmcnt(6)
 v_mfma_f32_16x16x32_bf16 v[64:67], v[124:127], a[104:107], v[64:67]
 ds_read_b128 v[112:115], v4 offset:12288
 v_mfma_f32_16x16x32_bf16 v[100:103], v[124:127], a[108:111], v[100:103]
 v_mfma_f32_16x16x32_bf16 v[68:71], v[128:131], a[104:107], v[68:71]
 ds_read_b128 v[116:119], v4 offset:13312
 v_mfma_f32_16x16x32_bf16 v[104:107], v[128:131], a[108:111], v[104:107]
 v_mfma_f32_16x16x32_bf16 v[72:75], v[132:135], a[104:107], v[72:75]
 ds_read_b128 v[120:123], v4 offset:14336
 v_mfma_f32_16x16x32_bf16 v[108:111], v[132:135], a[108:111], v[108:111]
 s_waitcnt lgkmcnt(6)
 v_mfma_f32_16x16x32_bf16 v[64:67], v[136:139], a[112:115], v[64:67]
 ds_read_b128 v[124:127], v4 offset:15360
 v_mfma_f32_16x16x32_bf16 v[100:103], v[136:139], a[116:119], v[100:103]
 v_mfma_f32_16x16x32_bf16 v[68:71], v[140:143], a[112:115], v[68:71]
 ds_read_b128 v[128:131], v4 offset:16384
 v_mfma_f32_16x16x32_bf16 v[104:107], v[140:143], a[116:119], v[104:107]
 v_mfma_f32_16x16x32_bf16 v[72:75], v[144:147], a[112:115], v[72:75]
 ds_read_b128 v[132:135], v4 offset:17408
 v_mfma_f32_16x16x32_bf16 v[108:111], v[144:147], a[116:119], v[108:111]
 s_waitcnt lgkmcnt(6)
 v_mfma_f32_16x16x32_bf16 v[64:67], v[148:151], a[120:123], v[64:67]
 ds_read_b128 v[136:139], v4 offset:18432
 v_mfma_f32_16x16x32_bf16 v[100:103], v[148:151], a[124:127], v[100:103]
 v_mfma_f32_16x16x32_bf16 v[68:71], v[152:155], a[120:123], v[68:71]
 ds_read_b128 v[140:143], v4 offset:19456
 v_mfma_f32_16x16x32_bf16 v[104:107], v[152:155], a[124:127], v[104:107]
 v_mfma_f32_16x16x32_bf16 v[72:75], v[156:159], a[120:123], v[72:75]
 ds_read_b128 v[144:147], v4 offset:20480
 v_mfma_f32_16x16x32_bf16 v[108:111], v[156:159], a[124:127], v[108:111]
 s_waitcnt lgkmcnt(6)
 v_mfma_f32_16x16x32_bf16 v[64:67], v[112:115], a[128:131], v[64:67]
 ds_read_b128 v[148:151], v4 offset:21504
 v_mfma_f32_16x16x32_bf16 v[100:103], v[112:115], a[132:135], v[100:103]
 v_mfma_f32_16x16x32_bf16 v[68:71], v[116:119], a[128:131], v[68:71]
 ds_read_b128 v[152:155], v4 offset:22528
 v_mfma_f32_16x16x32_bf16 v[104:107], v[116:119], a[132:135], v[104:107]
 v_mfma_f32_16x16x32_bf16 v[72:75], v[120:123], a[128:131], v[72:75]
 ds_read_b128 v[156:159], v4 offset:23552
 v_mfma_f32_16x16x32_bf16 v[108:111], v[120:123], a[132:135], v[108:111]
 s_waitcnt lgkmcnt(6)
 v_mfma_f32_16x16x32_bf16 v[64:67], v[124:127], a[136:139], v[64:67]
 ds_read_b128 v[112:115], v4 offset:24576
 v_mfma_f32_16x16x32_bf16 v[100:103], v[124:127], a[140:143], v[100:103]
 v_mfma_f32_16x16x32_bf16 v[68:71], v[128:131], a[136:139], v[68:71]
 ds_read_b128 v[116:119], v4 offset:25600
 v_mfma_f32_16x16x32_bf16 v[104:107], v[128:131], a[140:143], v[104:107]
 v_mfma_f32_16x16x32_bf16 v[72:75], v[132:135], a[136:139], v[72:75]
 ds_read_b128 v[120:123], v4 offset:26624
 v_mfma_f32_16x16x32_bf16 v[108:111], v[132:135], a[140:143], v[108:111]
 s_waitcnt lgkmcnt(6)
 v_mfma_f32_16x16x32_bf16 v[64:67], v[136:139], a[144:147], v[64:67]
 ds_read_b128 v[124:127], v4 offset:27648
 v_mfma_f32_16x16x32_bf16 v[100:103], v[136:139], a[148:151], v[100:103]
 v_mfma_f32_16x16x32_bf16 v[68:71], v[140:143], a[144:147], v[68:71]
 ds_read_b128 v[128:131], v4 offset:28672
 v_mfma_f32_16x16x32_bf16 v[104:107], v[140:143], a[148:151], v[104:107]
 v_mfma_f32_16x16x32_bf16 v[72:75], v[144:147], a[144:147], v[72:75]
 ds_read_b128 v[132:135], v4 offset:29696
 v_mfma_f32_16x16x32_bf16 v[108:111], v[144:147], a[148:151], v[108:111]
 s_waitcnt lgkmcnt(6)
 v_mfma_f32_16x16x32_bf16 v[64:67], v[148:151], a[152:155], v[64:67]
 ds_read_b128 v[136:139], v4 offset:30720
 v_mfma_f32_16x16x32_bf16 v[100:103], v[148:151], a[156:159], v[100:103]
 v_mfma_f32_16x16x32_bf16 v[68:71], v[152:155], a[152:155], v[68:71]
 ds_read_b128 v[140:143], v4 offset:31744
 v_mfma_f32_16x16x32_bf16 v[104:107], v[152:155], a[156:159], v[104:107]
 v_mfma_f32_16x16x32_bf16 v[72:75], v[156:159], a[152:155], v[72:75]
 ds_read_b128 v[144:147], v4 offset:32768
 v_mfma_f32_16x16x32_bf16 v[108:111], v[156:159], a[156:159], v[108:111]
 s_waitcnt lgkmcnt(6)
 v_mfma_f32_16x16x32_bf16 v[64:67], v[112:115], a[160:163], v[64:67]
 ds_read_b128 v[148:151], v4 offset:33792
 v_mfma_f32_16x16x32_bf16 v[100:103], v[112:115], a[164:167], v[100:103]
 v_mfma_f32_16x16x32_bf16 v[68:71], v[116:119], a[160:163], v[68:71]
 ds_read_b128 v[152:155], v4 offset:34816
 v_mfma_f32_16x16x32_bf16 v[104:107], v[116:119], a[164:167], v[104:107]
 v_mfma_f32_16x16x32_bf16 v[72:75], v[120:123], a[160:163], v[72:75]
 ds_read_b128 v[156:159], v4 offset:35840
 v_mfma_f32_16x16x32_bf16 v[108:111], v[120:123], a[164:167], v[108:111]
 s_waitcnt lgkmcnt(0)
 s_waitcnt vmcnt(0)
 s_barrier
 v_mfma_f32_16x16x32_bf16 v[64:67], v[124:127], a[168:171], v[64:67]
 ds_read_b128 v[112:115], v5 offset:0
 v_mfma_f32_16x16x32_bf16 v[100:103], v[124:127], a[172:175], v[100:103]
 v_mfma_f32_16x16x32_bf16 v[68:71], v[128:131], a[168:171], v[68:71]
 ds_read_b128 v[116:119], v5 offset:1024
 v_mfma_f32_16x16x32_bf16 v[104:107], v[128:131], a[172:175], v[104:107]
 v_mfma_f32_16x16x32_bf16 v[72:75], v[132:135], a[168:171], v[72:75]
 ds_read_b128 v[120:123], v5 offset:2048
 v_mfma_f32_16x16x32_bf16 v[108:111], v[132:135], a[172:175], v[108:111]
 s_waitcnt lgkmcnt(3)
 v_mfma_f32_16x16x32_bf16 v[64:67], v[136:139], a[176:179], v[64:67]
 ds_read_b128 v[124:127], v5 offset:3072
 v_mfma_f32_16x16x32_bf16 v[100:103], v[136:139], a[180:183], v[100:103]
 v_mfma_f32_16x16x32_bf16 v[68:71], v[140:143], a[176:179], v[68:71]
 ds_read_b128 v[128:131], v5 offset:4096
 v_mfma_f32_16x16x32_bf16 v[104:107], v[140:143], a[180:183], v[104:107]
 v_mfma_f32_16x16x32_bf16 v[72:75], v[144:147], a[176:179], v[72:75]
 ds_read_b128 v[132:135], v5 offset:5120
 v_mfma_f32_16x16x32_bf16 v[108:111], v[144:147], a[180:183], v[108:111]
 s_waitcnt lgkmcnt(6)
 v_mfma_f32_16x16x32_bf16 v[64:67], v[148:151], a[184:187], v[64:67]
 ds_read_b128 v[136:139], v5 offset:6144
 v_mfma_f32_16x16x32_bf16 v[100:103], v[148:151], a[188:191], v[100:103]
 v_mfma_f32_16x16x32_bf16 v[68:71], v[152:155], a[184:187], v[68:71]
 ds_read_b128 v[140:143], v5 offset:7168
 v_mfma_f32_16x16x32_bf16 v[104:107], v[152:155], a[188:191], v[104:107]
 v_mfma_f32_16x16x32_bf16 v[72:75], v[156:159], a[184:187], v[72:75]
 ds_read_b128 v[144:147], v5 offset:8192
 v_mfma_f32_16x16x32_bf16 v[108:111], v[156:159], a[188:191], v[108:111]
 s_waitcnt lgkmcnt(6)
 v_mfma_f32_16x16x32_bf16 v[64:67], v[112:115], a[192:195], v[64:67]
 ds_read_b128 v[148:151], v5 offset:9216
 v_mfma_f32_16x16x32_bf16 v[100:103], v[112:115], a[196:199], v[100:103]
 v_mfma_f32_16x16x32_bf16 v[68:71], v[116:119], a[192:195], v[68:71]
 ds_read_b128 v[152:155], v5 offset:10240
 v_mfma_f32_16x16x32_bf16 v[104:107], v[116:119], a[196:199], v[104:107]
 v_mfma_f32_16x16x32_bf16 v[72:75], v[120:123], a[192:195], v[72:75]
 ds_read_b128 v[156:159], v5 offset:11264
 v_mfma_f32_16x16x32_bf16 v[108:111], v[120:123], a[196:199], v[108:111]
 s_waitcnt lgkmcnt(6)
 v_mfma_f32_16x16x32_bf16 v[64:67], v[124:127], a[200:203], v[64:67]
 ds_read_b128 v[112:115], v5 offset:12288
 v_mfma_f32_16x16x32_bf16 v[100:103], v[124:127], a[204:207], v[100:103]
 v_mfma_f32_16x16x32_bf16 v[68:71], v[128:131], a[200:203], v[68:71]
 ds_read_b128 v[116:119], v5 offset:13312
 v_mfma_f32_16x16x32_bf16 v[104:107], v[128:131], a[204:207], v[104:107]
 v_mfma_f32_16x16x32_bf16 v[72:75], v[132:135], a[200:203], v[72:75]
 ds_read_b128 v[120:123], v5 offset:14336
 v_mfma_f32_16x16x32_bf16 v[108:111], v[132:135], a[204:207], v[108:111]
 s_waitcnt lgkmcnt(6)
 s_waitcnt vmcnt(9)
 s_barrier
 s_cmp_eq_u32 s32, 0
 s_cbranch_scc0 L_g2_nosig3
 v_mov_b32 v225, 1
 s_mov_b64 s[76:77], exec
 s_mov_b64 exec, 1
 buffer_atomic_add v225, v6, s[28:31], 0 offen sc1
 s_mov_b64 exec, s[76:77]
L_g2_nosig3:
 s_nop 0
 s_nop 2
 v_mfma_f32_16x16x32_bf16 v[64:67], v[136:139], a[208:211], v[64:67]
 ds_read_b128 v[124:127], v5 offset:15360
 v_mfma_f32_16x16x32_bf16 v[100:103], v[136:139], a[212:215], v[100:103]
 v_mfma_f32_16x16x32_bf16 v[68:71], v[140:143], a[208:211], v[68:71]
 ds_read_b128 v[128:131], v5 offset:16384
 v_mfma_f32_16x16x32_bf16 v[104:107], v[140:143], a[212:215], v[104:107]
 v_mfma_f32_16x16x32_bf16 v[72:75], v[144:147], a[208:211], v[72:75]
 ds_read_b128 v[132:135], v5 offset:17408
 v_mfma_f32_16x16x32_bf16 v[108:111], v[144:147], a[212:215], v[108:111]
 s_waitcnt lgkmcnt(6)
 v_mfma_f32_16x16x32_bf16 v[64:67], v[148:151], a[216:219], v[64:67]
 ds_read_b128 v[136:139], v5 offset:18432
 v_mfma_f32_16x16x32_bf16 v[100:103], v[148:151], a[220:223], v[100:103]
 v_mfma_f32_16x16x32_bf16 v[68:71], v[152:155], a[216:219], v[68:71]
 ds_read_b128 v[140:143], v5 offset:19456
 v_mfma_f32_16x16x32_bf16 v[104:107], v[152:155], a[220:223], v[104:107]
 v_mfma_f32_16x16x32_bf16 v[72:75], v[156:159], a[216:219], v[72:75]
 ds_read_b128 v[144:147], v5 offset:20480
 v_mfma_f32_16x16x32_bf16 v[108:111], v[156:159], a[220:223], v[108:111]
 s_waitcnt lgkmcnt(6)
 v_mfma_f32_16x16x32_bf16 v[64:67], v[112:115], a[224:227], v[64:67]
 ds_read_b128 v[148:151], v5 offset:21504
 v_mfma_f32_16x16x32_bf16 v[100:103], v[112:115], a[228:231], v[100:103]
 v_mfma_f32_16x16x32_bf16 v[68:71], v[116:119], a[224:227], v[68:71]
 ds_read_b128 v[152:155], v5 offset:22528
 v_mfma_f32_16x16x32_bf16 v[104:107], v[116:119], a[228:231], v[104:107]
 v_mfma_f32_16x16x32_bf16 v[72:75], v[120:123], a[224:227], v[72:75]
 ds_read_b128 v[156:159], v5 offset:23552
 v_mfma_f32_16x16x32_bf16 v[108:111], v[120:123], a[228:231], v[108:111]
 s_waitcnt lgkmcnt(6)
 v_mfma_f32_16x16x32_bf16 v[64:67], v[124:127], a[232:235], v[64:67]
 ds_read_b128 v[112:115], v5 offset:24576
 v_mfma_f32_16x16x32_bf16 v[100:103], v[124:127], a[236:239], v[100:103]
 v_mfma_f32_16x16x32_bf16 v[68:71], v[128:131], a[232:235], v[68:71]
 ds_read_b128 v[116:119], v5 offset:25600
 v_mfma_f32_16x16x32_bf16 v[104:107], v[128:131], a[236:239], v[104:107]
 v_mfma_f32_16x16x32_bf16 v[72:75], v[132:135], a[232:235], v[72:75]
 ds_read_b128 v[120:123], v5 offset:26624
 v_mfma_f32_16x16x32_bf16 v[108:111], v[132:135], a[236:239], v[108:111]
 s_waitcnt lgkmcnt(6)
 v_mfma_f32_16x16x32_bf16 v[64:67], v[136:139], a[240:243], v[64:67]
 ds_read_b128 v[124:127], v5 offset:27648
 v_mfma_f32_16x16x32_bf16 v[100:103], v[136:139], a[244:247], v[100:103]
 v_mfma_f32_16x16x32_bf16 v[68:71], v[140:143], a[240:243], v[68:71]
 ds_read_b128 v[128:131], v5 offset:28672
 v_mfma_f32_16x16x32_bf16 v[104:107], v[140:143], a[244:247], v[104:107]
 v_mfma_f32_16x16x32_bf16 v[72:75], v[144:147], a[240:243], v[72:75]
 ds_read_b128 v[132:135], v5 offset:29696
 v_mfma_f32_16x16x32_bf16 v[108:111], v[144:147], a[244:247], v[108:111]
 s_waitcnt lgkmcnt(6)
 v_mfma_f32_16x16x32_bf16 v[64:67], v[148:151], a[248:251], v[64:67]
 ds_read_b128 v[136:139], v5 offset:30720
 v_mfma_f32_16x16x32_bf16 v[100:103], v[148:151], a[252:255], v[100:103]
 v_mfma_f32_16x16x32_bf16 v[68:71], v[152:155], a[248:251], v[68:71]
 ds_read_b128 v[140:143], v5 offset:31744
 v_mfma_f32_16x16x32_bf16 v[104:107], v[152:155], a[252:255], v[104:107]
 v_mfma_f32_16x16x32_bf16 v[72:75], v[156:159], a[248:251], v[72:75]
 ds_read_b128 v[144:147], v5 offset:32768
 v_mfma_f32_16x16x32_bf16 v[108:111], v[156:159], a[252:255], v[108:111]
 s_waitcnt lgkmcnt(6)
 v_mfma_f32_16x16x32_bf16 v[64:67], v[112:115], v[8:11], v[64:67]
 ds_read_b128 v[148:151], v5 offset:33792
 v_mfma_f32_16x16x32_bf16 v[100:103], v[112:115], v[12:15], v[100:103]
 v_mfma_f32_16x16x32_bf16 v[68:71], v[116:119], v[8:11], v[68:71]
 ds_read_b128 v[152:155], v5 offset:34816
 v_mfma_f32_16x16x32_bf16 v[104:107], v[116:119], v[12:15], v[104:107]
 v_mfma_f32_16x16x32_bf16 v[72:75], v[120:123], v[8:11], v[72:75]
 ds_read_b128 v[156:159], v5 offset:35840
 v_mfma_f32_16x16x32_bf16 v[108:111], v[120:123], v[12:15], v[108:111]
 s_waitcnt lgkmcnt(6)
 v_mfma_f32_16x16x32_bf16 v[64:67], v[124:127], v[16:19], v[64:67]
 v_mfma_f32_16x16x32_bf16 v[100:103], v[124:127], v[20:23], v[100:103]
 v_mfma_f32_16x16x32_bf16 v[68:71], v[128:131], v[16:19], v[68:71]
 v_mfma_f32_16x16x32_bf16 v[104:107], v[128:131], v[20:23], v[104:107]
 v_mfma_f32_16x16x32_bf16 v[72:75], v[132:135], v[16:19], v[72:75]
 v_mfma_f32_16x16x32_bf16 v[108:111], v[132:135], v[20:23], v[108:111]
 s_waitcnt lgkmcnt(3)
 v_mfma_f32_16x16x32_bf16 v[64:67], v[136:139], v[24:27], v[64:67]
 v_mfma_f32_16x16x32_bf16 v[100:103], v[136:139], v[28:31], v[100:103]
 v_mfma_f32_16x16x32_bf16 v[68:71], v[140:143], v[24:27], v[68:71]
 v_mfma_f32_16x16x32_bf16 v[104:107], v[140:143], v[28:31], v[104:107]
 v_mfma_f32_16x16x32_bf16 v[72:75], v[144:147], v[24:27], v[72:75]
 v_mfma_f32_16x16x32_bf16 v[108:111], v[144:147], v[28:31], v[108:111]
 s_waitcnt lgkmcnt(0)
 v_mfma_f32_16x16x32_bf16 v[64:67], v[148:151], v[32:35], v[64:67]
 v_mfma_f32_16x16x32_bf16 v[100:103], v[148:151], v[36:39], v[100:103]
 v_mfma_f32_16x16x32_bf16 v[68:71], v[152:155], v[32:35], v[68:71]
 v_mfma_f32_16x16x32_bf16 v[104:107], v[152:155], v[36:39], v[104:107]
 v_mfma_f32_16x16x32_bf16 v[72:75], v[156:159], v[32:35], v[72:75]
 v_mfma_f32_16x16x32_bf16 v[108:111], v[156:159], v[36:39], v[108:111]
 s_lshl_b32 s84, s42, 2
 s_add_u32 s84, s84, 3
 s_lshl_b32 s84, s84, 2
 s_add_u32 s84, s84, 0
 s_lshl_b32 s84, s84, 2
 s_add_u32 s84, s84, s32
 s_mul_i32 s84, s84, 3072
 s_lshl_b32 s85, s42, 2
 s_add_u32 s85, s85, 3
 s_lshl_b32 s85, s85, 2
 s_add_u32 s85, s85, 1
 s_lshl_b32 s85, s85, 2
 s_add_u32 s85, s85, s32
 s_mul_i32 s85, s85, 3072
 s_lshl_b32 s86, s42, 2
 s_add_u32 s86, s86, 3
 s_lshl_b32 s86, s86, 2
 s_add_u32 s86, s86, 2
 s_lshl_b32 s86, s86, 2
 s_add_u32 s86, s86, s32
 s_mul_i32 s86, s86, 3072
 s_mul_i32 s40, s32, 3584
 v_and_b32 v2, 15, v0
 v_mul_u32_u24 v2, 112, v2
 v_lshrrev_b32 v3, 4, v0
 v_lshlrev_b32 v3, 3, v3
 v_add_u32 v2, v2, v3
 v_add_u32 v2, s40, v2
 s_cmp_eq_u32 s32, 0
 s_cbranch_scc0 L_g2_met3
 s_mov_b32 s56, 0
 s_mov_b64 s[76:77], exec
 s_mov_b64 exec, 1
L_g2_poll3:
 buffer_load_dword v225, v6, s[28:31], 0 offen sc1
 s_waitcnt vmcnt(0)
 v_readfirstlane_b32 s39, v225
 s_nop 0
 s_cmp_ge_u32 s39, 4
 s_cbranch_scc1 L_g2_met0_3
 s_add_u32 s56, s56, 1
 s_cmp_lt_u32 s56, 0x100000
 s_cbranch_scc0 L_g2_met0_3
 s_sleep 2
 s_branch L_g2_poll3
L_g2_met0_3:
 s_mov_b64 exec, s[76:77]
L_g2_met3:
 s_barrier
 buffer_load_dwordx4 v[112:115], v1, s[24:27], s84 offen offset:0 sc1
 buffer_load_dwordx4 v[116:119], v1, s[24:27], s84 offen offset:1024 sc1
 buffer_load_dwordx4 v[120:123], v1, s[24:27], s84 offen offset:2048 sc1
 buffer_load_dwordx4 v[124:127], v1, s[24:27], s85 offen offset:0 sc1
 buffer_load_dwordx4 v[128:131], v1, s[24:27], s85 offen offset:1024 sc1
 buffer_load_dwordx4 v[132:135], v1, s[24:27], s85 offen offset:2048 sc1
 buffer_load_dwordx4 v[136:139], v1, s[24:27], s86 offen offset:0 sc1
 buffer_load_dwordx4 v[140:143], v1, s[24:27], s86 offen offset:1024 sc1
 buffer_load_dwordx4 v[144:147], v1, s[24:27], s86 offen offset:2048 sc1
 s_mul_i32 s39, s32, 3584
 s_waitcnt vmcnt(0)
 v_lshlrev_b32 v4, 16, v112
 v_and_b32 v5, 0xffff0000, v112
 v_add_f32 v64, v64, v4
 v_add_f32 v65, v65, v5
 v_lshlrev_b32 v4, 16, v113
 v_and_b32 v5, 0xffff0000, v113
 v_add_f32 v66, v66, v4
 v_add_f32 v67, v67, v5
 v_lshlrev_b32 v4, 16, v124
 v_and_b32 v5, 0xffff0000, v124
 v_add_f32 v64, v64, v4
 v_add_f32 v65, v65, v5
 v_lshlrev_b32 v4, 16, v125
 v_and_b32 v5, 0xffff0000, v125
 v_add_f32 v66, v66, v4
 v_add_f32 v67, v67, v5
 v_lshlrev_b32 v4, 16, v136
 v_and_b32 v5, 0xffff0000, v136
 v_add_f32 v64, v64, v4
 v_add_f32 v65, v65, v5
 v_lshlrev_b32 v4, 16, v137
 v_and_b32 v5, 0xffff0000, v137
 v_add_f32 v66, v66, v4
 v_add_f32 v67, v67, v5
 v_lshlrev_b32 v4, 16, v200
 v_and_b32 v5, 0xffff0000, v200
 v_fma_f32 v64, v212, v64, v4
 v_fma_f32 v65, v213, v65, v5
 v_lshlrev_b32 v4, 16, v201
 v_and_b32 v5, 0xffff0000, v201
 v_fma_f32 v66, v214, v66, v4
 v_fma_f32 v67, v215, v67, v5
 v_cvt_pk_bf16_f32 v64, v64, v65
 v_cvt_pk_bf16_f32 v65, v66, v67
 ds_write_b64 v2, v[64:65] offset:0
 v_lshlrev_b32 v4, 16, v114
 v_and_b32 v5, 0xffff0000, v114
 v_add_f32 v68, v68, v4
 v_add_f32 v69, v69, v5
 v_lshlrev_b32 v4, 16, v115
 v_and_b32 v5, 0xffff0000, v115
 v_add_f32 v70, v70, v4
 v_add_f32 v71, v71, v5
 v_lshlrev_b32 v4, 16, v126
 v_and_b32 v5, 0xffff0000, v126
 v_add_f32 v68, v68, v4
 v_add_f32 v69, v69, v5
 v_lshlrev_b32 v4, 16, v127
 v_and_b32 v5, 0xffff0000, v127
 v_add_f32 v70, v70, v4
 v_add_f32 v71, v71, v5
 v_lshlrev_b32 v4, 16, v138
 v_and_b32 v5, 0xffff0000, v138
 v_add_f32 v68, v68, v4
 v_add_f32 v69, v69, v5
 v_lshlrev_b32 v4, 16, v139
 v_and_b32 v5, 0xffff0000, v139
 v_add_f32 v70, v70, v4
 v_add_f32 v71, v71, v5
 v_lshlrev_b32 v4, 16, v204
 v_and_b32 v5, 0xffff0000, v204
 v_fma_f32 v68, v216, v68, v4
 v_fma_f32 v69, v217, v69, v5
 v_lshlrev_b32 v4, 16, v205
 v_and_b32 v5, 0xffff0000, v205
 v_fma_f32 v70, v218, v70, v4
 v_fma_f32 v71, v219, v71, v5
 v_cvt_pk_bf16_f32 v68, v68, v69
 v_cvt_pk_bf16_f32 v69, v70, v71
 ds_write_b64 v2, v[68:69] offset:32
 v_lshlrev_b32 v4, 16, v120
 v_and_b32 v5, 0xffff0000, v120
 v_add_f32 v72, v72, v4
 v_add_f32 v73, v73, v5
 v_lshlrev_b32 v4, 16, v121
 v_and_b32 v5, 0xffff0000, v121
 v_add_f32 v74, v74, v4
 v_add_f32 v75, v75, v5
 v_lshlrev_b32 v4, 16, v132
 v_and_b32 v5, 0xffff0000, v132
 v_add_f32 v72, v72, v4
 v_add_f32 v73, v73, v5
 v_lshlrev_b32 v4, 16, v133
 v_and_b32 v5, 0xffff0000, v133
 v_add_f32 v74, v74, v4
 v_add_f32 v75, v75, v5
 v_lshlrev_b32 v4, 16, v144
 v_and_b32 v5, 0xffff0000, v144
 v_add_f32 v72, v72, v4
 v_add_f32 v73, v73, v5
 v_lshlrev_b32 v4, 16, v145
 v_and_b32 v5, 0xffff0000, v145
 v_add_f32 v74, v74, v4
 v_add_f32 v75, v75, v5
 v_lshlrev_b32 v4, 16, v208
 v_and_b32 v5, 0xffff0000, v208
 v_fma_f32 v72, v220, v72, v4
 v_fma_f32 v73, v221, v73, v5
 v_lshlrev_b32 v4, 16, v209
 v_and_b32 v5, 0xffff0000, v209
 v_fma_f32 v74, v222, v74, v4
 v_fma_f32 v75, v223, v75, v5
 v_cvt_pk_bf16_f32 v72, v72, v73
 v_cvt_pk_bf16_f32 v73, v74, v75
 ds_write_b64 v2, v[72:73] offset:64
 v_lshlrev_b32 v4, 16, v116
 v_and_b32 v5, 0xffff0000, v116
 v_add_f32 v100, v100, v4
 v_add_f32 v101, v101, v5
 v_lshlrev_b32 v4, 16, v117
 v_and_b32 v5, 0xffff0000, v117
 v_add_f32 v102, v102, v4
 v_add_f32 v103, v103, v5
 v_lshlrev_b32 v4, 16, v128
 v_and_b32 v5, 0xffff0000, v128
 v_add_f32 v100, v100, v4
 v_add_f32 v101, v101, v5
 v_lshlrev_b32 v4, 16, v129
 v_and_b32 v5, 0xffff0000, v129
 v_add_f32 v102, v102, v4
 v_add_f32 v103, v103, v5
 v_lshlrev_b32 v4, 16, v140
 v_and_b32 v5, 0xffff0000, v140
 v_add_f32 v100, v100, v4
 v_add_f32 v101, v101, v5
 v_lshlrev_b32 v4, 16, v141
 v_and_b32 v5, 0xffff0000, v141
 v_add_f32 v102, v102, v4
 v_add_f32 v103, v103, v5
 v_lshlrev_b32 v4, 16, v202
 v_and_b32 v5, 0xffff0000, v202
 v_fma_f32 v100, v212, v100, v4
 v_fma_f32 v101, v213, v101, v5
 v_lshlrev_b32 v4, 16, v203
 v_and_b32 v5, 0xffff0000, v203
 v_fma_f32 v102, v214, v102, v4
 v_fma_f32 v103, v215, v103, v5
 v_cvt_pk_bf16_f32 v100, v100, v101
 v_cvt_pk_bf16_f32 v101, v102, v103
 ds_write_b64 v2, v[100:101] offset:1792
 v_lshlrev_b32 v4, 16, v118
 v_and_b32 v5, 0xffff0000, v118
 v_add_f32 v104, v104, v4
 v_add_f32 v105, v105, v5
 v_lshlrev_b32 v4, 16, v119
 v_and_b32 v5, 0xffff0000, v119
 v_add_f32 v106, v106, v4
 v_add_f32 v107, v107, v5
 v_lshlrev_b32 v4, 16, v130
 v_and_b32 v5, 0xffff0000, v130
 v_add_f32 v104, v104, v4
 v_add_f32 v105, v105, v5
 v_lshlrev_b32 v4, 16, v131
 v_and_b32 v5, 0xffff0000, v131
 v_add_f32 v106, v106, v4
 v_add_f32 v107, v107, v5
 v_lshlrev_b32 v4, 16, v142
 v_and_b32 v5, 0xffff0000, v142
 v_add_f32 v104, v104, v4
 v_add_f32 v105, v105, v5
 v_lshlrev_b32 v4, 16, v143
 v_and_b32 v5, 0xffff0000, v143
 v_add_f32 v106, v106, v4
 v_add_f32 v107, v107, v5
 v_lshlrev_b32 v4, 16, v206
 v_and_b32 v5, 0xffff0000, v206
 v_fma_f32 v104, v216, v104, v4
 v_fma_f32 v105, v217, v105, v5
 v_lshlrev_b32 v4, 16, v207
 v_and_b32 v5, 0xffff0000, v207
 v_fma_f32 v106, v218, v106, v4
 v_fma_f32 v107, v219, v107, v5
 v_cvt_pk_bf16_f32 v104, v104, v105
 v_cvt_pk_bf16_f32 v105, v106, v107
 ds_write_b64 v2, v[104:105] offset:1824
 v_lshlrev_b32 v4, 16, v122
 v_and_b32 v5, 0xffff0000, v122
 v_add_f32 v108, v108, v4
 v_add_f32 v109, v109, v5
 v_lshlrev_b32 v4, 16, v123
 v_and_b32 v5, 0xffff0000, v123
 v_add_f32 v110, v110, v4
 v_add_f32 v111, v111, v5
 v_lshlrev_b32 v4, 16, v134
 v_and_b32 v5, 0xffff0000, v134
 v_add_f32 v108, v108, v4
 v_add_f32 v109, v109, v5
 v_lshlrev_b32 v4, 16, v135
 v_and_b32 v5, 0xffff0000, v135
 v_add_f32 v110, v110, v4
 v_add_f32 v111, v111, v5
 v_lshlrev_b32 v4, 16, v146
 v_and_b32 v5, 0xffff0000, v146
 v_add_f32 v108, v108, v4
 v_add_f32 v109, v109, v5
 v_lshlrev_b32 v4, 16, v147
 v_and_b32 v5, 0xffff0000, v147
 v_add_f32 v110, v110, v4
 v_add_f32 v111, v111, v5
 v_lshlrev_b32 v4, 16, v210
 v_and_b32 v5, 0xffff0000, v210
 v_fma_f32 v108, v220, v108, v4
 v_fma_f32 v109, v221, v109, v5
 v_lshlrev_b32 v4, 16, v211
 v_and_b32 v5, 0xffff0000, v211
 v_fma_f32 v110, v222, v110, v4
 v_fma_f32 v111, v223, v111, v5
 v_cvt_pk_bf16_f32 v108, v108, v109
 v_cvt_pk_bf16_f32 v109, v110, v111
 ds_write_b64 v2, v[108:109] offset:1856
 s_lshl_b32 s40, s57, 4
 s_mul_i32 s40, s40, 1152
 s_lshl_b32 s43, s58, 5
 s_add_u32 s40, s40, s43
 s_waitcnt lgkmcnt(0)
 v_add_u32 v3, 0, v0
 v_mul_u32_u24 v4, 10923, v3
 v_lshrrev_b32 v4, 16, v4
 v_mul_u32_u24 v5, 6, v4
 v_sub_u32 v3, v3, v5
 v_lshlrev_b32 v3, 4, v3
 v_mul_u32_u24 v5, 112, v4
 v_add_u32 v5, v5, v3
 v_add_u32 v5, s39, v5
 ds_read_b128 v[168:171], v5
 v_mul_u32_u24 v4, 1152, v4
 v_add_u32 v226, v4, v3
 v_add_u32 v3, 64, v0
 v_mul_u32_u24 v4, 10923, v3
 v_lshrrev_b32 v4, 16, v4
 v_mul_u32_u24 v5, 6, v4
 v_sub_u32 v3, v3, v5
 v_lshlrev_b32 v3, 4, v3
 v_mul_u32_u24 v5, 112, v4
 v_add_u32 v5, v5, v3
 v_add_u32 v5, s39, v5
 ds_read_b128 v[172:175], v5
 v_mul_u32_u24 v4, 1152, v4
 v_add_u32 v227, v4, v3
 v_add_u32 v3, 128, v0
 v_mul_u32_u24 v4, 10923, v3
 v_lshrrev_b32 v4, 16, v4
 v_mul_u32_u24 v5, 6, v4
 v_sub_u32 v3, v3, v5
 v_lshlrev_b32 v3, 4, v3
 v_mul_u32_u24 v5, 112, v4
 v_add_u32 v5, v5, v3
 v_add_u32 v5, s39, v5
 ds_read_b128 v[176:179], v5
 v_mul_u32_u24 v4, 1152, v4
 v_add_u32 v228, v4, v3
 s_waitcnt lgkmcnt(0)
 buffer_store_dwordx4 v[168:171], v226, s[52:55], s40 offen
 buffer_store_dwordx4 v[172:175], v227, s[52:55], s40 offen
 buffer_store_dwordx4 v[176:179], v228, s[52:55], s40 offen
 s_branch L_g2a_done
L_g2a_done:
L_pg_end:
 s_endpgm
pg_kernel_codeend:
.section .rodata,"a"
.p2align 6
.amdhsa_kernel k01_kernel
  .amdhsa_next_free_vgpr 340
  .amdhsa_next_free_sgpr 102
  .amdhsa_accum_offset 256
  .amdhsa_group_segment_fixed_size 0
  .amdhsa_kernarg_size 96
  .amdhsa_user_sgpr_count 2
  .amdhsa_user_sgpr_kernarg_segment_ptr 1
  .amdhsa_system_sgpr_workgroup_id_x 1
  .amdhsa_float_denorm_mode_32 3
.end_amdhsa_kernel
.p2align 6
.amdhsa_kernel att_kernel
  .amdhsa_next_free_vgpr 140
  .amdhsa_next_free_sgpr 102
  .amdhsa_accum_offset 140
  .amdhsa_group_segment_fixed_size 0
  .amdhsa_kernarg_size 96
  .amdhsa_user_sgpr_count 2
  .amdhsa_user_sgpr_kernarg_segment_ptr 1
  .amdhsa_system_sgpr_workgroup_id_x 1
  .amdhsa_float_denorm_mode_32 3
.end_amdhsa_kernel
.p2align 6
.amdhsa_kernel pg_kernel
  .amdhsa_next_free_vgpr 504
  .amdhsa_next_free_sgpr 102
  .amdhsa_accum_offset 248
  .amdhsa_group_segment_fixed_size 0
  .amdhsa_kernarg_size 96
  .amdhsa_user_sgpr_count 2
  .amdhsa_user_sgpr_kernarg_segment_ptr 1
  .amdhsa_system_sgpr_workgroup_id_x 1
  .amdhsa_float_denorm_mode_32 3
.end_amdhsa_kernel
```
